```python
import torch

def _softmax(x, axis=-1):
    return torch.softmax(x, dim=axis)
def _gelu(x):
    return torch.nn.functional.gelu(x, approximate="tanh")
def _silu(x):
    return torch.nn.functional.silu(x)
def _sigmoid(x):
    return torch.sigmoid(x)
def _layernorm(x, axis=-1, eps=1e-5):
    m = x.mean(dim=axis, keepdim=True)
    v = x.var(dim=axis, keepdim=True, unbiased=False)
    return (x - m) / torch.sqrt(v + eps)
def _scatter_add(tgt, idx, src, axis=0):
    return tgt.clone().index_add_(axis, idx, src)
def _segment_sum(src, seg, n):
    out = torch.zeros((n,) + src.shape[1:], dtype=src.dtype)
    return out.index_add_(0, seg, src)
def _pad(x, pw):
    flat = tuple(v for pair in reversed(pw) for v in pair)
    return torch.nn.functional.pad(x, flat)

kernel_name = 'sequential_preLN__sliding_block_cached__glu_gated_swiglu__decode'

def setup_inputs():

    _w = (lambda a: (lambda t: t.to(torch.bfloat16) if t.is_floating_point() else t)(torch.as_tensor(a)))
    def _A_setup():
        B, Sq, D = 1, 1, 640
        Hq, Hkv, Sk, Dh = 32, 32, 32768, 192
        assert Hq % Hkv == 0, (Hq, Hkv)
        return {
            "x": _w((lambda *s: torch.randn(*s, dtype=torch.bfloat16) * 0.05)(B, Sq, D)),
            "k_cache": _w((lambda *s: torch.randn(*s, dtype=torch.bfloat16) * 1.6)(B, Hkv, Sk, Dh)),
            "v_cache": _w((lambda *s: torch.randn(*s, dtype=torch.bfloat16) * 0.8)(B, Hkv, Sk, Dh)),
            "wq": _w((lambda *s: torch.randn(*s, dtype=torch.bfloat16) * 1.6)(D, Hq * Dh) * (D ** -0.5)),
            "wo": _w((lambda *s: torch.randn(*s, dtype=torch.bfloat16) * 0.8)(Hq * Dh, D) * ((Hq * Dh) ** -0.5)),
        }
    _A_in = _A_setup()

    def _B_setup():
        B, S, D, F = 1, 1, 640, 1536
        return {
            "x": _w((lambda *s: torch.randn(*s, dtype=torch.bfloat16) * 0.05)(B, S, D)),
            "w1": _w((lambda *s: torch.randn(*s, dtype=torch.bfloat16) * 0.4)(D, F) * (2.0 / D) ** 0.5),
            "w3": _w((lambda *s: torch.randn(*s, dtype=torch.bfloat16) * 0.4)(D, F) * (2.0 / D) ** 0.5),
            "w2": _w((lambda *s: torch.randn(*s, dtype=torch.bfloat16) * 0.4)(F, D) * (2.0 / F) ** 0.5),
        }
    _B_in = _B_setup()

    return {
        "A_x": _A_in["x"],
        "A_k_cache": _A_in["k_cache"],
        "A_v_cache": _A_in["v_cache"],
        "A_wq": _A_in["wq"],
        "A_wo": _A_in["wo"],
        "B_x": _B_in["x"],
        "B_w1": _B_in["w1"],
        "B_w3": _B_in["w3"],
        "B_w2": _B_in["w2"],
    }

def reference(A_x, A_k_cache, A_v_cache, A_wq, A_wo, B_x, B_w1, B_w3, B_w2):
    def _A_ref(x, k_cache, v_cache, wq, wo):
        B, Sq, D = x.shape
        Hq, Dh = 32, 192
        Hkv, Sk = k_cache.shape[1], k_cache.shape[2]
        W = min(4096, max(256, Sk // 4))
        rep = Hq // Hkv
        q = (lambda x, *d: x.permute(*d))((x @ wq).reshape(B, Sq, Hq, Dh), 0, 2, 1, 3)
        k = (lambda x, n, axis: torch.repeat_interleave(x, n, dim=axis))(k_cache[:, :, Sk - W:, :], rep, axis=1)
        v = (lambda x, n, axis: torch.repeat_interleave(x, n, dim=axis))(v_cache[:, :, Sk - W:, :], rep, axis=1)
        scores = torch.einsum("bhqd,bhkd->bhqk", q, k) * (Dh ** -0.5)
        p = _softmax(scores, axis=-1)
        o = torch.einsum("bhqk,bhkd->bhqd", p, v)
        return (lambda x, *d: x.permute(*d))(o, 0, 2, 1, 3).reshape(B, Sq, Hq * Dh) @ wo

    def _B_ref(x, w1, w3, w2):
        gate = torch.einsum("bsd,df->bsf", x, w1)
        up = torch.einsum("bsd,df->bsf", x, w3)
        h = _silu(gate) * up
        out = torch.einsum("bsf,fd->bsd", h, w2)
        return out

    x = A_x
    h = x + _A_ref(_layernorm(x, axis=-1), A_k_cache, A_v_cache, A_wq, A_wo)
    h2 = h + _B_ref(_layernorm(h, axis=-1), B_w1, B_w3, B_w2)
    return h2
```

```asm
; @launch grid=(256,1,1) block=(768,1,1) lds=57856
.amdgcn_target "amdgcn-amd-amdhsa--gfx950"
.text
.globl sequential_preLN__sliding_block_cached__glu_gated_swiglu__decode_kernel
.p2align 8
.type sequential_preLN__sliding_block_cached__glu_gated_swiglu__decode_kernel,@function
sequential_preLN__sliding_block_cached__glu_gated_swiglu__decode_kernel:
  s_load_dwordx2 s[8:9], s[0:1], 8
  s_lshr_b32 s79, s2, 6
  s_cmp_gt_u32 s79, 3
  s_cbranch_scc1 L_end
  v_readfirstlane_b32 s3, v0
  s_and_b32 s4, s2, 7
  s_lshl2_add_u32 s6, s4, s79
  s_bfe_u32 s7, s2, 0x30003
  s_lshr_b32 s73, s3, 6
  s_cmp_gt_u32 s73, 7
  s_cbranch_scc1 L_helper0
  s_lshl_b32 s60, s6, 9
  s_add_u32 s60, s60, s7
  s_addk_i32 s60, 448
  s_mulk_i32 s60, 24576
  v_lshlrev_b32 v3, 4, v0
  v_lshrrev_b32 v2, 3, v0
  v_lshl_add_u32 v1, v2, 8, v3
  s_lshl_b32 s10, 3, 27
  s_mov_b32 s11, 0x20000
  s_waitcnt lgkmcnt(0)
  buffer_load_dwordx4 v[16:19], v1, s[8:11], s60 offen offset:0 nt
  buffer_load_dwordx4 v[20:23], v1, s[8:11], s60 offen offset:128 nt
  buffer_load_dwordx4 v[24:27], v1, s[8:11], s60 offen offset:256 nt
  s_branch L_stream0
L_helper0:
  s_load_dwordx16 s[36:51], s[0:1], 0
  s_load_dwordx8 s[52:59], s[0:1], 64
  v_and_b32 v0, 63, v0
  s_sub_u32 s3, s73, 8
  s_cmp_lg_u32 s3, 3
  s_cbranch_scc1 L_helper
  s_getpc_b64 s[20:21]
L_pc0:
  v_lshlrev_b32 v8, 7, v0
  v_add_u32 v9, 8192, v8
  v_min_u32 v9, L_codeend-L_pc0-4, v9
  global_load_dword v10, v8, s[20:21]
  global_load_dword v11, v9, s[20:21]
  v_add_u32 v9, 16384, v8
  v_min_u32 v9, L_codeend-L_pc0-4, v9
  global_load_dword v30, v9, s[20:21]
  v_lshlrev_b32 v1, 3, v0
  v_mov_b32 v4, 0
  v_mov_b32 v5, 0
  ds_write_b64 v1, v[4:5] offset:384
  s_branch L_helper
L_stream0:
  s_load_dwordx16 s[36:51], s[0:1], 0
  s_load_dwordx8 s[52:59], s[0:1], 64
  s_memrealtime s[20:21]
  v_and_b32 v0, 63, v0
  s_add_u32 s3, s73, 4
  v_and_b32 v3, 0x70, v3
  s_waitcnt lgkmcnt(0)
  s_add_u32 s61, s60, 196608
  s_barrier
  s_waitcnt vmcnt(2)
  buffer_load_dwordx4 v[28:31], v1, s[8:11], s61 offen offset:0 nt
  s_load_dwordx2 s[28:29], s[58:59], 917504
  s_mov_b32 s24, s58
  s_mov_b32 s25, s59
  s_mov_b32 s26, 4194304
  s_mov_b32 s27, 0x20000
  s_add_u32 s32, s58, 4194304
  s_addc_u32 s33, s59, 0
  s_mov_b32 s34, 4194304
  s_mov_b32 s35, 0x20000
  s_lshl3_add_u32 s71, s6, s7
  s_mov_b32 s12, s40
  s_mov_b32 s13, s41
  s_mov_b32 s14, 402653184
  s_mov_b32 s15, 0x20000
  s_waitcnt vmcnt(2)
  buffer_load_dwordx4 v[32:35], v1, s[8:11], s61 offen offset:128 nt
  s_waitcnt vmcnt(2)
  buffer_load_dwordx4 v[36:39], v1, s[8:11], s61 offen offset:256 nt
  s_add_u32 s62, s61, 196608
  s_waitcnt vmcnt(2)
  buffer_load_dwordx4 v[40:43], v1, s[8:11], s62 offen offset:0 nt
  s_waitcnt vmcnt(2)
  buffer_load_dwordx4 v[44:47], v1, s[8:11], s62 offen offset:128 nt
  s_waitcnt vmcnt(2)
  buffer_load_dwordx4 v[48:51], v1, s[8:11], s62 offen offset:256 nt
  s_add_u32 s63, s62, 196608
  s_waitcnt vmcnt(2)
  buffer_load_dwordx4 v[52:55], v1, s[8:11], s63 offen offset:0 nt
  s_waitcnt vmcnt(2)
  buffer_load_dwordx4 v[56:59], v1, s[8:11], s63 offen offset:128 nt
  s_waitcnt vmcnt(2)
  buffer_load_dwordx4 v[60:63], v1, s[8:11], s63 offen offset:256 nt
  s_add_u32 s64, s63, 196608
  s_waitcnt vmcnt(2)
  buffer_load_dwordx4 v[64:67], v1, s[8:11], s64 offen offset:0 nt
  s_waitcnt vmcnt(2)
  buffer_load_dwordx4 v[68:71], v1, s[8:11], s64 offen offset:128 nt
  s_waitcnt vmcnt(2)
  buffer_load_dwordx4 v[72:75], v1, s[8:11], s64 offen offset:256 nt
  s_add_u32 s65, s64, 196608
  s_waitcnt vmcnt(2)
  buffer_load_dwordx4 v[76:79], v1, s[8:11], s65 offen offset:0 nt
  s_waitcnt vmcnt(2)
  buffer_load_dwordx4 v[80:83], v1, s[8:11], s65 offen offset:128 nt
  s_waitcnt vmcnt(2)
  buffer_load_dwordx4 v[84:87], v1, s[8:11], s65 offen offset:256 nt
  s_memrealtime s[76:77]
  s_waitcnt lgkmcnt(0)
  s_sub_u32 s75, s76, s20
  s_add_u32 s75, s75, 0x1000000
  v_mov_b32 v6, 0
  v_mov_b32 v8, s76
  v_mov_b32 v9, s75
  s_mov_b64 exec, 1
  ds_add_u32 v6, v8 offset:696
  ds_add_u32 v6, v9 offset:700
  s_mov_b64 exec, -1
  s_add_u32 s66, s65, 196608
  s_waitcnt vmcnt(2)
  buffer_load_dwordx4 v[88:91], v1, s[8:11], s66 offen offset:0 nt
  s_waitcnt vmcnt(2)
  buffer_load_dwordx4 v[92:95], v1, s[8:11], s66 offen offset:128 nt
  s_waitcnt vmcnt(2)
  buffer_load_dwordx4 v[96:99], v1, s[8:11], s66 offen offset:256 nt
  s_add_u32 s67, s66, 196608
  s_waitcnt vmcnt(2)
  buffer_load_dwordx4 v[100:103], v1, s[8:11], s67 offen offset:0 nt
  s_waitcnt vmcnt(2)
  buffer_load_dwordx4 v[104:107], v1, s[8:11], s67 offen offset:128 nt
  s_waitcnt vmcnt(2)
  buffer_load_dwordx4 v[108:111], v1, s[8:11], s67 offen offset:256 nt
  s_waitcnt vmcnt(2)
  buffer_load_dwordx4 v[112:115], v1, s[12:15], s60 offen offset:0 nt
  s_waitcnt vmcnt(2)
  buffer_load_dwordx4 v[116:119], v1, s[12:15], s60 offen offset:128 nt
  s_waitcnt vmcnt(2)
  buffer_load_dwordx4 v[120:123], v1, s[12:15], s60 offen offset:256 nt
  v_mov_b32 v6, 0
  v_mov_b32 v7, 1
  s_mov_b64 exec, 1
  ds_add_u32 v6, v7 offset:692
  s_mov_b64 exec, -1
  s_waitcnt lgkmcnt(0)
  s_mul_i32 s30, s28, 0x2c9277b5
  s_add_u32 s30, s30, 0xac564b05
  s_mul_i32 s31, s29, 0x0019660d
  s_add_u32 s31, s31, 0x3c6ef35f
  v_and_b32 v2, 3, v0
  v_min_u32 v2, 2, v2
  v_lshlrev_b32 v2, 3, v2
  s_mov_b32 s70, 200007
L_spin_1:
  ds_read_b32 v4, v2 offset:384
  s_waitcnt lgkmcnt(0)
  v_cmp_eq_u32 vcc, 0, v4
  s_nop 0
  s_cbranch_vccz L_sdone_2
  s_sleep 1
  s_sub_u32 s70, s70, 1
  s_cbranch_scc0 L_spin_1
L_sdone_2:
  ds_read_b128 v[4:7], v3 offset:0
  ds_read_b128 v[8:11], v3 offset:128
  ds_read_b128 v[12:15], v3 offset:256
  v_mov_b32 v160, 0
  v_mov_b32 v161, 0
  v_mov_b32 v162, 0
  v_mov_b32 v163, 0
  v_mov_b32 v164, 0
  v_mov_b32 v165, 0
  v_mov_b32 v166, 0
  v_mov_b32 v167, 0
  s_waitcnt vmcnt(3) lgkmcnt(0)
  v_dot2c_f32_bf16 v160, v16, v4
  v_dot2c_f32_bf16 v161, v28, v4
  v_dot2c_f32_bf16 v162, v40, v4
  v_dot2c_f32_bf16 v163, v52, v4
  v_dot2c_f32_bf16 v160, v17, v5
  v_dot2c_f32_bf16 v161, v29, v5
  v_dot2c_f32_bf16 v162, v41, v5
  v_dot2c_f32_bf16 v163, v53, v5
  v_dot2c_f32_bf16 v160, v18, v6
  v_dot2c_f32_bf16 v161, v30, v6
  v_dot2c_f32_bf16 v162, v42, v6
  v_dot2c_f32_bf16 v163, v54, v6
  v_dot2c_f32_bf16 v160, v19, v7
  v_dot2c_f32_bf16 v161, v31, v7
  v_dot2c_f32_bf16 v162, v43, v7
  v_dot2c_f32_bf16 v163, v55, v7
  v_dot2c_f32_bf16 v160, v20, v8
  v_dot2c_f32_bf16 v161, v32, v8
  v_dot2c_f32_bf16 v162, v44, v8
  v_dot2c_f32_bf16 v163, v56, v8
  v_dot2c_f32_bf16 v160, v21, v9
  v_dot2c_f32_bf16 v161, v33, v9
  v_dot2c_f32_bf16 v162, v45, v9
  v_dot2c_f32_bf16 v163, v57, v9
  v_dot2c_f32_bf16 v160, v22, v10
  v_dot2c_f32_bf16 v161, v34, v10
  v_dot2c_f32_bf16 v162, v46, v10
  v_dot2c_f32_bf16 v163, v58, v10
  v_dot2c_f32_bf16 v160, v23, v11
  v_dot2c_f32_bf16 v161, v35, v11
  v_dot2c_f32_bf16 v162, v47, v11
  v_dot2c_f32_bf16 v163, v59, v11
  v_dot2c_f32_bf16 v160, v24, v12
  v_dot2c_f32_bf16 v161, v36, v12
  v_dot2c_f32_bf16 v162, v48, v12
  v_dot2c_f32_bf16 v163, v60, v12
  v_dot2c_f32_bf16 v160, v25, v13
  v_dot2c_f32_bf16 v161, v37, v13
  v_dot2c_f32_bf16 v162, v49, v13
  v_dot2c_f32_bf16 v163, v61, v13
  v_dot2c_f32_bf16 v160, v26, v14
  v_dot2c_f32_bf16 v161, v38, v14
  v_dot2c_f32_bf16 v162, v50, v14
  v_dot2c_f32_bf16 v163, v62, v14
  v_dot2c_f32_bf16 v160, v27, v15
  v_dot2c_f32_bf16 v161, v39, v15
  v_dot2c_f32_bf16 v162, v51, v15
  v_dot2c_f32_bf16 v163, v63, v15
  v_dot2c_f32_bf16 v164, v64, v4
  v_dot2c_f32_bf16 v165, v76, v4
  v_dot2c_f32_bf16 v166, v88, v4
  v_dot2c_f32_bf16 v167, v100, v4
  v_dot2c_f32_bf16 v164, v65, v5
  v_dot2c_f32_bf16 v165, v77, v5
  v_dot2c_f32_bf16 v166, v89, v5
  v_dot2c_f32_bf16 v167, v101, v5
  v_dot2c_f32_bf16 v164, v66, v6
  v_dot2c_f32_bf16 v165, v78, v6
  v_dot2c_f32_bf16 v166, v90, v6
  v_dot2c_f32_bf16 v167, v102, v6
  v_dot2c_f32_bf16 v164, v67, v7
  v_dot2c_f32_bf16 v165, v79, v7
  v_dot2c_f32_bf16 v166, v91, v7
  v_dot2c_f32_bf16 v167, v103, v7
  v_dot2c_f32_bf16 v164, v68, v8
  v_dot2c_f32_bf16 v165, v80, v8
  v_dot2c_f32_bf16 v166, v92, v8
  v_dot2c_f32_bf16 v167, v104, v8
  v_dot2c_f32_bf16 v164, v69, v9
  v_dot2c_f32_bf16 v165, v81, v9
  v_dot2c_f32_bf16 v166, v93, v9
  v_dot2c_f32_bf16 v167, v105, v9
  v_dot2c_f32_bf16 v164, v70, v10
  v_dot2c_f32_bf16 v165, v82, v10
  v_dot2c_f32_bf16 v166, v94, v10
  v_dot2c_f32_bf16 v167, v106, v10
  v_dot2c_f32_bf16 v164, v71, v11
  v_dot2c_f32_bf16 v165, v83, v11
  v_dot2c_f32_bf16 v166, v95, v11
  v_dot2c_f32_bf16 v167, v107, v11
  v_dot2c_f32_bf16 v164, v72, v12
  v_dot2c_f32_bf16 v165, v84, v12
  v_dot2c_f32_bf16 v166, v96, v12
  v_dot2c_f32_bf16 v167, v108, v12
  v_dot2c_f32_bf16 v164, v73, v13
  v_dot2c_f32_bf16 v165, v85, v13
  v_dot2c_f32_bf16 v166, v97, v13
  v_dot2c_f32_bf16 v167, v109, v13
  v_dot2c_f32_bf16 v164, v74, v14
  v_dot2c_f32_bf16 v165, v86, v14
  v_dot2c_f32_bf16 v166, v98, v14
  v_dot2c_f32_bf16 v167, v110, v14
  v_dot2c_f32_bf16 v164, v75, v15
  v_dot2c_f32_bf16 v165, v87, v15
  v_dot2c_f32_bf16 v166, v99, v15
  v_dot2c_f32_bf16 v167, v111, v15
  v_add_f32_dpp v160, v160, v160 quad_perm:[1,0,3,2] row_mask:0xf bank_mask:0xf
  v_add_f32_dpp v161, v161, v161 quad_perm:[1,0,3,2] row_mask:0xf bank_mask:0xf
  v_add_f32_dpp v162, v162, v162 quad_perm:[1,0,3,2] row_mask:0xf bank_mask:0xf
  v_add_f32_dpp v163, v163, v163 quad_perm:[1,0,3,2] row_mask:0xf bank_mask:0xf
  v_add_f32_dpp v164, v164, v164 quad_perm:[1,0,3,2] row_mask:0xf bank_mask:0xf
  v_add_f32_dpp v165, v165, v165 quad_perm:[1,0,3,2] row_mask:0xf bank_mask:0xf
  v_add_f32_dpp v166, v166, v166 quad_perm:[1,0,3,2] row_mask:0xf bank_mask:0xf
  v_add_f32_dpp v167, v167, v167 quad_perm:[1,0,3,2] row_mask:0xf bank_mask:0xf
  v_add_f32_dpp v160, v160, v160 quad_perm:[2,3,0,1] row_mask:0xf bank_mask:0xf
  v_add_f32_dpp v161, v161, v161 quad_perm:[2,3,0,1] row_mask:0xf bank_mask:0xf
  v_add_f32_dpp v162, v162, v162 quad_perm:[2,3,0,1] row_mask:0xf bank_mask:0xf
  v_add_f32_dpp v163, v163, v163 quad_perm:[2,3,0,1] row_mask:0xf bank_mask:0xf
  v_add_f32_dpp v164, v164, v164 quad_perm:[2,3,0,1] row_mask:0xf bank_mask:0xf
  v_add_f32_dpp v165, v165, v165 quad_perm:[2,3,0,1] row_mask:0xf bank_mask:0xf
  v_add_f32_dpp v166, v166, v166 quad_perm:[2,3,0,1] row_mask:0xf bank_mask:0xf
  v_add_f32_dpp v167, v167, v167 quad_perm:[2,3,0,1] row_mask:0xf bank_mask:0xf
  v_add_f32_dpp v160, v160, v160 row_half_mirror row_mask:0xf bank_mask:0xf
  v_add_f32_dpp v161, v161, v161 row_half_mirror row_mask:0xf bank_mask:0xf
  v_add_f32_dpp v162, v162, v162 row_half_mirror row_mask:0xf bank_mask:0xf
  v_add_f32_dpp v163, v163, v163 row_half_mirror row_mask:0xf bank_mask:0xf
  v_add_f32_dpp v164, v164, v164 row_half_mirror row_mask:0xf bank_mask:0xf
  v_add_f32_dpp v165, v165, v165 row_half_mirror row_mask:0xf bank_mask:0xf
  v_add_f32_dpp v166, v166, v166 row_half_mirror row_mask:0xf bank_mask:0xf
  v_add_f32_dpp v167, v167, v167 row_half_mirror row_mask:0xf bank_mask:0xf
  s_mov_b32 s68, 0x3d93cd3a
  v_mov_b32 v2, 0
  v_cvt_pk_bf16_f32 v160, v2, v160
  v_cvt_pk_bf16_f32 v161, v2, v161
  v_cvt_pk_bf16_f32 v162, v2, v162
  v_cvt_pk_bf16_f32 v163, v2, v163
  v_cvt_pk_bf16_f32 v164, v2, v164
  v_cvt_pk_bf16_f32 v165, v2, v165
  v_cvt_pk_bf16_f32 v166, v2, v166
  v_cvt_pk_bf16_f32 v167, v2, v167
  v_mul_f32 v160, s68, v160
  v_mul_f32 v161, s68, v161
  v_mul_f32 v162, s68, v162
  v_mul_f32 v163, s68, v163
  v_mul_f32 v164, s68, v164
  v_mul_f32 v165, s68, v165
  v_mul_f32 v166, s68, v166
  v_mul_f32 v167, s68, v167
  v_cvt_pk_bf16_f32 v160, v2, v160
  v_cvt_pk_bf16_f32 v161, v2, v161
  v_cvt_pk_bf16_f32 v162, v2, v162
  v_cvt_pk_bf16_f32 v163, v2, v163
  v_cvt_pk_bf16_f32 v164, v2, v164
  v_cvt_pk_bf16_f32 v165, v2, v165
  v_cvt_pk_bf16_f32 v166, v2, v166
  v_cvt_pk_bf16_f32 v167, v2, v167
  v_max_f32 v4, v160, v161
  v_max3_f32 v4, v4, v162, v163
  v_max3_f32 v4, v4, v164, v165
  v_max3_f32 v4, v4, v166, v167
  s_nop 1
  v_max_f32_dpp v4, v4, v4 row_ror:8 row_mask:0xf bank_mask:0xf
  v_mov_b32 v88, v4
  s_nop 1
  v_permlane16_swap_b32 v4, v88
  v_max_f32 v4, v4, v88
  v_mov_b32 v88, v4
  s_nop 1
  v_permlane32_swap_b32 v4, v88
  v_max_f32 v4, v4, v88
  s_mov_b32 s68, 0x3fb8aa3b
  v_sub_f32 v160, v160, v4
  v_sub_f32 v161, v161, v4
  v_sub_f32 v162, v162, v4
  v_sub_f32 v163, v163, v4
  v_sub_f32 v164, v164, v4
  v_sub_f32 v165, v165, v4
  v_sub_f32 v166, v166, v4
  v_sub_f32 v167, v167, v4
  v_mul_f32 v160, s68, v160
  v_mul_f32 v161, s68, v161
  v_mul_f32 v162, s68, v162
  v_mul_f32 v163, s68, v163
  v_mul_f32 v164, s68, v164
  v_mul_f32 v165, s68, v165
  v_mul_f32 v166, s68, v166
  v_mul_f32 v167, s68, v167
  v_exp_f32 v160, v160
  v_exp_f32 v161, v161
  v_exp_f32 v162, v162
  v_exp_f32 v163, v163
  v_exp_f32 v164, v164
  v_exp_f32 v165, v165
  v_exp_f32 v166, v166
  v_exp_f32 v167, v167
  v_add_f32 v5, v160, v161
  v_add_f32 v5, v5, v162
  v_add_f32 v5, v5, v163
  v_add_f32 v5, v5, v164
  v_add_f32 v5, v5, v165
  v_add_f32 v5, v5, v166
  v_add_f32 v5, v5, v167
  s_nop 1
  v_add_f32_dpp v5, v5, v5 row_ror:8 row_mask:0xf bank_mask:0xf
  v_mov_b32 v88, v5
  s_nop 1
  v_permlane16_swap_b32 v5, v88
  v_add_f32 v5, v5, v88
  v_mov_b32 v88, v5
  s_nop 1
  v_permlane32_swap_b32 v5, v88
  v_add_f32 v5, v5, v88
  s_lshl_b32 s69, s73, 4
  v_mov_b32 v88, s69
  v_mov_b32 v6, 1
  v_mov_b32 v7, 1
  ds_write_b128 v88, v[4:7] offset:512
  v_cvt_pk_bf16_f32 v160, v160, v2
  v_cvt_pk_bf16_f32 v161, v161, v2
  v_cvt_pk_bf16_f32 v162, v162, v2
  v_cvt_pk_bf16_f32 v163, v163, v2
  v_cvt_pk_bf16_f32 v164, v164, v2
  v_cvt_pk_bf16_f32 v165, v165, v2
  v_cvt_pk_bf16_f32 v166, v166, v2
  v_cvt_pk_bf16_f32 v167, v167, v2
  v_mov_b32 v88, 0
  v_mov_b32 v89, 0
  v_mov_b32 v90, 0
  v_mov_b32 v91, 0
  v_mov_b32 v92, 0
  v_mov_b32 v93, 0
  v_mov_b32 v94, 0
  v_mov_b32 v95, 0
  v_mov_b32 v96, 0
  v_mov_b32 v97, 0
  v_mov_b32 v98, 0
  v_mov_b32 v99, 0
  v_mov_b32 v100, 0
  v_mov_b32 v101, 0
  v_mov_b32 v102, 0
  v_mov_b32 v103, 0
  v_mov_b32 v104, 0
  v_mov_b32 v105, 0
  v_mov_b32 v106, 0
  v_mov_b32 v107, 0
  v_mov_b32 v108, 0
  v_mov_b32 v109, 0
  v_mov_b32 v110, 0
  v_mov_b32 v111, 0
  v_and_b32 v8, 7, v0
  v_lshlrev_b32 v8, 5, v8
  v_lshrrev_b32 v9, 4, v0
  v_lshl_add_u32 v8, v9, 3, v8
  s_mul_i32 s69, s73, 768
  v_add_u32 v8, s69, v8
  v_mov_b32 v11, 1
  s_waitcnt vmcnt(2)
  buffer_load_dwordx4 v[124:127], v1, s[12:15], s61 offen offset:0 nt
  s_waitcnt vmcnt(2)
  buffer_load_dwordx4 v[128:131], v1, s[12:15], s61 offen offset:128 nt
  v_lshlrev_b32 v10, 16, v160
  v_dot2c_f32_bf16 v88, v112, v160
  v_dot2c_f32_bf16 v89, v112, v10
  v_dot2c_f32_bf16 v90, v113, v160
  v_dot2c_f32_bf16 v91, v113, v10
  v_dot2c_f32_bf16 v92, v114, v160
  v_dot2c_f32_bf16 v93, v114, v10
  v_dot2c_f32_bf16 v94, v115, v160
  v_dot2c_f32_bf16 v95, v115, v10
  s_waitcnt vmcnt(2)
  buffer_load_dwordx4 v[132:135], v1, s[12:15], s61 offen offset:256 nt
  s_memrealtime s[76:77]
  ds_read_b64 v[6:7], v2 offset:680
  s_waitcnt lgkmcnt(0)
  v_readfirstlane_b32 s78, v6
  v_readfirstlane_b32 s79, v7
  s_nop 0
  s_mul_i32 s75, s79, 12
  s_add_u32 s78, s78, s75
  s_cmp_lg_u32 s79, 0
  s_cselect_b32 s72, -1, 0
  v_dot2c_f32_bf16 v96, v116, v160
  v_dot2c_f32_bf16 v97, v116, v10
  v_dot2c_f32_bf16 v98, v117, v160
  v_dot2c_f32_bf16 v99, v117, v10
  v_dot2c_f32_bf16 v100, v118, v160
  v_dot2c_f32_bf16 v101, v118, v10
  v_dot2c_f32_bf16 v102, v119, v160
  v_dot2c_f32_bf16 v103, v119, v10
  s_waitcnt lgkmcnt(0)
  s_lshl_b32 s75, s76, 4
  s_sub_u32 s75, s75, s78
  s_and_b32 s75, s75, s72
  s_add_u32 s78, s78, s79
  s_waitcnt vmcnt(3)
  s_cmp_gt_i32 s75, 480
  s_cbranch_scc1 L_go_3
  s_waitcnt vmcnt(2)
  s_cmp_ge_i32 s75, 0
  s_cbranch_scc1 L_go_3
  s_waitcnt vmcnt(1)
L_go_3:
  buffer_load_dwordx4 v[136:139], v1, s[12:15], s62 offen offset:0 nt
  s_memrealtime s[76:77]
  v_dot2c_f32_bf16 v104, v120, v160
  v_dot2c_f32_bf16 v105, v120, v10
  v_dot2c_f32_bf16 v106, v121, v160
  v_dot2c_f32_bf16 v107, v121, v10
  v_dot2c_f32_bf16 v108, v122, v160
  v_dot2c_f32_bf16 v109, v122, v10
  v_dot2c_f32_bf16 v110, v123, v160
  v_dot2c_f32_bf16 v111, v123, v10
  s_waitcnt lgkmcnt(0)
  s_lshl_b32 s75, s76, 4
  s_sub_u32 s75, s75, s78
  s_and_b32 s75, s75, s72
  s_add_u32 s78, s78, s79
  s_waitcnt vmcnt(3)
  s_cmp_gt_i32 s75, 480
  s_cbranch_scc1 L_go_4
  s_waitcnt vmcnt(2)
  s_cmp_ge_i32 s75, 0
  s_cbranch_scc1 L_go_4
  s_waitcnt vmcnt(1)
L_go_4:
  buffer_load_dwordx4 v[140:143], v1, s[12:15], s62 offen offset:128 nt
  s_memrealtime s[76:77]
  v_lshlrev_b32 v10, 16, v161
  v_dot2c_f32_bf16 v88, v124, v161
  v_dot2c_f32_bf16 v89, v124, v10
  v_dot2c_f32_bf16 v90, v125, v161
  v_dot2c_f32_bf16 v91, v125, v10
  v_dot2c_f32_bf16 v92, v126, v161
  v_dot2c_f32_bf16 v93, v126, v10
  v_dot2c_f32_bf16 v94, v127, v161
  v_dot2c_f32_bf16 v95, v127, v10
  s_waitcnt lgkmcnt(0)
  s_lshl_b32 s75, s76, 4
  s_sub_u32 s75, s75, s78
  s_and_b32 s75, s75, s72
  s_add_u32 s78, s78, s79
  s_waitcnt vmcnt(3)
  s_cmp_gt_i32 s75, 480
  s_cbranch_scc1 L_go_5
  s_waitcnt vmcnt(2)
  s_cmp_ge_i32 s75, 0
  s_cbranch_scc1 L_go_5
  s_waitcnt vmcnt(1)
L_go_5:
  buffer_load_dwordx4 v[144:147], v1, s[12:15], s62 offen offset:256 nt
  s_memrealtime s[76:77]
  v_dot2c_f32_bf16 v96, v128, v161
  v_dot2c_f32_bf16 v97, v128, v10
  v_dot2c_f32_bf16 v98, v129, v161
  v_dot2c_f32_bf16 v99, v129, v10
  v_dot2c_f32_bf16 v100, v130, v161
  v_dot2c_f32_bf16 v101, v130, v10
  v_dot2c_f32_bf16 v102, v131, v161
  v_dot2c_f32_bf16 v103, v131, v10
  s_waitcnt lgkmcnt(0)
  s_lshl_b32 s75, s76, 4
  s_sub_u32 s75, s75, s78
  s_and_b32 s75, s75, s72
  s_add_u32 s78, s78, s79
  s_waitcnt vmcnt(3)
  s_cmp_gt_i32 s75, 480
  s_cbranch_scc1 L_go_6
  s_waitcnt vmcnt(2)
  s_cmp_ge_i32 s75, 0
  s_cbranch_scc1 L_go_6
  s_waitcnt vmcnt(1)
L_go_6:
  buffer_load_dwordx4 v[148:151], v1, s[12:15], s63 offen offset:0 nt
  s_memrealtime s[76:77]
  ds_read_b64 v[6:7], v2 offset:680
  s_waitcnt lgkmcnt(0)
  v_readfirstlane_b32 s78, v6
  v_readfirstlane_b32 s79, v7
  s_nop 0
  s_mul_i32 s75, s79, 16
  s_add_u32 s78, s78, s75
  s_cmp_lg_u32 s79, 0
  s_cselect_b32 s72, -1, 0
  v_dot2c_f32_bf16 v104, v132, v161
  v_dot2c_f32_bf16 v105, v132, v10
  v_dot2c_f32_bf16 v106, v133, v161
  v_dot2c_f32_bf16 v107, v133, v10
  v_dot2c_f32_bf16 v108, v134, v161
  v_dot2c_f32_bf16 v109, v134, v10
  v_dot2c_f32_bf16 v110, v135, v161
  v_dot2c_f32_bf16 v111, v135, v10
  s_waitcnt lgkmcnt(0)
  s_lshl_b32 s75, s76, 4
  s_sub_u32 s75, s75, s78
  s_and_b32 s75, s75, s72
  s_add_u32 s78, s78, s79
  s_waitcnt vmcnt(3)
  s_cmp_gt_i32 s75, 480
  s_cbranch_scc1 L_go_7
  s_waitcnt vmcnt(2)
  s_cmp_ge_i32 s75, 0
  s_cbranch_scc1 L_go_7
  s_waitcnt vmcnt(1)
L_go_7:
  buffer_load_dwordx4 v[152:155], v1, s[12:15], s63 offen offset:128 nt
  s_memrealtime s[76:77]
  v_lshlrev_b32 v10, 16, v162
  v_dot2c_f32_bf16 v88, v136, v162
  v_dot2c_f32_bf16 v89, v136, v10
  v_dot2c_f32_bf16 v90, v137, v162
  v_dot2c_f32_bf16 v91, v137, v10
  v_dot2c_f32_bf16 v92, v138, v162
  v_dot2c_f32_bf16 v93, v138, v10
  v_dot2c_f32_bf16 v94, v139, v162
  v_dot2c_f32_bf16 v95, v139, v10
  s_waitcnt lgkmcnt(0)
  s_lshl_b32 s75, s76, 4
  s_sub_u32 s75, s75, s78
  s_and_b32 s75, s75, s72
  s_add_u32 s78, s78, s79
  s_waitcnt vmcnt(3)
  s_cmp_gt_i32 s75, 480
  s_cbranch_scc1 L_go_8
  s_waitcnt vmcnt(2)
  s_cmp_ge_i32 s75, 0
  s_cbranch_scc1 L_go_8
  s_waitcnt vmcnt(1)
L_go_8:
  buffer_load_dwordx4 v[156:159], v1, s[12:15], s63 offen offset:256 nt
  s_memrealtime s[76:77]
  v_dot2c_f32_bf16 v96, v140, v162
  v_dot2c_f32_bf16 v97, v140, v10
  v_dot2c_f32_bf16 v98, v141, v162
  v_dot2c_f32_bf16 v99, v141, v10
  v_dot2c_f32_bf16 v100, v142, v162
  v_dot2c_f32_bf16 v101, v142, v10
  v_dot2c_f32_bf16 v102, v143, v162
  v_dot2c_f32_bf16 v103, v143, v10
  s_waitcnt lgkmcnt(0)
  s_lshl_b32 s75, s76, 4
  s_sub_u32 s75, s75, s78
  s_and_b32 s75, s75, s72
  s_add_u32 s78, s78, s79
  s_waitcnt vmcnt(3)
  s_cmp_gt_i32 s75, 480
  s_cbranch_scc1 L_go_9
  s_waitcnt vmcnt(2)
  s_cmp_ge_i32 s75, 0
  s_cbranch_scc1 L_go_9
  s_waitcnt vmcnt(1)
L_go_9:
  buffer_load_dwordx4 v[16:19], v1, s[12:15], s64 offen offset:0 nt
  s_memrealtime s[76:77]
  v_dot2c_f32_bf16 v104, v144, v162
  v_dot2c_f32_bf16 v105, v144, v10
  v_dot2c_f32_bf16 v106, v145, v162
  v_dot2c_f32_bf16 v107, v145, v10
  v_dot2c_f32_bf16 v108, v146, v162
  v_dot2c_f32_bf16 v109, v146, v10
  v_dot2c_f32_bf16 v110, v147, v162
  v_dot2c_f32_bf16 v111, v147, v10
  s_waitcnt lgkmcnt(0)
  s_lshl_b32 s75, s76, 4
  s_sub_u32 s75, s75, s78
  s_and_b32 s75, s75, s72
  s_add_u32 s78, s78, s79
  s_waitcnt vmcnt(3)
  s_cmp_gt_i32 s75, 480
  s_cbranch_scc1 L_go_10
  s_waitcnt vmcnt(2)
  s_cmp_ge_i32 s75, 0
  s_cbranch_scc1 L_go_10
  s_waitcnt vmcnt(1)
L_go_10:
  buffer_load_dwordx4 v[20:23], v1, s[12:15], s64 offen offset:128 nt
  s_memrealtime s[76:77]
  v_lshlrev_b32 v10, 16, v163
  v_dot2c_f32_bf16 v88, v148, v163
  v_dot2c_f32_bf16 v89, v148, v10
  v_dot2c_f32_bf16 v90, v149, v163
  v_dot2c_f32_bf16 v91, v149, v10
  v_dot2c_f32_bf16 v92, v150, v163
  v_dot2c_f32_bf16 v93, v150, v10
  v_dot2c_f32_bf16 v94, v151, v163
  v_dot2c_f32_bf16 v95, v151, v10
  s_waitcnt lgkmcnt(0)
  s_lshl_b32 s75, s76, 4
  s_sub_u32 s75, s75, s78
  s_and_b32 s75, s75, s72
  s_add_u32 s78, s78, s79
  s_waitcnt vmcnt(3)
  s_cmp_gt_i32 s75, 480
  s_cbranch_scc1 L_go_11
  s_waitcnt vmcnt(2)
  s_cmp_ge_i32 s75, 0
  s_cbranch_scc1 L_go_11
  s_waitcnt vmcnt(1)
L_go_11:
  buffer_load_dwordx4 v[24:27], v1, s[12:15], s64 offen offset:256 nt
  s_memrealtime s[76:77]
  s_mov_b64 exec, 1
  ds_add_u32 v2, v11 offset:656
  s_mov_b64 exec, -1
  v_dot2c_f32_bf16 v96, v152, v163
  v_dot2c_f32_bf16 v97, v152, v10
  v_dot2c_f32_bf16 v98, v153, v163
  v_dot2c_f32_bf16 v99, v153, v10
  v_dot2c_f32_bf16 v100, v154, v163
  v_dot2c_f32_bf16 v101, v154, v10
  v_dot2c_f32_bf16 v102, v155, v163
  v_dot2c_f32_bf16 v103, v155, v10
  s_waitcnt lgkmcnt(0)
  s_lshl_b32 s75, s76, 4
  s_sub_u32 s75, s75, s78
  s_and_b32 s75, s75, s72
  s_add_u32 s78, s78, s79
  s_waitcnt vmcnt(3)
  s_cmp_gt_i32 s75, 480
  s_cbranch_scc1 L_go_12
  s_waitcnt vmcnt(2)
  s_cmp_ge_i32 s75, 0
  s_cbranch_scc1 L_go_12
  s_waitcnt vmcnt(1)
L_go_12:
  buffer_load_dwordx4 v[28:31], v1, s[12:15], s65 offen offset:0 nt
  s_memrealtime s[76:77]
  v_dot2c_f32_bf16 v104, v156, v163
  v_dot2c_f32_bf16 v105, v156, v10
  v_dot2c_f32_bf16 v106, v157, v163
  v_dot2c_f32_bf16 v107, v157, v10
  v_dot2c_f32_bf16 v108, v158, v163
  v_dot2c_f32_bf16 v109, v158, v10
  v_dot2c_f32_bf16 v110, v159, v163
  v_dot2c_f32_bf16 v111, v159, v10
  s_waitcnt lgkmcnt(0)
  s_lshl_b32 s75, s76, 4
  s_sub_u32 s75, s75, s78
  s_and_b32 s75, s75, s72
  s_add_u32 s78, s78, s79
  s_waitcnt vmcnt(3)
  s_cmp_gt_i32 s75, 480
  s_cbranch_scc1 L_go_13
  s_waitcnt vmcnt(2)
  s_cmp_ge_i32 s75, 0
  s_cbranch_scc1 L_go_13
  s_waitcnt vmcnt(1)
L_go_13:
  buffer_load_dwordx4 v[32:35], v1, s[12:15], s65 offen offset:128 nt
  s_memrealtime s[76:77]
  v_lshlrev_b32 v10, 16, v164
  v_dot2c_f32_bf16 v88, v16, v164
  v_dot2c_f32_bf16 v89, v16, v10
  v_dot2c_f32_bf16 v90, v17, v164
  v_dot2c_f32_bf16 v91, v17, v10
  v_dot2c_f32_bf16 v92, v18, v164
  v_dot2c_f32_bf16 v93, v18, v10
  v_dot2c_f32_bf16 v94, v19, v164
  v_dot2c_f32_bf16 v95, v19, v10
  s_waitcnt lgkmcnt(0)
  s_lshl_b32 s75, s76, 4
  s_sub_u32 s75, s75, s78
  s_and_b32 s75, s75, s72
  s_add_u32 s78, s78, s79
  s_waitcnt vmcnt(3)
  s_cmp_gt_i32 s75, 480
  s_cbranch_scc1 L_go_14
  s_waitcnt vmcnt(2)
  s_cmp_ge_i32 s75, 0
  s_cbranch_scc1 L_go_14
  s_waitcnt vmcnt(1)
L_go_14:
  buffer_load_dwordx4 v[36:39], v1, s[12:15], s65 offen offset:256 nt
  s_memrealtime s[76:77]
  v_dot2c_f32_bf16 v96, v20, v164
  v_dot2c_f32_bf16 v97, v20, v10
  v_dot2c_f32_bf16 v98, v21, v164
  v_dot2c_f32_bf16 v99, v21, v10
  v_dot2c_f32_bf16 v100, v22, v164
  v_dot2c_f32_bf16 v101, v22, v10
  v_dot2c_f32_bf16 v102, v23, v164
  v_dot2c_f32_bf16 v103, v23, v10
  s_waitcnt lgkmcnt(0)
  s_lshl_b32 s75, s76, 4
  s_sub_u32 s75, s75, s78
  s_and_b32 s75, s75, s72
  s_add_u32 s78, s78, s79
  s_waitcnt vmcnt(3)
  s_cmp_gt_i32 s75, 480
  s_cbranch_scc1 L_go_15
  s_waitcnt vmcnt(2)
  s_cmp_ge_i32 s75, 0
  s_cbranch_scc1 L_go_15
  s_waitcnt vmcnt(1)
L_go_15:
  buffer_load_dwordx4 v[40:43], v1, s[12:15], s66 offen offset:0 nt
  s_memrealtime s[76:77]
  v_dot2c_f32_bf16 v104, v24, v164
  v_dot2c_f32_bf16 v105, v24, v10
  v_dot2c_f32_bf16 v106, v25, v164
  v_dot2c_f32_bf16 v107, v25, v10
  v_dot2c_f32_bf16 v108, v26, v164
  v_dot2c_f32_bf16 v109, v26, v10
  v_dot2c_f32_bf16 v110, v27, v164
  v_dot2c_f32_bf16 v111, v27, v10
  s_waitcnt lgkmcnt(0)
  s_lshl_b32 s75, s76, 4
  s_sub_u32 s75, s75, s78
  s_and_b32 s75, s75, s72
  s_add_u32 s78, s78, s79
  s_waitcnt vmcnt(3)
  s_cmp_gt_i32 s75, 480
  s_cbranch_scc1 L_go_16
  s_waitcnt vmcnt(2)
  s_cmp_ge_i32 s75, 0
  s_cbranch_scc1 L_go_16
  s_waitcnt vmcnt(1)
L_go_16:
  buffer_load_dwordx4 v[44:47], v1, s[12:15], s66 offen offset:128 nt
  s_memrealtime s[76:77]
  v_lshlrev_b32 v10, 16, v165
  v_dot2c_f32_bf16 v88, v28, v165
  v_dot2c_f32_bf16 v89, v28, v10
  v_dot2c_f32_bf16 v90, v29, v165
  v_dot2c_f32_bf16 v91, v29, v10
  v_dot2c_f32_bf16 v92, v30, v165
  v_dot2c_f32_bf16 v93, v30, v10
  v_dot2c_f32_bf16 v94, v31, v165
  v_dot2c_f32_bf16 v95, v31, v10
  s_waitcnt lgkmcnt(0)
  s_lshl_b32 s75, s76, 4
  s_sub_u32 s75, s75, s78
  s_and_b32 s75, s75, s72
  s_add_u32 s78, s78, s79
  s_waitcnt vmcnt(3)
  s_cmp_gt_i32 s75, 480
  s_cbranch_scc1 L_go_17
  s_waitcnt vmcnt(2)
  s_cmp_ge_i32 s75, 0
  s_cbranch_scc1 L_go_17
  s_waitcnt vmcnt(1)
L_go_17:
  buffer_load_dwordx4 v[48:51], v1, s[12:15], s66 offen offset:256 nt
  s_memrealtime s[76:77]
  v_dot2c_f32_bf16 v96, v32, v165
  v_dot2c_f32_bf16 v97, v32, v10
  v_dot2c_f32_bf16 v98, v33, v165
  v_dot2c_f32_bf16 v99, v33, v10
  v_dot2c_f32_bf16 v100, v34, v165
  v_dot2c_f32_bf16 v101, v34, v10
  v_dot2c_f32_bf16 v102, v35, v165
  v_dot2c_f32_bf16 v103, v35, v10
  s_waitcnt lgkmcnt(0)
  s_lshl_b32 s75, s76, 4
  s_sub_u32 s75, s75, s78
  s_and_b32 s75, s75, s72
  s_add_u32 s78, s78, s79
  s_waitcnt vmcnt(3)
  s_cmp_gt_i32 s75, 480
  s_cbranch_scc1 L_go_18
  s_waitcnt vmcnt(2)
  s_cmp_ge_i32 s75, 0
  s_cbranch_scc1 L_go_18
  s_waitcnt vmcnt(1)
L_go_18:
  buffer_load_dwordx4 v[52:55], v1, s[12:15], s67 offen offset:0 nt
  s_memrealtime s[76:77]
  s_mov_b64 exec, 1
  ds_add_u32 v2, v11 offset:644
  s_mov_b64 exec, -1
  v_dot2c_f32_bf16 v104, v36, v165
  v_dot2c_f32_bf16 v105, v36, v10
  v_dot2c_f32_bf16 v106, v37, v165
  v_dot2c_f32_bf16 v107, v37, v10
  v_dot2c_f32_bf16 v108, v38, v165
  v_dot2c_f32_bf16 v109, v38, v10
  v_dot2c_f32_bf16 v110, v39, v165
  v_dot2c_f32_bf16 v111, v39, v10
  s_waitcnt lgkmcnt(0)
  s_lshl_b32 s75, s76, 4
  s_sub_u32 s75, s75, s78
  s_and_b32 s75, s75, s72
  s_add_u32 s78, s78, s79
  s_waitcnt vmcnt(3)
  s_cmp_gt_i32 s75, 480
  s_cbranch_scc1 L_go_19
  s_waitcnt vmcnt(2)
  s_cmp_ge_i32 s75, 0
  s_cbranch_scc1 L_go_19
  s_waitcnt vmcnt(1)
L_go_19:
  buffer_load_dwordx4 v[56:59], v1, s[12:15], s67 offen offset:128 nt
  s_memrealtime s[76:77]
  v_lshlrev_b32 v10, 16, v166
  v_dot2c_f32_bf16 v88, v40, v166
  v_dot2c_f32_bf16 v89, v40, v10
  v_dot2c_f32_bf16 v90, v41, v166
  v_dot2c_f32_bf16 v91, v41, v10
  v_dot2c_f32_bf16 v92, v42, v166
  v_dot2c_f32_bf16 v93, v42, v10
  v_dot2c_f32_bf16 v94, v43, v166
  v_dot2c_f32_bf16 v95, v43, v10
  s_waitcnt lgkmcnt(0)
  s_lshl_b32 s75, s76, 4
  s_sub_u32 s75, s75, s78
  s_and_b32 s75, s75, s72
  s_add_u32 s78, s78, s79
  s_waitcnt vmcnt(3)
  s_cmp_gt_i32 s75, 480
  s_cbranch_scc1 L_go_20
  s_waitcnt vmcnt(2)
  s_cmp_ge_i32 s75, 0
  s_cbranch_scc1 L_go_20
  s_waitcnt vmcnt(1)
L_go_20:
  buffer_load_dwordx4 v[60:63], v1, s[12:15], s67 offen offset:256 nt
  v_dot2c_f32_bf16 v96, v44, v166
  v_dot2c_f32_bf16 v97, v44, v10
  v_dot2c_f32_bf16 v98, v45, v166
  v_dot2c_f32_bf16 v99, v45, v10
  v_dot2c_f32_bf16 v100, v46, v166
  v_dot2c_f32_bf16 v101, v46, v10
  v_dot2c_f32_bf16 v102, v47, v166
  v_dot2c_f32_bf16 v103, v47, v10
  s_waitcnt vmcnt(3)
  v_dot2c_f32_bf16 v104, v48, v166
  v_dot2c_f32_bf16 v105, v48, v10
  v_dot2c_f32_bf16 v106, v49, v166
  v_dot2c_f32_bf16 v107, v49, v10
  v_dot2c_f32_bf16 v108, v50, v166
  v_dot2c_f32_bf16 v109, v50, v10
  v_dot2c_f32_bf16 v110, v51, v166
  v_dot2c_f32_bf16 v111, v51, v10
  s_mov_b32 s70, 200007
L_spin_21:
  ds_read_b128 v[12:15], v3 offset:512
  s_waitcnt lgkmcnt(0)
  v_cmp_eq_u32 vcc, 0, v15
  s_nop 0
  s_cbranch_vccz L_sdone_22
  s_sleep 1
  s_sub_u32 s70, s70, 1
  s_cbranch_scc0 L_spin_21
L_sdone_22:
  v_max_f32_dpp v12, v12, v12 quad_perm:[1,0,3,2] row_mask:0xf bank_mask:0xf
  s_nop 1
  v_max_f32_dpp v12, v12, v12 quad_perm:[2,3,0,1] row_mask:0xf bank_mask:0xf
  s_nop 1
  v_max_f32_dpp v12, v12, v12 row_half_mirror row_mask:0xf bank_mask:0xf
  v_sub_f32 v9, v4, v12
  v_mul_f32 v9, s68, v9
  v_exp_f32 v9, v9
  v_mov_b32 v2, 0
  s_mov_b32 s70, 200007
L_spin_23:
  ds_read_b32 v13, v2 offset:648
  s_waitcnt lgkmcnt(0)
  v_cmp_gt_u32 vcc, 1, v13
  s_nop 0
  s_cbranch_vccz L_sdone_24
  s_sleep 2
  s_sub_u32 s70, s70, 1
  s_cbranch_scc0 L_spin_23
L_sdone_24:
  v_readfirstlane_b32 s46, v13
  v_min_u32 v12, 47, v0
  v_lshlrev_b32 v13, 7, v12
  v_lshlrev_b32 v12, 4, v12
  s_mul_i32 s74, s6, 6144
  s_lshl4_add_u32 s74, s7, s74
  s_add_u32 s74, s74, 524288
  s_mov_b32 s22, 0xaaaaaaaa
  s_mov_b32 s23, 0xaaaaaaaa
  v_mov_b32 v14, s30
  v_mov_b32 v15, s31
  s_waitcnt vmcnt(2)
  v_lshlrev_b32 v10, 16, v167
  v_dot2c_f32_bf16 v88, v52, v167
  v_dot2c_f32_bf16 v89, v52, v10
  v_dot2c_f32_bf16 v90, v53, v167
  v_dot2c_f32_bf16 v91, v53, v10
  v_dot2c_f32_bf16 v92, v54, v167
  v_dot2c_f32_bf16 v93, v54, v10
  v_dot2c_f32_bf16 v94, v55, v167
  v_dot2c_f32_bf16 v95, v55, v10
  v_permlane32_swap_b32 v88, v92
  v_permlane32_swap_b32 v89, v93
  v_permlane32_swap_b32 v90, v94
  v_permlane32_swap_b32 v91, v95
  v_add_f32 v88, v88, v92
  v_add_f32 v89, v89, v93
  v_add_f32 v90, v90, v94
  v_add_f32 v91, v91, v95
  s_nop 0
  v_permlane16_swap_b32 v88, v90
  v_permlane16_swap_b32 v89, v91
  v_add_f32 v88, v88, v90
  v_add_f32 v89, v89, v91
  s_nop 0
  v_add_f32_dpp v88, v88, v88 row_ror:8 row_mask:0xf bank_mask:0xf
  v_add_f32_dpp v89, v89, v89 row_ror:8 row_mask:0xf bank_mask:0xf
  v_mul_f32 v88, v9, v88
  v_mul_f32 v89, v9, v89
  ds_write_b64 v8, v[88:89] offset:1024
  s_waitcnt vmcnt(1)
  v_dot2c_f32_bf16 v96, v56, v167
  v_dot2c_f32_bf16 v97, v56, v10
  v_dot2c_f32_bf16 v98, v57, v167
  v_dot2c_f32_bf16 v99, v57, v10
  v_dot2c_f32_bf16 v100, v58, v167
  v_dot2c_f32_bf16 v101, v58, v10
  v_dot2c_f32_bf16 v102, v59, v167
  v_dot2c_f32_bf16 v103, v59, v10
  v_permlane32_swap_b32 v96, v100
  v_permlane32_swap_b32 v97, v101
  v_permlane32_swap_b32 v98, v102
  v_permlane32_swap_b32 v99, v103
  v_add_f32 v96, v96, v100
  v_add_f32 v97, v97, v101
  v_add_f32 v98, v98, v102
  v_add_f32 v99, v99, v103
  s_nop 0
  v_permlane16_swap_b32 v96, v98
  v_permlane16_swap_b32 v97, v99
  v_add_f32 v96, v96, v98
  v_add_f32 v97, v97, v99
  s_nop 0
  v_add_f32_dpp v96, v96, v96 row_ror:8 row_mask:0xf bank_mask:0xf
  v_add_f32_dpp v97, v97, v97 row_ror:8 row_mask:0xf bank_mask:0xf
  v_mul_f32 v96, v9, v96
  v_mul_f32 v97, v9, v97
  ds_write_b64 v8, v[96:97] offset:1280
  s_waitcnt vmcnt(0)
  v_dot2c_f32_bf16 v104, v60, v167
  v_dot2c_f32_bf16 v105, v60, v10
  v_dot2c_f32_bf16 v106, v61, v167
  v_dot2c_f32_bf16 v107, v61, v10
  v_dot2c_f32_bf16 v108, v62, v167
  v_dot2c_f32_bf16 v109, v62, v10
  v_dot2c_f32_bf16 v110, v63, v167
  v_dot2c_f32_bf16 v111, v63, v10
  v_permlane32_swap_b32 v104, v108
  v_permlane32_swap_b32 v105, v109
  v_permlane32_swap_b32 v106, v110
  v_permlane32_swap_b32 v107, v111
  v_add_f32 v104, v104, v108
  v_add_f32 v105, v105, v109
  v_add_f32 v106, v106, v110
  v_add_f32 v107, v107, v111
  s_nop 0
  v_permlane16_swap_b32 v104, v106
  v_permlane16_swap_b32 v105, v107
  v_add_f32 v104, v104, v106
  v_add_f32 v105, v105, v107
  s_nop 0
  v_add_f32_dpp v104, v104, v104 row_ror:8 row_mask:0xf bank_mask:0xf
  v_add_f32_dpp v105, v105, v105 row_ror:8 row_mask:0xf bank_mask:0xf
  v_mul_f32 v104, v9, v104
  v_mul_f32 v105, v9, v105
  ds_write_b64 v8, v[104:105] offset:1536
  s_mov_b64 exec, 1
  ds_add_rtn_u32 v10, v2, v11 offset:640
  s_mov_b64 exec, -1
  ds_read_b128 v[16:19], v12 offset:1024
  ds_read_b128 v[20:23], v12 offset:1792
  ds_read_b128 v[24:27], v12 offset:2560
  ds_read_b128 v[28:31], v12 offset:3328
  ds_read_b128 v[32:35], v12 offset:4096
  ds_read_b128 v[36:39], v12 offset:4864
  ds_read_b128 v[40:43], v12 offset:5632
  ds_read_b128 v[44:47], v12 offset:6400
  s_waitcnt lgkmcnt(8)
  v_readfirstlane_b32 s68, v10
  s_nop 0
  s_cmp_lg_u32 s68, 7
  s_cbranch_scc1 L_nopub
  s_waitcnt lgkmcnt(6)
  v_pk_add_f32 v[16:17], v[16:17], v[20:21]
  v_pk_add_f32 v[18:19], v[18:19], v[22:23]
  s_waitcnt lgkmcnt(4)
  v_pk_add_f32 v[24:25], v[24:25], v[28:29]
  v_pk_add_f32 v[26:27], v[26:27], v[30:31]
  v_pk_add_f32 v[16:17], v[16:17], v[24:25]
  v_pk_add_f32 v[18:19], v[18:19], v[26:27]
  s_waitcnt lgkmcnt(2)
  v_pk_add_f32 v[32:33], v[32:33], v[36:37]
  v_pk_add_f32 v[34:35], v[34:35], v[38:39]
  s_waitcnt lgkmcnt(0)
  v_pk_add_f32 v[40:41], v[40:41], v[44:45]
  v_pk_add_f32 v[42:43], v[42:43], v[46:47]
  v_pk_add_f32 v[32:33], v[32:33], v[40:41]
  v_pk_add_f32 v[34:35], v[34:35], v[42:43]
  v_pk_add_f32 v[4:5], v[16:17], v[32:33]
  v_pk_add_f32 v[6:7], v[18:19], v[34:35]
  v_cvt_pk_bf16_f32 v8, v4, v5
  v_cvt_pk_bf16_f32 v9, v6, v7
  v_cndmask_b32 v4, v8, v14, s[22:23]
  v_cndmask_b32 v5, v9, v15, s[22:23]
  v_cndmask_b32 v6, v14, v8, s[22:23]
  v_cndmask_b32 v7, v15, v9, s[22:23]
  s_mov_b32 exec_lo, 0xffffffff
  s_mov_b32 exec_hi, 0xffff
  buffer_store_dwordx4 v[4:7], v13, s[32:35], s74 offen
  s_mov_b64 exec, -1
  s_cmp_lg_u32 s46, 1
  s_cbranch_scc1 L_slow_25
L_back_26:
  ds_write_b32 v2, v11 offset:668
L_nopub:
  s_waitcnt lgkmcnt(0)
  v_mov_b32 v17, 0
  s_mov_b32 s70, 200007
L_spin_27:
  ds_read_b32 v16, v17 offset:660
  s_waitcnt lgkmcnt(0)
  v_cmp_gt_u32 vcc, 1, v16
  s_nop 0
  s_cbranch_vccz L_sdone_28
  s_sleep 1
  s_sub_u32 s70, s70, 1
  s_cbranch_scc0 L_spin_27
L_sdone_28:
  v_readfirstlane_b32 s5, v16
  s_nop 0
  s_bfe_u32 s47, s5, 0x80008
  s_and_b32 s5, s5, 31
  s_cmp_lt_u32 s5, 20
  s_cbranch_scc1 L_notf1
  s_cmp_lt_u32 s3, 9
  s_cbranch_scc1 L_f1
  s_branch L_stream_exit
L_notf1:
  s_cmp_gt_u32 s5, 11
  s_cbranch_scc1 L_stream_exit
  s_cmp_gt_u32 s3, 6
  s_cbranch_scc1 L_f2
  s_endpgm
L_stream_exit:
  s_endpgm
L_helper:
  s_setprio 3
  s_cmp_eq_u32 s3, 3
  s_cbranch_scc1 L_ids
  v_lshlrev_b32 v1, 2, v0
  v_lshrrev_b32 v2, 3, v0
  s_mul_i32 s68, s7, 80
  s_mul_i32 s69, s7, 80
  s_sub_u32 s69, s69, 0
  s_cmp_lt_u32 s7, 5
  s_cselect_b32 s68, s68, s69
  v_add_u32 v3, s68, v2
  v_lshlrev_b32 v3, 1, v3
  v_mul_u32_u24 v21, 1280, v2
  v_mul_u32_u24 v2, 12288, v2
  v_and_b32 v7, 7, v0
  v_lshl_add_u32 v2, v7, 4, v2
  v_lshl_add_u32 v21, v7, 4, v21
  s_mul_i32 s68, s68, 12288
  s_mul_i32 s69, s6, 384
  s_add_u32 s68, s68, s69
  s_lshl_b32 s69, s3, 7
  s_add_u32 s68, s68, s69
  s_mul_i32 s5, s79, 5
  s_add_u32 s5, s5, s7
  s_cmp_ge_u32 s5, 10
  s_cselect_b32 s76, 1, 0
  s_mul_i32 s77, s76, 10
  s_sub_u32 s77, s5, s77
  s_lshl1_add_u32 s60, s4, s76
  s_mul_i32 s60, s60, 491520
  s_lshl_b32 s69, s77, 7
  s_add_u32 s60, s60, s69
  s_mul_i32 s61, s3, 0
  s_waitcnt lgkmcnt(0)
  s_barrier
  s_mov_b32 s8, s42
  s_mov_b32 s9, s43
  s_mov_b32 s10, 7864320
  s_mov_b32 s11, 0x20000
  s_mov_b32 s12, s44
  s_mov_b32 s13, s45
  s_mov_b32 s14, 7864320
  s_mov_b32 s15, 0x20000
  global_load_dword v8, v1, s[36:37] offset:0
  global_load_dword v9, v1, s[36:37] offset:256
  global_load_dword v10, v1, s[36:37] offset:512
  global_load_dword v11, v1, s[36:37] offset:768
  global_load_dword v12, v1, s[36:37] offset:1024
  global_load_ushort v104, v3, s[36:37] offset:0
  global_load_ushort v105, v3, s[36:37] offset:16
  global_load_ushort v106, v3, s[36:37] offset:32
  global_load_ushort v107, v3, s[36:37] offset:48
  global_load_ushort v108, v3, s[36:37] offset:64
  global_load_ushort v109, v3, s[36:37] offset:80
  global_load_ushort v110, v3, s[36:37] offset:96
  global_load_ushort v111, v3, s[36:37] offset:112
  global_load_ushort v112, v3, s[36:37] offset:128
  global_load_ushort v113, v3, s[36:37] offset:144
  buffer_load_dwordx4 v[24:27], v2, s[8:11], s68 offen nt
  s_add_u32 s68, s68, 98304
  buffer_load_dwordx4 v[28:31], v2, s[8:11], s68 offen nt
  s_add_u32 s68, s68, 98304
  buffer_load_dwordx4 v[32:35], v2, s[8:11], s68 offen nt
  s_add_u32 s68, s68, 98304
  buffer_load_dwordx4 v[36:39], v2, s[8:11], s68 offen nt
  s_add_u32 s68, s68, 98304
  buffer_load_dwordx4 v[40:43], v2, s[8:11], s68 offen nt
  s_add_u32 s68, s68, 98304
  buffer_load_dwordx4 v[44:47], v2, s[8:11], s68 offen nt
  s_add_u32 s68, s68, 98304
  buffer_load_dwordx4 v[48:51], v2, s[8:11], s68 offen nt
  s_add_u32 s68, s68, 98304
  buffer_load_dwordx4 v[52:55], v2, s[8:11], s68 offen nt
  s_add_u32 s68, s68, 98304
  buffer_load_dwordx4 v[56:59], v2, s[8:11], s68 offen nt
  s_add_u32 s68, s68, 98304
  buffer_load_dwordx4 v[60:63], v2, s[8:11], s68 offen nt
  s_add_u32 s68, s68, 98304
  s_load_dwordx2 s[28:29], s[58:59], 917504
  s_mov_b32 s69, 0xffff0000
  s_mov_b32 s24, s58
  s_mov_b32 s25, s59
  s_mov_b32 s26, 4194304
  s_mov_b32 s27, 0x20000
  s_add_u32 s32, s58, 4194304
  s_addc_u32 s33, s59, 0
  s_mov_b32 s34, 4194304
  s_mov_b32 s35, 0x20000
  s_lshl3_add_u32 s71, s6, s7
  s_waitcnt lgkmcnt(0)
  s_mul_i32 s30, s28, 0x2c9277b5
  s_add_u32 s30, s30, 0xac564b05
  s_mul_i32 s31, s29, 0x0019660d
  s_add_u32 s31, s31, 0x3c6ef35f
  s_waitcnt vmcnt(20)
  v_lshlrev_b32 v124, 16, v8
  v_and_b32 v125, s69, v8
  v_lshlrev_b32 v126, 16, v9
  v_and_b32 v127, s69, v9
  v_lshlrev_b32 v128, 16, v10
  v_and_b32 v129, s69, v10
  v_lshlrev_b32 v130, 16, v11
  v_and_b32 v131, s69, v11
  v_lshlrev_b32 v132, 16, v12
  v_and_b32 v133, s69, v12
  v_add_f32 v4, v124, v125
  v_add_f32 v5, v126, v127
  v_add_f32 v6, v128, v129
  v_add_f32 v7, v130, v131
  v_add_f32 v4, v4, v5
  v_add_f32 v6, v6, v7
  v_add_f32 v5, v132, v133
  v_add_f32 v4, v4, v6
  v_add_f32 v4, v4, v5
  s_nop 1
  v_add_f32_dpp v4, v4, v4 quad_perm:[1,0,3,2] row_mask:0xf bank_mask:0xf
  s_nop 1
  v_add_f32_dpp v4, v4, v4 quad_perm:[2,3,0,1] row_mask:0xf bank_mask:0xf
  s_nop 1
  v_add_f32_dpp v4, v4, v4 row_half_mirror row_mask:0xf bank_mask:0xf
  s_nop 1
  v_add_f32_dpp v4, v4, v4 row_mirror row_mask:0xf bank_mask:0xf
  v_mov_b32 v5, v4
  s_nop 1
  v_permlane16_swap_b32 v4, v5
  v_add_f32 v4, v4, v5
  v_mov_b32 v5, v4
  s_nop 1
  v_permlane32_swap_b32 v4, v5
  v_add_f32 v4, v4, v5
  v_mul_f32 v4, 0x3acccccd, v4
  v_sub_f32 v124, v124, v4
  v_sub_f32 v125, v125, v4
  v_sub_f32 v126, v126, v4
  v_sub_f32 v127, v127, v4
  v_sub_f32 v128, v128, v4
  v_sub_f32 v129, v129, v4
  v_sub_f32 v130, v130, v4
  v_sub_f32 v131, v131, v4
  v_sub_f32 v132, v132, v4
  v_sub_f32 v133, v133, v4
  v_mul_f32 v5, v124, v124
  v_fmac_f32 v5, v125, v125
  v_fmac_f32 v5, v126, v126
  v_fmac_f32 v5, v127, v127
  v_fmac_f32 v5, v128, v128
  v_fmac_f32 v5, v129, v129
  v_fmac_f32 v5, v130, v130
  v_fmac_f32 v5, v131, v131
  v_fmac_f32 v5, v132, v132
  v_fmac_f32 v5, v133, v133
  s_nop 1
  v_add_f32_dpp v5, v5, v5 quad_perm:[1,0,3,2] row_mask:0xf bank_mask:0xf
  s_nop 1
  v_add_f32_dpp v5, v5, v5 quad_perm:[2,3,0,1] row_mask:0xf bank_mask:0xf
  s_nop 1
  v_add_f32_dpp v5, v5, v5 row_half_mirror row_mask:0xf bank_mask:0xf
  s_nop 1
  v_add_f32_dpp v5, v5, v5 row_mirror row_mask:0xf bank_mask:0xf
  v_mov_b32 v6, v5
  s_nop 1
  v_permlane16_swap_b32 v5, v6
  v_add_f32 v5, v5, v6
  v_mov_b32 v6, v5
  s_nop 1
  v_permlane32_swap_b32 v5, v6
  v_add_f32 v5, v5, v6
  v_mul_f32 v5, 0x3acccccd, v5
  v_cvt_pk_bf16_f32 v4, v4, v4
  v_lshlrev_b32 v4, 16, v4
  v_cvt_pk_bf16_f32 v5, v5, v5
  v_lshlrev_b32 v5, 16, v5
  v_add_f32 v5, 0x3727c5ac, v5
  v_cvt_pk_bf16_f32 v5, v5, v5
  v_lshlrev_b32 v5, 16, v5
  v_sqrt_f32 v5, v5
  s_nop 0
  v_cvt_pk_bf16_f32 v5, v5, v5
  v_lshlrev_b32 v5, 16, v5
  v_rcp_f32 v5, v5
  v_mov_b32 v6, 0
  v_mov_b32 v144, 0
  v_mov_b32 v145, 0
  v_mov_b32 v146, 0
  v_mov_b32 v147, 0
  v_mov_b32 v148, 0
  v_mov_b32 v149, 0
  v_mov_b32 v150, 0
  v_mov_b32 v151, 0
  v_and_b32 v152, 7, v0
  v_lshrrev_b32 v7, 4, v0
  v_lshl_add_u32 v152, v152, 2, v7
  v_lshlrev_b32 v152, 4, v152
  s_lshl_b32 s64, s71, 11
  s_lshl_b32 s65, s3, 9
  s_add_u32 s64, s64, s65
  s_waitcnt vmcnt(10)
  v_lshlrev_b32 v104, 16, v104
  v_lshlrev_b32 v105, 16, v105
  v_lshlrev_b32 v106, 16, v106
  v_lshlrev_b32 v107, 16, v107
  v_lshlrev_b32 v108, 16, v108
  v_lshlrev_b32 v109, 16, v109
  v_lshlrev_b32 v110, 16, v110
  v_lshlrev_b32 v111, 16, v111
  v_lshlrev_b32 v112, 16, v112
  v_lshlrev_b32 v113, 16, v113
  v_sub_f32 v104, v104, v4
  v_sub_f32 v105, v105, v4
  v_sub_f32 v106, v106, v4
  v_sub_f32 v107, v107, v4
  v_sub_f32 v108, v108, v4
  v_sub_f32 v109, v109, v4
  v_sub_f32 v110, v110, v4
  v_sub_f32 v111, v111, v4
  v_sub_f32 v112, v112, v4
  v_sub_f32 v113, v113, v4
  v_cvt_pk_bf16_f32 v104, v6, v104
  v_cvt_pk_bf16_f32 v105, v6, v105
  v_cvt_pk_bf16_f32 v106, v6, v106
  v_cvt_pk_bf16_f32 v107, v6, v107
  v_cvt_pk_bf16_f32 v108, v6, v108
  v_cvt_pk_bf16_f32 v109, v6, v109
  v_cvt_pk_bf16_f32 v110, v6, v110
  v_cvt_pk_bf16_f32 v111, v6, v111
  v_cvt_pk_bf16_f32 v112, v6, v112
  v_cvt_pk_bf16_f32 v113, v6, v113
  v_mul_f32 v104, v104, v5
  v_mul_f32 v105, v105, v5
  v_mul_f32 v106, v106, v5
  v_mul_f32 v107, v107, v5
  v_mul_f32 v108, v108, v5
  v_mul_f32 v109, v109, v5
  v_mul_f32 v110, v110, v5
  v_mul_f32 v111, v111, v5
  v_mul_f32 v112, v112, v5
  v_mul_f32 v113, v113, v5
  v_cvt_pk_bf16_f32 v124, v6, v104
  v_cvt_pk_bf16_f32 v104, v104, v6
  v_cvt_pk_bf16_f32 v125, v6, v105
  v_cvt_pk_bf16_f32 v105, v105, v6
  v_cvt_pk_bf16_f32 v126, v6, v106
  v_cvt_pk_bf16_f32 v106, v106, v6
  v_cvt_pk_bf16_f32 v127, v6, v107
  v_cvt_pk_bf16_f32 v107, v107, v6
  v_cvt_pk_bf16_f32 v128, v6, v108
  v_cvt_pk_bf16_f32 v108, v108, v6
  v_cvt_pk_bf16_f32 v129, v6, v109
  v_cvt_pk_bf16_f32 v109, v109, v6
  v_cvt_pk_bf16_f32 v130, v6, v110
  v_cvt_pk_bf16_f32 v110, v110, v6
  v_cvt_pk_bf16_f32 v131, v6, v111
  v_cvt_pk_bf16_f32 v111, v111, v6
  v_cvt_pk_bf16_f32 v132, v6, v112
  v_cvt_pk_bf16_f32 v112, v112, v6
  v_cvt_pk_bf16_f32 v133, v6, v113
  v_cvt_pk_bf16_f32 v113, v113, v6
  s_cmp_lt_u32 s7, 5
  s_cbranch_scc1 L_q2wo
  s_waitcnt vmcnt(9)
  v_dot2c_f32_bf16 v144, v24, v104
  v_dot2c_f32_bf16 v145, v24, v124
  v_dot2c_f32_bf16 v146, v25, v104
  v_dot2c_f32_bf16 v147, v25, v124
  v_dot2c_f32_bf16 v148, v26, v104
  v_dot2c_f32_bf16 v149, v26, v124
  v_dot2c_f32_bf16 v150, v27, v104
  v_dot2c_f32_bf16 v151, v27, v124
  s_waitcnt vmcnt(8)
  v_dot2c_f32_bf16 v144, v28, v105
  v_dot2c_f32_bf16 v145, v28, v125
  v_dot2c_f32_bf16 v146, v29, v105
  v_dot2c_f32_bf16 v147, v29, v125
  v_dot2c_f32_bf16 v148, v30, v105
  v_dot2c_f32_bf16 v149, v30, v125
  v_dot2c_f32_bf16 v150, v31, v105
  v_dot2c_f32_bf16 v151, v31, v125
  s_waitcnt vmcnt(7)
  v_dot2c_f32_bf16 v144, v32, v106
  v_dot2c_f32_bf16 v145, v32, v126
  v_dot2c_f32_bf16 v146, v33, v106
  v_dot2c_f32_bf16 v147, v33, v126
  v_dot2c_f32_bf16 v148, v34, v106
  v_dot2c_f32_bf16 v149, v34, v126
  v_dot2c_f32_bf16 v150, v35, v106
  v_dot2c_f32_bf16 v151, v35, v126
  s_waitcnt vmcnt(6)
  v_dot2c_f32_bf16 v144, v36, v107
  v_dot2c_f32_bf16 v145, v36, v127
  v_dot2c_f32_bf16 v146, v37, v107
  v_dot2c_f32_bf16 v147, v37, v127
  v_dot2c_f32_bf16 v148, v38, v107
  v_dot2c_f32_bf16 v149, v38, v127
  v_dot2c_f32_bf16 v150, v39, v107
  v_dot2c_f32_bf16 v151, v39, v127
  s_waitcnt vmcnt(5)
  v_dot2c_f32_bf16 v144, v40, v108
  v_dot2c_f32_bf16 v145, v40, v128
  v_dot2c_f32_bf16 v146, v41, v108
  v_dot2c_f32_bf16 v147, v41, v128
  v_dot2c_f32_bf16 v148, v42, v108
  v_dot2c_f32_bf16 v149, v42, v128
  v_dot2c_f32_bf16 v150, v43, v108
  v_dot2c_f32_bf16 v151, v43, v128
  s_waitcnt vmcnt(4)
  v_dot2c_f32_bf16 v144, v44, v109
  v_dot2c_f32_bf16 v145, v44, v129
  v_dot2c_f32_bf16 v146, v45, v109
  v_dot2c_f32_bf16 v147, v45, v129
  v_dot2c_f32_bf16 v148, v46, v109
  v_dot2c_f32_bf16 v149, v46, v129
  v_dot2c_f32_bf16 v150, v47, v109
  v_dot2c_f32_bf16 v151, v47, v129
  s_waitcnt vmcnt(3)
  v_dot2c_f32_bf16 v144, v48, v110
  v_dot2c_f32_bf16 v145, v48, v130
  v_dot2c_f32_bf16 v146, v49, v110
  v_dot2c_f32_bf16 v147, v49, v130
  v_dot2c_f32_bf16 v148, v50, v110
  v_dot2c_f32_bf16 v149, v50, v130
  v_dot2c_f32_bf16 v150, v51, v110
  v_dot2c_f32_bf16 v151, v51, v130
  s_waitcnt vmcnt(2)
  v_dot2c_f32_bf16 v144, v52, v111
  v_dot2c_f32_bf16 v145, v52, v131
  v_dot2c_f32_bf16 v146, v53, v111
  v_dot2c_f32_bf16 v147, v53, v131
  v_dot2c_f32_bf16 v148, v54, v111
  v_dot2c_f32_bf16 v149, v54, v131
  v_dot2c_f32_bf16 v150, v55, v111
  v_dot2c_f32_bf16 v151, v55, v131
  s_waitcnt vmcnt(1)
  v_dot2c_f32_bf16 v144, v56, v112
  v_dot2c_f32_bf16 v145, v56, v132
  v_dot2c_f32_bf16 v146, v57, v112
  v_dot2c_f32_bf16 v147, v57, v132
  v_dot2c_f32_bf16 v148, v58, v112
  v_dot2c_f32_bf16 v149, v58, v132
  v_dot2c_f32_bf16 v150, v59, v112
  v_dot2c_f32_bf16 v151, v59, v132
  s_waitcnt vmcnt(0)
  v_dot2c_f32_bf16 v144, v60, v113
  v_dot2c_f32_bf16 v145, v60, v133
  v_dot2c_f32_bf16 v146, v61, v113
  v_dot2c_f32_bf16 v147, v61, v133
  v_dot2c_f32_bf16 v148, v62, v113
  v_dot2c_f32_bf16 v149, v62, v133
  v_dot2c_f32_bf16 v150, v63, v113
  v_dot2c_f32_bf16 v151, v63, v133
  s_branch L_q2j
L_q2wo:
  s_waitcnt vmcnt(9)
  v_dot2c_f32_bf16 v144, v24, v104
  v_dot2c_f32_bf16 v145, v24, v124
  v_dot2c_f32_bf16 v146, v25, v104
  v_dot2c_f32_bf16 v147, v25, v124
  v_dot2c_f32_bf16 v148, v26, v104
  v_dot2c_f32_bf16 v149, v26, v124
  v_dot2c_f32_bf16 v150, v27, v104
  v_dot2c_f32_bf16 v151, v27, v124
  s_waitcnt vmcnt(8)
  v_dot2c_f32_bf16 v144, v28, v105
  v_dot2c_f32_bf16 v145, v28, v125
  v_dot2c_f32_bf16 v146, v29, v105
  v_dot2c_f32_bf16 v147, v29, v125
  v_dot2c_f32_bf16 v148, v30, v105
  v_dot2c_f32_bf16 v149, v30, v125
  v_dot2c_f32_bf16 v150, v31, v105
  v_dot2c_f32_bf16 v151, v31, v125
  s_waitcnt vmcnt(7)
  v_dot2c_f32_bf16 v144, v32, v106
  v_dot2c_f32_bf16 v145, v32, v126
  v_dot2c_f32_bf16 v146, v33, v106
  v_dot2c_f32_bf16 v147, v33, v126
  v_dot2c_f32_bf16 v148, v34, v106
  v_dot2c_f32_bf16 v149, v34, v126
  v_dot2c_f32_bf16 v150, v35, v106
  v_dot2c_f32_bf16 v151, v35, v126
  s_waitcnt vmcnt(6)
  v_dot2c_f32_bf16 v144, v36, v107
  v_dot2c_f32_bf16 v145, v36, v127
  v_dot2c_f32_bf16 v146, v37, v107
  v_dot2c_f32_bf16 v147, v37, v127
  v_dot2c_f32_bf16 v148, v38, v107
  v_dot2c_f32_bf16 v149, v38, v127
  v_dot2c_f32_bf16 v150, v39, v107
  v_dot2c_f32_bf16 v151, v39, v127
  s_waitcnt vmcnt(5)
  v_dot2c_f32_bf16 v144, v40, v108
  v_dot2c_f32_bf16 v145, v40, v128
  v_dot2c_f32_bf16 v146, v41, v108
  v_dot2c_f32_bf16 v147, v41, v128
  v_dot2c_f32_bf16 v148, v42, v108
  v_dot2c_f32_bf16 v149, v42, v128
  v_dot2c_f32_bf16 v150, v43, v108
  v_dot2c_f32_bf16 v151, v43, v128
  s_waitcnt vmcnt(4)
  v_dot2c_f32_bf16 v144, v44, v109
  v_dot2c_f32_bf16 v145, v44, v129
  v_dot2c_f32_bf16 v146, v45, v109
  v_dot2c_f32_bf16 v147, v45, v129
  v_dot2c_f32_bf16 v148, v46, v109
  v_dot2c_f32_bf16 v149, v46, v129
  v_dot2c_f32_bf16 v150, v47, v109
  v_dot2c_f32_bf16 v151, v47, v129
  s_waitcnt vmcnt(3)
  v_dot2c_f32_bf16 v144, v48, v110
  v_dot2c_f32_bf16 v145, v48, v130
  v_dot2c_f32_bf16 v146, v49, v110
  v_dot2c_f32_bf16 v147, v49, v130
  v_dot2c_f32_bf16 v148, v50, v110
  v_dot2c_f32_bf16 v149, v50, v130
  v_dot2c_f32_bf16 v150, v51, v110
  v_dot2c_f32_bf16 v151, v51, v130
  s_waitcnt vmcnt(2)
  v_dot2c_f32_bf16 v144, v52, v111
  v_dot2c_f32_bf16 v145, v52, v131
  v_dot2c_f32_bf16 v146, v53, v111
  v_dot2c_f32_bf16 v147, v53, v131
  v_dot2c_f32_bf16 v148, v54, v111
  v_dot2c_f32_bf16 v149, v54, v131
  v_dot2c_f32_bf16 v150, v55, v111
  v_dot2c_f32_bf16 v151, v55, v131
  s_waitcnt vmcnt(1)
  v_dot2c_f32_bf16 v144, v56, v112
  v_dot2c_f32_bf16 v145, v56, v132
  v_dot2c_f32_bf16 v146, v57, v112
  v_dot2c_f32_bf16 v147, v57, v132
  v_dot2c_f32_bf16 v148, v58, v112
  v_dot2c_f32_bf16 v149, v58, v132
  v_dot2c_f32_bf16 v150, v59, v112
  v_dot2c_f32_bf16 v151, v59, v132
  s_waitcnt vmcnt(0)
  v_dot2c_f32_bf16 v144, v60, v113
  v_dot2c_f32_bf16 v145, v60, v133
  v_dot2c_f32_bf16 v146, v61, v113
  v_dot2c_f32_bf16 v147, v61, v133
  v_dot2c_f32_bf16 v148, v62, v113
  v_dot2c_f32_bf16 v149, v62, v133
  v_dot2c_f32_bf16 v150, v63, v113
  v_dot2c_f32_bf16 v151, v63, v133
L_q2j:
  s_nop 2
  s_lshl_b32 s69, s3, 9
  v_permlane32_swap_b32 v144, v148
  v_permlane32_swap_b32 v145, v149
  v_permlane32_swap_b32 v146, v150
  v_permlane32_swap_b32 v147, v151
  v_add_f32 v144, v144, v148
  v_add_f32 v145, v145, v149
  v_add_f32 v146, v146, v150
  v_add_f32 v147, v147, v151
  s_nop 0
  v_permlane16_swap_b32 v144, v146
  v_permlane16_swap_b32 v145, v147
  v_add_f32 v144, v144, v146
  v_add_f32 v145, v145, v147
  s_nop 0
  v_add_f32_dpp v144, v144, v144 row_ror:8 row_mask:0xf bank_mask:0xf
  v_add_f32_dpp v145, v145, v145 row_ror:8 row_mask:0xf bank_mask:0xf
  v_mov_b32 v146, s30
  v_mov_b32 v147, s31
  s_mov_b32 exec_lo, 0xff00ff
  s_mov_b32 exec_hi, 0xff00ff
  buffer_store_dwordx4 v[144:147], v152, s[32:35], s64 offen offset:0
  s_mov_b64 exec, -1
  v_and_b32 v3, 31, v0
  v_lshrrev_b32 v2, 5, v0
  v_lshlrev_b32 v2, 11, v2
  v_lshl_add_u32 v2, v3, 4, v2
  s_lshl_b32 s68, s6, 14
  s_add_u32 s60, s68, s69
  s_add_u32 s61, s60, 4096
  s_add_u32 s62, s60, 8192
  s_add_u32 s63, s60, 12288
  v_lshlrev_b32 v3, 2, v3
  s_lshl_b32 s69, s3, 7
  v_add_u32 v3, s69, v3
  v_mov_b32 v1, 0
  s_mov_b32 s65, 0
  s_mov_b32 s16, s32
  s_mov_b32 s17, s33
  s_mov_b32 s18, 4194304
  s_mov_b32 s19, 0x20000
  s_mov_b32 s70, 200007
L_spin_29:
  buffer_load_dwordx4 v[8:11], v2, s[16:19], s60 offen offset:0 sc1 nt
  buffer_load_dwordx4 v[12:15], v2, s[16:19], s61 offen offset:0 sc1 nt
  buffer_load_dwordx4 v[16:19], v2, s[16:19], s62 offen offset:0 sc1 nt
  buffer_load_dwordx4 v[20:23], v2, s[16:19], s63 offen offset:0 sc1 nt
  s_waitcnt vmcnt(0)
  v_cmp_ne_u64 vcc, s[30:31], v[10:11]
  v_cmp_ne_u64 s[20:21], s[30:31], v[14:15]
  v_cmp_ne_u64 s[22:23], s[30:31], v[18:19]
  s_or_b64 vcc, vcc, s[20:21]
  v_cmp_ne_u64 s[20:21], s[30:31], v[22:23]
  s_or_b64 vcc, vcc, s[22:23]
  s_or_b64 vcc, vcc, s[20:21]
  s_nop 0
  s_cbranch_vccz L_sdone_30
  s_sleep 2
  ds_read_b32 v4, v1 offset:648
  s_waitcnt lgkmcnt(0)
  v_readfirstlane_b32 s46, v4
  s_nop 0
  s_sub_u32 s68, s46, s65
  s_cmp_lg_u32 s68, 2
  s_cbranch_scc1 L_qlazy_31
  s_mov_b32 exec_lo, 0xff00ff
  s_mov_b32 exec_hi, 0xff00ff
  buffer_store_dwordx4 v[144:147], v152, s[24:27], s64 offen offset:0 sc1
  s_mov_b64 exec, -1
  s_mov_b32 s65, 1
L_qlazy_31:
  s_and_b32 s99, s70, 7
  s_cselect_b32 s16, s32, s24
  s_cselect_b32 s17, s33, s25
  s_sub_u32 s70, s70, 1
  s_cbranch_scc0 L_spin_29
L_sdone_30:
  v_add_f32 v8, v8, v12
  v_add_f32 v9, v9, v13
  v_add_f32 v16, v16, v20
  v_add_f32 v17, v17, v21
  v_add_f32 v8, v8, v16
  v_add_f32 v9, v9, v17
  v_mov_b32 v10, v8
  v_mov_b32 v11, v9
  s_nop 0
  v_permlane32_swap_b32 v8, v10
  v_permlane32_swap_b32 v9, v11
  v_add_f32 v8, v8, v10
  v_add_f32 v9, v9, v11
  v_cvt_pk_bf16_f32 v8, v8, v9
  ds_write_b32 v3, v8 offset:0
  s_lshl_b32 s69, s3, 3
  v_mov_b32 v4, s69
  v_mov_b32 v6, 1
  s_waitcnt lgkmcnt(0)
  ds_write_b32 v4, v6 offset:384
  v_mov_b32 v1, 0
  s_mov_b32 s70, 200007
L_spin_32:
  ds_read_b32 v4, v1 offset:648
  s_waitcnt lgkmcnt(0)
  v_cmp_gt_u32 vcc, 1, v4
  s_nop 0
  s_cbranch_vccz L_sdone_33
  s_sleep 2
  s_sub_u32 s70, s70, 1
  s_cbranch_scc0 L_spin_32
L_sdone_33:
  v_readfirstlane_b32 s46, v4
  ds_read_b32 v4, v1 offset:648
  s_waitcnt lgkmcnt(0)
  v_readfirstlane_b32 s46, v4
  s_nop 0
  s_sub_u32 s68, s46, s65
  s_cmp_lg_u32 s68, 2
  s_cbranch_scc1 L_qlazy_34
  s_mov_b32 exec_lo, 0xff00ff
  s_mov_b32 exec_hi, 0xff00ff
  buffer_store_dwordx4 v[144:147], v152, s[24:27], s64 offen offset:0 sc1
  s_mov_b64 exec, -1
  s_mov_b32 s65, 1
L_qlazy_34:
  s_branch L_stats
L_ids:
  s_waitcnt lgkmcnt(0)
  s_memrealtime s[62:63]
  s_barrier
  s_getreg_b32 s64, hwreg(HW_REG_XCC_ID)
  s_load_dwordx2 s[28:29], s[58:59], 917504
  s_mov_b32 s24, s58
  s_mov_b32 s25, s59
  s_mov_b32 s26, 4194304
  s_mov_b32 s27, 0x20000
  s_add_u32 s32, s58, 4194304
  s_addc_u32 s33, s59, 0
  s_mov_b32 s34, 4194304
  s_mov_b32 s35, 0x20000
  s_lshl3_add_u32 s71, s6, s7
  s_waitcnt lgkmcnt(0)
  s_mul_i32 s30, s28, 0x2c9277b5
  s_add_u32 s30, s30, 0xac564b05
  s_mul_i32 s31, s29, 0x0019660d
  s_add_u32 s31, s31, 0x3c6ef35f
  s_and_b32 s64, s64, 15
  v_mov_b32 v4, s30
  v_mov_b32 v5, s31
  v_mov_b32 v6, s64
  v_mov_b32 v7, s64
  s_lshl_b32 s68, s4, 9
  s_add_u32 s68, s68, 753664
  s_lshr_b32 s65, s2, 3
  s_lshl_b32 s69, s65, 4
  v_mov_b32 v1, s69
  s_mov_b64 exec, 1
  buffer_store_dwordx4 v[4:7], v1, s[32:35], s68 offen
  s_mov_b64 exec, -1
  s_mul_i32 s66, s4, 2304
  s_add_u32 s66, s66, 921600
  s_cmp_lg_u32 s65, 7
  s_cbranch_scc1 L_noinit
  v_mov_b32 v13, s30
  s_mov_b64 exec, -1
  v_lshlrev_b32 v12, 8, v0
  s_lshl_b32 s69, s4, 15
  s_add_u32 s69, s69, 1703936
  s_mov_b32 exec_lo, 0x8040201
  s_mov_b32 exec_hi, 0x8040201
  buffer_store_dword v13, v12, s[24:27], s69 offen sc1
  s_mov_b64 exec, -1
L_noinit:
  v_and_b32 v1, 31, v0
  v_lshlrev_b32 v1, 4, v1
  s_mov_b32 s70, 12
  s_mov_b32 s46, 2
L_idpoll:
  s_sleep 16
  buffer_load_dwordx4 v[8:11], v1, s[32:35], s68 offen sc1
  s_waitcnt vmcnt(0)
  v_cmp_ne_u64 vcc, s[30:31], v[8:9]
  s_nop 0
  s_cbranch_vccz L_iddone
  s_sub_u32 s70, s70, 1
  s_cbranch_scc0 L_idpoll
  s_branch L_idset
L_iddone:
  v_cmp_ne_u32 vcc, s64, v10
  s_nop 0
  s_cbranch_vccnz L_idset
  s_mov_b32 s46, 1
L_idset:
  v_mov_b32 v1, 0
  v_mov_b32 v4, s46
  ds_write_b32 v1, v4 offset:648
  s_cmp_lg_u32 s65, 7
  s_cbranch_scc1 L_pf
  s_lshl_b32 s69, s4, 15
  s_add_u32 s69, s69, 1703936
  s_add_u32 s22, s58, s69
  s_addc_u32 s23, s59, 0
  s_not_b32 s20, s30
  s_mov_b32 s21, 0
  s_waitcnt lgkmcnt(0)
  s_mov_b32 s8, -1
  s_mov_b32 s9, -1
  s_memtime s[12:13]
  s_waitcnt lgkmcnt(0)
  s_load_dword s10, s[22:23], 0
  s_waitcnt lgkmcnt(0)
  s_memtime s[14:15]
  s_waitcnt lgkmcnt(0)
  s_sub_u32 s11, s14, s12
  s_min_u32 s8, s8, s11
  s_waitcnt lgkmcnt(0)
  s_load_dword s10, s[22:23], 8192
  s_waitcnt lgkmcnt(0)
  s_memtime s[12:13]
  s_waitcnt lgkmcnt(0)
  s_sub_u32 s11, s12, s14
  s_min_u32 s9, s9, s11
  s_waitcnt lgkmcnt(0)
  s_load_dword s10, s[22:23], 10496
  s_waitcnt lgkmcnt(0)
  s_memtime s[14:15]
  s_waitcnt lgkmcnt(0)
  s_sub_u32 s11, s14, s12
  s_min_u32 s9, s9, s11
  s_waitcnt lgkmcnt(0)
  s_load_dword s10, s[22:23], 2304
  s_waitcnt lgkmcnt(0)
  s_memtime s[12:13]
  s_waitcnt lgkmcnt(0)
  s_sub_u32 s11, s12, s14
  s_min_u32 s8, s8, s11
  s_waitcnt lgkmcnt(0)
  s_load_dword s10, s[22:23], 4608
  s_waitcnt lgkmcnt(0)
  s_memtime s[14:15]
  s_waitcnt lgkmcnt(0)
  s_sub_u32 s11, s14, s12
  s_min_u32 s8, s8, s11
  s_waitcnt lgkmcnt(0)
  s_load_dword s10, s[22:23], 12800
  s_waitcnt lgkmcnt(0)
  s_memtime s[12:13]
  s_waitcnt lgkmcnt(0)
  s_sub_u32 s11, s12, s14
  s_min_u32 s9, s9, s11
  s_waitcnt lgkmcnt(0)
  s_load_dword s10, s[22:23], 15104
  s_waitcnt lgkmcnt(0)
  s_memtime s[14:15]
  s_waitcnt lgkmcnt(0)
  s_sub_u32 s11, s14, s12
  s_min_u32 s9, s9, s11
  s_waitcnt lgkmcnt(0)
  s_load_dword s10, s[22:23], 6912
  s_waitcnt lgkmcnt(0)
  s_memtime s[12:13]
  s_waitcnt lgkmcnt(0)
  s_sub_u32 s11, s12, s14
  s_min_u32 s8, s8, s11
  s_sub_u32 s21, s8, s9
  s_cmp_gt_i32 s21, 0
  s_cselect_b32 s21, 1, 0
  v_mov_b32 v4, s21
  v_mov_b32 v5, s62
  v_mov_b32 v6, s30
  v_mov_b32 v7, s31
  s_lshl_b32 s69, s4, 4
  s_add_u32 s69, s69, 950272
  s_mov_b64 exec, 1
  buffer_store_dwordx4 v[4:7], v1, s[24:27], s69 offen sc1
  s_mov_b64 exec, -1
L_pf:
  s_and_b32 s63, s31, 0xffff0000
  s_cmp_lg_u32 s7, 6
  s_cbranch_scc1 L_nosample
  v_mov_b32 v1, 0
  s_mov_b32 s70, 200007
L_spin_35:
  ds_read_b64 v[4:5], v1 offset:696
  s_waitcnt lgkmcnt(0)
  v_cmp_gt_u32 vcc, 0x8000000, v5
  s_nop 0
  s_cbranch_vccz L_sdone_36
  s_sleep 2
  s_sub_u32 s70, s70, 1
  s_cbranch_scc0 L_spin_35
L_sdone_36:
  v_and_b32 v5, 0xffffff, v5
  v_min_u32 v5, 0xffff, v5
  v_or_b32 v5, s63, v5
  v_lshlrev_b32 v6, 9, v0
  s_lshl_b32 s68, s6, 3
  s_add_u32 s68, s68, 958464
  s_mov_b64 exec, 7
  buffer_store_dwordx2 v[4:5], v6, s[24:27], s68 offen sc1
  s_mov_b64 exec, -1
L_nosample:
  v_mov_b32 v1, 0
  s_mov_b32 s70, 200007
L_spin_37:
  ds_read_b32 v12, v1 offset:692
  s_waitcnt lgkmcnt(0)
  v_cmp_gt_u32 vcc, 8, v12
  s_nop 0
  s_cbranch_vccz L_sdone_38
  s_sleep 4
  s_sub_u32 s70, s70, 1
  s_cbranch_scc0 L_spin_37
L_sdone_38:
  s_setprio 3
  s_add_u32 s60, s58, 958464
  s_addc_u32 s61, s59, 0
  s_mov_b32 s70, 2
L_calpoll:
  s_lshl_b32 s96, s62, 8
  s_sub_u32 s96, 0, s96
  s_mov_b32 s97, 0
  s_mov_b32 s98, 0
  s_load_dwordx16 s[8:23], s[60:61], 0
  s_load_dwordx16 s[80:95], s[60:61], 64
  s_waitcnt lgkmcnt(0)
  s_add_u32 s96, s96, s8
  s_xor_b32 s9, s9, s63
  s_add_u32 s97, s97, s9
  s_or_b32 s98, s98, s9
  s_add_u32 s96, s96, s10
  s_xor_b32 s11, s11, s63
  s_add_u32 s97, s97, s11
  s_or_b32 s98, s98, s11
  s_add_u32 s96, s96, s12
  s_xor_b32 s13, s13, s63
  s_add_u32 s97, s97, s13
  s_or_b32 s98, s98, s13
  s_add_u32 s96, s96, s14
  s_xor_b32 s15, s15, s63
  s_add_u32 s97, s97, s15
  s_or_b32 s98, s98, s15
  s_add_u32 s96, s96, s16
  s_xor_b32 s17, s17, s63
  s_add_u32 s97, s97, s17
  s_or_b32 s98, s98, s17
  s_add_u32 s96, s96, s18
  s_xor_b32 s19, s19, s63
  s_add_u32 s97, s97, s19
  s_or_b32 s98, s98, s19
  s_add_u32 s96, s96, s20
  s_xor_b32 s21, s21, s63
  s_add_u32 s97, s97, s21
  s_or_b32 s98, s98, s21
  s_add_u32 s96, s96, s22
  s_xor_b32 s23, s23, s63
  s_add_u32 s97, s97, s23
  s_or_b32 s98, s98, s23
  s_add_u32 s96, s96, s80
  s_xor_b32 s81, s81, s63
  s_add_u32 s97, s97, s81
  s_or_b32 s98, s98, s81
  s_add_u32 s96, s96, s82
  s_xor_b32 s83, s83, s63
  s_add_u32 s97, s97, s83
  s_or_b32 s98, s98, s83
  s_add_u32 s96, s96, s84
  s_xor_b32 s85, s85, s63
  s_add_u32 s97, s97, s85
  s_or_b32 s98, s98, s85
  s_add_u32 s96, s96, s86
  s_xor_b32 s87, s87, s63
  s_add_u32 s97, s97, s87
  s_or_b32 s98, s98, s87
  s_add_u32 s96, s96, s88
  s_xor_b32 s89, s89, s63
  s_add_u32 s97, s97, s89
  s_or_b32 s98, s98, s89
  s_add_u32 s96, s96, s90
  s_xor_b32 s91, s91, s63
  s_add_u32 s97, s97, s91
  s_or_b32 s98, s98, s91
  s_add_u32 s96, s96, s92
  s_xor_b32 s93, s93, s63
  s_add_u32 s97, s97, s93
  s_or_b32 s98, s98, s93
  s_add_u32 s96, s96, s94
  s_xor_b32 s95, s95, s63
  s_add_u32 s97, s97, s95
  s_or_b32 s98, s98, s95
  s_load_dwordx16 s[8:23], s[60:61], 128
  s_load_dwordx16 s[80:95], s[60:61], 192
  s_waitcnt lgkmcnt(0)
  s_add_u32 s96, s96, s8
  s_xor_b32 s9, s9, s63
  s_add_u32 s97, s97, s9
  s_or_b32 s98, s98, s9
  s_add_u32 s96, s96, s10
  s_xor_b32 s11, s11, s63
  s_add_u32 s97, s97, s11
  s_or_b32 s98, s98, s11
  s_add_u32 s96, s96, s12
  s_xor_b32 s13, s13, s63
  s_add_u32 s97, s97, s13
  s_or_b32 s98, s98, s13
  s_add_u32 s96, s96, s14
  s_xor_b32 s15, s15, s63
  s_add_u32 s97, s97, s15
  s_or_b32 s98, s98, s15
  s_add_u32 s96, s96, s16
  s_xor_b32 s17, s17, s63
  s_add_u32 s97, s97, s17
  s_or_b32 s98, s98, s17
  s_add_u32 s96, s96, s18
  s_xor_b32 s19, s19, s63
  s_add_u32 s97, s97, s19
  s_or_b32 s98, s98, s19
  s_add_u32 s96, s96, s20
  s_xor_b32 s21, s21, s63
  s_add_u32 s97, s97, s21
  s_or_b32 s98, s98, s21
  s_add_u32 s96, s96, s22
  s_xor_b32 s23, s23, s63
  s_add_u32 s97, s97, s23
  s_or_b32 s98, s98, s23
  s_add_u32 s96, s96, s80
  s_xor_b32 s81, s81, s63
  s_add_u32 s97, s97, s81
  s_or_b32 s98, s98, s81
  s_add_u32 s96, s96, s82
  s_xor_b32 s83, s83, s63
  s_add_u32 s97, s97, s83
  s_or_b32 s98, s98, s83
  s_add_u32 s96, s96, s84
  s_xor_b32 s85, s85, s63
  s_add_u32 s97, s97, s85
  s_or_b32 s98, s98, s85
  s_add_u32 s96, s96, s86
  s_xor_b32 s87, s87, s63
  s_add_u32 s97, s97, s87
  s_or_b32 s98, s98, s87
  s_add_u32 s96, s96, s88
  s_xor_b32 s89, s89, s63
  s_add_u32 s97, s97, s89
  s_or_b32 s98, s98, s89
  s_add_u32 s96, s96, s90
  s_xor_b32 s91, s91, s63
  s_add_u32 s97, s97, s91
  s_or_b32 s98, s98, s91
  s_add_u32 s96, s96, s92
  s_xor_b32 s93, s93, s63
  s_add_u32 s97, s97, s93
  s_or_b32 s98, s98, s93
  s_add_u32 s96, s96, s94
  s_xor_b32 s95, s95, s63
  s_add_u32 s97, s97, s95
  s_or_b32 s98, s98, s95
  s_cmp_lt_u32 s98, 0x10000
  s_cbranch_scc1 L_calok
  s_add_u32 s60, s60, 512
  s_addc_u32 s61, s61, 0
  s_sub_u32 s70, s70, 1
  s_cbranch_scc1 L_calno
  s_sleep 20
  s_branch L_calpoll
L_calok:
  v_cvt_f32_u32 v13, s97
  s_ashr_i32 s96, s96, 4
  s_cmp_lt_u32 s7, 5
  s_mov_b32 s68, -208
  s_cselect_b32 s68, 112, s68
  s_lshl4_add_u32 s68, s62, s68
  s_add_u32 s68, s68, s96
  v_mov_b32 v12, s68
  v_mul_f32 v13, 0x00000000, v13
  v_add_f32 v13, 0x43e60000, v13
  v_cvt_u32_f32 v13, v13
  ds_write_b64 v1, v[12:13] offset:680
L_calno:
  s_setprio 3
L_stats:
  v_and_b32 v1, 7, v0
  v_lshlrev_b32 v1, 4, v1
  s_mov_b32 s70, 200007
L_spin_39:
  ds_read_b128 v[4:7], v1 offset:512
  s_waitcnt lgkmcnt(0)
  v_cmp_eq_u32 vcc, 0, v7
  s_nop 0
  s_cbranch_vccz L_sdone_40
  s_sleep 4
  s_sub_u32 s70, s70, 1
  s_cbranch_scc0 L_spin_39
L_sdone_40:
  s_cmp_lg_u32 s3, 3
  s_cbranch_scc1 L_nostat
  s_mov_b32 s68, 0x3fb8aa3b
  v_mov_b32 v2, v4
  s_nop 1
  v_max_f32_dpp v2, v2, v2 quad_perm:[1,0,3,2] row_mask:0xf bank_mask:0xf
  s_nop 1
  v_max_f32_dpp v2, v2, v2 quad_perm:[2,3,0,1] row_mask:0xf bank_mask:0xf
  s_nop 1
  v_max_f32_dpp v2, v2, v2 row_half_mirror row_mask:0xf bank_mask:0xf
  v_sub_f32 v4, v4, v2
  v_mul_f32 v4, s68, v4
  v_exp_f32 v4, v4
  s_nop 0
  v_mul_f32 v3, v4, v5
  s_nop 1
  v_add_f32_dpp v3, v3, v3 quad_perm:[1,0,3,2] row_mask:0xf bank_mask:0xf
  s_nop 1
  v_add_f32_dpp v3, v3, v3 quad_perm:[2,3,0,1] row_mask:0xf bank_mask:0xf
  s_nop 1
  v_add_f32_dpp v3, v3, v3 row_half_mirror row_mask:0xf bank_mask:0xf
  s_lshl_b32 s68, s71, 4
  s_add_u32 s68, s68, 720896
  v_mov_b32 v4, s30
  v_mov_b32 v5, s31
  s_mov_b32 exec_lo, 0x1
  s_mov_b32 exec_hi, 0x0
  buffer_store_dwordx4 v[2:5], v1, s[32:35], s68 offen
  s_mov_b64 exec, -1
  s_cmp_lg_u32 s46, 1
  s_cbranch_scc1 L_slow_41
L_back_42:
  s_mov_b32 s68, 950272
  s_mov_b32 s70, 200007
L_spin_43:
  buffer_load_dwordx4 v[8:11], v1, s[24:27], s68 offen sc1
  s_waitcnt vmcnt(0)
  v_cmp_ne_u64 vcc, s[30:31], v[10:11]
  s_nop 0
  s_cbranch_vccz L_sdone_44
  s_sleep 8
  s_sub_u32 s70, s70, 1
  s_cbranch_scc0 L_spin_43
L_sdone_44:
  v_cmp_ne_u32 vcc, 0, v8
  s_nop 0
  s_and_b32 s67, vcc_lo, 0xff
  s_lshl_b32 s67, s67, 8
  s_bitset1_b32 s67, 16
  s_mul_i32 s5, s79, 5
  s_add_u32 s5, s5, s7
  s_mul_i32 s72, s79, 3
  s_add_u32 s72, s72, s7
  s_add_u32 s72, s72, 15
  s_cmp_lt_u32 s7, 5
  s_cselect_b32 s5, s5, s72
  s_or_b32 s5, s5, s67
  v_mov_b32 v8, s5
  v_mov_b32 v1, 0
  s_mov_b64 exec, 1
  ds_write_b32 v1, v8 offset:660
  s_mov_b64 exec, -1
L_nostat:
  v_mov_b32 v1, 0
  s_mov_b32 s70, 200007
L_spin_45:
  ds_read_b32 v4, v1 offset:660
  s_waitcnt lgkmcnt(0)
  v_cmp_gt_u32 vcc, 1, v4
  s_nop 0
  s_cbranch_vccz L_sdone_46
  s_sleep 4
  s_sub_u32 s70, s70, 1
  s_cbranch_scc0 L_spin_45
L_sdone_46:
  v_readfirstlane_b32 s5, v4
  s_nop 0
  s_bfe_u32 s47, s5, 0x80008
  s_and_b32 s5, s5, 31
  s_cmp_lt_u32 s5, 20
  s_cbranch_scc0 L_helper_exit
  s_cmp_ge_u32 s5, 10
  s_cselect_b32 s76, 1, 0
  s_mul_i32 s77, s76, 10
  s_sub_u32 s77, s5, s77
  s_lshr_b32 s68, s3, 1
  s_lshl1_add_u32 s78, s76, s68
  v_bfe_u32 v2, v0, 4, 1
  v_lshlrev_b32 v2, 4, v2
  s_lshl_b32 s68, s78, 5
  v_add_u32 v22, s68, v2
  v_lshlrev_b32 v60, 4, v0
  s_lshl2_add_u32 s73, s4, s78
  s_mul_i32 s73, s73, 6144
  s_and_b32 s68, s3, 1
  s_mul_i32 s68, s68, 3072
  s_add_u32 s73, s73, s68
  s_add_u32 s73, s73, 524288
  v_lshlrev_b32 v62, 2, v0
  s_lshl_b32 s68, s3, 8
  v_add_u32 v61, s68, v62
  v_lshrrev_b32 v2, 5, v0
  v_lshlrev_b32 v2, 11, v2
  v_bfe_u32 v3, v0, 2, 3
  v_lshl_add_u32 v2, v3, 4, v2
  v_and_b32 v3, 1, v0
  v_lshl_add_u32 v63, v3, 13, v2
  s_lshr_b32 s75, s77, 1
  s_lshl_b32 s75, s75, 14
  s_and_b32 s68, s77, 1
  s_lshl_b32 s68, s68, 12
  s_add_u32 s75, s75, s68
  s_lshl1_add_u32 s68, s4, s76
  s_lshl_b32 s68, s68, 7
  s_add_u32 s75, s75, s68
  s_add_u32 s75, s75, 786432
  s_mov_b32 s66, 0xff00ff00
  s_mov_b32 s67, 0xff00ff00
  s_mov_b32 s8, 0x33333333
  s_mov_b32 s9, 0x33333333
  v_mov_b32 v6, s30
  v_mov_b32 v7, s31
  v_cndmask_b32 v52, 0, v6, s[66:67]
  v_cndmask_b32 v53, 0, v7, s[66:67]
  v_cndmask_b32 v54, v6, 0, s[66:67]
  v_cndmask_b32 v55, v7, 0, s[66:67]
  v_mov_b32 v50, s30
  v_mov_b32 v51, s31
  v_lshrrev_b32 v24, 4, v0
  v_lshlrev_b32 v24, 10, v24
  v_bfe_u32 v25, v0, 2, 2
  v_lshl_add_u32 v24, v25, 7, v24
  v_and_b32 v25, 3, v0
  v_lshl_add_u32 v24, v25, 3, v24
  s_mul_i32 s69, s3, 12288
  v_add_u32 v24, s69, v24
  s_cmp_lg_u32 s3, 0
  s_cbranch_scc1 L_noc
  s_lshl_b32 s72, s4, 9
  s_add_u32 s72, s72, 720896
  v_and_b32 v1, 31, v0
  v_lshlrev_b32 v1, 4, v1
  s_mov_b32 s16, s32
  s_mov_b32 s17, s33
  s_mov_b32 s18, 4194304
  s_mov_b32 s19, 0x20000
  s_mov_b32 s70, 200007
L_spin_47:
  s_sleep 24
  buffer_load_dwordx4 v[4:7], v1, s[16:19], s72 offen sc1
  s_waitcnt vmcnt(0)
  v_cmp_ne_u64 vcc, s[30:31], v[6:7]
  s_nop 0
  s_cbranch_vccz L_sdone_48
  s_and_b32 s99, s70, 7
  s_cmp_eq_u32 s46, 1
  s_cselect_b32 s99, 1, s99
  s_cmp_lg_u32 s99, 0
  s_cselect_b32 s16, s32, s24
  s_cselect_b32 s17, s33, s25
  s_sub_u32 s70, s70, 1
  s_cbranch_scc0 L_spin_47
L_sdone_48:
  s_mov_b32 s68, 0x3fb8aa3b
  v_mov_b32 v2, v4
  s_nop 1
  v_max_f32_dpp v2, v2, v2 quad_perm:[1,0,3,2] row_mask:0xf bank_mask:0xf
  s_nop 1
  v_max_f32_dpp v2, v2, v2 quad_perm:[2,3,0,1] row_mask:0xf bank_mask:0xf
  s_nop 1
  v_max_f32_dpp v2, v2, v2 row_half_mirror row_mask:0xf bank_mask:0xf
  v_sub_f32 v4, v4, v2
  v_mul_f32 v4, s68, v4
  v_exp_f32 v4, v4
  s_nop 0
  v_mul_f32 v3, v4, v5
  s_nop 1
  v_add_f32_dpp v3, v3, v3 quad_perm:[1,0,3,2] row_mask:0xf bank_mask:0xf
  s_nop 1
  v_add_f32_dpp v3, v3, v3 quad_perm:[2,3,0,1] row_mask:0xf bank_mask:0xf
  s_nop 1
  v_add_f32_dpp v3, v3, v3 row_half_mirror row_mask:0xf bank_mask:0xf
  v_rcp_f32 v3, v3
  v_lshrrev_b32 v1, 2, v1
  v_mul_f32 v4, v4, v3
  v_mov_b32 v2, 0
  v_mov_b32 v3, 1
  ds_write_b32 v1, v4 offset:768
  ds_write_b32 v2, v3 offset:664
L_noc:
  v_mov_b32 v1, 0
  s_mov_b32 s70, 200007
L_spin_49:
  ds_read_b32 v4, v1 offset:664
  s_waitcnt lgkmcnt(0)
  v_cmp_gt_u32 vcc, 1, v4
  s_nop 0
  s_cbranch_vccz L_sdone_50
  s_sleep 2
  s_sub_u32 s70, s70, 1
  s_cbranch_scc0 L_spin_49
L_sdone_50:
  ds_read_b128 v[56:59], v22 offset:768
  v_mov_b32 v23, 1
  s_lshl_b32 s68, s3, 2
  v_mov_b32 v25, s68
  s_mov_b32 s12, s44
  s_mov_b32 s13, s45
  s_mov_b32 s14, 7864320
  s_mov_b32 s15, 0x20000
  v_lshrrev_b32 v21, 3, v0
  v_mul_u32_u24 v21, 1280, v21
  v_and_b32 v3, 7, v0
  v_lshl_add_u32 v21, v3, 4, v21
  s_lshl1_add_u32 s60, s4, s76
  s_lshl2_add_u32 s60, s60, s3
  s_mul_i32 s60, s60, 122880
  s_lshl_b32 s69, s77, 7
  s_add_u32 s60, s60, s69
  s_add_u32 s60, s60, 0
  s_mul_i32 s61, s3, 12288
  s_add_u32 s61, s61, 8704
  v_mov_b32 v1, 0
  s_mov_b32 s70, 200007
L_spin_51:
  ds_read_b32 v4, v1 offset:644
  s_waitcnt lgkmcnt(0)
  v_cmp_gt_u32 vcc, 8, v4
  s_nop 0
  s_cbranch_vccz L_sdone_52
  s_sleep 2
  s_sub_u32 s70, s70, 1
  s_cbranch_scc0 L_spin_51
L_sdone_52:
  s_mov_b32 m0, s61
  s_nop 0
  buffer_load_dwordx4 v21, s[12:15], s60 offen nt lds
  s_add_u32 s60, s60, 10240
  s_add_u32 s61, s61, 1024
  s_mov_b32 m0, s61
  s_nop 0
  buffer_load_dwordx4 v21, s[12:15], s60 offen nt lds
  s_add_u32 s60, s60, 10240
  s_add_u32 s61, s61, 1024
  s_mov_b32 m0, s61
  s_nop 0
  buffer_load_dwordx4 v21, s[12:15], s60 offen nt lds
  s_add_u32 s60, s60, 10240
  s_add_u32 s61, s61, 1024
  s_mov_b32 m0, s61
  s_nop 0
  buffer_load_dwordx4 v21, s[12:15], s60 offen nt lds
  s_add_u32 s60, s60, 10240
  s_add_u32 s61, s61, 1024
  s_mov_b32 m0, s61
  s_nop 0
  buffer_load_dwordx4 v21, s[12:15], s60 offen nt lds
  s_add_u32 s60, s60, 10240
  s_add_u32 s61, s61, 1024
  s_waitcnt vmcnt(4)
  s_mov_b32 m0, s61
  s_nop 0
  buffer_load_dwordx4 v21, s[12:15], s60 offen nt lds
  s_add_u32 s60, s60, 10240
  s_add_u32 s61, s61, 1024
  s_waitcnt vmcnt(4)
  s_mov_b32 m0, s61
  s_nop 0
  buffer_load_dwordx4 v21, s[12:15], s60 offen nt lds
  s_add_u32 s60, s60, 10240
  s_add_u32 s61, s61, 1024
  s_waitcnt vmcnt(4)
  s_mov_b32 m0, s61
  s_nop 0
  buffer_load_dwordx4 v21, s[12:15], s60 offen nt lds
  s_add_u32 s60, s60, 10240
  s_add_u32 s61, s61, 1024
  s_waitcnt vmcnt(4)
  s_mov_b32 m0, s61
  s_nop 0
  buffer_load_dwordx4 v21, s[12:15], s60 offen nt lds
  s_add_u32 s60, s60, 10240
  s_add_u32 s61, s61, 1024
  s_waitcnt vmcnt(4)
  s_mov_b32 m0, s61
  s_nop 0
  buffer_load_dwordx4 v21, s[12:15], s60 offen nt lds
  s_add_u32 s60, s60, 10240
  s_add_u32 s61, s61, 1024
  s_waitcnt vmcnt(4)
  s_mov_b32 m0, s61
  s_nop 0
  buffer_load_dwordx4 v21, s[12:15], s60 offen nt lds
  s_add_u32 s60, s60, 10240
  s_add_u32 s61, s61, 1024
  s_waitcnt vmcnt(4)
  s_mov_b32 m0, s61
  s_nop 0
  buffer_load_dwordx4 v21, s[12:15], s60 offen nt lds
  s_add_u32 s60, s60, 10240
  s_add_u32 s61, s61, 1024
  s_waitcnt vmcnt(4)
  ds_read_b64_tr_b16 v[64:65], v24 offset:8704
  ds_read_b64_tr_b16 v[66:67], v24 offset:9216
  ds_read_b64_tr_b16 v[68:69], v24 offset:8736
  ds_read_b64_tr_b16 v[70:71], v24 offset:9248
  ds_read_b64_tr_b16 v[72:73], v24 offset:8768
  ds_read_b64_tr_b16 v[74:75], v24 offset:9280
  ds_read_b64_tr_b16 v[76:77], v24 offset:8800
  ds_read_b64_tr_b16 v[78:79], v24 offset:9312
  ds_read_b64_tr_b16 v[80:81], v24 offset:12800
  ds_read_b64_tr_b16 v[82:83], v24 offset:13312
  ds_read_b64_tr_b16 v[84:85], v24 offset:12832
  ds_read_b64_tr_b16 v[86:87], v24 offset:13344
  ds_read_b64_tr_b16 v[88:89], v24 offset:12864
  ds_read_b64_tr_b16 v[90:91], v24 offset:13376
  ds_read_b64_tr_b16 v[92:93], v24 offset:12896
  ds_read_b64_tr_b16 v[94:95], v24 offset:13408
  v_mov_b32 v1, 0
  s_mov_b32 s70, 200007
L_spin_53:
  ds_read_b32 v4, v1 offset:668
  s_waitcnt lgkmcnt(0)
  v_cmp_gt_u32 vcc, 1, v4
  s_nop 0
  s_cbranch_vccz L_sdone_54
  s_sleep 1
  s_sub_u32 s70, s70, 1
  s_cbranch_scc0 L_spin_53
L_sdone_54:
  s_waitcnt vmcnt(0)
  buffer_load_dwordx4 v[8:11], v60, s[32:35], s73 offen offset:0 sc1
  buffer_load_dwordx4 v[12:15], v60, s[32:35], s73 offen offset:1024 sc1
  buffer_load_dwordx4 v[16:19], v60, s[32:35], s73 offen offset:2048 sc1
  ds_read_b64_tr_b16 v[96:97], v24 offset:16896
  ds_read_b64_tr_b16 v[98:99], v24 offset:17408
  ds_read_b64_tr_b16 v[100:101], v24 offset:16928
  ds_read_b64_tr_b16 v[102:103], v24 offset:17440
  ds_read_b64_tr_b16 v[104:105], v24 offset:16960
  ds_read_b64_tr_b16 v[106:107], v24 offset:17472
  ds_read_b64_tr_b16 v[108:109], v24 offset:16992
  ds_read_b64_tr_b16 v[110:111], v24 offset:17504
  s_waitcnt lgkmcnt(0)
  s_mov_b32 s16, s32
  s_mov_b32 s17, s33
  s_mov_b32 s18, 4194304
  s_mov_b32 s19, 0x20000
  s_mov_b32 s70, 200007
  s_branch L_opw
L_spin_55:
  buffer_load_dwordx4 v[8:11], v60, s[16:19], s73 offen offset:0 sc1
  buffer_load_dwordx4 v[12:15], v60, s[16:19], s73 offen offset:1024 sc1
  buffer_load_dwordx4 v[16:19], v60, s[16:19], s73 offen offset:2048 sc1
L_opw:
  s_waitcnt vmcnt(2)
  v_xor_b32 v8, v8, v52
  v_xor_b32 v9, v9, v53
  v_xor_b32 v10, v10, v54
  v_xor_b32 v11, v11, v55
  s_nop 1
  v_mfma_f32_16x16x32_bf16 v[32:35], v[8:11], v[64:67], 0
  v_mfma_f32_16x16x32_bf16 v[36:39], v[8:11], v[68:71], 0
  v_mfma_f32_16x16x32_bf16 v[40:43], v[8:11], v[72:75], 0
  v_mfma_f32_16x16x32_bf16 v[44:47], v[8:11], v[76:79], 0
  v_or_b32 v2, v8, v9
  v_or_b32 v3, v10, v11
  s_waitcnt vmcnt(1)
  v_xor_b32 v12, v12, v52
  v_xor_b32 v13, v13, v53
  v_xor_b32 v14, v14, v54
  v_xor_b32 v15, v15, v55
  s_nop 1
  v_mfma_f32_16x16x32_bf16 v[32:35], v[12:15], v[80:83], v[32:35]
  v_mfma_f32_16x16x32_bf16 v[36:39], v[12:15], v[84:87], v[36:39]
  v_mfma_f32_16x16x32_bf16 v[40:43], v[12:15], v[88:91], v[40:43]
  v_mfma_f32_16x16x32_bf16 v[44:47], v[12:15], v[92:95], v[44:47]
  v_or3_b32 v2, v2, v12, v13
  v_or3_b32 v3, v3, v14, v15
  s_waitcnt vmcnt(0)
  v_xor_b32 v16, v16, v52
  v_xor_b32 v17, v17, v53
  v_xor_b32 v18, v18, v54
  v_xor_b32 v19, v19, v55
  s_nop 1
  v_mfma_f32_16x16x32_bf16 v[32:35], v[16:19], v[96:99], v[32:35]
  v_mfma_f32_16x16x32_bf16 v[36:39], v[16:19], v[100:103], v[36:39]
  v_mfma_f32_16x16x32_bf16 v[40:43], v[16:19], v[104:107], v[40:43]
  v_mfma_f32_16x16x32_bf16 v[44:47], v[16:19], v[108:111], v[44:47]
  v_or3_b32 v2, v2, v16, v17
  v_or3_b32 v3, v3, v18, v19
  v_cndmask_b32 v2, v3, v2, s[66:67]
  v_cmp_ne_u32 vcc, 0, v2
  s_nop 0
  s_cbranch_vccz L_sdone_56
  s_and_b32 s99, s70, 7
  s_cmp_eq_u32 s46, 1
  s_cselect_b32 s99, 1, s99
  s_cmp_lg_u32 s99, 0
  s_cselect_b32 s16, s32, s24
  s_cselect_b32 s17, s33, s25
  s_sub_u32 s70, s70, 1
  s_cbranch_scc0 L_spin_55
L_sdone_56:
  v_mul_f32 v4, v32, v56
  v_fmac_f32 v4, v33, v57
  v_fmac_f32 v4, v34, v58
  v_fmac_f32 v4, v35, v59
  v_mul_f32 v5, v36, v56
  v_fmac_f32 v5, v37, v57
  v_fmac_f32 v5, v38, v58
  v_fmac_f32 v5, v39, v59
  v_mul_f32 v6, v40, v56
  v_fmac_f32 v6, v41, v57
  v_fmac_f32 v6, v42, v58
  v_fmac_f32 v6, v43, v59
  v_mul_f32 v7, v44, v56
  v_fmac_f32 v7, v45, v57
  v_fmac_f32 v7, v46, v58
  v_fmac_f32 v7, v47, v59
  v_permlane32_swap_b32 v4, v6
  s_nop 0
  v_permlane32_swap_b32 v5, v7
  v_add_f32 v4, v4, v6
  v_add_f32 v5, v5, v7
  s_nop 1
  v_permlane16_swap_b32 v4, v5
  v_add_f32 v4, v4, v5
  ds_write_b32 v61, v4 offset:7168
  s_cmp_lg_u32 s3, 0
  s_waitcnt lgkmcnt(0)
  s_barrier
  s_cbranch_scc1 L_post_wo
  ds_read_b32 v5, v62 offset:7424
  ds_read_b32 v6, v62 offset:7680
  ds_read_b32 v7, v62 offset:7936
  s_waitcnt lgkmcnt(0)
  v_add_f32 v4, v4, v5
  v_add_f32 v6, v6, v7
  v_add_f32 v4, v4, v6
  s_nop 1
  v_mov_b32_dpp v5, v4 quad_perm:[1,0,3,2] row_mask:0xf bank_mask:0xf
  v_cvt_pk_bf16_f32 v4, v4, v5
  s_nop 1
  v_mov_b32_dpp v48, v4 quad_perm:[0,0,0,0] row_mask:0xf bank_mask:0xf
  v_mov_b32_dpp v49, v4 quad_perm:[2,2,2,2] row_mask:0xf bank_mask:0xf
  s_mov_b64 exec, s[8:9]
  buffer_store_dwordx4 v[48:51], v63, s[24:27], s75 offen sc1
  s_barrier
  s_endpgm
L_helper_exit:
  s_endpgm
L_f1:
  v_lshrrev_b32 v58, 4, v0
  v_lshlrev_b32 v58, 7, v58
  v_bfe_u32 v5, v0, 2, 2
  v_lshl_add_u32 v58, v5, 9, v58
  v_and_b32 v5, 3, v0
  v_lshl_add_u32 v58, v5, 3, v58
  s_mov_b32 s12, s48
  s_mov_b32 s13, s49
  s_mov_b32 s14, 1966080
  s_mov_b32 s15, 0x20000
  s_mov_b32 s16, s50
  s_mov_b32 s17, s51
  s_mov_b32 s18, 1966080
  s_mov_b32 s19, 0x20000
  s_mul_i32 s75, s5, 5
  s_add_u32 s75, s75, s73
  s_sub_u32 s75, s75, 100
  s_cmp_ge_u32 s75, 20
  s_cselect_b32 s78, 1, 0
  s_cmp_ge_u32 s75, 40
  s_cselect_b32 s78, 2, s78
  s_mul_i32 s68, s78, 20
  s_sub_u32 s74, s75, s68
  s_mul_i32 s68, s4, 3
  s_add_u32 s78, s78, s68
  s_lshl_b32 s68, s73, 13
  v_add_u32 v58, s68, v58
  s_add_u32 s79, s68, 8704
  v_lshrrev_b32 v3, 4, v0
  v_and_b32 v2, 7, v0
  v_lshl_add_u32 v50, v2, 2, v3
  v_lshlrev_b32 v50, 1, v50
  s_lshl_b32 s68, s74, 6
  v_add_u32 v61, s68, v50
  v_lshlrev_b32 v54, 6, v3
  v_lshl_add_u32 v54, v2, 3, v54
  v_lshrrev_b32 v53, 3, v0
  v_mul_u32_u24 v62, 3072, v53
  v_lshl_add_u32 v62, v2, 4, v62
  s_lshr_b32 s60, s74, 2
  s_lshl_b32 s60, s60, 14
  s_and_b32 s68, s74, 3
  s_lshl_b32 s68, s68, 11
  s_add_u32 s60, s60, s68
  s_lshr_b32 s68, s47, s4
  s_and_b32 s68, s68, 1
  s_lshl_b32 s68, s68, 13
  s_add_u32 s60, s60, s68
  s_add_u32 s60, s60, 786432
  v_lshlrev_b32 v55, 4, v0
  v_mov_b32 v57, 0
  v_cmp_eq_u32 s[62:63], 1, v3
  v_cmp_eq_u32 s[64:65], 2, v3
  v_cmp_eq_u32 s[66:67], 3, v3
  v_lshrrev_b32 v59, 4, v0
  v_mul_u32_u24 v59, 5120, v59
  v_bfe_u32 v4, v0, 3, 1
  v_lshl_add_u32 v59, v4, 9, v59
  v_lshl_add_u32 v59, v2, 4, v59
  s_mul_i32 s76, s78, 20480
  s_lshr_b32 s68, s74, 2
  s_lshl_b32 s68, s68, 10
  s_add_u32 s76, s76, s68
  s_and_b32 s68, s74, 3
  s_lshl_b32 s68, s68, 7
  s_add_u32 s76, s76, s68
  s_add_u32 s76, s76, 2228224
  s_lshl_b32 s72, s78, 9
  s_lshl4_add_u32 s72, s74, s72
  s_add_u32 s72, s72, 2752512
  s_mul_i32 s75, s4, 20
  s_add_u32 s75, s75, s74
  s_lshl_b32 s75, s75, 8
  s_add_u32 s75, s75, 2768896
  s_cmp_lt_u32 s5, 24
  s_cselect_b32 s75, s75, 2809856
  s_mov_b32 s77, 0x3f80
  s_mov_b32 s71, 0x3f800000
  v_mov_b32 v14, s30
  v_mov_b32 v15, s31
  s_mul_i32 s61, s74, 98304
  s_lshl_b32 s68, s78, 7
  s_add_u32 s61, s61, s68
  v_mov_b32 v1, 0
  s_mov_b32 s70, 200007
L_spin_57:
  ds_read_b32 v4, v1 offset:668
  s_waitcnt lgkmcnt(0)
  v_cmp_gt_u32 vcc, 1, v4
  s_nop 0
  s_cbranch_vccz L_sdone_58
  s_sleep 1
  s_sub_u32 s70, s70, 1
  s_cbranch_scc0 L_spin_57
L_sdone_58:
  s_add_u32 m0, s79, 0
  s_nop 0
  buffer_load_dwordx4 v62, s[12:15], s61 offen nt lds
  s_add_u32 m0, s79, 4096
  s_nop 0
  buffer_load_dwordx4 v62, s[16:19], s61 offen nt lds
  s_add_u32 s61, s61, 24576
  s_add_u32 m0, s79, 1024
  s_nop 0
  buffer_load_dwordx4 v62, s[12:15], s61 offen nt lds
  s_add_u32 m0, s79, 5120
  s_nop 0
  buffer_load_dwordx4 v62, s[16:19], s61 offen nt lds
  s_add_u32 s61, s61, 24576
  s_add_u32 m0, s79, 2048
  s_nop 0
  buffer_load_dwordx4 v62, s[12:15], s61 offen nt lds
  s_add_u32 m0, s79, 6144
  s_nop 0
  buffer_load_dwordx4 v62, s[16:19], s61 offen nt lds
  s_add_u32 s61, s61, 24576
  s_add_u32 m0, s79, 3072
  s_nop 0
  buffer_load_dwordx4 v62, s[12:15], s61 offen nt lds
  s_add_u32 m0, s79, 7168
  s_nop 0
  buffer_load_dwordx4 v62, s[16:19], s61 offen nt lds
  global_load_ushort v56, v61, s[36:37]
  s_add_u32 s68, s76, 917504
  s_mov_b32 exec_lo, 0x01010101
  s_mov_b32 exec_hi, 0x01010101
  buffer_load_dword v106, v54, s[32:35], s75 offen sc1
  s_mov_b64 exec, 1
  buffer_load_dword v107, v55, s[32:35], s72 offen sc1
  s_mov_b64 exec, -1
  s_setprio 3
  s_waitcnt vmcnt(2)
  buffer_load_dwordx4 v[96:99], v55, s[24:27], s60 offen sc1
  buffer_load_dwordx4 v[100:103], v55, s[24:27], s60 offen offset:1024 sc1
  ds_read_b64_tr_b16 v[64:65], v58 offset:8704
  ds_read_b64_tr_b16 v[66:67], v58 offset:10752
  ds_read_b64_tr_b16 v[68:69], v58 offset:8736
  ds_read_b64_tr_b16 v[70:71], v58 offset:10784
  ds_read_b64_tr_b16 v[72:73], v58 offset:8768
  ds_read_b64_tr_b16 v[74:75], v58 offset:10816
  ds_read_b64_tr_b16 v[76:77], v58 offset:8800
  ds_read_b64_tr_b16 v[78:79], v58 offset:10848
  ds_read_b64_tr_b16 v[80:81], v58 offset:12800
  ds_read_b64_tr_b16 v[82:83], v58 offset:14848
  ds_read_b64_tr_b16 v[84:85], v58 offset:12832
  ds_read_b64_tr_b16 v[86:87], v58 offset:14880
  ds_read_b64_tr_b16 v[88:89], v58 offset:12864
  ds_read_b64_tr_b16 v[90:91], v58 offset:14912
  ds_read_b64_tr_b16 v[92:93], v58 offset:12896
  ds_read_b64_tr_b16 v[94:95], v58 offset:14944
  v_mov_b32 v8, 0x3f803f80
  v_mov_b32 v9, 0x3f803f80
  v_mov_b32 v10, 0x3f803f80
  v_mov_b32 v11, 0x3f803f80
  s_waitcnt lgkmcnt(0)
  s_nop 0
  v_mfma_f32_16x16x32_bf16 v[16:19], v[8:11], v[64:67], 0
  v_mfma_f32_16x16x32_bf16 v[20:23], v[8:11], v[68:71], 0
  v_mfma_f32_16x16x32_bf16 v[24:27], v[8:11], v[72:75], 0
  v_mfma_f32_16x16x32_bf16 v[28:31], v[8:11], v[76:79], 0
  v_mfma_f32_16x16x32_bf16 v[32:35], v[8:11], v[80:83], 0
  v_mfma_f32_16x16x32_bf16 v[36:39], v[8:11], v[84:87], 0
  v_mfma_f32_16x16x32_bf16 v[40:43], v[8:11], v[88:91], 0
  v_mfma_f32_16x16x32_bf16 v[44:47], v[8:11], v[92:95], 0
  v_mov_b32 v6, s30
  v_mov_b32 v7, s31
  v_mov_b32 v50, s30
  v_mov_b32 v51, s31
  s_add_u32 s68, s76, 917504
  v_cndmask_b32 v12, v16, v20, s[62:63]
  v_cndmask_b32 v12, v12, v24, s[64:65]
  v_cndmask_b32 v12, v12, v28, s[66:67]
  v_cndmask_b32 v13, v32, v36, s[62:63]
  v_cndmask_b32 v13, v13, v40, s[64:65]
  v_cndmask_b32 v13, v13, v44, s[66:67]
  v_lshlrev_b32 v4, 3, v0
  s_lshl_b32 s68, s73, 9
  v_add_u32 v5, s68, v4
  v_mov_b32 v8, 1
  ds_write_b64 v5, v[12:13] offset:1024
  s_mov_b64 exec, 1
  ds_add_rtn_u32 v9, v57, v8 offset:652
  s_mov_b64 exec, -1
  ds_read_b64 v[16:17], v4 offset:1024
  ds_read_b64 v[18:19], v4 offset:1536
  ds_read_b64 v[20:21], v4 offset:2048
  ds_read_b64 v[22:23], v4 offset:2560
  ds_read_b64 v[24:25], v4 offset:3072
  v_lshrrev_b32 v4, 4, v0
  v_lshlrev_b32 v4, 10, v4
  v_bfe_u32 v5, v0, 3, 1
  v_lshl_add_u32 v4, v5, 9, v4
  v_and_b32 v5, 7, v0
  v_lshl_add_u32 v4, v5, 4, v4
  s_lshl_b32 s68, s78, 12
  s_and_b32 s69, s5, 3
  s_lshl_b32 s69, s69, 7
  s_add_u32 s68, s68, s69
  s_add_u32 s68, s68, 3145728
  s_waitcnt lgkmcnt(0)
  v_readfirstlane_b32 s69, v9
  s_nop 0
  s_cmp_lg_u32 s69, 4
  s_cbranch_scc1 L_nocb
  v_pk_add_f32 v[16:17], v[16:17], v[18:19]
  v_pk_add_f32 v[20:21], v[20:21], v[22:23]
  v_pk_add_f32 v[16:17], v[16:17], v[24:25]
  v_pk_add_f32 v[12:13], v[16:17], v[20:21]
  buffer_store_dwordx4 v[12:15], v4, s[32:35], s68 offen
  s_cmp_lg_u32 s46, 1
  s_cbranch_scc1 L_slow_59
L_back_60:
L_nocb:
  v_mov_b32 v8, 0
  v_mov_b32 v9, 0
  v_mov_b32 v10, 0
  v_mov_b32 v11, 0
  v_lshlrev_b32 v56, 16, v56
  s_mov_b32 s70, 200007
  s_branch L_ypw0
L_spin_61:
  buffer_load_dwordx4 v[96:99], v55, s[24:27], s60 offen sc1
  buffer_load_dwordx4 v[100:103], v55, s[24:27], s60 offen offset:1024 sc1
L_ypw0:
  s_waitcnt vmcnt(0)
  v_cmp_ne_u64 vcc, s[30:31], v[98:99]
  v_cmp_ne_u64 s[20:21], s[30:31], v[102:103]
  s_nop 0
  s_or_b64 vcc, vcc, s[20:21]
  s_nop 0
  s_cbranch_vccz L_sdone_62
  s_sub_u32 s70, s70, 1
  s_cbranch_scc0 L_spin_61
L_sdone_62:
  v_dot2c_f32_bf16 v8, s77, v96
  v_dot2c_f32_bf16 v10, s77, v97
  v_dot2c_f32_bf16 v9, s71, v96
  v_dot2c_f32_bf16 v11, s71, v97
  v_dot2c_f32_bf16 v8, s77, v100
  v_dot2c_f32_bf16 v10, s77, v101
  v_dot2c_f32_bf16 v9, s71, v100
  v_dot2c_f32_bf16 v11, s71, v101
  s_nop 0
  v_permlane32_swap_b32 v8, v10
  s_nop 0
  v_permlane32_swap_b32 v9, v11
  v_add_f32 v8, v8, v10
  v_add_f32 v9, v9, v11
  s_nop 1
  v_permlane16_swap_b32 v8, v9
  v_add_f32 v8, v8, v9
  s_nop 1
  v_add_f32_dpp v8, v8, v8 row_ror:8 row_mask:0xf bank_mask:0xf
  v_cvt_pk_bf16_f32 v8, v57, v8
  v_add_f32 v12, v8, v56
  s_nop 1
  v_mov_b32_dpp v13, v12 quad_perm:[1,0,3,2] row_mask:0xf bank_mask:0xf
  v_cvt_pk_bf16_f32 v12, v12, v13
  v_lshlrev_b32 v48, 16, v12
  v_mul_f32 v49, v48, v48
  v_mov_b32_dpp v8, v12 row_newbcast:0 row_mask:0xf bank_mask:0xf
  v_mov_b32_dpp v9, v12 row_newbcast:2 row_mask:0xf bank_mask:0xf
  v_mov_b32_dpp v10, v12 row_newbcast:4 row_mask:0xf bank_mask:0xf
  v_mov_b32_dpp v11, v12 row_newbcast:6 row_mask:0xf bank_mask:0xf
  v_add_f32_dpp v48, v48, v48 quad_perm:[1,0,3,2] row_mask:0xf bank_mask:0xf
  v_add_f32_dpp v49, v49, v49 quad_perm:[1,0,3,2] row_mask:0xf bank_mask:0xf
  v_mfma_f32_16x16x32_bf16 v[16:19], v[8:11], v[64:67], 0
  v_add_f32_dpp v48, v48, v48 quad_perm:[2,3,0,1] row_mask:0xf bank_mask:0xf
  v_add_f32_dpp v49, v49, v49 quad_perm:[2,3,0,1] row_mask:0xf bank_mask:0xf
  v_mfma_f32_16x16x32_bf16 v[20:23], v[8:11], v[68:71], 0
  v_add_f32_dpp v48, v48, v48 row_half_mirror row_mask:0xf bank_mask:0xf
  v_add_f32_dpp v49, v49, v49 row_half_mirror row_mask:0xf bank_mask:0xf
  v_mfma_f32_16x16x32_bf16 v[24:27], v[8:11], v[72:75], 0
  v_mov_b32 v52, v48
  v_mov_b32 v53, v49
  v_mfma_f32_16x16x32_bf16 v[28:31], v[8:11], v[76:79], 0
  v_permlane16_swap_b32 v48, v52
  v_permlane16_swap_b32 v49, v53
  v_mfma_f32_16x16x32_bf16 v[32:35], v[8:11], v[80:83], 0
  v_add_f32 v48, v48, v52
  v_add_f32 v49, v49, v53
  v_mfma_f32_16x16x32_bf16 v[36:39], v[8:11], v[84:87], 0
  v_mov_b32 v52, v48
  v_mov_b32 v53, v49
  v_mfma_f32_16x16x32_bf16 v[40:43], v[8:11], v[88:91], 0
  v_permlane32_swap_b32 v48, v52
  v_permlane32_swap_b32 v49, v53
  v_mfma_f32_16x16x32_bf16 v[44:47], v[8:11], v[92:95], 0
  v_add_f32 v48, v48, v52
  v_add_f32 v49, v49, v53
  v_cndmask_b32 v4, v16, v20, s[62:63]
  v_cndmask_b32 v4, v4, v24, s[64:65]
  v_cndmask_b32 v4, v4, v28, s[66:67]
  v_cndmask_b32 v5, v32, v36, s[62:63]
  v_cndmask_b32 v5, v5, v40, s[64:65]
  s_nop 0
  v_cndmask_b32 v5, v5, v44, s[66:67]
  buffer_store_dwordx4 v[4:7], v59, s[32:35], s76 offen
  s_mov_b32 exec_lo, 0x1
  s_mov_b32 exec_hi, 0x0
  buffer_store_dwordx4 v[48:51], v55, s[32:35], s72 offen
  s_mov_b32 exec_lo, 0x550055
  s_mov_b32 exec_hi, 0x550055
  buffer_store_dwordx4 v[12:15], v54, s[32:35], s75 offen
  s_mov_b64 exec, -1
  s_cmp_lg_u32 s46, 1
  s_cbranch_scc1 L_slow_63
L_back_64:
  s_endpgm
L_post_wo:
  s_cmp_gt_u32 s5, 11
  s_cbranch_scc1 L_end
  s_cmp_eq_u32 s3, 3
  s_cbranch_scc1 L_end
  v_mov_b32 v57, 0
  s_cmp_eq_u32 s3, 1
  s_cbranch_scc1 L_hid
  s_barrier
  s_and_b32 s68, s4, 1
  s_lshl_b32 s68, s68, 2
  s_sub_u32 s68, 12, s68
  s_cmp_ge_u32 s5, s68
  s_cbranch_scc1 L_end
  s_mul_i32 s72, s4, 5
  s_add_u32 s72, s72, 1
  s_lshr_b32 s72, s72, 1
  s_lshr_b32 s68, s5, 2
  s_add_u32 s72, s72, s68
  s_and_b32 s73, s5, 3
  v_lshrrev_b32 v2, 1, v0
  v_lshlrev_b32 v2, 7, v2
  v_and_b32 v3, 1, v0
  v_lshl_add_u32 v96, v3, 4, v2
  s_lshl_b32 s10, s72, 15
  s_lshr_b32 s68, s47, s4
  s_and_b32 s68, s68, 1
  s_lshl_b32 s68, s68, 13
  s_add_u32 s10, s10, s68
  s_lshl_b32 s68, s73, 5
  s_add_u32 s10, s10, s68
  s_add_u32 s10, s10, 1048576
  s_add_u32 s11, s10, 4096
  s_add_u32 s12, s10, 16384
  v_lshrrev_b32 v4, 4, v0
  v_lshl_add_u32 v97, v3, 2, v4
  v_lshlrev_b32 v97, 1, v97
  v_lshlrev_b32 v99, 6, v4
  v_lshlrev_b32 v98, 4, v3
  s_mul_i32 s13, s4, 20
  s_add_u32 s13, s13, s72
  s_lshl_b32 s13, s13, 8
  s_lshl4_add_u32 s13, s73, s13
  s_add_u32 s13, s13, 2768896
  s_lshl2_add_u32 s14, s72, s73
  s_lshl_b32 s14, s14, 4
  s_mov_b32 s8, 0x30003
  s_mov_b32 s9, 0x30003
  s_mov_b32 s77, 0x3f80
  s_mov_b32 s71, 0x3f800000
  v_mov_b32 v8, 0
  v_mov_b32 v9, 0
  v_mov_b32 v10, 0
  v_mov_b32 v11, 0
  s_mov_b32 s64, s54
  s_mov_b32 s65, s55
  s_mov_b32 s66, 1280
  s_mov_b32 s67, 0x20000
  v_mov_b32 v1, 0
  s_mov_b32 s70, 200007
L_spin_65:
  ds_read_b32 v4, v1 offset:736
  s_waitcnt lgkmcnt(0)
  v_cmp_gt_u32 vcc, 1, v4
  s_nop 0
  s_cbranch_vccz L_sdone_66
  s_sleep 2
  s_sub_u32 s70, s70, 1
  s_cbranch_scc0 L_spin_65
L_sdone_66:
  s_sleep 18
  s_mov_b32 s16, s32
  s_mov_b32 s17, s33
  s_mov_b32 s18, 4194304
  s_mov_b32 s19, 0x20000
  s_mov_b32 s70, 200007
L_spin_67:
  buffer_load_dwordx4 v[4:7], v99, s[16:19], s13 offen sc1
  buffer_load_dwordx4 v[16:19], v96, s[24:27], s10 offen sc1
  buffer_load_dwordx4 v[20:23], v96, s[24:27], s11 offen sc1
  buffer_load_dwordx4 v[24:27], v96, s[24:27], s12 offen sc1
  s_waitcnt vmcnt(0)
  v_cmp_ne_u64 vcc, s[30:31], v[6:7]
  v_cmp_ne_u64 s[20:21], s[30:31], v[18:19]
  v_cmp_ne_u64 s[22:23], s[30:31], v[22:23]
  s_or_b64 vcc, vcc, s[20:21]
  v_cmp_ne_u64 s[20:21], s[30:31], v[26:27]
  s_or_b64 vcc, vcc, s[22:23]
  s_or_b64 vcc, vcc, s[20:21]
  s_nop 0
  s_cbranch_vccz L_sdone_68
  s_and_b32 s99, s70, 7
  s_cmp_eq_u32 s46, 1
  s_cselect_b32 s99, 1, s99
  s_cmp_lg_u32 s99, 0
  s_cselect_b32 s16, s32, s24
  s_cselect_b32 s17, s33, s25
  s_sub_u32 s70, s70, 1
  s_cbranch_scc0 L_spin_67
L_sdone_68:
  v_dot2c_f32_bf16 v8, s77, v16
  v_dot2c_f32_bf16 v10, s77, v17
  v_dot2c_f32_bf16 v9, s71, v16
  v_dot2c_f32_bf16 v11, s71, v17
  v_dot2c_f32_bf16 v8, s77, v20
  v_dot2c_f32_bf16 v10, s77, v21
  v_dot2c_f32_bf16 v9, s71, v20
  v_dot2c_f32_bf16 v11, s71, v21
  v_dot2c_f32_bf16 v8, s77, v24
  v_dot2c_f32_bf16 v10, s77, v25
  v_dot2c_f32_bf16 v9, s71, v24
  v_dot2c_f32_bf16 v11, s71, v25
  v_lshrrev_b32 v58, v98, v4
  v_permlane32_swap_b32 v8, v10
  s_nop 0
  v_permlane32_swap_b32 v9, v11
  v_add_f32 v8, v8, v10
  v_add_f32 v9, v9, v11
  v_lshlrev_b32 v58, 16, v58
  s_nop 0
  v_permlane16_swap_b32 v8, v9
  v_add_f32 v8, v8, v9
  s_nop 1
  v_add_f32_dpp v8, v8, v8 row_ror:8 row_mask:0xf bank_mask:0xf
  s_nop 1
  v_add_f32_dpp v8, v8, v8 row_ror:4 row_mask:0xf bank_mask:0xf
  s_nop 1
  v_add_f32_dpp v8, v8, v8 quad_perm:[2,3,0,1] row_mask:0xf bank_mask:0xf
  v_cvt_pk_bf16_f32 v8, v57, v8
  v_add_f32 v8, v8, v58
  v_cvt_pk_bf16_f32 v8, v8, v8
  s_mov_b64 exec, s[8:9]
  buffer_store_short v8, v97, s[64:67], s14 offen
  s_cmp_lg_u32 s14, 0
  s_cbranch_scc1 L_fin_exit
  s_mov_b64 exec, 1
  v_mov_b32 v4, s30
  v_mov_b32 v5, s31
  s_mov_b32 s68, 917504
  buffer_store_dwordx2 v[4:5], v57, s[24:27], s68 offen
L_fin_exit:
  s_endpgm
L_hid:
  s_mul_i32 s72, s4, 12
  s_add_u32 s72, s72, s5
  v_lshrrev_b32 v4, 5, v0
  v_and_b32 v2, 7, v0
  v_lshl_add_u32 v62, v4, 3, v2
  v_lshlrev_b32 v62, 1, v62
  v_lshlrev_b32 v63, 2, v2
  v_lshlrev_b32 v60, 4, v0
  v_and_b32 v3, 31, v0
  v_lshlrev_b32 v61, 4, v3
  s_lshr_b32 s65, s72, 2
  s_lshl_b32 s65, s65, 9
  s_add_u32 s65, s65, 2752512
  s_mul_i32 s60, s72, 5120
  s_add_u32 s60, s60, 2228224
  s_add_u32 s61, s60, 4096
  v_mov_b32 v148, 0
  v_mov_b32 v149, 0
  v_mov_b32 v150, s30
  v_mov_b32 v151, s31
  v_mov_b32 v59, 1
  s_lshl_b32 s62, s72, 10
  s_add_u32 s62, s62, 3145728
  s_mov_b32 s78, 1
  s_barrier
  s_mov_b32 s16, s32
  s_mov_b32 s17, s33
  s_mov_b32 s18, 4194304
  s_mov_b32 s19, 0x20000
  s_mov_b32 s70, 200007
L_spin_69:
  buffer_load_dwordx4 v[16:19], v60, s[16:19], s62 offen offset:0 sc1
  s_mov_b32 exec_lo, 0xfffff
  s_mov_b32 exec_hi, 0xfffff
  buffer_load_dwordx4 v[148:151], v61, s[16:19], s65 offen sc1
  s_mov_b64 exec, -1
  buffer_load_dwordx4 v[128:131], v60, s[16:19], s60 offen offset:0 sc1
  buffer_load_dwordx4 v[132:135], v60, s[16:19], s60 offen offset:1024 sc1
  buffer_load_dwordx4 v[136:139], v60, s[16:19], s60 offen offset:2048 sc1
  buffer_load_dwordx4 v[140:143], v60, s[16:19], s60 offen offset:3072 sc1
  buffer_load_dwordx4 v[144:147], v60, s[16:19], s61 offen offset:0 sc1
  s_waitcnt vmcnt(0)
  v_cmp_ne_u64 vcc, s[30:31], v[18:19]
  s_nop 0
  s_cbranch_vccz L_sdone_70
  s_and_b32 s99, s70, 7
  s_cmp_eq_u32 s46, 1
  s_cselect_b32 s99, 1, s99
  s_cmp_lg_u32 s99, 0
  s_cselect_b32 s16, s32, s24
  s_cselect_b32 s17, s33, s25
  s_sub_u32 s70, s70, 1
  s_cbranch_scc0 L_spin_69
L_sdone_70:
  s_cmp_lg_u32 s46, 1
  s_cbranch_scc1 L_nopre
  s_mov_b32 exec_lo, 0xfffff
  s_mov_b32 exec_hi, 0xfffff
  buffer_load_dwordx4 v[148:151], v61, s[32:35], s65 offen sc1
  s_mov_b64 exec, -1
  buffer_load_dwordx4 v[128:131], v60, s[32:35], s60 offen offset:0 sc1
  buffer_load_dwordx4 v[132:135], v60, s[32:35], s60 offen offset:1024 sc1
  buffer_load_dwordx4 v[136:139], v60, s[32:35], s60 offen offset:2048 sc1
  buffer_load_dwordx4 v[140:143], v60, s[32:35], s60 offen offset:3072 sc1
  buffer_load_dwordx4 v[144:147], v60, s[32:35], s61 offen offset:0 sc1
L_nopre:
  v_mov_b32 v40, v16
  v_mov_b32 v41, v17
  s_nop 0
  v_add_f32_dpp v40, v40, v40 row_ror:8 row_mask:0xf bank_mask:0xf
  v_add_f32_dpp v41, v41, v41 row_ror:8 row_mask:0xf bank_mask:0xf
  v_mov_b32 v42, v40
  v_mov_b32 v43, v41
  s_nop 0
  v_permlane16_swap_b32 v40, v42
  v_permlane16_swap_b32 v41, v43
  v_add_f32 v40, v40, v42
  v_add_f32 v41, v41, v43
  v_cmp_ne_u64 vcc, s[30:31], v[150:151]
  v_cmp_ne_u64 s[20:21], s[30:31], v[130:131]
  v_cmp_ne_u64 s[22:23], s[30:31], v[134:135]
  s_or_b64 vcc, vcc, s[20:21]
  v_cmp_ne_u64 s[20:21], s[30:31], v[138:139]
  s_or_b64 vcc, vcc, s[22:23]
  v_cmp_ne_u64 s[22:23], s[30:31], v[142:143]
  s_or_b64 vcc, vcc, s[20:21]
  v_cmp_ne_u64 s[20:21], s[30:31], v[146:147]
  s_or_b64 vcc, vcc, s[22:23]
  s_or_b64 vcc, vcc, s[20:21]
  s_nop 0
  s_cbranch_vccz L_paok
  s_cmp_lg_u32 s46, 1
  s_cbranch_scc1 L_paslow
  s_mov_b32 s70, 200007
L_fp_71:
  s_mov_b32 exec_lo, 0xfffff
  s_mov_b32 exec_hi, 0xfffff
  buffer_load_dwordx4 v[148:151], v61, s[32:35], s65 offen sc1
  s_mov_b64 exec, -1
  buffer_load_dwordx4 v[128:131], v60, s[32:35], s60 offen offset:0 sc1
  buffer_load_dwordx4 v[132:135], v60, s[32:35], s60 offen offset:1024 sc1
  buffer_load_dwordx4 v[136:139], v60, s[32:35], s60 offen offset:2048 sc1
  buffer_load_dwordx4 v[140:143], v60, s[32:35], s60 offen offset:3072 sc1
  buffer_load_dwordx4 v[144:147], v60, s[32:35], s61 offen offset:0 sc1
  v_cmp_ne_u64 vcc, s[30:31], v[150:151]
  v_cmp_ne_u64 s[20:21], s[30:31], v[130:131]
  v_cmp_ne_u64 s[22:23], s[30:31], v[134:135]
  s_or_b64 vcc, vcc, s[20:21]
  v_cmp_ne_u64 s[20:21], s[30:31], v[138:139]
  s_or_b64 vcc, vcc, s[22:23]
  v_cmp_ne_u64 s[22:23], s[30:31], v[142:143]
  s_or_b64 vcc, vcc, s[20:21]
  v_cmp_ne_u64 s[20:21], s[30:31], v[146:147]
  s_or_b64 vcc, vcc, s[22:23]
  s_or_b64 vcc, vcc, s[20:21]
  s_nop 0
  s_cbranch_vccz L_paok
  s_waitcnt vmcnt(12)
  s_sub_u32 s70, s70, 1
  s_cbranch_scc0 L_fp_71
  s_branch L_paok
L_paslow:
  s_mov_b32 s16, s32
  s_mov_b32 s17, s33
  s_mov_b32 s18, 4194304
  s_mov_b32 s19, 0x20000
  s_mov_b32 s70, 200007
L_spin_72:
  s_mov_b32 exec_lo, 0xfffff
  s_mov_b32 exec_hi, 0xfffff
  buffer_load_dwordx4 v[148:151], v61, s[16:19], s65 offen sc1
  s_mov_b64 exec, -1
  buffer_load_dwordx4 v[128:131], v60, s[16:19], s60 offen offset:0 sc1
  buffer_load_dwordx4 v[132:135], v60, s[16:19], s60 offen offset:1024 sc1
  buffer_load_dwordx4 v[136:139], v60, s[16:19], s60 offen offset:2048 sc1
  buffer_load_dwordx4 v[140:143], v60, s[16:19], s60 offen offset:3072 sc1
  buffer_load_dwordx4 v[144:147], v60, s[16:19], s61 offen offset:0 sc1
  s_waitcnt vmcnt(0)
  v_cmp_ne_u64 vcc, s[30:31], v[150:151]
  v_cmp_ne_u64 s[20:21], s[30:31], v[130:131]
  v_cmp_ne_u64 s[22:23], s[30:31], v[134:135]
  s_or_b64 vcc, vcc, s[20:21]
  v_cmp_ne_u64 s[20:21], s[30:31], v[138:139]
  s_or_b64 vcc, vcc, s[22:23]
  v_cmp_ne_u64 s[22:23], s[30:31], v[142:143]
  s_or_b64 vcc, vcc, s[20:21]
  v_cmp_ne_u64 s[20:21], s[30:31], v[146:147]
  s_or_b64 vcc, vcc, s[22:23]
  s_or_b64 vcc, vcc, s[20:21]
  s_nop 0
  s_cbranch_vccz L_sdone_73
  s_and_b32 s99, s70, 7
  s_cmp_eq_u32 s46, 1
  s_cselect_b32 s99, 1, s99
  s_cmp_lg_u32 s99, 0
  s_cselect_b32 s16, s32, s24
  s_cselect_b32 s17, s33, s25
  s_sub_u32 s70, s70, 1
  s_cbranch_scc0 L_spin_72
L_sdone_73:
L_paok:
  v_add_f32_dpp v36, v148, v148 quad_perm:[1,0,3,2] row_mask:0xf bank_mask:0xf
  v_add_f32_dpp v37, v149, v149 quad_perm:[1,0,3,2] row_mask:0xf bank_mask:0xf
  v_pk_add_f32 v[8:9], v[128:129], v[132:133]
  v_add_f32_dpp v36, v36, v36 quad_perm:[2,3,0,1] row_mask:0xf bank_mask:0xf
  v_add_f32_dpp v37, v37, v37 quad_perm:[2,3,0,1] row_mask:0xf bank_mask:0xf
  v_pk_add_f32 v[10:11], v[136:137], v[140:141]
  v_add_f32_dpp v36, v36, v36 row_half_mirror row_mask:0xf bank_mask:0xf
  v_add_f32_dpp v37, v37, v37 row_half_mirror row_mask:0xf bank_mask:0xf
  v_pk_add_f32 v[8:9], v[8:9], v[144:145]
  v_add_f32_dpp v22, v36, v36 row_mirror row_mask:0xf bank_mask:0xf
  v_add_f32_dpp v23, v37, v37 row_mirror row_mask:0xf bank_mask:0xf
  v_add_f32_dpp v36, v36, v36 row_mirror row_mask:0xf bank_mask:0xf
  v_add_f32_dpp v37, v37, v37 row_mirror row_mask:0xf bank_mask:0xf
  v_pk_add_f32 v[8:9], v[8:9], v[10:11]
  v_permlane16_swap_b32 v36, v22
  v_permlane16_swap_b32 v37, v23
  v_pk_add_f32 v[36:37], v[36:37], v[22:23]
  v_add_f32_dpp v10, v8, v8 row_ror:8 row_mask:0xf bank_mask:0xf
  v_mul_f32 v20, 0x3acccccd, v36
  v_mul_f32 v21, 0x3acccccd, v37
  v_add_f32_dpp v11, v9, v9 row_ror:8 row_mask:0xf bank_mask:0xf
  v_fma_f32 v21, -v20, v20, v21
  v_add_f32_dpp v8, v8, v8 row_ror:8 row_mask:0xf bank_mask:0xf
  v_max_f32 v21, 0, v21
  v_add_f32_dpp v9, v9, v9 row_ror:8 row_mask:0xf bank_mask:0xf
  v_cvt_pk_bf16_f32 v21, v57, v21
  v_cvt_pk_bf16_f32 v20, v57, v20
  v_add_f32 v21, 0x3727c5ac, v21
  v_permlane16_swap_b32 v8, v10
  v_cvt_pk_bf16_f32 v21, v57, v21
  v_permlane16_swap_b32 v9, v11
  v_sqrt_f32 v21, v21
  v_pk_add_f32 v[8:9], v[8:9], v[10:11]
  v_cvt_pk_bf16_f32 v21, v57, v21
  v_fma_f32 v8, -v20, v40, v8
  v_rcp_f32 v21, v21
  v_fma_f32 v9, -v20, v41, v9
  v_mul_f32 v8, v8, v21
  v_mul_f32 v9, v9, v21
  v_cvt_pk_bf16_f32 v8, v57, v8
  v_mul_f32 v12, 0xbfb8aa3b, v8
  v_exp_f32 v12, v12
  v_cvt_pk_bf16_f32 v9, v57, v9
  v_add_f32 v12, 1.0, v12
  v_rcp_f32 v12, v12
  s_nop 0
  v_mul_f32 v8, v8, v12
  v_cvt_pk_bf16_f32 v8, v57, v8
  v_mul_f32 v8, v8, v9
  v_cvt_pk_bf16_f32 v8, v8, v8
  ds_write_b16 v62, v8 offset:704
  ds_write_b32 v63, v59 offset:736
  s_endpgm
L_f2:
  s_mov_b32 s8, s52
  s_mov_b32 s9, s53
  s_mov_b32 s10, 1966080
  s_mov_b32 s11, 0x20000
  s_mul_i32 s72, s4, 12
  s_add_u32 s72, s72, s5
  v_mov_b32 v57, 0
  s_sub_u32 s68, s3, 7
  s_lshl_b32 s69, s68, 8
  v_lshlrev_b32 v58, 2, v0
  v_add_u32 v58, s69, v58
  v_lshrrev_b32 v2, 4, v0
  v_lshl_add_u32 v2, s68, 2, v2
  v_mul_u32_u24 v3, 52, v2
  v_lshrrev_b32 v3, 8, v3
  v_mul_u32_u24 v4, 5, v3
  v_sub_u32 v4, v2, v4
  v_cmp_lt_u32 vcc, 2, v4
  v_lshlrev_b32 v3, 1, v3
  s_nop 0
  v_addc_co_u32 v3, vcc, 0, v3, vcc
  v_lshrrev_b32 v3, v3, s47
  v_and_b32 v3, 1, v3
  v_lshlrev_b32 v116, 15, v2
  v_lshl_add_u32 v116, v3, 13, v116
  v_bfe_u32 v3, v0, 1, 3
  v_lshl_add_u32 v116, v3, 4, v116
  s_lshr_b32 s79, s72, 6
  s_lshl_b32 s79, s79, 14
  s_and_b32 s68, s72, 63
  s_lshl_b32 s68, s68, 7
  s_add_u32 s79, s79, s68
  s_add_u32 s79, s79, 1048576
  s_mov_b32 s60, 0x05040100
  s_mov_b32 s61, 0x07060302
  s_mul_i32 s62, s72, 20480
  s_barrier
  buffer_load_dword v64, v58, s[8:11], s62 offen offset:0 nt
  buffer_load_dword v65, v58, s[8:11], s62 offen offset:1280 nt
  buffer_load_dword v66, v58, s[8:11], s62 offen offset:2560 nt
  s_add_u32 s62, s62, 3840
  buffer_load_dword v67, v58, s[8:11], s62 offen offset:0 nt
  buffer_load_dword v68, v58, s[8:11], s62 offen offset:1280 nt
  buffer_load_dword v69, v58, s[8:11], s62 offen offset:2560 nt
  s_add_u32 s62, s62, 3840
  buffer_load_dword v70, v58, s[8:11], s62 offen offset:0 nt
  buffer_load_dword v71, v58, s[8:11], s62 offen offset:1280 nt
  buffer_load_dword v72, v58, s[8:11], s62 offen offset:2560 nt
  s_add_u32 s62, s62, 3840
  buffer_load_dword v73, v58, s[8:11], s62 offen offset:0 nt
  buffer_load_dword v74, v58, s[8:11], s62 offen offset:1280 nt
  buffer_load_dword v75, v58, s[8:11], s62 offen offset:2560 nt
  s_add_u32 s62, s62, 3840
  buffer_load_dword v76, v58, s[8:11], s62 offen offset:0 nt
  buffer_load_dword v77, v58, s[8:11], s62 offen offset:1280 nt
  buffer_load_dword v78, v58, s[8:11], s62 offen offset:2560 nt
  s_add_u32 s62, s62, 3840
  buffer_load_dword v79, v58, s[8:11], s62 offen offset:0 nt
  s_barrier
  s_waitcnt vmcnt(0)
  v_perm_b32 v80, v65, v64, s60
  v_perm_b32 v88, v65, v64, s61
  v_perm_b32 v81, v67, v66, s60
  v_perm_b32 v89, v67, v66, s61
  v_perm_b32 v82, v69, v68, s60
  v_perm_b32 v90, v69, v68, s61
  v_perm_b32 v83, v71, v70, s60
  v_perm_b32 v91, v71, v70, s61
  v_perm_b32 v84, v73, v72, s60
  v_perm_b32 v92, v73, v72, s61
  v_perm_b32 v85, v75, v74, s60
  v_perm_b32 v93, v75, v74, s61
  v_perm_b32 v86, v77, v76, s60
  v_perm_b32 v94, v77, v76, s61
  v_perm_b32 v87, v79, v78, s60
  v_perm_b32 v95, v79, v78, s61
  v_mov_b32 v16, 0
  v_mov_b32 v17, 0
  v_mov_b32 v18, 0
  v_mov_b32 v19, 0
  s_mov_b32 s66, 0x55555555
  s_mov_b32 s67, 0x55555555
  v_mov_b32 v6, s30
  v_mov_b32 v7, s31
  v_and_b32 v9, 15, v0
  v_lshlrev_b32 v9, 2, v9
  v_mov_b32 v8, 0
  s_mov_b32 s64, 0xff00ff00
  s_mov_b32 s65, 0xff00ff00
  s_mov_b32 s70, 1600056
  s_waitcnt lgkmcnt(0)
L_f2poll:
  ds_read_b32 v8, v9 offset:704
  s_waitcnt lgkmcnt(4)
  v_cmp_eq_u32 vcc, 0, v8
  s_sub_u32 s70, s70, 1
  s_cbranch_scc1 L_f2go
  s_and_b64 vcc, vcc, s[64:65]
  s_cbranch_scc1 L_f2poll
L_f2go:
  v_dot2c_f32_bf16_dpp v16, v8, v80 row_newbcast:0 row_mask:0xf bank_mask:0xf
  v_dot2c_f32_bf16_dpp v17, v8, v88 row_newbcast:0 row_mask:0xf bank_mask:0xf
  v_dot2c_f32_bf16_dpp v18, v8, v81 row_newbcast:1 row_mask:0xf bank_mask:0xf
  v_dot2c_f32_bf16_dpp v19, v8, v89 row_newbcast:1 row_mask:0xf bank_mask:0xf
  v_dot2c_f32_bf16_dpp v16, v8, v82 row_newbcast:2 row_mask:0xf bank_mask:0xf
  v_dot2c_f32_bf16_dpp v17, v8, v90 row_newbcast:2 row_mask:0xf bank_mask:0xf
  v_dot2c_f32_bf16_dpp v18, v8, v83 row_newbcast:3 row_mask:0xf bank_mask:0xf
  v_dot2c_f32_bf16_dpp v19, v8, v91 row_newbcast:3 row_mask:0xf bank_mask:0xf
  v_dot2c_f32_bf16_dpp v16, v8, v84 row_newbcast:4 row_mask:0xf bank_mask:0xf
  v_dot2c_f32_bf16_dpp v17, v8, v92 row_newbcast:4 row_mask:0xf bank_mask:0xf
  v_dot2c_f32_bf16_dpp v18, v8, v85 row_newbcast:5 row_mask:0xf bank_mask:0xf
  v_dot2c_f32_bf16_dpp v19, v8, v93 row_newbcast:5 row_mask:0xf bank_mask:0xf
  v_dot2c_f32_bf16_dpp v16, v8, v86 row_newbcast:6 row_mask:0xf bank_mask:0xf
  v_dot2c_f32_bf16_dpp v17, v8, v94 row_newbcast:6 row_mask:0xf bank_mask:0xf
  v_dot2c_f32_bf16_dpp v18, v8, v87 row_newbcast:7 row_mask:0xf bank_mask:0xf
  v_dot2c_f32_bf16_dpp v19, v8, v95 row_newbcast:7 row_mask:0xf bank_mask:0xf
  s_nop 2
  v_pk_add_f32 v[16:17], v[16:17], v[18:19]
  v_cvt_pk_bf16_f32 v4, v16, v17
  s_nop 1
  v_mov_b32_dpp v5, v4 quad_perm:[1,0,3,2] row_mask:0xf bank_mask:0xf
  s_mov_b64 exec, s[66:67]
  buffer_store_dwordx4 v[4:7], v116, s[24:27], s79 offen sc1
L_end:
  s_endpgm
L_slow_25:
  s_mov_b32 exec_lo, 0xffffffff
  s_mov_b32 exec_hi, 0xffff
  buffer_store_dwordx4 v[4:7], v13, s[24:27], s74 offen sc1
  s_mov_b64 exec, -1
  s_nop 1
  s_branch L_back_26
L_slow_41:
  s_mov_b32 exec_lo, 0x1
  s_mov_b32 exec_hi, 0x0
  buffer_store_dwordx4 v[2:5], v1, s[24:27], s68 offen sc1
  s_mov_b64 exec, -1
  s_nop 1
  s_branch L_back_42
L_slow_59:
  buffer_store_dwordx4 v[12:15], v4, s[24:27], s68 offen sc1
  s_nop 1
  s_branch L_back_60
L_slow_63:
  buffer_store_dwordx4 v[4:7], v59, s[24:27], s76 offen sc1
  s_mov_b32 exec_lo, 0x1
  s_mov_b32 exec_hi, 0x0
  buffer_store_dwordx4 v[48:51], v55, s[24:27], s72 offen sc1
  s_mov_b32 exec_lo, 0x550055
  s_mov_b32 exec_hi, 0x550055
  buffer_store_dwordx4 v[12:15], v54, s[24:27], s75 offen sc1
  s_mov_b64 exec, -1
  s_nop 1
  s_branch L_back_64
L_codeend:
.section .rodata,"a"
.p2align 6
.amdhsa_kernel sequential_preLN__sliding_block_cached__glu_gated_swiglu__decode_kernel
  .amdhsa_next_free_vgpr 168
  .amdhsa_next_free_sgpr 100
  .amdhsa_accum_offset 168
  .amdhsa_group_segment_fixed_size 0
  .amdhsa_kernarg_size 96
  .amdhsa_user_sgpr_count 2
  .amdhsa_user_sgpr_kernarg_segment_ptr 1
  .amdhsa_system_sgpr_workgroup_id_x 1
.end_amdhsa_kernel
```

```asm
; @launch grid=(256,1,1) block=(768,1,1) lds=57856
.amdgcn_target "amdgcn-amd-amdhsa--gfx950"
.text
.globl sequential_preLN__sliding_block_cached__glu_gated_swiglu__decode_kernel
.p2align 8
.type sequential_preLN__sliding_block_cached__glu_gated_swiglu__decode_kernel,@function
sequential_preLN__sliding_block_cached__glu_gated_swiglu__decode_kernel:
  s_load_dwordx2 s[8:9], s[0:1], 8
  s_lshr_b32 s79, s2, 6
  s_cmp_gt_u32 s79, 3
  s_cbranch_scc1 L_end
  v_readfirstlane_b32 s3, v0
  s_and_b32 s4, s2, 7
  s_lshl2_add_u32 s6, s4, s79
  s_bfe_u32 s7, s2, 0x30003
  s_lshr_b32 s73, s3, 6
  s_cmp_gt_u32 s73, 7
  s_cbranch_scc1 L_helper0
  s_lshl_b32 s60, s6, 9
  s_add_u32 s60, s60, s7
  s_addk_i32 s60, 448
  s_mulk_i32 s60, 24576
  v_lshlrev_b32 v3, 4, v0
  v_lshrrev_b32 v2, 3, v0
  v_lshl_add_u32 v1, v2, 8, v3
  s_lshl_b32 s10, 3, 27
  s_mov_b32 s11, 0x20000
  s_waitcnt lgkmcnt(0)
  buffer_load_dwordx4 v[16:19], v1, s[8:11], s60 offen offset:0 nt
  buffer_load_dwordx4 v[20:23], v1, s[8:11], s60 offen offset:128 nt
  buffer_load_dwordx4 v[24:27], v1, s[8:11], s60 offen offset:256 nt
  s_branch L_stream0
L_helper0:
  s_load_dwordx16 s[36:51], s[0:1], 0
  s_load_dwordx8 s[52:59], s[0:1], 64
  v_and_b32 v0, 63, v0
  s_sub_u32 s3, s73, 8
  s_cmp_lg_u32 s3, 3
  s_cbranch_scc1 L_helper
  s_getpc_b64 s[20:21]
L_pc0:
  v_lshlrev_b32 v8, 7, v0
  v_add_u32 v9, 8192, v8
  v_min_u32 v9, L_codeend-L_pc0-4, v9
  global_load_dword v10, v8, s[20:21]
  global_load_dword v11, v9, s[20:21]
  v_add_u32 v9, 16384, v8
  v_min_u32 v9, L_codeend-L_pc0-4, v9
  global_load_dword v30, v9, s[20:21]
  v_lshlrev_b32 v1, 3, v0
  v_mov_b32 v4, 0
  v_mov_b32 v5, 0
  ds_write_b64 v1, v[4:5] offset:384
  s_branch L_helper
L_stream0:
  s_load_dwordx16 s[36:51], s[0:1], 0
  s_load_dwordx8 s[52:59], s[0:1], 64
  v_and_b32 v0, 63, v0
  s_add_u32 s3, s73, 4
  v_and_b32 v3, 0x70, v3
  s_waitcnt lgkmcnt(0)
  s_add_u32 s61, s60, 196608
  s_barrier
  s_waitcnt vmcnt(2)
  buffer_load_dwordx4 v[28:31], v1, s[8:11], s61 offen offset:0 nt
  s_load_dwordx2 s[28:29], s[58:59], 917504
  s_mov_b32 s24, s58
  s_mov_b32 s25, s59
  s_mov_b32 s26, 4194304
  s_mov_b32 s27, 0x20000
  s_add_u32 s32, s58, 4194304
  s_addc_u32 s33, s59, 0
  s_mov_b32 s34, 4194304
  s_mov_b32 s35, 0x20000
  s_lshl3_add_u32 s71, s6, s7
  s_mul_i32 s5, s79, 5
  s_mul_i32 s47, s79, 3
  s_add_u32 s47, s47, 15
  s_cmp_lt_u32 s7, 5
  s_cselect_b32 s5, s5, s47
  s_add_u32 s5, s5, s7
  s_mov_b32 s12, s40
  s_mov_b32 s13, s41
  s_mov_b32 s14, 402653184
  s_mov_b32 s15, 0x20000
  s_waitcnt vmcnt(2)
  buffer_load_dwordx4 v[32:35], v1, s[8:11], s61 offen offset:128 nt
  s_waitcnt vmcnt(2)
  buffer_load_dwordx4 v[36:39], v1, s[8:11], s61 offen offset:256 nt
  s_add_u32 s62, s61, 196608
  s_waitcnt vmcnt(2)
  buffer_load_dwordx4 v[40:43], v1, s[8:11], s62 offen offset:0 nt
  s_waitcnt vmcnt(2)
  buffer_load_dwordx4 v[44:47], v1, s[8:11], s62 offen offset:128 nt
  s_waitcnt vmcnt(2)
  buffer_load_dwordx4 v[48:51], v1, s[8:11], s62 offen offset:256 nt
  s_add_u32 s63, s62, 196608
  s_waitcnt vmcnt(2)
  buffer_load_dwordx4 v[52:55], v1, s[8:11], s63 offen offset:0 nt
  s_waitcnt vmcnt(2)
  buffer_load_dwordx4 v[56:59], v1, s[8:11], s63 offen offset:128 nt
  s_waitcnt vmcnt(2)
  buffer_load_dwordx4 v[60:63], v1, s[8:11], s63 offen offset:256 nt
  s_add_u32 s64, s63, 196608
  s_waitcnt vmcnt(2)
  buffer_load_dwordx4 v[64:67], v1, s[8:11], s64 offen offset:0 nt
  s_waitcnt vmcnt(2)
  buffer_load_dwordx4 v[68:71], v1, s[8:11], s64 offen offset:128 nt
  s_waitcnt vmcnt(2)
  buffer_load_dwordx4 v[72:75], v1, s[8:11], s64 offen offset:256 nt
  s_add_u32 s65, s64, 196608
  s_waitcnt vmcnt(2)
  buffer_load_dwordx4 v[76:79], v1, s[8:11], s65 offen offset:0 nt
  s_waitcnt vmcnt(2)
  buffer_load_dwordx4 v[80:83], v1, s[8:11], s65 offen offset:128 nt
  s_waitcnt vmcnt(2)
  buffer_load_dwordx4 v[84:87], v1, s[8:11], s65 offen offset:256 nt
  s_memrealtime s[76:77]
  s_waitcnt lgkmcnt(0)
  v_mov_b32 v6, 0
  v_mov_b32 v8, s76
  v_mov_b32 v9, 1
  s_mov_b64 exec, 1
  ds_add_u32 v6, v8 offset:696
  ds_add_u32 v6, v9 offset:700
  s_mov_b64 exec, -1
  s_add_u32 s66, s65, 196608
  s_waitcnt vmcnt(2)
  buffer_load_dwordx4 v[88:91], v1, s[8:11], s66 offen offset:0 nt
  s_waitcnt vmcnt(2)
  buffer_load_dwordx4 v[92:95], v1, s[8:11], s66 offen offset:128 nt
  s_waitcnt vmcnt(2)
  buffer_load_dwordx4 v[96:99], v1, s[8:11], s66 offen offset:256 nt
  s_add_u32 s67, s66, 196608
  s_waitcnt vmcnt(2)
  buffer_load_dwordx4 v[100:103], v1, s[8:11], s67 offen offset:0 nt
  s_waitcnt vmcnt(2)
  buffer_load_dwordx4 v[104:107], v1, s[8:11], s67 offen offset:128 nt
  s_waitcnt vmcnt(2)
  buffer_load_dwordx4 v[108:111], v1, s[8:11], s67 offen offset:256 nt
  s_waitcnt vmcnt(2)
  buffer_load_dwordx4 v[112:115], v1, s[12:15], s60 offen offset:0 nt
  s_waitcnt vmcnt(2)
  buffer_load_dwordx4 v[116:119], v1, s[12:15], s60 offen offset:128 nt
  s_waitcnt vmcnt(2)
  buffer_load_dwordx4 v[120:123], v1, s[12:15], s60 offen offset:256 nt
  v_mov_b32 v6, 0
  v_mov_b32 v7, 1
  s_mov_b64 exec, 1
  ds_add_u32 v6, v7 offset:692
  s_mov_b64 exec, -1
  s_waitcnt lgkmcnt(0)
  s_mul_i32 s30, s28, 0x2c9277b5
  s_add_u32 s30, s30, 0xac564b05
  s_mul_i32 s31, s29, 0x0019660d
  s_add_u32 s31, s31, 0x3c6ef35f
  v_and_b32 v2, 3, v0
  v_min_u32 v2, 2, v2
  v_lshlrev_b32 v2, 3, v2
  s_mov_b32 s70, 200007
L_spin_1:
  ds_read_b32 v4, v2 offset:384
  s_waitcnt lgkmcnt(0)
  v_cmp_eq_u32 vcc, 0, v4
  s_nop 0
  s_cbranch_vccz L_sdone_2
  s_sleep 1
  s_sub_u32 s70, s70, 1
  s_cbranch_scc0 L_spin_1
L_sdone_2:
  ds_read_b128 v[4:7], v3 offset:0
  ds_read_b128 v[8:11], v3 offset:128
  ds_read_b128 v[12:15], v3 offset:256
  v_mov_b32 v160, 0
  v_mov_b32 v161, 0
  v_mov_b32 v162, 0
  v_mov_b32 v163, 0
  v_mov_b32 v164, 0
  v_mov_b32 v165, 0
  v_mov_b32 v166, 0
  v_mov_b32 v167, 0
  s_waitcnt vmcnt(3) lgkmcnt(0)
  v_dot2c_f32_bf16 v160, v16, v4
  v_dot2c_f32_bf16 v161, v28, v4
  v_dot2c_f32_bf16 v162, v40, v4
  v_dot2c_f32_bf16 v163, v52, v4
  v_dot2c_f32_bf16 v160, v17, v5
  v_dot2c_f32_bf16 v161, v29, v5
  v_dot2c_f32_bf16 v162, v41, v5
  v_dot2c_f32_bf16 v163, v53, v5
  v_dot2c_f32_bf16 v160, v18, v6
  v_dot2c_f32_bf16 v161, v30, v6
  v_dot2c_f32_bf16 v162, v42, v6
  v_dot2c_f32_bf16 v163, v54, v6
  v_dot2c_f32_bf16 v160, v19, v7
  v_dot2c_f32_bf16 v161, v31, v7
  v_dot2c_f32_bf16 v162, v43, v7
  v_dot2c_f32_bf16 v163, v55, v7
  v_dot2c_f32_bf16 v160, v20, v8
  v_dot2c_f32_bf16 v161, v32, v8
  v_dot2c_f32_bf16 v162, v44, v8
  v_dot2c_f32_bf16 v163, v56, v8
  v_dot2c_f32_bf16 v160, v21, v9
  v_dot2c_f32_bf16 v161, v33, v9
  v_dot2c_f32_bf16 v162, v45, v9
  v_dot2c_f32_bf16 v163, v57, v9
  v_dot2c_f32_bf16 v160, v22, v10
  v_dot2c_f32_bf16 v161, v34, v10
  v_dot2c_f32_bf16 v162, v46, v10
  v_dot2c_f32_bf16 v163, v58, v10
  v_dot2c_f32_bf16 v160, v23, v11
  v_dot2c_f32_bf16 v161, v35, v11
  v_dot2c_f32_bf16 v162, v47, v11
  v_dot2c_f32_bf16 v163, v59, v11
  v_dot2c_f32_bf16 v160, v24, v12
  v_dot2c_f32_bf16 v161, v36, v12
  v_dot2c_f32_bf16 v162, v48, v12
  v_dot2c_f32_bf16 v163, v60, v12
  v_dot2c_f32_bf16 v160, v25, v13
  v_dot2c_f32_bf16 v161, v37, v13
  v_dot2c_f32_bf16 v162, v49, v13
  v_dot2c_f32_bf16 v163, v61, v13
  v_dot2c_f32_bf16 v160, v26, v14
  v_dot2c_f32_bf16 v161, v38, v14
  v_dot2c_f32_bf16 v162, v50, v14
  v_dot2c_f32_bf16 v163, v62, v14
  v_dot2c_f32_bf16 v160, v27, v15
  v_dot2c_f32_bf16 v161, v39, v15
  v_dot2c_f32_bf16 v162, v51, v15
  v_dot2c_f32_bf16 v163, v63, v15
  v_dot2c_f32_bf16 v164, v64, v4
  v_dot2c_f32_bf16 v165, v76, v4
  v_dot2c_f32_bf16 v166, v88, v4
  v_dot2c_f32_bf16 v167, v100, v4
  v_dot2c_f32_bf16 v164, v65, v5
  v_dot2c_f32_bf16 v165, v77, v5
  v_dot2c_f32_bf16 v166, v89, v5
  v_dot2c_f32_bf16 v167, v101, v5
  v_dot2c_f32_bf16 v164, v66, v6
  v_dot2c_f32_bf16 v165, v78, v6
  v_dot2c_f32_bf16 v166, v90, v6
  v_dot2c_f32_bf16 v167, v102, v6
  v_dot2c_f32_bf16 v164, v67, v7
  v_dot2c_f32_bf16 v165, v79, v7
  v_dot2c_f32_bf16 v166, v91, v7
  v_dot2c_f32_bf16 v167, v103, v7
  v_dot2c_f32_bf16 v164, v68, v8
  v_dot2c_f32_bf16 v165, v80, v8
  v_dot2c_f32_bf16 v166, v92, v8
  v_dot2c_f32_bf16 v167, v104, v8
  v_dot2c_f32_bf16 v164, v69, v9
  v_dot2c_f32_bf16 v165, v81, v9
  v_dot2c_f32_bf16 v166, v93, v9
  v_dot2c_f32_bf16 v167, v105, v9
  v_dot2c_f32_bf16 v164, v70, v10
  v_dot2c_f32_bf16 v165, v82, v10
  v_dot2c_f32_bf16 v166, v94, v10
  v_dot2c_f32_bf16 v167, v106, v10
  v_dot2c_f32_bf16 v164, v71, v11
  v_dot2c_f32_bf16 v165, v83, v11
  v_dot2c_f32_bf16 v166, v95, v11
  v_dot2c_f32_bf16 v167, v107, v11
  v_dot2c_f32_bf16 v164, v72, v12
  v_dot2c_f32_bf16 v165, v84, v12
  v_dot2c_f32_bf16 v166, v96, v12
  v_dot2c_f32_bf16 v167, v108, v12
  v_dot2c_f32_bf16 v164, v73, v13
  v_dot2c_f32_bf16 v165, v85, v13
  v_dot2c_f32_bf16 v166, v97, v13
  v_dot2c_f32_bf16 v167, v109, v13
  v_dot2c_f32_bf16 v164, v74, v14
  v_dot2c_f32_bf16 v165, v86, v14
  v_dot2c_f32_bf16 v166, v98, v14
  v_dot2c_f32_bf16 v167, v110, v14
  v_dot2c_f32_bf16 v164, v75, v15
  v_dot2c_f32_bf16 v165, v87, v15
  v_dot2c_f32_bf16 v166, v99, v15
  v_dot2c_f32_bf16 v167, v111, v15
  v_add_f32_dpp v160, v160, v160 quad_perm:[1,0,3,2] row_mask:0xf bank_mask:0xf
  v_add_f32_dpp v161, v161, v161 quad_perm:[1,0,3,2] row_mask:0xf bank_mask:0xf
  v_add_f32_dpp v162, v162, v162 quad_perm:[1,0,3,2] row_mask:0xf bank_mask:0xf
  v_add_f32_dpp v163, v163, v163 quad_perm:[1,0,3,2] row_mask:0xf bank_mask:0xf
  v_add_f32_dpp v164, v164, v164 quad_perm:[1,0,3,2] row_mask:0xf bank_mask:0xf
  v_add_f32_dpp v165, v165, v165 quad_perm:[1,0,3,2] row_mask:0xf bank_mask:0xf
  v_add_f32_dpp v166, v166, v166 quad_perm:[1,0,3,2] row_mask:0xf bank_mask:0xf
  v_add_f32_dpp v167, v167, v167 quad_perm:[1,0,3,2] row_mask:0xf bank_mask:0xf
  v_add_f32_dpp v160, v160, v160 quad_perm:[2,3,0,1] row_mask:0xf bank_mask:0xf
  v_add_f32_dpp v161, v161, v161 quad_perm:[2,3,0,1] row_mask:0xf bank_mask:0xf
  v_add_f32_dpp v162, v162, v162 quad_perm:[2,3,0,1] row_mask:0xf bank_mask:0xf
  v_add_f32_dpp v163, v163, v163 quad_perm:[2,3,0,1] row_mask:0xf bank_mask:0xf
  v_add_f32_dpp v164, v164, v164 quad_perm:[2,3,0,1] row_mask:0xf bank_mask:0xf
  v_add_f32_dpp v165, v165, v165 quad_perm:[2,3,0,1] row_mask:0xf bank_mask:0xf
  v_add_f32_dpp v166, v166, v166 quad_perm:[2,3,0,1] row_mask:0xf bank_mask:0xf
  v_add_f32_dpp v167, v167, v167 quad_perm:[2,3,0,1] row_mask:0xf bank_mask:0xf
  v_add_f32_dpp v160, v160, v160 row_half_mirror row_mask:0xf bank_mask:0xf
  v_add_f32_dpp v161, v161, v161 row_half_mirror row_mask:0xf bank_mask:0xf
  v_add_f32_dpp v162, v162, v162 row_half_mirror row_mask:0xf bank_mask:0xf
  v_add_f32_dpp v163, v163, v163 row_half_mirror row_mask:0xf bank_mask:0xf
  v_add_f32_dpp v164, v164, v164 row_half_mirror row_mask:0xf bank_mask:0xf
  v_add_f32_dpp v165, v165, v165 row_half_mirror row_mask:0xf bank_mask:0xf
  v_add_f32_dpp v166, v166, v166 row_half_mirror row_mask:0xf bank_mask:0xf
  v_add_f32_dpp v167, v167, v167 row_half_mirror row_mask:0xf bank_mask:0xf
  s_mov_b32 s68, 0x3d93cd3a
  v_mov_b32 v2, 0
  v_cvt_pk_bf16_f32 v160, v2, v160
  v_cvt_pk_bf16_f32 v161, v2, v161
  v_cvt_pk_bf16_f32 v162, v2, v162
  v_cvt_pk_bf16_f32 v163, v2, v163
  v_cvt_pk_bf16_f32 v164, v2, v164
  v_cvt_pk_bf16_f32 v165, v2, v165
  v_cvt_pk_bf16_f32 v166, v2, v166
  v_cvt_pk_bf16_f32 v167, v2, v167
  v_mul_f32 v160, s68, v160
  v_mul_f32 v161, s68, v161
  v_mul_f32 v162, s68, v162
  v_mul_f32 v163, s68, v163
  v_mul_f32 v164, s68, v164
  v_mul_f32 v165, s68, v165
  v_mul_f32 v166, s68, v166
  v_mul_f32 v167, s68, v167
  v_cvt_pk_bf16_f32 v160, v2, v160
  v_cvt_pk_bf16_f32 v161, v2, v161
  v_cvt_pk_bf16_f32 v162, v2, v162
  v_cvt_pk_bf16_f32 v163, v2, v163
  v_cvt_pk_bf16_f32 v164, v2, v164
  v_cvt_pk_bf16_f32 v165, v2, v165
  v_cvt_pk_bf16_f32 v166, v2, v166
  v_cvt_pk_bf16_f32 v167, v2, v167
  v_max_f32 v4, v160, v161
  v_max3_f32 v4, v4, v162, v163
  v_max3_f32 v4, v4, v164, v165
  v_max3_f32 v4, v4, v166, v167
  s_nop 1
  v_max_f32_dpp v4, v4, v4 row_ror:8 row_mask:0xf bank_mask:0xf
  v_mov_b32 v88, v4
  s_nop 1
  v_permlane16_swap_b32 v4, v88
  v_max_f32 v4, v4, v88
  v_mov_b32 v88, v4
  s_nop 1
  v_permlane32_swap_b32 v4, v88
  v_max_f32 v4, v4, v88
  s_mov_b32 s68, 0x3fb8aa3b
  v_sub_f32 v160, v160, v4
  v_sub_f32 v161, v161, v4
  v_sub_f32 v162, v162, v4
  v_sub_f32 v163, v163, v4
  v_sub_f32 v164, v164, v4
  v_sub_f32 v165, v165, v4
  v_sub_f32 v166, v166, v4
  v_sub_f32 v167, v167, v4
  v_mul_f32 v160, s68, v160
  v_mul_f32 v161, s68, v161
  v_mul_f32 v162, s68, v162
  v_mul_f32 v163, s68, v163
  v_mul_f32 v164, s68, v164
  v_mul_f32 v165, s68, v165
  v_mul_f32 v166, s68, v166
  v_mul_f32 v167, s68, v167
  v_exp_f32 v160, v160
  v_exp_f32 v161, v161
  v_exp_f32 v162, v162
  v_exp_f32 v163, v163
  v_exp_f32 v164, v164
  v_exp_f32 v165, v165
  v_exp_f32 v166, v166
  v_exp_f32 v167, v167
  v_add_f32 v5, v160, v161
  v_add_f32 v5, v5, v162
  v_add_f32 v5, v5, v163
  v_add_f32 v5, v5, v164
  v_add_f32 v5, v5, v165
  v_add_f32 v5, v5, v166
  v_add_f32 v5, v5, v167
  s_nop 1
  v_add_f32_dpp v5, v5, v5 row_ror:8 row_mask:0xf bank_mask:0xf
  v_mov_b32 v88, v5
  s_nop 1
  v_permlane16_swap_b32 v5, v88
  v_add_f32 v5, v5, v88
  v_mov_b32 v88, v5
  s_nop 1
  v_permlane32_swap_b32 v5, v88
  v_add_f32 v5, v5, v88
  s_lshl_b32 s69, s73, 4
  v_mov_b32 v88, s69
  v_mov_b32 v6, 1
  v_mov_b32 v7, 1
  ds_write_b128 v88, v[4:7] offset:512
  v_cvt_pk_bf16_f32 v160, v160, v2
  v_cvt_pk_bf16_f32 v161, v161, v2
  v_cvt_pk_bf16_f32 v162, v162, v2
  v_cvt_pk_bf16_f32 v163, v163, v2
  v_cvt_pk_bf16_f32 v164, v164, v2
  v_cvt_pk_bf16_f32 v165, v165, v2
  v_cvt_pk_bf16_f32 v166, v166, v2
  v_cvt_pk_bf16_f32 v167, v167, v2
  v_mov_b32 v88, 0
  v_mov_b32 v89, 0
  v_mov_b32 v90, 0
  v_mov_b32 v91, 0
  v_mov_b32 v92, 0
  v_mov_b32 v93, 0
  v_mov_b32 v94, 0
  v_mov_b32 v95, 0
  v_mov_b32 v96, 0
  v_mov_b32 v97, 0
  v_mov_b32 v98, 0
  v_mov_b32 v99, 0
  v_mov_b32 v100, 0
  v_mov_b32 v101, 0
  v_mov_b32 v102, 0
  v_mov_b32 v103, 0
  v_mov_b32 v104, 0
  v_mov_b32 v105, 0
  v_mov_b32 v106, 0
  v_mov_b32 v107, 0
  v_mov_b32 v108, 0
  v_mov_b32 v109, 0
  v_mov_b32 v110, 0
  v_mov_b32 v111, 0
  v_and_b32 v8, 7, v0
  v_lshlrev_b32 v8, 5, v8
  v_lshrrev_b32 v9, 4, v0
  v_lshl_add_u32 v8, v9, 3, v8
  s_mul_i32 s69, s73, 768
  v_add_u32 v8, s69, v8
  v_mov_b32 v11, 1
  s_waitcnt vmcnt(2)
  buffer_load_dwordx4 v[124:127], v1, s[12:15], s61 offen offset:0 nt
  s_waitcnt vmcnt(2)
  buffer_load_dwordx4 v[128:131], v1, s[12:15], s61 offen offset:128 nt
  v_lshlrev_b32 v10, 16, v160
  v_dot2c_f32_bf16 v88, v112, v160
  v_dot2c_f32_bf16 v89, v112, v10
  v_dot2c_f32_bf16 v90, v113, v160
  v_dot2c_f32_bf16 v91, v113, v10
  v_dot2c_f32_bf16 v92, v114, v160
  v_dot2c_f32_bf16 v93, v114, v10
  v_dot2c_f32_bf16 v94, v115, v160
  v_dot2c_f32_bf16 v95, v115, v10
  s_waitcnt vmcnt(2)
  buffer_load_dwordx4 v[132:135], v1, s[12:15], s61 offen offset:256 nt
  s_memrealtime s[76:77]
  v_mov_b32 v6, 0
  ds_read_b64 v[6:7], v6 offset:680
  s_movk_i32 s79, 460
  s_waitcnt lgkmcnt(0)
  v_readfirstlane_b32 s78, v6
  v_readfirstlane_b32 s72, v7
  s_add_u32 s78, s78, 5520
  v_dot2c_f32_bf16 v96, v116, v160
  v_dot2c_f32_bf16 v97, v116, v10
  v_dot2c_f32_bf16 v98, v117, v160
  v_dot2c_f32_bf16 v99, v117, v10
  v_dot2c_f32_bf16 v100, v118, v160
  v_dot2c_f32_bf16 v101, v118, v10
  v_dot2c_f32_bf16 v102, v119, v160
  v_dot2c_f32_bf16 v103, v119, v10
  s_waitcnt lgkmcnt(0)
  s_lshl_b32 s75, s76, 4
  s_sub_u32 s75, s75, s78
  s_and_b32 s75, s75, s72
  s_add_u32 s78, s78, s79
  s_waitcnt vmcnt(3)
  s_cmp_gt_i32 s75, 480
  s_cbranch_scc1 L_go_3
  s_waitcnt vmcnt(2)
  s_cmp_ge_i32 s75, 0
  s_cbranch_scc1 L_go_3
  s_waitcnt vmcnt(1)
L_go_3:
  buffer_load_dwordx4 v[136:139], v1, s[12:15], s62 offen offset:0 nt
  s_memrealtime s[76:77]
  v_dot2c_f32_bf16 v104, v120, v160
  v_dot2c_f32_bf16 v105, v120, v10
  v_dot2c_f32_bf16 v106, v121, v160
  v_dot2c_f32_bf16 v107, v121, v10
  v_dot2c_f32_bf16 v108, v122, v160
  v_dot2c_f32_bf16 v109, v122, v10
  v_dot2c_f32_bf16 v110, v123, v160
  v_dot2c_f32_bf16 v111, v123, v10
  s_waitcnt lgkmcnt(0)
  s_lshl_b32 s75, s76, 4
  s_sub_u32 s75, s75, s78
  s_and_b32 s75, s75, s72
  s_add_u32 s78, s78, s79
  s_waitcnt vmcnt(3)
  s_cmp_gt_i32 s75, 480
  s_cbranch_scc1 L_go_4
  s_waitcnt vmcnt(2)
  s_cmp_ge_i32 s75, 0
  s_cbranch_scc1 L_go_4
  s_waitcnt vmcnt(1)
L_go_4:
  buffer_load_dwordx4 v[140:143], v1, s[12:15], s62 offen offset:128 nt
  s_memrealtime s[76:77]
  v_lshlrev_b32 v10, 16, v161
  v_dot2c_f32_bf16 v88, v124, v161
  v_dot2c_f32_bf16 v89, v124, v10
  v_dot2c_f32_bf16 v90, v125, v161
  v_dot2c_f32_bf16 v91, v125, v10
  v_dot2c_f32_bf16 v92, v126, v161
  v_dot2c_f32_bf16 v93, v126, v10
  v_dot2c_f32_bf16 v94, v127, v161
  v_dot2c_f32_bf16 v95, v127, v10
  s_waitcnt lgkmcnt(0)
  s_lshl_b32 s75, s76, 4
  s_sub_u32 s75, s75, s78
  s_and_b32 s75, s75, s72
  s_add_u32 s78, s78, s79
  s_waitcnt vmcnt(3)
  s_cmp_gt_i32 s75, 480
  s_cbranch_scc1 L_go_5
  s_waitcnt vmcnt(2)
  s_cmp_ge_i32 s75, 0
  s_cbranch_scc1 L_go_5
  s_waitcnt vmcnt(1)
L_go_5:
  buffer_load_dwordx4 v[144:147], v1, s[12:15], s62 offen offset:256 nt
  s_memrealtime s[76:77]
  v_dot2c_f32_bf16 v96, v128, v161
  v_dot2c_f32_bf16 v97, v128, v10
  v_dot2c_f32_bf16 v98, v129, v161
  v_dot2c_f32_bf16 v99, v129, v10
  v_dot2c_f32_bf16 v100, v130, v161
  v_dot2c_f32_bf16 v101, v130, v10
  v_dot2c_f32_bf16 v102, v131, v161
  v_dot2c_f32_bf16 v103, v131, v10
  s_waitcnt lgkmcnt(0)
  s_lshl_b32 s75, s76, 4
  s_sub_u32 s75, s75, s78
  s_and_b32 s75, s75, s72
  s_add_u32 s78, s78, s79
  s_waitcnt vmcnt(3)
  s_cmp_gt_i32 s75, 480
  s_cbranch_scc1 L_go_6
  s_waitcnt vmcnt(2)
  s_cmp_ge_i32 s75, 0
  s_cbranch_scc1 L_go_6
  s_waitcnt vmcnt(1)
L_go_6:
  buffer_load_dwordx4 v[148:151], v1, s[12:15], s63 offen offset:0 nt
  s_memrealtime s[76:77]
  v_mov_b32 v6, 0
  ds_read_b64 v[6:7], v6 offset:680
  s_movk_i32 s79, 460
  s_waitcnt lgkmcnt(0)
  v_readfirstlane_b32 s78, v6
  v_readfirstlane_b32 s72, v7
  s_add_u32 s78, s78, 7360
  v_dot2c_f32_bf16 v104, v132, v161
  v_dot2c_f32_bf16 v105, v132, v10
  v_dot2c_f32_bf16 v106, v133, v161
  v_dot2c_f32_bf16 v107, v133, v10
  v_dot2c_f32_bf16 v108, v134, v161
  v_dot2c_f32_bf16 v109, v134, v10
  v_dot2c_f32_bf16 v110, v135, v161
  v_dot2c_f32_bf16 v111, v135, v10
  s_waitcnt lgkmcnt(0)
  s_lshl_b32 s75, s76, 4
  s_sub_u32 s75, s75, s78
  s_and_b32 s75, s75, s72
  s_add_u32 s78, s78, s79
  s_waitcnt vmcnt(3)
  s_cmp_gt_i32 s75, 480
  s_cbranch_scc1 L_go_7
  s_waitcnt vmcnt(2)
  s_cmp_ge_i32 s75, 0
  s_cbranch_scc1 L_go_7
  s_waitcnt vmcnt(1)
L_go_7:
  buffer_load_dwordx4 v[152:155], v1, s[12:15], s63 offen offset:128 nt
  s_memrealtime s[76:77]
  v_lshlrev_b32 v10, 16, v162
  v_dot2c_f32_bf16 v88, v136, v162
  v_dot2c_f32_bf16 v89, v136, v10
  v_dot2c_f32_bf16 v90, v137, v162
  v_dot2c_f32_bf16 v91, v137, v10
  v_dot2c_f32_bf16 v92, v138, v162
  v_dot2c_f32_bf16 v93, v138, v10
  v_dot2c_f32_bf16 v94, v139, v162
  v_dot2c_f32_bf16 v95, v139, v10
  s_waitcnt lgkmcnt(0)
  s_lshl_b32 s75, s76, 4
  s_sub_u32 s75, s75, s78
  s_and_b32 s75, s75, s72
  s_add_u32 s78, s78, s79
  s_waitcnt vmcnt(3)
  s_cmp_gt_i32 s75, 480
  s_cbranch_scc1 L_go_8
  s_waitcnt vmcnt(2)
  s_cmp_ge_i32 s75, 0
  s_cbranch_scc1 L_go_8
  s_waitcnt vmcnt(1)
L_go_8:
  buffer_load_dwordx4 v[156:159], v1, s[12:15], s63 offen offset:256 nt
  s_memrealtime s[76:77]
  v_dot2c_f32_bf16 v96, v140, v162
  v_dot2c_f32_bf16 v97, v140, v10
  v_dot2c_f32_bf16 v98, v141, v162
  v_dot2c_f32_bf16 v99, v141, v10
  v_dot2c_f32_bf16 v100, v142, v162
  v_dot2c_f32_bf16 v101, v142, v10
  v_dot2c_f32_bf16 v102, v143, v162
  v_dot2c_f32_bf16 v103, v143, v10
  s_waitcnt lgkmcnt(0)
  s_lshl_b32 s75, s76, 4
  s_sub_u32 s75, s75, s78
  s_and_b32 s75, s75, s72
  s_add_u32 s78, s78, s79
  s_waitcnt vmcnt(3)
  s_cmp_gt_i32 s75, 480
  s_cbranch_scc1 L_go_9
  s_waitcnt vmcnt(2)
  s_cmp_ge_i32 s75, 0
  s_cbranch_scc1 L_go_9
  s_waitcnt vmcnt(1)
L_go_9:
  buffer_load_dwordx4 v[16:19], v1, s[12:15], s64 offen offset:0 nt
  s_memrealtime s[76:77]
  v_dot2c_f32_bf16 v104, v144, v162
  v_dot2c_f32_bf16 v105, v144, v10
  v_dot2c_f32_bf16 v106, v145, v162
  v_dot2c_f32_bf16 v107, v145, v10
  v_dot2c_f32_bf16 v108, v146, v162
  v_dot2c_f32_bf16 v109, v146, v10
  v_dot2c_f32_bf16 v110, v147, v162
  v_dot2c_f32_bf16 v111, v147, v10
  s_waitcnt lgkmcnt(0)
  s_lshl_b32 s75, s76, 4
  s_sub_u32 s75, s75, s78
  s_and_b32 s75, s75, s72
  s_add_u32 s78, s78, s79
  s_waitcnt vmcnt(3)
  s_cmp_gt_i32 s75, 480
  s_cbranch_scc1 L_go_10
  s_waitcnt vmcnt(2)
  s_cmp_ge_i32 s75, 0
  s_cbranch_scc1 L_go_10
  s_waitcnt vmcnt(1)
L_go_10:
  buffer_load_dwordx4 v[20:23], v1, s[12:15], s64 offen offset:128 nt
  s_memrealtime s[76:77]
  v_lshlrev_b32 v10, 16, v163
  v_dot2c_f32_bf16 v88, v148, v163
  v_dot2c_f32_bf16 v89, v148, v10
  v_dot2c_f32_bf16 v90, v149, v163
  v_dot2c_f32_bf16 v91, v149, v10
  v_dot2c_f32_bf16 v92, v150, v163
  v_dot2c_f32_bf16 v93, v150, v10
  v_dot2c_f32_bf16 v94, v151, v163
  v_dot2c_f32_bf16 v95, v151, v10
  s_waitcnt lgkmcnt(0)
  s_lshl_b32 s75, s76, 4
  s_sub_u32 s75, s75, s78
  s_and_b32 s75, s75, s72
  s_add_u32 s78, s78, s79
  s_waitcnt vmcnt(3)
  s_cmp_gt_i32 s75, 480
  s_cbranch_scc1 L_go_11
  s_waitcnt vmcnt(2)
  s_cmp_ge_i32 s75, 0
  s_cbranch_scc1 L_go_11
  s_waitcnt vmcnt(1)
L_go_11:
  buffer_load_dwordx4 v[24:27], v1, s[12:15], s64 offen offset:256 nt
  s_memrealtime s[76:77]
  v_dot2c_f32_bf16 v96, v152, v163
  v_dot2c_f32_bf16 v97, v152, v10
  v_dot2c_f32_bf16 v98, v153, v163
  v_dot2c_f32_bf16 v99, v153, v10
  v_dot2c_f32_bf16 v100, v154, v163
  v_dot2c_f32_bf16 v101, v154, v10
  v_dot2c_f32_bf16 v102, v155, v163
  v_dot2c_f32_bf16 v103, v155, v10
  s_waitcnt lgkmcnt(0)
  s_lshl_b32 s75, s76, 4
  s_sub_u32 s75, s75, s78
  s_and_b32 s75, s75, s72
  s_add_u32 s78, s78, s79
  s_waitcnt vmcnt(3)
  s_cmp_gt_i32 s75, 480
  s_cbranch_scc1 L_go_12
  s_waitcnt vmcnt(2)
  s_cmp_ge_i32 s75, 0
  s_cbranch_scc1 L_go_12
  s_waitcnt vmcnt(1)
L_go_12:
  buffer_load_dwordx4 v[28:31], v1, s[12:15], s65 offen offset:0 nt
  s_memrealtime s[76:77]
  v_dot2c_f32_bf16 v104, v156, v163
  v_dot2c_f32_bf16 v105, v156, v10
  v_dot2c_f32_bf16 v106, v157, v163
  v_dot2c_f32_bf16 v107, v157, v10
  v_dot2c_f32_bf16 v108, v158, v163
  v_dot2c_f32_bf16 v109, v158, v10
  v_dot2c_f32_bf16 v110, v159, v163
  v_dot2c_f32_bf16 v111, v159, v10
  s_waitcnt lgkmcnt(0)
  s_lshl_b32 s75, s76, 4
  s_sub_u32 s75, s75, s78
  s_and_b32 s75, s75, s72
  s_add_u32 s78, s78, s79
  s_waitcnt vmcnt(3)
  s_cmp_gt_i32 s75, 480
  s_cbranch_scc1 L_go_13
  s_waitcnt vmcnt(2)
  s_cmp_ge_i32 s75, 0
  s_cbranch_scc1 L_go_13
  s_waitcnt vmcnt(1)
L_go_13:
  buffer_load_dwordx4 v[32:35], v1, s[12:15], s65 offen offset:128 nt
  s_memrealtime s[76:77]
  v_lshlrev_b32 v10, 16, v164
  v_dot2c_f32_bf16 v88, v16, v164
  v_dot2c_f32_bf16 v89, v16, v10
  v_dot2c_f32_bf16 v90, v17, v164
  v_dot2c_f32_bf16 v91, v17, v10
  v_dot2c_f32_bf16 v92, v18, v164
  v_dot2c_f32_bf16 v93, v18, v10
  v_dot2c_f32_bf16 v94, v19, v164
  v_dot2c_f32_bf16 v95, v19, v10
  s_waitcnt lgkmcnt(0)
  s_lshl_b32 s75, s76, 4
  s_sub_u32 s75, s75, s78
  s_and_b32 s75, s75, s72
  s_add_u32 s78, s78, s79
  s_waitcnt vmcnt(3)
  s_cmp_gt_i32 s75, 480
  s_cbranch_scc1 L_go_14
  s_waitcnt vmcnt(2)
  s_cmp_ge_i32 s75, 0
  s_cbranch_scc1 L_go_14
  s_waitcnt vmcnt(1)
L_go_14:
  buffer_load_dwordx4 v[36:39], v1, s[12:15], s65 offen offset:256 nt
  s_memrealtime s[76:77]
  v_dot2c_f32_bf16 v96, v20, v164
  v_dot2c_f32_bf16 v97, v20, v10
  v_dot2c_f32_bf16 v98, v21, v164
  v_dot2c_f32_bf16 v99, v21, v10
  v_dot2c_f32_bf16 v100, v22, v164
  v_dot2c_f32_bf16 v101, v22, v10
  v_dot2c_f32_bf16 v102, v23, v164
  v_dot2c_f32_bf16 v103, v23, v10
  s_waitcnt lgkmcnt(0)
  s_lshl_b32 s75, s76, 4
  s_sub_u32 s75, s75, s78
  s_and_b32 s75, s75, s72
  s_add_u32 s78, s78, s79
  s_waitcnt vmcnt(3)
  s_cmp_gt_i32 s75, 480
  s_cbranch_scc1 L_go_15
  s_waitcnt vmcnt(2)
  s_cmp_ge_i32 s75, 0
  s_cbranch_scc1 L_go_15
  s_waitcnt vmcnt(1)
L_go_15:
  buffer_load_dwordx4 v[40:43], v1, s[12:15], s66 offen offset:0 nt
  s_memrealtime s[76:77]
  v_dot2c_f32_bf16 v104, v24, v164
  v_dot2c_f32_bf16 v105, v24, v10
  v_dot2c_f32_bf16 v106, v25, v164
  v_dot2c_f32_bf16 v107, v25, v10
  v_dot2c_f32_bf16 v108, v26, v164
  v_dot2c_f32_bf16 v109, v26, v10
  v_dot2c_f32_bf16 v110, v27, v164
  v_dot2c_f32_bf16 v111, v27, v10
  s_waitcnt lgkmcnt(0)
  s_lshl_b32 s75, s76, 4
  s_sub_u32 s75, s75, s78
  s_and_b32 s75, s75, s72
  s_add_u32 s78, s78, s79
  s_waitcnt vmcnt(3)
  s_cmp_gt_i32 s75, 480
  s_cbranch_scc1 L_go_16
  s_waitcnt vmcnt(2)
  s_cmp_ge_i32 s75, 0
  s_cbranch_scc1 L_go_16
  s_waitcnt vmcnt(1)
L_go_16:
  buffer_load_dwordx4 v[44:47], v1, s[12:15], s66 offen offset:128 nt
  s_memrealtime s[76:77]
  v_lshlrev_b32 v10, 16, v165
  v_dot2c_f32_bf16 v88, v28, v165
  v_dot2c_f32_bf16 v89, v28, v10
  v_dot2c_f32_bf16 v90, v29, v165
  v_dot2c_f32_bf16 v91, v29, v10
  v_dot2c_f32_bf16 v92, v30, v165
  v_dot2c_f32_bf16 v93, v30, v10
  v_dot2c_f32_bf16 v94, v31, v165
  v_dot2c_f32_bf16 v95, v31, v10
  s_waitcnt lgkmcnt(0)
  s_lshl_b32 s75, s76, 4
  s_sub_u32 s75, s75, s78
  s_and_b32 s75, s75, s72
  s_add_u32 s78, s78, s79
  s_waitcnt vmcnt(3)
  s_cmp_gt_i32 s75, 480
  s_cbranch_scc1 L_go_17
  s_waitcnt vmcnt(2)
  s_cmp_ge_i32 s75, 0
  s_cbranch_scc1 L_go_17
  s_waitcnt vmcnt(1)
L_go_17:
  buffer_load_dwordx4 v[48:51], v1, s[12:15], s66 offen offset:256 nt
  s_memrealtime s[76:77]
  v_dot2c_f32_bf16 v96, v32, v165
  v_dot2c_f32_bf16 v97, v32, v10
  v_dot2c_f32_bf16 v98, v33, v165
  v_dot2c_f32_bf16 v99, v33, v10
  v_dot2c_f32_bf16 v100, v34, v165
  v_dot2c_f32_bf16 v101, v34, v10
  v_dot2c_f32_bf16 v102, v35, v165
  v_dot2c_f32_bf16 v103, v35, v10
  s_waitcnt lgkmcnt(0)
  s_lshl_b32 s75, s76, 4
  s_sub_u32 s75, s75, s78
  s_and_b32 s75, s75, s72
  s_add_u32 s78, s78, s79
  s_waitcnt vmcnt(3)
  s_cmp_gt_i32 s75, 480
  s_cbranch_scc1 L_go_18
  s_waitcnt vmcnt(2)
  s_cmp_ge_i32 s75, 0
  s_cbranch_scc1 L_go_18
  s_waitcnt vmcnt(1)
L_go_18:
  buffer_load_dwordx4 v[52:55], v1, s[12:15], s67 offen offset:0 nt
  s_memrealtime s[76:77]
  s_mov_b64 exec, 1
  ds_add_u32 v2, v11 offset:644
  s_mov_b64 exec, -1
  v_dot2c_f32_bf16 v104, v36, v165
  v_dot2c_f32_bf16 v105, v36, v10
  v_dot2c_f32_bf16 v106, v37, v165
  v_dot2c_f32_bf16 v107, v37, v10
  v_dot2c_f32_bf16 v108, v38, v165
  v_dot2c_f32_bf16 v109, v38, v10
  v_dot2c_f32_bf16 v110, v39, v165
  v_dot2c_f32_bf16 v111, v39, v10
  s_waitcnt lgkmcnt(0)
  s_lshl_b32 s75, s76, 4
  s_sub_u32 s75, s75, s78
  s_and_b32 s75, s75, s72
  s_add_u32 s78, s78, s79
  s_waitcnt vmcnt(3)
  s_cmp_gt_i32 s75, 480
  s_cbranch_scc1 L_go_19
  s_waitcnt vmcnt(2)
  s_cmp_ge_i32 s75, 0
  s_cbranch_scc1 L_go_19
  s_waitcnt vmcnt(1)
L_go_19:
  buffer_load_dwordx4 v[56:59], v1, s[12:15], s67 offen offset:128 nt
  s_memrealtime s[76:77]
  v_lshlrev_b32 v10, 16, v166
  v_dot2c_f32_bf16 v88, v40, v166
  v_dot2c_f32_bf16 v89, v40, v10
  v_dot2c_f32_bf16 v90, v41, v166
  v_dot2c_f32_bf16 v91, v41, v10
  v_dot2c_f32_bf16 v92, v42, v166
  v_dot2c_f32_bf16 v93, v42, v10
  v_dot2c_f32_bf16 v94, v43, v166
  v_dot2c_f32_bf16 v95, v43, v10
  s_waitcnt lgkmcnt(0)
  s_lshl_b32 s75, s76, 4
  s_sub_u32 s75, s75, s78
  s_and_b32 s75, s75, s72
  s_add_u32 s78, s78, s79
  s_waitcnt vmcnt(3)
  s_cmp_gt_i32 s75, 480
  s_cbranch_scc1 L_go_20
  s_waitcnt vmcnt(2)
  s_cmp_ge_i32 s75, 0
  s_cbranch_scc1 L_go_20
  s_waitcnt vmcnt(1)
L_go_20:
  buffer_load_dwordx4 v[60:63], v1, s[12:15], s67 offen offset:256 nt
  v_dot2c_f32_bf16 v96, v44, v166
  v_dot2c_f32_bf16 v97, v44, v10
  v_dot2c_f32_bf16 v98, v45, v166
  v_dot2c_f32_bf16 v99, v45, v10
  v_dot2c_f32_bf16 v100, v46, v166
  v_dot2c_f32_bf16 v101, v46, v10
  v_dot2c_f32_bf16 v102, v47, v166
  v_dot2c_f32_bf16 v103, v47, v10
  s_waitcnt vmcnt(3)
  v_dot2c_f32_bf16 v104, v48, v166
  v_dot2c_f32_bf16 v105, v48, v10
  v_dot2c_f32_bf16 v106, v49, v166
  v_dot2c_f32_bf16 v107, v49, v10
  v_dot2c_f32_bf16 v108, v50, v166
  v_dot2c_f32_bf16 v109, v50, v10
  v_dot2c_f32_bf16 v110, v51, v166
  v_dot2c_f32_bf16 v111, v51, v10
  s_mov_b32 s70, 200007
L_spin_21:
  ds_read_b128 v[12:15], v3 offset:512
  s_waitcnt lgkmcnt(0)
  v_cmp_eq_u32 vcc, 0, v15
  s_nop 0
  s_cbranch_vccz L_sdone_22
  s_sleep 1
  s_sub_u32 s70, s70, 1
  s_cbranch_scc0 L_spin_21
L_sdone_22:
  v_max_f32_dpp v12, v12, v12 quad_perm:[1,0,3,2] row_mask:0xf bank_mask:0xf
  s_nop 1
  v_max_f32_dpp v12, v12, v12 quad_perm:[2,3,0,1] row_mask:0xf bank_mask:0xf
  s_nop 1
  v_max_f32_dpp v12, v12, v12 row_half_mirror row_mask:0xf bank_mask:0xf
  v_sub_f32 v9, v4, v12
  v_mul_f32 v9, s68, v9
  v_exp_f32 v9, v9
  v_mov_b32 v2, 0
  s_mov_b32 s70, 200007
L_spin_23:
  ds_read_b32 v13, v2 offset:648
  s_waitcnt lgkmcnt(0)
  v_cmp_gt_u32 vcc, 1, v13
  s_nop 0
  s_cbranch_vccz L_sdone_24
  s_sleep 2
  s_sub_u32 s70, s70, 1
  s_cbranch_scc0 L_spin_23
L_sdone_24:
  v_readfirstlane_b32 s46, v13
  v_min_u32 v12, 47, v0
  v_lshlrev_b32 v13, 7, v12
  v_lshlrev_b32 v12, 4, v12
  s_mul_i32 s74, s6, 6144
  s_lshl4_add_u32 s74, s7, s74
  s_add_u32 s74, s74, 524288
  s_mov_b32 s22, 0xaaaaaaaa
  s_mov_b32 s23, 0xaaaaaaaa
  v_mov_b32 v14, s30
  v_mov_b32 v15, s31
  s_waitcnt vmcnt(2)
  v_lshlrev_b32 v10, 16, v167
  v_dot2c_f32_bf16 v88, v52, v167
  v_dot2c_f32_bf16 v89, v52, v10
  v_dot2c_f32_bf16 v90, v53, v167
  v_dot2c_f32_bf16 v91, v53, v10
  v_dot2c_f32_bf16 v92, v54, v167
  v_dot2c_f32_bf16 v93, v54, v10
  v_dot2c_f32_bf16 v94, v55, v167
  v_dot2c_f32_bf16 v95, v55, v10
  v_permlane32_swap_b32 v88, v92
  v_permlane32_swap_b32 v89, v93
  v_permlane32_swap_b32 v90, v94
  v_permlane32_swap_b32 v91, v95
  v_add_f32 v88, v88, v92
  v_add_f32 v89, v89, v93
  v_add_f32 v90, v90, v94
  v_add_f32 v91, v91, v95
  s_nop 0
  v_permlane16_swap_b32 v88, v90
  v_permlane16_swap_b32 v89, v91
  v_add_f32 v88, v88, v90
  v_add_f32 v89, v89, v91
  s_nop 0
  v_add_f32_dpp v88, v88, v88 row_ror:8 row_mask:0xf bank_mask:0xf
  v_add_f32_dpp v89, v89, v89 row_ror:8 row_mask:0xf bank_mask:0xf
  v_mul_f32 v88, v9, v88
  v_mul_f32 v89, v9, v89
  ds_write_b64 v8, v[88:89] offset:1024
  s_waitcnt vmcnt(1)
  v_dot2c_f32_bf16 v96, v56, v167
  v_dot2c_f32_bf16 v97, v56, v10
  v_dot2c_f32_bf16 v98, v57, v167
  v_dot2c_f32_bf16 v99, v57, v10
  v_dot2c_f32_bf16 v100, v58, v167
  v_dot2c_f32_bf16 v101, v58, v10
  v_dot2c_f32_bf16 v102, v59, v167
  v_dot2c_f32_bf16 v103, v59, v10
  v_permlane32_swap_b32 v96, v100
  v_permlane32_swap_b32 v97, v101
  v_permlane32_swap_b32 v98, v102
  v_permlane32_swap_b32 v99, v103
  v_add_f32 v96, v96, v100
  v_add_f32 v97, v97, v101
  v_add_f32 v98, v98, v102
  v_add_f32 v99, v99, v103
  s_nop 0
  v_permlane16_swap_b32 v96, v98
  v_permlane16_swap_b32 v97, v99
  v_add_f32 v96, v96, v98
  v_add_f32 v97, v97, v99
  s_nop 0
  v_add_f32_dpp v96, v96, v96 row_ror:8 row_mask:0xf bank_mask:0xf
  v_add_f32_dpp v97, v97, v97 row_ror:8 row_mask:0xf bank_mask:0xf
  v_mul_f32 v96, v9, v96
  v_mul_f32 v97, v9, v97
  ds_write_b64 v8, v[96:97] offset:1280
  s_waitcnt vmcnt(0)
  v_dot2c_f32_bf16 v104, v60, v167
  v_dot2c_f32_bf16 v105, v60, v10
  v_dot2c_f32_bf16 v106, v61, v167
  v_dot2c_f32_bf16 v107, v61, v10
  v_dot2c_f32_bf16 v108, v62, v167
  v_dot2c_f32_bf16 v109, v62, v10
  v_dot2c_f32_bf16 v110, v63, v167
  v_dot2c_f32_bf16 v111, v63, v10
  v_permlane32_swap_b32 v104, v108
  v_permlane32_swap_b32 v105, v109
  v_permlane32_swap_b32 v106, v110
  v_permlane32_swap_b32 v107, v111
  v_add_f32 v104, v104, v108
  v_add_f32 v105, v105, v109
  v_add_f32 v106, v106, v110
  v_add_f32 v107, v107, v111
  s_nop 0
  v_permlane16_swap_b32 v104, v106
  v_permlane16_swap_b32 v105, v107
  v_add_f32 v104, v104, v106
  v_add_f32 v105, v105, v107
  s_nop 0
  v_add_f32_dpp v104, v104, v104 row_ror:8 row_mask:0xf bank_mask:0xf
  v_add_f32_dpp v105, v105, v105 row_ror:8 row_mask:0xf bank_mask:0xf
  v_mul_f32 v104, v9, v104
  v_mul_f32 v105, v9, v105
  ds_write_b64 v8, v[104:105] offset:1536
  s_mov_b64 exec, 1
  ds_add_rtn_u32 v10, v2, v11 offset:640
  s_mov_b64 exec, -1
  ds_read_b128 v[16:19], v12 offset:1024
  ds_read_b128 v[20:23], v12 offset:1792
  ds_read_b128 v[24:27], v12 offset:2560
  ds_read_b128 v[28:31], v12 offset:3328
  ds_read_b128 v[32:35], v12 offset:4096
  ds_read_b128 v[36:39], v12 offset:4864
  ds_read_b128 v[40:43], v12 offset:5632
  ds_read_b128 v[44:47], v12 offset:6400
  s_waitcnt lgkmcnt(8)
  v_readfirstlane_b32 s68, v10
  s_nop 0
  s_cmp_lg_u32 s68, 7
  s_cbranch_scc1 L_nopub
  s_waitcnt lgkmcnt(6)
  v_pk_add_f32 v[16:17], v[16:17], v[20:21]
  v_pk_add_f32 v[18:19], v[18:19], v[22:23]
  s_waitcnt lgkmcnt(4)
  v_pk_add_f32 v[24:25], v[24:25], v[28:29]
  v_pk_add_f32 v[26:27], v[26:27], v[30:31]
  v_pk_add_f32 v[16:17], v[16:17], v[24:25]
  v_pk_add_f32 v[18:19], v[18:19], v[26:27]
  s_waitcnt lgkmcnt(2)
  v_pk_add_f32 v[32:33], v[32:33], v[36:37]
  v_pk_add_f32 v[34:35], v[34:35], v[38:39]
  s_waitcnt lgkmcnt(0)
  v_pk_add_f32 v[40:41], v[40:41], v[44:45]
  v_pk_add_f32 v[42:43], v[42:43], v[46:47]
  v_pk_add_f32 v[32:33], v[32:33], v[40:41]
  v_pk_add_f32 v[34:35], v[34:35], v[42:43]
  v_pk_add_f32 v[4:5], v[16:17], v[32:33]
  v_pk_add_f32 v[6:7], v[18:19], v[34:35]
  v_cvt_pk_bf16_f32 v8, v4, v5
  v_cvt_pk_bf16_f32 v9, v6, v7
  v_cndmask_b32 v4, v8, v14, s[22:23]
  v_cndmask_b32 v5, v9, v15, s[22:23]
  v_cndmask_b32 v6, v14, v8, s[22:23]
  v_cndmask_b32 v7, v15, v9, s[22:23]
  s_mov_b32 exec_lo, 0xffffffff
  s_mov_b32 exec_hi, 0xffff
  buffer_store_dwordx4 v[4:7], v13, s[32:35], s74 offen
  s_mov_b64 exec, -1
  s_cmp_lg_u32 s46, 1
  s_cbranch_scc1 L_slow_25
L_back_26:
  ds_write_b32 v2, v11 offset:668
L_nopub:
  s_waitcnt lgkmcnt(0)
  s_cmp_lt_u32 s5, 20
  s_cbranch_scc1 L_notf1
  s_cmp_lt_u32 s5, 30
  s_cbranch_scc1 L_f1
  s_branch L_stream_exit
L_notf1:
  s_cmp_gt_u32 s5, 11
  s_cbranch_scc1 L_stream_exit
  s_cmp_gt_u32 s3, 6
  s_cbranch_scc1 L_f2
  s_endpgm
L_stream_exit:
  s_endpgm
L_helper:
  s_setprio 3
  s_cmp_eq_u32 s3, 3
  s_cbranch_scc1 L_ids
  v_lshlrev_b32 v1, 2, v0
  v_lshrrev_b32 v2, 3, v0
  s_mul_i32 s68, s7, 80
  v_add_u32 v3, s68, v2
  v_lshlrev_b32 v3, 1, v3
  v_mul_u32_u24 v2, 12288, v2
  v_and_b32 v7, 7, v0
  v_lshl_add_u32 v2, v7, 4, v2
  s_mul_i32 s68, s68, 12288
  s_mul_i32 s69, s6, 384
  s_add_u32 s68, s68, s69
  s_lshl_b32 s69, s3, 7
  s_add_u32 s68, s68, s69
  s_waitcnt lgkmcnt(0)
  s_barrier
  s_mov_b32 s8, s42
  s_mov_b32 s9, s43
  s_mov_b32 s10, 7864320
  s_mov_b32 s11, 0x20000
  global_load_dword v64, v1, s[36:37] offset:0
  global_load_dword v65, v1, s[36:37] offset:256
  global_load_dword v66, v1, s[36:37] offset:512
  global_load_dword v67, v1, s[36:37] offset:768
  global_load_dword v68, v1, s[36:37] offset:1024
  global_load_ushort v8, v3, s[36:37] offset:0
  global_load_ushort v9, v3, s[36:37] offset:16
  global_load_ushort v10, v3, s[36:37] offset:32
  global_load_ushort v11, v3, s[36:37] offset:48
  global_load_ushort v12, v3, s[36:37] offset:64
  global_load_ushort v13, v3, s[36:37] offset:80
  global_load_ushort v14, v3, s[36:37] offset:96
  global_load_ushort v15, v3, s[36:37] offset:112
  global_load_ushort v16, v3, s[36:37] offset:128
  global_load_ushort v17, v3, s[36:37] offset:144
  buffer_load_dwordx4 v[24:27], v2, s[8:11], s68 offen nt
  s_add_u32 s68, s68, 98304
  buffer_load_dwordx4 v[28:31], v2, s[8:11], s68 offen nt
  s_add_u32 s68, s68, 98304
  buffer_load_dwordx4 v[32:35], v2, s[8:11], s68 offen nt
  s_add_u32 s68, s68, 98304
  buffer_load_dwordx4 v[36:39], v2, s[8:11], s68 offen nt
  s_add_u32 s68, s68, 98304
  buffer_load_dwordx4 v[40:43], v2, s[8:11], s68 offen nt
  s_add_u32 s68, s68, 98304
  buffer_load_dwordx4 v[44:47], v2, s[8:11], s68 offen nt
  s_add_u32 s68, s68, 98304
  buffer_load_dwordx4 v[48:51], v2, s[8:11], s68 offen nt
  s_add_u32 s68, s68, 98304
  buffer_load_dwordx4 v[52:55], v2, s[8:11], s68 offen nt
  s_add_u32 s68, s68, 98304
  buffer_load_dwordx4 v[56:59], v2, s[8:11], s68 offen nt
  s_add_u32 s68, s68, 98304
  buffer_load_dwordx4 v[60:63], v2, s[8:11], s68 offen nt
  s_load_dwordx2 s[28:29], s[58:59], 917504
  s_mov_b32 s69, 0xffff0000
  s_mov_b32 s24, s58
  s_mov_b32 s25, s59
  s_mov_b32 s26, 4194304
  s_mov_b32 s27, 0x20000
  s_add_u32 s32, s58, 4194304
  s_addc_u32 s33, s59, 0
  s_mov_b32 s34, 4194304
  s_mov_b32 s35, 0x20000
  s_lshl3_add_u32 s71, s6, s7
  s_mul_i32 s5, s79, 5
  s_mul_i32 s47, s79, 3
  s_add_u32 s47, s47, 15
  s_cmp_lt_u32 s7, 5
  s_cselect_b32 s5, s5, s47
  s_add_u32 s5, s5, s7
  s_waitcnt lgkmcnt(0)
  s_mul_i32 s30, s28, 0x2c9277b5
  s_add_u32 s30, s30, 0xac564b05
  s_mul_i32 s31, s29, 0x0019660d
  s_add_u32 s31, s31, 0x3c6ef35f
  s_waitcnt vmcnt(20)
  v_lshlrev_b32 v70, 16, v64
  v_and_b32 v71, s69, v64
  v_lshlrev_b32 v72, 16, v65
  v_and_b32 v73, s69, v65
  v_lshlrev_b32 v74, 16, v66
  v_and_b32 v75, s69, v66
  v_lshlrev_b32 v76, 16, v67
  v_and_b32 v77, s69, v67
  v_lshlrev_b32 v78, 16, v68
  v_and_b32 v79, s69, v68
  v_add_f32 v4, v70, v71
  v_add_f32 v5, v72, v73
  v_add_f32 v6, v74, v75
  v_add_f32 v7, v76, v77
  v_add_f32 v4, v4, v5
  v_add_f32 v6, v6, v7
  v_add_f32 v5, v78, v79
  v_add_f32 v4, v4, v6
  v_add_f32 v4, v4, v5
  s_nop 1
  v_add_f32_dpp v4, v4, v4 quad_perm:[1,0,3,2] row_mask:0xf bank_mask:0xf
  s_nop 1
  v_add_f32_dpp v4, v4, v4 quad_perm:[2,3,0,1] row_mask:0xf bank_mask:0xf
  s_nop 1
  v_add_f32_dpp v4, v4, v4 row_half_mirror row_mask:0xf bank_mask:0xf
  s_nop 1
  v_add_f32_dpp v4, v4, v4 row_mirror row_mask:0xf bank_mask:0xf
  v_mov_b32 v5, v4
  s_nop 1
  v_permlane16_swap_b32 v4, v5
  v_add_f32 v4, v4, v5
  v_mov_b32 v5, v4
  s_nop 1
  v_permlane32_swap_b32 v4, v5
  v_add_f32 v4, v4, v5
  v_mul_f32 v4, 0x3acccccd, v4
  v_sub_f32 v70, v70, v4
  v_sub_f32 v71, v71, v4
  v_sub_f32 v72, v72, v4
  v_sub_f32 v73, v73, v4
  v_sub_f32 v74, v74, v4
  v_sub_f32 v75, v75, v4
  v_sub_f32 v76, v76, v4
  v_sub_f32 v77, v77, v4
  v_sub_f32 v78, v78, v4
  v_sub_f32 v79, v79, v4
  v_mul_f32 v5, v70, v70
  v_fmac_f32 v5, v71, v71
  v_fmac_f32 v5, v72, v72
  v_fmac_f32 v5, v73, v73
  v_fmac_f32 v5, v74, v74
  v_fmac_f32 v5, v75, v75
  v_fmac_f32 v5, v76, v76
  v_fmac_f32 v5, v77, v77
  v_fmac_f32 v5, v78, v78
  v_fmac_f32 v5, v79, v79
  s_nop 1
  v_add_f32_dpp v5, v5, v5 quad_perm:[1,0,3,2] row_mask:0xf bank_mask:0xf
  s_nop 1
  v_add_f32_dpp v5, v5, v5 quad_perm:[2,3,0,1] row_mask:0xf bank_mask:0xf
  s_nop 1
  v_add_f32_dpp v5, v5, v5 row_half_mirror row_mask:0xf bank_mask:0xf
  s_nop 1
  v_add_f32_dpp v5, v5, v5 row_mirror row_mask:0xf bank_mask:0xf
  v_mov_b32 v6, v5
  s_nop 1
  v_permlane16_swap_b32 v5, v6
  v_add_f32 v5, v5, v6
  v_mov_b32 v6, v5
  s_nop 1
  v_permlane32_swap_b32 v5, v6
  v_add_f32 v5, v5, v6
  v_mul_f32 v5, 0x3acccccd, v5
  v_cvt_pk_bf16_f32 v4, v4, v4
  v_lshlrev_b32 v4, 16, v4
  v_cvt_pk_bf16_f32 v5, v5, v5
  v_lshlrev_b32 v5, 16, v5
  v_add_f32 v5, 0x3727c5ac, v5
  v_cvt_pk_bf16_f32 v5, v5, v5
  v_lshlrev_b32 v5, 16, v5
  v_sqrt_f32 v5, v5
  s_nop 0
  v_cvt_pk_bf16_f32 v5, v5, v5
  v_lshlrev_b32 v5, 16, v5
  v_rcp_f32 v5, v5
  v_mov_b32 v6, 0
  s_waitcnt vmcnt(10)
  v_lshlrev_b32 v8, 16, v8
  v_lshlrev_b32 v9, 16, v9
  v_lshlrev_b32 v10, 16, v10
  v_lshlrev_b32 v11, 16, v11
  v_lshlrev_b32 v12, 16, v12
  v_lshlrev_b32 v13, 16, v13
  v_lshlrev_b32 v14, 16, v14
  v_lshlrev_b32 v15, 16, v15
  v_lshlrev_b32 v16, 16, v16
  v_lshlrev_b32 v17, 16, v17
  v_sub_f32 v8, v8, v4
  v_sub_f32 v9, v9, v4
  v_sub_f32 v10, v10, v4
  v_sub_f32 v11, v11, v4
  v_sub_f32 v12, v12, v4
  v_sub_f32 v13, v13, v4
  v_sub_f32 v14, v14, v4
  v_sub_f32 v15, v15, v4
  v_sub_f32 v16, v16, v4
  v_sub_f32 v17, v17, v4
  v_cvt_pk_bf16_f32 v8, v6, v8
  v_cvt_pk_bf16_f32 v9, v6, v9
  v_cvt_pk_bf16_f32 v10, v6, v10
  v_cvt_pk_bf16_f32 v11, v6, v11
  v_cvt_pk_bf16_f32 v12, v6, v12
  v_cvt_pk_bf16_f32 v13, v6, v13
  v_cvt_pk_bf16_f32 v14, v6, v14
  v_cvt_pk_bf16_f32 v15, v6, v15
  v_cvt_pk_bf16_f32 v16, v6, v16
  v_cvt_pk_bf16_f32 v17, v6, v17
  v_mul_f32 v8, v8, v5
  v_mul_f32 v9, v9, v5
  v_mul_f32 v10, v10, v5
  v_mul_f32 v11, v11, v5
  v_mul_f32 v12, v12, v5
  v_mul_f32 v13, v13, v5
  v_mul_f32 v14, v14, v5
  v_mul_f32 v15, v15, v5
  v_mul_f32 v16, v16, v5
  v_mul_f32 v17, v17, v5
  v_cvt_pk_bf16_f32 v70, v6, v8
  v_cvt_pk_bf16_f32 v8, v8, v6
  v_cvt_pk_bf16_f32 v71, v6, v9
  v_cvt_pk_bf16_f32 v9, v9, v6
  v_cvt_pk_bf16_f32 v72, v6, v10
  v_cvt_pk_bf16_f32 v10, v10, v6
  v_cvt_pk_bf16_f32 v73, v6, v11
  v_cvt_pk_bf16_f32 v11, v11, v6
  v_cvt_pk_bf16_f32 v74, v6, v12
  v_cvt_pk_bf16_f32 v12, v12, v6
  v_cvt_pk_bf16_f32 v75, v6, v13
  v_cvt_pk_bf16_f32 v13, v13, v6
  v_cvt_pk_bf16_f32 v76, v6, v14
  v_cvt_pk_bf16_f32 v14, v14, v6
  v_cvt_pk_bf16_f32 v77, v6, v15
  v_cvt_pk_bf16_f32 v15, v15, v6
  v_cvt_pk_bf16_f32 v78, v6, v16
  v_cvt_pk_bf16_f32 v16, v16, v6
  v_cvt_pk_bf16_f32 v79, v6, v17
  v_cvt_pk_bf16_f32 v17, v17, v6
  v_mov_b32 v80, 0
  v_mov_b32 v81, 0
  v_mov_b32 v82, 0
  v_mov_b32 v83, 0
  v_mov_b32 v84, 0
  v_mov_b32 v85, 0
  v_mov_b32 v86, 0
  v_mov_b32 v87, 0
  v_and_b32 v90, 7, v0
  v_lshrrev_b32 v6, 4, v0
  v_lshl_add_u32 v90, v90, 2, v6
  v_lshlrev_b32 v90, 4, v90
  s_lshl_b32 s64, s71, 11
  s_lshl_b32 s69, s3, 9
  s_add_u32 s64, s64, s69
  s_waitcnt vmcnt(9)
  v_dot2c_f32_bf16 v80, v24, v8
  v_dot2c_f32_bf16 v81, v24, v70
  v_dot2c_f32_bf16 v82, v25, v8
  v_dot2c_f32_bf16 v83, v25, v70
  v_dot2c_f32_bf16 v84, v26, v8
  v_dot2c_f32_bf16 v85, v26, v70
  v_dot2c_f32_bf16 v86, v27, v8
  v_dot2c_f32_bf16 v87, v27, v70
  s_waitcnt vmcnt(8)
  v_dot2c_f32_bf16 v80, v28, v9
  v_dot2c_f32_bf16 v81, v28, v71
  v_dot2c_f32_bf16 v82, v29, v9
  v_dot2c_f32_bf16 v83, v29, v71
  v_dot2c_f32_bf16 v84, v30, v9
  v_dot2c_f32_bf16 v85, v30, v71
  v_dot2c_f32_bf16 v86, v31, v9
  v_dot2c_f32_bf16 v87, v31, v71
  s_waitcnt vmcnt(7)
  v_dot2c_f32_bf16 v80, v32, v10
  v_dot2c_f32_bf16 v81, v32, v72
  v_dot2c_f32_bf16 v82, v33, v10
  v_dot2c_f32_bf16 v83, v33, v72
  v_dot2c_f32_bf16 v84, v34, v10
  v_dot2c_f32_bf16 v85, v34, v72
  v_dot2c_f32_bf16 v86, v35, v10
  v_dot2c_f32_bf16 v87, v35, v72
  s_waitcnt vmcnt(6)
  v_dot2c_f32_bf16 v80, v36, v11
  v_dot2c_f32_bf16 v81, v36, v73
  v_dot2c_f32_bf16 v82, v37, v11
  v_dot2c_f32_bf16 v83, v37, v73
  v_dot2c_f32_bf16 v84, v38, v11
  v_dot2c_f32_bf16 v85, v38, v73
  v_dot2c_f32_bf16 v86, v39, v11
  v_dot2c_f32_bf16 v87, v39, v73
  s_waitcnt vmcnt(5)
  v_dot2c_f32_bf16 v80, v40, v12
  v_dot2c_f32_bf16 v81, v40, v74
  v_dot2c_f32_bf16 v82, v41, v12
  v_dot2c_f32_bf16 v83, v41, v74
  v_dot2c_f32_bf16 v84, v42, v12
  v_dot2c_f32_bf16 v85, v42, v74
  v_dot2c_f32_bf16 v86, v43, v12
  v_dot2c_f32_bf16 v87, v43, v74
  s_waitcnt vmcnt(4)
  v_dot2c_f32_bf16 v80, v44, v13
  v_dot2c_f32_bf16 v81, v44, v75
  v_dot2c_f32_bf16 v82, v45, v13
  v_dot2c_f32_bf16 v83, v45, v75
  v_dot2c_f32_bf16 v84, v46, v13
  v_dot2c_f32_bf16 v85, v46, v75
  v_dot2c_f32_bf16 v86, v47, v13
  v_dot2c_f32_bf16 v87, v47, v75
  s_waitcnt vmcnt(3)
  v_dot2c_f32_bf16 v80, v48, v14
  v_dot2c_f32_bf16 v81, v48, v76
  v_dot2c_f32_bf16 v82, v49, v14
  v_dot2c_f32_bf16 v83, v49, v76
  v_dot2c_f32_bf16 v84, v50, v14
  v_dot2c_f32_bf16 v85, v50, v76
  v_dot2c_f32_bf16 v86, v51, v14
  v_dot2c_f32_bf16 v87, v51, v76
  s_waitcnt vmcnt(2)
  v_dot2c_f32_bf16 v80, v52, v15
  v_dot2c_f32_bf16 v81, v52, v77
  v_dot2c_f32_bf16 v82, v53, v15
  v_dot2c_f32_bf16 v83, v53, v77
  v_dot2c_f32_bf16 v84, v54, v15
  v_dot2c_f32_bf16 v85, v54, v77
  v_dot2c_f32_bf16 v86, v55, v15
  v_dot2c_f32_bf16 v87, v55, v77
  s_waitcnt vmcnt(1)
  v_dot2c_f32_bf16 v80, v56, v16
  v_dot2c_f32_bf16 v81, v56, v78
  v_dot2c_f32_bf16 v82, v57, v16
  v_dot2c_f32_bf16 v83, v57, v78
  v_dot2c_f32_bf16 v84, v58, v16
  v_dot2c_f32_bf16 v85, v58, v78
  v_dot2c_f32_bf16 v86, v59, v16
  v_dot2c_f32_bf16 v87, v59, v78
  s_waitcnt vmcnt(0)
  v_dot2c_f32_bf16 v80, v60, v17
  v_dot2c_f32_bf16 v81, v60, v79
  v_dot2c_f32_bf16 v82, v61, v17
  v_dot2c_f32_bf16 v83, v61, v79
  v_dot2c_f32_bf16 v84, v62, v17
  v_dot2c_f32_bf16 v85, v62, v79
  v_dot2c_f32_bf16 v86, v63, v17
  v_dot2c_f32_bf16 v87, v63, v79
  v_permlane32_swap_b32 v80, v84
  v_permlane32_swap_b32 v81, v85
  v_permlane32_swap_b32 v82, v86
  v_permlane32_swap_b32 v83, v87
  v_add_f32 v80, v80, v84
  v_add_f32 v81, v81, v85
  v_add_f32 v82, v82, v86
  v_add_f32 v83, v83, v87
  s_nop 0
  v_permlane16_swap_b32 v80, v82
  v_permlane16_swap_b32 v81, v83
  v_add_f32 v80, v80, v82
  v_add_f32 v81, v81, v83
  s_nop 0
  v_add_f32_dpp v80, v80, v80 row_ror:8 row_mask:0xf bank_mask:0xf
  v_add_f32_dpp v81, v81, v81 row_ror:8 row_mask:0xf bank_mask:0xf
  v_mov_b32 v82, s30
  v_mov_b32 v83, s31
  s_mov_b32 exec_lo, 0xff00ff
  s_mov_b32 exec_hi, 0xff00ff
  buffer_store_dwordx4 v[80:83], v90, s[32:35], s64 offen offset:0
  s_mov_b64 exec, -1
  v_and_b32 v3, 31, v0
  v_lshrrev_b32 v2, 5, v0
  v_lshlrev_b32 v2, 11, v2
  v_lshl_add_u32 v2, v3, 4, v2
  s_lshl_b32 s68, s6, 14
  s_add_u32 s60, s68, s69
  s_add_u32 s61, s60, 4096
  s_add_u32 s62, s60, 8192
  s_add_u32 s63, s60, 12288
  v_lshlrev_b32 v3, 2, v3
  s_lshl_b32 s69, s3, 7
  v_add_u32 v3, s69, v3
  v_mov_b32 v1, 0
  s_mov_b32 s65, 0
  s_mov_b32 s16, s32
  s_mov_b32 s17, s33
  s_mov_b32 s18, 4194304
  s_mov_b32 s19, 0x20000
  s_mov_b32 s70, 200007
L_spin_27:
  buffer_load_dwordx4 v[8:11], v2, s[16:19], s60 offen offset:0 sc1 nt
  buffer_load_dwordx4 v[12:15], v2, s[16:19], s61 offen offset:0 sc1 nt
  buffer_load_dwordx4 v[16:19], v2, s[16:19], s62 offen offset:0 sc1 nt
  buffer_load_dwordx4 v[20:23], v2, s[16:19], s63 offen offset:0 sc1 nt
  s_waitcnt vmcnt(0)
  v_cmp_ne_u64 vcc, s[30:31], v[10:11]
  v_cmp_ne_u64 s[20:21], s[30:31], v[14:15]
  v_cmp_ne_u64 s[22:23], s[30:31], v[18:19]
  s_or_b64 vcc, vcc, s[20:21]
  v_cmp_ne_u64 s[20:21], s[30:31], v[22:23]
  s_or_b64 vcc, vcc, s[22:23]
  s_or_b64 vcc, vcc, s[20:21]
  s_nop 0
  s_cbranch_vccz L_sdone_28
  s_sleep 2
  ds_read_b32 v4, v1 offset:648
  s_waitcnt lgkmcnt(0)
  v_readfirstlane_b32 s46, v4
  s_nop 0
  s_sub_u32 s68, s46, s65
  s_cmp_lg_u32 s68, 2
  s_cbranch_scc1 L_qlazy_29
  s_mov_b32 exec_lo, 0xff00ff
  s_mov_b32 exec_hi, 0xff00ff
  buffer_store_dwordx4 v[80:83], v90, s[24:27], s64 offen offset:0 sc1
  s_mov_b64 exec, -1
  s_mov_b32 s65, 1
L_qlazy_29:
  s_and_b32 s99, s70, 7
  s_cselect_b32 s16, s32, s24
  s_cselect_b32 s17, s33, s25
  s_sub_u32 s70, s70, 1
  s_cbranch_scc0 L_spin_27
L_sdone_28:
  v_add_f32 v8, v8, v12
  v_add_f32 v9, v9, v13
  v_add_f32 v16, v16, v20
  v_add_f32 v17, v17, v21
  v_add_f32 v8, v8, v16
  v_add_f32 v9, v9, v17
  v_mov_b32 v10, v8
  v_mov_b32 v11, v9
  s_nop 0
  v_permlane32_swap_b32 v8, v10
  v_permlane32_swap_b32 v9, v11
  v_add_f32 v8, v8, v10
  v_add_f32 v9, v9, v11
  v_cvt_pk_bf16_f32 v8, v8, v9
  ds_write_b32 v3, v8 offset:0
  s_lshl_b32 s69, s3, 3
  v_mov_b32 v4, s69
  v_mov_b32 v6, 1
  s_waitcnt lgkmcnt(0)
  ds_write_b32 v4, v6 offset:384
  v_mov_b32 v1, 0
  s_mov_b32 s70, 200007
L_spin_30:
  ds_read_b32 v4, v1 offset:648
  s_waitcnt lgkmcnt(0)
  v_cmp_gt_u32 vcc, 1, v4
  s_nop 0
  s_cbranch_vccz L_sdone_31
  s_sleep 2
  s_sub_u32 s70, s70, 1
  s_cbranch_scc0 L_spin_30
L_sdone_31:
  v_readfirstlane_b32 s46, v4
  ds_read_b32 v4, v1 offset:648
  s_waitcnt lgkmcnt(0)
  v_readfirstlane_b32 s46, v4
  s_nop 0
  s_sub_u32 s68, s46, s65
  s_cmp_lg_u32 s68, 2
  s_cbranch_scc1 L_qlazy_32
  s_mov_b32 exec_lo, 0xff00ff
  s_mov_b32 exec_hi, 0xff00ff
  buffer_store_dwordx4 v[80:83], v90, s[24:27], s64 offen offset:0 sc1
  s_mov_b64 exec, -1
  s_mov_b32 s65, 1
L_qlazy_32:
  s_branch L_stats
L_ids:
  s_waitcnt lgkmcnt(0)
  s_memrealtime s[62:63]
  s_barrier
  s_getreg_b32 s64, hwreg(HW_REG_XCC_ID)
  s_load_dwordx2 s[28:29], s[58:59], 917504
  s_mov_b32 s24, s58
  s_mov_b32 s25, s59
  s_mov_b32 s26, 4194304
  s_mov_b32 s27, 0x20000
  s_add_u32 s32, s58, 4194304
  s_addc_u32 s33, s59, 0
  s_mov_b32 s34, 4194304
  s_mov_b32 s35, 0x20000
  s_lshl3_add_u32 s71, s6, s7
  s_mul_i32 s5, s79, 5
  s_mul_i32 s47, s79, 3
  s_add_u32 s47, s47, 15
  s_cmp_lt_u32 s7, 5
  s_cselect_b32 s5, s5, s47
  s_add_u32 s5, s5, s7
  s_waitcnt lgkmcnt(0)
  s_mul_i32 s30, s28, 0x2c9277b5
  s_add_u32 s30, s30, 0xac564b05
  s_mul_i32 s31, s29, 0x0019660d
  s_add_u32 s31, s31, 0x3c6ef35f
  s_and_b32 s64, s64, 15
  v_mov_b32 v4, s30
  v_mov_b32 v5, s31
  v_mov_b32 v6, s64
  v_mov_b32 v7, s64
  s_lshl_b32 s68, s4, 9
  s_add_u32 s68, s68, 753664
  s_lshr_b32 s65, s2, 3
  s_lshl_b32 s69, s65, 4
  v_mov_b32 v1, s69
  s_mov_b64 exec, 1
  buffer_store_dwordx4 v[4:7], v1, s[32:35], s68 offen
  s_mov_b64 exec, -1
  s_cmp_lg_u32 s65, 31
  s_cbranch_scc1 L_noinit
  v_lshlrev_b32 v12, 8, v0
  s_lshl_b32 s69, s4, 15
  s_add_u32 s69, s69, 1703936
  s_mov_b32 exec_lo, 0x8040201
  s_mov_b32 exec_hi, 0x8040201
  buffer_store_dword v4, v12, s[24:27], s69 offen sc1
  s_mov_b64 exec, -1
L_noinit:
  v_and_b32 v1, 31, v0
  v_lshlrev_b32 v1, 4, v1
  s_mov_b32 s70, 12
  s_mov_b32 s46, 2
L_idpoll:
  s_sleep 16
  buffer_load_dwordx4 v[8:11], v1, s[32:35], s68 offen sc1
  s_waitcnt vmcnt(0)
  v_cmp_ne_u64 vcc, s[30:31], v[8:9]
  s_nop 0
  s_cbranch_vccz L_iddone
  s_sub_u32 s70, s70, 1
  s_cbranch_scc0 L_idpoll
  s_branch L_idset
L_iddone:
  v_cmp_ne_u32 vcc, s64, v10
  s_nop 0
  s_cbranch_vccnz L_idset
  s_mov_b32 s46, 1
L_idset:
  v_mov_b32 v1, 0
  v_mov_b32 v4, s46
  ds_write_b32 v1, v4 offset:648
  s_cmp_lg_u32 s65, 31
  s_cbranch_scc1 L_pf
  s_lshl_b32 s69, s4, 15
  s_add_u32 s69, s69, 1703936
  s_add_u32 s22, s58, s69
  s_addc_u32 s23, s59, 0
  s_waitcnt lgkmcnt(0)
  s_mov_b32 s8, -1
  s_mov_b32 s9, -1
  s_memtime s[12:13]
  s_waitcnt lgkmcnt(0)
  s_load_dword s10, s[22:23], 0
  s_waitcnt lgkmcnt(0)
  s_memtime s[14:15]
  s_waitcnt lgkmcnt(0)
  s_sub_u32 s11, s14, s12
  s_min_u32 s8, s8, s11
  s_waitcnt lgkmcnt(0)
  s_load_dword s10, s[22:23], 8192
  s_waitcnt lgkmcnt(0)
  s_memtime s[12:13]
  s_waitcnt lgkmcnt(0)
  s_sub_u32 s11, s12, s14
  s_min_u32 s9, s9, s11
  s_waitcnt lgkmcnt(0)
  s_load_dword s10, s[22:23], 10496
  s_waitcnt lgkmcnt(0)
  s_memtime s[14:15]
  s_waitcnt lgkmcnt(0)
  s_sub_u32 s11, s14, s12
  s_min_u32 s9, s9, s11
  s_waitcnt lgkmcnt(0)
  s_load_dword s10, s[22:23], 2304
  s_waitcnt lgkmcnt(0)
  s_memtime s[12:13]
  s_waitcnt lgkmcnt(0)
  s_sub_u32 s11, s12, s14
  s_min_u32 s8, s8, s11
  s_waitcnt lgkmcnt(0)
  s_load_dword s10, s[22:23], 4608
  s_waitcnt lgkmcnt(0)
  s_memtime s[14:15]
  s_waitcnt lgkmcnt(0)
  s_sub_u32 s11, s14, s12
  s_min_u32 s8, s8, s11
  s_waitcnt lgkmcnt(0)
  s_load_dword s10, s[22:23], 12800
  s_waitcnt lgkmcnt(0)
  s_memtime s[12:13]
  s_waitcnt lgkmcnt(0)
  s_sub_u32 s11, s12, s14
  s_min_u32 s9, s9, s11
  s_waitcnt lgkmcnt(0)
  s_load_dword s10, s[22:23], 15104
  s_waitcnt lgkmcnt(0)
  s_memtime s[14:15]
  s_waitcnt lgkmcnt(0)
  s_sub_u32 s11, s14, s12
  s_min_u32 s9, s9, s11
  s_waitcnt lgkmcnt(0)
  s_load_dword s10, s[22:23], 6912
  s_waitcnt lgkmcnt(0)
  s_memtime s[12:13]
  s_waitcnt lgkmcnt(0)
  s_sub_u32 s11, s12, s14
  s_min_u32 s8, s8, s11
  s_cmp_gt_u32 s8, s9
  s_cselect_b32 s21, 1, 0
  v_mov_b32 v4, s21
  v_mov_b32 v5, s62
  v_mov_b32 v6, s30
  v_mov_b32 v7, s31
  s_lshl_b32 s69, s4, 4
  s_add_u32 s69, s69, 950272
  s_mov_b64 exec, 1
  buffer_store_dwordx4 v[4:7], v1, s[24:27], s69 offen sc1
  s_mov_b64 exec, -1
L_pf:
  s_cmp_lg_u32 s7, 6
  s_cbranch_scc1 L_nosample
  v_mov_b32 v1, 0
  s_mov_b32 s70, 200007
L_spin_33:
  ds_read_b64 v[4:5], v1 offset:696
  s_waitcnt lgkmcnt(0)
  v_cmp_gt_u32 vcc, 8, v5
  s_nop 0
  s_cbranch_vccz L_sdone_34
  s_sleep 2
  s_sub_u32 s70, s70, 1
  s_cbranch_scc0 L_spin_33
L_sdone_34:
  v_mov_b32 v5, s31
  v_lshlrev_b32 v6, 9, v0
  s_lshl_b32 s68, s6, 3
  s_add_u32 s68, s68, 958464
  s_mov_b64 exec, 7
  buffer_store_dwordx2 v[4:5], v6, s[24:27], s68 offen sc1
  s_mov_b64 exec, -1
L_nosample:
  v_mov_b32 v1, 0
  s_mov_b32 s70, 200007
L_spin_35:
  ds_read_b32 v12, v1 offset:692
  s_waitcnt lgkmcnt(0)
  v_cmp_gt_u32 vcc, 8, v12
  s_nop 0
  s_cbranch_vccz L_sdone_36
  s_sleep 4
  s_sub_u32 s70, s70, 1
  s_cbranch_scc0 L_spin_35
L_sdone_36:
  s_add_u32 s60, s58, 958464
  s_addc_u32 s61, s59, 0
  s_mov_b32 s70, 2
L_calpoll:
  s_lshl_b32 s96, s62, 8
  s_sub_u32 s96, 0, s96
  s_mov_b32 s97, 0
  s_load_dwordx16 s[8:23], s[60:61], 0
  s_load_dwordx16 s[80:95], s[60:61], 64
  s_waitcnt lgkmcnt(0)
  s_add_u32 s96, s96, s8
  s_cmp_lg_u32 s9, s31
  s_addc_u32 s97, s97, 0
  s_add_u32 s96, s96, s10
  s_cmp_lg_u32 s11, s31
  s_addc_u32 s97, s97, 0
  s_add_u32 s96, s96, s12
  s_cmp_lg_u32 s13, s31
  s_addc_u32 s97, s97, 0
  s_add_u32 s96, s96, s14
  s_cmp_lg_u32 s15, s31
  s_addc_u32 s97, s97, 0
  s_add_u32 s96, s96, s16
  s_cmp_lg_u32 s17, s31
  s_addc_u32 s97, s97, 0
  s_add_u32 s96, s96, s18
  s_cmp_lg_u32 s19, s31
  s_addc_u32 s97, s97, 0
  s_add_u32 s96, s96, s20
  s_cmp_lg_u32 s21, s31
  s_addc_u32 s97, s97, 0
  s_add_u32 s96, s96, s22
  s_cmp_lg_u32 s23, s31
  s_addc_u32 s97, s97, 0
  s_add_u32 s96, s96, s80
  s_cmp_lg_u32 s81, s31
  s_addc_u32 s97, s97, 0
  s_add_u32 s96, s96, s82
  s_cmp_lg_u32 s83, s31
  s_addc_u32 s97, s97, 0
  s_add_u32 s96, s96, s84
  s_cmp_lg_u32 s85, s31
  s_addc_u32 s97, s97, 0
  s_add_u32 s96, s96, s86
  s_cmp_lg_u32 s87, s31
  s_addc_u32 s97, s97, 0
  s_add_u32 s96, s96, s88
  s_cmp_lg_u32 s89, s31
  s_addc_u32 s97, s97, 0
  s_add_u32 s96, s96, s90
  s_cmp_lg_u32 s91, s31
  s_addc_u32 s97, s97, 0
  s_add_u32 s96, s96, s92
  s_cmp_lg_u32 s93, s31
  s_addc_u32 s97, s97, 0
  s_add_u32 s96, s96, s94
  s_cmp_lg_u32 s95, s31
  s_addc_u32 s97, s97, 0
  s_load_dwordx16 s[8:23], s[60:61], 128
  s_load_dwordx16 s[80:95], s[60:61], 192
  s_waitcnt lgkmcnt(0)
  s_add_u32 s96, s96, s8
  s_cmp_lg_u32 s9, s31
  s_addc_u32 s97, s97, 0
  s_add_u32 s96, s96, s10
  s_cmp_lg_u32 s11, s31
  s_addc_u32 s97, s97, 0
  s_add_u32 s96, s96, s12
  s_cmp_lg_u32 s13, s31
  s_addc_u32 s97, s97, 0
  s_add_u32 s96, s96, s14
  s_cmp_lg_u32 s15, s31
  s_addc_u32 s97, s97, 0
  s_add_u32 s96, s96, s16
  s_cmp_lg_u32 s17, s31
  s_addc_u32 s97, s97, 0
  s_add_u32 s96, s96, s18
  s_cmp_lg_u32 s19, s31
  s_addc_u32 s97, s97, 0
  s_add_u32 s96, s96, s20
  s_cmp_lg_u32 s21, s31
  s_addc_u32 s97, s97, 0
  s_add_u32 s96, s96, s22
  s_cmp_lg_u32 s23, s31
  s_addc_u32 s97, s97, 0
  s_add_u32 s96, s96, s80
  s_cmp_lg_u32 s81, s31
  s_addc_u32 s97, s97, 0
  s_add_u32 s96, s96, s82
  s_cmp_lg_u32 s83, s31
  s_addc_u32 s97, s97, 0
  s_add_u32 s96, s96, s84
  s_cmp_lg_u32 s85, s31
  s_addc_u32 s97, s97, 0
  s_add_u32 s96, s96, s86
  s_cmp_lg_u32 s87, s31
  s_addc_u32 s97, s97, 0
  s_add_u32 s96, s96, s88
  s_cmp_lg_u32 s89, s31
  s_addc_u32 s97, s97, 0
  s_add_u32 s96, s96, s90
  s_cmp_lg_u32 s91, s31
  s_addc_u32 s97, s97, 0
  s_add_u32 s96, s96, s92
  s_cmp_lg_u32 s93, s31
  s_addc_u32 s97, s97, 0
  s_add_u32 s96, s96, s94
  s_cmp_lg_u32 s95, s31
  s_addc_u32 s97, s97, 0
  s_cmp_eq_u32 s97, 0
  s_cbranch_scc1 L_calok
  s_add_u32 s60, s60, 512
  s_addc_u32 s61, s61, 0
  s_sub_u32 s70, s70, 1
  s_cbranch_scc1 L_stats
  s_sleep 20
  s_branch L_calpoll
L_calok:
  s_ashr_i32 s96, s96, 4
  s_mov_b32 s68, 112
  s_cmp_lt_u32 s5, 30
  s_cselect_b32 s68, -208, s68
  s_cmp_lt_u32 s5, 20
  s_cselect_b32 s68, 112, s68
  s_lshl4_add_u32 s68, s62, s68
  s_add_u32 s68, s68, s96
  v_mov_b32 v12, s68
  v_mov_b32 v13, -1
  ds_write_b64 v1, v[12:13] offset:680
L_stats:
  v_and_b32 v1, 7, v0
  v_lshlrev_b32 v1, 4, v1
  s_mov_b32 s70, 200007
L_spin_37:
  ds_read_b128 v[4:7], v1 offset:512
  s_waitcnt lgkmcnt(0)
  v_cmp_eq_u32 vcc, 0, v7
  s_nop 0
  s_cbranch_vccz L_sdone_38
  s_sleep 4
  s_sub_u32 s70, s70, 1
  s_cbranch_scc0 L_spin_37
L_sdone_38:
  s_cmp_lg_u32 s3, 3
  s_cbranch_scc1 L_nostat
  s_mov_b32 s68, 0x3fb8aa3b
  v_mov_b32 v2, v4
  s_nop 1
  v_max_f32_dpp v2, v2, v2 quad_perm:[1,0,3,2] row_mask:0xf bank_mask:0xf
  s_nop 1
  v_max_f32_dpp v2, v2, v2 quad_perm:[2,3,0,1] row_mask:0xf bank_mask:0xf
  s_nop 1
  v_max_f32_dpp v2, v2, v2 row_half_mirror row_mask:0xf bank_mask:0xf
  v_sub_f32 v4, v4, v2
  v_mul_f32 v4, s68, v4
  v_exp_f32 v4, v4
  s_nop 0
  v_mul_f32 v3, v4, v5
  s_nop 1
  v_add_f32_dpp v3, v3, v3 quad_perm:[1,0,3,2] row_mask:0xf bank_mask:0xf
  s_nop 1
  v_add_f32_dpp v3, v3, v3 quad_perm:[2,3,0,1] row_mask:0xf bank_mask:0xf
  s_nop 1
  v_add_f32_dpp v3, v3, v3 row_half_mirror row_mask:0xf bank_mask:0xf
  s_lshl_b32 s68, s71, 4
  s_add_u32 s68, s68, 720896
  v_mov_b32 v4, s30
  v_mov_b32 v5, s31
  s_mov_b32 exec_lo, 0x1
  s_mov_b32 exec_hi, 0x0
  buffer_store_dwordx4 v[2:5], v1, s[32:35], s68 offen
  s_mov_b64 exec, -1
  s_cmp_lg_u32 s46, 1
  s_cbranch_scc1 L_slow_39
L_back_40:
  s_mov_b32 s68, 950272
  s_mov_b32 s70, 200007
L_spin_41:
  buffer_load_dwordx4 v[8:11], v1, s[24:27], s68 offen sc1
  s_waitcnt vmcnt(0)
  v_cmp_ne_u64 vcc, s[30:31], v[10:11]
  s_nop 0
  s_cbranch_vccz L_sdone_42
  s_sleep 8
  s_sub_u32 s70, s70, 1
  s_cbranch_scc0 L_spin_41
L_sdone_42:
  v_cmp_ne_u32 vcc, 0, v8
  s_nop 0
  s_and_b32 s67, vcc_lo, 0xff
  s_bitset1_b32 s67, 8
  v_mov_b32 v4, s67
  v_mov_b32 v1, 0
  ds_write_b32 v1, v4 offset:660
L_nostat:
  s_cmp_lt_u32 s5, 20
  s_cbranch_scc0 L_helper_exit
  s_cmp_ge_u32 s5, 10
  s_cselect_b32 s76, 1, 0
  s_mul_i32 s77, s76, 10
  s_sub_u32 s77, s5, s77
  s_lshr_b32 s68, s3, 1
  s_lshl1_add_u32 s78, s76, s68
  v_bfe_u32 v2, v0, 4, 1
  v_lshlrev_b32 v2, 4, v2
  s_lshl_b32 s68, s78, 5
  v_add_u32 v22, s68, v2
  v_lshlrev_b32 v60, 4, v0
  s_lshl2_add_u32 s73, s4, s78
  s_mul_i32 s73, s73, 6144
  s_and_b32 s68, s3, 1
  s_mul_i32 s68, s68, 3072
  s_add_u32 s73, s73, s68
  s_add_u32 s73, s73, 524288
  v_lshlrev_b32 v62, 2, v0
  s_lshl_b32 s68, s3, 8
  v_add_u32 v61, s68, v62
  v_lshrrev_b32 v2, 5, v0
  v_lshlrev_b32 v2, 11, v2
  v_bfe_u32 v3, v0, 2, 3
  v_lshl_add_u32 v2, v3, 4, v2
  v_and_b32 v3, 1, v0
  v_lshl_add_u32 v63, v3, 13, v2
  s_lshr_b32 s75, s77, 1
  s_lshl_b32 s75, s75, 14
  s_and_b32 s68, s77, 1
  s_lshl_b32 s68, s68, 12
  s_add_u32 s75, s75, s68
  s_lshl1_add_u32 s68, s4, s76
  s_lshl_b32 s68, s68, 7
  s_add_u32 s75, s75, s68
  s_add_u32 s75, s75, 786432
  s_mov_b32 s66, 0xff00ff00
  s_mov_b32 s67, 0xff00ff00
  s_mov_b32 s8, 0x33333333
  s_mov_b32 s9, 0x33333333
  v_mov_b32 v6, s30
  v_mov_b32 v7, s31
  v_cndmask_b32 v52, 0, v6, s[66:67]
  v_cndmask_b32 v53, 0, v7, s[66:67]
  v_cndmask_b32 v54, v6, 0, s[66:67]
  v_cndmask_b32 v55, v7, 0, s[66:67]
  v_mov_b32 v50, s30
  v_mov_b32 v51, s31
  v_lshrrev_b32 v24, 4, v0
  v_lshlrev_b32 v24, 10, v24
  v_bfe_u32 v25, v0, 2, 2
  v_lshl_add_u32 v24, v25, 7, v24
  v_and_b32 v25, 3, v0
  v_lshl_add_u32 v24, v25, 3, v24
  s_mul_i32 s69, s3, 12288
  v_add_u32 v24, s69, v24
  s_cmp_lg_u32 s3, 0
  s_cbranch_scc1 L_noc
  s_lshl_b32 s72, s4, 9
  s_add_u32 s72, s72, 720896
  v_and_b32 v1, 31, v0
  v_lshlrev_b32 v1, 4, v1
  s_mov_b32 s16, s32
  s_mov_b32 s17, s33
  s_mov_b32 s18, 4194304
  s_mov_b32 s19, 0x20000
  s_mov_b32 s70, 200007
L_spin_43:
  s_sleep 24
  buffer_load_dwordx4 v[4:7], v1, s[16:19], s72 offen sc1
  s_waitcnt vmcnt(0)
  v_cmp_ne_u64 vcc, s[30:31], v[6:7]
  s_nop 0
  s_cbranch_vccz L_sdone_44
  s_and_b32 s99, s70, 7
  s_cmp_eq_u32 s46, 1
  s_cselect_b32 s99, 1, s99
  s_cmp_lg_u32 s99, 0
  s_cselect_b32 s16, s32, s24
  s_cselect_b32 s17, s33, s25
  s_sub_u32 s70, s70, 1
  s_cbranch_scc0 L_spin_43
L_sdone_44:
  s_mov_b32 s68, 0x3fb8aa3b
  v_mov_b32 v2, v4
  s_nop 1
  v_max_f32_dpp v2, v2, v2 quad_perm:[1,0,3,2] row_mask:0xf bank_mask:0xf
  s_nop 1
  v_max_f32_dpp v2, v2, v2 quad_perm:[2,3,0,1] row_mask:0xf bank_mask:0xf
  s_nop 1
  v_max_f32_dpp v2, v2, v2 row_half_mirror row_mask:0xf bank_mask:0xf
  v_sub_f32 v4, v4, v2
  v_mul_f32 v4, s68, v4
  v_exp_f32 v4, v4
  s_nop 0
  v_mul_f32 v3, v4, v5
  s_nop 1
  v_add_f32_dpp v3, v3, v3 quad_perm:[1,0,3,2] row_mask:0xf bank_mask:0xf
  s_nop 1
  v_add_f32_dpp v3, v3, v3 quad_perm:[2,3,0,1] row_mask:0xf bank_mask:0xf
  s_nop 1
  v_add_f32_dpp v3, v3, v3 row_half_mirror row_mask:0xf bank_mask:0xf
  v_rcp_f32 v3, v3
  v_lshrrev_b32 v1, 2, v1
  v_mul_f32 v4, v4, v3
  v_mov_b32 v2, 0
  v_mov_b32 v3, 1
  ds_write_b32 v1, v4 offset:768
  ds_write_b32 v2, v3 offset:664
L_noc:
  v_mov_b32 v1, 0
  s_mov_b32 s70, 200007
L_spin_45:
  ds_read_b32 v4, v1 offset:664
  s_waitcnt lgkmcnt(0)
  v_cmp_gt_u32 vcc, 1, v4
  s_nop 0
  s_cbranch_vccz L_sdone_46
  s_sleep 2
  s_sub_u32 s70, s70, 1
  s_cbranch_scc0 L_spin_45
L_sdone_46:
  ds_read_b128 v[56:59], v22 offset:768
  s_mov_b32 s12, s44
  s_mov_b32 s13, s45
  s_mov_b32 s14, 7864320
  s_mov_b32 s15, 0x20000
  v_lshrrev_b32 v21, 3, v0
  v_mul_u32_u24 v21, 1280, v21
  v_and_b32 v3, 7, v0
  v_lshl_add_u32 v21, v3, 4, v21
  s_lshl1_add_u32 s60, s4, s76
  s_lshl2_add_u32 s60, s60, s3
  s_mul_i32 s60, s60, 122880
  s_lshl_b32 s69, s77, 7
  s_add_u32 s60, s60, s69
  s_mul_i32 s61, s3, 12288
  s_add_u32 s61, s61, 8704
  v_mov_b32 v23, 1
  s_lshl_b32 s68, s3, 2
  v_mov_b32 v25, s68
  v_mov_b32 v1, 0
  s_mov_b32 s70, 200007
L_spin_47:
  ds_read_b32 v4, v1 offset:660
  s_waitcnt lgkmcnt(0)
  v_cmp_gt_u32 vcc, 1, v4
  s_nop 0
  s_cbranch_vccz L_sdone_48
  s_sleep 4
  s_sub_u32 s70, s70, 1
  s_cbranch_scc0 L_spin_47
L_sdone_48:
  v_readfirstlane_b32 s47, v4
  v_mov_b32 v1, 0
  s_mov_b32 s70, 200007
L_spin_49:
  ds_read_b32 v4, v1 offset:644
  s_waitcnt lgkmcnt(0)
  v_cmp_gt_u32 vcc, 8, v4
  s_nop 0
  s_cbranch_vccz L_sdone_50
  s_sleep 2
  s_sub_u32 s70, s70, 1
  s_cbranch_scc0 L_spin_49
L_sdone_50:
  s_mov_b32 m0, s61
  s_nop 0
  buffer_load_dwordx4 v21, s[12:15], s60 offen nt lds
  s_add_u32 s60, s60, 10240
  s_add_u32 s61, s61, 1024
  s_mov_b32 m0, s61
  s_nop 0
  buffer_load_dwordx4 v21, s[12:15], s60 offen nt lds
  s_add_u32 s60, s60, 10240
  s_add_u32 s61, s61, 1024
  s_mov_b32 m0, s61
  s_nop 0
  buffer_load_dwordx4 v21, s[12:15], s60 offen nt lds
  s_add_u32 s60, s60, 10240
  s_add_u32 s61, s61, 1024
  s_mov_b32 m0, s61
  s_nop 0
  buffer_load_dwordx4 v21, s[12:15], s60 offen nt lds
  s_add_u32 s60, s60, 10240
  s_add_u32 s61, s61, 1024
  s_mov_b32 m0, s61
  s_nop 0
  buffer_load_dwordx4 v21, s[12:15], s60 offen nt lds
  s_add_u32 s60, s60, 10240
  s_add_u32 s61, s61, 1024
  s_mov_b32 m0, s61
  s_nop 0
  buffer_load_dwordx4 v21, s[12:15], s60 offen nt lds
  s_add_u32 s60, s60, 10240
  s_add_u32 s61, s61, 1024
  s_waitcnt vmcnt(5)
  s_mov_b32 m0, s61
  s_nop 0
  buffer_load_dwordx4 v21, s[12:15], s60 offen nt lds
  s_add_u32 s60, s60, 10240
  s_add_u32 s61, s61, 1024
  s_waitcnt vmcnt(5)
  s_mov_b32 m0, s61
  s_nop 0
  buffer_load_dwordx4 v21, s[12:15], s60 offen nt lds
  s_add_u32 s60, s60, 10240
  s_add_u32 s61, s61, 1024
  s_waitcnt vmcnt(5)
  s_mov_b32 m0, s61
  s_nop 0
  buffer_load_dwordx4 v21, s[12:15], s60 offen nt lds
  s_add_u32 s60, s60, 10240
  s_add_u32 s61, s61, 1024
  s_waitcnt vmcnt(5)
  s_mov_b32 m0, s61
  s_nop 0
  buffer_load_dwordx4 v21, s[12:15], s60 offen nt lds
  s_add_u32 s60, s60, 10240
  s_add_u32 s61, s61, 1024
  s_waitcnt vmcnt(5)
  s_mov_b32 m0, s61
  s_nop 0
  buffer_load_dwordx4 v21, s[12:15], s60 offen nt lds
  s_add_u32 s60, s60, 10240
  s_add_u32 s61, s61, 1024
  s_waitcnt vmcnt(5)
  s_mov_b32 m0, s61
  s_nop 0
  buffer_load_dwordx4 v21, s[12:15], s60 offen nt lds
  s_waitcnt vmcnt(4)
  ds_read_b64_tr_b16 v[64:65], v24 offset:8704
  ds_read_b64_tr_b16 v[66:67], v24 offset:9216
  ds_read_b64_tr_b16 v[68:69], v24 offset:8736
  ds_read_b64_tr_b16 v[70:71], v24 offset:9248
  ds_read_b64_tr_b16 v[72:73], v24 offset:8768
  ds_read_b64_tr_b16 v[74:75], v24 offset:9280
  ds_read_b64_tr_b16 v[76:77], v24 offset:8800
  ds_read_b64_tr_b16 v[78:79], v24 offset:9312
  ds_read_b64_tr_b16 v[80:81], v24 offset:12800
  ds_read_b64_tr_b16 v[82:83], v24 offset:13312
  ds_read_b64_tr_b16 v[84:85], v24 offset:12832
  ds_read_b64_tr_b16 v[86:87], v24 offset:13344
  ds_read_b64_tr_b16 v[88:89], v24 offset:12864
  ds_read_b64_tr_b16 v[90:91], v24 offset:13376
  ds_read_b64_tr_b16 v[92:93], v24 offset:12896
  ds_read_b64_tr_b16 v[94:95], v24 offset:13408
  v_mov_b32 v1, 0
  s_mov_b32 s70, 200007
L_spin_51:
  ds_read_b32 v4, v1 offset:668
  s_waitcnt lgkmcnt(0)
  v_cmp_gt_u32 vcc, 1, v4
  s_nop 0
  s_cbranch_vccz L_sdone_52
  s_sleep 1
  s_sub_u32 s70, s70, 1
  s_cbranch_scc0 L_spin_51
L_sdone_52:
  s_waitcnt vmcnt(2)
  buffer_load_dwordx4 v[112:115], v60, s[32:35], s73 offen offset:0 sc1
  buffer_load_dwordx4 v[116:119], v60, s[32:35], s73 offen offset:1024 sc1
  buffer_load_dwordx4 v[120:123], v60, s[32:35], s73 offen offset:2048 sc1
  s_waitcnt vmcnt(3)
  ds_read_b64_tr_b16 v[96:97], v24 offset:16896
  ds_read_b64_tr_b16 v[98:99], v24 offset:17408
  ds_read_b64_tr_b16 v[100:101], v24 offset:16928
  ds_read_b64_tr_b16 v[102:103], v24 offset:17440
  ds_read_b64_tr_b16 v[104:105], v24 offset:16960
  ds_read_b64_tr_b16 v[106:107], v24 offset:17472
  ds_read_b64_tr_b16 v[108:109], v24 offset:16992
  ds_read_b64_tr_b16 v[110:111], v24 offset:17504
  s_waitcnt lgkmcnt(0)
  s_mov_b32 s16, s32
  s_mov_b32 s17, s33
  s_mov_b32 s18, 4194304
  s_mov_b32 s19, 0x20000
  s_mov_b32 s70, 200007
  s_branch L_opw
L_spin_53:
  buffer_load_dwordx4 v[112:115], v60, s[16:19], s73 offen offset:0 sc1
  buffer_load_dwordx4 v[116:119], v60, s[16:19], s73 offen offset:1024 sc1
  buffer_load_dwordx4 v[120:123], v60, s[16:19], s73 offen offset:2048 sc1
L_opw:
  s_waitcnt vmcnt(2)
  v_xor_b32 v112, v112, v52
  v_xor_b32 v113, v113, v53
  v_xor_b32 v114, v114, v54
  v_xor_b32 v115, v115, v55
  s_nop 1
  v_mfma_f32_16x16x32_bf16 v[32:35], v[112:115], v[64:67], 0
  v_mfma_f32_16x16x32_bf16 v[36:39], v[112:115], v[68:71], 0
  v_mfma_f32_16x16x32_bf16 v[40:43], v[112:115], v[72:75], 0
  v_mfma_f32_16x16x32_bf16 v[44:47], v[112:115], v[76:79], 0
  v_or_b32 v2, v112, v113
  v_or_b32 v3, v114, v115
  s_waitcnt vmcnt(1)
  v_xor_b32 v116, v116, v52
  v_xor_b32 v117, v117, v53
  v_xor_b32 v118, v118, v54
  v_xor_b32 v119, v119, v55
  s_nop 1
  v_mfma_f32_16x16x32_bf16 v[32:35], v[116:119], v[80:83], v[32:35]
  v_mfma_f32_16x16x32_bf16 v[36:39], v[116:119], v[84:87], v[36:39]
  v_mfma_f32_16x16x32_bf16 v[40:43], v[116:119], v[88:91], v[40:43]
  v_mfma_f32_16x16x32_bf16 v[44:47], v[116:119], v[92:95], v[44:47]
  v_or3_b32 v2, v2, v116, v117
  v_or3_b32 v3, v3, v118, v119
  s_waitcnt vmcnt(0)
  v_xor_b32 v120, v120, v52
  v_xor_b32 v121, v121, v53
  v_xor_b32 v122, v122, v54
  v_xor_b32 v123, v123, v55
  s_nop 1
  v_mfma_f32_16x16x32_bf16 v[32:35], v[120:123], v[96:99], v[32:35]
  v_mfma_f32_16x16x32_bf16 v[36:39], v[120:123], v[100:103], v[36:39]
  v_mfma_f32_16x16x32_bf16 v[40:43], v[120:123], v[104:107], v[40:43]
  v_mfma_f32_16x16x32_bf16 v[44:47], v[120:123], v[108:111], v[44:47]
  v_or3_b32 v2, v2, v120, v121
  v_or3_b32 v3, v3, v122, v123
  v_cndmask_b32 v2, v3, v2, s[66:67]
  v_cmp_ne_u32 vcc, 0, v2
  s_nop 0
  s_cbranch_vccz L_sdone_54
  s_and_b32 s99, s70, 7
  s_cmp_eq_u32 s46, 1
  s_cselect_b32 s99, 1, s99
  s_cmp_lg_u32 s99, 0
  s_cselect_b32 s16, s32, s24
  s_cselect_b32 s17, s33, s25
  s_sub_u32 s70, s70, 1
  s_cbranch_scc0 L_spin_53
L_sdone_54:
  v_mul_f32 v4, v32, v56
  v_fmac_f32 v4, v33, v57
  v_fmac_f32 v4, v34, v58
  v_fmac_f32 v4, v35, v59
  v_mul_f32 v5, v36, v56
  v_fmac_f32 v5, v37, v57
  v_fmac_f32 v5, v38, v58
  v_fmac_f32 v5, v39, v59
  v_mul_f32 v6, v40, v56
  v_fmac_f32 v6, v41, v57
  v_fmac_f32 v6, v42, v58
  v_fmac_f32 v6, v43, v59
  v_mul_f32 v7, v44, v56
  v_fmac_f32 v7, v45, v57
  v_fmac_f32 v7, v46, v58
  v_fmac_f32 v7, v47, v59
  v_permlane32_swap_b32 v4, v6
  s_nop 0
  v_permlane32_swap_b32 v5, v7
  v_add_f32 v4, v4, v6
  v_add_f32 v5, v5, v7
  s_nop 1
  v_permlane16_swap_b32 v4, v5
  v_add_f32 v4, v4, v5
  ds_write_b32 v61, v4 offset:7168
  s_cmp_lg_u32 s3, 0
  s_waitcnt lgkmcnt(0)
  s_barrier
  s_cbranch_scc1 L_post_wo
  ds_read_b32 v5, v62 offset:7424
  ds_read_b32 v6, v62 offset:7680
  ds_read_b32 v7, v62 offset:7936
  s_waitcnt lgkmcnt(0)
  v_add_f32 v4, v4, v5
  v_add_f32 v6, v6, v7
  v_add_f32 v4, v4, v6
  s_nop 1
  v_mov_b32_dpp v5, v4 quad_perm:[1,0,3,2] row_mask:0xf bank_mask:0xf
  v_cvt_pk_bf16_f32 v4, v4, v5
  s_nop 1
  v_mov_b32_dpp v48, v4 quad_perm:[0,0,0,0] row_mask:0xf bank_mask:0xf
  v_mov_b32_dpp v49, v4 quad_perm:[2,2,2,2] row_mask:0xf bank_mask:0xf
  s_mov_b64 exec, s[8:9]
  buffer_store_dwordx4 v[48:51], v63, s[24:27], s75 offen sc1
  s_barrier
  s_endpgm
L_helper_exit:
  s_endpgm
L_f1:
  s_mov_b32 s12, s48
  s_mov_b32 s13, s49
  s_mov_b32 s14, 1966080
  s_mov_b32 s15, 0x20000
  s_mov_b32 s16, s50
  s_mov_b32 s17, s51
  s_mov_b32 s18, 1966080
  s_mov_b32 s19, 0x20000
  s_sub_u32 s74, s5, 20
  v_lshrrev_b32 v3, 4, v0
  v_and_b32 v2, 7, v0
  v_lshrrev_b32 v62, 3, v0
  v_mul_u32_u24 v62, 3072, v62
  v_lshl_add_u32 v62, v2, 4, v62
  s_lshl3_add_u32 s61, s74, s73
  s_mul_i32 s61, s61, 24576
  s_mul_i32 s68, s4, 384
  s_add_u32 s61, s61, s68
  s_add_u32 s62, s61, 128
  s_add_u32 s63, s61, 256
  s_lshl_b32 s79, s73, 10
  s_add_u32 s79, s79, 8704
  v_mov_b32 v57, 0
  v_mov_b32 v6, s30
  v_mov_b32 v7, s31
  v_mov_b32 v1, 0
  s_mov_b32 s70, 200007
L_spin_55:
  ds_read_b32 v4, v1 offset:668
  s_waitcnt lgkmcnt(0)
  v_cmp_gt_u32 vcc, 1, v4
  s_nop 0
  s_cbranch_vccz L_sdone_56
  s_sleep 1
  s_sub_u32 s70, s70, 1
  s_cbranch_scc0 L_spin_55
L_sdone_56:
  s_add_u32 m0, s79, 0
  s_nop 0
  buffer_load_dwordx4 v62, s[12:15], s61 offen nt lds
  s_add_u32 m0, s79, 24576
  s_nop 0
  buffer_load_dwordx4 v62, s[16:19], s61 offen nt lds
  s_add_u32 m0, s79, 8192
  s_nop 0
  buffer_load_dwordx4 v62, s[12:15], s62 offen nt lds
  s_add_u32 m0, s79, 32768
  s_nop 0
  buffer_load_dwordx4 v62, s[16:19], s62 offen nt lds
  s_add_u32 m0, s79, 16384
  s_nop 0
  buffer_load_dwordx4 v62, s[12:15], s63 offen nt lds
  s_add_u32 m0, s79, 40960
  s_nop 0
  buffer_load_dwordx4 v62, s[16:19], s63 offen nt lds
  s_setprio 3
  s_cmp_gt_u32 s73, 1
  s_cbranch_scc1 L_f1m
  v_mov_b32 v1, 0
  s_mov_b32 s70, 200007
L_spin_57:
  ds_read_b32 v4, v1 offset:660
  s_waitcnt lgkmcnt(0)
  v_cmp_gt_u32 vcc, 1, v4
  s_nop 0
  s_cbranch_vccz L_sdone_58
  s_sleep 1
  s_sub_u32 s70, s70, 1
  s_cbranch_scc0 L_spin_57
L_sdone_58:
  v_readfirstlane_b32 s47, v4
  s_lshl1_add_u32 s74, s74, s73
  v_lshl_add_u32 v61, v2, 2, v3
  v_lshlrev_b32 v61, 1, v61
  s_lshl_b32 s68, s74, 6
  v_add_u32 v61, s68, v61
  global_load_ushort v56, v61, s[36:37]
  v_lshlrev_b32 v54, 6, v3
  v_lshl_add_u32 v54, v2, 3, v54
  v_lshlrev_b32 v55, 4, v0
  s_lshl_b32 s72, s4, 9
  s_lshl4_add_u32 s72, s74, s72
  s_add_u32 s72, s72, 2752512
  s_mul_i32 s75, s4, 20
  s_add_u32 s75, s75, s74
  s_lshl_b32 s75, s75, 8
  s_add_u32 s75, s75, 2768896
  s_mov_b32 exec_lo, 1
  s_mov_b32 exec_hi, 1
  buffer_load_dword v104, v54, s[32:35], s75 offen sc1
  s_mov_b64 exec, 1
  buffer_load_dword v105, v55, s[32:35], s72 offen sc1
  s_mov_b64 exec, -1
  s_lshr_b32 s60, s74, 2
  s_lshl_b32 s60, s60, 14
  s_and_b32 s68, s74, 3
  s_lshl_b32 s68, s68, 11
  s_add_u32 s60, s60, s68
  s_lshr_b32 s68, s47, s4
  s_and_b32 s68, s68, 1
  s_lshl_b32 s68, s68, 13
  s_add_u32 s60, s60, s68
  s_add_u32 s60, s60, 786432
  v_lshlrev_b32 v51, 4, v3
  v_lshl_add_u32 v51, v2, 1, v51
  v_and_b32 v4, 1, v0
  v_mul_u32_u24 v4, 126, v4
  v_add_u32 v51, v51, v4
  s_lshl_b32 s68, s73, 6
  v_add_u32 v51, s68, v51
  s_mov_b32 s77, 0x3f80
  s_mov_b32 s71, 0x3f800000
  v_mov_b32 v14, s30
  v_mov_b32 v15, s31
  v_mov_b32 v8, 0
  v_mov_b32 v9, 0
  v_mov_b32 v10, 0
  v_mov_b32 v11, 0
  v_not_b32 v98, s30
  v_not_b32 v102, s30
  s_waitcnt vmcnt(2)
  s_barrier
  v_lshlrev_b32 v56, 16, v56
  s_mov_b32 s70, 200007
  s_mov_b64 s[20:21], -1
  s_mov_b64 s[22:23], -1
L_ypoll:
  s_mov_b64 exec, s[20:21]
  buffer_load_dwordx4 v[96:99], v55, s[24:27], s60 offen sc1
  s_mov_b64 exec, s[22:23]
  buffer_load_dwordx4 v[100:103], v55, s[24:27], s60 offen offset:1024 sc1
  s_mov_b64 exec, -1
  v_cmp_ne_u64 s[20:21], s[30:31], v[98:99]
  v_cmp_ne_u64 s[22:23], s[30:31], v[102:103]
  s_nop 0
  s_or_b64 vcc, s[20:21], s[22:23]
  s_cbranch_scc0 L_yok
  v_cmp_ne_u64 s[20:21], s[30:31], v[98:99]
  v_cmp_ne_u64 s[22:23], s[30:31], v[102:103]
  s_nop 0
  s_or_b64 vcc, s[20:21], s[22:23]
  s_cbranch_scc0 L_yok
  v_cmp_ne_u64 s[20:21], s[30:31], v[98:99]
  v_cmp_ne_u64 s[22:23], s[30:31], v[102:103]
  s_nop 0
  s_or_b64 vcc, s[20:21], s[22:23]
  s_cbranch_scc0 L_yok
  v_cmp_ne_u64 s[20:21], s[30:31], v[98:99]
  v_cmp_ne_u64 s[22:23], s[30:31], v[102:103]
  s_nop 0
  s_or_b64 vcc, s[20:21], s[22:23]
  s_cbranch_scc0 L_yok
  v_cmp_ne_u64 s[20:21], s[30:31], v[98:99]
  v_cmp_ne_u64 s[22:23], s[30:31], v[102:103]
  s_nop 0
  s_or_b64 vcc, s[20:21], s[22:23]
  s_cbranch_scc0 L_yok
  v_cmp_ne_u64 s[20:21], s[30:31], v[98:99]
  v_cmp_ne_u64 s[22:23], s[30:31], v[102:103]
  s_nop 0
  s_or_b64 vcc, s[20:21], s[22:23]
  s_cbranch_scc0 L_yok
  s_waitcnt vmcnt(16)
  s_sub_u32 s70, s70, 1
  s_cbranch_scc0 L_ypoll
L_yok:
  v_dot2c_f32_bf16 v8, s77, v96
  v_dot2c_f32_bf16 v10, s77, v97
  v_dot2c_f32_bf16 v9, s71, v96
  v_dot2c_f32_bf16 v11, s71, v97
  v_dot2c_f32_bf16 v8, s77, v100
  v_dot2c_f32_bf16 v10, s77, v101
  v_dot2c_f32_bf16 v9, s71, v100
  v_dot2c_f32_bf16 v11, s71, v101
  s_nop 0
  v_permlane32_swap_b32 v8, v10
  s_nop 0
  v_permlane32_swap_b32 v9, v11
  v_add_f32 v8, v8, v10
  v_add_f32 v9, v9, v11
  s_nop 1
  v_permlane16_swap_b32 v8, v9
  v_add_f32 v8, v8, v9
  s_nop 1
  v_add_f32_dpp v8, v8, v8 row_ror:8 row_mask:0xf bank_mask:0xf
  v_cvt_pk_bf16_f32 v8, v57, v8
  v_add_f32 v12, v8, v56
  s_nop 1
  v_mov_b32_dpp v13, v12 quad_perm:[1,0,3,2] row_mask:0xf bank_mask:0xf
  v_cvt_pk_bf16_f32 v12, v12, v13
  ds_write_b32 v51, v12 offset:7168
  v_lshlrev_b32 v4, 16, v12
  v_mul_f32 v5, v4, v4
  s_nop 0
  v_add_f32_dpp v4, v4, v4 quad_perm:[1,0,3,2] row_mask:0xf bank_mask:0xf
  v_add_f32_dpp v5, v5, v5 quad_perm:[1,0,3,2] row_mask:0xf bank_mask:0xf
  s_nop 0
  v_add_f32_dpp v4, v4, v4 quad_perm:[2,3,0,1] row_mask:0xf bank_mask:0xf
  v_add_f32_dpp v5, v5, v5 quad_perm:[2,3,0,1] row_mask:0xf bank_mask:0xf
  s_nop 0
  v_add_f32_dpp v4, v4, v4 row_half_mirror row_mask:0xf bank_mask:0xf
  v_add_f32_dpp v5, v5, v5 row_half_mirror row_mask:0xf bank_mask:0xf
  s_waitcnt lgkmcnt(0)
  s_barrier
  v_mov_b32 v8, v4
  v_mov_b32 v9, v5
  s_nop 0
  v_permlane16_swap_b32 v4, v8
  v_permlane16_swap_b32 v5, v9
  v_add_f32 v4, v4, v8
  v_add_f32 v5, v5, v9
  v_mov_b32 v8, v4
  v_mov_b32 v9, v5
  s_nop 0
  v_permlane32_swap_b32 v4, v8
  v_permlane32_swap_b32 v5, v9
  v_add_f32 v4, v4, v8
  v_add_f32 v5, v5, v9
  s_mov_b32 exec_lo, 0x1
  s_mov_b32 exec_hi, 0x0
  buffer_store_dwordx4 v[4:7], v55, s[32:35], s72 offen
  s_mov_b32 exec_lo, 0x550055
  s_mov_b32 exec_hi, 0x550055
  buffer_store_dwordx4 v[12:15], v54, s[32:35], s75 offen
  s_mov_b64 exec, -1
  s_cmp_lg_u32 s46, 1
  s_cbranch_scc1 L_slow_59
L_back_60:
  s_endpgm
L_f1m:
  s_sub_u32 s68, s73, 2
  s_lshr_b32 s78, s68, 1
  s_and_b32 s69, s73, 1
  v_lshlrev_b32 v58, 7, v3
  v_bfe_u32 v4, v0, 2, 2
  v_lshl_add_u32 v58, v4, 9, v58
  v_and_b32 v4, 3, v0
  v_lshl_add_u32 v58, v4, 3, v58
  s_lshl_b32 s75, s78, 13
  s_lshl_b32 s68, s69, 6
  s_add_u32 s75, s75, s68
  v_add_u32 v58, s75, v58
  v_lshlrev_b32 v52, 4, v3
  v_and_b32 v59, 1, v3
  v_cmp_eq_u32 s[62:63], 1, v59
  v_mul_u32_u24 v59, 3072, v59
  v_bfe_u32 v4, v0, 3, 1
  v_lshl_add_u32 v59, v4, 9, v59
  v_lshl_add_u32 v59, v2, 4, v59
  s_mul_i32 s76, s4, 3
  s_add_u32 s76, s76, s78
  s_lshl1_add_u32 s76, s76, s69
  s_mul_i32 s76, s76, 6144
  s_lshr_b32 s68, s74, 2
  s_lshl_b32 s68, s68, 10
  s_add_u32 s76, s76, s68
  s_and_b32 s68, s74, 3
  s_lshl_b32 s68, s68, 7
  s_add_u32 s76, s76, s68
  s_add_u32 s77, s76, 3145728
  s_add_u32 s76, s76, 2228224
  v_mov_b32 v8, 0x3f803f80
  v_mov_b32 v9, 0x3f803f80
  v_mov_b32 v10, 0x3f803f80
  v_mov_b32 v11, 0x3f803f80
  v_mov_b32 v34, s30
  v_mov_b32 v35, s31
  s_waitcnt vmcnt(0)
  s_barrier
  ds_read_b64_tr_b16 v[64:65], v58 offset:8704
  ds_read_b64_tr_b16 v[66:67], v58 offset:10752
  ds_read_b64_tr_b16 v[68:69], v58 offset:8736
  ds_read_b64_tr_b16 v[70:71], v58 offset:10784
  ds_read_b64_tr_b16 v[72:73], v58 offset:33280
  ds_read_b64_tr_b16 v[74:75], v58 offset:35328
  ds_read_b64_tr_b16 v[76:77], v58 offset:33312
  ds_read_b64_tr_b16 v[78:79], v58 offset:35360
  ds_read_b64_tr_b16 v[80:81], v58 offset:12800
  ds_read_b64_tr_b16 v[82:83], v58 offset:14848
  ds_read_b64_tr_b16 v[84:85], v58 offset:12832
  ds_read_b64_tr_b16 v[86:87], v58 offset:14880
  ds_read_b64_tr_b16 v[88:89], v58 offset:37376
  ds_read_b64_tr_b16 v[90:91], v58 offset:39424
  ds_read_b64_tr_b16 v[92:93], v58 offset:37408
  ds_read_b64_tr_b16 v[94:95], v58 offset:39456
  s_waitcnt lgkmcnt(0)
  v_mfma_f32_16x16x32_bf16 v[16:19], v[8:11], v[64:67], 0
  v_mfma_f32_16x16x32_bf16 v[20:23], v[8:11], v[68:71], 0
  v_mfma_f32_16x16x32_bf16 v[24:27], v[8:11], v[72:75], 0
  v_mfma_f32_16x16x32_bf16 v[28:31], v[8:11], v[76:79], 0
  v_mfma_f32_16x16x32_bf16 v[16:19], v[8:11], v[80:83], v[16:19]
  v_mfma_f32_16x16x32_bf16 v[20:23], v[8:11], v[84:87], v[20:23]
  v_mfma_f32_16x16x32_bf16 v[24:27], v[8:11], v[88:91], v[24:27]
  v_mfma_f32_16x16x32_bf16 v[28:31], v[8:11], v[92:95], v[28:31]
  s_nop 5
  v_cndmask_b32 v32, v16, v20, s[62:63]
  s_nop 0
  v_cndmask_b32 v33, v24, v28, s[62:63]
  s_mov_b32 exec_lo, 0xffffffff
  s_mov_b32 exec_hi, 0x0
  buffer_store_dwordx4 v[32:35], v59, s[32:35], s77 offen
  s_mov_b64 exec, -1
  s_cmp_lg_u32 s46, 1
  s_cbranch_scc1 L_slow_61
L_back_62:
  s_barrier
  ds_read_b128 v[8:11], v52 offset:7168
  ds_read_b128 v[12:15], v52 offset:7232
  s_waitcnt lgkmcnt(1)
  v_mfma_f32_16x16x32_bf16 v[16:19], v[8:11], v[64:67], 0
  v_mfma_f32_16x16x32_bf16 v[20:23], v[8:11], v[68:71], 0
  v_mfma_f32_16x16x32_bf16 v[24:27], v[8:11], v[72:75], 0
  v_mfma_f32_16x16x32_bf16 v[28:31], v[8:11], v[76:79], 0
  s_waitcnt lgkmcnt(0)
  v_mfma_f32_16x16x32_bf16 v[16:19], v[12:15], v[80:83], v[16:19]
  v_mfma_f32_16x16x32_bf16 v[20:23], v[12:15], v[84:87], v[20:23]
  v_mfma_f32_16x16x32_bf16 v[24:27], v[12:15], v[88:91], v[24:27]
  v_mfma_f32_16x16x32_bf16 v[28:31], v[12:15], v[92:95], v[28:31]
  s_nop 5
  v_cndmask_b32 v4, v16, v20, s[62:63]
  s_nop 0
  v_cndmask_b32 v5, v24, v28, s[62:63]
  s_mov_b32 exec_lo, 0xffffffff
  s_mov_b32 exec_hi, 0x0
  buffer_store_dwordx4 v[4:7], v59, s[32:35], s76 offen
  s_mov_b64 exec, -1
  s_cmp_lg_u32 s46, 1
  s_cbranch_scc1 L_slow_63
L_back_64:
  s_endpgm
L_post_wo:
  s_cmp_gt_u32 s5, 11
  s_cbranch_scc1 L_end
  s_cmp_eq_u32 s3, 3
  s_cbranch_scc1 L_end
  v_mov_b32 v57, 0
  s_cmp_eq_u32 s3, 1
  s_cbranch_scc1 L_hid
  s_barrier
  s_and_b32 s68, s4, 1
  s_lshl_b32 s68, s68, 2
  s_sub_u32 s68, 12, s68
  s_cmp_ge_u32 s5, s68
  s_cbranch_scc1 L_end
  s_mul_i32 s72, s4, 5
  s_add_u32 s72, s72, 1
  s_lshr_b32 s72, s72, 1
  s_lshr_b32 s68, s5, 2
  s_add_u32 s72, s72, s68
  s_and_b32 s73, s5, 3
  v_lshrrev_b32 v2, 1, v0
  v_lshlrev_b32 v2, 7, v2
  v_and_b32 v3, 1, v0
  v_lshl_add_u32 v96, v3, 4, v2
  s_lshl_b32 s10, s72, 15
  s_lshr_b32 s68, s47, s4
  s_and_b32 s68, s68, 1
  s_lshl_b32 s68, s68, 13
  s_add_u32 s10, s10, s68
  s_lshl_b32 s68, s73, 5
  s_add_u32 s10, s10, s68
  s_add_u32 s10, s10, 1048576
  s_add_u32 s11, s10, 4096
  s_add_u32 s12, s10, 16384
  v_lshrrev_b32 v4, 4, v0
  v_lshl_add_u32 v97, v3, 2, v4
  v_lshlrev_b32 v97, 1, v97
  v_lshlrev_b32 v99, 6, v4
  v_lshlrev_b32 v98, 4, v3
  s_mul_i32 s13, s4, 20
  s_add_u32 s13, s13, s72
  s_lshl_b32 s13, s13, 8
  s_lshl4_add_u32 s13, s73, s13
  s_add_u32 s13, s13, 2768896
  s_lshl2_add_u32 s14, s72, s73
  s_lshl_b32 s14, s14, 4
  s_mov_b32 s8, 0x30003
  s_mov_b32 s9, 0x30003
  s_mov_b32 s77, 0x3f80
  s_mov_b32 s71, 0x3f800000
  v_mov_b32 v8, 0
  v_mov_b32 v9, 0
  v_mov_b32 v10, 0
  v_mov_b32 v11, 0
  s_mov_b32 s64, s54
  s_mov_b32 s65, s55
  s_mov_b32 s66, 1280
  s_mov_b32 s67, 0x20000
  s_setprio 0
  v_mov_b32 v1, 0
  s_mov_b32 s70, 200007
L_spin_65:
  ds_read_b32 v4, v1 offset:736
  s_waitcnt lgkmcnt(0)
  v_cmp_gt_u32 vcc, 1, v4
  s_nop 0
  s_cbranch_vccz L_sdone_66
  s_sub_u32 s70, s70, 1
  s_cbranch_scc0 L_spin_65
L_sdone_66:
  s_sleep 16
  s_mov_b32 s16, s32
  s_mov_b32 s17, s33
  s_mov_b32 s18, 4194304
  s_mov_b32 s19, 0x20000
  s_mov_b32 s70, 200007
L_spin_67:
  buffer_load_dwordx4 v[4:7], v99, s[16:19], s13 offen sc1
  buffer_load_dwordx4 v[16:19], v96, s[24:27], s10 offen sc1
  buffer_load_dwordx4 v[20:23], v96, s[24:27], s11 offen sc1
  buffer_load_dwordx4 v[24:27], v96, s[24:27], s12 offen sc1
  s_waitcnt vmcnt(0)
  v_cmp_ne_u64 vcc, s[30:31], v[6:7]
  v_cmp_ne_u64 s[20:21], s[30:31], v[18:19]
  v_cmp_ne_u64 s[22:23], s[30:31], v[22:23]
  s_or_b64 vcc, vcc, s[20:21]
  v_cmp_ne_u64 s[20:21], s[30:31], v[26:27]
  s_or_b64 vcc, vcc, s[22:23]
  s_or_b64 vcc, vcc, s[20:21]
  s_nop 0
  s_cbranch_vccz L_sdone_68
  s_and_b32 s99, s70, 7
  s_cmp_eq_u32 s46, 1
  s_cselect_b32 s99, 1, s99
  s_cmp_lg_u32 s99, 0
  s_cselect_b32 s16, s32, s24
  s_cselect_b32 s17, s33, s25
  s_sub_u32 s70, s70, 1
  s_cbranch_scc0 L_spin_67
L_sdone_68:
  v_dot2c_f32_bf16 v8, s77, v16
  v_dot2c_f32_bf16 v10, s77, v17
  v_dot2c_f32_bf16 v9, s71, v16
  v_dot2c_f32_bf16 v11, s71, v17
  v_dot2c_f32_bf16 v8, s77, v20
  v_dot2c_f32_bf16 v10, s77, v21
  v_dot2c_f32_bf16 v9, s71, v20
  v_dot2c_f32_bf16 v11, s71, v21
  v_dot2c_f32_bf16 v8, s77, v24
  v_dot2c_f32_bf16 v10, s77, v25
  v_dot2c_f32_bf16 v9, s71, v24
  v_dot2c_f32_bf16 v11, s71, v25
  v_lshrrev_b32 v58, v98, v4
  v_permlane32_swap_b32 v8, v10
  s_nop 0
  v_permlane32_swap_b32 v9, v11
  v_add_f32 v8, v8, v10
  v_add_f32 v9, v9, v11
  v_lshlrev_b32 v58, 16, v58
  s_nop 0
  v_permlane16_swap_b32 v8, v9
  v_add_f32 v8, v8, v9
  s_nop 1
  v_add_f32_dpp v8, v8, v8 row_ror:8 row_mask:0xf bank_mask:0xf
  s_nop 1
  v_add_f32_dpp v8, v8, v8 row_ror:4 row_mask:0xf bank_mask:0xf
  s_nop 1
  v_add_f32_dpp v8, v8, v8 quad_perm:[2,3,0,1] row_mask:0xf bank_mask:0xf
  v_cvt_pk_bf16_f32 v8, v57, v8
  v_add_f32 v8, v8, v58
  v_cvt_pk_bf16_f32 v8, v8, v8
  s_mov_b64 exec, s[8:9]
  buffer_store_short v8, v97, s[64:67], s14 offen
  s_cmp_lg_u32 s14, 0
  s_cbranch_scc1 L_fin_exit
  s_mov_b64 exec, 1
  v_mov_b32 v4, s30
  v_mov_b32 v5, s31
  s_mov_b32 s68, 917504
  buffer_store_dwordx2 v[4:5], v57, s[24:27], s68 offen
L_fin_exit:
  s_endpgm
L_hid:
  s_mul_i32 s72, s4, 12
  s_add_u32 s72, s72, s5
  v_lshrrev_b32 v4, 5, v0
  v_and_b32 v2, 7, v0
  v_lshl_add_u32 v62, v4, 3, v2
  v_lshlrev_b32 v62, 1, v62
  v_lshlrev_b32 v63, 2, v2
  v_lshlrev_b32 v60, 4, v0
  v_and_b32 v3, 31, v0
  v_lshlrev_b32 v61, 4, v3
  s_lshl_b32 s65, s4, 9
  s_add_u32 s65, s65, 2752512
  s_mul_i32 s60, s72, 3072
  s_add_u32 s62, s60, 3145728
  s_add_u32 s60, s60, 2228224
  s_mov_b32 s8, 0xfffff
  s_mov_b32 s9, 0xfffff
  s_mov_b32 s10, 0xffff
  s_mov_b32 s11, 0xffff
  v_mov_b32 v59, 1
  v_mov_b32 v24, 0
  v_mov_b32 v25, 0
  v_mov_b32 v26, s30
  v_mov_b32 v27, s31
  v_mov_b32 v136, 0
  v_mov_b32 v137, 0
  v_mov_b32 v138, s30
  v_mov_b32 v139, s31
  v_mov_b32 v140, 0
  v_mov_b32 v141, 0
  v_mov_b32 v142, s30
  v_mov_b32 v143, s31
  v_not_b32 v18, s30
  v_not_b32 v22, s30
  v_not_b32 v130, s30
  v_not_b32 v134, s30
  s_mov_b64 exec, s[10:11]
  v_not_b32 v26, s30
  v_not_b32 v138, s30
  s_mov_b64 exec, s[8:9]
  v_not_b32 v142, s30
  s_mov_b64 exec, -1
  s_barrier
  v_cmp_ne_u64 vcc, s[30:31], v[18:19]
  v_cmp_ne_u64 s[20:21], s[30:31], v[22:23]
  v_cmp_ne_u64 s[22:23], s[30:31], v[26:27]
  s_or_b64 vcc, vcc, s[20:21]
  s_or_b64 vcc, vcc, s[22:23]
  s_nop 0
  s_cbranch_vccz L_pok_70
  s_cmp_lg_u32 s46, 1
  s_cbranch_scc1 L_pslow_69
  s_mov_b32 s70, 200007
L_fp_71:
  buffer_load_dwordx4 v[16:19], v60, s[32:35], s62 offen sc1
  buffer_load_dwordx4 v[20:23], v60, s[32:35], s62 offen offset:1024 sc1
  s_mov_b64 exec, s[10:11]
  buffer_load_dwordx4 v[24:27], v60, s[32:35], s62 offen offset:2048 sc1
  s_mov_b64 exec, -1
  s_mov_b64 exec, s[8:9]
  buffer_load_dwordx4 v[140:143], v61, s[32:35], s65 offen sc1
  s_mov_b64 exec, -1
  buffer_load_dwordx4 v[128:131], v60, s[32:35], s60 offen sc1
  buffer_load_dwordx4 v[132:135], v60, s[32:35], s60 offen offset:1024 sc1
  s_mov_b64 exec, s[10:11]
  buffer_load_dwordx4 v[136:139], v60, s[32:35], s60 offen offset:2048 sc1
  s_mov_b64 exec, -1
  v_cmp_ne_u64 vcc, s[30:31], v[18:19]
  v_cmp_ne_u64 s[20:21], s[30:31], v[22:23]
  v_cmp_ne_u64 s[22:23], s[30:31], v[26:27]
  s_or_b64 vcc, vcc, s[20:21]
  s_or_b64 vcc, vcc, s[22:23]
  s_nop 0
  s_cbranch_vccz L_pok_70
  v_cmp_ne_u64 vcc, s[30:31], v[18:19]
  v_cmp_ne_u64 s[20:21], s[30:31], v[22:23]
  v_cmp_ne_u64 s[22:23], s[30:31], v[26:27]
  s_or_b64 vcc, vcc, s[20:21]
  s_or_b64 vcc, vcc, s[22:23]
  s_nop 0
  s_cbranch_vccz L_pok_70
  v_cmp_ne_u64 vcc, s[30:31], v[18:19]
  v_cmp_ne_u64 s[20:21], s[30:31], v[22:23]
  v_cmp_ne_u64 s[22:23], s[30:31], v[26:27]
  s_or_b64 vcc, vcc, s[20:21]
  s_or_b64 vcc, vcc, s[22:23]
  s_nop 0
  s_cbranch_vccz L_pok_70
  v_cmp_ne_u64 vcc, s[30:31], v[18:19]
  v_cmp_ne_u64 s[20:21], s[30:31], v[22:23]
  v_cmp_ne_u64 s[22:23], s[30:31], v[26:27]
  s_or_b64 vcc, vcc, s[20:21]
  s_or_b64 vcc, vcc, s[22:23]
  s_nop 0
  s_cbranch_vccz L_pok_70
  v_cmp_ne_u64 vcc, s[30:31], v[18:19]
  v_cmp_ne_u64 s[20:21], s[30:31], v[22:23]
  v_cmp_ne_u64 s[22:23], s[30:31], v[26:27]
  s_or_b64 vcc, vcc, s[20:21]
  s_or_b64 vcc, vcc, s[22:23]
  s_nop 0
  s_cbranch_vccz L_pok_70
  v_cmp_ne_u64 vcc, s[30:31], v[18:19]
  v_cmp_ne_u64 s[20:21], s[30:31], v[22:23]
  v_cmp_ne_u64 s[22:23], s[30:31], v[26:27]
  s_or_b64 vcc, vcc, s[20:21]
  s_or_b64 vcc, vcc, s[22:23]
  s_nop 0
  s_cbranch_vccz L_pok_70
  v_cmp_ne_u64 vcc, s[30:31], v[18:19]
  v_cmp_ne_u64 s[20:21], s[30:31], v[22:23]
  v_cmp_ne_u64 s[22:23], s[30:31], v[26:27]
  s_or_b64 vcc, vcc, s[20:21]
  s_or_b64 vcc, vcc, s[22:23]
  s_nop 0
  s_cbranch_vccz L_pok_70
  v_cmp_ne_u64 vcc, s[30:31], v[18:19]
  v_cmp_ne_u64 s[20:21], s[30:31], v[22:23]
  v_cmp_ne_u64 s[22:23], s[30:31], v[26:27]
  s_or_b64 vcc, vcc, s[20:21]
  s_or_b64 vcc, vcc, s[22:23]
  s_nop 0
  s_cbranch_vccz L_pok_70
  s_waitcnt vmcnt(14)
  s_sub_u32 s70, s70, 1
  s_cbranch_scc0 L_fp_71
  s_branch L_pok_70
L_pslow_69:
  s_mov_b32 s16, s32
  s_mov_b32 s17, s33
  s_mov_b32 s18, 4194304
  s_mov_b32 s19, 0x20000
  s_mov_b32 s70, 200007
L_spin_72:
  buffer_load_dwordx4 v[16:19], v60, s[16:19], s62 offen sc1
  buffer_load_dwordx4 v[20:23], v60, s[16:19], s62 offen offset:1024 sc1
  s_mov_b64 exec, s[10:11]
  buffer_load_dwordx4 v[24:27], v60, s[16:19], s62 offen offset:2048 sc1
  s_mov_b64 exec, -1
  s_mov_b64 exec, s[8:9]
  buffer_load_dwordx4 v[140:143], v61, s[16:19], s65 offen sc1
  s_mov_b64 exec, -1
  buffer_load_dwordx4 v[128:131], v60, s[16:19], s60 offen sc1
  buffer_load_dwordx4 v[132:135], v60, s[16:19], s60 offen offset:1024 sc1
  s_mov_b64 exec, s[10:11]
  buffer_load_dwordx4 v[136:139], v60, s[16:19], s60 offen offset:2048 sc1
  s_mov_b64 exec, -1
  s_waitcnt vmcnt(0)
  v_cmp_ne_u64 vcc, s[30:31], v[18:19]
  v_cmp_ne_u64 s[20:21], s[30:31], v[22:23]
  v_cmp_ne_u64 s[22:23], s[30:31], v[26:27]
  s_or_b64 vcc, vcc, s[20:21]
  s_or_b64 vcc, vcc, s[22:23]
  s_nop 0
  s_cbranch_vccz L_sdone_73
  s_and_b32 s99, s70, 7
  s_cmp_eq_u32 s46, 1
  s_cselect_b32 s99, 1, s99
  s_cmp_lg_u32 s99, 0
  s_cselect_b32 s16, s32, s24
  s_cselect_b32 s17, s33, s25
  s_sub_u32 s70, s70, 1
  s_cbranch_scc0 L_spin_72
L_sdone_73:
L_pok_70:
  v_pk_add_f32 v[40:41], v[16:17], v[20:21]
  v_pk_add_f32 v[40:41], v[40:41], v[24:25]
  s_nop 1
  v_add_f32_dpp v40, v40, v40 row_ror:8 row_mask:0xf bank_mask:0xf
  v_add_f32_dpp v41, v41, v41 row_ror:8 row_mask:0xf bank_mask:0xf
  v_mov_b32 v42, v40
  v_mov_b32 v43, v41
  s_nop 0
  v_permlane16_swap_b32 v40, v42
  v_permlane16_swap_b32 v41, v43
  v_add_f32 v40, v40, v42
  v_add_f32 v41, v41, v43
  v_cmp_ne_u64 vcc, s[30:31], v[142:143]
  s_nop 0
  s_cbranch_vccz L_pok_75
  s_cmp_lg_u32 s46, 1
  s_cbranch_scc1 L_pslow_74
  s_mov_b32 s70, 200007
L_fp_76:
  s_mov_b64 exec, s[8:9]
  buffer_load_dwordx4 v[140:143], v61, s[32:35], s65 offen sc1
  s_mov_b64 exec, -1
  v_cmp_ne_u64 vcc, s[30:31], v[142:143]
  s_nop 0
  s_cbranch_vccz L_pok_75
  v_cmp_ne_u64 vcc, s[30:31], v[142:143]
  s_nop 0
  s_cbranch_vccz L_pok_75
  s_waitcnt vmcnt(12)
  s_sub_u32 s70, s70, 1
  s_cbranch_scc0 L_fp_76
  s_branch L_pok_75
L_pslow_74:
  s_mov_b32 s16, s32
  s_mov_b32 s17, s33
  s_mov_b32 s18, 4194304
  s_mov_b32 s19, 0x20000
  s_mov_b32 s70, 200007
L_spin_77:
  s_mov_b64 exec, s[8:9]
  buffer_load_dwordx4 v[140:143], v61, s[16:19], s65 offen sc1
  s_mov_b64 exec, -1
  s_waitcnt vmcnt(0)
  v_cmp_ne_u64 vcc, s[30:31], v[142:143]
  s_nop 0
  s_cbranch_vccz L_sdone_78
  s_and_b32 s99, s70, 7
  s_cmp_eq_u32 s46, 1
  s_cselect_b32 s99, 1, s99
  s_cmp_lg_u32 s99, 0
  s_cselect_b32 s16, s32, s24
  s_cselect_b32 s17, s33, s25
  s_sub_u32 s70, s70, 1
  s_cbranch_scc0 L_spin_77
L_sdone_78:
L_pok_75:
  s_cmp_lg_u32 s46, 1
  s_cbranch_scc1 L_nopre
  buffer_load_dwordx4 v[128:131], v60, s[32:35], s60 offen sc1
  buffer_load_dwordx4 v[132:135], v60, s[32:35], s60 offen offset:1024 sc1
  s_mov_b64 exec, s[10:11]
  buffer_load_dwordx4 v[136:139], v60, s[32:35], s60 offen offset:2048 sc1
  s_mov_b64 exec, -1
L_nopre:
  v_add_f32_dpp v36, v140, v140 quad_perm:[1,0,3,2] row_mask:0xf bank_mask:0xf
  v_add_f32_dpp v37, v141, v141 quad_perm:[1,0,3,2] row_mask:0xf bank_mask:0xf
  s_nop 0
  v_add_f32_dpp v36, v36, v36 quad_perm:[2,3,0,1] row_mask:0xf bank_mask:0xf
  v_add_f32_dpp v37, v37, v37 quad_perm:[2,3,0,1] row_mask:0xf bank_mask:0xf
  s_nop 0
  v_add_f32_dpp v36, v36, v36 row_half_mirror row_mask:0xf bank_mask:0xf
  v_add_f32_dpp v37, v37, v37 row_half_mirror row_mask:0xf bank_mask:0xf
  s_nop 0
  v_add_f32_dpp v46, v36, v36 row_mirror row_mask:0xf bank_mask:0xf
  v_add_f32_dpp v47, v37, v37 row_mirror row_mask:0xf bank_mask:0xf
  v_add_f32_dpp v36, v36, v36 row_mirror row_mask:0xf bank_mask:0xf
  v_add_f32_dpp v37, v37, v37 row_mirror row_mask:0xf bank_mask:0xf
  s_nop 0
  v_permlane16_swap_b32 v36, v46
  v_permlane16_swap_b32 v37, v47
  v_pk_add_f32 v[36:37], v[36:37], v[46:47]
  s_cbranch_scc1 L_nopre2
  buffer_load_dwordx4 v[128:131], v60, s[32:35], s60 offen sc1
  buffer_load_dwordx4 v[132:135], v60, s[32:35], s60 offen offset:1024 sc1
  s_mov_b64 exec, s[10:11]
  buffer_load_dwordx4 v[136:139], v60, s[32:35], s60 offen offset:2048 sc1
  s_mov_b64 exec, -1
L_nopre2:
  v_mul_f32 v44, 0x3acccccd, v36
  v_mul_f32 v45, 0x3acccccd, v37
  v_fma_f32 v45, -v44, v44, v45
  v_max_f32 v45, 0, v45
  v_cvt_pk_bf16_f32 v45, v57, v45
  v_cvt_pk_bf16_f32 v44, v57, v44
  v_add_f32 v45, 0x3727c5ac, v45
  v_cvt_pk_bf16_f32 v45, v57, v45
  v_sqrt_f32 v45, v45
  v_mul_f32 v40, v44, v40
  v_cvt_pk_bf16_f32 v45, v57, v45
  v_rcp_f32 v45, v45
  v_mul_f32 v41, v44, v41
  v_cmp_ne_u64 vcc, s[30:31], v[130:131]
  v_cmp_ne_u64 s[20:21], s[30:31], v[134:135]
  v_cmp_ne_u64 s[22:23], s[30:31], v[138:139]
  s_or_b64 vcc, vcc, s[20:21]
  s_or_b64 vcc, vcc, s[22:23]
  s_nop 0
  s_cbranch_vccz L_pok_80
  s_cmp_lg_u32 s46, 1
  s_cbranch_scc1 L_pslow_79
  s_mov_b32 s70, 200007
L_fp_81:
  buffer_load_dwordx4 v[128:131], v60, s[32:35], s60 offen sc1
  buffer_load_dwordx4 v[132:135], v60, s[32:35], s60 offen offset:1024 sc1
  s_mov_b64 exec, s[10:11]
  buffer_load_dwordx4 v[136:139], v60, s[32:35], s60 offen offset:2048 sc1
  s_mov_b64 exec, -1
  v_cmp_ne_u64 vcc, s[30:31], v[130:131]
  v_cmp_ne_u64 s[20:21], s[30:31], v[134:135]
  v_cmp_ne_u64 s[22:23], s[30:31], v[138:139]
  s_or_b64 vcc, vcc, s[20:21]
  s_or_b64 vcc, vcc, s[22:23]
  s_nop 0
  s_cbranch_vccz L_pok_80
  s_waitcnt vmcnt(12)
  s_sub_u32 s70, s70, 1
  s_cbranch_scc0 L_fp_81
  s_branch L_pok_80
L_pslow_79:
  s_mov_b32 s16, s32
  s_mov_b32 s17, s33
  s_mov_b32 s18, 4194304
  s_mov_b32 s19, 0x20000
  s_mov_b32 s70, 200007
L_spin_82:
  buffer_load_dwordx4 v[128:131], v60, s[16:19], s60 offen sc1
  buffer_load_dwordx4 v[132:135], v60, s[16:19], s60 offen offset:1024 sc1
  s_mov_b64 exec, s[10:11]
  buffer_load_dwordx4 v[136:139], v60, s[16:19], s60 offen offset:2048 sc1
  s_mov_b64 exec, -1
  s_waitcnt vmcnt(0)
  v_cmp_ne_u64 vcc, s[30:31], v[130:131]
  v_cmp_ne_u64 s[20:21], s[30:31], v[134:135]
  v_cmp_ne_u64 s[22:23], s[30:31], v[138:139]
  s_or_b64 vcc, vcc, s[20:21]
  s_or_b64 vcc, vcc, s[22:23]
  s_nop 0
  s_cbranch_vccz L_sdone_83
  s_and_b32 s99, s70, 7
  s_cmp_eq_u32 s46, 1
  s_cselect_b32 s99, 1, s99
  s_cmp_lg_u32 s99, 0
  s_cselect_b32 s16, s32, s24
  s_cselect_b32 s17, s33, s25
  s_sub_u32 s70, s70, 1
  s_cbranch_scc0 L_spin_82
L_sdone_83:
L_pok_80:
  v_pk_add_f32 v[8:9], v[128:129], v[132:133]
  v_pk_add_f32 v[8:9], v[8:9], v[136:137]
  s_nop 1
  v_add_f32_dpp v10, v8, v8 row_ror:8 row_mask:0xf bank_mask:0xf
  v_add_f32_dpp v11, v9, v9 row_ror:8 row_mask:0xf bank_mask:0xf
  v_add_f32_dpp v8, v8, v8 row_ror:8 row_mask:0xf bank_mask:0xf
  v_add_f32_dpp v9, v9, v9 row_ror:8 row_mask:0xf bank_mask:0xf
  s_nop 0
  v_permlane16_swap_b32 v8, v10
  v_permlane16_swap_b32 v9, v11
  v_add_f32 v8, v8, v10
  v_sub_f32 v8, v8, v40
  v_mul_f32 v8, v8, v45
  v_cvt_pk_bf16_f32 v8, v57, v8
  v_mul_f32 v12, 0xbfb8aa3b, v8
  v_exp_f32 v12, v12
  v_add_f32 v9, v9, v11
  v_add_f32 v12, 1.0, v12
  v_rcp_f32 v12, v12
  v_sub_f32 v9, v9, v41
  v_mul_f32 v9, v9, v45
  v_mul_f32 v8, v8, v12
  v_cvt_pk_bf16_f32 v9, v57, v9
  v_cvt_pk_bf16_f32 v8, v57, v8
  v_mul_f32 v8, v8, v9
  v_cvt_pk_bf16_f32 v8, v8, v8
  ds_write_b16 v62, v8 offset:704
  ds_write_b32 v63, v59 offset:736
  s_endpgm
L_f2:
  s_mov_b32 s8, s52
  s_mov_b32 s9, s53
  s_mov_b32 s10, 1966080
  s_mov_b32 s11, 0x20000
  v_mov_b32 v17, 0
  s_mov_b32 s70, 200007
L_spin_84:
  ds_read_b32 v16, v17 offset:660
  s_waitcnt lgkmcnt(0)
  v_cmp_gt_u32 vcc, 1, v16
  s_nop 0
  s_cbranch_vccz L_sdone_85
  s_sleep 1
  s_sub_u32 s70, s70, 1
  s_cbranch_scc0 L_spin_84
L_sdone_85:
  v_readfirstlane_b32 s47, v16
  s_mul_i32 s72, s4, 12
  s_add_u32 s72, s72, s5
  v_mov_b32 v57, 0
  s_sub_u32 s68, s3, 7
  s_lshl_b32 s69, s68, 8
  v_lshlrev_b32 v58, 2, v0
  v_add_u32 v58, s69, v58
  v_lshrrev_b32 v2, 4, v0
  v_lshl_add_u32 v2, s68, 2, v2
  v_mul_u32_u24 v3, 52, v2
  v_lshrrev_b32 v3, 8, v3
  v_mul_u32_u24 v4, 5, v3
  v_sub_u32 v4, v2, v4
  v_cmp_lt_u32 vcc, 2, v4
  v_lshlrev_b32 v3, 1, v3
  s_nop 0
  v_addc_co_u32 v3, vcc, 0, v3, vcc
  v_lshrrev_b32 v3, v3, s47
  v_and_b32 v3, 1, v3
  v_lshlrev_b32 v116, 15, v2
  v_lshl_add_u32 v116, v3, 13, v116
  v_bfe_u32 v3, v0, 1, 3
  v_lshl_add_u32 v116, v3, 4, v116
  s_lshr_b32 s79, s72, 6
  s_lshl_b32 s79, s79, 14
  s_and_b32 s68, s72, 63
  s_lshl_b32 s68, s68, 7
  s_add_u32 s79, s79, s68
  s_add_u32 s79, s79, 1048576
  s_mov_b32 s60, 0x05040100
  s_mov_b32 s61, 0x07060302
  s_mul_i32 s62, s72, 20480
  v_lshrrev_b32 v2, 4, v0
  v_mul_u32_u24 v2, 1280, v2
  v_and_b32 v3, 15, v0
  v_lshl_add_u32 v2, v3, 4, v2
  s_add_u32 s62, s62, s69
  s_lshl_b32 s63, s69, 4
  v_lshlrev_b32 v3, 2, v0
  v_add_u32 v3, s63, v3
  s_add_u32 s63, s63, 8704
  s_barrier
  s_add_u32 m0, s63, 0
  s_nop 0
  buffer_load_dwordx4 v2, s[8:11], s62 offen nt lds
  s_add_u32 s62, s62, 5120
  s_add_u32 m0, s63, 1024
  s_nop 0
  buffer_load_dwordx4 v2, s[8:11], s62 offen nt lds
  s_add_u32 s62, s62, 5120
  s_add_u32 m0, s63, 2048
  s_nop 0
  buffer_load_dwordx4 v2, s[8:11], s62 offen nt lds
  s_add_u32 s62, s62, 5120
  s_add_u32 m0, s63, 3072
  s_nop 0
  buffer_load_dwordx4 v2, s[8:11], s62 offen nt lds
  s_add_u32 s62, s62, 5120
  s_barrier
  s_waitcnt vmcnt(0)
  ds_read_b32 v64, v3 offset:8704
  ds_read_b32 v65, v3 offset:8960
  ds_read_b32 v66, v3 offset:9216
  ds_read_b32 v67, v3 offset:9472
  ds_read_b32 v68, v3 offset:9728
  ds_read_b32 v69, v3 offset:9984
  ds_read_b32 v70, v3 offset:10240
  ds_read_b32 v71, v3 offset:10496
  ds_read_b32 v72, v3 offset:10752
  ds_read_b32 v73, v3 offset:11008
  ds_read_b32 v74, v3 offset:11264
  ds_read_b32 v75, v3 offset:11520
  ds_read_b32 v76, v3 offset:11776
  ds_read_b32 v77, v3 offset:12032
  ds_read_b32 v78, v3 offset:12288
  ds_read_b32 v79, v3 offset:12544
  s_waitcnt lgkmcnt(0)
  v_perm_b32 v80, v65, v64, s60
  v_perm_b32 v88, v65, v64, s61
  v_perm_b32 v81, v67, v66, s60
  v_perm_b32 v89, v67, v66, s61
  v_perm_b32 v82, v69, v68, s60
  v_perm_b32 v90, v69, v68, s61
  v_perm_b32 v83, v71, v70, s60
  v_perm_b32 v91, v71, v70, s61
  v_perm_b32 v84, v73, v72, s60
  v_perm_b32 v92, v73, v72, s61
  v_perm_b32 v85, v75, v74, s60
  v_perm_b32 v93, v75, v74, s61
  v_perm_b32 v86, v77, v76, s60
  v_perm_b32 v94, v77, v76, s61
  v_perm_b32 v87, v79, v78, s60
  v_perm_b32 v95, v79, v78, s61
  v_mov_b32 v16, 0
  v_mov_b32 v17, 0
  v_mov_b32 v18, 0
  v_mov_b32 v19, 0
  s_mov_b32 s66, 0x55555555
  s_mov_b32 s67, 0x55555555
  v_mov_b32 v6, s30
  v_mov_b32 v7, s31
  v_and_b32 v9, 15, v0
  v_lshlrev_b32 v9, 2, v9
  v_mov_b32 v8, 0
  s_mov_b32 s64, 0xff00ff00
  s_mov_b32 s65, 0xff00ff00
  s_mov_b32 s70, 1600056
  s_waitcnt lgkmcnt(0)
L_f2poll:
  ds_read_b32 v8, v9 offset:704
  s_waitcnt lgkmcnt(4)
  v_cmp_eq_u32 vcc, 0, v8
  s_sub_u32 s70, s70, 1
  s_cbranch_scc1 L_f2go
  s_and_b64 vcc, vcc, s[64:65]
  s_cbranch_scc1 L_f2poll
L_f2go:
  v_dot2c_f32_bf16_dpp v16, v8, v80 row_newbcast:0 row_mask:0xf bank_mask:0xf
  v_dot2c_f32_bf16_dpp v17, v8, v88 row_newbcast:0 row_mask:0xf bank_mask:0xf
  v_dot2c_f32_bf16_dpp v18, v8, v81 row_newbcast:1 row_mask:0xf bank_mask:0xf
  v_dot2c_f32_bf16_dpp v19, v8, v89 row_newbcast:1 row_mask:0xf bank_mask:0xf
  v_dot2c_f32_bf16_dpp v16, v8, v82 row_newbcast:2 row_mask:0xf bank_mask:0xf
  v_dot2c_f32_bf16_dpp v17, v8, v90 row_newbcast:2 row_mask:0xf bank_mask:0xf
  v_dot2c_f32_bf16_dpp v18, v8, v83 row_newbcast:3 row_mask:0xf bank_mask:0xf
  v_dot2c_f32_bf16_dpp v19, v8, v91 row_newbcast:3 row_mask:0xf bank_mask:0xf
  v_dot2c_f32_bf16_dpp v16, v8, v84 row_newbcast:4 row_mask:0xf bank_mask:0xf
  v_dot2c_f32_bf16_dpp v17, v8, v92 row_newbcast:4 row_mask:0xf bank_mask:0xf
  v_dot2c_f32_bf16_dpp v18, v8, v85 row_newbcast:5 row_mask:0xf bank_mask:0xf
  v_dot2c_f32_bf16_dpp v19, v8, v93 row_newbcast:5 row_mask:0xf bank_mask:0xf
  v_dot2c_f32_bf16_dpp v16, v8, v86 row_newbcast:6 row_mask:0xf bank_mask:0xf
  v_dot2c_f32_bf16_dpp v17, v8, v94 row_newbcast:6 row_mask:0xf bank_mask:0xf
  v_dot2c_f32_bf16_dpp v18, v8, v87 row_newbcast:7 row_mask:0xf bank_mask:0xf
  v_dot2c_f32_bf16_dpp v19, v8, v95 row_newbcast:7 row_mask:0xf bank_mask:0xf
  s_nop 2
  v_pk_add_f32 v[16:17], v[16:17], v[18:19]
  v_cvt_pk_bf16_f32 v4, v16, v17
  s_nop 1
  v_mov_b32_dpp v5, v4 quad_perm:[1,0,3,2] row_mask:0xf bank_mask:0xf
  s_mov_b64 exec, s[66:67]
  buffer_store_dwordx4 v[4:7], v116, s[24:27], s79 offen sc1
L_end:
  s_endpgm
L_slow_25:
  s_mov_b32 exec_lo, 0xffffffff
  s_mov_b32 exec_hi, 0xffff
  buffer_store_dwordx4 v[4:7], v13, s[24:27], s74 offen sc1
  s_mov_b64 exec, -1
  s_nop 1
  s_branch L_back_26
L_slow_39:
  s_mov_b32 exec_lo, 0x1
  s_mov_b32 exec_hi, 0x0
  buffer_store_dwordx4 v[2:5], v1, s[24:27], s68 offen sc1
  s_mov_b64 exec, -1
  s_nop 1
  s_branch L_back_40
L_slow_59:
  s_mov_b32 exec_lo, 0x1
  s_mov_b32 exec_hi, 0x0
  buffer_store_dwordx4 v[4:7], v55, s[24:27], s72 offen sc1
  s_mov_b32 exec_lo, 0x550055
  s_mov_b32 exec_hi, 0x550055
  buffer_store_dwordx4 v[12:15], v54, s[24:27], s75 offen sc1
  s_mov_b64 exec, -1
  s_nop 1
  s_branch L_back_60
L_slow_61:
  s_mov_b32 exec_lo, 0xffffffff
  s_mov_b32 exec_hi, 0x0
  buffer_store_dwordx4 v[32:35], v59, s[24:27], s77 offen sc1
  s_mov_b64 exec, -1
  s_nop 1
  s_branch L_back_62
L_slow_63:
  s_mov_b32 exec_lo, 0xffffffff
  s_mov_b32 exec_hi, 0x0
  buffer_store_dwordx4 v[4:7], v59, s[24:27], s76 offen sc1
  s_mov_b64 exec, -1
  s_nop 1
  s_branch L_back_64
L_codeend:
.section .rodata,"a"
.p2align 6
.amdhsa_kernel sequential_preLN__sliding_block_cached__glu_gated_swiglu__decode_kernel
  .amdhsa_next_free_vgpr 168
  .amdhsa_next_free_sgpr 100
  .amdhsa_accum_offset 168
  .amdhsa_group_segment_fixed_size 0
  .amdhsa_kernarg_size 96
  .amdhsa_user_sgpr_count 2
  .amdhsa_user_sgpr_kernarg_segment_ptr 1
  .amdhsa_system_sgpr_workgroup_id_x 1
.end_amdhsa_kernel
```

```asm
; @launch grid=(256,1,1) block=(768,1,1) lds=57856
.amdgcn_target "amdgcn-amd-amdhsa--gfx950"
.text
.globl sequential_preLN__sliding_block_cached__glu_gated_swiglu__decode_kernel
.p2align 8
.type sequential_preLN__sliding_block_cached__glu_gated_swiglu__decode_kernel,@function
sequential_preLN__sliding_block_cached__glu_gated_swiglu__decode_kernel:
  s_load_dwordx2 s[8:9], s[0:1], 8
  v_readfirstlane_b32 s3, v0
  s_lshr_b32 s79, s2, 6
  s_cmp_gt_u32 s79, 3
  s_cbranch_scc1 L_end
  s_lshr_b32 s3, s3, 6
  s_cmp_gt_u32 s3, 3
  s_cbranch_scc1 L_str
  s_getpc_b64 s[20:21]
L_pc0:
  v_lshlrev_b32 v8, 7, v0
  v_min_u32 v8, L_codeend-L_pc0-4, v8
  global_load_dword v166, v8, s[20:21]
  s_branch L_helper0
L_str:
  s_and_b32 s4, s2, 7
  s_lshl2_add_u32 s6, s4, s79
  s_bfe_u32 s7, s2, 0x30003
  s_lshl_b32 s60, s6, 10
  s_lshl1_add_u32 s60, s7, s60
  s_addk_i32 s60, 895
  s_mulk_i32 s60, 12288
  v_lshlrev_b32 v3, 4, v0
  v_lshrrev_b32 v2, 3, v0
  v_lshl_add_u32 v1, v2, 8, v3
  s_lshl_b32 s10, 3, 27
  s_mov_b32 s11, 0x20000
  s_waitcnt lgkmcnt(0)
  buffer_load_dwordx4 v[16:19], v1, s[8:11], s60 offen offset:0 nt
  buffer_load_dwordx4 v[20:23], v1, s[8:11], s60 offen offset:128 nt
  buffer_load_dwordx4 v[24:27], v1, s[8:11], s60 offen offset:256 nt
  s_branch L_stream0
L_helper0:
  s_load_dwordx16 s[36:51], s[0:1], 0
  s_load_dwordx8 s[52:59], s[0:1], 64
  s_and_b32 s4, s2, 7
  s_lshl2_add_u32 s6, s4, s79
  s_bfe_u32 s7, s2, 0x30003
  v_and_b32 v0, 63, v0
  s_cmp_lg_u32 s3, 3
  s_cbranch_scc0 L_w3
  v_lshrrev_b32 v2, 3, v0
  v_mul_u32_u24 v2, 12160, v2
  v_lshl_add_u32 v2, v0, 4, v2
  s_mul_i32 s68, s7, 7680
  s_mul_i32 s69, s6, 3
  s_add_u32 s68, s68, s69
  s_add_u32 s68, s68, s3
  s_lshl_b32 s68, s68, 7
  s_lshl_b32 s69, 3, 15
  s_mov_b32 s10, 7864320
  s_mov_b32 s11, 0x20000
  s_waitcnt lgkmcnt(0)
  s_mov_b64 s[8:9], s[42:43]
  buffer_load_dwordx4 v[24:27], v2, s[8:11], s68 offen nt
  s_add_u32 s68, s68, s69
  buffer_load_dwordx4 v[28:31], v2, s[8:11], s68 offen nt
  s_add_u32 s68, s68, s69
  buffer_load_dwordx4 v[32:35], v2, s[8:11], s68 offen nt
  s_add_u32 s68, s68, s69
  buffer_load_dwordx4 v[36:39], v2, s[8:11], s68 offen nt
  s_add_u32 s68, s68, s69
  buffer_load_dwordx4 v[40:43], v2, s[8:11], s68 offen nt
  s_add_u32 s68, s68, s69
  buffer_load_dwordx4 v[44:47], v2, s[8:11], s68 offen nt
  s_add_u32 s68, s68, s69
  buffer_load_dwordx4 v[48:51], v2, s[8:11], s68 offen nt
  s_add_u32 s68, s68, s69
  buffer_load_dwordx4 v[52:55], v2, s[8:11], s68 offen nt
  s_add_u32 s68, s68, s69
  buffer_load_dwordx4 v[56:59], v2, s[8:11], s68 offen nt
  s_add_u32 s68, s68, s69
  buffer_load_dwordx4 v[60:63], v2, s[8:11], s68 offen nt
  s_branch L_helper
L_w3:
  v_lshlrev_b32 v1, 3, v0
  v_mov_b32 v4, 0
  v_mov_b32 v5, 0
  ds_write_b64 v1, v[4:5] offset:384
  s_waitcnt lgkmcnt(0)
  s_memrealtime s[62:63]
  s_barrier
  s_load_dwordx2 s[28:29], s[58:59], 917504
  s_branch L_ids
L_stream0:
  s_load_dwordx16 s[36:51], s[0:1], 0
  s_load_dwordx8 s[52:59], s[0:1], 64
  v_and_b32 v0, 63, v0
  s_sub_u32 s73, s3, 4
  v_and_b32 v3, 0x70, v3
  s_add_u32 s61, s60, 196608
  s_waitcnt lgkmcnt(0)
  s_barrier
  s_waitcnt vmcnt(2)
  buffer_load_dwordx4 v[28:31], v1, s[8:11], s61 offen offset:0 nt
  s_load_dwordx2 s[28:29], s[58:59], 917504
  s_mov_b32 s24, s58
  s_mov_b32 s25, s59
  s_mov_b32 s26, 4194304
  s_mov_b32 s27, 0x20000
  s_add_u32 s32, s58, 4194304
  s_addc_u32 s33, s59, 0
  s_mov_b32 s34, 4194304
  s_mov_b32 s35, 0x20000
  s_lshl3_add_u32 s71, s6, s7
  s_mul_i32 s5, s79, 5
  s_mul_i32 s47, s79, 3
  s_add_u32 s47, s47, 15
  s_cmp_lt_u32 s7, 5
  s_cselect_b32 s5, s5, s47
  s_add_u32 s5, s5, s7
  s_mov_b32 s12, s40
  s_mov_b32 s13, s41
  s_mov_b32 s14, 402653184
  s_mov_b32 s15, 0x20000
  s_waitcnt vmcnt(2)
  buffer_load_dwordx4 v[32:35], v1, s[8:11], s61 offen offset:128 nt
  s_waitcnt vmcnt(2)
  buffer_load_dwordx4 v[36:39], v1, s[8:11], s61 offen offset:256 nt
  s_add_u32 s62, s61, 196608
  s_waitcnt vmcnt(2)
  buffer_load_dwordx4 v[40:43], v1, s[8:11], s62 offen offset:0 nt
  s_waitcnt vmcnt(2)
  buffer_load_dwordx4 v[44:47], v1, s[8:11], s62 offen offset:128 nt
  s_waitcnt vmcnt(2)
  buffer_load_dwordx4 v[48:51], v1, s[8:11], s62 offen offset:256 nt
  s_add_u32 s63, s62, 196608
  s_waitcnt vmcnt(2)
  buffer_load_dwordx4 v[52:55], v1, s[8:11], s63 offen offset:0 nt
  s_waitcnt vmcnt(2)
  buffer_load_dwordx4 v[56:59], v1, s[8:11], s63 offen offset:128 nt
  s_waitcnt vmcnt(2)
  buffer_load_dwordx4 v[60:63], v1, s[8:11], s63 offen offset:256 nt
  s_add_u32 s64, s63, 196608
  s_waitcnt vmcnt(2)
  buffer_load_dwordx4 v[64:67], v1, s[8:11], s64 offen offset:0 nt
  s_waitcnt vmcnt(2)
  buffer_load_dwordx4 v[68:71], v1, s[8:11], s64 offen offset:128 nt
  s_waitcnt vmcnt(2)
  buffer_load_dwordx4 v[72:75], v1, s[8:11], s64 offen offset:256 nt
  s_add_u32 s65, s64, 196608
  s_waitcnt vmcnt(2)
  buffer_load_dwordx4 v[76:79], v1, s[8:11], s65 offen offset:0 nt
  s_waitcnt vmcnt(2)
  buffer_load_dwordx4 v[80:83], v1, s[8:11], s65 offen offset:128 nt
  s_waitcnt vmcnt(2)
  buffer_load_dwordx4 v[84:87], v1, s[8:11], s65 offen offset:256 nt
  s_memrealtime s[76:77]
  s_waitcnt lgkmcnt(0)
  v_mov_b32 v6, 0
  v_mov_b32 v8, s76
  v_mov_b32 v9, 1
  s_mov_b64 exec, 1
  ds_add_u32 v6, v8 offset:696
  ds_add_u32 v6, v9 offset:700
  s_mov_b64 exec, -1
  s_add_u32 s66, s65, 196608
  s_waitcnt vmcnt(2)
  buffer_load_dwordx4 v[88:91], v1, s[8:11], s66 offen offset:0 nt
  s_waitcnt vmcnt(2)
  buffer_load_dwordx4 v[92:95], v1, s[8:11], s66 offen offset:128 nt
  s_waitcnt vmcnt(2)
  buffer_load_dwordx4 v[96:99], v1, s[8:11], s66 offen offset:256 nt
  s_add_u32 s67, s66, 196608
  s_waitcnt vmcnt(2)
  buffer_load_dwordx4 v[100:103], v1, s[8:11], s67 offen offset:0 nt
  s_waitcnt vmcnt(2)
  buffer_load_dwordx4 v[104:107], v1, s[8:11], s67 offen offset:128 nt
  s_waitcnt vmcnt(2)
  buffer_load_dwordx4 v[108:111], v1, s[8:11], s67 offen offset:256 nt
  s_waitcnt vmcnt(2)
  buffer_load_dwordx4 v[112:115], v1, s[12:15], s60 offen offset:0 nt
  s_waitcnt vmcnt(2)
  buffer_load_dwordx4 v[116:119], v1, s[12:15], s60 offen offset:128 nt
  s_waitcnt vmcnt(2)
  buffer_load_dwordx4 v[120:123], v1, s[12:15], s60 offen offset:256 nt
  v_mov_b32 v6, 0
  v_mov_b32 v7, 1
  s_mov_b64 exec, 1
  ds_add_u32 v6, v7 offset:692
  s_mov_b64 exec, -1
  s_waitcnt lgkmcnt(0)
  s_mul_i32 s30, s28, 0x2c9277b5
  s_add_u32 s30, s30, 0xac564b05
  s_mul_i32 s31, s29, 0x0019660d
  s_add_u32 s31, s31, 0x3c6ef35f
  v_and_b32 v2, 3, v0
  v_min_u32 v2, 2, v2
  v_lshlrev_b32 v2, 3, v2
  s_mov_b32 s70, 4000007
L_spin_1:
  ds_read_b32 v4, v2 offset:384
  s_waitcnt lgkmcnt(0)
  v_cmp_eq_u32 vcc, 0, v4
  s_nop 0
  s_cbranch_vccz L_sdone_2
  s_sleep 1
  s_sub_u32 s70, s70, 1
  s_cbranch_scc0 L_spin_1
L_sdone_2:
  ds_read_b128 v[4:7], v3 offset:0
  ds_read_b128 v[8:11], v3 offset:128
  ds_read_b128 v[12:15], v3 offset:256
  v_mov_b32 v160, 0
  v_mov_b32 v161, 0
  v_mov_b32 v162, 0
  v_mov_b32 v163, 0
  v_mov_b32 v164, 0
  v_mov_b32 v165, 0
  v_mov_b32 v166, 0
  v_mov_b32 v167, 0
  s_waitcnt vmcnt(3) lgkmcnt(0)
  v_dot2c_f32_bf16 v160, v16, v4
  v_dot2c_f32_bf16 v161, v28, v4
  v_dot2c_f32_bf16 v162, v40, v4
  v_dot2c_f32_bf16 v163, v52, v4
  v_dot2c_f32_bf16 v160, v17, v5
  v_dot2c_f32_bf16 v161, v29, v5
  v_dot2c_f32_bf16 v162, v41, v5
  v_dot2c_f32_bf16 v163, v53, v5
  v_dot2c_f32_bf16 v160, v18, v6
  v_dot2c_f32_bf16 v161, v30, v6
  v_dot2c_f32_bf16 v162, v42, v6
  v_dot2c_f32_bf16 v163, v54, v6
  v_dot2c_f32_bf16 v160, v19, v7
  v_dot2c_f32_bf16 v161, v31, v7
  v_dot2c_f32_bf16 v162, v43, v7
  v_dot2c_f32_bf16 v163, v55, v7
  v_dot2c_f32_bf16 v160, v20, v8
  v_dot2c_f32_bf16 v161, v32, v8
  v_dot2c_f32_bf16 v162, v44, v8
  v_dot2c_f32_bf16 v163, v56, v8
  v_dot2c_f32_bf16 v160, v21, v9
  v_dot2c_f32_bf16 v161, v33, v9
  v_dot2c_f32_bf16 v162, v45, v9
  v_dot2c_f32_bf16 v163, v57, v9
  v_dot2c_f32_bf16 v160, v22, v10
  v_dot2c_f32_bf16 v161, v34, v10
  v_dot2c_f32_bf16 v162, v46, v10
  v_dot2c_f32_bf16 v163, v58, v10
  v_dot2c_f32_bf16 v160, v23, v11
  v_dot2c_f32_bf16 v161, v35, v11
  v_dot2c_f32_bf16 v162, v47, v11
  v_dot2c_f32_bf16 v163, v59, v11
  v_dot2c_f32_bf16 v160, v24, v12
  v_dot2c_f32_bf16 v161, v36, v12
  v_dot2c_f32_bf16 v162, v48, v12
  v_dot2c_f32_bf16 v163, v60, v12
  v_dot2c_f32_bf16 v160, v25, v13
  v_dot2c_f32_bf16 v161, v37, v13
  v_dot2c_f32_bf16 v162, v49, v13
  v_dot2c_f32_bf16 v163, v61, v13
  v_dot2c_f32_bf16 v160, v26, v14
  v_dot2c_f32_bf16 v161, v38, v14
  v_dot2c_f32_bf16 v162, v50, v14
  v_dot2c_f32_bf16 v163, v62, v14
  v_dot2c_f32_bf16 v160, v27, v15
  v_dot2c_f32_bf16 v161, v39, v15
  v_dot2c_f32_bf16 v162, v51, v15
  v_dot2c_f32_bf16 v163, v63, v15
  v_dot2c_f32_bf16 v164, v64, v4
  v_dot2c_f32_bf16 v165, v76, v4
  v_dot2c_f32_bf16 v166, v88, v4
  v_dot2c_f32_bf16 v167, v100, v4
  v_dot2c_f32_bf16 v164, v65, v5
  v_dot2c_f32_bf16 v165, v77, v5
  v_dot2c_f32_bf16 v166, v89, v5
  v_dot2c_f32_bf16 v167, v101, v5
  v_dot2c_f32_bf16 v164, v66, v6
  v_dot2c_f32_bf16 v165, v78, v6
  v_dot2c_f32_bf16 v166, v90, v6
  v_dot2c_f32_bf16 v167, v102, v6
  v_dot2c_f32_bf16 v164, v67, v7
  v_dot2c_f32_bf16 v165, v79, v7
  v_dot2c_f32_bf16 v166, v91, v7
  v_dot2c_f32_bf16 v167, v103, v7
  v_dot2c_f32_bf16 v164, v68, v8
  v_dot2c_f32_bf16 v165, v80, v8
  v_dot2c_f32_bf16 v166, v92, v8
  v_dot2c_f32_bf16 v167, v104, v8
  v_dot2c_f32_bf16 v164, v69, v9
  v_dot2c_f32_bf16 v165, v81, v9
  v_dot2c_f32_bf16 v166, v93, v9
  v_dot2c_f32_bf16 v167, v105, v9
  v_dot2c_f32_bf16 v164, v70, v10
  v_dot2c_f32_bf16 v165, v82, v10
  v_dot2c_f32_bf16 v166, v94, v10
  v_dot2c_f32_bf16 v167, v106, v10
  v_dot2c_f32_bf16 v164, v71, v11
  v_dot2c_f32_bf16 v165, v83, v11
  v_dot2c_f32_bf16 v166, v95, v11
  v_dot2c_f32_bf16 v167, v107, v11
  v_dot2c_f32_bf16 v164, v72, v12
  v_dot2c_f32_bf16 v165, v84, v12
  v_dot2c_f32_bf16 v166, v96, v12
  v_dot2c_f32_bf16 v167, v108, v12
  v_dot2c_f32_bf16 v164, v73, v13
  v_dot2c_f32_bf16 v165, v85, v13
  v_dot2c_f32_bf16 v166, v97, v13
  v_dot2c_f32_bf16 v167, v109, v13
  v_dot2c_f32_bf16 v164, v74, v14
  v_dot2c_f32_bf16 v165, v86, v14
  v_dot2c_f32_bf16 v166, v98, v14
  v_dot2c_f32_bf16 v167, v110, v14
  v_dot2c_f32_bf16 v164, v75, v15
  v_dot2c_f32_bf16 v165, v87, v15
  v_dot2c_f32_bf16 v166, v99, v15
  v_dot2c_f32_bf16 v167, v111, v15
  v_add_f32_dpp v160, v160, v160 quad_perm:[1,0,3,2] row_mask:0xf bank_mask:0xf
  v_add_f32_dpp v161, v161, v161 quad_perm:[1,0,3,2] row_mask:0xf bank_mask:0xf
  v_add_f32_dpp v162, v162, v162 quad_perm:[1,0,3,2] row_mask:0xf bank_mask:0xf
  v_add_f32_dpp v163, v163, v163 quad_perm:[1,0,3,2] row_mask:0xf bank_mask:0xf
  v_add_f32_dpp v164, v164, v164 quad_perm:[1,0,3,2] row_mask:0xf bank_mask:0xf
  v_add_f32_dpp v165, v165, v165 quad_perm:[1,0,3,2] row_mask:0xf bank_mask:0xf
  v_add_f32_dpp v166, v166, v166 quad_perm:[1,0,3,2] row_mask:0xf bank_mask:0xf
  v_add_f32_dpp v167, v167, v167 quad_perm:[1,0,3,2] row_mask:0xf bank_mask:0xf
  v_add_f32_dpp v160, v160, v160 quad_perm:[2,3,0,1] row_mask:0xf bank_mask:0xf
  v_add_f32_dpp v161, v161, v161 quad_perm:[2,3,0,1] row_mask:0xf bank_mask:0xf
  v_add_f32_dpp v162, v162, v162 quad_perm:[2,3,0,1] row_mask:0xf bank_mask:0xf
  v_add_f32_dpp v163, v163, v163 quad_perm:[2,3,0,1] row_mask:0xf bank_mask:0xf
  v_add_f32_dpp v164, v164, v164 quad_perm:[2,3,0,1] row_mask:0xf bank_mask:0xf
  v_add_f32_dpp v165, v165, v165 quad_perm:[2,3,0,1] row_mask:0xf bank_mask:0xf
  v_add_f32_dpp v166, v166, v166 quad_perm:[2,3,0,1] row_mask:0xf bank_mask:0xf
  v_add_f32_dpp v167, v167, v167 quad_perm:[2,3,0,1] row_mask:0xf bank_mask:0xf
  v_add_f32_dpp v160, v160, v160 row_half_mirror row_mask:0xf bank_mask:0xf
  v_add_f32_dpp v161, v161, v161 row_half_mirror row_mask:0xf bank_mask:0xf
  v_add_f32_dpp v162, v162, v162 row_half_mirror row_mask:0xf bank_mask:0xf
  v_add_f32_dpp v163, v163, v163 row_half_mirror row_mask:0xf bank_mask:0xf
  v_add_f32_dpp v164, v164, v164 row_half_mirror row_mask:0xf bank_mask:0xf
  v_add_f32_dpp v165, v165, v165 row_half_mirror row_mask:0xf bank_mask:0xf
  v_add_f32_dpp v166, v166, v166 row_half_mirror row_mask:0xf bank_mask:0xf
  v_add_f32_dpp v167, v167, v167 row_half_mirror row_mask:0xf bank_mask:0xf
  s_mov_b32 s68, 0x3d93cd3a
  v_mov_b32 v2, 0
  v_cvt_pk_bf16_f32 v160, v2, v160
  v_cvt_pk_bf16_f32 v161, v2, v161
  v_cvt_pk_bf16_f32 v162, v2, v162
  v_cvt_pk_bf16_f32 v163, v2, v163
  v_cvt_pk_bf16_f32 v164, v2, v164
  v_cvt_pk_bf16_f32 v165, v2, v165
  v_cvt_pk_bf16_f32 v166, v2, v166
  v_cvt_pk_bf16_f32 v167, v2, v167
  v_mul_f32 v160, s68, v160
  v_mul_f32 v161, s68, v161
  v_mul_f32 v162, s68, v162
  v_mul_f32 v163, s68, v163
  v_mul_f32 v164, s68, v164
  v_mul_f32 v165, s68, v165
  v_mul_f32 v166, s68, v166
  v_mul_f32 v167, s68, v167
  v_cvt_pk_bf16_f32 v160, v2, v160
  v_cvt_pk_bf16_f32 v161, v2, v161
  v_cvt_pk_bf16_f32 v162, v2, v162
  v_cvt_pk_bf16_f32 v163, v2, v163
  v_cvt_pk_bf16_f32 v164, v2, v164
  v_cvt_pk_bf16_f32 v165, v2, v165
  v_cvt_pk_bf16_f32 v166, v2, v166
  v_cvt_pk_bf16_f32 v167, v2, v167
  v_max_f32 v4, v160, v161
  v_max3_f32 v4, v4, v162, v163
  v_max3_f32 v4, v4, v164, v165
  v_max3_f32 v4, v4, v166, v167
  s_nop 1
  v_max_f32_dpp v4, v4, v4 row_ror:8 row_mask:0xf bank_mask:0xf
  v_mov_b32 v88, v4
  s_nop 1
  v_permlane16_swap_b32 v4, v88
  v_max_f32 v4, v4, v88
  v_mov_b32 v88, v4
  s_nop 1
  v_permlane32_swap_b32 v4, v88
  v_max_f32 v4, v4, v88
  s_mov_b32 s68, 0x3fb8aa3b
  v_sub_f32 v160, v160, v4
  v_sub_f32 v161, v161, v4
  v_sub_f32 v162, v162, v4
  v_sub_f32 v163, v163, v4
  v_sub_f32 v164, v164, v4
  v_sub_f32 v165, v165, v4
  v_sub_f32 v166, v166, v4
  v_sub_f32 v167, v167, v4
  v_mul_f32 v160, s68, v160
  v_mul_f32 v161, s68, v161
  v_mul_f32 v162, s68, v162
  v_mul_f32 v163, s68, v163
  v_mul_f32 v164, s68, v164
  v_mul_f32 v165, s68, v165
  v_mul_f32 v166, s68, v166
  v_mul_f32 v167, s68, v167
  v_exp_f32 v160, v160
  v_exp_f32 v161, v161
  v_exp_f32 v162, v162
  v_exp_f32 v163, v163
  v_exp_f32 v164, v164
  v_exp_f32 v165, v165
  v_exp_f32 v166, v166
  v_exp_f32 v167, v167
  v_add_f32 v5, v160, v161
  v_add_f32 v5, v5, v162
  v_add_f32 v5, v5, v163
  v_add_f32 v5, v5, v164
  v_add_f32 v5, v5, v165
  v_add_f32 v5, v5, v166
  v_add_f32 v5, v5, v167
  s_nop 1
  v_add_f32_dpp v5, v5, v5 row_ror:8 row_mask:0xf bank_mask:0xf
  v_mov_b32 v88, v5
  s_nop 1
  v_permlane16_swap_b32 v5, v88
  v_add_f32 v5, v5, v88
  v_mov_b32 v88, v5
  s_nop 1
  v_permlane32_swap_b32 v5, v88
  v_add_f32 v5, v5, v88
  s_lshl_b32 s69, s73, 4
  v_mov_b32 v88, s69
  v_mov_b32 v6, 1
  v_mov_b32 v7, 1
  ds_write_b128 v88, v[4:7] offset:512
  v_cvt_pk_bf16_f32 v160, v160, v2
  v_cvt_pk_bf16_f32 v161, v161, v2
  v_cvt_pk_bf16_f32 v162, v162, v2
  v_cvt_pk_bf16_f32 v163, v163, v2
  v_cvt_pk_bf16_f32 v164, v164, v2
  v_cvt_pk_bf16_f32 v165, v165, v2
  v_cvt_pk_bf16_f32 v166, v166, v2
  v_cvt_pk_bf16_f32 v167, v167, v2
  v_mov_b32 v88, 0
  v_mov_b32 v89, 0
  v_mov_b32 v90, 0
  v_mov_b32 v91, 0
  v_mov_b32 v92, 0
  v_mov_b32 v93, 0
  v_mov_b32 v94, 0
  v_mov_b32 v95, 0
  v_mov_b32 v96, 0
  v_mov_b32 v97, 0
  v_mov_b32 v98, 0
  v_mov_b32 v99, 0
  v_mov_b32 v100, 0
  v_mov_b32 v101, 0
  v_mov_b32 v102, 0
  v_mov_b32 v103, 0
  v_mov_b32 v104, 0
  v_mov_b32 v105, 0
  v_mov_b32 v106, 0
  v_mov_b32 v107, 0
  v_mov_b32 v108, 0
  v_mov_b32 v109, 0
  v_mov_b32 v110, 0
  v_mov_b32 v111, 0
  v_and_b32 v8, 7, v0
  v_lshlrev_b32 v8, 5, v8
  v_lshrrev_b32 v9, 4, v0
  v_lshl_add_u32 v8, v9, 3, v8
  s_mul_i32 s69, s73, 768
  v_add_u32 v8, s69, v8
  v_mov_b32 v11, 1
  s_waitcnt vmcnt(2)
  buffer_load_dwordx4 v[124:127], v1, s[12:15], s61 offen offset:0 nt
  s_waitcnt vmcnt(2)
  buffer_load_dwordx4 v[128:131], v1, s[12:15], s61 offen offset:128 nt
  v_lshlrev_b32 v10, 16, v160
  v_dot2c_f32_bf16 v88, v112, v160
  v_dot2c_f32_bf16 v89, v112, v10
  v_dot2c_f32_bf16 v90, v113, v160
  v_dot2c_f32_bf16 v91, v113, v10
  v_dot2c_f32_bf16 v92, v114, v160
  v_dot2c_f32_bf16 v93, v114, v10
  v_dot2c_f32_bf16 v94, v115, v160
  v_dot2c_f32_bf16 v95, v115, v10
  s_waitcnt vmcnt(2)
  buffer_load_dwordx4 v[132:135], v1, s[12:15], s61 offen offset:256 nt
  s_memrealtime s[76:77]
  v_mov_b32 v6, 0
  ds_read_b64 v[6:7], v6 offset:680
  s_movk_i32 s79, 460
  s_waitcnt lgkmcnt(0)
  v_readfirstlane_b32 s78, v6
  v_readfirstlane_b32 s72, v7
  s_add_u32 s78, s78, 5520
  v_dot2c_f32_bf16 v96, v116, v160
  v_dot2c_f32_bf16 v97, v116, v10
  v_dot2c_f32_bf16 v98, v117, v160
  v_dot2c_f32_bf16 v99, v117, v10
  v_dot2c_f32_bf16 v100, v118, v160
  v_dot2c_f32_bf16 v101, v118, v10
  v_dot2c_f32_bf16 v102, v119, v160
  v_dot2c_f32_bf16 v103, v119, v10
  s_waitcnt lgkmcnt(0)
  s_lshl_b32 s75, s76, 4
  s_sub_u32 s75, s75, s78
  s_and_b32 s75, s75, s72
  s_add_u32 s78, s78, s79
  s_waitcnt vmcnt(3)
  s_cmp_gt_i32 s75, 480
  s_cbranch_scc1 L_go_3
  s_waitcnt vmcnt(2)
  s_cmp_ge_i32 s75, 0
  s_cbranch_scc1 L_go_3
  s_waitcnt vmcnt(1)
L_go_3:
  buffer_load_dwordx4 v[136:139], v1, s[12:15], s62 offen offset:0 nt
  s_memrealtime s[76:77]
  v_dot2c_f32_bf16 v104, v120, v160
  v_dot2c_f32_bf16 v105, v120, v10
  v_dot2c_f32_bf16 v106, v121, v160
  v_dot2c_f32_bf16 v107, v121, v10
  v_dot2c_f32_bf16 v108, v122, v160
  v_dot2c_f32_bf16 v109, v122, v10
  v_dot2c_f32_bf16 v110, v123, v160
  v_dot2c_f32_bf16 v111, v123, v10
  s_waitcnt lgkmcnt(0)
  s_lshl_b32 s75, s76, 4
  s_sub_u32 s75, s75, s78
  s_and_b32 s75, s75, s72
  s_add_u32 s78, s78, s79
  s_waitcnt vmcnt(3)
  s_cmp_gt_i32 s75, 480
  s_cbranch_scc1 L_go_4
  s_waitcnt vmcnt(2)
  s_cmp_ge_i32 s75, 0
  s_cbranch_scc1 L_go_4
  s_waitcnt vmcnt(1)
L_go_4:
  buffer_load_dwordx4 v[140:143], v1, s[12:15], s62 offen offset:128 nt
  s_memrealtime s[76:77]
  v_lshlrev_b32 v10, 16, v161
  v_dot2c_f32_bf16 v88, v124, v161
  v_dot2c_f32_bf16 v89, v124, v10
  v_dot2c_f32_bf16 v90, v125, v161
  v_dot2c_f32_bf16 v91, v125, v10
  v_dot2c_f32_bf16 v92, v126, v161
  v_dot2c_f32_bf16 v93, v126, v10
  v_dot2c_f32_bf16 v94, v127, v161
  v_dot2c_f32_bf16 v95, v127, v10
  s_waitcnt lgkmcnt(0)
  s_lshl_b32 s75, s76, 4
  s_sub_u32 s75, s75, s78
  s_and_b32 s75, s75, s72
  s_add_u32 s78, s78, s79
  s_waitcnt vmcnt(3)
  s_cmp_gt_i32 s75, 480
  s_cbranch_scc1 L_go_5
  s_waitcnt vmcnt(2)
  s_cmp_ge_i32 s75, 0
  s_cbranch_scc1 L_go_5
  s_waitcnt vmcnt(1)
L_go_5:
  buffer_load_dwordx4 v[144:147], v1, s[12:15], s62 offen offset:256 nt
  s_memrealtime s[76:77]
  v_dot2c_f32_bf16 v96, v128, v161
  v_dot2c_f32_bf16 v97, v128, v10
  v_dot2c_f32_bf16 v98, v129, v161
  v_dot2c_f32_bf16 v99, v129, v10
  v_dot2c_f32_bf16 v100, v130, v161
  v_dot2c_f32_bf16 v101, v130, v10
  v_dot2c_f32_bf16 v102, v131, v161
  v_dot2c_f32_bf16 v103, v131, v10
  s_waitcnt lgkmcnt(0)
  s_lshl_b32 s75, s76, 4
  s_sub_u32 s75, s75, s78
  s_and_b32 s75, s75, s72
  s_add_u32 s78, s78, s79
  s_waitcnt vmcnt(3)
  s_cmp_gt_i32 s75, 480
  s_cbranch_scc1 L_go_6
  s_waitcnt vmcnt(2)
  s_cmp_ge_i32 s75, 0
  s_cbranch_scc1 L_go_6
  s_waitcnt vmcnt(1)
L_go_6:
  buffer_load_dwordx4 v[148:151], v1, s[12:15], s63 offen offset:0 nt
  s_memrealtime s[76:77]
  v_mov_b32 v6, 0
  ds_read_b64 v[6:7], v6 offset:680
  s_movk_i32 s79, 460
  s_waitcnt lgkmcnt(0)
  v_readfirstlane_b32 s78, v6
  v_readfirstlane_b32 s72, v7
  s_add_u32 s78, s78, 7360
  v_dot2c_f32_bf16 v104, v132, v161
  v_dot2c_f32_bf16 v105, v132, v10
  v_dot2c_f32_bf16 v106, v133, v161
  v_dot2c_f32_bf16 v107, v133, v10
  v_dot2c_f32_bf16 v108, v134, v161
  v_dot2c_f32_bf16 v109, v134, v10
  v_dot2c_f32_bf16 v110, v135, v161
  v_dot2c_f32_bf16 v111, v135, v10
  s_waitcnt lgkmcnt(0)
  s_lshl_b32 s75, s76, 4
  s_sub_u32 s75, s75, s78
  s_and_b32 s75, s75, s72
  s_add_u32 s78, s78, s79
  s_waitcnt vmcnt(3)
  s_cmp_gt_i32 s75, 480
  s_cbranch_scc1 L_go_7
  s_waitcnt vmcnt(2)
  s_cmp_ge_i32 s75, 0
  s_cbranch_scc1 L_go_7
  s_waitcnt vmcnt(1)
L_go_7:
  buffer_load_dwordx4 v[152:155], v1, s[12:15], s63 offen offset:128 nt
  s_memrealtime s[76:77]
  v_lshlrev_b32 v10, 16, v162
  v_dot2c_f32_bf16 v88, v136, v162
  v_dot2c_f32_bf16 v89, v136, v10
  v_dot2c_f32_bf16 v90, v137, v162
  v_dot2c_f32_bf16 v91, v137, v10
  v_dot2c_f32_bf16 v92, v138, v162
  v_dot2c_f32_bf16 v93, v138, v10
  v_dot2c_f32_bf16 v94, v139, v162
  v_dot2c_f32_bf16 v95, v139, v10
  s_waitcnt lgkmcnt(0)
  s_lshl_b32 s75, s76, 4
  s_sub_u32 s75, s75, s78
  s_and_b32 s75, s75, s72
  s_add_u32 s78, s78, s79
  s_waitcnt vmcnt(3)
  s_cmp_gt_i32 s75, 480
  s_cbranch_scc1 L_go_8
  s_waitcnt vmcnt(2)
  s_cmp_ge_i32 s75, 0
  s_cbranch_scc1 L_go_8
  s_waitcnt vmcnt(1)
L_go_8:
  buffer_load_dwordx4 v[156:159], v1, s[12:15], s63 offen offset:256 nt
  s_memrealtime s[76:77]
  v_dot2c_f32_bf16 v96, v140, v162
  v_dot2c_f32_bf16 v97, v140, v10
  v_dot2c_f32_bf16 v98, v141, v162
  v_dot2c_f32_bf16 v99, v141, v10
  v_dot2c_f32_bf16 v100, v142, v162
  v_dot2c_f32_bf16 v101, v142, v10
  v_dot2c_f32_bf16 v102, v143, v162
  v_dot2c_f32_bf16 v103, v143, v10
  s_waitcnt lgkmcnt(0)
  s_lshl_b32 s75, s76, 4
  s_sub_u32 s75, s75, s78
  s_and_b32 s75, s75, s72
  s_add_u32 s78, s78, s79
  s_waitcnt vmcnt(3)
  s_cmp_gt_i32 s75, 480
  s_cbranch_scc1 L_go_9
  s_waitcnt vmcnt(2)
  s_cmp_ge_i32 s75, 0
  s_cbranch_scc1 L_go_9
  s_waitcnt vmcnt(1)
L_go_9:
  buffer_load_dwordx4 v[16:19], v1, s[12:15], s64 offen offset:0 nt
  s_memrealtime s[76:77]
  v_dot2c_f32_bf16 v104, v144, v162
  v_dot2c_f32_bf16 v105, v144, v10
  v_dot2c_f32_bf16 v106, v145, v162
  v_dot2c_f32_bf16 v107, v145, v10
  v_dot2c_f32_bf16 v108, v146, v162
  v_dot2c_f32_bf16 v109, v146, v10
  v_dot2c_f32_bf16 v110, v147, v162
  v_dot2c_f32_bf16 v111, v147, v10
  s_waitcnt lgkmcnt(0)
  s_lshl_b32 s75, s76, 4
  s_sub_u32 s75, s75, s78
  s_and_b32 s75, s75, s72
  s_add_u32 s78, s78, s79
  s_waitcnt vmcnt(3)
  s_cmp_gt_i32 s75, 480
  s_cbranch_scc1 L_go_10
  s_waitcnt vmcnt(2)
  s_cmp_ge_i32 s75, 0
  s_cbranch_scc1 L_go_10
  s_waitcnt vmcnt(1)
L_go_10:
  buffer_load_dwordx4 v[20:23], v1, s[12:15], s64 offen offset:128 nt
  s_memrealtime s[76:77]
  v_lshlrev_b32 v10, 16, v163
  v_dot2c_f32_bf16 v88, v148, v163
  v_dot2c_f32_bf16 v89, v148, v10
  v_dot2c_f32_bf16 v90, v149, v163
  v_dot2c_f32_bf16 v91, v149, v10
  v_dot2c_f32_bf16 v92, v150, v163
  v_dot2c_f32_bf16 v93, v150, v10
  v_dot2c_f32_bf16 v94, v151, v163
  v_dot2c_f32_bf16 v95, v151, v10
  s_waitcnt lgkmcnt(0)
  s_lshl_b32 s75, s76, 4
  s_sub_u32 s75, s75, s78
  s_and_b32 s75, s75, s72
  s_add_u32 s78, s78, s79
  s_waitcnt vmcnt(3)
  s_cmp_gt_i32 s75, 480
  s_cbranch_scc1 L_go_11
  s_waitcnt vmcnt(2)
  s_cmp_ge_i32 s75, 0
  s_cbranch_scc1 L_go_11
  s_waitcnt vmcnt(1)
L_go_11:
  buffer_load_dwordx4 v[24:27], v1, s[12:15], s64 offen offset:256 nt
  s_memrealtime s[76:77]
  v_dot2c_f32_bf16 v96, v152, v163
  v_dot2c_f32_bf16 v97, v152, v10
  v_dot2c_f32_bf16 v98, v153, v163
  v_dot2c_f32_bf16 v99, v153, v10
  v_dot2c_f32_bf16 v100, v154, v163
  v_dot2c_f32_bf16 v101, v154, v10
  v_dot2c_f32_bf16 v102, v155, v163
  v_dot2c_f32_bf16 v103, v155, v10
  s_waitcnt lgkmcnt(0)
  s_lshl_b32 s75, s76, 4
  s_sub_u32 s75, s75, s78
  s_and_b32 s75, s75, s72
  s_add_u32 s78, s78, s79
  s_waitcnt vmcnt(3)
  s_cmp_gt_i32 s75, 480
  s_cbranch_scc1 L_go_12
  s_waitcnt vmcnt(2)
  s_cmp_ge_i32 s75, 0
  s_cbranch_scc1 L_go_12
  s_waitcnt vmcnt(1)
L_go_12:
  buffer_load_dwordx4 v[28:31], v1, s[12:15], s65 offen offset:0 nt
  s_memrealtime s[76:77]
  v_dot2c_f32_bf16 v104, v156, v163
  v_dot2c_f32_bf16 v105, v156, v10
  v_dot2c_f32_bf16 v106, v157, v163
  v_dot2c_f32_bf16 v107, v157, v10
  v_dot2c_f32_bf16 v108, v158, v163
  v_dot2c_f32_bf16 v109, v158, v10
  v_dot2c_f32_bf16 v110, v159, v163
  v_dot2c_f32_bf16 v111, v159, v10
  s_waitcnt lgkmcnt(0)
  s_lshl_b32 s75, s76, 4
  s_sub_u32 s75, s75, s78
  s_and_b32 s75, s75, s72
  s_add_u32 s78, s78, s79
  s_waitcnt vmcnt(3)
  s_cmp_gt_i32 s75, 480
  s_cbranch_scc1 L_go_13
  s_waitcnt vmcnt(2)
  s_cmp_ge_i32 s75, 0
  s_cbranch_scc1 L_go_13
  s_waitcnt vmcnt(1)
L_go_13:
  buffer_load_dwordx4 v[32:35], v1, s[12:15], s65 offen offset:128 nt
  s_memrealtime s[76:77]
  v_lshlrev_b32 v10, 16, v164
  v_dot2c_f32_bf16 v88, v16, v164
  v_dot2c_f32_bf16 v89, v16, v10
  v_dot2c_f32_bf16 v90, v17, v164
  v_dot2c_f32_bf16 v91, v17, v10
  v_dot2c_f32_bf16 v92, v18, v164
  v_dot2c_f32_bf16 v93, v18, v10
  v_dot2c_f32_bf16 v94, v19, v164
  v_dot2c_f32_bf16 v95, v19, v10
  s_waitcnt lgkmcnt(0)
  s_lshl_b32 s75, s76, 4
  s_sub_u32 s75, s75, s78
  s_and_b32 s75, s75, s72
  s_add_u32 s78, s78, s79
  s_waitcnt vmcnt(3)
  s_cmp_gt_i32 s75, 480
  s_cbranch_scc1 L_go_14
  s_waitcnt vmcnt(2)
  s_cmp_ge_i32 s75, 0
  s_cbranch_scc1 L_go_14
  s_waitcnt vmcnt(1)
L_go_14:
  buffer_load_dwordx4 v[36:39], v1, s[12:15], s65 offen offset:256 nt
  s_memrealtime s[76:77]
  v_dot2c_f32_bf16 v96, v20, v164
  v_dot2c_f32_bf16 v97, v20, v10
  v_dot2c_f32_bf16 v98, v21, v164
  v_dot2c_f32_bf16 v99, v21, v10
  v_dot2c_f32_bf16 v100, v22, v164
  v_dot2c_f32_bf16 v101, v22, v10
  v_dot2c_f32_bf16 v102, v23, v164
  v_dot2c_f32_bf16 v103, v23, v10
  s_waitcnt lgkmcnt(0)
  s_lshl_b32 s75, s76, 4
  s_sub_u32 s75, s75, s78
  s_and_b32 s75, s75, s72
  s_add_u32 s78, s78, s79
  s_waitcnt vmcnt(3)
  s_cmp_gt_i32 s75, 480
  s_cbranch_scc1 L_go_15
  s_waitcnt vmcnt(2)
  s_cmp_ge_i32 s75, 0
  s_cbranch_scc1 L_go_15
  s_waitcnt vmcnt(1)
L_go_15:
  buffer_load_dwordx4 v[40:43], v1, s[12:15], s66 offen offset:0 nt
  s_memrealtime s[76:77]
  v_dot2c_f32_bf16 v104, v24, v164
  v_dot2c_f32_bf16 v105, v24, v10
  v_dot2c_f32_bf16 v106, v25, v164
  v_dot2c_f32_bf16 v107, v25, v10
  v_dot2c_f32_bf16 v108, v26, v164
  v_dot2c_f32_bf16 v109, v26, v10
  v_dot2c_f32_bf16 v110, v27, v164
  v_dot2c_f32_bf16 v111, v27, v10
  s_waitcnt lgkmcnt(0)
  s_lshl_b32 s75, s76, 4
  s_sub_u32 s75, s75, s78
  s_and_b32 s75, s75, s72
  s_add_u32 s78, s78, s79
  s_waitcnt vmcnt(3)
  s_cmp_gt_i32 s75, 480
  s_cbranch_scc1 L_go_16
  s_waitcnt vmcnt(2)
  s_cmp_ge_i32 s75, 0
  s_cbranch_scc1 L_go_16
  s_waitcnt vmcnt(1)
L_go_16:
  buffer_load_dwordx4 v[44:47], v1, s[12:15], s66 offen offset:128 nt
  s_memrealtime s[76:77]
  v_lshlrev_b32 v10, 16, v165
  v_dot2c_f32_bf16 v88, v28, v165
  v_dot2c_f32_bf16 v89, v28, v10
  v_dot2c_f32_bf16 v90, v29, v165
  v_dot2c_f32_bf16 v91, v29, v10
  v_dot2c_f32_bf16 v92, v30, v165
  v_dot2c_f32_bf16 v93, v30, v10
  v_dot2c_f32_bf16 v94, v31, v165
  v_dot2c_f32_bf16 v95, v31, v10
  s_waitcnt lgkmcnt(0)
  s_lshl_b32 s75, s76, 4
  s_sub_u32 s75, s75, s78
  s_and_b32 s75, s75, s72
  s_add_u32 s78, s78, s79
  s_waitcnt vmcnt(3)
  s_cmp_gt_i32 s75, 480
  s_cbranch_scc1 L_go_17
  s_waitcnt vmcnt(2)
  s_cmp_ge_i32 s75, 0
  s_cbranch_scc1 L_go_17
  s_waitcnt vmcnt(1)
L_go_17:
  buffer_load_dwordx4 v[48:51], v1, s[12:15], s66 offen offset:256 nt
  s_memrealtime s[76:77]
  v_dot2c_f32_bf16 v96, v32, v165
  v_dot2c_f32_bf16 v97, v32, v10
  v_dot2c_f32_bf16 v98, v33, v165
  v_dot2c_f32_bf16 v99, v33, v10
  v_dot2c_f32_bf16 v100, v34, v165
  v_dot2c_f32_bf16 v101, v34, v10
  v_dot2c_f32_bf16 v102, v35, v165
  v_dot2c_f32_bf16 v103, v35, v10
  s_waitcnt lgkmcnt(0)
  s_lshl_b32 s75, s76, 4
  s_sub_u32 s75, s75, s78
  s_and_b32 s75, s75, s72
  s_add_u32 s78, s78, s79
  s_waitcnt vmcnt(3)
  s_cmp_gt_i32 s75, 480
  s_cbranch_scc1 L_go_18
  s_waitcnt vmcnt(2)
  s_cmp_ge_i32 s75, 0
  s_cbranch_scc1 L_go_18
  s_waitcnt vmcnt(1)
L_go_18:
  buffer_load_dwordx4 v[52:55], v1, s[12:15], s67 offen offset:0 nt
  s_memrealtime s[76:77]
  s_mov_b64 exec, 1
  ds_add_u32 v2, v11 offset:644
  s_mov_b64 exec, -1
  v_dot2c_f32_bf16 v104, v36, v165
  v_dot2c_f32_bf16 v105, v36, v10
  v_dot2c_f32_bf16 v106, v37, v165
  v_dot2c_f32_bf16 v107, v37, v10
  v_dot2c_f32_bf16 v108, v38, v165
  v_dot2c_f32_bf16 v109, v38, v10
  v_dot2c_f32_bf16 v110, v39, v165
  v_dot2c_f32_bf16 v111, v39, v10
  s_waitcnt lgkmcnt(0)
  s_lshl_b32 s75, s76, 4
  s_sub_u32 s75, s75, s78
  s_and_b32 s75, s75, s72
  s_add_u32 s78, s78, s79
  s_waitcnt vmcnt(3)
  s_cmp_gt_i32 s75, 480
  s_cbranch_scc1 L_go_19
  s_waitcnt vmcnt(2)
  s_cmp_ge_i32 s75, 0
  s_cbranch_scc1 L_go_19
  s_waitcnt vmcnt(1)
L_go_19:
  buffer_load_dwordx4 v[56:59], v1, s[12:15], s67 offen offset:128 nt
  s_memrealtime s[76:77]
  v_lshlrev_b32 v10, 16, v166
  v_dot2c_f32_bf16 v88, v40, v166
  v_dot2c_f32_bf16 v89, v40, v10
  v_dot2c_f32_bf16 v90, v41, v166
  v_dot2c_f32_bf16 v91, v41, v10
  v_dot2c_f32_bf16 v92, v42, v166
  v_dot2c_f32_bf16 v93, v42, v10
  v_dot2c_f32_bf16 v94, v43, v166
  v_dot2c_f32_bf16 v95, v43, v10
  s_waitcnt lgkmcnt(0)
  s_lshl_b32 s75, s76, 4
  s_sub_u32 s75, s75, s78
  s_and_b32 s75, s75, s72
  s_add_u32 s78, s78, s79
  s_waitcnt vmcnt(3)
  s_cmp_gt_i32 s75, 480
  s_cbranch_scc1 L_go_20
  s_waitcnt vmcnt(2)
  s_cmp_ge_i32 s75, 0
  s_cbranch_scc1 L_go_20
  s_waitcnt vmcnt(1)
L_go_20:
  buffer_load_dwordx4 v[60:63], v1, s[12:15], s67 offen offset:256 nt
  v_dot2c_f32_bf16 v96, v44, v166
  v_dot2c_f32_bf16 v97, v44, v10
  v_dot2c_f32_bf16 v98, v45, v166
  v_dot2c_f32_bf16 v99, v45, v10
  v_dot2c_f32_bf16 v100, v46, v166
  v_dot2c_f32_bf16 v101, v46, v10
  v_dot2c_f32_bf16 v102, v47, v166
  v_dot2c_f32_bf16 v103, v47, v10
  s_waitcnt vmcnt(3)
  v_dot2c_f32_bf16 v104, v48, v166
  v_dot2c_f32_bf16 v105, v48, v10
  v_dot2c_f32_bf16 v106, v49, v166
  v_dot2c_f32_bf16 v107, v49, v10
  v_dot2c_f32_bf16 v108, v50, v166
  v_dot2c_f32_bf16 v109, v50, v10
  v_dot2c_f32_bf16 v110, v51, v166
  v_dot2c_f32_bf16 v111, v51, v10
  s_mov_b32 s70, 4000007
L_spin_21:
  ds_read_b128 v[12:15], v3 offset:512
  s_waitcnt lgkmcnt(0)
  v_cmp_eq_u32 vcc, 0, v15
  s_nop 0
  s_cbranch_vccz L_sdone_22
  s_sleep 1
  s_sub_u32 s70, s70, 1
  s_cbranch_scc0 L_spin_21
L_sdone_22:
  v_max_f32_dpp v12, v12, v12 quad_perm:[1,0,3,2] row_mask:0xf bank_mask:0xf
  s_nop 1
  v_max_f32_dpp v12, v12, v12 quad_perm:[2,3,0,1] row_mask:0xf bank_mask:0xf
  s_nop 1
  v_max_f32_dpp v12, v12, v12 row_half_mirror row_mask:0xf bank_mask:0xf
  v_sub_f32 v9, v4, v12
  v_mul_f32 v9, s68, v9
  v_exp_f32 v9, v9
  v_mov_b32 v2, 0
  s_mov_b32 s70, 4000007
L_spin_23:
  ds_read_b32 v13, v2 offset:648
  s_waitcnt lgkmcnt(0)
  v_cmp_gt_u32 vcc, 1, v13
  s_nop 0
  s_cbranch_vccz L_sdone_24
  s_sleep 2
  s_sub_u32 s70, s70, 1
  s_cbranch_scc0 L_spin_23
L_sdone_24:
  v_readfirstlane_b32 s46, v13
  v_min_u32 v12, 47, v0
  v_lshlrev_b32 v13, 7, v12
  v_lshlrev_b32 v12, 4, v12
  s_mul_i32 s74, s6, 6144
  s_lshl4_add_u32 s74, s7, s74
  s_add_u32 s74, s74, 524288
  s_mov_b32 s22, 0xaaaaaaaa
  s_mov_b32 s23, 0xaaaaaaaa
  v_mov_b32 v14, s30
  v_mov_b32 v15, s31
  s_waitcnt vmcnt(2)
  v_lshlrev_b32 v10, 16, v167
  v_dot2c_f32_bf16 v88, v52, v167
  v_dot2c_f32_bf16 v89, v52, v10
  v_dot2c_f32_bf16 v90, v53, v167
  v_dot2c_f32_bf16 v91, v53, v10
  v_dot2c_f32_bf16 v92, v54, v167
  v_dot2c_f32_bf16 v93, v54, v10
  v_dot2c_f32_bf16 v94, v55, v167
  v_dot2c_f32_bf16 v95, v55, v10
  v_permlane32_swap_b32 v88, v92
  v_permlane32_swap_b32 v89, v93
  v_permlane32_swap_b32 v90, v94
  v_permlane32_swap_b32 v91, v95
  v_add_f32 v88, v88, v92
  v_add_f32 v89, v89, v93
  v_add_f32 v90, v90, v94
  v_add_f32 v91, v91, v95
  s_nop 0
  v_permlane16_swap_b32 v88, v90
  v_permlane16_swap_b32 v89, v91
  v_add_f32 v88, v88, v90
  v_add_f32 v89, v89, v91
  s_nop 0
  v_add_f32_dpp v88, v88, v88 row_ror:8 row_mask:0xf bank_mask:0xf
  v_add_f32_dpp v89, v89, v89 row_ror:8 row_mask:0xf bank_mask:0xf
  v_mul_f32 v88, v9, v88
  v_mul_f32 v89, v9, v89
  ds_write_b64 v8, v[88:89] offset:1024
  s_waitcnt vmcnt(1)
  v_dot2c_f32_bf16 v96, v56, v167
  v_dot2c_f32_bf16 v97, v56, v10
  v_dot2c_f32_bf16 v98, v57, v167
  v_dot2c_f32_bf16 v99, v57, v10
  v_dot2c_f32_bf16 v100, v58, v167
  v_dot2c_f32_bf16 v101, v58, v10
  v_dot2c_f32_bf16 v102, v59, v167
  v_dot2c_f32_bf16 v103, v59, v10
  v_permlane32_swap_b32 v96, v100
  v_permlane32_swap_b32 v97, v101
  v_permlane32_swap_b32 v98, v102
  v_permlane32_swap_b32 v99, v103
  v_add_f32 v96, v96, v100
  v_add_f32 v97, v97, v101
  v_add_f32 v98, v98, v102
  v_add_f32 v99, v99, v103
  s_nop 0
  v_permlane16_swap_b32 v96, v98
  v_permlane16_swap_b32 v97, v99
  v_add_f32 v96, v96, v98
  v_add_f32 v97, v97, v99
  s_nop 0
  v_add_f32_dpp v96, v96, v96 row_ror:8 row_mask:0xf bank_mask:0xf
  v_add_f32_dpp v97, v97, v97 row_ror:8 row_mask:0xf bank_mask:0xf
  v_mul_f32 v96, v9, v96
  v_mul_f32 v97, v9, v97
  ds_write_b64 v8, v[96:97] offset:1280
  s_waitcnt vmcnt(0)
  v_dot2c_f32_bf16 v104, v60, v167
  v_dot2c_f32_bf16 v105, v60, v10
  v_dot2c_f32_bf16 v106, v61, v167
  v_dot2c_f32_bf16 v107, v61, v10
  v_dot2c_f32_bf16 v108, v62, v167
  v_dot2c_f32_bf16 v109, v62, v10
  v_dot2c_f32_bf16 v110, v63, v167
  v_dot2c_f32_bf16 v111, v63, v10
  v_permlane32_swap_b32 v104, v108
  v_permlane32_swap_b32 v105, v109
  v_permlane32_swap_b32 v106, v110
  v_permlane32_swap_b32 v107, v111
  v_add_f32 v104, v104, v108
  v_add_f32 v105, v105, v109
  v_add_f32 v106, v106, v110
  v_add_f32 v107, v107, v111
  s_nop 0
  v_permlane16_swap_b32 v104, v106
  v_permlane16_swap_b32 v105, v107
  v_add_f32 v104, v104, v106
  v_add_f32 v105, v105, v107
  s_nop 0
  v_add_f32_dpp v104, v104, v104 row_ror:8 row_mask:0xf bank_mask:0xf
  v_add_f32_dpp v105, v105, v105 row_ror:8 row_mask:0xf bank_mask:0xf
  v_mul_f32 v104, v9, v104
  v_mul_f32 v105, v9, v105
  ds_write_b64 v8, v[104:105] offset:1536
  s_mov_b64 exec, 1
  ds_add_rtn_u32 v10, v2, v11 offset:640
  s_mov_b64 exec, -1
  ds_read_b128 v[16:19], v12 offset:1024
  ds_read_b128 v[20:23], v12 offset:1792
  ds_read_b128 v[24:27], v12 offset:2560
  ds_read_b128 v[28:31], v12 offset:3328
  ds_read_b128 v[32:35], v12 offset:4096
  ds_read_b128 v[36:39], v12 offset:4864
  ds_read_b128 v[40:43], v12 offset:5632
  ds_read_b128 v[44:47], v12 offset:6400
  s_waitcnt lgkmcnt(8)
  v_readfirstlane_b32 s68, v10
  s_nop 0
  s_cmp_lg_u32 s68, 7
  s_cbranch_scc1 L_nopub
  s_waitcnt lgkmcnt(6)
  v_pk_add_f32 v[16:17], v[16:17], v[20:21]
  v_pk_add_f32 v[18:19], v[18:19], v[22:23]
  s_waitcnt lgkmcnt(4)
  v_pk_add_f32 v[24:25], v[24:25], v[28:29]
  v_pk_add_f32 v[26:27], v[26:27], v[30:31]
  v_pk_add_f32 v[16:17], v[16:17], v[24:25]
  v_pk_add_f32 v[18:19], v[18:19], v[26:27]
  s_waitcnt lgkmcnt(2)
  v_pk_add_f32 v[32:33], v[32:33], v[36:37]
  v_pk_add_f32 v[34:35], v[34:35], v[38:39]
  s_waitcnt lgkmcnt(0)
  v_pk_add_f32 v[40:41], v[40:41], v[44:45]
  v_pk_add_f32 v[42:43], v[42:43], v[46:47]
  v_pk_add_f32 v[32:33], v[32:33], v[40:41]
  v_pk_add_f32 v[34:35], v[34:35], v[42:43]
  v_pk_add_f32 v[4:5], v[16:17], v[32:33]
  v_pk_add_f32 v[6:7], v[18:19], v[34:35]
  v_cvt_pk_bf16_f32 v8, v4, v5
  v_cvt_pk_bf16_f32 v9, v6, v7
  v_cndmask_b32 v4, v8, v14, s[22:23]
  v_cndmask_b32 v5, v9, v15, s[22:23]
  v_cndmask_b32 v6, v14, v8, s[22:23]
  v_cndmask_b32 v7, v15, v9, s[22:23]
  s_mov_b32 exec_lo, 0xffffffff
  s_mov_b32 exec_hi, 0xffff
  buffer_store_dwordx4 v[4:7], v13, s[32:35], s74 offen
  s_mov_b64 exec, -1
  s_cmp_lg_u32 s46, 1
  s_cbranch_scc1 L_slow_25
L_back_26:
  ds_write_b32 v2, v11 offset:668
L_nopub:
  s_waitcnt lgkmcnt(0)
  s_cmp_lt_u32 s5, 20
  s_cbranch_scc1 L_notf1
  s_cmp_lt_u32 s5, 30
  s_cbranch_scc1 L_f1
  s_branch L_stream_exit
L_notf1:
  s_cmp_gt_u32 s5, 11
  s_cbranch_scc1 L_stream_exit
  s_cmp_gt_u32 s3, 6
  s_cbranch_scc1 L_f2
  s_endpgm
L_stream_exit:
  s_endpgm
L_helper:
  s_setprio 3
  v_lshlrev_b32 v1, 2, v0
  v_lshrrev_b32 v2, 3, v0
  s_mul_i32 s68, s7, 80
  v_add_u32 v3, s68, v2
  v_lshlrev_b32 v3, 1, v3
  v_mul_u32_u24 v2, 12288, v2
  v_and_b32 v7, 7, v0
  v_lshl_add_u32 v2, v7, 4, v2
  s_mul_i32 s68, s68, 12288
  s_mul_i32 s69, s6, 384
  s_add_u32 s68, s68, s69
  s_lshl_b32 s69, s3, 7
  s_add_u32 s68, s68, s69
  s_waitcnt lgkmcnt(0)
  s_load_dword s12, s[36:37], 0
  s_load_dword s13, s[36:37], 128
  s_load_dword s14, s[36:37], 256
  s_load_dword s15, s[36:37], 384
  s_load_dword s16, s[36:37], 512
  s_load_dword s17, s[36:37], 640
  s_load_dword s18, s[36:37], 768
  s_load_dword s19, s[36:37], 896
  s_load_dword s20, s[36:37], 1024
  s_load_dword s21, s[36:37], 1152
  s_barrier
  s_mov_b32 s8, s42
  s_mov_b32 s9, s43
  s_mov_b32 s10, 7864320
  s_mov_b32 s11, 0x20000
  s_waitcnt lgkmcnt(0)
  global_load_dword v64, v1, s[36:37] offset:0
  global_load_dword v65, v1, s[36:37] offset:256
  global_load_dword v66, v1, s[36:37] offset:512
  global_load_dword v67, v1, s[36:37] offset:768
  global_load_dword v68, v1, s[36:37] offset:1024
  global_load_ushort v8, v3, s[36:37] offset:0
  global_load_ushort v9, v3, s[36:37] offset:16
  global_load_ushort v10, v3, s[36:37] offset:32
  global_load_ushort v11, v3, s[36:37] offset:48
  global_load_ushort v12, v3, s[36:37] offset:64
  global_load_ushort v13, v3, s[36:37] offset:80
  global_load_ushort v14, v3, s[36:37] offset:96
  global_load_ushort v15, v3, s[36:37] offset:112
  global_load_ushort v16, v3, s[36:37] offset:128
  global_load_ushort v17, v3, s[36:37] offset:144
  s_load_dwordx2 s[28:29], s[58:59], 917504
  s_mov_b32 s69, 0xffff0000
  s_mov_b32 s24, s58
  s_mov_b32 s25, s59
  s_mov_b32 s26, 4194304
  s_mov_b32 s27, 0x20000
  s_add_u32 s32, s58, 4194304
  s_addc_u32 s33, s59, 0
  s_mov_b32 s34, 4194304
  s_mov_b32 s35, 0x20000
  s_lshl3_add_u32 s71, s6, s7
  s_mul_i32 s5, s79, 5
  s_mul_i32 s47, s79, 3
  s_add_u32 s47, s47, 15
  s_cmp_lt_u32 s7, 5
  s_cselect_b32 s5, s5, s47
  s_add_u32 s5, s5, s7
  s_waitcnt lgkmcnt(0)
  s_mul_i32 s30, s28, 0x2c9277b5
  s_add_u32 s30, s30, 0xac564b05
  s_mul_i32 s31, s29, 0x0019660d
  s_add_u32 s31, s31, 0x3c6ef35f
  s_waitcnt vmcnt(10)
  v_lshlrev_b32 v70, 16, v64
  v_and_b32 v71, s69, v64
  v_lshlrev_b32 v72, 16, v65
  v_and_b32 v73, s69, v65
  v_lshlrev_b32 v74, 16, v66
  v_and_b32 v75, s69, v66
  v_lshlrev_b32 v76, 16, v67
  v_and_b32 v77, s69, v67
  v_lshlrev_b32 v78, 16, v68
  v_and_b32 v79, s69, v68
  v_add_f32 v4, v70, v71
  v_add_f32 v5, v72, v73
  v_add_f32 v6, v74, v75
  v_add_f32 v7, v76, v77
  v_add_f32 v4, v4, v5
  v_add_f32 v6, v6, v7
  v_add_f32 v5, v78, v79
  v_add_f32 v4, v4, v6
  v_add_f32 v4, v4, v5
  s_nop 1
  v_add_f32_dpp v4, v4, v4 quad_perm:[1,0,3,2] row_mask:0xf bank_mask:0xf
  s_nop 1
  v_add_f32_dpp v4, v4, v4 quad_perm:[2,3,0,1] row_mask:0xf bank_mask:0xf
  s_nop 1
  v_add_f32_dpp v4, v4, v4 row_half_mirror row_mask:0xf bank_mask:0xf
  s_nop 1
  v_add_f32_dpp v4, v4, v4 row_mirror row_mask:0xf bank_mask:0xf
  v_mov_b32 v5, v4
  s_nop 1
  v_permlane16_swap_b32 v4, v5
  v_add_f32 v4, v4, v5
  v_mov_b32 v5, v4
  s_nop 1
  v_permlane32_swap_b32 v4, v5
  v_add_f32 v4, v4, v5
  v_mul_f32 v4, 0x3acccccd, v4
  v_sub_f32 v70, v70, v4
  v_sub_f32 v71, v71, v4
  v_sub_f32 v72, v72, v4
  v_sub_f32 v73, v73, v4
  v_sub_f32 v74, v74, v4
  v_sub_f32 v75, v75, v4
  v_sub_f32 v76, v76, v4
  v_sub_f32 v77, v77, v4
  v_sub_f32 v78, v78, v4
  v_sub_f32 v79, v79, v4
  v_mul_f32 v5, v70, v70
  v_fmac_f32 v5, v71, v71
  v_fmac_f32 v5, v72, v72
  v_fmac_f32 v5, v73, v73
  v_fmac_f32 v5, v74, v74
  v_fmac_f32 v5, v75, v75
  v_fmac_f32 v5, v76, v76
  v_fmac_f32 v5, v77, v77
  v_fmac_f32 v5, v78, v78
  v_fmac_f32 v5, v79, v79
  s_nop 1
  v_add_f32_dpp v5, v5, v5 quad_perm:[1,0,3,2] row_mask:0xf bank_mask:0xf
  s_nop 1
  v_add_f32_dpp v5, v5, v5 quad_perm:[2,3,0,1] row_mask:0xf bank_mask:0xf
  s_nop 1
  v_add_f32_dpp v5, v5, v5 row_half_mirror row_mask:0xf bank_mask:0xf
  s_nop 1
  v_add_f32_dpp v5, v5, v5 row_mirror row_mask:0xf bank_mask:0xf
  v_mov_b32 v6, v5
  s_nop 1
  v_permlane16_swap_b32 v5, v6
  v_add_f32 v5, v5, v6
  v_mov_b32 v6, v5
  s_nop 1
  v_permlane32_swap_b32 v5, v6
  v_add_f32 v5, v5, v6
  v_mul_f32 v5, 0x3acccccd, v5
  v_cvt_pk_bf16_f32 v4, v4, v4
  v_lshlrev_b32 v4, 16, v4
  v_cvt_pk_bf16_f32 v5, v5, v5
  v_lshlrev_b32 v5, 16, v5
  v_add_f32 v5, 0x3727c5ac, v5
  v_cvt_pk_bf16_f32 v5, v5, v5
  v_lshlrev_b32 v5, 16, v5
  v_sqrt_f32 v5, v5
  s_nop 0
  v_cvt_pk_bf16_f32 v5, v5, v5
  v_lshlrev_b32 v5, 16, v5
  v_rcp_f32 v5, v5
  v_mov_b32 v6, 0
  s_waitcnt vmcnt(0)
  v_lshlrev_b32 v8, 16, v8
  v_lshlrev_b32 v9, 16, v9
  v_lshlrev_b32 v10, 16, v10
  v_lshlrev_b32 v11, 16, v11
  v_lshlrev_b32 v12, 16, v12
  v_lshlrev_b32 v13, 16, v13
  v_lshlrev_b32 v14, 16, v14
  v_lshlrev_b32 v15, 16, v15
  v_lshlrev_b32 v16, 16, v16
  v_lshlrev_b32 v17, 16, v17
  v_sub_f32 v8, v8, v4
  v_sub_f32 v9, v9, v4
  v_sub_f32 v10, v10, v4
  v_sub_f32 v11, v11, v4
  v_sub_f32 v12, v12, v4
  v_sub_f32 v13, v13, v4
  v_sub_f32 v14, v14, v4
  v_sub_f32 v15, v15, v4
  v_sub_f32 v16, v16, v4
  v_sub_f32 v17, v17, v4
  v_cvt_pk_bf16_f32 v8, v6, v8
  v_cvt_pk_bf16_f32 v9, v6, v9
  v_cvt_pk_bf16_f32 v10, v6, v10
  v_cvt_pk_bf16_f32 v11, v6, v11
  v_cvt_pk_bf16_f32 v12, v6, v12
  v_cvt_pk_bf16_f32 v13, v6, v13
  v_cvt_pk_bf16_f32 v14, v6, v14
  v_cvt_pk_bf16_f32 v15, v6, v15
  v_cvt_pk_bf16_f32 v16, v6, v16
  v_cvt_pk_bf16_f32 v17, v6, v17
  v_mul_f32 v8, v8, v5
  v_mul_f32 v9, v9, v5
  v_mul_f32 v10, v10, v5
  v_mul_f32 v11, v11, v5
  v_mul_f32 v12, v12, v5
  v_mul_f32 v13, v13, v5
  v_mul_f32 v14, v14, v5
  v_mul_f32 v15, v15, v5
  v_mul_f32 v16, v16, v5
  v_mul_f32 v17, v17, v5
  v_cvt_pk_bf16_f32 v70, v6, v8
  v_cvt_pk_bf16_f32 v8, v8, v6
  v_cvt_pk_bf16_f32 v71, v6, v9
  v_cvt_pk_bf16_f32 v9, v9, v6
  v_cvt_pk_bf16_f32 v72, v6, v10
  v_cvt_pk_bf16_f32 v10, v10, v6
  v_cvt_pk_bf16_f32 v73, v6, v11
  v_cvt_pk_bf16_f32 v11, v11, v6
  v_cvt_pk_bf16_f32 v74, v6, v12
  v_cvt_pk_bf16_f32 v12, v12, v6
  v_cvt_pk_bf16_f32 v75, v6, v13
  v_cvt_pk_bf16_f32 v13, v13, v6
  v_cvt_pk_bf16_f32 v76, v6, v14
  v_cvt_pk_bf16_f32 v14, v14, v6
  v_cvt_pk_bf16_f32 v77, v6, v15
  v_cvt_pk_bf16_f32 v15, v15, v6
  v_cvt_pk_bf16_f32 v78, v6, v16
  v_cvt_pk_bf16_f32 v16, v16, v6
  v_cvt_pk_bf16_f32 v79, v6, v17
  v_cvt_pk_bf16_f32 v17, v17, v6
  v_mov_b32 v80, 0
  v_mov_b32 v81, 0
  v_mov_b32 v82, 0
  v_mov_b32 v83, 0
  v_mov_b32 v84, 0
  v_mov_b32 v85, 0
  v_mov_b32 v86, 0
  v_mov_b32 v87, 0
  v_and_b32 v90, 7, v0
  v_lshrrev_b32 v6, 4, v0
  v_lshl_add_u32 v90, v90, 2, v6
  v_lshlrev_b32 v90, 4, v90
  s_lshl_b32 s64, s71, 11
  s_lshl_b32 s69, s3, 9
  s_add_u32 s64, s64, s69
  s_waitcnt vmcnt(9)
  v_dot2c_f32_bf16 v80, v24, v8
  v_dot2c_f32_bf16 v81, v24, v70
  v_dot2c_f32_bf16 v82, v25, v8
  v_dot2c_f32_bf16 v83, v25, v70
  v_dot2c_f32_bf16 v84, v26, v8
  v_dot2c_f32_bf16 v85, v26, v70
  v_dot2c_f32_bf16 v86, v27, v8
  v_dot2c_f32_bf16 v87, v27, v70
  s_waitcnt vmcnt(8)
  v_dot2c_f32_bf16 v80, v28, v9
  v_dot2c_f32_bf16 v81, v28, v71
  v_dot2c_f32_bf16 v82, v29, v9
  v_dot2c_f32_bf16 v83, v29, v71
  v_dot2c_f32_bf16 v84, v30, v9
  v_dot2c_f32_bf16 v85, v30, v71
  v_dot2c_f32_bf16 v86, v31, v9
  v_dot2c_f32_bf16 v87, v31, v71
  s_waitcnt vmcnt(7)
  v_dot2c_f32_bf16 v80, v32, v10
  v_dot2c_f32_bf16 v81, v32, v72
  v_dot2c_f32_bf16 v82, v33, v10
  v_dot2c_f32_bf16 v83, v33, v72
  v_dot2c_f32_bf16 v84, v34, v10
  v_dot2c_f32_bf16 v85, v34, v72
  v_dot2c_f32_bf16 v86, v35, v10
  v_dot2c_f32_bf16 v87, v35, v72
  s_waitcnt vmcnt(6)
  v_dot2c_f32_bf16 v80, v36, v11
  v_dot2c_f32_bf16 v81, v36, v73
  v_dot2c_f32_bf16 v82, v37, v11
  v_dot2c_f32_bf16 v83, v37, v73
  v_dot2c_f32_bf16 v84, v38, v11
  v_dot2c_f32_bf16 v85, v38, v73
  v_dot2c_f32_bf16 v86, v39, v11
  v_dot2c_f32_bf16 v87, v39, v73
  s_waitcnt vmcnt(5)
  v_dot2c_f32_bf16 v80, v40, v12
  v_dot2c_f32_bf16 v81, v40, v74
  v_dot2c_f32_bf16 v82, v41, v12
  v_dot2c_f32_bf16 v83, v41, v74
  v_dot2c_f32_bf16 v84, v42, v12
  v_dot2c_f32_bf16 v85, v42, v74
  v_dot2c_f32_bf16 v86, v43, v12
  v_dot2c_f32_bf16 v87, v43, v74
  s_waitcnt vmcnt(4)
  v_dot2c_f32_bf16 v80, v44, v13
  v_dot2c_f32_bf16 v81, v44, v75
  v_dot2c_f32_bf16 v82, v45, v13
  v_dot2c_f32_bf16 v83, v45, v75
  v_dot2c_f32_bf16 v84, v46, v13
  v_dot2c_f32_bf16 v85, v46, v75
  v_dot2c_f32_bf16 v86, v47, v13
  v_dot2c_f32_bf16 v87, v47, v75
  s_waitcnt vmcnt(3)
  v_dot2c_f32_bf16 v80, v48, v14
  v_dot2c_f32_bf16 v81, v48, v76
  v_dot2c_f32_bf16 v82, v49, v14
  v_dot2c_f32_bf16 v83, v49, v76
  v_dot2c_f32_bf16 v84, v50, v14
  v_dot2c_f32_bf16 v85, v50, v76
  v_dot2c_f32_bf16 v86, v51, v14
  v_dot2c_f32_bf16 v87, v51, v76
  s_waitcnt vmcnt(2)
  v_dot2c_f32_bf16 v80, v52, v15
  v_dot2c_f32_bf16 v81, v52, v77
  v_dot2c_f32_bf16 v82, v53, v15
  v_dot2c_f32_bf16 v83, v53, v77
  v_dot2c_f32_bf16 v84, v54, v15
  v_dot2c_f32_bf16 v85, v54, v77
  v_dot2c_f32_bf16 v86, v55, v15
  v_dot2c_f32_bf16 v87, v55, v77
  s_waitcnt vmcnt(1)
  v_dot2c_f32_bf16 v80, v56, v16
  v_dot2c_f32_bf16 v81, v56, v78
  v_dot2c_f32_bf16 v82, v57, v16
  v_dot2c_f32_bf16 v83, v57, v78
  v_dot2c_f32_bf16 v84, v58, v16
  v_dot2c_f32_bf16 v85, v58, v78
  v_dot2c_f32_bf16 v86, v59, v16
  v_dot2c_f32_bf16 v87, v59, v78
  s_waitcnt vmcnt(0)
  v_dot2c_f32_bf16 v80, v60, v17
  v_dot2c_f32_bf16 v81, v60, v79
  v_dot2c_f32_bf16 v82, v61, v17
  v_dot2c_f32_bf16 v83, v61, v79
  v_dot2c_f32_bf16 v84, v62, v17
  v_dot2c_f32_bf16 v85, v62, v79
  v_dot2c_f32_bf16 v86, v63, v17
  v_dot2c_f32_bf16 v87, v63, v79
  v_permlane32_swap_b32 v80, v84
  v_permlane32_swap_b32 v81, v85
  v_permlane32_swap_b32 v82, v86
  v_permlane32_swap_b32 v83, v87
  v_add_f32 v80, v80, v84
  v_add_f32 v81, v81, v85
  v_add_f32 v82, v82, v86
  v_add_f32 v83, v83, v87
  s_nop 0
  v_permlane16_swap_b32 v80, v82
  v_permlane16_swap_b32 v81, v83
  v_add_f32 v80, v80, v82
  v_add_f32 v81, v81, v83
  s_nop 0
  v_add_f32_dpp v80, v80, v80 row_ror:8 row_mask:0xf bank_mask:0xf
  v_add_f32_dpp v81, v81, v81 row_ror:8 row_mask:0xf bank_mask:0xf
  v_mov_b32 v82, s30
  v_mov_b32 v83, s31
  s_mov_b32 exec_lo, 0xff00ff
  s_mov_b32 exec_hi, 0xff00ff
  buffer_store_dwordx4 v[80:83], v90, s[32:35], s64 offen offset:0
  s_mov_b64 exec, -1
  v_and_b32 v3, 31, v0
  v_lshrrev_b32 v2, 5, v0
  v_lshlrev_b32 v2, 11, v2
  v_lshl_add_u32 v2, v3, 4, v2
  s_lshl_b32 s68, s6, 14
  s_add_u32 s60, s68, s69
  s_add_u32 s61, s60, 4096
  s_add_u32 s62, s60, 8192
  s_add_u32 s63, s60, 12288
  v_lshlrev_b32 v3, 2, v3
  s_lshl_b32 s69, s3, 7
  v_add_u32 v3, s69, v3
  v_mov_b32 v1, 0
  s_mov_b32 s65, 0
  s_mov_b32 s16, s32
  s_mov_b32 s17, s33
  s_mov_b32 s18, 4194304
  s_mov_b32 s19, 0x20000
  s_mov_b32 s70, 4000007
L_spin_27:
  buffer_load_dwordx4 v[8:11], v2, s[16:19], s60 offen offset:0 sc1 nt
  buffer_load_dwordx4 v[12:15], v2, s[16:19], s61 offen offset:0 sc1 nt
  buffer_load_dwordx4 v[16:19], v2, s[16:19], s62 offen offset:0 sc1 nt
  buffer_load_dwordx4 v[20:23], v2, s[16:19], s63 offen offset:0 sc1 nt
  s_waitcnt vmcnt(0)
  v_cmp_ne_u64 vcc, s[30:31], v[10:11]
  v_cmp_ne_u64 s[20:21], s[30:31], v[14:15]
  v_cmp_ne_u64 s[22:23], s[30:31], v[18:19]
  s_or_b64 vcc, vcc, s[20:21]
  v_cmp_ne_u64 s[20:21], s[30:31], v[22:23]
  s_or_b64 vcc, vcc, s[22:23]
  s_or_b64 vcc, vcc, s[20:21]
  s_nop 0
  s_cbranch_vccz L_sdone_28
  s_sleep 2
  ds_read_b32 v4, v1 offset:648
  s_waitcnt lgkmcnt(0)
  v_readfirstlane_b32 s46, v4
  s_nop 0
  s_sub_u32 s68, s46, s65
  s_cmp_lg_u32 s68, 2
  s_cbranch_scc1 L_qlazy_29
  s_mov_b32 exec_lo, 0xff00ff
  s_mov_b32 exec_hi, 0xff00ff
  buffer_store_dwordx4 v[80:83], v90, s[24:27], s64 offen offset:0 sc1
  s_mov_b64 exec, -1
  s_mov_b32 s65, 1
L_qlazy_29:
  s_and_b32 s99, s70, 7
  s_cselect_b32 s16, s32, s24
  s_cselect_b32 s17, s33, s25
  s_sub_u32 s70, s70, 1
  s_cbranch_scc0 L_spin_27
L_sdone_28:
  v_add_f32 v8, v8, v12
  v_add_f32 v9, v9, v13
  v_add_f32 v16, v16, v20
  v_add_f32 v17, v17, v21
  v_add_f32 v8, v8, v16
  v_add_f32 v9, v9, v17
  v_mov_b32 v10, v8
  v_mov_b32 v11, v9
  s_nop 0
  v_permlane32_swap_b32 v8, v10
  v_permlane32_swap_b32 v9, v11
  v_add_f32 v8, v8, v10
  v_add_f32 v9, v9, v11
  v_cvt_pk_bf16_f32 v8, v8, v9
  ds_write_b32 v3, v8 offset:0
  s_lshl_b32 s69, s3, 3
  v_mov_b32 v4, s69
  v_mov_b32 v6, 1
  s_waitcnt lgkmcnt(0)
  ds_write_b32 v4, v6 offset:384
  v_mov_b32 v1, 0
  s_mov_b32 s70, 4000007
L_spin_30:
  ds_read_b32 v4, v1 offset:648
  s_waitcnt lgkmcnt(0)
  v_cmp_gt_u32 vcc, 1, v4
  s_nop 0
  s_cbranch_vccz L_sdone_31
  s_sleep 2
  s_sub_u32 s70, s70, 1
  s_cbranch_scc0 L_spin_30
L_sdone_31:
  v_readfirstlane_b32 s46, v4
  ds_read_b32 v4, v1 offset:648
  s_waitcnt lgkmcnt(0)
  v_readfirstlane_b32 s46, v4
  s_nop 0
  s_sub_u32 s68, s46, s65
  s_cmp_lg_u32 s68, 2
  s_cbranch_scc1 L_qlazy_32
  s_mov_b32 exec_lo, 0xff00ff
  s_mov_b32 exec_hi, 0xff00ff
  buffer_store_dwordx4 v[80:83], v90, s[24:27], s64 offen offset:0 sc1
  s_mov_b64 exec, -1
  s_mov_b32 s65, 1
L_qlazy_32:
  s_branch L_stats
L_ids:
  s_setprio 3
  s_getreg_b32 s64, hwreg(HW_REG_XCC_ID)
  s_mov_b32 s24, s58
  s_mov_b32 s25, s59
  s_mov_b32 s26, 4194304
  s_mov_b32 s27, 0x20000
  s_add_u32 s32, s58, 4194304
  s_addc_u32 s33, s59, 0
  s_mov_b32 s34, 4194304
  s_mov_b32 s35, 0x20000
  s_lshl3_add_u32 s71, s6, s7
  s_mul_i32 s5, s79, 5
  s_mul_i32 s47, s79, 3
  s_add_u32 s47, s47, 15
  s_cmp_lt_u32 s7, 5
  s_cselect_b32 s5, s5, s47
  s_add_u32 s5, s5, s7
  s_waitcnt lgkmcnt(0)
  s_mul_i32 s30, s28, 0x2c9277b5
  s_add_u32 s30, s30, 0xac564b05
  s_mul_i32 s31, s29, 0x0019660d
  s_add_u32 s31, s31, 0x3c6ef35f
  s_and_b32 s64, s64, 15
  v_mov_b32 v4, s30
  v_mov_b32 v5, s31
  v_mov_b32 v6, s64
  v_mov_b32 v7, s64
  s_lshl_b32 s68, s4, 9
  s_add_u32 s68, s68, 753664
  s_lshr_b32 s65, s2, 3
  s_lshl_b32 s69, s65, 4
  v_mov_b32 v1, s69
  s_mov_b64 exec, 1
  buffer_store_dwordx4 v[4:7], v1, s[32:35], s68 offen
  s_mov_b64 exec, -1
  s_cmp_lg_u32 s65, 31
  s_cbranch_scc1 L_noinit
  v_lshlrev_b32 v12, 8, v0
  s_lshl_b32 s69, s4, 15
  s_add_u32 s69, s69, 1703936
  s_mov_b32 exec_lo, 0x8040201
  s_mov_b32 exec_hi, 0x8040201
  buffer_store_dword v4, v12, s[24:27], s69 offen sc1
  s_mov_b64 exec, -1
L_noinit:
  v_and_b32 v1, 31, v0
  v_lshlrev_b32 v1, 4, v1
  s_mov_b32 s70, 12
  s_mov_b32 s46, 2
L_idpoll:
  s_sleep 16
  buffer_load_dwordx4 v[8:11], v1, s[32:35], s68 offen sc1 nt
  s_waitcnt vmcnt(0)
  v_cmp_ne_u64 vcc, s[30:31], v[8:9]
  s_nop 0
  s_cbranch_vccz L_iddone
  s_sub_u32 s70, s70, 1
  s_cbranch_scc0 L_idpoll
  s_branch L_idset
L_iddone:
  v_cmp_ne_u32 vcc, s64, v10
  s_nop 0
  s_cbranch_vccnz L_idset
  s_mov_b32 s46, 1
L_idset:
  v_mov_b32 v1, 0
  v_mov_b32 v4, s46
  ds_write_b32 v1, v4 offset:648
  s_cmp_lg_u32 s65, 31
  s_cbranch_scc1 L_pf
  s_lshl_b32 s69, s4, 15
  s_add_u32 s69, s69, 1703936
  s_add_u32 s22, s58, s69
  s_addc_u32 s23, s59, 0
  s_waitcnt lgkmcnt(0)
  s_mov_b32 s8, -1
  s_mov_b32 s9, -1
  s_memtime s[12:13]
  s_waitcnt lgkmcnt(0)
  s_load_dword s10, s[22:23], 0
  s_waitcnt lgkmcnt(0)
  s_memtime s[14:15]
  s_waitcnt lgkmcnt(0)
  s_sub_u32 s11, s14, s12
  s_min_u32 s8, s8, s11
  s_waitcnt lgkmcnt(0)
  s_load_dword s10, s[22:23], 8192
  s_waitcnt lgkmcnt(0)
  s_memtime s[12:13]
  s_waitcnt lgkmcnt(0)
  s_sub_u32 s11, s12, s14
  s_min_u32 s9, s9, s11
  s_waitcnt lgkmcnt(0)
  s_load_dword s10, s[22:23], 10496
  s_waitcnt lgkmcnt(0)
  s_memtime s[14:15]
  s_waitcnt lgkmcnt(0)
  s_sub_u32 s11, s14, s12
  s_min_u32 s9, s9, s11
  s_waitcnt lgkmcnt(0)
  s_load_dword s10, s[22:23], 2304
  s_waitcnt lgkmcnt(0)
  s_memtime s[12:13]
  s_waitcnt lgkmcnt(0)
  s_sub_u32 s11, s12, s14
  s_min_u32 s8, s8, s11
  s_waitcnt lgkmcnt(0)
  s_load_dword s10, s[22:23], 4608
  s_waitcnt lgkmcnt(0)
  s_memtime s[14:15]
  s_waitcnt lgkmcnt(0)
  s_sub_u32 s11, s14, s12
  s_min_u32 s8, s8, s11
  s_waitcnt lgkmcnt(0)
  s_load_dword s10, s[22:23], 12800
  s_waitcnt lgkmcnt(0)
  s_memtime s[12:13]
  s_waitcnt lgkmcnt(0)
  s_sub_u32 s11, s12, s14
  s_min_u32 s9, s9, s11
  s_waitcnt lgkmcnt(0)
  s_load_dword s10, s[22:23], 15104
  s_waitcnt lgkmcnt(0)
  s_memtime s[14:15]
  s_waitcnt lgkmcnt(0)
  s_sub_u32 s11, s14, s12
  s_min_u32 s9, s9, s11
  s_waitcnt lgkmcnt(0)
  s_load_dword s10, s[22:23], 6912
  s_waitcnt lgkmcnt(0)
  s_memtime s[12:13]
  s_waitcnt lgkmcnt(0)
  s_sub_u32 s11, s12, s14
  s_min_u32 s8, s8, s11
  s_cmp_gt_u32 s8, s9
  s_cselect_b32 s21, 1, 0
  v_mov_b32 v4, s21
  v_mov_b32 v5, s62
  v_mov_b32 v6, s30
  v_mov_b32 v7, s31
  s_lshl_b32 s69, s4, 4
  s_add_u32 s69, s69, 950272
  s_mov_b64 exec, 1
  buffer_store_dwordx4 v[4:7], v1, s[24:27], s69 offen sc1
  s_mov_b64 exec, -1
L_pf:
  s_cmp_lg_u32 s7, 6
  s_cbranch_scc1 L_nosample
  v_mov_b32 v1, 0
  s_mov_b32 s70, 4000007
L_spin_33:
  ds_read_b64 v[4:5], v1 offset:696
  s_waitcnt lgkmcnt(0)
  v_cmp_gt_u32 vcc, 8, v5
  s_nop 0
  s_cbranch_vccz L_sdone_34
  s_sleep 2
  s_sub_u32 s70, s70, 1
  s_cbranch_scc0 L_spin_33
L_sdone_34:
  v_mov_b32 v5, s31
  v_lshlrev_b32 v6, 9, v0
  s_lshl_b32 s68, s6, 3
  s_add_u32 s68, s68, 958464
  s_mov_b64 exec, 7
  buffer_store_dwordx2 v[4:5], v6, s[24:27], s68 offen sc1
  s_mov_b64 exec, -1
L_nosample:
  v_mov_b32 v1, 0
  s_mov_b32 s70, 4000007
L_spin_35:
  ds_read_b32 v12, v1 offset:692
  s_waitcnt lgkmcnt(0)
  v_cmp_gt_u32 vcc, 8, v12
  s_nop 0
  s_cbranch_vccz L_sdone_36
  s_sleep 4
  s_sub_u32 s70, s70, 1
  s_cbranch_scc0 L_spin_35
L_sdone_36:
  s_add_u32 s60, s58, 958464
  s_addc_u32 s61, s59, 0
  s_mov_b32 s70, 2
L_calpoll:
  s_lshl_b32 s96, s62, 8
  s_sub_u32 s96, 0, s96
  s_mov_b32 s97, 0
  s_load_dwordx16 s[8:23], s[60:61], 0
  s_load_dwordx16 s[80:95], s[60:61], 64
  s_waitcnt lgkmcnt(0)
  s_add_u32 s96, s96, s8
  s_cmp_lg_u32 s9, s31
  s_addc_u32 s97, s97, 0
  s_add_u32 s96, s96, s10
  s_cmp_lg_u32 s11, s31
  s_addc_u32 s97, s97, 0
  s_add_u32 s96, s96, s12
  s_cmp_lg_u32 s13, s31
  s_addc_u32 s97, s97, 0
  s_add_u32 s96, s96, s14
  s_cmp_lg_u32 s15, s31
  s_addc_u32 s97, s97, 0
  s_add_u32 s96, s96, s16
  s_cmp_lg_u32 s17, s31
  s_addc_u32 s97, s97, 0
  s_add_u32 s96, s96, s18
  s_cmp_lg_u32 s19, s31
  s_addc_u32 s97, s97, 0
  s_add_u32 s96, s96, s20
  s_cmp_lg_u32 s21, s31
  s_addc_u32 s97, s97, 0
  s_add_u32 s96, s96, s22
  s_cmp_lg_u32 s23, s31
  s_addc_u32 s97, s97, 0
  s_add_u32 s96, s96, s80
  s_cmp_lg_u32 s81, s31
  s_addc_u32 s97, s97, 0
  s_add_u32 s96, s96, s82
  s_cmp_lg_u32 s83, s31
  s_addc_u32 s97, s97, 0
  s_add_u32 s96, s96, s84
  s_cmp_lg_u32 s85, s31
  s_addc_u32 s97, s97, 0
  s_add_u32 s96, s96, s86
  s_cmp_lg_u32 s87, s31
  s_addc_u32 s97, s97, 0
  s_add_u32 s96, s96, s88
  s_cmp_lg_u32 s89, s31
  s_addc_u32 s97, s97, 0
  s_add_u32 s96, s96, s90
  s_cmp_lg_u32 s91, s31
  s_addc_u32 s97, s97, 0
  s_add_u32 s96, s96, s92
  s_cmp_lg_u32 s93, s31
  s_addc_u32 s97, s97, 0
  s_add_u32 s96, s96, s94
  s_cmp_lg_u32 s95, s31
  s_addc_u32 s97, s97, 0
  s_load_dwordx16 s[8:23], s[60:61], 128
  s_load_dwordx16 s[80:95], s[60:61], 192
  s_waitcnt lgkmcnt(0)
  s_add_u32 s96, s96, s8
  s_cmp_lg_u32 s9, s31
  s_addc_u32 s97, s97, 0
  s_add_u32 s96, s96, s10
  s_cmp_lg_u32 s11, s31
  s_addc_u32 s97, s97, 0
  s_add_u32 s96, s96, s12
  s_cmp_lg_u32 s13, s31
  s_addc_u32 s97, s97, 0
  s_add_u32 s96, s96, s14
  s_cmp_lg_u32 s15, s31
  s_addc_u32 s97, s97, 0
  s_add_u32 s96, s96, s16
  s_cmp_lg_u32 s17, s31
  s_addc_u32 s97, s97, 0
  s_add_u32 s96, s96, s18
  s_cmp_lg_u32 s19, s31
  s_addc_u32 s97, s97, 0
  s_add_u32 s96, s96, s20
  s_cmp_lg_u32 s21, s31
  s_addc_u32 s97, s97, 0
  s_add_u32 s96, s96, s22
  s_cmp_lg_u32 s23, s31
  s_addc_u32 s97, s97, 0
  s_add_u32 s96, s96, s80
  s_cmp_lg_u32 s81, s31
  s_addc_u32 s97, s97, 0
  s_add_u32 s96, s96, s82
  s_cmp_lg_u32 s83, s31
  s_addc_u32 s97, s97, 0
  s_add_u32 s96, s96, s84
  s_cmp_lg_u32 s85, s31
  s_addc_u32 s97, s97, 0
  s_add_u32 s96, s96, s86
  s_cmp_lg_u32 s87, s31
  s_addc_u32 s97, s97, 0
  s_add_u32 s96, s96, s88
  s_cmp_lg_u32 s89, s31
  s_addc_u32 s97, s97, 0
  s_add_u32 s96, s96, s90
  s_cmp_lg_u32 s91, s31
  s_addc_u32 s97, s97, 0
  s_add_u32 s96, s96, s92
  s_cmp_lg_u32 s93, s31
  s_addc_u32 s97, s97, 0
  s_add_u32 s96, s96, s94
  s_cmp_lg_u32 s95, s31
  s_addc_u32 s97, s97, 0
  s_cmp_eq_u32 s97, 0
  s_cbranch_scc1 L_calok
  s_add_u32 s60, s60, 512
  s_addc_u32 s61, s61, 0
  s_sub_u32 s70, s70, 1
  s_cbranch_scc1 L_stats
  s_sleep 20
  s_branch L_calpoll
L_calok:
  s_ashr_i32 s96, s96, 4
  s_mov_b32 s68, 112
  s_cmp_lt_u32 s5, 30
  s_cselect_b32 s68, -208, s68
  s_cmp_lt_u32 s5, 20
  s_cselect_b32 s68, 112, s68
  s_lshl4_add_u32 s68, s62, s68
  s_add_u32 s68, s68, s96
  v_mov_b32 v12, s68
  v_mov_b32 v13, -1
  ds_write_b64 v1, v[12:13] offset:680
L_stats:
  v_and_b32 v1, 7, v0
  v_lshlrev_b32 v1, 4, v1
  s_mov_b32 s70, 4000007
L_spin_37:
  ds_read_b128 v[4:7], v1 offset:512
  s_waitcnt lgkmcnt(0)
  v_cmp_eq_u32 vcc, 0, v7
  s_nop 0
  s_cbranch_vccz L_sdone_38
  s_sleep 4
  s_sub_u32 s70, s70, 1
  s_cbranch_scc0 L_spin_37
L_sdone_38:
  s_cmp_lg_u32 s3, 3
  s_cbranch_scc1 L_nostat
  s_mov_b32 s68, 0x3fb8aa3b
  v_mov_b32 v2, v4
  s_nop 1
  v_max_f32_dpp v2, v2, v2 quad_perm:[1,0,3,2] row_mask:0xf bank_mask:0xf
  s_nop 1
  v_max_f32_dpp v2, v2, v2 quad_perm:[2,3,0,1] row_mask:0xf bank_mask:0xf
  s_nop 1
  v_max_f32_dpp v2, v2, v2 row_half_mirror row_mask:0xf bank_mask:0xf
  v_sub_f32 v4, v4, v2
  v_mul_f32 v4, s68, v4
  v_exp_f32 v4, v4
  s_nop 0
  v_mul_f32 v3, v4, v5
  s_nop 1
  v_add_f32_dpp v3, v3, v3 quad_perm:[1,0,3,2] row_mask:0xf bank_mask:0xf
  s_nop 1
  v_add_f32_dpp v3, v3, v3 quad_perm:[2,3,0,1] row_mask:0xf bank_mask:0xf
  s_nop 1
  v_add_f32_dpp v3, v3, v3 row_half_mirror row_mask:0xf bank_mask:0xf
  s_lshl_b32 s68, s71, 4
  s_add_u32 s68, s68, 720896
  v_mov_b32 v4, s30
  v_mov_b32 v5, s31
  s_mov_b32 exec_lo, 0x1
  s_mov_b32 exec_hi, 0x0
  buffer_store_dwordx4 v[2:5], v1, s[32:35], s68 offen
  s_mov_b64 exec, -1
  s_cmp_lg_u32 s46, 1
  s_cbranch_scc1 L_slow_39
L_back_40:
  s_mov_b32 s68, 950272
  s_mov_b32 s70, 4000007
L_spin_41:
  buffer_load_dwordx4 v[8:11], v1, s[24:27], s68 offen sc1
  s_waitcnt vmcnt(0)
  v_cmp_ne_u64 vcc, s[30:31], v[10:11]
  s_nop 0
  s_cbranch_vccz L_sdone_42
  s_sleep 8
  s_sub_u32 s70, s70, 1
  s_cbranch_scc0 L_spin_41
L_sdone_42:
  v_cmp_ne_u32 vcc, 0, v8
  s_nop 0
  s_and_b32 s67, vcc_lo, 0xff
  s_bitset1_b32 s67, 8
  v_mov_b32 v4, s67
  v_mov_b32 v1, 0
  ds_write_b32 v1, v4 offset:660
L_nostat:
  s_cmp_lt_u32 s5, 20
  s_cbranch_scc0 L_helper_exit
  s_cmp_ge_u32 s5, 10
  s_cselect_b32 s76, 1, 0
  s_mul_i32 s77, s76, 10
  s_sub_u32 s77, s5, s77
  s_lshr_b32 s68, s3, 1
  s_lshl1_add_u32 s78, s76, s68
  v_bfe_u32 v2, v0, 4, 1
  v_lshlrev_b32 v2, 4, v2
  s_lshl_b32 s68, s78, 5
  v_add_u32 v22, s68, v2
  v_lshlrev_b32 v60, 4, v0
  s_lshl2_add_u32 s73, s4, s78
  s_mul_i32 s73, s73, 6144
  s_and_b32 s68, s3, 1
  s_mul_i32 s68, s68, 3072
  s_add_u32 s73, s73, s68
  s_add_u32 s73, s73, 524288
  v_lshlrev_b32 v62, 2, v0
  s_lshl_b32 s68, s3, 8
  v_add_u32 v61, s68, v62
  v_lshrrev_b32 v2, 5, v0
  v_lshlrev_b32 v2, 11, v2
  v_bfe_u32 v3, v0, 2, 3
  v_lshl_add_u32 v2, v3, 4, v2
  v_and_b32 v3, 1, v0
  v_lshl_add_u32 v63, v3, 13, v2
  s_lshr_b32 s75, s77, 1
  s_lshl_b32 s75, s75, 14
  s_and_b32 s68, s77, 1
  s_lshl_b32 s68, s68, 12
  s_add_u32 s75, s75, s68
  s_lshl1_add_u32 s68, s4, s76
  s_lshl_b32 s68, s68, 7
  s_add_u32 s75, s75, s68
  s_add_u32 s75, s75, 786432
  s_mov_b32 s66, 0xff00ff00
  s_mov_b32 s67, 0xff00ff00
  s_mov_b32 s8, 0x33333333
  s_mov_b32 s9, 0x33333333
  v_mov_b32 v6, s30
  v_mov_b32 v7, s31
  v_cndmask_b32 v52, 0, v6, s[66:67]
  v_cndmask_b32 v53, 0, v7, s[66:67]
  v_cndmask_b32 v54, v6, 0, s[66:67]
  v_cndmask_b32 v55, v7, 0, s[66:67]
  v_mov_b32 v50, s30
  v_mov_b32 v51, s31
  v_lshrrev_b32 v24, 4, v0
  v_lshlrev_b32 v24, 10, v24
  v_bfe_u32 v25, v0, 2, 2
  v_lshl_add_u32 v24, v25, 7, v24
  v_and_b32 v25, 3, v0
  v_lshl_add_u32 v24, v25, 3, v24
  s_mul_i32 s69, s3, 12288
  v_add_u32 v24, s69, v24
  s_cmp_lg_u32 s3, 0
  s_cbranch_scc1 L_noc
  s_lshl_b32 s72, s4, 9
  s_add_u32 s72, s72, 720896
  v_and_b32 v1, 31, v0
  v_lshlrev_b32 v1, 4, v1
  s_mov_b32 s16, s32
  s_mov_b32 s17, s33
  s_mov_b32 s18, 4194304
  s_mov_b32 s19, 0x20000
  s_mov_b32 s70, 4000007
L_spin_43:
  s_sleep 24
  buffer_load_dwordx4 v[4:7], v1, s[16:19], s72 offen sc1 nt
  s_waitcnt vmcnt(0)
  v_cmp_ne_u64 vcc, s[30:31], v[6:7]
  s_nop 0
  s_cbranch_vccz L_sdone_44
  s_and_b32 s99, s70, 7
  s_cmp_eq_u32 s46, 1
  s_cselect_b32 s99, 1, s99
  s_cmp_lg_u32 s99, 0
  s_cselect_b32 s16, s32, s24
  s_cselect_b32 s17, s33, s25
  s_sub_u32 s70, s70, 1
  s_cbranch_scc0 L_spin_43
L_sdone_44:
  s_mov_b32 s68, 0x3fb8aa3b
  v_mov_b32 v2, v4
  s_nop 1
  v_max_f32_dpp v2, v2, v2 quad_perm:[1,0,3,2] row_mask:0xf bank_mask:0xf
  s_nop 1
  v_max_f32_dpp v2, v2, v2 quad_perm:[2,3,0,1] row_mask:0xf bank_mask:0xf
  s_nop 1
  v_max_f32_dpp v2, v2, v2 row_half_mirror row_mask:0xf bank_mask:0xf
  v_sub_f32 v4, v4, v2
  v_mul_f32 v4, s68, v4
  v_exp_f32 v4, v4
  s_nop 0
  v_mul_f32 v3, v4, v5
  s_nop 1
  v_add_f32_dpp v3, v3, v3 quad_perm:[1,0,3,2] row_mask:0xf bank_mask:0xf
  s_nop 1
  v_add_f32_dpp v3, v3, v3 quad_perm:[2,3,0,1] row_mask:0xf bank_mask:0xf
  s_nop 1
  v_add_f32_dpp v3, v3, v3 row_half_mirror row_mask:0xf bank_mask:0xf
  v_rcp_f32 v3, v3
  v_lshrrev_b32 v1, 2, v1
  v_mul_f32 v4, v4, v3
  v_mov_b32 v2, 0
  v_mov_b32 v3, 1
  ds_write_b32 v1, v4 offset:768
  ds_write_b32 v2, v3 offset:664
L_noc:
  v_mov_b32 v1, 0
  s_mov_b32 s70, 4000007
L_spin_45:
  ds_read_b32 v4, v1 offset:664
  s_waitcnt lgkmcnt(0)
  v_cmp_gt_u32 vcc, 1, v4
  s_nop 0
  s_cbranch_vccz L_sdone_46
  s_sleep 2
  s_sub_u32 s70, s70, 1
  s_cbranch_scc0 L_spin_45
L_sdone_46:
  ds_read_b128 v[56:59], v22 offset:768
  s_mov_b32 s12, s44
  s_mov_b32 s13, s45
  s_mov_b32 s14, 7864320
  s_mov_b32 s15, 0x20000
  v_lshrrev_b32 v21, 3, v0
  v_mul_u32_u24 v21, 1280, v21
  v_and_b32 v3, 7, v0
  v_lshl_add_u32 v21, v3, 4, v21
  s_lshl1_add_u32 s60, s4, s76
  s_lshl2_add_u32 s60, s60, s3
  s_mul_i32 s60, s60, 122880
  s_lshl_b32 s69, s77, 7
  s_add_u32 s60, s60, s69
  s_mul_i32 s61, s3, 12288
  s_add_u32 s61, s61, 8704
  v_mov_b32 v23, 1
  s_lshl_b32 s68, s3, 2
  v_mov_b32 v25, s68
  v_mov_b32 v1, 0
  s_mov_b32 s70, 4000007
L_spin_47:
  ds_read_b32 v4, v1 offset:660
  s_waitcnt lgkmcnt(0)
  v_cmp_gt_u32 vcc, 1, v4
  s_nop 0
  s_cbranch_vccz L_sdone_48
  s_sleep 4
  s_sub_u32 s70, s70, 1
  s_cbranch_scc0 L_spin_47
L_sdone_48:
  v_readfirstlane_b32 s47, v4
  v_mov_b32 v1, 0
  s_mov_b32 s70, 4000007
L_spin_49:
  ds_read_b32 v4, v1 offset:644
  s_waitcnt lgkmcnt(0)
  v_cmp_gt_u32 vcc, 8, v4
  s_nop 0
  s_cbranch_vccz L_sdone_50
  s_sleep 2
  s_sub_u32 s70, s70, 1
  s_cbranch_scc0 L_spin_49
L_sdone_50:
  s_mov_b32 m0, s61
  s_nop 0
  buffer_load_dwordx4 v21, s[12:15], s60 offen nt lds
  s_add_u32 s60, s60, 10240
  s_add_u32 s61, s61, 1024
  s_mov_b32 m0, s61
  s_nop 0
  buffer_load_dwordx4 v21, s[12:15], s60 offen nt lds
  s_add_u32 s60, s60, 10240
  s_add_u32 s61, s61, 1024
  s_mov_b32 m0, s61
  s_nop 0
  buffer_load_dwordx4 v21, s[12:15], s60 offen nt lds
  s_add_u32 s60, s60, 10240
  s_add_u32 s61, s61, 1024
  s_mov_b32 m0, s61
  s_nop 0
  buffer_load_dwordx4 v21, s[12:15], s60 offen nt lds
  s_add_u32 s60, s60, 10240
  s_add_u32 s61, s61, 1024
  s_mov_b32 m0, s61
  s_nop 0
  buffer_load_dwordx4 v21, s[12:15], s60 offen nt lds
  s_add_u32 s60, s60, 10240
  s_add_u32 s61, s61, 1024
  s_mov_b32 m0, s61
  s_nop 0
  buffer_load_dwordx4 v21, s[12:15], s60 offen nt lds
  s_add_u32 s60, s60, 10240
  s_add_u32 s61, s61, 1024
  s_waitcnt vmcnt(5)
  s_mov_b32 m0, s61
  s_nop 0
  buffer_load_dwordx4 v21, s[12:15], s60 offen nt lds
  s_add_u32 s60, s60, 10240
  s_add_u32 s61, s61, 1024
  s_waitcnt vmcnt(5)
  s_mov_b32 m0, s61
  s_nop 0
  buffer_load_dwordx4 v21, s[12:15], s60 offen nt lds
  s_add_u32 s60, s60, 10240
  s_add_u32 s61, s61, 1024
  s_waitcnt vmcnt(5)
  s_mov_b32 m0, s61
  s_nop 0
  buffer_load_dwordx4 v21, s[12:15], s60 offen nt lds
  s_add_u32 s60, s60, 10240
  s_add_u32 s61, s61, 1024
  s_waitcnt vmcnt(5)
  s_mov_b32 m0, s61
  s_nop 0
  buffer_load_dwordx4 v21, s[12:15], s60 offen nt lds
  s_add_u32 s60, s60, 10240
  s_add_u32 s61, s61, 1024
  s_waitcnt vmcnt(5)
  s_mov_b32 m0, s61
  s_nop 0
  buffer_load_dwordx4 v21, s[12:15], s60 offen nt lds
  s_add_u32 s60, s60, 10240
  s_add_u32 s61, s61, 1024
  s_waitcnt vmcnt(5)
  s_mov_b32 m0, s61
  s_nop 0
  buffer_load_dwordx4 v21, s[12:15], s60 offen nt lds
  s_waitcnt vmcnt(4)
  ds_read_b64_tr_b16 v[64:65], v24 offset:8704
  ds_read_b64_tr_b16 v[66:67], v24 offset:9216
  ds_read_b64_tr_b16 v[68:69], v24 offset:8736
  ds_read_b64_tr_b16 v[70:71], v24 offset:9248
  ds_read_b64_tr_b16 v[72:73], v24 offset:8768
  ds_read_b64_tr_b16 v[74:75], v24 offset:9280
  ds_read_b64_tr_b16 v[76:77], v24 offset:8800
  ds_read_b64_tr_b16 v[78:79], v24 offset:9312
  ds_read_b64_tr_b16 v[80:81], v24 offset:12800
  ds_read_b64_tr_b16 v[82:83], v24 offset:13312
  ds_read_b64_tr_b16 v[84:85], v24 offset:12832
  ds_read_b64_tr_b16 v[86:87], v24 offset:13344
  ds_read_b64_tr_b16 v[88:89], v24 offset:12864
  ds_read_b64_tr_b16 v[90:91], v24 offset:13376
  ds_read_b64_tr_b16 v[92:93], v24 offset:12896
  ds_read_b64_tr_b16 v[94:95], v24 offset:13408
  v_mov_b32 v1, 0
  s_mov_b32 s70, 4000007
L_spin_51:
  ds_read_b32 v4, v1 offset:668
  s_waitcnt lgkmcnt(0)
  v_cmp_gt_u32 vcc, 1, v4
  s_nop 0
  s_cbranch_vccz L_sdone_52
  s_sleep 1
  s_sub_u32 s70, s70, 1
  s_cbranch_scc0 L_spin_51
L_sdone_52:
  s_waitcnt vmcnt(2)
  buffer_load_dwordx4 v[112:115], v60, s[32:35], s73 offen offset:0 sc1
  buffer_load_dwordx4 v[116:119], v60, s[32:35], s73 offen offset:1024 sc1
  buffer_load_dwordx4 v[120:123], v60, s[32:35], s73 offen offset:2048 sc1
  s_waitcnt vmcnt(3)
  ds_read_b64_tr_b16 v[96:97], v24 offset:16896
  ds_read_b64_tr_b16 v[98:99], v24 offset:17408
  ds_read_b64_tr_b16 v[100:101], v24 offset:16928
  ds_read_b64_tr_b16 v[102:103], v24 offset:17440
  ds_read_b64_tr_b16 v[104:105], v24 offset:16960
  ds_read_b64_tr_b16 v[106:107], v24 offset:17472
  ds_read_b64_tr_b16 v[108:109], v24 offset:16992
  ds_read_b64_tr_b16 v[110:111], v24 offset:17504
  s_waitcnt lgkmcnt(0)
  s_mov_b32 s16, s32
  s_mov_b32 s17, s33
  s_mov_b32 s18, 4194304
  s_mov_b32 s19, 0x20000
  s_mov_b32 s70, 4000007
  s_branch L_opw
L_spin_53:
  buffer_load_dwordx4 v[112:115], v60, s[16:19], s73 offen offset:0 sc1
  buffer_load_dwordx4 v[116:119], v60, s[16:19], s73 offen offset:1024 sc1
  buffer_load_dwordx4 v[120:123], v60, s[16:19], s73 offen offset:2048 sc1
L_opw:
  s_waitcnt vmcnt(2)
  v_xor_b32 v112, v112, v52
  v_xor_b32 v113, v113, v53
  v_xor_b32 v114, v114, v54
  v_xor_b32 v115, v115, v55
  v_or_b32 v2, v112, v113
  v_or_b32 v3, v114, v115
  v_mfma_f32_16x16x32_bf16 v[32:35], v[112:115], v[64:67], 0
  v_mfma_f32_16x16x32_bf16 v[36:39], v[112:115], v[68:71], 0
  v_mfma_f32_16x16x32_bf16 v[40:43], v[112:115], v[72:75], 0
  v_mfma_f32_16x16x32_bf16 v[44:47], v[112:115], v[76:79], 0
  s_waitcnt vmcnt(1)
  v_xor_b32 v116, v116, v52
  v_xor_b32 v117, v117, v53
  v_xor_b32 v118, v118, v54
  v_xor_b32 v119, v119, v55
  v_or3_b32 v2, v2, v116, v117
  v_or3_b32 v3, v3, v118, v119
  v_mfma_f32_16x16x32_bf16 v[32:35], v[116:119], v[80:83], v[32:35]
  v_mfma_f32_16x16x32_bf16 v[36:39], v[116:119], v[84:87], v[36:39]
  v_mfma_f32_16x16x32_bf16 v[40:43], v[116:119], v[88:91], v[40:43]
  v_mfma_f32_16x16x32_bf16 v[44:47], v[116:119], v[92:95], v[44:47]
  s_waitcnt vmcnt(0)
  v_xor_b32 v120, v120, v52
  v_xor_b32 v121, v121, v53
  v_xor_b32 v122, v122, v54
  v_xor_b32 v123, v123, v55
  v_or3_b32 v2, v2, v120, v121
  v_or3_b32 v3, v3, v122, v123
  v_mfma_f32_16x16x32_bf16 v[32:35], v[120:123], v[96:99], v[32:35]
  v_cndmask_b32 v2, v3, v2, s[66:67]
  v_mfma_f32_16x16x32_bf16 v[36:39], v[120:123], v[100:103], v[36:39]
  v_cmp_ne_u32 vcc, 0, v2
  v_mfma_f32_16x16x32_bf16 v[40:43], v[120:123], v[104:107], v[40:43]
  v_mfma_f32_16x16x32_bf16 v[44:47], v[120:123], v[108:111], v[44:47]
  s_nop 0
  s_cbranch_vccz L_sdone_54
  s_and_b32 s99, s70, 7
  s_cmp_eq_u32 s46, 1
  s_cselect_b32 s99, 1, s99
  s_cmp_lg_u32 s99, 0
  s_cselect_b32 s16, s32, s24
  s_cselect_b32 s17, s33, s25
  s_sub_u32 s70, s70, 1
  s_cbranch_scc0 L_spin_53
L_sdone_54:
  s_nop 0
  v_mul_f32 v4, v32, v56
  v_fmac_f32 v4, v33, v57
  v_fmac_f32 v4, v34, v58
  v_fmac_f32 v4, v35, v59
  v_mul_f32 v5, v36, v56
  v_fmac_f32 v5, v37, v57
  v_fmac_f32 v5, v38, v58
  v_fmac_f32 v5, v39, v59
  v_mul_f32 v6, v40, v56
  v_fmac_f32 v6, v41, v57
  v_fmac_f32 v6, v42, v58
  v_fmac_f32 v6, v43, v59
  v_mul_f32 v7, v44, v56
  v_fmac_f32 v7, v45, v57
  v_fmac_f32 v7, v46, v58
  v_fmac_f32 v7, v47, v59
  v_permlane32_swap_b32 v4, v6
  s_nop 0
  v_permlane32_swap_b32 v5, v7
  v_add_f32 v4, v4, v6
  v_add_f32 v5, v5, v7
  s_nop 1
  v_permlane16_swap_b32 v4, v5
  v_add_f32 v4, v4, v5
  ds_write_b32 v61, v4 offset:7168
  s_cmp_lg_u32 s3, 0
  s_waitcnt lgkmcnt(0)
  s_barrier
  s_cbranch_scc1 L_post_wo
  ds_read_b32 v5, v62 offset:7424
  ds_read_b32 v6, v62 offset:7680
  ds_read_b32 v7, v62 offset:7936
  s_waitcnt lgkmcnt(0)
  v_add_f32 v4, v4, v5
  v_add_f32 v6, v6, v7
  v_add_f32 v4, v4, v6
  s_nop 1
  v_mov_b32_dpp v5, v4 quad_perm:[1,0,3,2] row_mask:0xf bank_mask:0xf
  v_cvt_pk_bf16_f32 v4, v4, v5
  s_nop 1
  v_mov_b32_dpp v48, v4 quad_perm:[0,0,0,0] row_mask:0xf bank_mask:0xf
  v_mov_b32_dpp v49, v4 quad_perm:[2,2,2,2] row_mask:0xf bank_mask:0xf
  s_mov_b64 exec, s[8:9]
  buffer_store_dwordx4 v[48:51], v63, s[24:27], s75 offen sc1
  s_barrier
  s_endpgm
L_helper_exit:
  s_endpgm
L_f1:
  s_mov_b32 s12, s48
  s_mov_b32 s13, s49
  s_mov_b32 s14, 1966080
  s_mov_b32 s15, 0x20000
  s_mov_b32 s16, s50
  s_mov_b32 s17, s51
  s_mov_b32 s18, 1966080
  s_mov_b32 s19, 0x20000
  s_sub_u32 s74, s5, 20
  v_lshrrev_b32 v3, 4, v0
  v_and_b32 v2, 7, v0
  v_lshrrev_b32 v62, 3, v0
  v_mul_u32_u24 v62, 3072, v62
  v_lshl_add_u32 v62, v2, 4, v62
  s_lshl3_add_u32 s61, s74, s73
  s_mul_i32 s61, s61, 24576
  s_mul_i32 s68, s4, 384
  s_add_u32 s61, s61, s68
  s_add_u32 s62, s61, 128
  s_add_u32 s63, s61, 256
  s_lshl_b32 s79, s73, 10
  s_add_u32 s79, s79, 8704
  v_mov_b32 v57, 0
  v_mov_b32 v6, s30
  v_mov_b32 v7, s31
  v_mov_b32 v1, 0
  s_mov_b32 s70, 4000007
L_spin_55:
  ds_read_b32 v4, v1 offset:668
  s_waitcnt lgkmcnt(0)
  v_cmp_gt_u32 vcc, 1, v4
  s_nop 0
  s_cbranch_vccz L_sdone_56
  s_sleep 1
  s_sub_u32 s70, s70, 1
  s_cbranch_scc0 L_spin_55
L_sdone_56:
  s_add_u32 m0, s79, 0
  s_nop 0
  buffer_load_dwordx4 v62, s[12:15], s61 offen nt lds
  s_add_u32 m0, s79, 24576
  s_nop 0
  buffer_load_dwordx4 v62, s[16:19], s61 offen nt lds
  s_add_u32 m0, s79, 8192
  s_nop 0
  buffer_load_dwordx4 v62, s[12:15], s62 offen nt lds
  s_add_u32 m0, s79, 32768
  s_nop 0
  buffer_load_dwordx4 v62, s[16:19], s62 offen nt lds
  s_add_u32 m0, s79, 16384
  s_nop 0
  buffer_load_dwordx4 v62, s[12:15], s63 offen nt lds
  s_add_u32 m0, s79, 40960
  s_nop 0
  buffer_load_dwordx4 v62, s[16:19], s63 offen nt lds
  s_setprio 3
  s_cmp_gt_u32 s73, 1
  s_cbranch_scc1 L_f1m
  v_mov_b32 v1, 0
  s_mov_b32 s70, 4000007
L_spin_57:
  ds_read_b32 v4, v1 offset:660
  s_waitcnt lgkmcnt(0)
  v_cmp_gt_u32 vcc, 1, v4
  s_nop 0
  s_cbranch_vccz L_sdone_58
  s_sleep 1
  s_sub_u32 s70, s70, 1
  s_cbranch_scc0 L_spin_57
L_sdone_58:
  v_readfirstlane_b32 s47, v4
  s_lshl1_add_u32 s74, s74, s73
  v_lshl_add_u32 v61, v2, 2, v3
  v_lshlrev_b32 v61, 1, v61
  s_lshl_b32 s68, s74, 6
  v_add_u32 v61, s68, v61
  global_load_ushort v56, v61, s[36:37]
  v_lshlrev_b32 v54, 5, v3
  v_lshl_add_u32 v54, v2, 2, v54
  v_lshlrev_b32 v55, 4, v0
  s_lshl_b32 s72, s4, 9
  s_lshl4_add_u32 s72, s74, s72
  s_add_u32 s72, s72, 2752512
  s_mul_i32 s75, s4, 20
  s_add_u32 s75, s75, s74
  s_lshl_b32 s75, s75, 7
  s_add_u32 s75, s75, 2768896
  s_mov_b64 exec, 1
  buffer_load_dword v104, v54, s[32:35], s75 offen sc1
  buffer_load_dword v105, v55, s[32:35], s72 offen sc1
  s_mov_b64 exec, -1
  s_lshr_b32 s60, s74, 2
  s_lshl_b32 s60, s60, 14
  s_and_b32 s68, s74, 3
  s_lshl_b32 s68, s68, 11
  s_add_u32 s60, s60, s68
  s_lshr_b32 s68, s47, s4
  s_and_b32 s68, s68, 1
  s_lshl_b32 s68, s68, 13
  s_add_u32 s60, s60, s68
  s_add_u32 s60, s60, 786432
  v_lshlrev_b32 v51, 4, v3
  v_lshl_add_u32 v51, v2, 1, v51
  v_and_b32 v4, 1, v0
  v_mul_u32_u24 v4, 126, v4
  v_add_u32 v51, v51, v4
  s_lshl_b32 s68, s73, 6
  v_add_u32 v51, s68, v51
  s_mov_b32 s77, 0x3f80
  s_mov_b32 s71, 0x3f800000
  v_mov_b32 v14, s30
  v_mov_b32 v15, s31
  v_mov_b32 v8, 0
  v_mov_b32 v9, 0
  v_mov_b32 v10, 0
  v_mov_b32 v11, 0
  v_not_b32 v98, s30
  v_not_b32 v102, s30
  s_waitcnt vmcnt(2)
  s_barrier
  v_lshlrev_b32 v56, 16, v56
  s_mov_b32 s70, 4000007
  s_mov_b64 s[20:21], -1
  s_mov_b64 s[22:23], -1
L_ypoll:
  s_mov_b64 exec, s[20:21]
  buffer_load_dwordx4 v[96:99], v55, s[24:27], s60 offen sc1
  s_mov_b64 exec, s[22:23]
  buffer_load_dwordx4 v[100:103], v55, s[24:27], s60 offen offset:1024 sc1
  s_mov_b64 exec, -1
  v_cmp_ne_u64 s[20:21], s[30:31], v[98:99]
  v_cmp_ne_u64 s[22:23], s[30:31], v[102:103]
  s_nop 0
  s_or_b64 vcc, s[20:21], s[22:23]
  s_cbranch_scc0 L_yok
  v_cmp_ne_u64 s[20:21], s[30:31], v[98:99]
  v_cmp_ne_u64 s[22:23], s[30:31], v[102:103]
  s_nop 0
  s_or_b64 vcc, s[20:21], s[22:23]
  s_cbranch_scc0 L_yok
  v_cmp_ne_u64 s[20:21], s[30:31], v[98:99]
  v_cmp_ne_u64 s[22:23], s[30:31], v[102:103]
  s_nop 0
  s_or_b64 vcc, s[20:21], s[22:23]
  s_cbranch_scc0 L_yok
  v_cmp_ne_u64 s[20:21], s[30:31], v[98:99]
  v_cmp_ne_u64 s[22:23], s[30:31], v[102:103]
  s_nop 0
  s_or_b64 vcc, s[20:21], s[22:23]
  s_cbranch_scc0 L_yok
  v_cmp_ne_u64 s[20:21], s[30:31], v[98:99]
  v_cmp_ne_u64 s[22:23], s[30:31], v[102:103]
  s_nop 0
  s_or_b64 vcc, s[20:21], s[22:23]
  s_cbranch_scc0 L_yok
  v_cmp_ne_u64 s[20:21], s[30:31], v[98:99]
  v_cmp_ne_u64 s[22:23], s[30:31], v[102:103]
  s_nop 0
  s_or_b64 vcc, s[20:21], s[22:23]
  s_cbranch_scc0 L_yok
  s_waitcnt vmcnt(16)
  s_sub_u32 s70, s70, 1
  s_cbranch_scc0 L_ypoll
L_yok:
  v_dot2c_f32_bf16 v8, s77, v96
  v_dot2c_f32_bf16 v10, s77, v97
  v_dot2c_f32_bf16 v9, s71, v96
  v_dot2c_f32_bf16 v11, s71, v97
  v_dot2c_f32_bf16 v8, s77, v100
  v_dot2c_f32_bf16 v10, s77, v101
  v_dot2c_f32_bf16 v9, s71, v100
  v_dot2c_f32_bf16 v11, s71, v101
  s_nop 0
  v_permlane32_swap_b32 v8, v10
  s_nop 0
  v_permlane32_swap_b32 v9, v11
  v_add_f32 v8, v8, v10
  v_add_f32 v9, v9, v11
  s_nop 1
  v_permlane16_swap_b32 v8, v9
  v_add_f32 v8, v8, v9
  s_nop 1
  v_add_f32_dpp v8, v8, v8 row_ror:8 row_mask:0xf bank_mask:0xf
  v_cvt_pk_bf16_f32 v8, v57, v8
  v_add_f32 v12, v8, v56
  s_nop 1
  v_mov_b32_dpp v13, v12 quad_perm:[1,0,3,2] row_mask:0xf bank_mask:0xf
  v_cvt_pk_bf16_f32 v12, v12, v13
  ds_write_b32 v51, v12 offset:7168
  v_lshlrev_b32 v4, 16, v12
  v_mul_f32 v5, v4, v4
  s_nop 0
  v_add_f32_dpp v4, v4, v4 quad_perm:[1,0,3,2] row_mask:0xf bank_mask:0xf
  v_add_f32_dpp v5, v5, v5 quad_perm:[1,0,3,2] row_mask:0xf bank_mask:0xf
  s_nop 0
  v_add_f32_dpp v4, v4, v4 quad_perm:[2,3,0,1] row_mask:0xf bank_mask:0xf
  v_add_f32_dpp v5, v5, v5 quad_perm:[2,3,0,1] row_mask:0xf bank_mask:0xf
  s_nop 0
  v_add_f32_dpp v4, v4, v4 row_half_mirror row_mask:0xf bank_mask:0xf
  v_add_f32_dpp v5, v5, v5 row_half_mirror row_mask:0xf bank_mask:0xf
  s_waitcnt lgkmcnt(0)
  s_barrier
  v_mov_b32_dpp v13, v12 quad_perm:[2,3,2,3] row_mask:0xf bank_mask:0xf
  v_mov_b32 v8, v4
  v_mov_b32 v9, v5
  s_nop 0
  v_permlane16_swap_b32 v4, v8
  v_permlane16_swap_b32 v5, v9
  v_add_f32 v4, v4, v8
  v_add_f32 v5, v5, v9
  v_mov_b32 v8, v4
  v_mov_b32 v9, v5
  s_nop 0
  v_permlane32_swap_b32 v4, v8
  v_permlane32_swap_b32 v5, v9
  v_add_f32 v4, v4, v8
  v_add_f32 v5, v5, v9
  s_mov_b32 exec_lo, 0x1
  s_mov_b32 exec_hi, 0x0
  buffer_store_dwordx4 v[4:7], v55, s[32:35], s72 offen
  s_mov_b32 exec_lo, 0x110011
  s_mov_b32 exec_hi, 0x110011
  buffer_store_dwordx4 v[12:15], v54, s[32:35], s75 offen
  s_mov_b64 exec, -1
  s_cmp_lg_u32 s46, 1
  s_cbranch_scc1 L_slow_59
L_back_60:
  s_endpgm
L_f1m:
  s_sub_u32 s68, s73, 2
  s_lshr_b32 s78, s68, 1
  s_and_b32 s69, s73, 1
  v_lshlrev_b32 v58, 7, v3
  v_bfe_u32 v4, v0, 2, 2
  v_lshl_add_u32 v58, v4, 9, v58
  v_and_b32 v4, 3, v0
  v_lshl_add_u32 v58, v4, 3, v58
  s_lshl_b32 s75, s78, 13
  s_lshl_b32 s68, s69, 6
  s_add_u32 s75, s75, s68
  v_add_u32 v58, s75, v58
  v_lshlrev_b32 v52, 4, v3
  v_and_b32 v59, 1, v3
  v_cmp_eq_u32 s[62:63], 1, v59
  v_mul_u32_u24 v59, 3072, v59
  v_bfe_u32 v4, v0, 3, 1
  v_lshl_add_u32 v59, v4, 9, v59
  v_lshl_add_u32 v59, v2, 4, v59
  s_mul_i32 s76, s4, 3
  s_add_u32 s76, s76, s78
  s_lshl1_add_u32 s76, s76, s69
  s_mul_i32 s76, s76, 6144
  s_lshr_b32 s68, s74, 2
  s_lshl_b32 s68, s68, 10
  s_add_u32 s76, s76, s68
  s_and_b32 s68, s74, 3
  s_lshl_b32 s68, s68, 7
  s_add_u32 s76, s76, s68
  s_add_u32 s77, s76, 3145728
  s_add_u32 s76, s76, 2228224
  v_mov_b32 v8, 0x3f803f80
  v_mov_b32 v9, 0x3f803f80
  v_mov_b32 v10, 0x3f803f80
  v_mov_b32 v11, 0x3f803f80
  v_mov_b32 v34, s30
  v_mov_b32 v35, s31
  s_waitcnt vmcnt(0)
  s_barrier
  ds_read_b64_tr_b16 v[64:65], v58 offset:8704
  ds_read_b64_tr_b16 v[66:67], v58 offset:10752
  ds_read_b64_tr_b16 v[68:69], v58 offset:8736
  ds_read_b64_tr_b16 v[70:71], v58 offset:10784
  ds_read_b64_tr_b16 v[72:73], v58 offset:33280
  ds_read_b64_tr_b16 v[74:75], v58 offset:35328
  ds_read_b64_tr_b16 v[76:77], v58 offset:33312
  ds_read_b64_tr_b16 v[78:79], v58 offset:35360
  ds_read_b64_tr_b16 v[80:81], v58 offset:12800
  ds_read_b64_tr_b16 v[82:83], v58 offset:14848
  ds_read_b64_tr_b16 v[84:85], v58 offset:12832
  ds_read_b64_tr_b16 v[86:87], v58 offset:14880
  ds_read_b64_tr_b16 v[88:89], v58 offset:37376
  ds_read_b64_tr_b16 v[90:91], v58 offset:39424
  ds_read_b64_tr_b16 v[92:93], v58 offset:37408
  ds_read_b64_tr_b16 v[94:95], v58 offset:39456
  s_waitcnt lgkmcnt(0)
  v_mfma_f32_16x16x32_bf16 v[16:19], v[8:11], v[64:67], 0
  v_mfma_f32_16x16x32_bf16 v[20:23], v[8:11], v[68:71], 0
  v_mfma_f32_16x16x32_bf16 v[24:27], v[8:11], v[72:75], 0
  v_mfma_f32_16x16x32_bf16 v[28:31], v[8:11], v[76:79], 0
  v_mfma_f32_16x16x32_bf16 v[16:19], v[8:11], v[80:83], v[16:19]
  v_mfma_f32_16x16x32_bf16 v[20:23], v[8:11], v[84:87], v[20:23]
  v_mfma_f32_16x16x32_bf16 v[24:27], v[8:11], v[88:91], v[24:27]
  v_mfma_f32_16x16x32_bf16 v[28:31], v[8:11], v[92:95], v[28:31]
  s_nop 5
  v_cndmask_b32 v32, v16, v20, s[62:63]
  s_nop 0
  v_cndmask_b32 v33, v24, v28, s[62:63]
  s_mov_b32 exec_lo, 0xffffffff
  s_mov_b32 exec_hi, 0x0
  buffer_store_dwordx4 v[32:35], v59, s[32:35], s77 offen
  s_mov_b64 exec, -1
  s_cmp_lg_u32 s46, 1
  s_cbranch_scc1 L_slow_61
L_back_62:
  s_barrier
  ds_read_b128 v[8:11], v52 offset:7168
  ds_read_b128 v[12:15], v52 offset:7232
  s_waitcnt lgkmcnt(1)
  v_mfma_f32_16x16x32_bf16 v[16:19], v[8:11], v[64:67], 0
  v_mfma_f32_16x16x32_bf16 v[20:23], v[8:11], v[68:71], 0
  v_mfma_f32_16x16x32_bf16 v[24:27], v[8:11], v[72:75], 0
  v_mfma_f32_16x16x32_bf16 v[28:31], v[8:11], v[76:79], 0
  s_waitcnt lgkmcnt(0)
  v_mfma_f32_16x16x32_bf16 v[16:19], v[12:15], v[80:83], v[16:19]
  v_mfma_f32_16x16x32_bf16 v[20:23], v[12:15], v[84:87], v[20:23]
  v_mfma_f32_16x16x32_bf16 v[24:27], v[12:15], v[88:91], v[24:27]
  v_mfma_f32_16x16x32_bf16 v[28:31], v[12:15], v[92:95], v[28:31]
  s_nop 5
  v_cndmask_b32 v4, v16, v20, s[62:63]
  s_nop 0
  v_cndmask_b32 v5, v24, v28, s[62:63]
  s_mov_b32 exec_lo, 0xffffffff
  s_mov_b32 exec_hi, 0x0
  buffer_store_dwordx4 v[4:7], v59, s[32:35], s76 offen
  s_mov_b64 exec, -1
  s_cmp_lg_u32 s46, 1
  s_cbranch_scc1 L_slow_63
L_back_64:
  s_endpgm
L_post_wo:
  s_cmp_gt_u32 s5, 11
  s_cbranch_scc1 L_end
  s_cmp_eq_u32 s3, 3
  s_cbranch_scc1 L_end
  v_mov_b32 v57, 0
  s_cmp_eq_u32 s3, 1
  s_cbranch_scc1 L_hid
  s_barrier
  s_and_b32 s68, s4, 1
  s_lshl_b32 s68, s68, 2
  s_sub_u32 s68, 12, s68
  s_cmp_ge_u32 s5, s68
  s_cbranch_scc1 L_end
  s_mul_i32 s72, s4, 5
  s_add_u32 s72, s72, 1
  s_lshr_b32 s72, s72, 1
  s_lshr_b32 s68, s5, 2
  s_add_u32 s72, s72, s68
  s_and_b32 s73, s5, 3
  v_lshrrev_b32 v2, 1, v0
  v_lshlrev_b32 v2, 7, v2
  v_and_b32 v3, 1, v0
  v_lshl_add_u32 v96, v3, 4, v2
  s_lshl_b32 s10, s72, 15
  s_lshr_b32 s68, s47, s4
  s_and_b32 s68, s68, 1
  s_lshl_b32 s68, s68, 13
  s_add_u32 s10, s10, s68
  s_lshl_b32 s68, s73, 5
  s_add_u32 s10, s10, s68
  s_add_u32 s10, s10, 1048576
  s_add_u32 s11, s10, 4096
  s_add_u32 s12, s10, 16384
  v_lshrrev_b32 v4, 4, v0
  v_lshl_add_u32 v97, v3, 2, v4
  v_lshlrev_b32 v97, 1, v97
  v_lshlrev_b32 v99, 5, v4
  s_and_b32 s68, s73, 1
  s_lshl_b32 s68, s68, 5
  v_lshl_add_u32 v98, v3, 4, s68
  s_mul_i32 s13, s4, 20
  s_add_u32 s13, s13, s72
  s_lshl_b32 s13, s13, 7
  s_lshr_b32 s68, s73, 1
  s_lshl4_add_u32 s13, s68, s13
  s_add_u32 s13, s13, 2768896
  s_lshl2_add_u32 s14, s72, s73
  s_lshl_b32 s14, s14, 4
  s_mov_b32 s8, 0x30003
  s_mov_b32 s9, 0x30003
  s_mov_b32 s77, 0x3f80
  s_mov_b32 s71, 0x3f800000
  v_mov_b32 v8, 0
  v_mov_b32 v9, 0
  v_mov_b32 v10, 0
  v_mov_b32 v11, 0
  s_mov_b32 s64, s54
  s_mov_b32 s65, s55
  s_mov_b32 s66, 1280
  s_mov_b32 s67, 0x20000
  s_setprio 0
  v_mov_b32 v1, 0
  s_mov_b32 s70, 4000007
L_spin_65:
  ds_read_b32 v4, v1 offset:736
  s_waitcnt lgkmcnt(0)
  v_cmp_gt_u32 vcc, 1, v4
  s_nop 0
  s_cbranch_vccz L_sdone_66
  s_sub_u32 s70, s70, 1
  s_cbranch_scc0 L_spin_65
L_sdone_66:
  s_sleep 16
  s_mov_b32 s16, s32
  s_mov_b32 s17, s33
  s_mov_b32 s18, 4194304
  s_mov_b32 s19, 0x20000
  s_mov_b32 s70, 4000007
L_spin_67:
  buffer_load_dwordx4 v[4:7], v99, s[16:19], s13 offen sc1
  buffer_load_dwordx4 v[16:19], v96, s[24:27], s10 offen sc1
  buffer_load_dwordx4 v[20:23], v96, s[24:27], s11 offen sc1
  buffer_load_dwordx4 v[24:27], v96, s[24:27], s12 offen sc1
  s_waitcnt vmcnt(0)
  v_cmp_ne_u64 vcc, s[30:31], v[6:7]
  v_cmp_ne_u64 s[20:21], s[30:31], v[18:19]
  v_cmp_ne_u64 s[22:23], s[30:31], v[22:23]
  s_or_b64 vcc, vcc, s[20:21]
  v_cmp_ne_u64 s[20:21], s[30:31], v[26:27]
  s_or_b64 vcc, vcc, s[22:23]
  s_or_b64 vcc, vcc, s[20:21]
  s_nop 0
  s_cbranch_vccz L_sdone_68
  s_and_b32 s99, s70, 7
  s_cmp_eq_u32 s46, 1
  s_cselect_b32 s99, 1, s99
  s_cmp_lg_u32 s99, 0
  s_cselect_b32 s16, s32, s24
  s_cselect_b32 s17, s33, s25
  s_sub_u32 s70, s70, 1
  s_cbranch_scc0 L_spin_67
L_sdone_68:
  v_dot2c_f32_bf16 v8, s77, v16
  v_dot2c_f32_bf16 v10, s77, v17
  v_dot2c_f32_bf16 v9, s71, v16
  v_dot2c_f32_bf16 v11, s71, v17
  v_dot2c_f32_bf16 v8, s77, v20
  v_dot2c_f32_bf16 v10, s77, v21
  v_dot2c_f32_bf16 v9, s71, v20
  v_dot2c_f32_bf16 v11, s71, v21
  v_dot2c_f32_bf16 v8, s77, v24
  v_dot2c_f32_bf16 v10, s77, v25
  v_dot2c_f32_bf16 v9, s71, v24
  v_dot2c_f32_bf16 v11, s71, v25
  v_lshrrev_b64 v[58:59], v98, v[4:5]
  v_permlane32_swap_b32 v8, v10
  s_nop 0
  v_permlane32_swap_b32 v9, v11
  v_add_f32 v8, v8, v10
  v_add_f32 v9, v9, v11
  v_lshlrev_b32 v58, 16, v58
  s_nop 0
  v_permlane16_swap_b32 v8, v9
  v_add_f32 v8, v8, v9
  s_nop 1
  v_add_f32_dpp v8, v8, v8 row_ror:8 row_mask:0xf bank_mask:0xf
  s_nop 1
  v_add_f32_dpp v8, v8, v8 row_ror:4 row_mask:0xf bank_mask:0xf
  s_nop 1
  v_add_f32_dpp v8, v8, v8 quad_perm:[2,3,0,1] row_mask:0xf bank_mask:0xf
  v_cvt_pk_bf16_f32 v8, v57, v8
  v_add_f32 v8, v8, v58
  v_cvt_pk_bf16_f32 v8, v8, v8
  s_mov_b64 exec, s[8:9]
  buffer_store_short v8, v97, s[64:67], s14 offen
  s_cmp_lg_u32 s14, 0
  s_cbranch_scc1 L_fin_exit
  s_mov_b64 exec, 1
  v_mov_b32 v4, s30
  v_mov_b32 v5, s31
  s_mov_b32 s68, 917504
  buffer_store_dwordx2 v[4:5], v57, s[24:27], s68 offen
L_fin_exit:
  s_endpgm
L_hid:
  s_mul_i32 s72, s4, 12
  s_add_u32 s72, s72, s5
  v_lshrrev_b32 v4, 5, v0
  v_and_b32 v2, 7, v0
  v_lshl_add_u32 v62, v4, 3, v2
  v_lshlrev_b32 v62, 1, v62
  v_lshlrev_b32 v63, 2, v2
  v_lshlrev_b32 v60, 4, v0
  v_and_b32 v3, 31, v0
  v_lshlrev_b32 v61, 4, v3
  s_lshl_b32 s65, s4, 9
  s_add_u32 s65, s65, 2752512
  s_mul_i32 s60, s72, 3072
  s_add_u32 s62, s60, 3145728
  s_add_u32 s60, s60, 2228224
  s_mov_b32 s8, 0xfffff
  s_mov_b32 s9, 0xfffff
  s_mov_b32 s10, 0xffff
  s_mov_b32 s11, 0xffff
  v_mov_b32 v59, 1
  v_mov_b32 v24, 0
  v_mov_b32 v25, 0
  v_mov_b32 v26, s30
  v_mov_b32 v27, s31
  v_mov_b32 v136, 0
  v_mov_b32 v137, 0
  v_mov_b32 v138, s30
  v_mov_b32 v139, s31
  v_mov_b32 v140, 0
  v_mov_b32 v141, 0
  v_mov_b32 v142, s30
  v_mov_b32 v143, s31
  v_not_b32 v18, s30
  v_not_b32 v22, s30
  v_not_b32 v130, s30
  v_not_b32 v134, s30
  s_mov_b64 exec, s[10:11]
  v_not_b32 v26, s30
  v_not_b32 v138, s30
  s_mov_b64 exec, s[8:9]
  v_not_b32 v142, s30
  s_mov_b64 exec, -1
  s_barrier
  v_cmp_ne_u64 vcc, s[30:31], v[18:19]
  v_cmp_ne_u64 s[20:21], s[30:31], v[22:23]
  v_cmp_ne_u64 s[22:23], s[30:31], v[26:27]
  s_or_b64 vcc, vcc, s[20:21]
  s_or_b64 vcc, vcc, s[22:23]
  s_nop 0
  s_cbranch_vccz L_pok_70
  s_cmp_lg_u32 s46, 1
  s_cbranch_scc1 L_pslow_69
  s_mov_b32 s70, 4000007
L_fp_71:
  buffer_load_dwordx4 v[16:19], v60, s[32:35], s62 offen sc1
  buffer_load_dwordx4 v[20:23], v60, s[32:35], s62 offen offset:1024 sc1
  s_mov_b64 exec, s[10:11]
  buffer_load_dwordx4 v[24:27], v60, s[32:35], s62 offen offset:2048 sc1
  s_mov_b64 exec, -1
  s_mov_b64 exec, s[8:9]
  buffer_load_dwordx4 v[140:143], v61, s[32:35], s65 offen sc1
  s_mov_b64 exec, -1
  buffer_load_dwordx4 v[128:131], v60, s[32:35], s60 offen sc1
  buffer_load_dwordx4 v[132:135], v60, s[32:35], s60 offen offset:1024 sc1
  s_mov_b64 exec, s[10:11]
  buffer_load_dwordx4 v[136:139], v60, s[32:35], s60 offen offset:2048 sc1
  s_mov_b64 exec, -1
  v_cmp_ne_u64 vcc, s[30:31], v[18:19]
  v_cmp_ne_u64 s[20:21], s[30:31], v[22:23]
  v_cmp_ne_u64 s[22:23], s[30:31], v[26:27]
  s_or_b64 vcc, vcc, s[20:21]
  s_or_b64 vcc, vcc, s[22:23]
  s_nop 0
  s_cbranch_vccz L_pok_70
  v_cmp_ne_u64 vcc, s[30:31], v[18:19]
  v_cmp_ne_u64 s[20:21], s[30:31], v[22:23]
  v_cmp_ne_u64 s[22:23], s[30:31], v[26:27]
  s_or_b64 vcc, vcc, s[20:21]
  s_or_b64 vcc, vcc, s[22:23]
  s_nop 0
  s_cbranch_vccz L_pok_70
  v_cmp_ne_u64 vcc, s[30:31], v[18:19]
  v_cmp_ne_u64 s[20:21], s[30:31], v[22:23]
  v_cmp_ne_u64 s[22:23], s[30:31], v[26:27]
  s_or_b64 vcc, vcc, s[20:21]
  s_or_b64 vcc, vcc, s[22:23]
  s_nop 0
  s_cbranch_vccz L_pok_70
  v_cmp_ne_u64 vcc, s[30:31], v[18:19]
  v_cmp_ne_u64 s[20:21], s[30:31], v[22:23]
  v_cmp_ne_u64 s[22:23], s[30:31], v[26:27]
  s_or_b64 vcc, vcc, s[20:21]
  s_or_b64 vcc, vcc, s[22:23]
  s_nop 0
  s_cbranch_vccz L_pok_70
  v_cmp_ne_u64 vcc, s[30:31], v[18:19]
  v_cmp_ne_u64 s[20:21], s[30:31], v[22:23]
  v_cmp_ne_u64 s[22:23], s[30:31], v[26:27]
  s_or_b64 vcc, vcc, s[20:21]
  s_or_b64 vcc, vcc, s[22:23]
  s_nop 0
  s_cbranch_vccz L_pok_70
  v_cmp_ne_u64 vcc, s[30:31], v[18:19]
  v_cmp_ne_u64 s[20:21], s[30:31], v[22:23]
  v_cmp_ne_u64 s[22:23], s[30:31], v[26:27]
  s_or_b64 vcc, vcc, s[20:21]
  s_or_b64 vcc, vcc, s[22:23]
  s_nop 0
  s_cbranch_vccz L_pok_70
  v_cmp_ne_u64 vcc, s[30:31], v[18:19]
  v_cmp_ne_u64 s[20:21], s[30:31], v[22:23]
  v_cmp_ne_u64 s[22:23], s[30:31], v[26:27]
  s_or_b64 vcc, vcc, s[20:21]
  s_or_b64 vcc, vcc, s[22:23]
  s_nop 0
  s_cbranch_vccz L_pok_70
  v_cmp_ne_u64 vcc, s[30:31], v[18:19]
  v_cmp_ne_u64 s[20:21], s[30:31], v[22:23]
  v_cmp_ne_u64 s[22:23], s[30:31], v[26:27]
  s_or_b64 vcc, vcc, s[20:21]
  s_or_b64 vcc, vcc, s[22:23]
  s_nop 0
  s_cbranch_vccz L_pok_70
  s_waitcnt vmcnt(14)
  s_sub_u32 s70, s70, 1
  s_cbranch_scc0 L_fp_71
  s_branch L_pok_70
L_pslow_69:
  s_mov_b32 s16, s32
  s_mov_b32 s17, s33
  s_mov_b32 s18, 4194304
  s_mov_b32 s19, 0x20000
  s_mov_b32 s70, 4000007
L_spin_72:
  buffer_load_dwordx4 v[16:19], v60, s[16:19], s62 offen sc1
  buffer_load_dwordx4 v[20:23], v60, s[16:19], s62 offen offset:1024 sc1
  s_mov_b64 exec, s[10:11]
  buffer_load_dwordx4 v[24:27], v60, s[16:19], s62 offen offset:2048 sc1
  s_mov_b64 exec, -1
  s_mov_b64 exec, s[8:9]
  buffer_load_dwordx4 v[140:143], v61, s[16:19], s65 offen sc1
  s_mov_b64 exec, -1
  buffer_load_dwordx4 v[128:131], v60, s[16:19], s60 offen sc1
  buffer_load_dwordx4 v[132:135], v60, s[16:19], s60 offen offset:1024 sc1
  s_mov_b64 exec, s[10:11]
  buffer_load_dwordx4 v[136:139], v60, s[16:19], s60 offen offset:2048 sc1
  s_mov_b64 exec, -1
  s_waitcnt vmcnt(0)
  v_cmp_ne_u64 vcc, s[30:31], v[18:19]
  v_cmp_ne_u64 s[20:21], s[30:31], v[22:23]
  v_cmp_ne_u64 s[22:23], s[30:31], v[26:27]
  s_or_b64 vcc, vcc, s[20:21]
  s_or_b64 vcc, vcc, s[22:23]
  s_nop 0
  s_cbranch_vccz L_sdone_73
  s_and_b32 s99, s70, 7
  s_cmp_eq_u32 s46, 1
  s_cselect_b32 s99, 1, s99
  s_cmp_lg_u32 s99, 0
  s_cselect_b32 s16, s32, s24
  s_cselect_b32 s17, s33, s25
  s_sub_u32 s70, s70, 1
  s_cbranch_scc0 L_spin_72
L_sdone_73:
L_pok_70:
  v_pk_add_f32 v[40:41], v[16:17], v[20:21]
  v_pk_add_f32 v[40:41], v[40:41], v[24:25]
  s_nop 1
  v_add_f32_dpp v40, v40, v40 row_ror:8 row_mask:0xf bank_mask:0xf
  v_add_f32_dpp v41, v41, v41 row_ror:8 row_mask:0xf bank_mask:0xf
  v_mov_b32 v42, v40
  v_mov_b32 v43, v41
  s_nop 0
  v_permlane16_swap_b32 v40, v42
  v_permlane16_swap_b32 v41, v43
  v_add_f32 v40, v40, v42
  v_add_f32 v41, v41, v43
  v_cmp_ne_u64 vcc, s[30:31], v[142:143]
  s_nop 0
  s_cbranch_vccz L_pok_75
  s_cmp_lg_u32 s46, 1
  s_cbranch_scc1 L_pslow_74
  s_mov_b32 s70, 4000007
L_fp_76:
  s_mov_b64 exec, s[8:9]
  buffer_load_dwordx4 v[140:143], v61, s[32:35], s65 offen sc1
  s_mov_b64 exec, -1
  v_cmp_ne_u64 vcc, s[30:31], v[142:143]
  s_nop 0
  s_cbranch_vccz L_pok_75
  v_cmp_ne_u64 vcc, s[30:31], v[142:143]
  s_nop 0
  s_cbranch_vccz L_pok_75
  s_waitcnt vmcnt(12)
  s_sub_u32 s70, s70, 1
  s_cbranch_scc0 L_fp_76
  s_branch L_pok_75
L_pslow_74:
  s_mov_b32 s16, s32
  s_mov_b32 s17, s33
  s_mov_b32 s18, 4194304
  s_mov_b32 s19, 0x20000
  s_mov_b32 s70, 4000007
L_spin_77:
  s_mov_b64 exec, s[8:9]
  buffer_load_dwordx4 v[140:143], v61, s[16:19], s65 offen sc1
  s_mov_b64 exec, -1
  s_waitcnt vmcnt(0)
  v_cmp_ne_u64 vcc, s[30:31], v[142:143]
  s_nop 0
  s_cbranch_vccz L_sdone_78
  s_and_b32 s99, s70, 7
  s_cmp_eq_u32 s46, 1
  s_cselect_b32 s99, 1, s99
  s_cmp_lg_u32 s99, 0
  s_cselect_b32 s16, s32, s24
  s_cselect_b32 s17, s33, s25
  s_sub_u32 s70, s70, 1
  s_cbranch_scc0 L_spin_77
L_sdone_78:
L_pok_75:
  s_cmp_lg_u32 s46, 1
  s_cbranch_scc1 L_nopre
  buffer_load_dwordx4 v[128:131], v60, s[32:35], s60 offen sc1
  buffer_load_dwordx4 v[132:135], v60, s[32:35], s60 offen offset:1024 sc1
  s_mov_b64 exec, s[10:11]
  buffer_load_dwordx4 v[136:139], v60, s[32:35], s60 offen offset:2048 sc1
  s_mov_b64 exec, -1
L_nopre:
  v_add_f32_dpp v36, v140, v140 quad_perm:[1,0,3,2] row_mask:0xf bank_mask:0xf
  v_add_f32_dpp v37, v141, v141 quad_perm:[1,0,3,2] row_mask:0xf bank_mask:0xf
  s_nop 0
  v_add_f32_dpp v36, v36, v36 quad_perm:[2,3,0,1] row_mask:0xf bank_mask:0xf
  v_add_f32_dpp v37, v37, v37 quad_perm:[2,3,0,1] row_mask:0xf bank_mask:0xf
  s_nop 0
  v_add_f32_dpp v36, v36, v36 row_half_mirror row_mask:0xf bank_mask:0xf
  v_add_f32_dpp v37, v37, v37 row_half_mirror row_mask:0xf bank_mask:0xf
  s_nop 0
  v_add_f32_dpp v46, v36, v36 row_mirror row_mask:0xf bank_mask:0xf
  v_add_f32_dpp v47, v37, v37 row_mirror row_mask:0xf bank_mask:0xf
  v_add_f32_dpp v36, v36, v36 row_mirror row_mask:0xf bank_mask:0xf
  v_add_f32_dpp v37, v37, v37 row_mirror row_mask:0xf bank_mask:0xf
  s_nop 0
  v_permlane16_swap_b32 v36, v46
  v_permlane16_swap_b32 v37, v47
  v_pk_add_f32 v[36:37], v[36:37], v[46:47]
  s_cbranch_scc1 L_nopre2
  buffer_load_dwordx4 v[128:131], v60, s[32:35], s60 offen sc1
  buffer_load_dwordx4 v[132:135], v60, s[32:35], s60 offen offset:1024 sc1
  s_mov_b64 exec, s[10:11]
  buffer_load_dwordx4 v[136:139], v60, s[32:35], s60 offen offset:2048 sc1
  s_mov_b64 exec, -1
L_nopre2:
  v_mul_f32 v44, 0x3acccccd, v36
  v_mul_f32 v45, 0x3acccccd, v37
  v_fma_f32 v45, -v44, v44, v45
  v_max_f32 v45, 0, v45
  v_cvt_pk_bf16_f32 v45, v57, v45
  v_cvt_pk_bf16_f32 v44, v57, v44
  v_add_f32 v45, 0x3727c5ac, v45
  v_cvt_pk_bf16_f32 v45, v57, v45
  v_sqrt_f32 v45, v45
  v_mul_f32 v40, v44, v40
  v_cvt_pk_bf16_f32 v45, v57, v45
  v_rcp_f32 v45, v45
  v_mul_f32 v41, v44, v41
  v_cmp_ne_u64 vcc, s[30:31], v[130:131]
  v_cmp_ne_u64 s[20:21], s[30:31], v[134:135]
  v_cmp_ne_u64 s[22:23], s[30:31], v[138:139]
  s_or_b64 vcc, vcc, s[20:21]
  s_or_b64 vcc, vcc, s[22:23]
  s_nop 0
  s_cbranch_vccz L_pok_80
  s_cmp_lg_u32 s46, 1
  s_cbranch_scc1 L_pslow_79
  s_mov_b32 s70, 4000007
L_fp_81:
  buffer_load_dwordx4 v[128:131], v60, s[32:35], s60 offen sc1
  buffer_load_dwordx4 v[132:135], v60, s[32:35], s60 offen offset:1024 sc1
  s_mov_b64 exec, s[10:11]
  buffer_load_dwordx4 v[136:139], v60, s[32:35], s60 offen offset:2048 sc1
  s_mov_b64 exec, -1
  v_cmp_ne_u64 vcc, s[30:31], v[130:131]
  v_cmp_ne_u64 s[20:21], s[30:31], v[134:135]
  v_cmp_ne_u64 s[22:23], s[30:31], v[138:139]
  s_or_b64 vcc, vcc, s[20:21]
  s_or_b64 vcc, vcc, s[22:23]
  s_nop 0
  s_cbranch_vccz L_pok_80
  s_waitcnt vmcnt(12)
  s_sub_u32 s70, s70, 1
  s_cbranch_scc0 L_fp_81
  s_branch L_pok_80
L_pslow_79:
  s_mov_b32 s16, s32
  s_mov_b32 s17, s33
  s_mov_b32 s18, 4194304
  s_mov_b32 s19, 0x20000
  s_mov_b32 s70, 4000007
L_spin_82:
  buffer_load_dwordx4 v[128:131], v60, s[16:19], s60 offen sc1
  buffer_load_dwordx4 v[132:135], v60, s[16:19], s60 offen offset:1024 sc1
  s_mov_b64 exec, s[10:11]
  buffer_load_dwordx4 v[136:139], v60, s[16:19], s60 offen offset:2048 sc1
  s_mov_b64 exec, -1
  s_waitcnt vmcnt(0)
  v_cmp_ne_u64 vcc, s[30:31], v[130:131]
  v_cmp_ne_u64 s[20:21], s[30:31], v[134:135]
  v_cmp_ne_u64 s[22:23], s[30:31], v[138:139]
  s_or_b64 vcc, vcc, s[20:21]
  s_or_b64 vcc, vcc, s[22:23]
  s_nop 0
  s_cbranch_vccz L_sdone_83
  s_and_b32 s99, s70, 7
  s_cmp_eq_u32 s46, 1
  s_cselect_b32 s99, 1, s99
  s_cmp_lg_u32 s99, 0
  s_cselect_b32 s16, s32, s24
  s_cselect_b32 s17, s33, s25
  s_sub_u32 s70, s70, 1
  s_cbranch_scc0 L_spin_82
L_sdone_83:
L_pok_80:
  v_pk_add_f32 v[8:9], v[128:129], v[132:133]
  v_pk_add_f32 v[8:9], v[8:9], v[136:137]
  s_nop 1
  v_add_f32_dpp v10, v8, v8 row_ror:8 row_mask:0xf bank_mask:0xf
  v_add_f32_dpp v11, v9, v9 row_ror:8 row_mask:0xf bank_mask:0xf
  v_add_f32_dpp v8, v8, v8 row_ror:8 row_mask:0xf bank_mask:0xf
  v_add_f32_dpp v9, v9, v9 row_ror:8 row_mask:0xf bank_mask:0xf
  s_nop 0
  v_permlane16_swap_b32 v8, v10
  v_permlane16_swap_b32 v9, v11
  v_add_f32 v8, v8, v10
  v_sub_f32 v8, v8, v40
  v_mul_f32 v8, v8, v45
  v_cvt_pk_bf16_f32 v8, v57, v8
  v_mul_f32 v12, 0xbfb8aa3b, v8
  v_exp_f32 v12, v12
  v_add_f32 v9, v9, v11
  v_add_f32 v12, 1.0, v12
  v_rcp_f32 v12, v12
  v_sub_f32 v9, v9, v41
  v_mul_f32 v9, v9, v45
  v_mul_f32 v8, v8, v12
  v_cvt_pk_bf16_f32 v9, v57, v9
  v_cvt_pk_bf16_f32 v8, v57, v8
  v_mul_f32 v8, v8, v9
  v_cvt_pk_bf16_f32 v8, v8, v8
  ds_write_b16 v62, v8 offset:704
  ds_write_b32 v63, v59 offset:736
  s_endpgm
L_f2:
  s_mov_b32 s8, s52
  s_mov_b32 s9, s53
  s_mov_b32 s10, 1966080
  s_mov_b32 s11, 0x20000
  v_mov_b32 v17, 0
  s_mov_b32 s70, 4000007
L_spin_84:
  ds_read_b32 v16, v17 offset:660
  s_waitcnt lgkmcnt(0)
  v_cmp_gt_u32 vcc, 1, v16
  s_nop 0
  s_cbranch_vccz L_sdone_85
  s_sleep 1
  s_sub_u32 s70, s70, 1
  s_cbranch_scc0 L_spin_84
L_sdone_85:
  v_readfirstlane_b32 s47, v16
  s_mul_i32 s72, s4, 12
  s_add_u32 s72, s72, s5
  v_mov_b32 v57, 0
  s_sub_u32 s68, s3, 7
  s_lshl_b32 s69, s68, 8
  v_lshlrev_b32 v58, 2, v0
  v_add_u32 v58, s69, v58
  v_lshrrev_b32 v2, 4, v0
  v_lshl_add_u32 v2, s68, 2, v2
  v_mul_u32_u24 v3, 52, v2
  v_lshrrev_b32 v3, 8, v3
  v_mul_u32_u24 v4, 5, v3
  v_sub_u32 v4, v2, v4
  v_cmp_lt_u32 vcc, 2, v4
  v_lshlrev_b32 v3, 1, v3
  s_nop 0
  v_addc_co_u32 v3, vcc, 0, v3, vcc
  v_lshrrev_b32 v3, v3, s47
  v_and_b32 v3, 1, v3
  v_lshlrev_b32 v116, 15, v2
  v_lshl_add_u32 v116, v3, 13, v116
  v_bfe_u32 v3, v0, 1, 3
  v_lshl_add_u32 v116, v3, 4, v116
  s_lshr_b32 s79, s72, 6
  s_lshl_b32 s79, s79, 14
  s_and_b32 s68, s72, 63
  s_lshl_b32 s68, s68, 7
  s_add_u32 s79, s79, s68
  s_add_u32 s79, s79, 1048576
  s_mov_b32 s60, 0x05040100
  s_mov_b32 s61, 0x07060302
  s_mul_i32 s62, s72, 20480
  v_lshrrev_b32 v2, 4, v0
  v_mul_u32_u24 v2, 1280, v2
  v_and_b32 v3, 15, v0
  v_lshl_add_u32 v2, v3, 4, v2
  s_add_u32 s62, s62, s69
  s_lshl_b32 s63, s69, 4
  v_lshlrev_b32 v3, 2, v0
  v_add_u32 v3, s63, v3
  s_add_u32 s63, s63, 8704
  s_barrier
  s_add_u32 m0, s63, 0
  s_nop 0
  buffer_load_dwordx4 v2, s[8:11], s62 offen nt lds
  s_add_u32 s62, s62, 5120
  s_add_u32 m0, s63, 1024
  s_nop 0
  buffer_load_dwordx4 v2, s[8:11], s62 offen nt lds
  s_add_u32 s62, s62, 5120
  s_add_u32 m0, s63, 2048
  s_nop 0
  buffer_load_dwordx4 v2, s[8:11], s62 offen nt lds
  s_add_u32 s62, s62, 5120
  s_add_u32 m0, s63, 3072
  s_nop 0
  buffer_load_dwordx4 v2, s[8:11], s62 offen nt lds
  s_add_u32 s62, s62, 5120
  s_barrier
  s_waitcnt vmcnt(0)
  ds_read_b32 v64, v3 offset:8704
  ds_read_b32 v65, v3 offset:8960
  ds_read_b32 v66, v3 offset:9216
  ds_read_b32 v67, v3 offset:9472
  ds_read_b32 v68, v3 offset:9728
  ds_read_b32 v69, v3 offset:9984
  ds_read_b32 v70, v3 offset:10240
  ds_read_b32 v71, v3 offset:10496
  ds_read_b32 v72, v3 offset:10752
  ds_read_b32 v73, v3 offset:11008
  ds_read_b32 v74, v3 offset:11264
  ds_read_b32 v75, v3 offset:11520
  ds_read_b32 v76, v3 offset:11776
  ds_read_b32 v77, v3 offset:12032
  ds_read_b32 v78, v3 offset:12288
  ds_read_b32 v79, v3 offset:12544
  s_waitcnt lgkmcnt(0)
  v_perm_b32 v80, v65, v64, s60
  v_perm_b32 v88, v65, v64, s61
  v_perm_b32 v81, v67, v66, s60
  v_perm_b32 v89, v67, v66, s61
  v_perm_b32 v82, v69, v68, s60
  v_perm_b32 v90, v69, v68, s61
  v_perm_b32 v83, v71, v70, s60
  v_perm_b32 v91, v71, v70, s61
  v_perm_b32 v84, v73, v72, s60
  v_perm_b32 v92, v73, v72, s61
  v_perm_b32 v85, v75, v74, s60
  v_perm_b32 v93, v75, v74, s61
  v_perm_b32 v86, v77, v76, s60
  v_perm_b32 v94, v77, v76, s61
  v_perm_b32 v87, v79, v78, s60
  v_perm_b32 v95, v79, v78, s61
  v_mov_b32 v16, 0
  v_mov_b32 v17, 0
  v_mov_b32 v18, 0
  v_mov_b32 v19, 0
  s_mov_b32 s66, 0x55555555
  s_mov_b32 s67, 0x55555555
  v_mov_b32 v6, s30
  v_mov_b32 v7, s31
  v_and_b32 v9, 15, v0
  v_lshlrev_b32 v9, 2, v9
  v_mov_b32 v8, 0
  s_mov_b32 s64, 0xff00ff00
  s_mov_b32 s65, 0xff00ff00
  s_mov_b32 s70, 32000056
  s_waitcnt lgkmcnt(0)
L_f2poll:
  ds_read_b32 v8, v9 offset:704
  s_waitcnt lgkmcnt(4)
  v_cmp_eq_u32 vcc, 0, v8
  s_sub_u32 s70, s70, 1
  s_cbranch_scc1 L_f2go
  s_and_b64 vcc, vcc, s[64:65]
  s_cbranch_scc1 L_f2poll
L_f2go:
  v_dot2c_f32_bf16_dpp v16, v8, v80 row_newbcast:0 row_mask:0xf bank_mask:0xf
  v_dot2c_f32_bf16_dpp v17, v8, v88 row_newbcast:0 row_mask:0xf bank_mask:0xf
  v_dot2c_f32_bf16_dpp v18, v8, v81 row_newbcast:1 row_mask:0xf bank_mask:0xf
  v_dot2c_f32_bf16_dpp v19, v8, v89 row_newbcast:1 row_mask:0xf bank_mask:0xf
  v_dot2c_f32_bf16_dpp v16, v8, v82 row_newbcast:2 row_mask:0xf bank_mask:0xf
  v_dot2c_f32_bf16_dpp v17, v8, v90 row_newbcast:2 row_mask:0xf bank_mask:0xf
  v_dot2c_f32_bf16_dpp v18, v8, v83 row_newbcast:3 row_mask:0xf bank_mask:0xf
  v_dot2c_f32_bf16_dpp v19, v8, v91 row_newbcast:3 row_mask:0xf bank_mask:0xf
  v_dot2c_f32_bf16_dpp v16, v8, v84 row_newbcast:4 row_mask:0xf bank_mask:0xf
  v_dot2c_f32_bf16_dpp v17, v8, v92 row_newbcast:4 row_mask:0xf bank_mask:0xf
  v_dot2c_f32_bf16_dpp v18, v8, v85 row_newbcast:5 row_mask:0xf bank_mask:0xf
  v_dot2c_f32_bf16_dpp v19, v8, v93 row_newbcast:5 row_mask:0xf bank_mask:0xf
  v_dot2c_f32_bf16_dpp v16, v8, v86 row_newbcast:6 row_mask:0xf bank_mask:0xf
  v_dot2c_f32_bf16_dpp v17, v8, v94 row_newbcast:6 row_mask:0xf bank_mask:0xf
  v_dot2c_f32_bf16_dpp v18, v8, v87 row_newbcast:7 row_mask:0xf bank_mask:0xf
  v_dot2c_f32_bf16_dpp v19, v8, v95 row_newbcast:7 row_mask:0xf bank_mask:0xf
  s_nop 2
  v_pk_add_f32 v[16:17], v[16:17], v[18:19]
  v_cvt_pk_bf16_f32 v4, v16, v17
  s_nop 1
  v_mov_b32_dpp v5, v4 quad_perm:[1,0,3,2] row_mask:0xf bank_mask:0xf
  s_mov_b64 exec, s[66:67]
  buffer_store_dwordx4 v[4:7], v116, s[24:27], s79 offen sc1
L_end:
  s_endpgm
L_slow_25:
  s_mov_b32 exec_lo, 0xffffffff
  s_mov_b32 exec_hi, 0xffff
  buffer_store_dwordx4 v[4:7], v13, s[24:27], s74 offen sc1
  s_mov_b64 exec, -1
  s_nop 1
  s_branch L_back_26
L_slow_39:
  s_mov_b32 exec_lo, 0x1
  s_mov_b32 exec_hi, 0x0
  buffer_store_dwordx4 v[2:5], v1, s[24:27], s68 offen sc1
  s_mov_b64 exec, -1
  s_nop 1
  s_branch L_back_40
L_slow_59:
  s_mov_b32 exec_lo, 0x1
  s_mov_b32 exec_hi, 0x0
  buffer_store_dwordx4 v[4:7], v55, s[24:27], s72 offen sc1
  s_mov_b32 exec_lo, 0x110011
  s_mov_b32 exec_hi, 0x110011
  buffer_store_dwordx4 v[12:15], v54, s[24:27], s75 offen sc1
  s_mov_b64 exec, -1
  s_nop 1
  s_branch L_back_60
L_slow_61:
  s_mov_b32 exec_lo, 0xffffffff
  s_mov_b32 exec_hi, 0x0
  buffer_store_dwordx4 v[32:35], v59, s[24:27], s77 offen sc1
  s_mov_b64 exec, -1
  s_nop 1
  s_branch L_back_62
L_slow_63:
  s_mov_b32 exec_lo, 0xffffffff
  s_mov_b32 exec_hi, 0x0
  buffer_store_dwordx4 v[4:7], v59, s[24:27], s76 offen sc1
  s_mov_b64 exec, -1
  s_nop 1
  s_branch L_back_64
L_codeend:
.section .rodata,"a"
.p2align 6
.amdhsa_kernel sequential_preLN__sliding_block_cached__glu_gated_swiglu__decode_kernel
  .amdhsa_next_free_vgpr 168
  .amdhsa_next_free_sgpr 100
  .amdhsa_accum_offset 168
  .amdhsa_group_segment_fixed_size 0
  .amdhsa_kernarg_size 96
  .amdhsa_user_sgpr_count 2
  .amdhsa_user_sgpr_kernarg_segment_ptr 1
  .amdhsa_system_sgpr_workgroup_id_x 1
.end_amdhsa_kernel
```

```asm
; @launch grid=(256,1,1) block=(768,1,1) lds=57856
.amdgcn_target "amdgcn-amd-amdhsa--gfx950"
.text
.globl sequential_preLN__sliding_block_cached__glu_gated_swiglu__decode_kernel
.p2align 8
.type sequential_preLN__sliding_block_cached__glu_gated_swiglu__decode_kernel,@function
sequential_preLN__sliding_block_cached__glu_gated_swiglu__decode_kernel:
  s_load_dwordx2 s[8:9], s[0:1], 8
  v_readfirstlane_b32 s3, v0
  s_lshr_b32 s79, s2, 6
  s_cmp_gt_u32 s79, 3
  s_cbranch_scc1 L_end
  s_lshr_b32 s3, s3, 6
  s_cmp_gt_u32 s3, 3
  s_cbranch_scc1 L_str
  s_getpc_b64 s[20:21]
L_pc0:
  v_lshlrev_b32 v8, 7, v0
  v_min_u32 v8, L_codeend-L_pc0-4, v8
  global_load_dword v166, v8, s[20:21]
  s_branch L_helper0
L_str:
  s_and_b32 s4, s2, 7
  s_lshl2_add_u32 s6, s4, s79
  s_bfe_u32 s7, s2, 0x30003
  s_lshl_b32 s60, s6, 10
  s_lshl1_add_u32 s60, s7, s60
  s_addk_i32 s60, 895
  s_mulk_i32 s60, 12288
  v_lshlrev_b32 v3, 4, v0
  v_lshrrev_b32 v2, 3, v0
  v_lshl_add_u32 v1, v2, 8, v3
  s_lshl_b32 s10, 3, 27
  s_mov_b32 s11, 0x20000
  s_waitcnt lgkmcnt(0)
  buffer_load_dwordx4 v[16:19], v1, s[8:11], s60 offen offset:0 nt
  buffer_load_dwordx4 v[20:23], v1, s[8:11], s60 offen offset:128 nt
  buffer_load_dwordx4 v[24:27], v1, s[8:11], s60 offen offset:256 nt
  s_branch L_stream0
L_helper0:
  s_load_dwordx16 s[36:51], s[0:1], 0
  s_load_dwordx8 s[52:59], s[0:1], 64
  s_and_b32 s4, s2, 7
  s_lshl2_add_u32 s6, s4, s79
  s_bfe_u32 s7, s2, 0x30003
  v_and_b32 v0, 63, v0
  s_cmp_lg_u32 s3, 3
  s_cbranch_scc0 L_w3
  v_lshrrev_b32 v2, 3, v0
  v_mul_u32_u24 v2, 12160, v2
  v_lshl_add_u32 v2, v0, 4, v2
  s_mul_i32 s68, s7, 7680
  s_mul_i32 s69, s6, 3
  s_add_u32 s68, s68, s69
  s_add_u32 s68, s68, s3
  s_lshl_b32 s68, s68, 7
  s_lshl_b32 s69, 3, 15
  s_mov_b32 s10, 7864320
  s_mov_b32 s11, 0x20000
  s_waitcnt lgkmcnt(0)
  s_mov_b64 s[8:9], s[42:43]
  buffer_load_dwordx4 v[24:27], v2, s[8:11], s68 offen nt
  s_add_u32 s68, s68, s69
  buffer_load_dwordx4 v[28:31], v2, s[8:11], s68 offen nt
  s_add_u32 s68, s68, s69
  buffer_load_dwordx4 v[32:35], v2, s[8:11], s68 offen nt
  s_add_u32 s68, s68, s69
  buffer_load_dwordx4 v[36:39], v2, s[8:11], s68 offen nt
  s_add_u32 s68, s68, s69
  buffer_load_dwordx4 v[40:43], v2, s[8:11], s68 offen nt
  s_add_u32 s68, s68, s69
  buffer_load_dwordx4 v[44:47], v2, s[8:11], s68 offen nt
  s_add_u32 s68, s68, s69
  buffer_load_dwordx4 v[48:51], v2, s[8:11], s68 offen nt
  s_add_u32 s68, s68, s69
  buffer_load_dwordx4 v[52:55], v2, s[8:11], s68 offen nt
  s_add_u32 s68, s68, s69
  buffer_load_dwordx4 v[56:59], v2, s[8:11], s68 offen nt
  s_add_u32 s68, s68, s69
  buffer_load_dwordx4 v[60:63], v2, s[8:11], s68 offen nt
  s_branch L_helper
L_w3:
  v_lshlrev_b32 v1, 3, v0
  v_mov_b32 v4, 0
  v_mov_b32 v5, 0
  ds_write_b64 v1, v[4:5] offset:384
  s_waitcnt lgkmcnt(0)
  s_memrealtime s[62:63]
  s_barrier
  s_load_dwordx2 s[28:29], s[58:59], 917504
  s_branch L_ids
L_stream0:
  s_load_dwordx16 s[36:51], s[0:1], 0
  s_load_dwordx8 s[52:59], s[0:1], 64
  v_and_b32 v0, 63, v0
  s_sub_u32 s73, s3, 4
  v_and_b32 v3, 0x70, v3
  s_add_u32 s61, s60, 196608
  s_waitcnt lgkmcnt(0)
  s_barrier
  s_waitcnt vmcnt(2)
  buffer_load_dwordx4 v[28:31], v1, s[8:11], s61 offen offset:0 nt
  s_load_dwordx2 s[28:29], s[58:59], 917504
  s_mov_b32 s24, s58
  s_mov_b32 s25, s59
  s_mov_b32 s26, 4194304
  s_mov_b32 s27, 0x20000
  s_add_u32 s32, s58, 4194304
  s_addc_u32 s33, s59, 0
  s_mov_b32 s34, 4194304
  s_mov_b32 s35, 0x20000
  s_lshl3_add_u32 s71, s6, s7
  s_mul_i32 s5, s79, 5
  s_mul_i32 s47, s79, 3
  s_add_u32 s47, s47, 15
  s_cmp_lt_u32 s7, 5
  s_cselect_b32 s5, s5, s47
  s_add_u32 s5, s5, s7
  s_mov_b32 s12, s40
  s_mov_b32 s13, s41
  s_mov_b32 s14, 402653184
  s_mov_b32 s15, 0x20000
  s_waitcnt vmcnt(2)
  buffer_load_dwordx4 v[32:35], v1, s[8:11], s61 offen offset:128 nt
  s_waitcnt vmcnt(2)
  buffer_load_dwordx4 v[36:39], v1, s[8:11], s61 offen offset:256 nt
  s_add_u32 s62, s61, 196608
  s_waitcnt vmcnt(2)
  buffer_load_dwordx4 v[40:43], v1, s[8:11], s62 offen offset:0 nt
  s_waitcnt vmcnt(2)
  buffer_load_dwordx4 v[44:47], v1, s[8:11], s62 offen offset:128 nt
  s_waitcnt vmcnt(2)
  buffer_load_dwordx4 v[48:51], v1, s[8:11], s62 offen offset:256 nt
  s_add_u32 s63, s62, 196608
  s_waitcnt vmcnt(2)
  buffer_load_dwordx4 v[52:55], v1, s[8:11], s63 offen offset:0 nt
  s_waitcnt vmcnt(2)
  buffer_load_dwordx4 v[56:59], v1, s[8:11], s63 offen offset:128 nt
  s_waitcnt vmcnt(2)
  buffer_load_dwordx4 v[60:63], v1, s[8:11], s63 offen offset:256 nt
  s_add_u32 s64, s63, 196608
  s_waitcnt vmcnt(2)
  buffer_load_dwordx4 v[64:67], v1, s[8:11], s64 offen offset:0 nt
  s_waitcnt vmcnt(2)
  buffer_load_dwordx4 v[68:71], v1, s[8:11], s64 offen offset:128 nt
  s_waitcnt vmcnt(2)
  buffer_load_dwordx4 v[72:75], v1, s[8:11], s64 offen offset:256 nt
  s_add_u32 s65, s64, 196608
  s_waitcnt vmcnt(2)
  buffer_load_dwordx4 v[76:79], v1, s[8:11], s65 offen offset:0 nt
  s_waitcnt vmcnt(2)
  buffer_load_dwordx4 v[80:83], v1, s[8:11], s65 offen offset:128 nt
  s_waitcnt vmcnt(2)
  buffer_load_dwordx4 v[84:87], v1, s[8:11], s65 offen offset:256 nt
  s_memrealtime s[76:77]
  s_waitcnt lgkmcnt(0)
  v_mov_b32 v6, 0
  v_mov_b32 v8, s76
  v_mov_b32 v9, 1
  s_mov_b64 exec, 1
  ds_add_u32 v6, v8 offset:696
  ds_add_u32 v6, v9 offset:700
  s_mov_b64 exec, -1
  s_add_u32 s66, s65, 196608
  s_waitcnt vmcnt(2)
  buffer_load_dwordx4 v[88:91], v1, s[8:11], s66 offen offset:0 nt
  s_waitcnt vmcnt(2)
  buffer_load_dwordx4 v[92:95], v1, s[8:11], s66 offen offset:128 nt
  s_waitcnt vmcnt(2)
  buffer_load_dwordx4 v[96:99], v1, s[8:11], s66 offen offset:256 nt
  s_add_u32 s67, s66, 196608
  s_waitcnt vmcnt(2)
  buffer_load_dwordx4 v[100:103], v1, s[8:11], s67 offen offset:0 nt
  s_waitcnt vmcnt(2)
  buffer_load_dwordx4 v[104:107], v1, s[8:11], s67 offen offset:128 nt
  s_waitcnt vmcnt(2)
  buffer_load_dwordx4 v[108:111], v1, s[8:11], s67 offen offset:256 nt
  s_waitcnt vmcnt(2)
  buffer_load_dwordx4 v[112:115], v1, s[12:15], s60 offen offset:0 nt
  s_waitcnt vmcnt(2)
  buffer_load_dwordx4 v[116:119], v1, s[12:15], s60 offen offset:128 nt
  s_waitcnt vmcnt(2)
  buffer_load_dwordx4 v[120:123], v1, s[12:15], s60 offen offset:256 nt
  v_mov_b32 v6, 0
  v_mov_b32 v7, 1
  s_mov_b64 exec, 1
  ds_add_u32 v6, v7 offset:692
  s_mov_b64 exec, -1
  s_waitcnt lgkmcnt(0)
  s_mul_i32 s30, s28, 0x2c9277b5
  s_add_u32 s30, s30, 0xac564b05
  s_mul_i32 s31, s29, 0x0019660d
  s_add_u32 s31, s31, 0x3c6ef35f
  v_and_b32 v2, 3, v0
  v_min_u32 v2, 2, v2
  v_lshlrev_b32 v2, 3, v2
  s_mov_b32 s70, 4000007
L_spin_1:
  ds_read_b32 v4, v2 offset:384
  s_waitcnt lgkmcnt(0)
  v_cmp_eq_u32 vcc, 0, v4
  s_nop 0
  s_cbranch_vccz L_sdone_2
  s_sleep 1
  s_sub_u32 s70, s70, 1
  s_cbranch_scc0 L_spin_1
L_sdone_2:
  ds_read_b128 v[4:7], v3 offset:0
  ds_read_b128 v[8:11], v3 offset:128
  ds_read_b128 v[12:15], v3 offset:256
  v_mov_b32 v160, 0
  v_mov_b32 v161, 0
  v_mov_b32 v162, 0
  v_mov_b32 v163, 0
  v_mov_b32 v164, 0
  v_mov_b32 v165, 0
  v_mov_b32 v166, 0
  v_mov_b32 v167, 0
  s_waitcnt vmcnt(3) lgkmcnt(0)
  v_dot2c_f32_bf16 v160, v16, v4
  v_dot2c_f32_bf16 v161, v28, v4
  v_dot2c_f32_bf16 v162, v40, v4
  v_dot2c_f32_bf16 v163, v52, v4
  v_dot2c_f32_bf16 v160, v17, v5
  v_dot2c_f32_bf16 v161, v29, v5
  v_dot2c_f32_bf16 v162, v41, v5
  v_dot2c_f32_bf16 v163, v53, v5
  v_dot2c_f32_bf16 v160, v18, v6
  v_dot2c_f32_bf16 v161, v30, v6
  v_dot2c_f32_bf16 v162, v42, v6
  v_dot2c_f32_bf16 v163, v54, v6
  v_dot2c_f32_bf16 v160, v19, v7
  v_dot2c_f32_bf16 v161, v31, v7
  v_dot2c_f32_bf16 v162, v43, v7
  v_dot2c_f32_bf16 v163, v55, v7
  v_dot2c_f32_bf16 v160, v20, v8
  v_dot2c_f32_bf16 v161, v32, v8
  v_dot2c_f32_bf16 v162, v44, v8
  v_dot2c_f32_bf16 v163, v56, v8
  v_dot2c_f32_bf16 v160, v21, v9
  v_dot2c_f32_bf16 v161, v33, v9
  v_dot2c_f32_bf16 v162, v45, v9
  v_dot2c_f32_bf16 v163, v57, v9
  v_dot2c_f32_bf16 v160, v22, v10
  v_dot2c_f32_bf16 v161, v34, v10
  v_dot2c_f32_bf16 v162, v46, v10
  v_dot2c_f32_bf16 v163, v58, v10
  v_dot2c_f32_bf16 v160, v23, v11
  v_dot2c_f32_bf16 v161, v35, v11
  v_dot2c_f32_bf16 v162, v47, v11
  v_dot2c_f32_bf16 v163, v59, v11
  v_dot2c_f32_bf16 v160, v24, v12
  v_dot2c_f32_bf16 v161, v36, v12
  v_dot2c_f32_bf16 v162, v48, v12
  v_dot2c_f32_bf16 v163, v60, v12
  v_dot2c_f32_bf16 v160, v25, v13
  v_dot2c_f32_bf16 v161, v37, v13
  v_dot2c_f32_bf16 v162, v49, v13
  v_dot2c_f32_bf16 v163, v61, v13
  v_dot2c_f32_bf16 v160, v26, v14
  v_dot2c_f32_bf16 v161, v38, v14
  v_dot2c_f32_bf16 v162, v50, v14
  v_dot2c_f32_bf16 v163, v62, v14
  v_dot2c_f32_bf16 v160, v27, v15
  v_dot2c_f32_bf16 v161, v39, v15
  v_dot2c_f32_bf16 v162, v51, v15
  v_dot2c_f32_bf16 v163, v63, v15
  v_dot2c_f32_bf16 v164, v64, v4
  v_dot2c_f32_bf16 v165, v76, v4
  v_dot2c_f32_bf16 v166, v88, v4
  v_dot2c_f32_bf16 v167, v100, v4
  v_dot2c_f32_bf16 v164, v65, v5
  v_dot2c_f32_bf16 v165, v77, v5
  v_dot2c_f32_bf16 v166, v89, v5
  v_dot2c_f32_bf16 v167, v101, v5
  v_dot2c_f32_bf16 v164, v66, v6
  v_dot2c_f32_bf16 v165, v78, v6
  v_dot2c_f32_bf16 v166, v90, v6
  v_dot2c_f32_bf16 v167, v102, v6
  v_dot2c_f32_bf16 v164, v67, v7
  v_dot2c_f32_bf16 v165, v79, v7
  v_dot2c_f32_bf16 v166, v91, v7
  v_dot2c_f32_bf16 v167, v103, v7
  v_dot2c_f32_bf16 v164, v68, v8
  v_dot2c_f32_bf16 v165, v80, v8
  v_dot2c_f32_bf16 v166, v92, v8
  v_dot2c_f32_bf16 v167, v104, v8
  v_dot2c_f32_bf16 v164, v69, v9
  v_dot2c_f32_bf16 v165, v81, v9
  v_dot2c_f32_bf16 v166, v93, v9
  v_dot2c_f32_bf16 v167, v105, v9
  v_dot2c_f32_bf16 v164, v70, v10
  v_dot2c_f32_bf16 v165, v82, v10
  v_dot2c_f32_bf16 v166, v94, v10
  v_dot2c_f32_bf16 v167, v106, v10
  v_dot2c_f32_bf16 v164, v71, v11
  v_dot2c_f32_bf16 v165, v83, v11
  v_dot2c_f32_bf16 v166, v95, v11
  v_dot2c_f32_bf16 v167, v107, v11
  v_dot2c_f32_bf16 v164, v72, v12
  v_dot2c_f32_bf16 v165, v84, v12
  v_dot2c_f32_bf16 v166, v96, v12
  v_dot2c_f32_bf16 v167, v108, v12
  v_dot2c_f32_bf16 v164, v73, v13
  v_dot2c_f32_bf16 v165, v85, v13
  v_dot2c_f32_bf16 v166, v97, v13
  v_dot2c_f32_bf16 v167, v109, v13
  v_dot2c_f32_bf16 v164, v74, v14
  v_dot2c_f32_bf16 v165, v86, v14
  v_dot2c_f32_bf16 v166, v98, v14
  v_dot2c_f32_bf16 v167, v110, v14
  v_dot2c_f32_bf16 v164, v75, v15
  v_dot2c_f32_bf16 v165, v87, v15
  v_dot2c_f32_bf16 v166, v99, v15
  v_dot2c_f32_bf16 v167, v111, v15
  v_add_f32_dpp v160, v160, v160 quad_perm:[1,0,3,2] row_mask:0xf bank_mask:0xf
  v_add_f32_dpp v161, v161, v161 quad_perm:[1,0,3,2] row_mask:0xf bank_mask:0xf
  v_add_f32_dpp v162, v162, v162 quad_perm:[1,0,3,2] row_mask:0xf bank_mask:0xf
  v_add_f32_dpp v163, v163, v163 quad_perm:[1,0,3,2] row_mask:0xf bank_mask:0xf
  v_add_f32_dpp v164, v164, v164 quad_perm:[1,0,3,2] row_mask:0xf bank_mask:0xf
  v_add_f32_dpp v165, v165, v165 quad_perm:[1,0,3,2] row_mask:0xf bank_mask:0xf
  v_add_f32_dpp v166, v166, v166 quad_perm:[1,0,3,2] row_mask:0xf bank_mask:0xf
  v_add_f32_dpp v167, v167, v167 quad_perm:[1,0,3,2] row_mask:0xf bank_mask:0xf
  v_add_f32_dpp v160, v160, v160 quad_perm:[2,3,0,1] row_mask:0xf bank_mask:0xf
  v_add_f32_dpp v161, v161, v161 quad_perm:[2,3,0,1] row_mask:0xf bank_mask:0xf
  v_add_f32_dpp v162, v162, v162 quad_perm:[2,3,0,1] row_mask:0xf bank_mask:0xf
  v_add_f32_dpp v163, v163, v163 quad_perm:[2,3,0,1] row_mask:0xf bank_mask:0xf
  v_add_f32_dpp v164, v164, v164 quad_perm:[2,3,0,1] row_mask:0xf bank_mask:0xf
  v_add_f32_dpp v165, v165, v165 quad_perm:[2,3,0,1] row_mask:0xf bank_mask:0xf
  v_add_f32_dpp v166, v166, v166 quad_perm:[2,3,0,1] row_mask:0xf bank_mask:0xf
  v_add_f32_dpp v167, v167, v167 quad_perm:[2,3,0,1] row_mask:0xf bank_mask:0xf
  v_add_f32_dpp v160, v160, v160 row_half_mirror row_mask:0xf bank_mask:0xf
  v_add_f32_dpp v161, v161, v161 row_half_mirror row_mask:0xf bank_mask:0xf
  v_add_f32_dpp v162, v162, v162 row_half_mirror row_mask:0xf bank_mask:0xf
  v_add_f32_dpp v163, v163, v163 row_half_mirror row_mask:0xf bank_mask:0xf
  v_add_f32_dpp v164, v164, v164 row_half_mirror row_mask:0xf bank_mask:0xf
  v_add_f32_dpp v165, v165, v165 row_half_mirror row_mask:0xf bank_mask:0xf
  v_add_f32_dpp v166, v166, v166 row_half_mirror row_mask:0xf bank_mask:0xf
  v_add_f32_dpp v167, v167, v167 row_half_mirror row_mask:0xf bank_mask:0xf
  s_mov_b32 s68, 0x3d93cd3a
  v_mov_b32 v2, 0
  v_cvt_pk_bf16_f32 v160, v2, v160
  v_cvt_pk_bf16_f32 v161, v2, v161
  v_cvt_pk_bf16_f32 v162, v2, v162
  v_cvt_pk_bf16_f32 v163, v2, v163
  v_cvt_pk_bf16_f32 v164, v2, v164
  v_cvt_pk_bf16_f32 v165, v2, v165
  v_cvt_pk_bf16_f32 v166, v2, v166
  v_cvt_pk_bf16_f32 v167, v2, v167
  v_mul_f32 v160, s68, v160
  v_mul_f32 v161, s68, v161
  v_mul_f32 v162, s68, v162
  v_mul_f32 v163, s68, v163
  v_mul_f32 v164, s68, v164
  v_mul_f32 v165, s68, v165
  v_mul_f32 v166, s68, v166
  v_mul_f32 v167, s68, v167
  v_cvt_pk_bf16_f32 v160, v2, v160
  v_cvt_pk_bf16_f32 v161, v2, v161
  v_cvt_pk_bf16_f32 v162, v2, v162
  v_cvt_pk_bf16_f32 v163, v2, v163
  v_cvt_pk_bf16_f32 v164, v2, v164
  v_cvt_pk_bf16_f32 v165, v2, v165
  v_cvt_pk_bf16_f32 v166, v2, v166
  v_cvt_pk_bf16_f32 v167, v2, v167
  v_max_f32 v4, v160, v161
  v_max3_f32 v4, v4, v162, v163
  v_max3_f32 v4, v4, v164, v165
  v_max3_f32 v4, v4, v166, v167
  s_nop 1
  v_max_f32_dpp v4, v4, v4 row_ror:8 row_mask:0xf bank_mask:0xf
  v_mov_b32 v88, v4
  s_nop 1
  v_permlane16_swap_b32 v4, v88
  v_max_f32 v4, v4, v88
  v_mov_b32 v88, v4
  s_nop 1
  v_permlane32_swap_b32 v4, v88
  v_max_f32 v4, v4, v88
  s_mov_b32 s68, 0x3fb8aa3b
  v_sub_f32 v160, v160, v4
  v_sub_f32 v161, v161, v4
  v_sub_f32 v162, v162, v4
  v_sub_f32 v163, v163, v4
  v_sub_f32 v164, v164, v4
  v_sub_f32 v165, v165, v4
  v_sub_f32 v166, v166, v4
  v_sub_f32 v167, v167, v4
  v_mul_f32 v160, s68, v160
  v_mul_f32 v161, s68, v161
  v_mul_f32 v162, s68, v162
  v_mul_f32 v163, s68, v163
  v_mul_f32 v164, s68, v164
  v_mul_f32 v165, s68, v165
  v_mul_f32 v166, s68, v166
  v_mul_f32 v167, s68, v167
  v_exp_f32 v160, v160
  v_exp_f32 v161, v161
  v_exp_f32 v162, v162
  v_exp_f32 v163, v163
  v_exp_f32 v164, v164
  v_exp_f32 v165, v165
  v_exp_f32 v166, v166
  v_exp_f32 v167, v167
  v_add_f32 v5, v160, v161
  v_add_f32 v5, v5, v162
  v_add_f32 v5, v5, v163
  v_add_f32 v5, v5, v164
  v_add_f32 v5, v5, v165
  v_add_f32 v5, v5, v166
  v_add_f32 v5, v5, v167
  s_nop 1
  v_add_f32_dpp v5, v5, v5 row_ror:8 row_mask:0xf bank_mask:0xf
  v_mov_b32 v88, v5
  s_nop 1
  v_permlane16_swap_b32 v5, v88
  v_add_f32 v5, v5, v88
  v_mov_b32 v88, v5
  s_nop 1
  v_permlane32_swap_b32 v5, v88
  v_add_f32 v5, v5, v88
  s_lshl_b32 s69, s73, 4
  v_mov_b32 v88, s69
  v_mov_b32 v6, 1
  v_mov_b32 v7, 1
  ds_write_b128 v88, v[4:7] offset:512
  v_cvt_pk_bf16_f32 v160, v160, v2
  v_cvt_pk_bf16_f32 v161, v161, v2
  v_cvt_pk_bf16_f32 v162, v162, v2
  v_cvt_pk_bf16_f32 v163, v163, v2
  v_cvt_pk_bf16_f32 v164, v164, v2
  v_cvt_pk_bf16_f32 v165, v165, v2
  v_cvt_pk_bf16_f32 v166, v166, v2
  v_cvt_pk_bf16_f32 v167, v167, v2
  v_mov_b32 v88, 0
  v_mov_b32 v89, 0
  v_mov_b32 v90, 0
  v_mov_b32 v91, 0
  v_mov_b32 v92, 0
  v_mov_b32 v93, 0
  v_mov_b32 v94, 0
  v_mov_b32 v95, 0
  v_mov_b32 v96, 0
  v_mov_b32 v97, 0
  v_mov_b32 v98, 0
  v_mov_b32 v99, 0
  v_mov_b32 v100, 0
  v_mov_b32 v101, 0
  v_mov_b32 v102, 0
  v_mov_b32 v103, 0
  v_mov_b32 v104, 0
  v_mov_b32 v105, 0
  v_mov_b32 v106, 0
  v_mov_b32 v107, 0
  v_mov_b32 v108, 0
  v_mov_b32 v109, 0
  v_mov_b32 v110, 0
  v_mov_b32 v111, 0
  v_and_b32 v8, 7, v0
  v_lshlrev_b32 v8, 5, v8
  v_lshrrev_b32 v9, 4, v0
  v_lshl_add_u32 v8, v9, 3, v8
  s_mul_i32 s69, s73, 768
  v_add_u32 v8, s69, v8
  v_mov_b32 v11, 1
  s_waitcnt vmcnt(2)
  buffer_load_dwordx4 v[124:127], v1, s[12:15], s61 offen offset:0 nt
  s_waitcnt vmcnt(2)
  buffer_load_dwordx4 v[128:131], v1, s[12:15], s61 offen offset:128 nt
  v_lshlrev_b32 v10, 16, v160
  v_dot2c_f32_bf16 v88, v112, v160
  v_dot2c_f32_bf16 v89, v112, v10
  v_dot2c_f32_bf16 v90, v113, v160
  v_dot2c_f32_bf16 v91, v113, v10
  v_dot2c_f32_bf16 v92, v114, v160
  v_dot2c_f32_bf16 v93, v114, v10
  v_dot2c_f32_bf16 v94, v115, v160
  v_dot2c_f32_bf16 v95, v115, v10
  s_waitcnt vmcnt(2)
  buffer_load_dwordx4 v[132:135], v1, s[12:15], s61 offen offset:256 nt
  s_memrealtime s[76:77]
  v_mov_b32 v6, 0
  ds_read_b64 v[6:7], v6 offset:680
  s_movk_i32 s79, 463
  s_waitcnt lgkmcnt(0)
  v_readfirstlane_b32 s78, v6
  v_readfirstlane_b32 s72, v7
  s_add_u32 s78, s78, 5556
  v_dot2c_f32_bf16 v96, v116, v160
  v_dot2c_f32_bf16 v97, v116, v10
  v_dot2c_f32_bf16 v98, v117, v160
  v_dot2c_f32_bf16 v99, v117, v10
  v_dot2c_f32_bf16 v100, v118, v160
  v_dot2c_f32_bf16 v101, v118, v10
  v_dot2c_f32_bf16 v102, v119, v160
  v_dot2c_f32_bf16 v103, v119, v10
  s_waitcnt lgkmcnt(0)
  s_lshl_b32 s75, s76, 4
  s_sub_u32 s75, s75, s78
  s_and_b32 s75, s75, s72
  s_add_u32 s78, s78, s79
  s_waitcnt vmcnt(3)
  s_cmp_gt_i32 s75, 480
  s_cbranch_scc1 L_go_3
  s_waitcnt vmcnt(2)
  s_cmp_ge_i32 s75, 0
  s_cbranch_scc1 L_go_3
  s_waitcnt vmcnt(1)
L_go_3:
  buffer_load_dwordx4 v[136:139], v1, s[12:15], s62 offen offset:0 nt
  s_memrealtime s[76:77]
  v_dot2c_f32_bf16 v104, v120, v160
  v_dot2c_f32_bf16 v105, v120, v10
  v_dot2c_f32_bf16 v106, v121, v160
  v_dot2c_f32_bf16 v107, v121, v10
  v_dot2c_f32_bf16 v108, v122, v160
  v_dot2c_f32_bf16 v109, v122, v10
  v_dot2c_f32_bf16 v110, v123, v160
  v_dot2c_f32_bf16 v111, v123, v10
  s_waitcnt lgkmcnt(0)
  s_lshl_b32 s75, s76, 4
  s_sub_u32 s75, s75, s78
  s_and_b32 s75, s75, s72
  s_add_u32 s78, s78, s79
  s_waitcnt vmcnt(3)
  s_cmp_gt_i32 s75, 480
  s_cbranch_scc1 L_go_4
  s_waitcnt vmcnt(2)
  s_cmp_ge_i32 s75, 0
  s_cbranch_scc1 L_go_4
  s_waitcnt vmcnt(1)
L_go_4:
  buffer_load_dwordx4 v[140:143], v1, s[12:15], s62 offen offset:128 nt
  s_memrealtime s[76:77]
  v_lshlrev_b32 v10, 16, v161
  v_dot2c_f32_bf16 v88, v124, v161
  v_dot2c_f32_bf16 v89, v124, v10
  v_dot2c_f32_bf16 v90, v125, v161
  v_dot2c_f32_bf16 v91, v125, v10
  v_dot2c_f32_bf16 v92, v126, v161
  v_dot2c_f32_bf16 v93, v126, v10
  v_dot2c_f32_bf16 v94, v127, v161
  v_dot2c_f32_bf16 v95, v127, v10
  s_waitcnt lgkmcnt(0)
  s_lshl_b32 s75, s76, 4
  s_sub_u32 s75, s75, s78
  s_and_b32 s75, s75, s72
  s_add_u32 s78, s78, s79
  s_waitcnt vmcnt(3)
  s_cmp_gt_i32 s75, 480
  s_cbranch_scc1 L_go_5
  s_waitcnt vmcnt(2)
  s_cmp_ge_i32 s75, 0
  s_cbranch_scc1 L_go_5
  s_waitcnt vmcnt(1)
L_go_5:
  buffer_load_dwordx4 v[144:147], v1, s[12:15], s62 offen offset:256 nt
  s_memrealtime s[76:77]
  v_dot2c_f32_bf16 v96, v128, v161
  v_dot2c_f32_bf16 v97, v128, v10
  v_dot2c_f32_bf16 v98, v129, v161
  v_dot2c_f32_bf16 v99, v129, v10
  v_dot2c_f32_bf16 v100, v130, v161
  v_dot2c_f32_bf16 v101, v130, v10
  v_dot2c_f32_bf16 v102, v131, v161
  v_dot2c_f32_bf16 v103, v131, v10
  s_waitcnt lgkmcnt(0)
  s_lshl_b32 s75, s76, 4
  s_sub_u32 s75, s75, s78
  s_and_b32 s75, s75, s72
  s_add_u32 s78, s78, s79
  s_waitcnt vmcnt(3)
  s_cmp_gt_i32 s75, 480
  s_cbranch_scc1 L_go_6
  s_waitcnt vmcnt(2)
  s_cmp_ge_i32 s75, 0
  s_cbranch_scc1 L_go_6
  s_waitcnt vmcnt(1)
L_go_6:
  buffer_load_dwordx4 v[148:151], v1, s[12:15], s63 offen offset:0 nt
  s_memrealtime s[76:77]
  v_mov_b32 v6, 0
  ds_read_b64 v[6:7], v6 offset:680
  s_movk_i32 s79, 463
  s_waitcnt lgkmcnt(0)
  v_readfirstlane_b32 s78, v6
  v_readfirstlane_b32 s72, v7
  s_add_u32 s78, s78, 7408
  v_dot2c_f32_bf16 v104, v132, v161
  v_dot2c_f32_bf16 v105, v132, v10
  v_dot2c_f32_bf16 v106, v133, v161
  v_dot2c_f32_bf16 v107, v133, v10
  v_dot2c_f32_bf16 v108, v134, v161
  v_dot2c_f32_bf16 v109, v134, v10
  v_dot2c_f32_bf16 v110, v135, v161
  v_dot2c_f32_bf16 v111, v135, v10
  s_waitcnt lgkmcnt(0)
  s_lshl_b32 s75, s76, 4
  s_sub_u32 s75, s75, s78
  s_and_b32 s75, s75, s72
  s_add_u32 s78, s78, s79
  s_waitcnt vmcnt(3)
  s_cmp_gt_i32 s75, 480
  s_cbranch_scc1 L_go_7
  s_waitcnt vmcnt(2)
  s_cmp_ge_i32 s75, 0
  s_cbranch_scc1 L_go_7
  s_waitcnt vmcnt(1)
L_go_7:
  buffer_load_dwordx4 v[152:155], v1, s[12:15], s63 offen offset:128 nt
  s_memrealtime s[76:77]
  v_lshlrev_b32 v10, 16, v162
  v_dot2c_f32_bf16 v88, v136, v162
  v_dot2c_f32_bf16 v89, v136, v10
  v_dot2c_f32_bf16 v90, v137, v162
  v_dot2c_f32_bf16 v91, v137, v10
  v_dot2c_f32_bf16 v92, v138, v162
  v_dot2c_f32_bf16 v93, v138, v10
  v_dot2c_f32_bf16 v94, v139, v162
  v_dot2c_f32_bf16 v95, v139, v10
  s_waitcnt lgkmcnt(0)
  s_lshl_b32 s75, s76, 4
  s_sub_u32 s75, s75, s78
  s_and_b32 s75, s75, s72
  s_add_u32 s78, s78, s79
  s_waitcnt vmcnt(3)
  s_cmp_gt_i32 s75, 480
  s_cbranch_scc1 L_go_8
  s_waitcnt vmcnt(2)
  s_cmp_ge_i32 s75, 0
  s_cbranch_scc1 L_go_8
  s_waitcnt vmcnt(1)
L_go_8:
  buffer_load_dwordx4 v[156:159], v1, s[12:15], s63 offen offset:256 nt
  s_memrealtime s[76:77]
  v_dot2c_f32_bf16 v96, v140, v162
  v_dot2c_f32_bf16 v97, v140, v10
  v_dot2c_f32_bf16 v98, v141, v162
  v_dot2c_f32_bf16 v99, v141, v10
  v_dot2c_f32_bf16 v100, v142, v162
  v_dot2c_f32_bf16 v101, v142, v10
  v_dot2c_f32_bf16 v102, v143, v162
  v_dot2c_f32_bf16 v103, v143, v10
  s_waitcnt lgkmcnt(0)
  s_lshl_b32 s75, s76, 4
  s_sub_u32 s75, s75, s78
  s_and_b32 s75, s75, s72
  s_add_u32 s78, s78, s79
  s_waitcnt vmcnt(3)
  s_cmp_gt_i32 s75, 480
  s_cbranch_scc1 L_go_9
  s_waitcnt vmcnt(2)
  s_cmp_ge_i32 s75, 0
  s_cbranch_scc1 L_go_9
  s_waitcnt vmcnt(1)
L_go_9:
  buffer_load_dwordx4 v[16:19], v1, s[12:15], s64 offen offset:0 nt
  s_memrealtime s[76:77]
  v_dot2c_f32_bf16 v104, v144, v162
  v_dot2c_f32_bf16 v105, v144, v10
  v_dot2c_f32_bf16 v106, v145, v162
  v_dot2c_f32_bf16 v107, v145, v10
  v_dot2c_f32_bf16 v108, v146, v162
  v_dot2c_f32_bf16 v109, v146, v10
  v_dot2c_f32_bf16 v110, v147, v162
  v_dot2c_f32_bf16 v111, v147, v10
  s_waitcnt lgkmcnt(0)
  s_lshl_b32 s75, s76, 4
  s_sub_u32 s75, s75, s78
  s_and_b32 s75, s75, s72
  s_add_u32 s78, s78, s79
  s_waitcnt vmcnt(3)
  s_cmp_gt_i32 s75, 480
  s_cbranch_scc1 L_go_10
  s_waitcnt vmcnt(2)
  s_cmp_ge_i32 s75, 0
  s_cbranch_scc1 L_go_10
  s_waitcnt vmcnt(1)
L_go_10:
  buffer_load_dwordx4 v[20:23], v1, s[12:15], s64 offen offset:128 nt
  s_memrealtime s[76:77]
  v_lshlrev_b32 v10, 16, v163
  v_dot2c_f32_bf16 v88, v148, v163
  v_dot2c_f32_bf16 v89, v148, v10
  v_dot2c_f32_bf16 v90, v149, v163
  v_dot2c_f32_bf16 v91, v149, v10
  v_dot2c_f32_bf16 v92, v150, v163
  v_dot2c_f32_bf16 v93, v150, v10
  v_dot2c_f32_bf16 v94, v151, v163
  v_dot2c_f32_bf16 v95, v151, v10
  s_waitcnt lgkmcnt(0)
  s_lshl_b32 s75, s76, 4
  s_sub_u32 s75, s75, s78
  s_and_b32 s75, s75, s72
  s_add_u32 s78, s78, s79
  s_waitcnt vmcnt(3)
  s_cmp_gt_i32 s75, 480
  s_cbranch_scc1 L_go_11
  s_waitcnt vmcnt(2)
  s_cmp_ge_i32 s75, 0
  s_cbranch_scc1 L_go_11
  s_waitcnt vmcnt(1)
L_go_11:
  buffer_load_dwordx4 v[24:27], v1, s[12:15], s64 offen offset:256 nt
  s_memrealtime s[76:77]
  v_dot2c_f32_bf16 v96, v152, v163
  v_dot2c_f32_bf16 v97, v152, v10
  v_dot2c_f32_bf16 v98, v153, v163
  v_dot2c_f32_bf16 v99, v153, v10
  v_dot2c_f32_bf16 v100, v154, v163
  v_dot2c_f32_bf16 v101, v154, v10
  v_dot2c_f32_bf16 v102, v155, v163
  v_dot2c_f32_bf16 v103, v155, v10
  s_waitcnt lgkmcnt(0)
  s_lshl_b32 s75, s76, 4
  s_sub_u32 s75, s75, s78
  s_and_b32 s75, s75, s72
  s_add_u32 s78, s78, s79
  s_waitcnt vmcnt(3)
  s_cmp_gt_i32 s75, 480
  s_cbranch_scc1 L_go_12
  s_waitcnt vmcnt(2)
  s_cmp_ge_i32 s75, 0
  s_cbranch_scc1 L_go_12
  s_waitcnt vmcnt(1)
L_go_12:
  buffer_load_dwordx4 v[28:31], v1, s[12:15], s65 offen offset:0 nt
  s_memrealtime s[76:77]
  v_dot2c_f32_bf16 v104, v156, v163
  v_dot2c_f32_bf16 v105, v156, v10
  v_dot2c_f32_bf16 v106, v157, v163
  v_dot2c_f32_bf16 v107, v157, v10
  v_dot2c_f32_bf16 v108, v158, v163
  v_dot2c_f32_bf16 v109, v158, v10
  v_dot2c_f32_bf16 v110, v159, v163
  v_dot2c_f32_bf16 v111, v159, v10
  s_waitcnt lgkmcnt(0)
  s_lshl_b32 s75, s76, 4
  s_sub_u32 s75, s75, s78
  s_and_b32 s75, s75, s72
  s_add_u32 s78, s78, s79
  s_waitcnt vmcnt(3)
  s_cmp_gt_i32 s75, 480
  s_cbranch_scc1 L_go_13
  s_waitcnt vmcnt(2)
  s_cmp_ge_i32 s75, 0
  s_cbranch_scc1 L_go_13
  s_waitcnt vmcnt(1)
L_go_13:
  buffer_load_dwordx4 v[32:35], v1, s[12:15], s65 offen offset:128 nt
  s_memrealtime s[76:77]
  v_lshlrev_b32 v10, 16, v164
  v_dot2c_f32_bf16 v88, v16, v164
  v_dot2c_f32_bf16 v89, v16, v10
  v_dot2c_f32_bf16 v90, v17, v164
  v_dot2c_f32_bf16 v91, v17, v10
  v_dot2c_f32_bf16 v92, v18, v164
  v_dot2c_f32_bf16 v93, v18, v10
  v_dot2c_f32_bf16 v94, v19, v164
  v_dot2c_f32_bf16 v95, v19, v10
  s_waitcnt lgkmcnt(0)
  s_lshl_b32 s75, s76, 4
  s_sub_u32 s75, s75, s78
  s_and_b32 s75, s75, s72
  s_add_u32 s78, s78, s79
  s_waitcnt vmcnt(3)
  s_cmp_gt_i32 s75, 480
  s_cbranch_scc1 L_go_14
  s_waitcnt vmcnt(2)
  s_cmp_ge_i32 s75, 0
  s_cbranch_scc1 L_go_14
  s_waitcnt vmcnt(1)
L_go_14:
  buffer_load_dwordx4 v[36:39], v1, s[12:15], s65 offen offset:256 nt
  s_memrealtime s[76:77]
  v_dot2c_f32_bf16 v96, v20, v164
  v_dot2c_f32_bf16 v97, v20, v10
  v_dot2c_f32_bf16 v98, v21, v164
  v_dot2c_f32_bf16 v99, v21, v10
  v_dot2c_f32_bf16 v100, v22, v164
  v_dot2c_f32_bf16 v101, v22, v10
  v_dot2c_f32_bf16 v102, v23, v164
  v_dot2c_f32_bf16 v103, v23, v10
  s_waitcnt lgkmcnt(0)
  s_lshl_b32 s75, s76, 4
  s_sub_u32 s75, s75, s78
  s_and_b32 s75, s75, s72
  s_add_u32 s78, s78, s79
  s_waitcnt vmcnt(3)
  s_cmp_gt_i32 s75, 480
  s_cbranch_scc1 L_go_15
  s_waitcnt vmcnt(2)
  s_cmp_ge_i32 s75, 0
  s_cbranch_scc1 L_go_15
  s_waitcnt vmcnt(1)
L_go_15:
  buffer_load_dwordx4 v[40:43], v1, s[12:15], s66 offen offset:0 nt
  s_memrealtime s[76:77]
  v_dot2c_f32_bf16 v104, v24, v164
  v_dot2c_f32_bf16 v105, v24, v10
  v_dot2c_f32_bf16 v106, v25, v164
  v_dot2c_f32_bf16 v107, v25, v10
  v_dot2c_f32_bf16 v108, v26, v164
  v_dot2c_f32_bf16 v109, v26, v10
  v_dot2c_f32_bf16 v110, v27, v164
  v_dot2c_f32_bf16 v111, v27, v10
  s_waitcnt lgkmcnt(0)
  s_lshl_b32 s75, s76, 4
  s_sub_u32 s75, s75, s78
  s_and_b32 s75, s75, s72
  s_add_u32 s78, s78, s79
  s_waitcnt vmcnt(3)
  s_cmp_gt_i32 s75, 480
  s_cbranch_scc1 L_go_16
  s_waitcnt vmcnt(2)
  s_cmp_ge_i32 s75, 0
  s_cbranch_scc1 L_go_16
  s_waitcnt vmcnt(1)
L_go_16:
  buffer_load_dwordx4 v[44:47], v1, s[12:15], s66 offen offset:128 nt
  s_memrealtime s[76:77]
  v_lshlrev_b32 v10, 16, v165
  v_dot2c_f32_bf16 v88, v28, v165
  v_dot2c_f32_bf16 v89, v28, v10
  v_dot2c_f32_bf16 v90, v29, v165
  v_dot2c_f32_bf16 v91, v29, v10
  v_dot2c_f32_bf16 v92, v30, v165
  v_dot2c_f32_bf16 v93, v30, v10
  v_dot2c_f32_bf16 v94, v31, v165
  v_dot2c_f32_bf16 v95, v31, v10
  s_waitcnt lgkmcnt(0)
  s_lshl_b32 s75, s76, 4
  s_sub_u32 s75, s75, s78
  s_and_b32 s75, s75, s72
  s_add_u32 s78, s78, s79
  s_waitcnt vmcnt(3)
  s_cmp_gt_i32 s75, 480
  s_cbranch_scc1 L_go_17
  s_waitcnt vmcnt(2)
  s_cmp_ge_i32 s75, 0
  s_cbranch_scc1 L_go_17
  s_waitcnt vmcnt(1)
L_go_17:
  buffer_load_dwordx4 v[48:51], v1, s[12:15], s66 offen offset:256 nt
  s_memrealtime s[76:77]
  v_dot2c_f32_bf16 v96, v32, v165
  v_dot2c_f32_bf16 v97, v32, v10
  v_dot2c_f32_bf16 v98, v33, v165
  v_dot2c_f32_bf16 v99, v33, v10
  v_dot2c_f32_bf16 v100, v34, v165
  v_dot2c_f32_bf16 v101, v34, v10
  v_dot2c_f32_bf16 v102, v35, v165
  v_dot2c_f32_bf16 v103, v35, v10
  s_waitcnt lgkmcnt(0)
  s_lshl_b32 s75, s76, 4
  s_sub_u32 s75, s75, s78
  s_and_b32 s75, s75, s72
  s_add_u32 s78, s78, s79
  s_waitcnt vmcnt(3)
  s_cmp_gt_i32 s75, 480
  s_cbranch_scc1 L_go_18
  s_waitcnt vmcnt(2)
  s_cmp_ge_i32 s75, 0
  s_cbranch_scc1 L_go_18
  s_waitcnt vmcnt(1)
L_go_18:
  buffer_load_dwordx4 v[52:55], v1, s[12:15], s67 offen offset:0 nt
  s_memrealtime s[76:77]
  s_mov_b64 exec, 1
  ds_add_u32 v2, v11 offset:644
  s_mov_b64 exec, -1
  v_dot2c_f32_bf16 v104, v36, v165
  v_dot2c_f32_bf16 v105, v36, v10
  v_dot2c_f32_bf16 v106, v37, v165
  v_dot2c_f32_bf16 v107, v37, v10
  v_dot2c_f32_bf16 v108, v38, v165
  v_dot2c_f32_bf16 v109, v38, v10
  v_dot2c_f32_bf16 v110, v39, v165
  v_dot2c_f32_bf16 v111, v39, v10
  s_waitcnt lgkmcnt(0)
  s_lshl_b32 s75, s76, 4
  s_sub_u32 s75, s75, s78
  s_and_b32 s75, s75, s72
  s_add_u32 s78, s78, s79
  s_waitcnt vmcnt(3)
  s_cmp_gt_i32 s75, 480
  s_cbranch_scc1 L_go_19
  s_waitcnt vmcnt(2)
  s_cmp_ge_i32 s75, 0
  s_cbranch_scc1 L_go_19
  s_waitcnt vmcnt(1)
L_go_19:
  buffer_load_dwordx4 v[56:59], v1, s[12:15], s67 offen offset:128 nt
  s_memrealtime s[76:77]
  v_lshlrev_b32 v10, 16, v166
  v_dot2c_f32_bf16 v88, v40, v166
  v_dot2c_f32_bf16 v89, v40, v10
  v_dot2c_f32_bf16 v90, v41, v166
  v_dot2c_f32_bf16 v91, v41, v10
  v_dot2c_f32_bf16 v92, v42, v166
  v_dot2c_f32_bf16 v93, v42, v10
  v_dot2c_f32_bf16 v94, v43, v166
  v_dot2c_f32_bf16 v95, v43, v10
  s_waitcnt lgkmcnt(0)
  s_lshl_b32 s75, s76, 4
  s_sub_u32 s75, s75, s78
  s_and_b32 s75, s75, s72
  s_add_u32 s78, s78, s79
  s_waitcnt vmcnt(3)
  s_cmp_gt_i32 s75, 480
  s_cbranch_scc1 L_go_20
  s_waitcnt vmcnt(2)
  s_cmp_ge_i32 s75, 0
  s_cbranch_scc1 L_go_20
  s_waitcnt vmcnt(1)
L_go_20:
  buffer_load_dwordx4 v[60:63], v1, s[12:15], s67 offen offset:256 nt
  v_dot2c_f32_bf16 v96, v44, v166
  v_dot2c_f32_bf16 v97, v44, v10
  v_dot2c_f32_bf16 v98, v45, v166
  v_dot2c_f32_bf16 v99, v45, v10
  v_dot2c_f32_bf16 v100, v46, v166
  v_dot2c_f32_bf16 v101, v46, v10
  v_dot2c_f32_bf16 v102, v47, v166
  v_dot2c_f32_bf16 v103, v47, v10
  s_waitcnt vmcnt(3)
  v_dot2c_f32_bf16 v104, v48, v166
  v_dot2c_f32_bf16 v105, v48, v10
  v_dot2c_f32_bf16 v106, v49, v166
  v_dot2c_f32_bf16 v107, v49, v10
  v_dot2c_f32_bf16 v108, v50, v166
  v_dot2c_f32_bf16 v109, v50, v10
  v_dot2c_f32_bf16 v110, v51, v166
  v_dot2c_f32_bf16 v111, v51, v10
  s_mov_b32 s70, 4000007
L_spin_21:
  ds_read_b128 v[12:15], v3 offset:512
  s_waitcnt lgkmcnt(0)
  v_cmp_eq_u32 vcc, 0, v15
  s_nop 0
  s_cbranch_vccz L_sdone_22
  s_sleep 1
  s_sub_u32 s70, s70, 1
  s_cbranch_scc0 L_spin_21
L_sdone_22:
  v_max_f32_dpp v12, v12, v12 quad_perm:[1,0,3,2] row_mask:0xf bank_mask:0xf
  s_nop 1
  v_max_f32_dpp v12, v12, v12 quad_perm:[2,3,0,1] row_mask:0xf bank_mask:0xf
  s_nop 1
  v_max_f32_dpp v12, v12, v12 row_half_mirror row_mask:0xf bank_mask:0xf
  v_sub_f32 v9, v4, v12
  v_mul_f32 v9, s68, v9
  v_exp_f32 v9, v9
  v_mov_b32 v2, 0
  s_mov_b32 s70, 4000007
L_spin_23:
  ds_read_b32 v13, v2 offset:648
  s_waitcnt lgkmcnt(0)
  v_cmp_gt_u32 vcc, 1, v13
  s_nop 0
  s_cbranch_vccz L_sdone_24
  s_sleep 2
  s_sub_u32 s70, s70, 1
  s_cbranch_scc0 L_spin_23
L_sdone_24:
  v_readfirstlane_b32 s46, v13
  v_min_u32 v12, 47, v0
  v_lshlrev_b32 v13, 7, v12
  v_lshlrev_b32 v12, 4, v12
  s_mul_i32 s74, s6, 6144
  s_lshl4_add_u32 s74, s7, s74
  s_add_u32 s74, s74, 524288
  s_mov_b32 s22, 0xaaaaaaaa
  s_mov_b32 s23, 0xaaaaaaaa
  v_mov_b32 v14, s30
  v_mov_b32 v15, s31
  s_waitcnt vmcnt(2)
  v_lshlrev_b32 v10, 16, v167
  v_dot2c_f32_bf16 v88, v52, v167
  v_dot2c_f32_bf16 v89, v52, v10
  v_dot2c_f32_bf16 v90, v53, v167
  v_dot2c_f32_bf16 v91, v53, v10
  v_dot2c_f32_bf16 v92, v54, v167
  v_dot2c_f32_bf16 v93, v54, v10
  v_dot2c_f32_bf16 v94, v55, v167
  v_dot2c_f32_bf16 v95, v55, v10
  v_permlane32_swap_b32 v88, v92
  v_permlane32_swap_b32 v89, v93
  v_permlane32_swap_b32 v90, v94
  v_permlane32_swap_b32 v91, v95
  v_add_f32 v88, v88, v92
  v_add_f32 v89, v89, v93
  v_add_f32 v90, v90, v94
  v_add_f32 v91, v91, v95
  s_nop 0
  v_permlane16_swap_b32 v88, v90
  v_permlane16_swap_b32 v89, v91
  v_add_f32 v88, v88, v90
  v_add_f32 v89, v89, v91
  s_nop 0
  v_add_f32_dpp v88, v88, v88 row_ror:8 row_mask:0xf bank_mask:0xf
  v_add_f32_dpp v89, v89, v89 row_ror:8 row_mask:0xf bank_mask:0xf
  v_mul_f32 v88, v9, v88
  v_mul_f32 v89, v9, v89
  ds_write_b64 v8, v[88:89] offset:1024
  s_waitcnt vmcnt(1)
  v_dot2c_f32_bf16 v96, v56, v167
  v_dot2c_f32_bf16 v97, v56, v10
  v_dot2c_f32_bf16 v98, v57, v167
  v_dot2c_f32_bf16 v99, v57, v10
  v_dot2c_f32_bf16 v100, v58, v167
  v_dot2c_f32_bf16 v101, v58, v10
  v_dot2c_f32_bf16 v102, v59, v167
  v_dot2c_f32_bf16 v103, v59, v10
  v_permlane32_swap_b32 v96, v100
  v_permlane32_swap_b32 v97, v101
  v_permlane32_swap_b32 v98, v102
  v_permlane32_swap_b32 v99, v103
  v_add_f32 v96, v96, v100
  v_add_f32 v97, v97, v101
  v_add_f32 v98, v98, v102
  v_add_f32 v99, v99, v103
  s_nop 0
  v_permlane16_swap_b32 v96, v98
  v_permlane16_swap_b32 v97, v99
  v_add_f32 v96, v96, v98
  v_add_f32 v97, v97, v99
  s_nop 0
  v_add_f32_dpp v96, v96, v96 row_ror:8 row_mask:0xf bank_mask:0xf
  v_add_f32_dpp v97, v97, v97 row_ror:8 row_mask:0xf bank_mask:0xf
  v_mul_f32 v96, v9, v96
  v_mul_f32 v97, v9, v97
  ds_write_b64 v8, v[96:97] offset:1280
  s_waitcnt vmcnt(0)
  v_dot2c_f32_bf16 v104, v60, v167
  v_dot2c_f32_bf16 v105, v60, v10
  v_dot2c_f32_bf16 v106, v61, v167
  v_dot2c_f32_bf16 v107, v61, v10
  v_dot2c_f32_bf16 v108, v62, v167
  v_dot2c_f32_bf16 v109, v62, v10
  v_dot2c_f32_bf16 v110, v63, v167
  v_dot2c_f32_bf16 v111, v63, v10
  v_permlane32_swap_b32 v104, v108
  v_permlane32_swap_b32 v105, v109
  v_permlane32_swap_b32 v106, v110
  v_permlane32_swap_b32 v107, v111
  v_add_f32 v104, v104, v108
  v_add_f32 v105, v105, v109
  v_add_f32 v106, v106, v110
  v_add_f32 v107, v107, v111
  s_nop 0
  v_permlane16_swap_b32 v104, v106
  v_permlane16_swap_b32 v105, v107
  v_add_f32 v104, v104, v106
  v_add_f32 v105, v105, v107
  s_nop 0
  v_add_f32_dpp v104, v104, v104 row_ror:8 row_mask:0xf bank_mask:0xf
  v_add_f32_dpp v105, v105, v105 row_ror:8 row_mask:0xf bank_mask:0xf
  v_mul_f32 v104, v9, v104
  v_mul_f32 v105, v9, v105
  ds_write_b64 v8, v[104:105] offset:1536
  s_mov_b64 exec, 1
  ds_add_rtn_u32 v10, v2, v11 offset:640
  s_mov_b64 exec, -1
  ds_read_b128 v[16:19], v12 offset:1024
  ds_read_b128 v[20:23], v12 offset:1792
  ds_read_b128 v[24:27], v12 offset:2560
  ds_read_b128 v[28:31], v12 offset:3328
  ds_read_b128 v[32:35], v12 offset:4096
  ds_read_b128 v[36:39], v12 offset:4864
  ds_read_b128 v[40:43], v12 offset:5632
  ds_read_b128 v[44:47], v12 offset:6400
  s_waitcnt lgkmcnt(8)
  v_readfirstlane_b32 s68, v10
  s_nop 0
  s_cmp_lg_u32 s68, 7
  s_cbranch_scc1 L_nopub
  s_waitcnt lgkmcnt(6)
  v_pk_add_f32 v[16:17], v[16:17], v[20:21]
  v_pk_add_f32 v[18:19], v[18:19], v[22:23]
  s_waitcnt lgkmcnt(4)
  v_pk_add_f32 v[24:25], v[24:25], v[28:29]
  v_pk_add_f32 v[26:27], v[26:27], v[30:31]
  v_pk_add_f32 v[16:17], v[16:17], v[24:25]
  v_pk_add_f32 v[18:19], v[18:19], v[26:27]
  s_waitcnt lgkmcnt(2)
  v_pk_add_f32 v[32:33], v[32:33], v[36:37]
  v_pk_add_f32 v[34:35], v[34:35], v[38:39]
  s_waitcnt lgkmcnt(0)
  v_pk_add_f32 v[40:41], v[40:41], v[44:45]
  v_pk_add_f32 v[42:43], v[42:43], v[46:47]
  v_pk_add_f32 v[32:33], v[32:33], v[40:41]
  v_pk_add_f32 v[34:35], v[34:35], v[42:43]
  v_pk_add_f32 v[4:5], v[16:17], v[32:33]
  v_pk_add_f32 v[6:7], v[18:19], v[34:35]
  v_cvt_pk_bf16_f32 v8, v4, v5
  v_cvt_pk_bf16_f32 v9, v6, v7
  v_cndmask_b32 v4, v8, v14, s[22:23]
  v_cndmask_b32 v5, v9, v15, s[22:23]
  v_cndmask_b32 v6, v14, v8, s[22:23]
  v_cndmask_b32 v7, v15, v9, s[22:23]
  s_mov_b32 exec_lo, 0xffffffff
  s_mov_b32 exec_hi, 0xffff
  buffer_store_dwordx4 v[4:7], v13, s[32:35], s74 offen
  s_mov_b64 exec, -1
  s_cmp_lg_u32 s46, 1
  s_cbranch_scc1 L_slow_25
L_back_26:
  ds_write_b32 v2, v11 offset:668
L_nopub:
  s_waitcnt lgkmcnt(0)
  s_cmp_lt_u32 s5, 20
  s_cbranch_scc1 L_notf1
  s_cmp_lt_u32 s5, 30
  s_cbranch_scc1 L_f1
  s_branch L_stream_exit
L_notf1:
  s_cmp_gt_u32 s5, 11
  s_cbranch_scc1 L_stream_exit
  s_cmp_gt_u32 s3, 6
  s_cbranch_scc1 L_f2
  s_branch L_dry
L_stream_exit:
  s_endpgm
L_helper:
  s_setprio 3
  v_lshlrev_b32 v1, 2, v0
  v_lshrrev_b32 v2, 3, v0
  s_mul_i32 s68, s7, 80
  v_add_u32 v3, s68, v2
  v_lshlrev_b32 v3, 1, v3
  v_mul_u32_u24 v2, 12288, v2
  v_and_b32 v7, 7, v0
  v_lshl_add_u32 v2, v7, 4, v2
  s_mul_i32 s68, s68, 12288
  s_mul_i32 s69, s6, 384
  s_add_u32 s68, s68, s69
  s_lshl_b32 s69, s3, 7
  s_add_u32 s68, s68, s69
  s_waitcnt lgkmcnt(0)
  s_load_dword s12, s[36:37], 0
  s_load_dword s13, s[36:37], 128
  s_load_dword s14, s[36:37], 256
  s_load_dword s15, s[36:37], 384
  s_load_dword s16, s[36:37], 512
  s_load_dword s17, s[36:37], 640
  s_load_dword s18, s[36:37], 768
  s_load_dword s19, s[36:37], 896
  s_load_dword s20, s[36:37], 1024
  s_load_dword s21, s[36:37], 1152
  s_barrier
  s_mov_b32 s8, s42
  s_mov_b32 s9, s43
  s_mov_b32 s10, 7864320
  s_mov_b32 s11, 0x20000
  s_waitcnt lgkmcnt(0)
  global_load_dword v64, v1, s[36:37] offset:0
  global_load_dword v65, v1, s[36:37] offset:256
  global_load_dword v66, v1, s[36:37] offset:512
  global_load_dword v67, v1, s[36:37] offset:768
  global_load_dword v68, v1, s[36:37] offset:1024
  global_load_ushort v8, v3, s[36:37] offset:0
  global_load_ushort v9, v3, s[36:37] offset:16
  global_load_ushort v10, v3, s[36:37] offset:32
  global_load_ushort v11, v3, s[36:37] offset:48
  global_load_ushort v12, v3, s[36:37] offset:64
  global_load_ushort v13, v3, s[36:37] offset:80
  global_load_ushort v14, v3, s[36:37] offset:96
  global_load_ushort v15, v3, s[36:37] offset:112
  global_load_ushort v16, v3, s[36:37] offset:128
  global_load_ushort v17, v3, s[36:37] offset:144
  s_load_dwordx2 s[28:29], s[58:59], 917504
  s_mov_b32 s69, 0xffff0000
  s_mov_b32 s24, s58
  s_mov_b32 s25, s59
  s_mov_b32 s26, 4194304
  s_mov_b32 s27, 0x20000
  s_add_u32 s32, s58, 4194304
  s_addc_u32 s33, s59, 0
  s_mov_b32 s34, 4194304
  s_mov_b32 s35, 0x20000
  s_lshl3_add_u32 s71, s6, s7
  s_mul_i32 s5, s79, 5
  s_mul_i32 s47, s79, 3
  s_add_u32 s47, s47, 15
  s_cmp_lt_u32 s7, 5
  s_cselect_b32 s5, s5, s47
  s_add_u32 s5, s5, s7
  s_waitcnt lgkmcnt(0)
  s_mul_i32 s30, s28, 0x2c9277b5
  s_add_u32 s30, s30, 0xac564b05
  s_mul_i32 s31, s29, 0x0019660d
  s_add_u32 s31, s31, 0x3c6ef35f
  s_waitcnt vmcnt(10)
  v_lshlrev_b32 v70, 16, v64
  v_and_b32 v71, s69, v64
  v_lshlrev_b32 v72, 16, v65
  v_and_b32 v73, s69, v65
  v_lshlrev_b32 v74, 16, v66
  v_and_b32 v75, s69, v66
  v_lshlrev_b32 v76, 16, v67
  v_and_b32 v77, s69, v67
  v_lshlrev_b32 v78, 16, v68
  v_and_b32 v79, s69, v68
  v_add_f32 v4, v70, v71
  v_add_f32 v5, v72, v73
  v_add_f32 v6, v74, v75
  v_add_f32 v7, v76, v77
  v_add_f32 v4, v4, v5
  v_add_f32 v6, v6, v7
  v_add_f32 v5, v78, v79
  v_add_f32 v4, v4, v6
  v_add_f32 v4, v4, v5
  s_nop 1
  v_add_f32_dpp v4, v4, v4 quad_perm:[1,0,3,2] row_mask:0xf bank_mask:0xf
  s_nop 1
  v_add_f32_dpp v4, v4, v4 quad_perm:[2,3,0,1] row_mask:0xf bank_mask:0xf
  s_nop 1
  v_add_f32_dpp v4, v4, v4 row_half_mirror row_mask:0xf bank_mask:0xf
  s_nop 1
  v_add_f32_dpp v4, v4, v4 row_mirror row_mask:0xf bank_mask:0xf
  v_mov_b32 v5, v4
  s_nop 1
  v_permlane16_swap_b32 v4, v5
  v_add_f32 v4, v4, v5
  v_mov_b32 v5, v4
  s_nop 1
  v_permlane32_swap_b32 v4, v5
  v_add_f32 v4, v4, v5
  v_mul_f32 v4, 0x3acccccd, v4
  v_sub_f32 v70, v70, v4
  v_sub_f32 v71, v71, v4
  v_sub_f32 v72, v72, v4
  v_sub_f32 v73, v73, v4
  v_sub_f32 v74, v74, v4
  v_sub_f32 v75, v75, v4
  v_sub_f32 v76, v76, v4
  v_sub_f32 v77, v77, v4
  v_sub_f32 v78, v78, v4
  v_sub_f32 v79, v79, v4
  v_mul_f32 v5, v70, v70
  v_fmac_f32 v5, v71, v71
  v_fmac_f32 v5, v72, v72
  v_fmac_f32 v5, v73, v73
  v_fmac_f32 v5, v74, v74
  v_fmac_f32 v5, v75, v75
  v_fmac_f32 v5, v76, v76
  v_fmac_f32 v5, v77, v77
  v_fmac_f32 v5, v78, v78
  v_fmac_f32 v5, v79, v79
  s_nop 1
  v_add_f32_dpp v5, v5, v5 quad_perm:[1,0,3,2] row_mask:0xf bank_mask:0xf
  s_nop 1
  v_add_f32_dpp v5, v5, v5 quad_perm:[2,3,0,1] row_mask:0xf bank_mask:0xf
  s_nop 1
  v_add_f32_dpp v5, v5, v5 row_half_mirror row_mask:0xf bank_mask:0xf
  s_nop 1
  v_add_f32_dpp v5, v5, v5 row_mirror row_mask:0xf bank_mask:0xf
  v_mov_b32 v6, v5
  s_nop 1
  v_permlane16_swap_b32 v5, v6
  v_add_f32 v5, v5, v6
  v_mov_b32 v6, v5
  s_nop 1
  v_permlane32_swap_b32 v5, v6
  v_add_f32 v5, v5, v6
  v_mul_f32 v5, 0x3acccccd, v5
  v_cvt_pk_bf16_f32 v4, v4, v4
  v_lshlrev_b32 v4, 16, v4
  v_cvt_pk_bf16_f32 v5, v5, v5
  v_lshlrev_b32 v5, 16, v5
  v_add_f32 v5, 0x3727c5ac, v5
  v_cvt_pk_bf16_f32 v5, v5, v5
  v_lshlrev_b32 v5, 16, v5
  v_sqrt_f32 v5, v5
  s_nop 0
  v_cvt_pk_bf16_f32 v5, v5, v5
  v_lshlrev_b32 v5, 16, v5
  v_rcp_f32 v5, v5
  v_mov_b32 v6, 0
  s_waitcnt vmcnt(0)
  v_lshlrev_b32 v8, 16, v8
  v_lshlrev_b32 v9, 16, v9
  v_lshlrev_b32 v10, 16, v10
  v_lshlrev_b32 v11, 16, v11
  v_lshlrev_b32 v12, 16, v12
  v_lshlrev_b32 v13, 16, v13
  v_lshlrev_b32 v14, 16, v14
  v_lshlrev_b32 v15, 16, v15
  v_lshlrev_b32 v16, 16, v16
  v_lshlrev_b32 v17, 16, v17
  v_sub_f32 v8, v8, v4
  v_sub_f32 v9, v9, v4
  v_sub_f32 v10, v10, v4
  v_sub_f32 v11, v11, v4
  v_sub_f32 v12, v12, v4
  v_sub_f32 v13, v13, v4
  v_sub_f32 v14, v14, v4
  v_sub_f32 v15, v15, v4
  v_sub_f32 v16, v16, v4
  v_sub_f32 v17, v17, v4
  v_cvt_pk_bf16_f32 v8, v6, v8
  v_cvt_pk_bf16_f32 v9, v6, v9
  v_cvt_pk_bf16_f32 v10, v6, v10
  v_cvt_pk_bf16_f32 v11, v6, v11
  v_cvt_pk_bf16_f32 v12, v6, v12
  v_cvt_pk_bf16_f32 v13, v6, v13
  v_cvt_pk_bf16_f32 v14, v6, v14
  v_cvt_pk_bf16_f32 v15, v6, v15
  v_cvt_pk_bf16_f32 v16, v6, v16
  v_cvt_pk_bf16_f32 v17, v6, v17
  v_mul_f32 v8, v8, v5
  v_mul_f32 v9, v9, v5
  v_mul_f32 v10, v10, v5
  v_mul_f32 v11, v11, v5
  v_mul_f32 v12, v12, v5
  v_mul_f32 v13, v13, v5
  v_mul_f32 v14, v14, v5
  v_mul_f32 v15, v15, v5
  v_mul_f32 v16, v16, v5
  v_mul_f32 v17, v17, v5
  v_cvt_pk_bf16_f32 v70, v6, v8
  v_cvt_pk_bf16_f32 v8, v8, v6
  v_cvt_pk_bf16_f32 v71, v6, v9
  v_cvt_pk_bf16_f32 v9, v9, v6
  v_cvt_pk_bf16_f32 v72, v6, v10
  v_cvt_pk_bf16_f32 v10, v10, v6
  v_cvt_pk_bf16_f32 v73, v6, v11
  v_cvt_pk_bf16_f32 v11, v11, v6
  v_cvt_pk_bf16_f32 v74, v6, v12
  v_cvt_pk_bf16_f32 v12, v12, v6
  v_cvt_pk_bf16_f32 v75, v6, v13
  v_cvt_pk_bf16_f32 v13, v13, v6
  v_cvt_pk_bf16_f32 v76, v6, v14
  v_cvt_pk_bf16_f32 v14, v14, v6
  v_cvt_pk_bf16_f32 v77, v6, v15
  v_cvt_pk_bf16_f32 v15, v15, v6
  v_cvt_pk_bf16_f32 v78, v6, v16
  v_cvt_pk_bf16_f32 v16, v16, v6
  v_cvt_pk_bf16_f32 v79, v6, v17
  v_cvt_pk_bf16_f32 v17, v17, v6
  v_mov_b32 v80, 0
  v_mov_b32 v81, 0
  v_mov_b32 v82, 0
  v_mov_b32 v83, 0
  v_mov_b32 v84, 0
  v_mov_b32 v85, 0
  v_mov_b32 v86, 0
  v_mov_b32 v87, 0
  v_and_b32 v90, 7, v0
  v_lshrrev_b32 v6, 4, v0
  v_lshl_add_u32 v90, v90, 2, v6
  v_lshlrev_b32 v90, 4, v90
  s_lshl_b32 s64, s71, 11
  s_lshl_b32 s69, s3, 9
  s_add_u32 s64, s64, s69
  s_waitcnt vmcnt(9)
  v_dot2c_f32_bf16 v80, v24, v8
  v_dot2c_f32_bf16 v81, v24, v70
  v_dot2c_f32_bf16 v82, v25, v8
  v_dot2c_f32_bf16 v83, v25, v70
  v_dot2c_f32_bf16 v84, v26, v8
  v_dot2c_f32_bf16 v85, v26, v70
  v_dot2c_f32_bf16 v86, v27, v8
  v_dot2c_f32_bf16 v87, v27, v70
  s_waitcnt vmcnt(8)
  v_dot2c_f32_bf16 v80, v28, v9
  v_dot2c_f32_bf16 v81, v28, v71
  v_dot2c_f32_bf16 v82, v29, v9
  v_dot2c_f32_bf16 v83, v29, v71
  v_dot2c_f32_bf16 v84, v30, v9
  v_dot2c_f32_bf16 v85, v30, v71
  v_dot2c_f32_bf16 v86, v31, v9
  v_dot2c_f32_bf16 v87, v31, v71
  s_waitcnt vmcnt(7)
  v_dot2c_f32_bf16 v80, v32, v10
  v_dot2c_f32_bf16 v81, v32, v72
  v_dot2c_f32_bf16 v82, v33, v10
  v_dot2c_f32_bf16 v83, v33, v72
  v_dot2c_f32_bf16 v84, v34, v10
  v_dot2c_f32_bf16 v85, v34, v72
  v_dot2c_f32_bf16 v86, v35, v10
  v_dot2c_f32_bf16 v87, v35, v72
  s_waitcnt vmcnt(6)
  v_dot2c_f32_bf16 v80, v36, v11
  v_dot2c_f32_bf16 v81, v36, v73
  v_dot2c_f32_bf16 v82, v37, v11
  v_dot2c_f32_bf16 v83, v37, v73
  v_dot2c_f32_bf16 v84, v38, v11
  v_dot2c_f32_bf16 v85, v38, v73
  v_dot2c_f32_bf16 v86, v39, v11
  v_dot2c_f32_bf16 v87, v39, v73
  s_waitcnt vmcnt(5)
  v_dot2c_f32_bf16 v80, v40, v12
  v_dot2c_f32_bf16 v81, v40, v74
  v_dot2c_f32_bf16 v82, v41, v12
  v_dot2c_f32_bf16 v83, v41, v74
  v_dot2c_f32_bf16 v84, v42, v12
  v_dot2c_f32_bf16 v85, v42, v74
  v_dot2c_f32_bf16 v86, v43, v12
  v_dot2c_f32_bf16 v87, v43, v74
  s_waitcnt vmcnt(4)
  v_dot2c_f32_bf16 v80, v44, v13
  v_dot2c_f32_bf16 v81, v44, v75
  v_dot2c_f32_bf16 v82, v45, v13
  v_dot2c_f32_bf16 v83, v45, v75
  v_dot2c_f32_bf16 v84, v46, v13
  v_dot2c_f32_bf16 v85, v46, v75
  v_dot2c_f32_bf16 v86, v47, v13
  v_dot2c_f32_bf16 v87, v47, v75
  s_waitcnt vmcnt(3)
  v_dot2c_f32_bf16 v80, v48, v14
  v_dot2c_f32_bf16 v81, v48, v76
  v_dot2c_f32_bf16 v82, v49, v14
  v_dot2c_f32_bf16 v83, v49, v76
  v_dot2c_f32_bf16 v84, v50, v14
  v_dot2c_f32_bf16 v85, v50, v76
  v_dot2c_f32_bf16 v86, v51, v14
  v_dot2c_f32_bf16 v87, v51, v76
  s_waitcnt vmcnt(2)
  v_dot2c_f32_bf16 v80, v52, v15
  v_dot2c_f32_bf16 v81, v52, v77
  v_dot2c_f32_bf16 v82, v53, v15
  v_dot2c_f32_bf16 v83, v53, v77
  v_dot2c_f32_bf16 v84, v54, v15
  v_dot2c_f32_bf16 v85, v54, v77
  v_dot2c_f32_bf16 v86, v55, v15
  v_dot2c_f32_bf16 v87, v55, v77
  s_waitcnt vmcnt(1)
  v_dot2c_f32_bf16 v80, v56, v16
  v_dot2c_f32_bf16 v81, v56, v78
  v_dot2c_f32_bf16 v82, v57, v16
  v_dot2c_f32_bf16 v83, v57, v78
  v_dot2c_f32_bf16 v84, v58, v16
  v_dot2c_f32_bf16 v85, v58, v78
  v_dot2c_f32_bf16 v86, v59, v16
  v_dot2c_f32_bf16 v87, v59, v78
  s_waitcnt vmcnt(0)
  v_dot2c_f32_bf16 v80, v60, v17
  v_dot2c_f32_bf16 v81, v60, v79
  v_dot2c_f32_bf16 v82, v61, v17
  v_dot2c_f32_bf16 v83, v61, v79
  v_dot2c_f32_bf16 v84, v62, v17
  v_dot2c_f32_bf16 v85, v62, v79
  v_dot2c_f32_bf16 v86, v63, v17
  v_dot2c_f32_bf16 v87, v63, v79
  v_permlane32_swap_b32 v80, v84
  v_permlane32_swap_b32 v81, v85
  v_permlane32_swap_b32 v82, v86
  v_permlane32_swap_b32 v83, v87
  v_add_f32 v80, v80, v84
  v_add_f32 v81, v81, v85
  v_add_f32 v82, v82, v86
  v_add_f32 v83, v83, v87
  s_nop 0
  v_permlane16_swap_b32 v80, v82
  v_permlane16_swap_b32 v81, v83
  v_add_f32 v80, v80, v82
  v_add_f32 v81, v81, v83
  s_nop 0
  v_add_f32_dpp v80, v80, v80 row_ror:8 row_mask:0xf bank_mask:0xf
  v_add_f32_dpp v81, v81, v81 row_ror:8 row_mask:0xf bank_mask:0xf
  v_mov_b32 v82, s30
  v_mov_b32 v83, s31
  s_mov_b32 exec_lo, 0xff00ff
  s_mov_b32 exec_hi, 0xff00ff
  buffer_store_dwordx4 v[80:83], v90, s[32:35], s64 offen offset:0
  s_mov_b64 exec, -1
  v_and_b32 v3, 31, v0
  v_lshrrev_b32 v2, 5, v0
  v_lshlrev_b32 v2, 11, v2
  v_lshl_add_u32 v2, v3, 4, v2
  s_lshl_b32 s68, s6, 14
  s_add_u32 s60, s68, s69
  s_add_u32 s61, s60, 4096
  s_add_u32 s62, s60, 8192
  s_add_u32 s63, s60, 12288
  v_lshlrev_b32 v3, 2, v3
  s_lshl_b32 s69, s3, 7
  v_add_u32 v3, s69, v3
  v_mov_b32 v1, 0
  s_mov_b32 s65, 0
  s_lshl_b32 s66, s6, 14
  s_lshl_b32 s68, s3, 11
  s_add_u32 s66, s66, s68
  s_add_u32 s68, s3, 5
  s_cmp_eq_u32 s68, s7
  s_cbranch_scc1 L_qred
  v_and_b32 v2, 15, v0
  v_lshlrev_b32 v3, 3, v2
  v_add_u32 v3, s69, v3
  v_lshlrev_b32 v2, 4, v2
  s_sleep 40
  s_mov_b32 s16, s32
  s_mov_b32 s17, s33
  s_mov_b32 s18, 4194304
  s_mov_b32 s19, 0x20000
  s_mov_b32 s70, 4000007
L_spin_27:
  buffer_load_dwordx4 v[8:11], v2, s[16:19], s66 offen offset:1536 sc1 nt
  s_waitcnt vmcnt(0)
  v_cmp_ne_u64 vcc, s[30:31], v[10:11]
  s_nop 0
  s_cbranch_vccz L_sdone_28
  s_sleep 8
  ds_read_b32 v4, v1 offset:648
  s_waitcnt lgkmcnt(0)
  v_readfirstlane_b32 s46, v4
  s_nop 0
  s_sub_u32 s68, s46, s65
  s_cmp_lg_u32 s68, 2
  s_cbranch_scc1 L_qlazy_29
  s_mov_b32 exec_lo, 0xff00ff
  s_mov_b32 exec_hi, 0xff00ff
  buffer_store_dwordx4 v[80:83], v90, s[24:27], s64 offen offset:0 sc1
  s_mov_b64 exec, -1
  s_mov_b32 s65, 1
L_qlazy_29:
  s_and_b32 s99, s70, 7
  s_cselect_b32 s16, s32, s24
  s_cselect_b32 s17, s33, s25
  s_sub_u32 s70, s70, 1
  s_cbranch_scc0 L_spin_27
L_sdone_28:
  ds_write_b64 v3, v[8:9] offset:0
  s_branch L_qdone
L_qred:
  s_mov_b32 s16, s32
  s_mov_b32 s17, s33
  s_mov_b32 s18, 4194304
  s_mov_b32 s19, 0x20000
  s_mov_b32 s70, 4000007
L_spin_30:
  buffer_load_dwordx4 v[8:11], v2, s[16:19], s60 offen offset:0 sc1 nt
  buffer_load_dwordx4 v[12:15], v2, s[16:19], s61 offen offset:0 sc1 nt
  buffer_load_dwordx4 v[16:19], v2, s[16:19], s62 offen offset:0 sc1 nt
  buffer_load_dwordx4 v[20:23], v2, s[16:19], s63 offen offset:0 sc1 nt
  s_waitcnt vmcnt(0)
  v_cmp_ne_u64 vcc, s[30:31], v[10:11]
  v_cmp_ne_u64 s[20:21], s[30:31], v[14:15]
  v_cmp_ne_u64 s[22:23], s[30:31], v[18:19]
  s_or_b64 vcc, vcc, s[20:21]
  v_cmp_ne_u64 s[20:21], s[30:31], v[22:23]
  s_or_b64 vcc, vcc, s[22:23]
  s_or_b64 vcc, vcc, s[20:21]
  s_nop 0
  s_cbranch_vccz L_sdone_31
  s_sleep 2
  ds_read_b32 v4, v1 offset:648
  s_waitcnt lgkmcnt(0)
  v_readfirstlane_b32 s46, v4
  s_nop 0
  s_sub_u32 s68, s46, s65
  s_cmp_lg_u32 s68, 2
  s_cbranch_scc1 L_qlazy_32
  s_mov_b32 exec_lo, 0xff00ff
  s_mov_b32 exec_hi, 0xff00ff
  buffer_store_dwordx4 v[80:83], v90, s[24:27], s64 offen offset:0 sc1
  s_mov_b64 exec, -1
  s_mov_b32 s65, 1
L_qlazy_32:
  s_and_b32 s99, s70, 7
  s_cselect_b32 s16, s32, s24
  s_cselect_b32 s17, s33, s25
  s_sub_u32 s70, s70, 1
  s_cbranch_scc0 L_spin_30
L_sdone_31:
  v_add_f32 v8, v8, v12
  v_add_f32 v9, v9, v13
  v_add_f32 v16, v16, v20
  v_add_f32 v17, v17, v21
  v_add_f32 v8, v8, v16
  v_add_f32 v9, v9, v17
  v_mov_b32 v10, v8
  v_mov_b32 v11, v9
  s_nop 0
  v_permlane32_swap_b32 v8, v10
  v_permlane32_swap_b32 v9, v11
  v_add_f32 v8, v8, v10
  v_add_f32 v9, v9, v11
  v_cvt_pk_bf16_f32 v8, v8, v9
  ds_write_b32 v3, v8 offset:0
  s_nop 0
  v_mov_b32_dpp v9, v8 quad_perm:[1,0,3,2] row_mask:0xf bank_mask:0xf
  v_mov_b32 v10, s30
  v_mov_b32 v11, s31
  v_lshlrev_b32 v2, 3, v0
  v_mov_b32 v1, 0
  s_mov_b32 s70, 4000007
L_spin_33:
  ds_read_b32 v4, v1 offset:648
  s_waitcnt lgkmcnt(0)
  v_cmp_gt_u32 vcc, 1, v4
  s_nop 0
  s_cbranch_vccz L_sdone_34
  s_sleep 2
  s_sub_u32 s70, s70, 1
  s_cbranch_scc0 L_spin_33
L_sdone_34:
  v_readfirstlane_b32 s46, v4
  s_mov_b32 exec_lo, 0x55555555
  s_mov_b32 exec_hi, 0x0
  buffer_store_dwordx4 v[8:11], v2, s[32:35], s66 offen offset:1536
  s_mov_b64 exec, -1
  s_cmp_lg_u32 s46, 1
  s_cbranch_scc1 L_slow_35
L_back_36:
L_qdone:
  s_lshl_b32 s69, s3, 3
  v_mov_b32 v4, s69
  v_mov_b32 v6, 1
  s_waitcnt lgkmcnt(0)
  ds_write_b32 v4, v6 offset:384
  v_mov_b32 v1, 0
  s_mov_b32 s70, 4000007
L_spin_37:
  ds_read_b32 v4, v1 offset:648
  s_waitcnt lgkmcnt(0)
  v_cmp_gt_u32 vcc, 1, v4
  s_nop 0
  s_cbranch_vccz L_sdone_38
  s_sleep 2
  s_sub_u32 s70, s70, 1
  s_cbranch_scc0 L_spin_37
L_sdone_38:
  v_readfirstlane_b32 s46, v4
  ds_read_b32 v4, v1 offset:648
  s_waitcnt lgkmcnt(0)
  v_readfirstlane_b32 s46, v4
  s_nop 0
  s_sub_u32 s68, s46, s65
  s_cmp_lg_u32 s68, 2
  s_cbranch_scc1 L_qlazy_39
  s_mov_b32 exec_lo, 0xff00ff
  s_mov_b32 exec_hi, 0xff00ff
  buffer_store_dwordx4 v[80:83], v90, s[24:27], s64 offen offset:0 sc1
  s_mov_b64 exec, -1
  s_mov_b32 s65, 1
L_qlazy_39:
  s_branch L_stats
L_ids:
  s_setprio 3
  s_getreg_b32 s64, hwreg(HW_REG_XCC_ID)
  s_mov_b32 s24, s58
  s_mov_b32 s25, s59
  s_mov_b32 s26, 4194304
  s_mov_b32 s27, 0x20000
  s_add_u32 s32, s58, 4194304
  s_addc_u32 s33, s59, 0
  s_mov_b32 s34, 4194304
  s_mov_b32 s35, 0x20000
  s_lshl3_add_u32 s71, s6, s7
  s_mul_i32 s5, s79, 5
  s_mul_i32 s47, s79, 3
  s_add_u32 s47, s47, 15
  s_cmp_lt_u32 s7, 5
  s_cselect_b32 s5, s5, s47
  s_add_u32 s5, s5, s7
  s_waitcnt lgkmcnt(0)
  s_mul_i32 s30, s28, 0x2c9277b5
  s_add_u32 s30, s30, 0xac564b05
  s_mul_i32 s31, s29, 0x0019660d
  s_add_u32 s31, s31, 0x3c6ef35f
  s_and_b32 s64, s64, 15
  v_mov_b32 v4, s30
  v_mov_b32 v5, s31
  v_mov_b32 v6, s64
  v_mov_b32 v7, s64
  s_lshl_b32 s68, s4, 9
  s_add_u32 s68, s68, 753664
  s_lshr_b32 s65, s2, 3
  s_lshl_b32 s69, s65, 4
  v_mov_b32 v1, s69
  s_mov_b64 exec, 1
  buffer_store_dwordx4 v[4:7], v1, s[32:35], s68 offen
  s_mov_b64 exec, -1
  s_cmp_lg_u32 s65, 31
  s_cbranch_scc1 L_noinit
  v_lshlrev_b32 v12, 8, v0
  s_lshl_b32 s69, s4, 15
  s_add_u32 s69, s69, 1703936
  s_mov_b32 exec_lo, 0x8040201
  s_mov_b32 exec_hi, 0x8040201
  buffer_store_dword v4, v12, s[24:27], s69 offen sc1
  s_mov_b64 exec, -1
L_noinit:
  v_and_b32 v1, 31, v0
  v_lshlrev_b32 v1, 4, v1
  s_mov_b32 s70, 12
  s_mov_b32 s46, 2
L_idpoll:
  s_sleep 16
  buffer_load_dwordx4 v[8:11], v1, s[32:35], s68 offen sc1 nt
  s_waitcnt vmcnt(0)
  v_cmp_ne_u64 vcc, s[30:31], v[8:9]
  s_nop 0
  s_cbranch_vccz L_iddone
  s_sub_u32 s70, s70, 1
  s_cbranch_scc0 L_idpoll
  s_branch L_idset
L_iddone:
  v_cmp_ne_u32 vcc, s64, v10
  s_nop 0
  s_cbranch_vccnz L_idset
  s_mov_b32 s46, 1
L_idset:
  v_mov_b32 v1, 0
  v_mov_b32 v4, s46
  ds_write_b32 v1, v4 offset:648
  s_cmp_lg_u32 s65, 31
  s_cbranch_scc1 L_pf
  s_lshl_b32 s69, s4, 15
  s_add_u32 s69, s69, 1703936
  s_add_u32 s22, s58, s69
  s_addc_u32 s23, s59, 0
  s_waitcnt lgkmcnt(0)
  s_mov_b32 s8, -1
  s_mov_b32 s9, -1
  s_memtime s[12:13]
  s_waitcnt lgkmcnt(0)
  s_load_dword s10, s[22:23], 0
  s_waitcnt lgkmcnt(0)
  s_memtime s[14:15]
  s_waitcnt lgkmcnt(0)
  s_sub_u32 s11, s14, s12
  s_min_u32 s8, s8, s11
  s_waitcnt lgkmcnt(0)
  s_load_dword s10, s[22:23], 8192
  s_waitcnt lgkmcnt(0)
  s_memtime s[12:13]
  s_waitcnt lgkmcnt(0)
  s_sub_u32 s11, s12, s14
  s_min_u32 s9, s9, s11
  s_waitcnt lgkmcnt(0)
  s_load_dword s10, s[22:23], 10496
  s_waitcnt lgkmcnt(0)
  s_memtime s[14:15]
  s_waitcnt lgkmcnt(0)
  s_sub_u32 s11, s14, s12
  s_min_u32 s9, s9, s11
  s_waitcnt lgkmcnt(0)
  s_load_dword s10, s[22:23], 2304
  s_waitcnt lgkmcnt(0)
  s_memtime s[12:13]
  s_waitcnt lgkmcnt(0)
  s_sub_u32 s11, s12, s14
  s_min_u32 s8, s8, s11
  s_waitcnt lgkmcnt(0)
  s_load_dword s10, s[22:23], 4608
  s_waitcnt lgkmcnt(0)
  s_memtime s[14:15]
  s_waitcnt lgkmcnt(0)
  s_sub_u32 s11, s14, s12
  s_min_u32 s8, s8, s11
  s_waitcnt lgkmcnt(0)
  s_load_dword s10, s[22:23], 12800
  s_waitcnt lgkmcnt(0)
  s_memtime s[12:13]
  s_waitcnt lgkmcnt(0)
  s_sub_u32 s11, s12, s14
  s_min_u32 s9, s9, s11
  s_waitcnt lgkmcnt(0)
  s_load_dword s10, s[22:23], 15104
  s_waitcnt lgkmcnt(0)
  s_memtime s[14:15]
  s_waitcnt lgkmcnt(0)
  s_sub_u32 s11, s14, s12
  s_min_u32 s9, s9, s11
  s_waitcnt lgkmcnt(0)
  s_load_dword s10, s[22:23], 6912
  s_waitcnt lgkmcnt(0)
  s_memtime s[12:13]
  s_waitcnt lgkmcnt(0)
  s_sub_u32 s11, s12, s14
  s_min_u32 s8, s8, s11
  s_cmp_gt_u32 s8, s9
  s_cselect_b32 s21, 1, 0
  v_mov_b32 v4, s21
  v_mov_b32 v5, s62
  v_mov_b32 v6, s30
  v_mov_b32 v7, s31
  s_lshl_b32 s69, s4, 4
  s_add_u32 s69, s69, 950272
  s_mov_b64 exec, 1
  buffer_store_dwordx4 v[4:7], v1, s[24:27], s69 offen sc1
  s_mov_b64 exec, -1
L_pf:
  s_cmp_lg_u32 s7, 6
  s_cbranch_scc1 L_nosample
  v_mov_b32 v1, 0
  s_mov_b32 s70, 4000007
L_spin_40:
  ds_read_b64 v[4:5], v1 offset:696
  s_waitcnt lgkmcnt(0)
  v_cmp_gt_u32 vcc, 8, v5
  s_nop 0
  s_cbranch_vccz L_sdone_41
  s_sleep 2
  s_sub_u32 s70, s70, 1
  s_cbranch_scc0 L_spin_40
L_sdone_41:
  v_mov_b32 v5, s31
  v_lshlrev_b32 v6, 9, v0
  s_lshl_b32 s68, s6, 3
  s_add_u32 s68, s68, 958464
  s_mov_b64 exec, 7
  buffer_store_dwordx2 v[4:5], v6, s[24:27], s68 offen sc1
  s_mov_b64 exec, -1
L_nosample:
  v_mov_b32 v1, 0
  s_mov_b32 s70, 4000007
L_spin_42:
  ds_read_b32 v12, v1 offset:692
  s_waitcnt lgkmcnt(0)
  v_cmp_gt_u32 vcc, 8, v12
  s_nop 0
  s_cbranch_vccz L_sdone_43
  s_sleep 4
  s_sub_u32 s70, s70, 1
  s_cbranch_scc0 L_spin_42
L_sdone_43:
  s_add_u32 s60, s58, 958464
  s_addc_u32 s61, s59, 0
  s_mov_b32 s70, 2
L_calpoll:
  s_lshl_b32 s96, s62, 8
  s_sub_u32 s96, 0, s96
  s_mov_b32 s97, 0
  s_load_dwordx16 s[8:23], s[60:61], 0
  s_load_dwordx16 s[80:95], s[60:61], 64
  s_waitcnt lgkmcnt(0)
  s_add_u32 s96, s96, s8
  s_cmp_lg_u32 s9, s31
  s_addc_u32 s97, s97, 0
  s_add_u32 s96, s96, s10
  s_cmp_lg_u32 s11, s31
  s_addc_u32 s97, s97, 0
  s_add_u32 s96, s96, s12
  s_cmp_lg_u32 s13, s31
  s_addc_u32 s97, s97, 0
  s_add_u32 s96, s96, s14
  s_cmp_lg_u32 s15, s31
  s_addc_u32 s97, s97, 0
  s_add_u32 s96, s96, s16
  s_cmp_lg_u32 s17, s31
  s_addc_u32 s97, s97, 0
  s_add_u32 s96, s96, s18
  s_cmp_lg_u32 s19, s31
  s_addc_u32 s97, s97, 0
  s_add_u32 s96, s96, s20
  s_cmp_lg_u32 s21, s31
  s_addc_u32 s97, s97, 0
  s_add_u32 s96, s96, s22
  s_cmp_lg_u32 s23, s31
  s_addc_u32 s97, s97, 0
  s_add_u32 s96, s96, s80
  s_cmp_lg_u32 s81, s31
  s_addc_u32 s97, s97, 0
  s_add_u32 s96, s96, s82
  s_cmp_lg_u32 s83, s31
  s_addc_u32 s97, s97, 0
  s_add_u32 s96, s96, s84
  s_cmp_lg_u32 s85, s31
  s_addc_u32 s97, s97, 0
  s_add_u32 s96, s96, s86
  s_cmp_lg_u32 s87, s31
  s_addc_u32 s97, s97, 0
  s_add_u32 s96, s96, s88
  s_cmp_lg_u32 s89, s31
  s_addc_u32 s97, s97, 0
  s_add_u32 s96, s96, s90
  s_cmp_lg_u32 s91, s31
  s_addc_u32 s97, s97, 0
  s_add_u32 s96, s96, s92
  s_cmp_lg_u32 s93, s31
  s_addc_u32 s97, s97, 0
  s_add_u32 s96, s96, s94
  s_cmp_lg_u32 s95, s31
  s_addc_u32 s97, s97, 0
  s_load_dwordx16 s[8:23], s[60:61], 128
  s_load_dwordx16 s[80:95], s[60:61], 192
  s_waitcnt lgkmcnt(0)
  s_add_u32 s96, s96, s8
  s_cmp_lg_u32 s9, s31
  s_addc_u32 s97, s97, 0
  s_add_u32 s96, s96, s10
  s_cmp_lg_u32 s11, s31
  s_addc_u32 s97, s97, 0
  s_add_u32 s96, s96, s12
  s_cmp_lg_u32 s13, s31
  s_addc_u32 s97, s97, 0
  s_add_u32 s96, s96, s14
  s_cmp_lg_u32 s15, s31
  s_addc_u32 s97, s97, 0
  s_add_u32 s96, s96, s16
  s_cmp_lg_u32 s17, s31
  s_addc_u32 s97, s97, 0
  s_add_u32 s96, s96, s18
  s_cmp_lg_u32 s19, s31
  s_addc_u32 s97, s97, 0
  s_add_u32 s96, s96, s20
  s_cmp_lg_u32 s21, s31
  s_addc_u32 s97, s97, 0
  s_add_u32 s96, s96, s22
  s_cmp_lg_u32 s23, s31
  s_addc_u32 s97, s97, 0
  s_add_u32 s96, s96, s80
  s_cmp_lg_u32 s81, s31
  s_addc_u32 s97, s97, 0
  s_add_u32 s96, s96, s82
  s_cmp_lg_u32 s83, s31
  s_addc_u32 s97, s97, 0
  s_add_u32 s96, s96, s84
  s_cmp_lg_u32 s85, s31
  s_addc_u32 s97, s97, 0
  s_add_u32 s96, s96, s86
  s_cmp_lg_u32 s87, s31
  s_addc_u32 s97, s97, 0
  s_add_u32 s96, s96, s88
  s_cmp_lg_u32 s89, s31
  s_addc_u32 s97, s97, 0
  s_add_u32 s96, s96, s90
  s_cmp_lg_u32 s91, s31
  s_addc_u32 s97, s97, 0
  s_add_u32 s96, s96, s92
  s_cmp_lg_u32 s93, s31
  s_addc_u32 s97, s97, 0
  s_add_u32 s96, s96, s94
  s_cmp_lg_u32 s95, s31
  s_addc_u32 s97, s97, 0
  s_cmp_eq_u32 s97, 0
  s_cbranch_scc1 L_calok
  s_add_u32 s60, s60, 512
  s_addc_u32 s61, s61, 0
  s_sub_u32 s70, s70, 1
  s_cbranch_scc1 L_stats
  s_sleep 20
  s_branch L_calpoll
L_calok:
  s_ashr_i32 s96, s96, 4
  s_mov_b32 s68, 112
  s_cmp_lt_u32 s5, 30
  s_cselect_b32 s68, -208, s68
  s_cmp_lt_u32 s5, 20
  s_cselect_b32 s68, 112, s68
  s_lshl4_add_u32 s68, s62, s68
  s_add_u32 s68, s68, s96
  v_mov_b32 v12, s68
  v_mov_b32 v13, -1
  ds_write_b64 v1, v[12:13] offset:680
L_stats:
  v_and_b32 v1, 7, v0
  v_lshlrev_b32 v1, 4, v1
  s_mov_b32 s70, 4000007
L_spin_44:
  ds_read_b128 v[4:7], v1 offset:512
  s_waitcnt lgkmcnt(0)
  v_cmp_eq_u32 vcc, 0, v7
  s_nop 0
  s_cbranch_vccz L_sdone_45
  s_sleep 4
  s_sub_u32 s70, s70, 1
  s_cbranch_scc0 L_spin_44
L_sdone_45:
  s_cmp_lg_u32 s3, 3
  s_cbranch_scc1 L_nostat
  s_mov_b32 s68, 0x3fb8aa3b
  v_mov_b32 v2, v4
  s_nop 1
  v_max_f32_dpp v2, v2, v2 quad_perm:[1,0,3,2] row_mask:0xf bank_mask:0xf
  s_nop 1
  v_max_f32_dpp v2, v2, v2 quad_perm:[2,3,0,1] row_mask:0xf bank_mask:0xf
  s_nop 1
  v_max_f32_dpp v2, v2, v2 row_half_mirror row_mask:0xf bank_mask:0xf
  v_sub_f32 v4, v4, v2
  v_mul_f32 v4, s68, v4
  v_exp_f32 v4, v4
  s_nop 0
  v_mul_f32 v3, v4, v5
  s_nop 1
  v_add_f32_dpp v3, v3, v3 quad_perm:[1,0,3,2] row_mask:0xf bank_mask:0xf
  s_nop 1
  v_add_f32_dpp v3, v3, v3 quad_perm:[2,3,0,1] row_mask:0xf bank_mask:0xf
  s_nop 1
  v_add_f32_dpp v3, v3, v3 row_half_mirror row_mask:0xf bank_mask:0xf
  s_lshl_b32 s68, s71, 4
  s_add_u32 s68, s68, 720896
  v_mov_b32 v4, s30
  v_mov_b32 v5, s31
  s_mov_b32 exec_lo, 0x1
  s_mov_b32 exec_hi, 0x0
  buffer_store_dwordx4 v[2:5], v1, s[32:35], s68 offen
  s_mov_b64 exec, -1
  s_cmp_lg_u32 s46, 1
  s_cbranch_scc1 L_slow_46
L_back_47:
  s_mov_b32 s68, 950272
  s_mov_b32 s70, 4000007
L_spin_48:
  buffer_load_dwordx4 v[8:11], v1, s[24:27], s68 offen sc1
  s_waitcnt vmcnt(0)
  v_cmp_ne_u64 vcc, s[30:31], v[10:11]
  s_nop 0
  s_cbranch_vccz L_sdone_49
  s_sleep 8
  s_sub_u32 s70, s70, 1
  s_cbranch_scc0 L_spin_48
L_sdone_49:
  v_cmp_ne_u32 vcc, 0, v8
  s_nop 0
  s_and_b32 s67, vcc_lo, 0xff
  s_bitset1_b32 s67, 8
  v_mov_b32 v4, s67
  v_mov_b32 v1, 0
  ds_write_b32 v1, v4 offset:660
L_nostat:
  s_cmp_lt_u32 s5, 20
  s_cbranch_scc0 L_helper_exit
  s_cmp_ge_u32 s5, 10
  s_cselect_b32 s76, 1, 0
  s_mul_i32 s77, s76, 10
  s_sub_u32 s77, s5, s77
  s_lshr_b32 s68, s3, 1
  s_lshl1_add_u32 s78, s76, s68
  v_bfe_u32 v2, v0, 4, 1
  v_lshlrev_b32 v2, 4, v2
  s_lshl_b32 s68, s78, 5
  v_add_u32 v22, s68, v2
  v_lshlrev_b32 v60, 4, v0
  s_lshl2_add_u32 s73, s4, s78
  s_mul_i32 s73, s73, 6144
  s_and_b32 s68, s3, 1
  s_mul_i32 s68, s68, 3072
  s_add_u32 s73, s73, s68
  s_add_u32 s73, s73, 524288
  v_lshlrev_b32 v62, 2, v0
  s_lshl_b32 s68, s3, 8
  v_add_u32 v61, s68, v62
  v_lshrrev_b32 v2, 5, v0
  v_lshlrev_b32 v2, 11, v2
  v_bfe_u32 v3, v0, 2, 3
  v_lshl_add_u32 v2, v3, 4, v2
  v_and_b32 v3, 1, v0
  v_lshl_add_u32 v63, v3, 13, v2
  s_lshr_b32 s75, s77, 1
  s_lshl_b32 s75, s75, 14
  s_and_b32 s68, s77, 1
  s_lshl_b32 s68, s68, 12
  s_add_u32 s75, s75, s68
  s_lshl1_add_u32 s68, s4, s76
  s_lshl_b32 s68, s68, 7
  s_add_u32 s75, s75, s68
  s_add_u32 s75, s75, 786432
  s_mov_b32 s66, 0xff00ff00
  s_mov_b32 s67, s66
  s_mov_b32 s8, 0x33333333
  s_mov_b32 s9, 0x33333333
  v_mov_b32 v6, s30
  v_mov_b32 v7, s31
  v_cndmask_b32 v52, 0, v6, s[66:67]
  v_cndmask_b32 v53, 0, v7, s[66:67]
  v_cndmask_b32 v54, v6, 0, s[66:67]
  v_cndmask_b32 v55, v7, 0, s[66:67]
  v_mov_b32 v50, s30
  v_mov_b32 v51, s31
  v_lshrrev_b32 v24, 4, v0
  v_lshlrev_b32 v24, 10, v24
  v_bfe_u32 v25, v0, 2, 2
  v_lshl_add_u32 v24, v25, 7, v24
  v_and_b32 v25, 3, v0
  v_lshl_add_u32 v24, v25, 3, v24
  s_mul_i32 s69, s3, 12288
  v_add_u32 v24, s69, v24
  s_cmp_lg_u32 s3, 0
  s_cbranch_scc1 L_noc
  s_lshl_b32 s72, s4, 9
  s_add_u32 s72, s72, 720896
  v_and_b32 v1, 31, v0
  v_lshlrev_b32 v1, 4, v1
  s_mov_b32 s16, s32
  s_mov_b32 s17, s33
  s_mov_b32 s18, 4194304
  s_mov_b32 s19, 0x20000
  s_mov_b32 s70, 4000007
L_spin_50:
  s_sleep 24
  buffer_load_dwordx4 v[4:7], v1, s[16:19], s72 offen sc1 nt
  s_waitcnt vmcnt(0)
  v_cmp_ne_u64 vcc, s[30:31], v[6:7]
  s_nop 0
  s_cbranch_vccz L_sdone_51
  s_and_b32 s99, s70, 7
  s_cmp_eq_u32 s46, 1
  s_cselect_b32 s99, 1, s99
  s_cmp_lg_u32 s99, 0
  s_cselect_b32 s16, s32, s24
  s_cselect_b32 s17, s33, s25
  s_sub_u32 s70, s70, 1
  s_cbranch_scc0 L_spin_50
L_sdone_51:
  s_mov_b32 s68, 0x3fb8aa3b
  v_mov_b32 v2, v4
  s_nop 1
  v_max_f32_dpp v2, v2, v2 quad_perm:[1,0,3,2] row_mask:0xf bank_mask:0xf
  s_nop 1
  v_max_f32_dpp v2, v2, v2 quad_perm:[2,3,0,1] row_mask:0xf bank_mask:0xf
  s_nop 1
  v_max_f32_dpp v2, v2, v2 row_half_mirror row_mask:0xf bank_mask:0xf
  v_sub_f32 v4, v4, v2
  v_mul_f32 v4, s68, v4
  v_exp_f32 v4, v4
  s_nop 0
  v_mul_f32 v3, v4, v5
  s_nop 1
  v_add_f32_dpp v3, v3, v3 quad_perm:[1,0,3,2] row_mask:0xf bank_mask:0xf
  s_nop 1
  v_add_f32_dpp v3, v3, v3 quad_perm:[2,3,0,1] row_mask:0xf bank_mask:0xf
  s_nop 1
  v_add_f32_dpp v3, v3, v3 row_half_mirror row_mask:0xf bank_mask:0xf
  v_rcp_f32 v3, v3
  v_lshrrev_b32 v1, 2, v1
  v_mul_f32 v4, v4, v3
  v_mov_b32 v2, 0
  v_mov_b32 v3, 1
  ds_write_b32 v1, v4 offset:768
  ds_write_b32 v2, v3 offset:664
L_noc:
  v_mov_b32 v1, 0
  s_mov_b32 s70, 4000007
L_spin_52:
  ds_read_b32 v4, v1 offset:664
  s_waitcnt lgkmcnt(0)
  v_cmp_gt_u32 vcc, 1, v4
  s_nop 0
  s_cbranch_vccz L_sdone_53
  s_sleep 2
  s_sub_u32 s70, s70, 1
  s_cbranch_scc0 L_spin_52
L_sdone_53:
  ds_read_b128 v[56:59], v22 offset:768
  s_mov_b32 s12, s44
  s_mov_b32 s13, s45
  s_mov_b32 s14, 7864320
  s_mov_b32 s15, 0x20000
  v_lshrrev_b32 v21, 3, v0
  v_mul_u32_u24 v21, 1280, v21
  v_and_b32 v3, 7, v0
  v_lshl_add_u32 v21, v3, 4, v21
  s_lshl1_add_u32 s60, s4, s76
  s_lshl2_add_u32 s60, s60, s3
  s_mul_i32 s60, s60, 122880
  s_lshl_b32 s69, s77, 7
  s_add_u32 s60, s60, s69
  s_mul_i32 s61, s3, 12288
  s_add_u32 s61, s61, 8704
  v_mov_b32 v23, 1
  s_lshl_b32 s68, s3, 2
  v_mov_b32 v25, s68
  v_mov_b32 v1, 0
  s_mov_b32 s70, 4000007
L_spin_54:
  ds_read_b32 v4, v1 offset:660
  s_waitcnt lgkmcnt(0)
  v_cmp_gt_u32 vcc, 1, v4
  s_nop 0
  s_cbranch_vccz L_sdone_55
  s_sleep 4
  s_sub_u32 s70, s70, 1
  s_cbranch_scc0 L_spin_54
L_sdone_55:
  v_readfirstlane_b32 s47, v4
  v_mov_b32 v1, 0
  s_mov_b32 s70, 4000007
L_spin_56:
  ds_read_b32 v4, v1 offset:644
  s_waitcnt lgkmcnt(0)
  v_cmp_gt_u32 vcc, 8, v4
  s_nop 0
  s_cbranch_vccz L_sdone_57
  s_sleep 2
  s_sub_u32 s70, s70, 1
  s_cbranch_scc0 L_spin_56
L_sdone_57:
  s_mov_b32 m0, s61
  s_nop 0
  buffer_load_dwordx4 v21, s[12:15], s60 offen nt lds
  s_add_u32 s60, s60, 10240
  s_add_u32 s61, s61, 1024
  s_mov_b32 m0, s61
  s_nop 0
  buffer_load_dwordx4 v21, s[12:15], s60 offen nt lds
  s_add_u32 s60, s60, 10240
  s_add_u32 s61, s61, 1024
  s_mov_b32 m0, s61
  s_nop 0
  buffer_load_dwordx4 v21, s[12:15], s60 offen nt lds
  s_add_u32 s60, s60, 10240
  s_add_u32 s61, s61, 1024
  s_mov_b32 m0, s61
  s_nop 0
  buffer_load_dwordx4 v21, s[12:15], s60 offen nt lds
  s_add_u32 s60, s60, 10240
  s_add_u32 s61, s61, 1024
  s_mov_b32 m0, s61
  s_nop 0
  buffer_load_dwordx4 v21, s[12:15], s60 offen nt lds
  s_add_u32 s60, s60, 10240
  s_add_u32 s61, s61, 1024
  s_mov_b32 m0, s61
  s_nop 0
  buffer_load_dwordx4 v21, s[12:15], s60 offen nt lds
  s_add_u32 s60, s60, 10240
  s_add_u32 s61, s61, 1024
  s_waitcnt vmcnt(5)
  s_mov_b32 m0, s61
  s_nop 0
  buffer_load_dwordx4 v21, s[12:15], s60 offen nt lds
  s_add_u32 s60, s60, 10240
  s_add_u32 s61, s61, 1024
  s_waitcnt vmcnt(5)
  s_mov_b32 m0, s61
  s_nop 0
  buffer_load_dwordx4 v21, s[12:15], s60 offen nt lds
  s_add_u32 s60, s60, 10240
  s_add_u32 s61, s61, 1024
  s_waitcnt vmcnt(5)
  s_mov_b32 m0, s61
  s_nop 0
  buffer_load_dwordx4 v21, s[12:15], s60 offen nt lds
  s_add_u32 s60, s60, 10240
  s_add_u32 s61, s61, 1024
  s_waitcnt vmcnt(5)
  s_mov_b32 m0, s61
  s_nop 0
  buffer_load_dwordx4 v21, s[12:15], s60 offen nt lds
  s_add_u32 s60, s60, 10240
  s_add_u32 s61, s61, 1024
  s_waitcnt vmcnt(5)
  s_mov_b32 m0, s61
  s_nop 0
  buffer_load_dwordx4 v21, s[12:15], s60 offen nt lds
  s_add_u32 s60, s60, 10240
  s_add_u32 s61, s61, 1024
  s_waitcnt vmcnt(5)
  s_mov_b32 m0, s61
  s_nop 0
  buffer_load_dwordx4 v21, s[12:15], s60 offen nt lds
  s_waitcnt vmcnt(4)
  ds_read_b64_tr_b16 v[64:65], v24 offset:8704
  ds_read_b64_tr_b16 v[66:67], v24 offset:9216
  ds_read_b64_tr_b16 v[68:69], v24 offset:8736
  ds_read_b64_tr_b16 v[70:71], v24 offset:9248
  ds_read_b64_tr_b16 v[72:73], v24 offset:8768
  ds_read_b64_tr_b16 v[74:75], v24 offset:9280
  ds_read_b64_tr_b16 v[76:77], v24 offset:8800
  ds_read_b64_tr_b16 v[78:79], v24 offset:9312
  ds_read_b64_tr_b16 v[80:81], v24 offset:12800
  ds_read_b64_tr_b16 v[82:83], v24 offset:13312
  ds_read_b64_tr_b16 v[84:85], v24 offset:12832
  ds_read_b64_tr_b16 v[86:87], v24 offset:13344
  ds_read_b64_tr_b16 v[88:89], v24 offset:12864
  ds_read_b64_tr_b16 v[90:91], v24 offset:13376
  ds_read_b64_tr_b16 v[92:93], v24 offset:12896
  ds_read_b64_tr_b16 v[94:95], v24 offset:13408
  v_mov_b32 v1, 0
  s_mov_b32 s70, 4000007
L_spin_58:
  ds_read_b32 v4, v1 offset:668
  s_waitcnt lgkmcnt(0)
  v_cmp_gt_u32 vcc, 1, v4
  s_nop 0
  s_cbranch_vccz L_sdone_59
  s_sleep 1
  s_sub_u32 s70, s70, 1
  s_cbranch_scc0 L_spin_58
L_sdone_59:
  s_waitcnt vmcnt(2)
  buffer_load_dwordx4 v[112:115], v60, s[32:35], s73 offen offset:0 sc1
  buffer_load_dwordx4 v[116:119], v60, s[32:35], s73 offen offset:1024 sc1
  buffer_load_dwordx4 v[120:123], v60, s[32:35], s73 offen offset:2048 sc1
  s_waitcnt vmcnt(3)
  ds_read_b64_tr_b16 v[96:97], v24 offset:16896
  ds_read_b64_tr_b16 v[98:99], v24 offset:17408
  ds_read_b64_tr_b16 v[100:101], v24 offset:16928
  ds_read_b64_tr_b16 v[102:103], v24 offset:17440
  ds_read_b64_tr_b16 v[104:105], v24 offset:16960
  ds_read_b64_tr_b16 v[106:107], v24 offset:17472
  ds_read_b64_tr_b16 v[108:109], v24 offset:16992
  ds_read_b64_tr_b16 v[110:111], v24 offset:17504
  s_mov_b32 s16, s32
  s_mov_b32 s17, s33
  s_mov_b32 s18, 4194304
  s_mov_b32 s19, 0x20000
  s_mov_b32 s70, 4000007
  s_branch L_opw
L_spin_60:
  buffer_load_dwordx4 v[112:115], v60, s[16:19], s73 offen offset:0 sc1
  buffer_load_dwordx4 v[116:119], v60, s[16:19], s73 offen offset:1024 sc1
  buffer_load_dwordx4 v[120:123], v60, s[16:19], s73 offen offset:2048 sc1
L_opw:
  s_waitcnt vmcnt(2)
  v_xor_b32 v112, v112, v52
  v_xor_b32 v113, v113, v53
  v_xor_b32 v114, v114, v54
  v_xor_b32 v115, v115, v55
  v_or_b32 v2, v112, v113
  v_or_b32 v3, v114, v115
  v_mfma_f32_16x16x32_bf16 v[32:35], v[112:115], v[64:67], 0
  v_mfma_f32_16x16x32_bf16 v[36:39], v[112:115], v[68:71], 0
  v_mfma_f32_16x16x32_bf16 v[40:43], v[112:115], v[72:75], 0
  v_mfma_f32_16x16x32_bf16 v[44:47], v[112:115], v[76:79], 0
  s_waitcnt vmcnt(1)
  v_xor_b32 v116, v116, v52
  v_xor_b32 v117, v117, v53
  v_xor_b32 v118, v118, v54
  v_xor_b32 v119, v119, v55
  v_or3_b32 v2, v2, v116, v117
  v_or3_b32 v3, v3, v118, v119
  v_mfma_f32_16x16x32_bf16 v[32:35], v[116:119], v[80:83], v[32:35]
  v_mfma_f32_16x16x32_bf16 v[36:39], v[116:119], v[84:87], v[36:39]
  v_mfma_f32_16x16x32_bf16 v[40:43], v[116:119], v[88:91], v[40:43]
  v_mfma_f32_16x16x32_bf16 v[44:47], v[116:119], v[92:95], v[44:47]
  s_waitcnt vmcnt(0) lgkmcnt(0)
  v_xor_b32 v120, v120, v52
  v_xor_b32 v121, v121, v53
  v_xor_b32 v122, v122, v54
  v_xor_b32 v123, v123, v55
  v_or3_b32 v2, v2, v120, v121
  v_or3_b32 v3, v3, v122, v123
  v_mfma_f32_16x16x32_bf16 v[32:35], v[120:123], v[96:99], v[32:35]
  v_cndmask_b32 v2, v3, v2, s[66:67]
  v_mfma_f32_16x16x32_bf16 v[36:39], v[120:123], v[100:103], v[36:39]
  v_cmp_ne_u32 vcc, 0, v2
  v_mfma_f32_16x16x32_bf16 v[40:43], v[120:123], v[104:107], v[40:43]
  v_mfma_f32_16x16x32_bf16 v[44:47], v[120:123], v[108:111], v[44:47]
  s_nop 0
  s_cbranch_vccz L_sdone_61
  s_and_b32 s99, s70, 7
  s_cmp_eq_u32 s46, 1
  s_cselect_b32 s99, 1, s99
  s_cmp_lg_u32 s99, 0
  s_cselect_b32 s16, s32, s24
  s_cselect_b32 s17, s33, s25
  s_sub_u32 s70, s70, 1
  s_cbranch_scc0 L_spin_60
L_sdone_61:
  s_nop 0
  v_mul_f32 v4, v32, v56
  v_fmac_f32 v4, v33, v57
  v_fmac_f32 v4, v34, v58
  v_fmac_f32 v4, v35, v59
  v_mul_f32 v5, v36, v56
  v_fmac_f32 v5, v37, v57
  v_fmac_f32 v5, v38, v58
  v_fmac_f32 v5, v39, v59
  v_mul_f32 v6, v40, v56
  v_fmac_f32 v6, v41, v57
  v_fmac_f32 v6, v42, v58
  v_fmac_f32 v6, v43, v59
  v_mul_f32 v7, v44, v56
  v_fmac_f32 v7, v45, v57
  v_fmac_f32 v7, v46, v58
  v_fmac_f32 v7, v47, v59
  v_permlane32_swap_b32 v4, v6
  s_nop 0
  v_permlane32_swap_b32 v5, v7
  v_add_f32 v4, v4, v6
  v_add_f32 v5, v5, v7
  s_nop 1
  v_permlane16_swap_b32 v4, v5
  v_add_f32 v4, v4, v5
  ds_write_b32 v61, v4 offset:7168
  s_cmp_lg_u32 s3, 0
  s_waitcnt lgkmcnt(0)
  s_barrier
  s_cbranch_scc1 L_post_wo
  ds_read_b32 v5, v62 offset:7424
  ds_read_b32 v6, v62 offset:7680
  ds_read_b32 v7, v62 offset:7936
  s_waitcnt lgkmcnt(0)
  v_add_f32 v4, v4, v5
  v_add_f32 v6, v6, v7
  v_add_f32 v4, v4, v6
  s_nop 1
  v_mov_b32_dpp v5, v4 quad_perm:[1,0,3,2] row_mask:0xf bank_mask:0xf
  v_cvt_pk_bf16_f32 v4, v4, v5
  s_nop 1
  v_mov_b32_dpp v48, v4 quad_perm:[0,0,0,0] row_mask:0xf bank_mask:0xf
  v_mov_b32_dpp v49, v4 quad_perm:[2,2,2,2] row_mask:0xf bank_mask:0xf
  s_mov_b64 exec, s[8:9]
  buffer_store_dwordx4 v[48:51], v63, s[24:27], s75 offen sc1
  s_barrier
  s_endpgm
L_helper_exit:
  s_endpgm
L_f1:
  s_mov_b32 s12, s48
  s_mov_b32 s13, s49
  s_mov_b32 s14, 1966080
  s_mov_b32 s15, 0x20000
  s_mov_b32 s16, s50
  s_mov_b32 s17, s51
  s_mov_b32 s18, 1966080
  s_mov_b32 s19, 0x20000
  s_sub_u32 s74, s5, 20
  v_lshrrev_b32 v3, 4, v0
  v_and_b32 v2, 7, v0
  v_lshrrev_b32 v62, 3, v0
  v_mul_u32_u24 v62, 3072, v62
  v_lshl_add_u32 v62, v2, 4, v62
  s_lshl3_add_u32 s61, s74, s73
  s_mul_i32 s61, s61, 24576
  s_mul_i32 s68, s4, 384
  s_add_u32 s61, s61, s68
  s_add_u32 s62, s61, 128
  s_add_u32 s63, s61, 256
  s_lshl_b32 s79, s73, 10
  s_add_u32 s79, s79, 8704
  v_mov_b32 v57, 0
  v_mov_b32 v6, s30
  v_mov_b32 v7, s31
  v_mov_b32 v1, 0
  s_mov_b32 s70, 4000007
L_spin_62:
  ds_read_b32 v4, v1 offset:668
  s_waitcnt lgkmcnt(0)
  v_cmp_gt_u32 vcc, 1, v4
  s_nop 0
  s_cbranch_vccz L_sdone_63
  s_sleep 1
  s_sub_u32 s70, s70, 1
  s_cbranch_scc0 L_spin_62
L_sdone_63:
  s_add_u32 m0, s79, 0
  s_nop 0
  buffer_load_dwordx4 v62, s[12:15], s61 offen nt lds
  s_add_u32 m0, s79, 24576
  s_nop 0
  buffer_load_dwordx4 v62, s[16:19], s61 offen nt lds
  s_add_u32 m0, s79, 8192
  s_nop 0
  buffer_load_dwordx4 v62, s[12:15], s62 offen nt lds
  s_add_u32 m0, s79, 32768
  s_nop 0
  buffer_load_dwordx4 v62, s[16:19], s62 offen nt lds
  s_add_u32 m0, s79, 16384
  s_nop 0
  buffer_load_dwordx4 v62, s[12:15], s63 offen nt lds
  s_add_u32 m0, s79, 40960
  s_nop 0
  buffer_load_dwordx4 v62, s[16:19], s63 offen nt lds
  s_setprio 3
  s_cmp_gt_u32 s73, 1
  s_cbranch_scc1 L_f1m
  v_mov_b32 v1, 0
  s_mov_b32 s70, 4000007
L_spin_64:
  ds_read_b32 v4, v1 offset:660
  s_waitcnt lgkmcnt(0)
  v_cmp_gt_u32 vcc, 1, v4
  s_nop 0
  s_cbranch_vccz L_sdone_65
  s_sleep 1
  s_sub_u32 s70, s70, 1
  s_cbranch_scc0 L_spin_64
L_sdone_65:
  v_readfirstlane_b32 s47, v4
  s_lshl1_add_u32 s74, s74, s73
  v_lshl_add_u32 v61, v2, 2, v3
  v_lshlrev_b32 v61, 1, v61
  s_lshl_b32 s68, s74, 6
  v_add_u32 v61, s68, v61
  global_load_ushort v56, v61, s[36:37]
  v_lshlrev_b32 v54, 5, v3
  v_lshl_add_u32 v54, v2, 2, v54
  v_lshlrev_b32 v55, 4, v0
  s_lshl_b32 s72, s4, 9
  s_lshl4_add_u32 s72, s74, s72
  s_add_u32 s72, s72, 2752512
  s_mul_i32 s75, s4, 20
  s_add_u32 s75, s75, s74
  s_lshl_b32 s75, s75, 7
  s_add_u32 s75, s75, 2768896
  s_mov_b64 exec, 1
  buffer_load_dword v104, v54, s[32:35], s75 offen sc1
  buffer_load_dword v105, v55, s[32:35], s72 offen sc1
  s_mov_b64 exec, -1
  s_lshr_b32 s60, s74, 2
  s_lshl_b32 s60, s60, 14
  s_and_b32 s68, s74, 3
  s_lshl_b32 s68, s68, 11
  s_add_u32 s60, s60, s68
  s_lshr_b32 s68, s47, s4
  s_and_b32 s68, s68, 1
  s_lshl_b32 s68, s68, 13
  s_add_u32 s60, s60, s68
  s_add_u32 s60, s60, 786432
  v_lshlrev_b32 v51, 4, v3
  v_lshl_add_u32 v51, v2, 1, v51
  v_and_b32 v4, 1, v0
  v_mul_u32_u24 v4, 126, v4
  v_add_u32 v51, v51, v4
  s_lshl_b32 s68, s73, 6
  v_add_u32 v51, s68, v51
  s_mov_b32 s77, 0x3f80
  s_mov_b32 s71, 0x3f800000
  v_mov_b32 v14, s30
  v_mov_b32 v15, s31
  v_mov_b32 v8, 0
  v_mov_b32 v9, 0
  v_mov_b32 v10, 0
  v_mov_b32 v11, 0
  v_not_b32 v98, s30
  v_not_b32 v102, s30
  s_waitcnt vmcnt(2)
  s_barrier
  v_lshlrev_b32 v56, 16, v56
  s_mov_b32 s70, 4000007
  s_mov_b64 s[20:21], -1
  s_mov_b64 s[22:23], -1
L_ypoll:
  s_mov_b64 exec, s[20:21]
  buffer_load_dwordx4 v[96:99], v55, s[24:27], s60 offen sc1
  s_mov_b64 exec, s[22:23]
  buffer_load_dwordx4 v[100:103], v55, s[24:27], s60 offen offset:1024 sc1
  s_mov_b64 exec, -1
  v_cmp_ne_u64 s[20:21], s[30:31], v[98:99]
  v_cmp_ne_u64 s[22:23], s[30:31], v[102:103]
  s_nop 0
  s_or_b64 vcc, s[20:21], s[22:23]
  s_cbranch_scc0 L_yok
  v_cmp_ne_u64 s[20:21], s[30:31], v[98:99]
  v_cmp_ne_u64 s[22:23], s[30:31], v[102:103]
  s_nop 0
  s_or_b64 vcc, s[20:21], s[22:23]
  s_cbranch_scc0 L_yok
  v_cmp_ne_u64 s[20:21], s[30:31], v[98:99]
  v_cmp_ne_u64 s[22:23], s[30:31], v[102:103]
  s_nop 0
  s_or_b64 vcc, s[20:21], s[22:23]
  s_cbranch_scc0 L_yok
  v_cmp_ne_u64 s[20:21], s[30:31], v[98:99]
  v_cmp_ne_u64 s[22:23], s[30:31], v[102:103]
  s_nop 0
  s_or_b64 vcc, s[20:21], s[22:23]
  s_cbranch_scc0 L_yok
  v_cmp_ne_u64 s[20:21], s[30:31], v[98:99]
  v_cmp_ne_u64 s[22:23], s[30:31], v[102:103]
  s_nop 0
  s_or_b64 vcc, s[20:21], s[22:23]
  s_cbranch_scc0 L_yok
  v_cmp_ne_u64 s[20:21], s[30:31], v[98:99]
  v_cmp_ne_u64 s[22:23], s[30:31], v[102:103]
  s_nop 0
  s_or_b64 vcc, s[20:21], s[22:23]
  s_cbranch_scc0 L_yok
  s_waitcnt vmcnt(16)
  s_sub_u32 s70, s70, 1
  s_cbranch_scc0 L_ypoll
L_yok:
  v_dot2c_f32_bf16 v8, s77, v96
  v_dot2c_f32_bf16 v10, s77, v97
  v_dot2c_f32_bf16 v9, s71, v96
  v_dot2c_f32_bf16 v11, s71, v97
  v_dot2c_f32_bf16 v8, s77, v100
  v_dot2c_f32_bf16 v10, s77, v101
  v_dot2c_f32_bf16 v9, s71, v100
  v_dot2c_f32_bf16 v11, s71, v101
  s_nop 0
  v_permlane32_swap_b32 v8, v10
  s_nop 0
  v_permlane32_swap_b32 v9, v11
  v_add_f32 v8, v8, v10
  v_add_f32 v9, v9, v11
  s_nop 1
  v_permlane16_swap_b32 v8, v9
  v_add_f32 v8, v8, v9
  s_nop 1
  v_add_f32_dpp v8, v8, v8 row_ror:8 row_mask:0xf bank_mask:0xf
  v_cvt_pk_bf16_f32 v8, v57, v8
  v_add_f32 v12, v8, v56
  s_nop 1
  v_mov_b32_dpp v13, v12 quad_perm:[1,0,3,2] row_mask:0xf bank_mask:0xf
  v_cvt_pk_bf16_f32 v12, v12, v13
  ds_write_b32 v51, v12 offset:7168
  v_lshlrev_b32 v4, 16, v12
  v_mul_f32 v5, v4, v4
  s_nop 0
  v_add_f32_dpp v4, v4, v4 quad_perm:[1,0,3,2] row_mask:0xf bank_mask:0xf
  v_add_f32_dpp v5, v5, v5 quad_perm:[1,0,3,2] row_mask:0xf bank_mask:0xf
  s_nop 0
  v_add_f32_dpp v4, v4, v4 quad_perm:[2,3,0,1] row_mask:0xf bank_mask:0xf
  v_add_f32_dpp v5, v5, v5 quad_perm:[2,3,0,1] row_mask:0xf bank_mask:0xf
  s_nop 0
  v_add_f32_dpp v4, v4, v4 row_half_mirror row_mask:0xf bank_mask:0xf
  v_add_f32_dpp v5, v5, v5 row_half_mirror row_mask:0xf bank_mask:0xf
  s_waitcnt lgkmcnt(0)
  s_barrier
  v_mov_b32_dpp v13, v12 quad_perm:[2,3,2,3] row_mask:0xf bank_mask:0xf
  v_mov_b32 v8, v4
  v_mov_b32 v9, v5
  s_nop 0
  v_permlane16_swap_b32 v4, v8
  v_permlane16_swap_b32 v5, v9
  v_add_f32 v4, v4, v8
  v_add_f32 v5, v5, v9
  v_mov_b32 v8, v4
  v_mov_b32 v9, v5
  s_nop 0
  v_permlane32_swap_b32 v4, v8
  v_permlane32_swap_b32 v5, v9
  v_add_f32 v4, v4, v8
  v_add_f32 v5, v5, v9
  s_mov_b32 exec_lo, 0x1
  s_mov_b32 exec_hi, 0x0
  buffer_store_dwordx4 v[4:7], v55, s[32:35], s72 offen
  s_mov_b32 exec_lo, 0x110011
  s_mov_b32 exec_hi, 0x110011
  buffer_store_dwordx4 v[12:15], v54, s[32:35], s75 offen
  s_mov_b64 exec, -1
  s_cmp_lg_u32 s46, 1
  s_cbranch_scc1 L_slow_66
L_back_67:
  s_endpgm
L_f1m:
  s_sub_u32 s68, s73, 2
  s_lshr_b32 s78, s68, 1
  s_and_b32 s69, s73, 1
  v_lshlrev_b32 v58, 7, v3
  v_bfe_u32 v4, v0, 2, 2
  v_lshl_add_u32 v58, v4, 9, v58
  v_and_b32 v4, 3, v0
  v_lshl_add_u32 v58, v4, 3, v58
  s_lshl_b32 s75, s78, 13
  s_lshl_b32 s68, s69, 6
  s_add_u32 s75, s75, s68
  v_add_u32 v58, s75, v58
  v_lshlrev_b32 v52, 4, v3
  v_and_b32 v59, 1, v3
  v_cmp_eq_u32 s[62:63], 1, v59
  v_mul_u32_u24 v59, 3072, v59
  v_bfe_u32 v4, v0, 3, 1
  v_lshl_add_u32 v59, v4, 9, v59
  v_lshl_add_u32 v59, v2, 4, v59
  s_mul_i32 s76, s4, 3
  s_add_u32 s76, s76, s78
  s_lshl1_add_u32 s76, s76, s69
  s_mul_i32 s76, s76, 6144
  s_lshr_b32 s68, s74, 2
  s_lshl_b32 s68, s68, 10
  s_add_u32 s76, s76, s68
  s_and_b32 s68, s74, 3
  s_lshl_b32 s68, s68, 7
  s_add_u32 s76, s76, s68
  s_add_u32 s77, s76, 3145728
  s_add_u32 s76, s76, 2228224
  v_mov_b32 v8, 0x3f803f80
  v_mov_b32 v9, 0x3f803f80
  v_mov_b32 v10, 0x3f803f80
  v_mov_b32 v11, 0x3f803f80
  v_mov_b32 v34, s30
  v_mov_b32 v35, s31
  s_waitcnt vmcnt(0)
  s_barrier
  ds_read_b64_tr_b16 v[64:65], v58 offset:8704
  ds_read_b64_tr_b16 v[66:67], v58 offset:10752
  ds_read_b64_tr_b16 v[68:69], v58 offset:8736
  ds_read_b64_tr_b16 v[70:71], v58 offset:10784
  ds_read_b64_tr_b16 v[72:73], v58 offset:33280
  ds_read_b64_tr_b16 v[74:75], v58 offset:35328
  ds_read_b64_tr_b16 v[76:77], v58 offset:33312
  ds_read_b64_tr_b16 v[78:79], v58 offset:35360
  ds_read_b64_tr_b16 v[80:81], v58 offset:12800
  ds_read_b64_tr_b16 v[82:83], v58 offset:14848
  ds_read_b64_tr_b16 v[84:85], v58 offset:12832
  ds_read_b64_tr_b16 v[86:87], v58 offset:14880
  ds_read_b64_tr_b16 v[88:89], v58 offset:37376
  ds_read_b64_tr_b16 v[90:91], v58 offset:39424
  ds_read_b64_tr_b16 v[92:93], v58 offset:37408
  ds_read_b64_tr_b16 v[94:95], v58 offset:39456
  s_waitcnt lgkmcnt(0)
  v_mfma_f32_16x16x32_bf16 v[16:19], v[8:11], v[64:67], 0
  v_mfma_f32_16x16x32_bf16 v[20:23], v[8:11], v[68:71], 0
  v_mfma_f32_16x16x32_bf16 v[24:27], v[8:11], v[72:75], 0
  v_mfma_f32_16x16x32_bf16 v[28:31], v[8:11], v[76:79], 0
  v_mfma_f32_16x16x32_bf16 v[16:19], v[8:11], v[80:83], v[16:19]
  v_mfma_f32_16x16x32_bf16 v[20:23], v[8:11], v[84:87], v[20:23]
  v_mfma_f32_16x16x32_bf16 v[24:27], v[8:11], v[88:91], v[24:27]
  v_mfma_f32_16x16x32_bf16 v[28:31], v[8:11], v[92:95], v[28:31]
  s_nop 5
  v_cndmask_b32 v32, v16, v20, s[62:63]
  s_nop 0
  v_cndmask_b32 v33, v24, v28, s[62:63]
  s_mov_b32 exec_lo, 0xffffffff
  s_mov_b32 exec_hi, 0x0
  buffer_store_dwordx4 v[32:35], v59, s[32:35], s77 offen
  s_mov_b64 exec, -1
  s_cmp_lg_u32 s46, 1
  s_cbranch_scc1 L_slow_68
L_back_69:
  s_barrier
  ds_read_b128 v[8:11], v52 offset:7168
  ds_read_b128 v[12:15], v52 offset:7232
  s_waitcnt lgkmcnt(1)
  v_mfma_f32_16x16x32_bf16 v[16:19], v[8:11], v[64:67], 0
  v_mfma_f32_16x16x32_bf16 v[20:23], v[8:11], v[68:71], 0
  v_mfma_f32_16x16x32_bf16 v[24:27], v[8:11], v[72:75], 0
  v_mfma_f32_16x16x32_bf16 v[28:31], v[8:11], v[76:79], 0
  s_waitcnt lgkmcnt(0)
  v_mfma_f32_16x16x32_bf16 v[16:19], v[12:15], v[80:83], v[16:19]
  v_mfma_f32_16x16x32_bf16 v[20:23], v[12:15], v[84:87], v[20:23]
  v_mfma_f32_16x16x32_bf16 v[24:27], v[12:15], v[88:91], v[24:27]
  v_mfma_f32_16x16x32_bf16 v[28:31], v[12:15], v[92:95], v[28:31]
  s_nop 5
  v_cndmask_b32 v4, v16, v20, s[62:63]
  s_nop 0
  v_cndmask_b32 v5, v24, v28, s[62:63]
  s_mov_b32 exec_lo, 0xffffffff
  s_mov_b32 exec_hi, 0x0
  buffer_store_dwordx4 v[4:7], v59, s[32:35], s76 offen
  s_mov_b64 exec, -1
  s_cmp_lg_u32 s46, 1
  s_cbranch_scc1 L_slow_70
L_back_71:
  s_endpgm
L_post_wo:
  s_cmp_gt_u32 s5, 11
  s_cbranch_scc1 L_end
  s_cmp_eq_u32 s3, 3
  s_cbranch_scc1 L_end
  v_mov_b32 v57, 0
  s_cmp_eq_u32 s3, 1
  s_cbranch_scc1 L_hid
  s_barrier
  s_and_b32 s68, s4, 1
  s_lshl_b32 s68, s68, 2
  s_sub_u32 s68, 12, s68
  s_cmp_ge_u32 s5, s68
  s_cbranch_scc1 L_end
  s_mul_i32 s72, s4, 5
  s_add_u32 s72, s72, 1
  s_lshr_b32 s72, s72, 1
  s_lshr_b32 s68, s5, 2
  s_add_u32 s72, s72, s68
  s_and_b32 s73, s5, 3
  v_lshrrev_b32 v2, 1, v0
  v_lshlrev_b32 v2, 7, v2
  v_and_b32 v3, 1, v0
  v_lshl_add_u32 v96, v3, 4, v2
  s_lshl_b32 s10, s72, 15
  s_lshr_b32 s68, s47, s4
  s_and_b32 s68, s68, 1
  s_lshl_b32 s68, s68, 13
  s_add_u32 s10, s10, s68
  s_lshl_b32 s68, s73, 5
  s_add_u32 s10, s10, s68
  s_add_u32 s10, s10, 1048576
  s_add_u32 s11, s10, 4096
  s_add_u32 s12, s10, 16384
  v_lshrrev_b32 v4, 4, v0
  v_lshl_add_u32 v97, v3, 2, v4
  v_lshlrev_b32 v97, 1, v97
  v_lshlrev_b32 v99, 5, v4
  s_and_b32 s68, s73, 1
  s_lshl_b32 s68, s68, 5
  v_lshl_add_u32 v98, v3, 4, s68
  s_mul_i32 s13, s4, 20
  s_add_u32 s13, s13, s72
  s_lshl_b32 s13, s13, 7
  s_lshr_b32 s68, s73, 1
  s_lshl4_add_u32 s13, s68, s13
  s_add_u32 s13, s13, 2768896
  s_lshl2_add_u32 s14, s72, s73
  s_lshl_b32 s14, s14, 4
  s_mov_b32 s8, 0x30003
  s_mov_b32 s9, 0x30003
  s_mov_b32 s77, 0x3f80
  s_mov_b32 s71, 0x3f800000
  v_mov_b32 v8, 0
  v_mov_b32 v9, 0
  v_mov_b32 v10, 0
  v_mov_b32 v11, 0
  s_mov_b32 s64, s54
  s_mov_b32 s65, s55
  s_mov_b32 s66, 1280
  s_mov_b32 s67, 0x20000
  s_setprio 0
  v_mov_b32 v1, 0
  s_mov_b32 s70, 4000007
L_spin_72:
  ds_read_b32 v4, v1 offset:736
  s_waitcnt lgkmcnt(0)
  v_cmp_gt_u32 vcc, 1, v4
  s_nop 0
  s_cbranch_vccz L_sdone_73
  s_sub_u32 s70, s70, 1
  s_cbranch_scc0 L_spin_72
L_sdone_73:
  s_sleep 16
  s_mov_b32 s16, s32
  s_mov_b32 s17, s33
  s_mov_b32 s18, 4194304
  s_mov_b32 s19, 0x20000
  s_mov_b32 s70, 4000007
L_spin_74:
  buffer_load_dwordx4 v[4:7], v99, s[16:19], s13 offen sc1
  buffer_load_dwordx4 v[16:19], v96, s[24:27], s10 offen sc1
  buffer_load_dwordx4 v[20:23], v96, s[24:27], s11 offen sc1
  buffer_load_dwordx4 v[24:27], v96, s[24:27], s12 offen sc1
  s_waitcnt vmcnt(0)
  v_cmp_ne_u64 vcc, s[30:31], v[6:7]
  v_cmp_ne_u64 s[20:21], s[30:31], v[18:19]
  v_cmp_ne_u64 s[22:23], s[30:31], v[22:23]
  s_or_b64 vcc, vcc, s[20:21]
  v_cmp_ne_u64 s[20:21], s[30:31], v[26:27]
  s_or_b64 vcc, vcc, s[22:23]
  s_or_b64 vcc, vcc, s[20:21]
  s_nop 0
  s_cbranch_vccz L_sdone_75
  s_and_b32 s99, s70, 7
  s_cmp_eq_u32 s46, 1
  s_cselect_b32 s99, 1, s99
  s_cmp_lg_u32 s99, 0
  s_cselect_b32 s16, s32, s24
  s_cselect_b32 s17, s33, s25
  s_sub_u32 s70, s70, 1
  s_cbranch_scc0 L_spin_74
L_sdone_75:
L_finc:
  v_dot2c_f32_bf16 v8, s77, v16
  v_dot2c_f32_bf16 v10, s77, v17
  v_dot2c_f32_bf16 v9, s71, v16
  v_dot2c_f32_bf16 v11, s71, v17
  v_dot2c_f32_bf16 v8, s77, v20
  v_dot2c_f32_bf16 v10, s77, v21
  v_dot2c_f32_bf16 v9, s71, v20
  v_dot2c_f32_bf16 v11, s71, v21
  v_dot2c_f32_bf16 v8, s77, v24
  v_dot2c_f32_bf16 v10, s77, v25
  v_dot2c_f32_bf16 v9, s71, v24
  v_dot2c_f32_bf16 v11, s71, v25
  v_lshrrev_b64 v[58:59], v98, v[4:5]
  v_permlane32_swap_b32 v8, v10
  s_nop 0
  v_permlane32_swap_b32 v9, v11
  v_add_f32 v8, v8, v10
  v_add_f32 v9, v9, v11
  v_lshlrev_b32 v58, 16, v58
  s_nop 0
  v_permlane16_swap_b32 v8, v9
  v_add_f32 v8, v8, v9
  s_nop 1
  v_add_f32_dpp v8, v8, v8 row_ror:8 row_mask:0xf bank_mask:0xf
  s_nop 1
  v_add_f32_dpp v8, v8, v8 row_ror:4 row_mask:0xf bank_mask:0xf
  s_nop 1
  v_add_f32_dpp v8, v8, v8 quad_perm:[2,3,0,1] row_mask:0xf bank_mask:0xf
  v_cvt_pk_bf16_f32 v8, v57, v8
  v_add_f32 v8, v8, v58
  v_cvt_pk_bf16_f32 v8, v8, v8
  s_mov_b64 exec, s[8:9]
  buffer_store_short v8, v97, s[64:67], s14 offen
  s_cmp_lg_u32 s14, 0
  s_cbranch_scc1 L_fin_exit
  s_mov_b64 exec, 1
  v_mov_b32 v4, s30
  v_mov_b32 v5, s31
  s_mov_b32 s68, 917504
  buffer_store_dwordx2 v[4:5], v57, s[24:27], s68 offen
L_fin_exit:
  s_endpgm
L_hid:
  s_mul_i32 s72, s4, 12
  s_add_u32 s72, s72, s5
  v_lshrrev_b32 v4, 5, v0
  v_and_b32 v2, 7, v0
  v_lshl_add_u32 v62, v4, 3, v2
  v_lshlrev_b32 v62, 1, v62
  v_lshlrev_b32 v63, 2, v2
  v_lshlrev_b32 v60, 4, v0
  v_and_b32 v3, 31, v0
  v_lshlrev_b32 v61, 4, v3
  s_lshl_b32 s65, s4, 9
  s_add_u32 s65, s65, 2752512
  s_mul_i32 s60, s72, 3072
  s_add_u32 s62, s60, 3145728
  s_add_u32 s60, s60, 2228224
  s_mov_b32 s8, 0xfffff
  s_mov_b32 s9, 0xfffff
  s_mov_b32 s10, 0xffff
  s_mov_b32 s11, 0xffff
  v_mov_b32 v59, 1
  v_mov_b32 v24, 0
  v_mov_b32 v25, 0
  v_mov_b32 v26, s30
  v_mov_b32 v27, s31
  v_mov_b32 v136, 0
  v_mov_b32 v137, 0
  v_mov_b32 v138, s30
  v_mov_b32 v139, s31
  v_mov_b32 v140, 0
  v_mov_b32 v141, 0
  v_mov_b32 v142, s30
  v_mov_b32 v143, s31
  v_not_b32 v18, s30
  v_not_b32 v22, s30
  v_not_b32 v130, s30
  v_not_b32 v134, s30
  s_mov_b64 exec, s[10:11]
  v_not_b32 v26, s30
  v_not_b32 v138, s30
  s_mov_b64 exec, s[8:9]
  v_not_b32 v142, s30
  s_mov_b64 exec, -1
  s_barrier
  v_cmp_ne_u64 vcc, s[30:31], v[18:19]
  v_cmp_ne_u64 s[20:21], s[30:31], v[22:23]
  v_cmp_ne_u64 s[22:23], s[30:31], v[26:27]
  s_or_b64 vcc, vcc, s[20:21]
  s_or_b64 vcc, vcc, s[22:23]
  s_nop 0
  s_cbranch_vccz L_pok_77
  s_cmp_lg_u32 s46, 1
  s_cbranch_scc1 L_pslow_76
  s_mov_b32 s70, 4000007
L_fp_78:
  buffer_load_dwordx4 v[16:19], v60, s[32:35], s62 offen sc1
  buffer_load_dwordx4 v[20:23], v60, s[32:35], s62 offen offset:1024 sc1
  s_mov_b64 exec, s[10:11]
  buffer_load_dwordx4 v[24:27], v60, s[32:35], s62 offen offset:2048 sc1
  s_mov_b64 exec, -1
  s_mov_b64 exec, s[8:9]
  buffer_load_dwordx4 v[140:143], v61, s[32:35], s65 offen sc1
  s_mov_b64 exec, -1
  buffer_load_dwordx4 v[128:131], v60, s[32:35], s60 offen sc1
  buffer_load_dwordx4 v[132:135], v60, s[32:35], s60 offen offset:1024 sc1
  s_mov_b64 exec, s[10:11]
  buffer_load_dwordx4 v[136:139], v60, s[32:35], s60 offen offset:2048 sc1
  s_mov_b64 exec, -1
  v_cmp_ne_u64 vcc, s[30:31], v[18:19]
  v_cmp_ne_u64 s[20:21], s[30:31], v[22:23]
  v_cmp_ne_u64 s[22:23], s[30:31], v[26:27]
  s_or_b64 vcc, vcc, s[20:21]
  s_or_b64 vcc, vcc, s[22:23]
  s_nop 0
  s_cbranch_vccz L_pok_77
  v_cmp_ne_u64 vcc, s[30:31], v[18:19]
  v_cmp_ne_u64 s[20:21], s[30:31], v[22:23]
  v_cmp_ne_u64 s[22:23], s[30:31], v[26:27]
  s_or_b64 vcc, vcc, s[20:21]
  s_or_b64 vcc, vcc, s[22:23]
  s_nop 0
  s_cbranch_vccz L_pok_77
  v_cmp_ne_u64 vcc, s[30:31], v[18:19]
  v_cmp_ne_u64 s[20:21], s[30:31], v[22:23]
  v_cmp_ne_u64 s[22:23], s[30:31], v[26:27]
  s_or_b64 vcc, vcc, s[20:21]
  s_or_b64 vcc, vcc, s[22:23]
  s_nop 0
  s_cbranch_vccz L_pok_77
  v_cmp_ne_u64 vcc, s[30:31], v[18:19]
  v_cmp_ne_u64 s[20:21], s[30:31], v[22:23]
  v_cmp_ne_u64 s[22:23], s[30:31], v[26:27]
  s_or_b64 vcc, vcc, s[20:21]
  s_or_b64 vcc, vcc, s[22:23]
  s_nop 0
  s_cbranch_vccz L_pok_77
  v_cmp_ne_u64 vcc, s[30:31], v[18:19]
  v_cmp_ne_u64 s[20:21], s[30:31], v[22:23]
  v_cmp_ne_u64 s[22:23], s[30:31], v[26:27]
  s_or_b64 vcc, vcc, s[20:21]
  s_or_b64 vcc, vcc, s[22:23]
  s_nop 0
  s_cbranch_vccz L_pok_77
  v_cmp_ne_u64 vcc, s[30:31], v[18:19]
  v_cmp_ne_u64 s[20:21], s[30:31], v[22:23]
  v_cmp_ne_u64 s[22:23], s[30:31], v[26:27]
  s_or_b64 vcc, vcc, s[20:21]
  s_or_b64 vcc, vcc, s[22:23]
  s_nop 0
  s_cbranch_vccz L_pok_77
  v_cmp_ne_u64 vcc, s[30:31], v[18:19]
  v_cmp_ne_u64 s[20:21], s[30:31], v[22:23]
  v_cmp_ne_u64 s[22:23], s[30:31], v[26:27]
  s_or_b64 vcc, vcc, s[20:21]
  s_or_b64 vcc, vcc, s[22:23]
  s_nop 0
  s_cbranch_vccz L_pok_77
  v_cmp_ne_u64 vcc, s[30:31], v[18:19]
  v_cmp_ne_u64 s[20:21], s[30:31], v[22:23]
  v_cmp_ne_u64 s[22:23], s[30:31], v[26:27]
  s_or_b64 vcc, vcc, s[20:21]
  s_or_b64 vcc, vcc, s[22:23]
  s_nop 0
  s_cbranch_vccz L_pok_77
  s_waitcnt vmcnt(14)
  s_sub_u32 s70, s70, 1
  s_cbranch_scc0 L_fp_78
L_pok_77:
  v_pk_add_f32 v[40:41], v[16:17], v[20:21]
  v_pk_add_f32 v[40:41], v[40:41], v[24:25]
  s_nop 1
  v_add_f32_dpp v40, v40, v40 row_ror:8 row_mask:0xf bank_mask:0xf
  v_add_f32_dpp v41, v41, v41 row_ror:8 row_mask:0xf bank_mask:0xf
  v_mov_b32 v42, v40
  v_mov_b32 v43, v41
  s_nop 0
  v_permlane16_swap_b32 v40, v42
  v_permlane16_swap_b32 v41, v43
  v_add_f32 v40, v40, v42
  v_add_f32 v41, v41, v43
  v_cmp_ne_u64 vcc, s[30:31], v[142:143]
  s_nop 0
  s_cbranch_vccz L_pok_82
  s_cmp_lg_u32 s46, 1
  s_cbranch_scc1 L_pslow_81
  s_mov_b32 s70, 4000007
L_fp_83:
  s_mov_b64 exec, s[8:9]
  buffer_load_dwordx4 v[140:143], v61, s[32:35], s65 offen sc1
  s_mov_b64 exec, -1
  v_cmp_ne_u64 vcc, s[30:31], v[142:143]
  s_nop 0
  s_cbranch_vccz L_pok_82
  v_cmp_ne_u64 vcc, s[30:31], v[142:143]
  s_nop 0
  s_cbranch_vccz L_pok_82
  s_waitcnt vmcnt(12)
  s_sub_u32 s70, s70, 1
  s_cbranch_scc0 L_fp_83
L_pok_82:
  s_cmp_lg_u32 s46, 1
  s_cbranch_scc1 L_nopre
  buffer_load_dwordx4 v[128:131], v60, s[32:35], s60 offen sc1
  buffer_load_dwordx4 v[132:135], v60, s[32:35], s60 offen offset:1024 sc1
  s_mov_b64 exec, s[10:11]
  buffer_load_dwordx4 v[136:139], v60, s[32:35], s60 offen offset:2048 sc1
  s_mov_b64 exec, -1
L_nopre:
  v_add_f32_dpp v36, v140, v140 quad_perm:[1,0,3,2] row_mask:0xf bank_mask:0xf
  v_add_f32_dpp v37, v141, v141 quad_perm:[1,0,3,2] row_mask:0xf bank_mask:0xf
  s_nop 0
  v_add_f32_dpp v36, v36, v36 quad_perm:[2,3,0,1] row_mask:0xf bank_mask:0xf
  v_add_f32_dpp v37, v37, v37 quad_perm:[2,3,0,1] row_mask:0xf bank_mask:0xf
  s_nop 0
  v_add_f32_dpp v36, v36, v36 row_half_mirror row_mask:0xf bank_mask:0xf
  v_add_f32_dpp v37, v37, v37 row_half_mirror row_mask:0xf bank_mask:0xf
  s_nop 0
  v_add_f32_dpp v46, v36, v36 row_mirror row_mask:0xf bank_mask:0xf
  v_add_f32_dpp v47, v37, v37 row_mirror row_mask:0xf bank_mask:0xf
  v_add_f32_dpp v36, v36, v36 row_mirror row_mask:0xf bank_mask:0xf
  v_add_f32_dpp v37, v37, v37 row_mirror row_mask:0xf bank_mask:0xf
  s_nop 0
  v_permlane16_swap_b32 v36, v46
  v_permlane16_swap_b32 v37, v47
  v_pk_add_f32 v[36:37], v[36:37], v[46:47]
  s_cbranch_scc1 L_nopre2
  buffer_load_dwordx4 v[128:131], v60, s[32:35], s60 offen sc1
  buffer_load_dwordx4 v[132:135], v60, s[32:35], s60 offen offset:1024 sc1
  s_mov_b64 exec, s[10:11]
  buffer_load_dwordx4 v[136:139], v60, s[32:35], s60 offen offset:2048 sc1
  s_mov_b64 exec, -1
L_nopre2:
  v_mul_f32 v44, 0x3acccccd, v36
  v_mul_f32 v45, 0x3acccccd, v37
  v_fma_f32 v45, -v44, v44, v45
  v_max_f32 v45, 0, v45
  v_cvt_pk_bf16_f32 v45, v57, v45
  v_cvt_pk_bf16_f32 v44, v57, v44
  v_add_f32 v45, 0x3727c5ac, v45
  v_cvt_pk_bf16_f32 v45, v57, v45
  v_sqrt_f32 v45, v45
  v_mul_f32 v40, v44, v40
  v_cvt_pk_bf16_f32 v45, v57, v45
  v_rcp_f32 v45, v45
  v_mul_f32 v41, v44, v41
  v_cmp_ne_u64 vcc, s[30:31], v[130:131]
  v_cmp_ne_u64 s[20:21], s[30:31], v[134:135]
  v_cmp_ne_u64 s[22:23], s[30:31], v[138:139]
  s_or_b64 vcc, vcc, s[20:21]
  s_or_b64 vcc, vcc, s[22:23]
  s_nop 0
  s_cbranch_vccz L_pok_87
  s_cmp_lg_u32 s46, 1
  s_cbranch_scc1 L_pslow_86
  s_mov_b32 s70, 4000007
L_fp_88:
  buffer_load_dwordx4 v[128:131], v60, s[32:35], s60 offen sc1
  buffer_load_dwordx4 v[132:135], v60, s[32:35], s60 offen offset:1024 sc1
  s_mov_b64 exec, s[10:11]
  buffer_load_dwordx4 v[136:139], v60, s[32:35], s60 offen offset:2048 sc1
  s_mov_b64 exec, -1
  v_cmp_ne_u64 vcc, s[30:31], v[130:131]
  v_cmp_ne_u64 s[20:21], s[30:31], v[134:135]
  v_cmp_ne_u64 s[22:23], s[30:31], v[138:139]
  s_or_b64 vcc, vcc, s[20:21]
  s_or_b64 vcc, vcc, s[22:23]
  s_nop 0
  s_cbranch_vccz L_pok_87
  s_waitcnt vmcnt(12)
  s_sub_u32 s70, s70, 1
  s_cbranch_scc0 L_fp_88
L_pok_87:
L_hidc:
  v_pk_add_f32 v[8:9], v[128:129], v[132:133]
  v_pk_add_f32 v[8:9], v[8:9], v[136:137]
  s_nop 1
  v_add_f32_dpp v10, v8, v8 row_ror:8 row_mask:0xf bank_mask:0xf
  v_add_f32_dpp v11, v9, v9 row_ror:8 row_mask:0xf bank_mask:0xf
  v_add_f32_dpp v8, v8, v8 row_ror:8 row_mask:0xf bank_mask:0xf
  v_add_f32_dpp v9, v9, v9 row_ror:8 row_mask:0xf bank_mask:0xf
  s_nop 0
  v_permlane16_swap_b32 v8, v10
  v_permlane16_swap_b32 v9, v11
  v_add_f32 v8, v8, v10
  v_sub_f32 v8, v8, v40
  v_mul_f32 v8, v8, v45
  v_cvt_pk_bf16_f32 v8, v57, v8
  v_mul_f32 v12, 0xbfb8aa3b, v8
  v_exp_f32 v12, v12
  v_add_f32 v9, v9, v11
  v_add_f32 v12, 1.0, v12
  v_rcp_f32 v12, v12
  v_sub_f32 v9, v9, v41
  v_mul_f32 v9, v9, v45
  v_mul_f32 v8, v8, v12
  v_cvt_pk_bf16_f32 v9, v57, v9
  v_cvt_pk_bf16_f32 v8, v57, v8
  v_mul_f32 v8, v8, v9
  v_cvt_pk_bf16_f32 v8, v8, v8
  ds_write_b16 v62, v8 offset:704
  ds_write_b32 v63, v59 offset:736
  s_endpgm
L_f2:
  s_mov_b32 s8, s52
  s_mov_b32 s9, s53
  s_mov_b32 s10, 1966080
  s_mov_b32 s11, 0x20000
  v_mov_b32 v17, 0
  s_mov_b32 s70, 4000007
L_spin_91:
  ds_read_b32 v16, v17 offset:660
  s_waitcnt lgkmcnt(0)
  v_cmp_gt_u32 vcc, 1, v16
  s_nop 0
  s_cbranch_vccz L_sdone_92
  s_sleep 1
  s_sub_u32 s70, s70, 1
  s_cbranch_scc0 L_spin_91
L_sdone_92:
  v_readfirstlane_b32 s47, v16
  s_mul_i32 s72, s4, 12
  s_add_u32 s72, s72, s5
  v_mov_b32 v57, 0
  s_sub_u32 s68, s3, 7
  s_lshl_b32 s69, s68, 8
  v_lshlrev_b32 v58, 2, v0
  v_add_u32 v58, s69, v58
  v_lshrrev_b32 v2, 4, v0
  v_lshl_add_u32 v2, s68, 2, v2
  v_mul_u32_u24 v3, 52, v2
  v_lshrrev_b32 v3, 8, v3
  v_mul_u32_u24 v4, 5, v3
  v_sub_u32 v4, v2, v4
  v_cmp_lt_u32 vcc, 2, v4
  v_lshlrev_b32 v3, 1, v3
  s_nop 0
  v_addc_co_u32 v3, vcc, 0, v3, vcc
  v_lshrrev_b32 v3, v3, s47
  v_and_b32 v3, 1, v3
  v_lshlrev_b32 v116, 15, v2
  v_lshl_add_u32 v116, v3, 13, v116
  v_bfe_u32 v3, v0, 1, 3
  v_lshl_add_u32 v116, v3, 4, v116
  s_lshr_b32 s79, s72, 6
  s_lshl_b32 s79, s79, 14
  s_and_b32 s68, s72, 63
  s_lshl_b32 s68, s68, 7
  s_add_u32 s79, s79, s68
  s_add_u32 s79, s79, 1048576
  s_mov_b32 s60, 0x05040100
  s_mov_b32 s61, 0x07060302
  s_mul_i32 s62, s72, 20480
  v_lshrrev_b32 v2, 4, v0
  v_mul_u32_u24 v2, 1280, v2
  v_and_b32 v3, 15, v0
  v_lshl_add_u32 v2, v3, 4, v2
  s_add_u32 s62, s62, s69
  s_lshl_b32 s63, s69, 4
  v_lshlrev_b32 v3, 2, v0
  v_add_u32 v3, s63, v3
  s_add_u32 s63, s63, 8704
  s_barrier
  s_add_u32 m0, s63, 0
  s_nop 0
  buffer_load_dwordx4 v2, s[8:11], s62 offen nt lds
  s_add_u32 s62, s62, 5120
  s_add_u32 m0, s63, 1024
  s_nop 0
  buffer_load_dwordx4 v2, s[8:11], s62 offen nt lds
  s_add_u32 s62, s62, 5120
  s_add_u32 m0, s63, 2048
  s_nop 0
  buffer_load_dwordx4 v2, s[8:11], s62 offen nt lds
  s_add_u32 s62, s62, 5120
  s_add_u32 m0, s63, 3072
  s_nop 0
  buffer_load_dwordx4 v2, s[8:11], s62 offen nt lds
  s_add_u32 s62, s62, 5120
  s_barrier
  s_waitcnt vmcnt(0)
  ds_read_b32 v64, v3 offset:8704
  ds_read_b32 v65, v3 offset:8960
  ds_read_b32 v66, v3 offset:9216
  ds_read_b32 v67, v3 offset:9472
  ds_read_b32 v68, v3 offset:9728
  ds_read_b32 v69, v3 offset:9984
  ds_read_b32 v70, v3 offset:10240
  ds_read_b32 v71, v3 offset:10496
  ds_read_b32 v72, v3 offset:10752
  ds_read_b32 v73, v3 offset:11008
  ds_read_b32 v74, v3 offset:11264
  ds_read_b32 v75, v3 offset:11520
  ds_read_b32 v76, v3 offset:11776
  ds_read_b32 v77, v3 offset:12032
  ds_read_b32 v78, v3 offset:12288
  ds_read_b32 v79, v3 offset:12544
  s_waitcnt lgkmcnt(0)
  v_perm_b32 v80, v65, v64, s60
  v_perm_b32 v88, v65, v64, s61
  v_perm_b32 v81, v67, v66, s60
  v_perm_b32 v89, v67, v66, s61
  v_perm_b32 v82, v69, v68, s60
  v_perm_b32 v90, v69, v68, s61
  v_perm_b32 v83, v71, v70, s60
  v_perm_b32 v91, v71, v70, s61
  v_perm_b32 v84, v73, v72, s60
  v_perm_b32 v92, v73, v72, s61
  v_perm_b32 v85, v75, v74, s60
  v_perm_b32 v93, v75, v74, s61
  v_perm_b32 v86, v77, v76, s60
  v_perm_b32 v94, v77, v76, s61
  v_perm_b32 v87, v79, v78, s60
  v_perm_b32 v95, v79, v78, s61
  v_mov_b32 v16, 0
  v_mov_b32 v17, 0
  v_mov_b32 v18, 0
  v_mov_b32 v19, 0
  s_mov_b32 s66, 0x55555555
  s_mov_b32 s67, 0x55555555
  v_mov_b32 v6, s30
  v_mov_b32 v7, s31
  v_and_b32 v9, 15, v0
  v_lshlrev_b32 v9, 2, v9
  v_mov_b32 v8, 0
  s_mov_b32 s64, 0xff00ff00
  s_mov_b32 s65, 0xff00ff00
  s_mov_b32 s70, 32000056
  s_waitcnt lgkmcnt(0)
L_f2poll:
  ds_read_b32 v8, v9 offset:704
  s_waitcnt lgkmcnt(4)
  v_cmp_eq_u32 vcc, 0, v8
  s_sub_u32 s70, s70, 1
  s_cbranch_scc1 L_f2go
  s_and_b64 vcc, vcc, s[64:65]
  s_cbranch_scc1 L_f2poll
L_f2go:
  v_dot2c_f32_bf16_dpp v16, v8, v80 row_newbcast:0 row_mask:0xf bank_mask:0xf
  v_dot2c_f32_bf16_dpp v17, v8, v88 row_newbcast:0 row_mask:0xf bank_mask:0xf
  v_dot2c_f32_bf16_dpp v18, v8, v81 row_newbcast:1 row_mask:0xf bank_mask:0xf
  v_dot2c_f32_bf16_dpp v19, v8, v89 row_newbcast:1 row_mask:0xf bank_mask:0xf
  v_dot2c_f32_bf16_dpp v16, v8, v82 row_newbcast:2 row_mask:0xf bank_mask:0xf
  v_dot2c_f32_bf16_dpp v17, v8, v90 row_newbcast:2 row_mask:0xf bank_mask:0xf
  v_dot2c_f32_bf16_dpp v18, v8, v83 row_newbcast:3 row_mask:0xf bank_mask:0xf
  v_dot2c_f32_bf16_dpp v19, v8, v91 row_newbcast:3 row_mask:0xf bank_mask:0xf
  v_dot2c_f32_bf16_dpp v16, v8, v84 row_newbcast:4 row_mask:0xf bank_mask:0xf
  v_dot2c_f32_bf16_dpp v17, v8, v92 row_newbcast:4 row_mask:0xf bank_mask:0xf
  v_dot2c_f32_bf16_dpp v18, v8, v85 row_newbcast:5 row_mask:0xf bank_mask:0xf
  v_dot2c_f32_bf16_dpp v19, v8, v93 row_newbcast:5 row_mask:0xf bank_mask:0xf
  v_dot2c_f32_bf16_dpp v16, v8, v86 row_newbcast:6 row_mask:0xf bank_mask:0xf
  v_dot2c_f32_bf16_dpp v17, v8, v94 row_newbcast:6 row_mask:0xf bank_mask:0xf
  v_dot2c_f32_bf16_dpp v18, v8, v87 row_newbcast:7 row_mask:0xf bank_mask:0xf
  v_dot2c_f32_bf16_dpp v19, v8, v95 row_newbcast:7 row_mask:0xf bank_mask:0xf
  s_nop 2
  v_pk_add_f32 v[16:17], v[16:17], v[18:19]
  v_cvt_pk_bf16_f32 v4, v16, v17
  s_nop 1
  v_mov_b32_dpp v5, v4 quad_perm:[1,0,3,2] row_mask:0xf bank_mask:0xf
  s_mov_b64 exec, s[66:67]
  buffer_store_dwordx4 v[4:7], v116, s[24:27], s79 offen sc1
L_end:
  s_endpgm
L_dry:
  s_endpgm
L_slow_25:
  s_mov_b32 exec_lo, 0xffffffff
  s_mov_b32 exec_hi, 0xffff
  buffer_store_dwordx4 v[4:7], v13, s[24:27], s74 offen sc1
  s_mov_b64 exec, -1
  s_nop 1
  s_branch L_back_26
L_slow_35:
  s_mov_b32 exec_lo, 0x55555555
  s_mov_b32 exec_hi, 0x0
  buffer_store_dwordx4 v[8:11], v2, s[24:27], s66 offen offset:1536 sc1
  s_mov_b64 exec, -1
  s_nop 1
  s_branch L_back_36
L_slow_46:
  s_mov_b32 exec_lo, 0x1
  s_mov_b32 exec_hi, 0x0
  buffer_store_dwordx4 v[2:5], v1, s[24:27], s68 offen sc1
  s_mov_b64 exec, -1
  s_nop 1
  s_branch L_back_47
L_slow_66:
  s_mov_b32 exec_lo, 0x1
  s_mov_b32 exec_hi, 0x0
  buffer_store_dwordx4 v[4:7], v55, s[24:27], s72 offen sc1
  s_mov_b32 exec_lo, 0x110011
  s_mov_b32 exec_hi, 0x110011
  buffer_store_dwordx4 v[12:15], v54, s[24:27], s75 offen sc1
  s_mov_b64 exec, -1
  s_nop 1
  s_branch L_back_67
L_slow_68:
  s_mov_b32 exec_lo, 0xffffffff
  s_mov_b32 exec_hi, 0x0
  buffer_store_dwordx4 v[32:35], v59, s[24:27], s77 offen sc1
  s_mov_b64 exec, -1
  s_nop 1
  s_branch L_back_69
L_slow_70:
  s_mov_b32 exec_lo, 0xffffffff
  s_mov_b32 exec_hi, 0x0
  buffer_store_dwordx4 v[4:7], v59, s[24:27], s76 offen sc1
  s_mov_b64 exec, -1
  s_nop 1
  s_branch L_back_71
L_pslow_76:
  s_mov_b32 s16, s32
  s_mov_b32 s17, s33
  s_mov_b32 s18, 4194304
  s_mov_b32 s19, 0x20000
  s_mov_b32 s70, 4000007
L_spin_79:
  buffer_load_dwordx4 v[16:19], v60, s[16:19], s62 offen sc1
  buffer_load_dwordx4 v[20:23], v60, s[16:19], s62 offen offset:1024 sc1
  s_mov_b64 exec, s[10:11]
  buffer_load_dwordx4 v[24:27], v60, s[16:19], s62 offen offset:2048 sc1
  s_mov_b64 exec, -1
  s_mov_b64 exec, s[8:9]
  buffer_load_dwordx4 v[140:143], v61, s[16:19], s65 offen sc1
  s_mov_b64 exec, -1
  buffer_load_dwordx4 v[128:131], v60, s[16:19], s60 offen sc1
  buffer_load_dwordx4 v[132:135], v60, s[16:19], s60 offen offset:1024 sc1
  s_mov_b64 exec, s[10:11]
  buffer_load_dwordx4 v[136:139], v60, s[16:19], s60 offen offset:2048 sc1
  s_mov_b64 exec, -1
  s_waitcnt vmcnt(0)
  v_cmp_ne_u64 vcc, s[30:31], v[18:19]
  v_cmp_ne_u64 s[20:21], s[30:31], v[22:23]
  v_cmp_ne_u64 s[22:23], s[30:31], v[26:27]
  s_or_b64 vcc, vcc, s[20:21]
  s_or_b64 vcc, vcc, s[22:23]
  s_nop 0
  s_cbranch_vccz L_sdone_80
  s_and_b32 s99, s70, 7
  s_cmp_eq_u32 s46, 1
  s_cselect_b32 s99, 1, s99
  s_cmp_lg_u32 s99, 0
  s_cselect_b32 s16, s32, s24
  s_cselect_b32 s17, s33, s25
  s_sub_u32 s70, s70, 1
  s_cbranch_scc0 L_spin_79
L_sdone_80:
  s_branch L_pok_77
L_pslow_81:
  s_mov_b32 s16, s32
  s_mov_b32 s17, s33
  s_mov_b32 s18, 4194304
  s_mov_b32 s19, 0x20000
  s_mov_b32 s70, 4000007
L_spin_84:
  s_mov_b64 exec, s[8:9]
  buffer_load_dwordx4 v[140:143], v61, s[16:19], s65 offen sc1
  s_mov_b64 exec, -1
  s_waitcnt vmcnt(0)
  v_cmp_ne_u64 vcc, s[30:31], v[142:143]
  s_nop 0
  s_cbranch_vccz L_sdone_85
  s_and_b32 s99, s70, 7
  s_cmp_eq_u32 s46, 1
  s_cselect_b32 s99, 1, s99
  s_cmp_lg_u32 s99, 0
  s_cselect_b32 s16, s32, s24
  s_cselect_b32 s17, s33, s25
  s_sub_u32 s70, s70, 1
  s_cbranch_scc0 L_spin_84
L_sdone_85:
  s_branch L_pok_82
L_pslow_86:
  s_mov_b32 s16, s32
  s_mov_b32 s17, s33
  s_mov_b32 s18, 4194304
  s_mov_b32 s19, 0x20000
  s_mov_b32 s70, 4000007
L_spin_89:
  buffer_load_dwordx4 v[128:131], v60, s[16:19], s60 offen sc1
  buffer_load_dwordx4 v[132:135], v60, s[16:19], s60 offen offset:1024 sc1
  s_mov_b64 exec, s[10:11]
  buffer_load_dwordx4 v[136:139], v60, s[16:19], s60 offen offset:2048 sc1
  s_mov_b64 exec, -1
  s_waitcnt vmcnt(0)
  v_cmp_ne_u64 vcc, s[30:31], v[130:131]
  v_cmp_ne_u64 s[20:21], s[30:31], v[134:135]
  v_cmp_ne_u64 s[22:23], s[30:31], v[138:139]
  s_or_b64 vcc, vcc, s[20:21]
  s_or_b64 vcc, vcc, s[22:23]
  s_nop 0
  s_cbranch_vccz L_sdone_90
  s_and_b32 s99, s70, 7
  s_cmp_eq_u32 s46, 1
  s_cselect_b32 s99, 1, s99
  s_cmp_lg_u32 s99, 0
  s_cselect_b32 s16, s32, s24
  s_cselect_b32 s17, s33, s25
  s_sub_u32 s70, s70, 1
  s_cbranch_scc0 L_spin_89
L_sdone_90:
  s_branch L_pok_87
L_codeend:
.section .rodata,"a"
.p2align 6
.amdhsa_kernel sequential_preLN__sliding_block_cached__glu_gated_swiglu__decode_kernel
  .amdhsa_next_free_vgpr 168
  .amdhsa_next_free_sgpr 100
  .amdhsa_accum_offset 168
  .amdhsa_group_segment_fixed_size 0
  .amdhsa_kernarg_size 96
  .amdhsa_user_sgpr_count 2
  .amdhsa_user_sgpr_kernarg_segment_ptr 1
  .amdhsa_system_sgpr_workgroup_id_x 1
.end_amdhsa_kernel
```

```asm
; @launch grid=(256,1,1) block=(768,1,1) lds=64000
.amdgcn_target "amdgcn-amd-amdhsa--gfx950"
.text
.globl sequential_preLN__sliding_block_cached__glu_gated_swiglu__decode_kernel
.p2align 8
.type sequential_preLN__sliding_block_cached__glu_gated_swiglu__decode_kernel,@function
sequential_preLN__sliding_block_cached__glu_gated_swiglu__decode_kernel:
  s_load_dwordx2 s[8:9], s[0:1], 8
  v_readfirstlane_b32 s3, v0
  s_lshr_b32 s79, s2, 6
  s_cmp_gt_u32 s79, 3
  s_cbranch_scc1 L_end
  s_lshr_b32 s3, s3, 6
  s_cmp_gt_u32 s3, 3
  s_cbranch_scc1 L_str
  s_getpc_b64 s[20:21]
L_pc0:
  v_lshlrev_b32 v8, 7, v0
  v_min_u32 v8, L_codeend-L_pc0-4, v8
  global_load_dword v166, v8, s[20:21]
  s_branch L_helper0
L_str:
  s_and_b32 s4, s2, 7
  s_lshr_b32 s6, s2, 7
  s_bfe_u32 s7, s2, 0x40003
  s_lshl1_add_u32 s6, s4, s6
  s_lshl_b32 s6, s6, 10
  s_lshl1_add_u32 s64, s7, s6
  s_addk_i32 s64, 17279
  s_mulk_i32 s64, 12288
  v_lshlrev_b32 v3, 4, v0
  v_lshrrev_b32 v2, 3, v0
  v_lshl_add_u32 v1, v2, 8, v3
  s_lshl_b32 s10, 3, 27
  s_mov_b32 s11, 0x20000
  s_waitcnt lgkmcnt(0)
  buffer_load_dwordx4 v[64:67], v1, s[8:11], s64 offen offset:0 nt
  buffer_load_dwordx4 v[68:71], v1, s[8:11], s64 offen offset:128 nt
  buffer_load_dwordx4 v[72:75], v1, s[8:11], s64 offen offset:256 nt
  s_branch L_stream0
L_helper0:
  s_load_dwordx16 s[36:51], s[0:1], 0
  s_load_dwordx8 s[52:59], s[0:1], 64
  s_and_b32 s4, s2, 7
  s_lshl2_add_u32 s6, s4, s79
  s_bfe_u32 s7, s2, 0x30003
  v_and_b32 v0, 63, v0
  s_cmp_lg_u32 s3, 3
  s_cbranch_scc0 L_w3
  v_lshrrev_b32 v2, 3, v0
  v_mul_u32_u24 v2, 12160, v2
  v_lshl_add_u32 v2, v0, 4, v2
  s_mul_i32 s68, s7, 7680
  s_lshr_b32 s69, s79, 1
  s_mul_i32 s69, s69, 14
  s_add_u32 s69, s69, s79
  s_lshl1_add_u32 s69, s4, s69
  s_add_u32 s69, s69, 0
  s_mul_i32 s69, s69, 3
  s_add_u32 s68, s68, s69
  s_add_u32 s68, s68, s3
  s_lshl_b32 s68, s68, 7
  s_lshl_b32 s69, 3, 15
  s_mov_b32 s10, 7864320
  s_mov_b32 s11, 0x20000
  s_waitcnt lgkmcnt(0)
  s_mov_b64 s[8:9], s[42:43]
  buffer_load_dwordx4 v[24:27], v2, s[8:11], s68 offen nt
  s_add_u32 s68, s68, s69
  buffer_load_dwordx4 v[28:31], v2, s[8:11], s68 offen nt
  s_add_u32 s68, s68, s69
  buffer_load_dwordx4 v[32:35], v2, s[8:11], s68 offen nt
  s_add_u32 s68, s68, s69
  buffer_load_dwordx4 v[36:39], v2, s[8:11], s68 offen nt
  s_add_u32 s68, s68, s69
  buffer_load_dwordx4 v[40:43], v2, s[8:11], s68 offen nt
  s_add_u32 s68, s68, s69
  buffer_load_dwordx4 v[44:47], v2, s[8:11], s68 offen nt
  s_add_u32 s68, s68, s69
  buffer_load_dwordx4 v[48:51], v2, s[8:11], s68 offen nt
  s_add_u32 s68, s68, s69
  buffer_load_dwordx4 v[52:55], v2, s[8:11], s68 offen nt
  s_add_u32 s68, s68, s69
  buffer_load_dwordx4 v[56:59], v2, s[8:11], s68 offen nt
  s_add_u32 s68, s68, s69
  buffer_load_dwordx4 v[60:63], v2, s[8:11], s68 offen nt
  s_branch L_helper
L_w3:
  v_lshlrev_b32 v1, 3, v0
  v_mov_b32 v4, 0
  v_mov_b32 v5, 0
  ds_write_b64 v1, v[4:5] offset:384
  s_waitcnt lgkmcnt(0)
  s_memrealtime s[62:63]
  s_barrier
  s_load_dwordx2 s[28:29], s[58:59], 917504
  s_branch L_ids
L_stream0:
  s_load_dwordx16 s[36:51], s[0:1], 0
  s_load_dwordx8 s[52:59], s[0:1], 64
  v_and_b32 v0, 63, v0
  s_sub_u32 s73, s3, 4
  v_and_b32 v3, 0x70, v3
  s_lshl2_add_u32 s6, s4, s79
  s_and_b32 s7, s7, 7
  s_add_u32 s65, s64, 393216
  s_waitcnt lgkmcnt(0)
  s_barrier
  s_waitcnt vmcnt(2)
  buffer_load_dwordx4 v[76:79], v1, s[8:11], s65 offen offset:0 nt
  s_load_dwordx2 s[28:29], s[58:59], 917504
  s_mov_b32 s24, s58
  s_mov_b32 s25, s59
  s_mov_b32 s26, 4194304
  s_mov_b32 s27, 0x20000
  s_add_u32 s32, s58, 4194304
  s_addc_u32 s33, s59, 0
  s_mov_b32 s34, 4194304
  s_mov_b32 s35, 0x20000
  s_lshl3_add_u32 s71, s6, s7
  s_mul_i32 s5, s79, 5
  s_mul_i32 s47, s79, 3
  s_add_u32 s47, s47, 15
  s_cmp_lt_u32 s7, 5
  s_cselect_b32 s5, s5, s47
  s_add_u32 s5, s5, s7
  s_mov_b32 s12, s40
  s_mov_b32 s13, s41
  s_mov_b32 s14, 402653184
  s_mov_b32 s15, 0x20000
  s_waitcnt vmcnt(2)
  buffer_load_dwordx4 v[80:83], v1, s[8:11], s65 offen offset:128 nt
  s_waitcnt vmcnt(2)
  buffer_load_dwordx4 v[84:87], v1, s[8:11], s65 offen offset:256 nt
  s_add_u32 s66, s65, 393216
  s_waitcnt vmcnt(2)
  buffer_load_dwordx4 v[88:91], v1, s[8:11], s66 offen offset:0 nt
  s_waitcnt vmcnt(2)
  buffer_load_dwordx4 v[92:95], v1, s[8:11], s66 offen offset:128 nt
  s_waitcnt vmcnt(2)
  buffer_load_dwordx4 v[96:99], v1, s[8:11], s66 offen offset:256 nt
  s_add_u32 s67, s66, 393216
  s_waitcnt vmcnt(2)
  buffer_load_dwordx4 v[100:103], v1, s[8:11], s67 offen offset:0 nt
  s_waitcnt vmcnt(2)
  buffer_load_dwordx4 v[104:107], v1, s[8:11], s67 offen offset:128 nt
  s_waitcnt vmcnt(2)
  buffer_load_dwordx4 v[108:111], v1, s[8:11], s67 offen offset:256 nt
  s_add_u32 s60, s67, 4092461056
  s_waitcnt vmcnt(2)
  buffer_load_dwordx4 v[16:19], v1, s[8:11], s60 offen offset:0 nt
  s_waitcnt vmcnt(2)
  buffer_load_dwordx4 v[20:23], v1, s[8:11], s60 offen offset:128 nt
  s_waitcnt vmcnt(2)
  buffer_load_dwordx4 v[24:27], v1, s[8:11], s60 offen offset:256 nt
  s_add_u32 s61, s60, 393216
  s_waitcnt vmcnt(2)
  buffer_load_dwordx4 v[28:31], v1, s[8:11], s61 offen offset:0 nt
  s_waitcnt vmcnt(2)
  buffer_load_dwordx4 v[32:35], v1, s[8:11], s61 offen offset:128 nt
  s_waitcnt vmcnt(2)
  buffer_load_dwordx4 v[36:39], v1, s[8:11], s61 offen offset:256 nt
  s_memrealtime s[76:77]
  s_waitcnt lgkmcnt(0)
  v_mov_b32 v6, 0
  v_mov_b32 v8, s76
  v_mov_b32 v9, 1
  s_mov_b64 exec, 1
  ds_add_u32 v6, v8 offset:696
  ds_add_u32 v6, v9 offset:700
  s_mov_b64 exec, -1
  s_add_u32 s62, s61, 393216
  s_waitcnt vmcnt(2)
  buffer_load_dwordx4 v[40:43], v1, s[8:11], s62 offen offset:0 nt
  s_waitcnt vmcnt(2)
  buffer_load_dwordx4 v[44:47], v1, s[8:11], s62 offen offset:128 nt
  s_waitcnt vmcnt(2)
  buffer_load_dwordx4 v[48:51], v1, s[8:11], s62 offen offset:256 nt
  s_add_u32 s63, s62, 393216
  s_waitcnt vmcnt(2)
  buffer_load_dwordx4 v[52:55], v1, s[8:11], s63 offen offset:0 nt
  s_waitcnt vmcnt(2)
  buffer_load_dwordx4 v[56:59], v1, s[8:11], s63 offen offset:128 nt
  s_waitcnt vmcnt(2)
  buffer_load_dwordx4 v[60:63], v1, s[8:11], s63 offen offset:256 nt
  s_waitcnt vmcnt(2)
  buffer_load_dwordx4 v[112:115], v1, s[12:15], s60 offen offset:0 nt
  s_waitcnt vmcnt(2)
  buffer_load_dwordx4 v[116:119], v1, s[12:15], s60 offen offset:128 nt
  s_waitcnt vmcnt(2)
  buffer_load_dwordx4 v[120:123], v1, s[12:15], s60 offen offset:256 nt
  v_mov_b32 v6, 0
  v_mov_b32 v7, 1
  s_mov_b64 exec, 1
  ds_add_u32 v6, v7 offset:692
  s_mov_b64 exec, -1
  s_waitcnt lgkmcnt(0)
  s_mul_i32 s30, s28, 0x2c9277b5
  s_add_u32 s30, s30, 0xac564b05
  s_mul_i32 s31, s29, 0x0019660d
  s_add_u32 s31, s31, 0x3c6ef35f
  v_and_b32 v2, 3, v0
  v_min_u32 v2, 2, v2
  v_lshlrev_b32 v2, 3, v2
  s_mov_b32 s70, 4000007
L_spin_1:
  ds_read_b32 v4, v2 offset:384
  s_waitcnt lgkmcnt(0)
  v_cmp_eq_u32 vcc, 0, v4
  s_nop 0
  s_cbranch_vccz L_sdone_2
  s_sleep 1
  s_sub_u32 s70, s70, 1
  s_cbranch_scc0 L_spin_1
L_sdone_2:
  ds_read_b128 v[4:7], v3 offset:0
  ds_read_b128 v[8:11], v3 offset:128
  ds_read_b128 v[12:15], v3 offset:256
  ds_read_b128 v[148:151], v3 offset:8192
  ds_read_b128 v[152:155], v3 offset:8320
  ds_read_b128 v[156:159], v3 offset:8448
  v_mov_b32 v160, 0
  v_mov_b32 v161, 0
  v_mov_b32 v162, 0
  v_mov_b32 v163, 0
  v_mov_b32 v164, 0
  v_mov_b32 v165, 0
  v_mov_b32 v166, 0
  v_mov_b32 v167, 0
  s_waitcnt vmcnt(3) lgkmcnt(0)
  v_dot2c_f32_bf16 v160, v16, v4
  v_dot2c_f32_bf16 v161, v28, v4
  v_dot2c_f32_bf16 v162, v40, v4
  v_dot2c_f32_bf16 v163, v52, v4
  v_dot2c_f32_bf16 v160, v17, v5
  v_dot2c_f32_bf16 v161, v29, v5
  v_dot2c_f32_bf16 v162, v41, v5
  v_dot2c_f32_bf16 v163, v53, v5
  v_dot2c_f32_bf16 v160, v18, v6
  v_dot2c_f32_bf16 v161, v30, v6
  v_dot2c_f32_bf16 v162, v42, v6
  v_dot2c_f32_bf16 v163, v54, v6
  v_dot2c_f32_bf16 v160, v19, v7
  v_dot2c_f32_bf16 v161, v31, v7
  v_dot2c_f32_bf16 v162, v43, v7
  v_dot2c_f32_bf16 v163, v55, v7
  v_dot2c_f32_bf16 v160, v20, v8
  v_dot2c_f32_bf16 v161, v32, v8
  v_dot2c_f32_bf16 v162, v44, v8
  v_dot2c_f32_bf16 v163, v56, v8
  v_dot2c_f32_bf16 v160, v21, v9
  v_dot2c_f32_bf16 v161, v33, v9
  v_dot2c_f32_bf16 v162, v45, v9
  v_dot2c_f32_bf16 v163, v57, v9
  v_dot2c_f32_bf16 v160, v22, v10
  v_dot2c_f32_bf16 v161, v34, v10
  v_dot2c_f32_bf16 v162, v46, v10
  v_dot2c_f32_bf16 v163, v58, v10
  v_dot2c_f32_bf16 v160, v23, v11
  v_dot2c_f32_bf16 v161, v35, v11
  v_dot2c_f32_bf16 v162, v47, v11
  v_dot2c_f32_bf16 v163, v59, v11
  v_dot2c_f32_bf16 v160, v24, v12
  v_dot2c_f32_bf16 v161, v36, v12
  v_dot2c_f32_bf16 v162, v48, v12
  v_dot2c_f32_bf16 v163, v60, v12
  v_dot2c_f32_bf16 v160, v25, v13
  v_dot2c_f32_bf16 v161, v37, v13
  v_dot2c_f32_bf16 v162, v49, v13
  v_dot2c_f32_bf16 v163, v61, v13
  v_dot2c_f32_bf16 v160, v26, v14
  v_dot2c_f32_bf16 v161, v38, v14
  v_dot2c_f32_bf16 v162, v50, v14
  v_dot2c_f32_bf16 v163, v62, v14
  v_dot2c_f32_bf16 v160, v27, v15
  v_dot2c_f32_bf16 v161, v39, v15
  v_dot2c_f32_bf16 v162, v51, v15
  v_dot2c_f32_bf16 v163, v63, v15
  v_dot2c_f32_bf16 v164, v64, v148
  v_dot2c_f32_bf16 v165, v76, v148
  v_dot2c_f32_bf16 v166, v88, v148
  v_dot2c_f32_bf16 v167, v100, v148
  v_dot2c_f32_bf16 v164, v65, v149
  v_dot2c_f32_bf16 v165, v77, v149
  v_dot2c_f32_bf16 v166, v89, v149
  v_dot2c_f32_bf16 v167, v101, v149
  v_dot2c_f32_bf16 v164, v66, v150
  v_dot2c_f32_bf16 v165, v78, v150
  v_dot2c_f32_bf16 v166, v90, v150
  v_dot2c_f32_bf16 v167, v102, v150
  v_dot2c_f32_bf16 v164, v67, v151
  v_dot2c_f32_bf16 v165, v79, v151
  v_dot2c_f32_bf16 v166, v91, v151
  v_dot2c_f32_bf16 v167, v103, v151
  v_dot2c_f32_bf16 v164, v68, v152
  v_dot2c_f32_bf16 v165, v80, v152
  v_dot2c_f32_bf16 v166, v92, v152
  v_dot2c_f32_bf16 v167, v104, v152
  v_dot2c_f32_bf16 v164, v69, v153
  v_dot2c_f32_bf16 v165, v81, v153
  v_dot2c_f32_bf16 v166, v93, v153
  v_dot2c_f32_bf16 v167, v105, v153
  v_dot2c_f32_bf16 v164, v70, v154
  v_dot2c_f32_bf16 v165, v82, v154
  v_dot2c_f32_bf16 v166, v94, v154
  v_dot2c_f32_bf16 v167, v106, v154
  v_dot2c_f32_bf16 v164, v71, v155
  v_dot2c_f32_bf16 v165, v83, v155
  v_dot2c_f32_bf16 v166, v95, v155
  v_dot2c_f32_bf16 v167, v107, v155
  v_dot2c_f32_bf16 v164, v72, v156
  v_dot2c_f32_bf16 v165, v84, v156
  v_dot2c_f32_bf16 v166, v96, v156
  v_dot2c_f32_bf16 v167, v108, v156
  v_dot2c_f32_bf16 v164, v73, v157
  v_dot2c_f32_bf16 v165, v85, v157
  v_dot2c_f32_bf16 v166, v97, v157
  v_dot2c_f32_bf16 v167, v109, v157
  v_dot2c_f32_bf16 v164, v74, v158
  v_dot2c_f32_bf16 v165, v86, v158
  v_dot2c_f32_bf16 v166, v98, v158
  v_dot2c_f32_bf16 v167, v110, v158
  v_dot2c_f32_bf16 v164, v75, v159
  v_dot2c_f32_bf16 v165, v87, v159
  v_dot2c_f32_bf16 v166, v99, v159
  v_dot2c_f32_bf16 v167, v111, v159
  v_add_f32_dpp v160, v160, v160 quad_perm:[1,0,3,2] row_mask:0xf bank_mask:0xf
  v_add_f32_dpp v161, v161, v161 quad_perm:[1,0,3,2] row_mask:0xf bank_mask:0xf
  v_add_f32_dpp v162, v162, v162 quad_perm:[1,0,3,2] row_mask:0xf bank_mask:0xf
  v_add_f32_dpp v163, v163, v163 quad_perm:[1,0,3,2] row_mask:0xf bank_mask:0xf
  v_add_f32_dpp v164, v164, v164 quad_perm:[1,0,3,2] row_mask:0xf bank_mask:0xf
  v_add_f32_dpp v165, v165, v165 quad_perm:[1,0,3,2] row_mask:0xf bank_mask:0xf
  v_add_f32_dpp v166, v166, v166 quad_perm:[1,0,3,2] row_mask:0xf bank_mask:0xf
  v_add_f32_dpp v167, v167, v167 quad_perm:[1,0,3,2] row_mask:0xf bank_mask:0xf
  v_add_f32_dpp v160, v160, v160 quad_perm:[2,3,0,1] row_mask:0xf bank_mask:0xf
  v_add_f32_dpp v161, v161, v161 quad_perm:[2,3,0,1] row_mask:0xf bank_mask:0xf
  v_add_f32_dpp v162, v162, v162 quad_perm:[2,3,0,1] row_mask:0xf bank_mask:0xf
  v_add_f32_dpp v163, v163, v163 quad_perm:[2,3,0,1] row_mask:0xf bank_mask:0xf
  v_add_f32_dpp v164, v164, v164 quad_perm:[2,3,0,1] row_mask:0xf bank_mask:0xf
  v_add_f32_dpp v165, v165, v165 quad_perm:[2,3,0,1] row_mask:0xf bank_mask:0xf
  v_add_f32_dpp v166, v166, v166 quad_perm:[2,3,0,1] row_mask:0xf bank_mask:0xf
  v_add_f32_dpp v167, v167, v167 quad_perm:[2,3,0,1] row_mask:0xf bank_mask:0xf
  v_add_f32_dpp v160, v160, v160 row_half_mirror row_mask:0xf bank_mask:0xf
  v_add_f32_dpp v161, v161, v161 row_half_mirror row_mask:0xf bank_mask:0xf
  v_add_f32_dpp v162, v162, v162 row_half_mirror row_mask:0xf bank_mask:0xf
  v_add_f32_dpp v163, v163, v163 row_half_mirror row_mask:0xf bank_mask:0xf
  v_add_f32_dpp v164, v164, v164 row_half_mirror row_mask:0xf bank_mask:0xf
  v_add_f32_dpp v165, v165, v165 row_half_mirror row_mask:0xf bank_mask:0xf
  v_add_f32_dpp v166, v166, v166 row_half_mirror row_mask:0xf bank_mask:0xf
  v_add_f32_dpp v167, v167, v167 row_half_mirror row_mask:0xf bank_mask:0xf
  s_mov_b32 s68, 0x3d93cd3a
  v_mov_b32 v2, 0
  v_cvt_pk_bf16_f32 v160, v2, v160
  v_cvt_pk_bf16_f32 v161, v2, v161
  v_cvt_pk_bf16_f32 v162, v2, v162
  v_cvt_pk_bf16_f32 v163, v2, v163
  v_cvt_pk_bf16_f32 v164, v2, v164
  v_cvt_pk_bf16_f32 v165, v2, v165
  v_cvt_pk_bf16_f32 v166, v2, v166
  v_cvt_pk_bf16_f32 v167, v2, v167
  v_mul_f32 v160, s68, v160
  v_mul_f32 v161, s68, v161
  v_mul_f32 v162, s68, v162
  v_mul_f32 v163, s68, v163
  v_mul_f32 v164, s68, v164
  v_mul_f32 v165, s68, v165
  v_mul_f32 v166, s68, v166
  v_mul_f32 v167, s68, v167
  v_cvt_pk_bf16_f32 v160, v2, v160
  v_cvt_pk_bf16_f32 v161, v2, v161
  v_cvt_pk_bf16_f32 v162, v2, v162
  v_cvt_pk_bf16_f32 v163, v2, v163
  v_cvt_pk_bf16_f32 v164, v2, v164
  v_cvt_pk_bf16_f32 v165, v2, v165
  v_cvt_pk_bf16_f32 v166, v2, v166
  v_cvt_pk_bf16_f32 v167, v2, v167
  v_max_f32 v4, v160, v161
  v_max_f32 v6, v164, v165
  v_max3_f32 v4, v4, v162, v163
  v_max3_f32 v6, v6, v166, v167
  s_nop 0
  v_max_f32_dpp v4, v4, v4 row_ror:8 row_mask:0xf bank_mask:0xf
  v_max_f32_dpp v6, v6, v6 row_ror:8 row_mask:0xf bank_mask:0xf
  v_mov_b32 v88, v4
  v_mov_b32 v89, v6
  s_nop 0
  v_permlane16_swap_b32 v4, v88
  v_permlane16_swap_b32 v6, v89
  v_max_f32 v4, v4, v88
  v_max_f32 v6, v6, v89
  v_mov_b32 v88, v4
  v_mov_b32 v89, v6
  s_nop 0
  v_permlane32_swap_b32 v4, v88
  v_permlane32_swap_b32 v6, v89
  v_max_f32 v4, v4, v88
  v_max_f32 v6, v6, v89
  s_mov_b32 s68, 0x3fb8aa3b
  v_sub_f32 v160, v160, v4
  v_sub_f32 v161, v161, v4
  v_sub_f32 v162, v162, v4
  v_sub_f32 v163, v163, v4
  v_sub_f32 v164, v164, v6
  v_sub_f32 v165, v165, v6
  v_sub_f32 v166, v166, v6
  v_sub_f32 v167, v167, v6
  v_mul_f32 v160, s68, v160
  v_mul_f32 v161, s68, v161
  v_mul_f32 v162, s68, v162
  v_mul_f32 v163, s68, v163
  v_mul_f32 v164, s68, v164
  v_mul_f32 v165, s68, v165
  v_mul_f32 v166, s68, v166
  v_mul_f32 v167, s68, v167
  v_exp_f32 v160, v160
  v_exp_f32 v161, v161
  v_exp_f32 v162, v162
  v_exp_f32 v163, v163
  v_exp_f32 v164, v164
  v_exp_f32 v165, v165
  v_exp_f32 v166, v166
  v_exp_f32 v167, v167
  v_add_f32 v5, v160, v161
  v_add_f32 v7, v164, v165
  v_add_f32 v5, v5, v162
  v_add_f32 v7, v7, v166
  v_add_f32 v5, v5, v163
  v_add_f32 v7, v7, v167
  s_nop 0
  v_add_f32_dpp v5, v5, v5 row_ror:8 row_mask:0xf bank_mask:0xf
  v_add_f32_dpp v7, v7, v7 row_ror:8 row_mask:0xf bank_mask:0xf
  v_mov_b32 v88, v5
  v_mov_b32 v89, v7
  s_nop 0
  v_permlane16_swap_b32 v5, v88
  v_permlane16_swap_b32 v7, v89
  v_add_f32 v5, v5, v88
  v_add_f32 v7, v7, v89
  v_mov_b32 v88, v5
  v_mov_b32 v89, v7
  s_nop 0
  v_permlane32_swap_b32 v5, v88
  v_permlane32_swap_b32 v7, v89
  v_add_f32 v5, v5, v88
  v_add_f32 v7, v7, v89
  s_lshl_b32 s69, s73, 4
  v_mov_b32 v88, s69
  ds_write_b128 v88, v[4:7] offset:512
  v_cvt_pk_bf16_f32 v160, v160, v2
  v_cvt_pk_bf16_f32 v161, v161, v2
  v_cvt_pk_bf16_f32 v162, v162, v2
  v_cvt_pk_bf16_f32 v163, v163, v2
  v_cvt_pk_bf16_f32 v164, v164, v2
  v_cvt_pk_bf16_f32 v165, v165, v2
  v_cvt_pk_bf16_f32 v166, v166, v2
  v_cvt_pk_bf16_f32 v167, v167, v2
  v_mov_b32 v64, 0
  v_mov_b32 v65, 0
  v_mov_b32 v66, 0
  v_mov_b32 v67, 0
  v_mov_b32 v68, 0
  v_mov_b32 v69, 0
  v_mov_b32 v70, 0
  v_mov_b32 v71, 0
  v_mov_b32 v72, 0
  v_mov_b32 v73, 0
  v_mov_b32 v74, 0
  v_mov_b32 v75, 0
  v_mov_b32 v76, 0
  v_mov_b32 v77, 0
  v_mov_b32 v78, 0
  v_mov_b32 v79, 0
  v_mov_b32 v80, 0
  v_mov_b32 v81, 0
  v_mov_b32 v82, 0
  v_mov_b32 v83, 0
  v_mov_b32 v84, 0
  v_mov_b32 v85, 0
  v_mov_b32 v86, 0
  v_mov_b32 v87, 0
  v_mov_b32 v88, 0
  v_mov_b32 v89, 0
  v_mov_b32 v90, 0
  v_mov_b32 v91, 0
  v_mov_b32 v92, 0
  v_mov_b32 v93, 0
  v_mov_b32 v94, 0
  v_mov_b32 v95, 0
  v_mov_b32 v96, 0
  v_mov_b32 v97, 0
  v_mov_b32 v98, 0
  v_mov_b32 v99, 0
  v_mov_b32 v100, 0
  v_mov_b32 v101, 0
  v_mov_b32 v102, 0
  v_mov_b32 v103, 0
  v_mov_b32 v104, 0
  v_mov_b32 v105, 0
  v_mov_b32 v106, 0
  v_mov_b32 v107, 0
  v_mov_b32 v108, 0
  v_mov_b32 v109, 0
  v_mov_b32 v110, 0
  v_mov_b32 v111, 0
  v_mov_b32 v5, v6
  v_and_b32 v8, 7, v0
  v_lshlrev_b32 v8, 5, v8
  v_lshrrev_b32 v9, 4, v0
  v_lshl_add_u32 v8, v9, 3, v8
  s_mul_i32 s69, s73, 768
  v_add_u32 v8, s69, v8
  v_mov_b32 v11, 1
  s_waitcnt vmcnt(2)
  buffer_load_dwordx4 v[124:127], v1, s[12:15], s61 offen offset:0 nt
  s_waitcnt vmcnt(2)
  buffer_load_dwordx4 v[128:131], v1, s[12:15], s61 offen offset:128 nt
  v_lshlrev_b32 v10, 16, v160
  v_dot2c_f32_bf16 v64, v112, v160
  v_dot2c_f32_bf16 v65, v112, v10
  v_dot2c_f32_bf16 v66, v113, v160
  v_dot2c_f32_bf16 v67, v113, v10
  v_dot2c_f32_bf16 v68, v114, v160
  v_dot2c_f32_bf16 v69, v114, v10
  v_dot2c_f32_bf16 v70, v115, v160
  v_dot2c_f32_bf16 v71, v115, v10
  s_waitcnt vmcnt(2)
  buffer_load_dwordx4 v[132:135], v1, s[12:15], s61 offen offset:256 nt
  s_memrealtime s[76:77]
  v_mov_b32 v6, 0
  ds_read_b64 v[6:7], v6 offset:680
  s_movk_i32 s79, 457
  s_waitcnt lgkmcnt(0)
  v_readfirstlane_b32 s78, v6
  v_readfirstlane_b32 s72, v7
  s_add_u32 s78, s78, 5484
  v_dot2c_f32_bf16 v72, v116, v160
  v_dot2c_f32_bf16 v73, v116, v10
  v_dot2c_f32_bf16 v74, v117, v160
  v_dot2c_f32_bf16 v75, v117, v10
  v_dot2c_f32_bf16 v76, v118, v160
  v_dot2c_f32_bf16 v77, v118, v10
  v_dot2c_f32_bf16 v78, v119, v160
  v_dot2c_f32_bf16 v79, v119, v10
  s_waitcnt lgkmcnt(0)
  s_lshl_b32 s75, s76, 4
  s_sub_u32 s75, s75, s78
  s_and_b32 s75, s75, s72
  s_add_u32 s78, s78, s79
  s_waitcnt vmcnt(3)
  s_cmp_gt_i32 s75, 480
  s_cbranch_scc1 L_go_3
  s_waitcnt vmcnt(2)
  s_cmp_ge_i32 s75, 0
  s_cbranch_scc1 L_go_3
  s_waitcnt vmcnt(1)
L_go_3:
  buffer_load_dwordx4 v[136:139], v1, s[12:15], s62 offen offset:0 nt
  s_memrealtime s[76:77]
  v_dot2c_f32_bf16 v80, v120, v160
  v_dot2c_f32_bf16 v81, v120, v10
  v_dot2c_f32_bf16 v82, v121, v160
  v_dot2c_f32_bf16 v83, v121, v10
  v_dot2c_f32_bf16 v84, v122, v160
  v_dot2c_f32_bf16 v85, v122, v10
  v_dot2c_f32_bf16 v86, v123, v160
  v_dot2c_f32_bf16 v87, v123, v10
  s_waitcnt lgkmcnt(0)
  s_lshl_b32 s75, s76, 4
  s_sub_u32 s75, s75, s78
  s_and_b32 s75, s75, s72
  s_add_u32 s78, s78, s79
  s_waitcnt vmcnt(3)
  s_cmp_gt_i32 s75, 480
  s_cbranch_scc1 L_go_4
  s_waitcnt vmcnt(2)
  s_cmp_ge_i32 s75, 0
  s_cbranch_scc1 L_go_4
  s_waitcnt vmcnt(1)
L_go_4:
  buffer_load_dwordx4 v[140:143], v1, s[12:15], s62 offen offset:128 nt
  s_memrealtime s[76:77]
  v_lshlrev_b32 v10, 16, v161
  v_dot2c_f32_bf16 v64, v124, v161
  v_dot2c_f32_bf16 v65, v124, v10
  v_dot2c_f32_bf16 v66, v125, v161
  v_dot2c_f32_bf16 v67, v125, v10
  v_dot2c_f32_bf16 v68, v126, v161
  v_dot2c_f32_bf16 v69, v126, v10
  v_dot2c_f32_bf16 v70, v127, v161
  v_dot2c_f32_bf16 v71, v127, v10
  s_waitcnt lgkmcnt(0)
  s_lshl_b32 s75, s76, 4
  s_sub_u32 s75, s75, s78
  s_and_b32 s75, s75, s72
  s_add_u32 s78, s78, s79
  s_waitcnt vmcnt(3)
  s_cmp_gt_i32 s75, 480
  s_cbranch_scc1 L_go_5
  s_waitcnt vmcnt(2)
  s_cmp_ge_i32 s75, 0
  s_cbranch_scc1 L_go_5
  s_waitcnt vmcnt(1)
L_go_5:
  buffer_load_dwordx4 v[144:147], v1, s[12:15], s62 offen offset:256 nt
  s_memrealtime s[76:77]
  v_dot2c_f32_bf16 v72, v128, v161
  v_dot2c_f32_bf16 v73, v128, v10
  v_dot2c_f32_bf16 v74, v129, v161
  v_dot2c_f32_bf16 v75, v129, v10
  v_dot2c_f32_bf16 v76, v130, v161
  v_dot2c_f32_bf16 v77, v130, v10
  v_dot2c_f32_bf16 v78, v131, v161
  v_dot2c_f32_bf16 v79, v131, v10
  s_waitcnt lgkmcnt(0)
  s_lshl_b32 s75, s76, 4
  s_sub_u32 s75, s75, s78
  s_and_b32 s75, s75, s72
  s_add_u32 s78, s78, s79
  s_waitcnt vmcnt(3)
  s_cmp_gt_i32 s75, 480
  s_cbranch_scc1 L_go_6
  s_waitcnt vmcnt(2)
  s_cmp_ge_i32 s75, 0
  s_cbranch_scc1 L_go_6
  s_waitcnt vmcnt(1)
L_go_6:
  buffer_load_dwordx4 v[148:151], v1, s[12:15], s63 offen offset:0 nt
  s_memrealtime s[76:77]
  v_mov_b32 v6, 0
  ds_read_b64 v[6:7], v6 offset:680
  s_movk_i32 s79, 457
  s_waitcnt lgkmcnt(0)
  v_readfirstlane_b32 s78, v6
  v_readfirstlane_b32 s72, v7
  s_add_u32 s78, s78, 7312
  v_dot2c_f32_bf16 v80, v132, v161
  v_dot2c_f32_bf16 v81, v132, v10
  v_dot2c_f32_bf16 v82, v133, v161
  v_dot2c_f32_bf16 v83, v133, v10
  v_dot2c_f32_bf16 v84, v134, v161
  v_dot2c_f32_bf16 v85, v134, v10
  v_dot2c_f32_bf16 v86, v135, v161
  v_dot2c_f32_bf16 v87, v135, v10
  s_waitcnt lgkmcnt(0)
  s_lshl_b32 s75, s76, 4
  s_sub_u32 s75, s75, s78
  s_and_b32 s75, s75, s72
  s_add_u32 s78, s78, s79
  s_waitcnt vmcnt(3)
  s_cmp_gt_i32 s75, 480
  s_cbranch_scc1 L_go_7
  s_waitcnt vmcnt(2)
  s_cmp_ge_i32 s75, 0
  s_cbranch_scc1 L_go_7
  s_waitcnt vmcnt(1)
L_go_7:
  buffer_load_dwordx4 v[152:155], v1, s[12:15], s63 offen offset:128 nt
  s_memrealtime s[76:77]
  v_lshlrev_b32 v10, 16, v162
  v_dot2c_f32_bf16 v64, v136, v162
  v_dot2c_f32_bf16 v65, v136, v10
  v_dot2c_f32_bf16 v66, v137, v162
  v_dot2c_f32_bf16 v67, v137, v10
  v_dot2c_f32_bf16 v68, v138, v162
  v_dot2c_f32_bf16 v69, v138, v10
  v_dot2c_f32_bf16 v70, v139, v162
  v_dot2c_f32_bf16 v71, v139, v10
  s_waitcnt lgkmcnt(0)
  s_lshl_b32 s75, s76, 4
  s_sub_u32 s75, s75, s78
  s_and_b32 s75, s75, s72
  s_add_u32 s78, s78, s79
  s_waitcnt vmcnt(3)
  s_cmp_gt_i32 s75, 480
  s_cbranch_scc1 L_go_8
  s_waitcnt vmcnt(2)
  s_cmp_ge_i32 s75, 0
  s_cbranch_scc1 L_go_8
  s_waitcnt vmcnt(1)
L_go_8:
  buffer_load_dwordx4 v[156:159], v1, s[12:15], s63 offen offset:256 nt
  s_memrealtime s[76:77]
  v_dot2c_f32_bf16 v72, v140, v162
  v_dot2c_f32_bf16 v73, v140, v10
  v_dot2c_f32_bf16 v74, v141, v162
  v_dot2c_f32_bf16 v75, v141, v10
  v_dot2c_f32_bf16 v76, v142, v162
  v_dot2c_f32_bf16 v77, v142, v10
  v_dot2c_f32_bf16 v78, v143, v162
  v_dot2c_f32_bf16 v79, v143, v10
  s_waitcnt lgkmcnt(0)
  s_lshl_b32 s75, s76, 4
  s_sub_u32 s75, s75, s78
  s_and_b32 s75, s75, s72
  s_add_u32 s78, s78, s79
  s_waitcnt vmcnt(3)
  s_cmp_gt_i32 s75, 480
  s_cbranch_scc1 L_go_9
  s_waitcnt vmcnt(2)
  s_cmp_ge_i32 s75, 0
  s_cbranch_scc1 L_go_9
  s_waitcnt vmcnt(1)
L_go_9:
  buffer_load_dwordx4 v[16:19], v1, s[12:15], s64 offen offset:0 nt
  s_memrealtime s[76:77]
  v_dot2c_f32_bf16 v80, v144, v162
  v_dot2c_f32_bf16 v81, v144, v10
  v_dot2c_f32_bf16 v82, v145, v162
  v_dot2c_f32_bf16 v83, v145, v10
  v_dot2c_f32_bf16 v84, v146, v162
  v_dot2c_f32_bf16 v85, v146, v10
  v_dot2c_f32_bf16 v86, v147, v162
  v_dot2c_f32_bf16 v87, v147, v10
  s_waitcnt lgkmcnt(0)
  s_lshl_b32 s75, s76, 4
  s_sub_u32 s75, s75, s78
  s_and_b32 s75, s75, s72
  s_add_u32 s78, s78, s79
  s_waitcnt vmcnt(3)
  s_cmp_gt_i32 s75, 480
  s_cbranch_scc1 L_go_10
  s_waitcnt vmcnt(2)
  s_cmp_ge_i32 s75, 0
  s_cbranch_scc1 L_go_10
  s_waitcnt vmcnt(1)
L_go_10:
  buffer_load_dwordx4 v[20:23], v1, s[12:15], s64 offen offset:128 nt
  s_memrealtime s[76:77]
  v_lshlrev_b32 v10, 16, v163
  s_mov_b32 s70, 4000007
L_spin_11:
  ds_read_b128 v[12:15], v3 offset:512
  s_waitcnt lgkmcnt(0)
  v_cmp_eq_u32 vcc, 0, v15
  s_nop 0
  s_cbranch_vccz L_sdone_12
  s_sleep 1
  s_sub_u32 s70, s70, 1
  s_cbranch_scc0 L_spin_11
L_sdone_12:
  v_max_f32_dpp v12, v12, v12 quad_perm:[1,0,3,2] row_mask:0xf bank_mask:0xf
  v_max_f32_dpp v14, v14, v14 quad_perm:[1,0,3,2] row_mask:0xf bank_mask:0xf
  s_nop 0
  v_max_f32_dpp v12, v12, v12 quad_perm:[2,3,0,1] row_mask:0xf bank_mask:0xf
  v_max_f32_dpp v14, v14, v14 quad_perm:[2,3,0,1] row_mask:0xf bank_mask:0xf
  s_nop 0
  v_max_f32_dpp v12, v12, v12 row_half_mirror row_mask:0xf bank_mask:0xf
  v_max_f32_dpp v14, v14, v14 row_half_mirror row_mask:0xf bank_mask:0xf
  v_sub_f32 v4, v4, v12
  v_sub_f32 v5, v5, v14
  v_mul_f32 v4, s68, v4
  v_mul_f32 v5, s68, v5
  v_exp_f32 v4, v4
  v_exp_f32 v5, v5
  v_mov_b32 v2, 0
  s_mov_b32 s70, 4000007
L_spin_13:
  ds_read_b32 v13, v2 offset:648
  s_waitcnt lgkmcnt(0)
  v_cmp_gt_u32 vcc, 1, v13
  s_nop 0
  s_cbranch_vccz L_sdone_14
  s_sleep 2
  s_sub_u32 s70, s70, 1
  s_cbranch_scc0 L_spin_13
L_sdone_14:
  v_readfirstlane_b32 s46, v13
  v_min_u32 v12, 47, v0
  v_lshrrev_b32 v13, 3, v12
  v_lshlrev_b32 v13, 11, v13
  v_and_b32 v14, 1, v12
  v_lshl_add_u32 v13, v14, 10, v13
  v_bfe_u32 v14, v12, 1, 2
  v_lshl_add_u32 v13, v14, 8, v13
  v_lshlrev_b32 v12, 4, v12
  s_lshr_b32 s74, s2, 7
  s_lshl2_add_u32 s74, s4, s74
  s_mul_i32 s74, s74, 12288
  s_bfe_u32 s69, s2, 0x40003
  s_lshl4_add_u32 s74, s69, s74
  s_add_u32 s74, s74, 548864
  s_mov_b32 s22, 0x55555555
  s_mov_b32 s23, 0x55555555
  v_mov_b32 v14, s30
  v_mov_b32 v15, s31
  v_dot2c_f32_bf16 v64, v148, v163
  v_dot2c_f32_bf16 v65, v148, v10
  v_dot2c_f32_bf16 v66, v149, v163
  v_dot2c_f32_bf16 v67, v149, v10
  v_dot2c_f32_bf16 v68, v150, v163
  v_dot2c_f32_bf16 v69, v150, v10
  v_dot2c_f32_bf16 v70, v151, v163
  v_dot2c_f32_bf16 v71, v151, v10
  v_permlane32_swap_b32 v64, v68
  v_permlane32_swap_b32 v65, v69
  v_permlane32_swap_b32 v66, v70
  v_permlane32_swap_b32 v67, v71
  v_add_f32 v64, v64, v68
  v_add_f32 v65, v65, v69
  v_add_f32 v66, v66, v70
  v_add_f32 v67, v67, v71
  s_nop 0
  v_permlane16_swap_b32 v64, v66
  v_permlane16_swap_b32 v65, v67
  v_add_f32 v64, v64, v66
  v_add_f32 v65, v65, v67
  s_nop 0
  v_add_f32_dpp v64, v64, v64 row_ror:8 row_mask:0xf bank_mask:0xf
  v_add_f32_dpp v65, v65, v65 row_ror:8 row_mask:0xf bank_mask:0xf
  v_mul_f32 v64, v4, v64
  v_mul_f32 v65, v4, v65
  ds_write_b64 v8, v[64:65] offset:57856
  s_waitcnt lgkmcnt(0)
  s_lshl_b32 s75, s76, 4
  s_sub_u32 s75, s75, s78
  s_and_b32 s75, s75, s72
  s_add_u32 s78, s78, s79
  s_waitcnt vmcnt(3)
  s_cmp_gt_i32 s75, 480
  s_cbranch_scc1 L_go_15
  s_waitcnt vmcnt(2)
  s_cmp_ge_i32 s75, 0
  s_cbranch_scc1 L_go_15
  s_waitcnt vmcnt(1)
L_go_15:
  buffer_load_dwordx4 v[24:27], v1, s[12:15], s64 offen offset:256 nt
  s_memrealtime s[76:77]
  v_dot2c_f32_bf16 v72, v152, v163
  v_dot2c_f32_bf16 v73, v152, v10
  v_dot2c_f32_bf16 v74, v153, v163
  v_dot2c_f32_bf16 v75, v153, v10
  v_dot2c_f32_bf16 v76, v154, v163
  v_dot2c_f32_bf16 v77, v154, v10
  v_dot2c_f32_bf16 v78, v155, v163
  v_dot2c_f32_bf16 v79, v155, v10
  v_permlane32_swap_b32 v72, v76
  v_permlane32_swap_b32 v73, v77
  v_permlane32_swap_b32 v74, v78
  v_permlane32_swap_b32 v75, v79
  v_add_f32 v72, v72, v76
  v_add_f32 v73, v73, v77
  v_add_f32 v74, v74, v78
  v_add_f32 v75, v75, v79
  s_nop 0
  v_permlane16_swap_b32 v72, v74
  v_permlane16_swap_b32 v73, v75
  v_add_f32 v72, v72, v74
  v_add_f32 v73, v73, v75
  s_nop 0
  v_add_f32_dpp v72, v72, v72 row_ror:8 row_mask:0xf bank_mask:0xf
  v_add_f32_dpp v73, v73, v73 row_ror:8 row_mask:0xf bank_mask:0xf
  v_mul_f32 v72, v4, v72
  v_mul_f32 v73, v4, v73
  ds_write_b64 v8, v[72:73] offset:58112
  s_waitcnt lgkmcnt(0)
  s_lshl_b32 s75, s76, 4
  s_sub_u32 s75, s75, s78
  s_and_b32 s75, s75, s72
  s_add_u32 s78, s78, s79
  s_waitcnt vmcnt(3)
  s_cmp_gt_i32 s75, 480
  s_cbranch_scc1 L_go_16
  s_waitcnt vmcnt(2)
  s_cmp_ge_i32 s75, 0
  s_cbranch_scc1 L_go_16
  s_waitcnt vmcnt(1)
L_go_16:
  buffer_load_dwordx4 v[28:31], v1, s[12:15], s65 offen offset:0 nt
  s_memrealtime s[76:77]
  v_dot2c_f32_bf16 v80, v156, v163
  v_dot2c_f32_bf16 v81, v156, v10
  v_dot2c_f32_bf16 v82, v157, v163
  v_dot2c_f32_bf16 v83, v157, v10
  v_dot2c_f32_bf16 v84, v158, v163
  v_dot2c_f32_bf16 v85, v158, v10
  v_dot2c_f32_bf16 v86, v159, v163
  v_dot2c_f32_bf16 v87, v159, v10
  v_permlane32_swap_b32 v80, v84
  v_permlane32_swap_b32 v81, v85
  v_permlane32_swap_b32 v82, v86
  v_permlane32_swap_b32 v83, v87
  v_add_f32 v80, v80, v84
  v_add_f32 v81, v81, v85
  v_add_f32 v82, v82, v86
  v_add_f32 v83, v83, v87
  s_nop 0
  v_permlane16_swap_b32 v80, v82
  v_permlane16_swap_b32 v81, v83
  v_add_f32 v80, v80, v82
  v_add_f32 v81, v81, v83
  s_nop 0
  v_add_f32_dpp v80, v80, v80 row_ror:8 row_mask:0xf bank_mask:0xf
  v_add_f32_dpp v81, v81, v81 row_ror:8 row_mask:0xf bank_mask:0xf
  v_mul_f32 v80, v4, v80
  v_mul_f32 v81, v4, v81
  ds_write_b64 v8, v[80:81] offset:58368
  s_mov_b64 exec, 1
  ds_add_u32 v2, v11 offset:652
  s_mov_b64 exec, -1
  s_waitcnt lgkmcnt(0)
  s_lshl_b32 s75, s76, 4
  s_sub_u32 s75, s75, s78
  s_and_b32 s75, s75, s72
  s_add_u32 s78, s78, s79
  s_waitcnt vmcnt(3)
  s_cmp_gt_i32 s75, 480
  s_cbranch_scc1 L_go_17
  s_waitcnt vmcnt(2)
  s_cmp_ge_i32 s75, 0
  s_cbranch_scc1 L_go_17
  s_waitcnt vmcnt(1)
L_go_17:
  buffer_load_dwordx4 v[32:35], v1, s[12:15], s65 offen offset:128 nt
  s_memrealtime s[76:77]
  v_lshlrev_b32 v10, 16, v164
  v_dot2c_f32_bf16 v88, v16, v164
  v_dot2c_f32_bf16 v89, v16, v10
  v_dot2c_f32_bf16 v90, v17, v164
  v_dot2c_f32_bf16 v91, v17, v10
  v_dot2c_f32_bf16 v92, v18, v164
  v_dot2c_f32_bf16 v93, v18, v10
  v_dot2c_f32_bf16 v94, v19, v164
  v_dot2c_f32_bf16 v95, v19, v10
  s_waitcnt lgkmcnt(0)
  s_lshl_b32 s75, s76, 4
  s_sub_u32 s75, s75, s78
  s_and_b32 s75, s75, s72
  s_add_u32 s78, s78, s79
  s_waitcnt vmcnt(3)
  s_cmp_gt_i32 s75, 480
  s_cbranch_scc1 L_go_18
  s_waitcnt vmcnt(2)
  s_cmp_ge_i32 s75, 0
  s_cbranch_scc1 L_go_18
  s_waitcnt vmcnt(1)
L_go_18:
  buffer_load_dwordx4 v[36:39], v1, s[12:15], s65 offen offset:256 nt
  s_memrealtime s[76:77]
  v_dot2c_f32_bf16 v96, v20, v164
  v_dot2c_f32_bf16 v97, v20, v10
  v_dot2c_f32_bf16 v98, v21, v164
  v_dot2c_f32_bf16 v99, v21, v10
  v_dot2c_f32_bf16 v100, v22, v164
  v_dot2c_f32_bf16 v101, v22, v10
  v_dot2c_f32_bf16 v102, v23, v164
  v_dot2c_f32_bf16 v103, v23, v10
  s_waitcnt lgkmcnt(0)
  s_lshl_b32 s75, s76, 4
  s_sub_u32 s75, s75, s78
  s_and_b32 s75, s75, s72
  s_add_u32 s78, s78, s79
  s_waitcnt vmcnt(3)
  s_cmp_gt_i32 s75, 480
  s_cbranch_scc1 L_go_19
  s_waitcnt vmcnt(2)
  s_cmp_ge_i32 s75, 0
  s_cbranch_scc1 L_go_19
  s_waitcnt vmcnt(1)
L_go_19:
  buffer_load_dwordx4 v[40:43], v1, s[12:15], s66 offen offset:0 nt
  s_memrealtime s[76:77]
  v_dot2c_f32_bf16 v104, v24, v164
  v_dot2c_f32_bf16 v105, v24, v10
  v_dot2c_f32_bf16 v106, v25, v164
  v_dot2c_f32_bf16 v107, v25, v10
  v_dot2c_f32_bf16 v108, v26, v164
  v_dot2c_f32_bf16 v109, v26, v10
  v_dot2c_f32_bf16 v110, v27, v164
  v_dot2c_f32_bf16 v111, v27, v10
  s_waitcnt lgkmcnt(0)
  s_lshl_b32 s75, s76, 4
  s_sub_u32 s75, s75, s78
  s_and_b32 s75, s75, s72
  s_add_u32 s78, s78, s79
  s_waitcnt vmcnt(3)
  s_cmp_gt_i32 s75, 480
  s_cbranch_scc1 L_go_20
  s_waitcnt vmcnt(2)
  s_cmp_ge_i32 s75, 0
  s_cbranch_scc1 L_go_20
  s_waitcnt vmcnt(1)
L_go_20:
  buffer_load_dwordx4 v[44:47], v1, s[12:15], s66 offen offset:128 nt
  s_memrealtime s[76:77]
  v_lshlrev_b32 v10, 16, v165
  v_dot2c_f32_bf16 v88, v28, v165
  v_dot2c_f32_bf16 v89, v28, v10
  v_dot2c_f32_bf16 v90, v29, v165
  v_dot2c_f32_bf16 v91, v29, v10
  v_dot2c_f32_bf16 v92, v30, v165
  v_dot2c_f32_bf16 v93, v30, v10
  v_dot2c_f32_bf16 v94, v31, v165
  v_dot2c_f32_bf16 v95, v31, v10
  s_waitcnt lgkmcnt(0)
  s_lshl_b32 s75, s76, 4
  s_sub_u32 s75, s75, s78
  s_and_b32 s75, s75, s72
  s_add_u32 s78, s78, s79
  s_waitcnt vmcnt(3)
  s_cmp_gt_i32 s75, 480
  s_cbranch_scc1 L_go_21
  s_waitcnt vmcnt(2)
  s_cmp_ge_i32 s75, 0
  s_cbranch_scc1 L_go_21
  s_waitcnt vmcnt(1)
L_go_21:
  buffer_load_dwordx4 v[48:51], v1, s[12:15], s66 offen offset:256 nt
  s_memrealtime s[76:77]
  v_dot2c_f32_bf16 v96, v32, v165
  v_dot2c_f32_bf16 v97, v32, v10
  v_dot2c_f32_bf16 v98, v33, v165
  v_dot2c_f32_bf16 v99, v33, v10
  v_dot2c_f32_bf16 v100, v34, v165
  v_dot2c_f32_bf16 v101, v34, v10
  v_dot2c_f32_bf16 v102, v35, v165
  v_dot2c_f32_bf16 v103, v35, v10
  s_waitcnt lgkmcnt(0)
  s_lshl_b32 s75, s76, 4
  s_sub_u32 s75, s75, s78
  s_and_b32 s75, s75, s72
  s_add_u32 s78, s78, s79
  s_waitcnt vmcnt(3)
  s_cmp_gt_i32 s75, 480
  s_cbranch_scc1 L_go_22
  s_waitcnt vmcnt(2)
  s_cmp_ge_i32 s75, 0
  s_cbranch_scc1 L_go_22
  s_waitcnt vmcnt(1)
L_go_22:
  buffer_load_dwordx4 v[52:55], v1, s[12:15], s67 offen offset:0 nt
  s_memrealtime s[76:77]
  s_mov_b64 exec, 1
  ds_add_u32 v2, v11 offset:644
  s_mov_b64 exec, -1
  v_dot2c_f32_bf16 v104, v36, v165
  v_dot2c_f32_bf16 v105, v36, v10
  v_dot2c_f32_bf16 v106, v37, v165
  v_dot2c_f32_bf16 v107, v37, v10
  v_dot2c_f32_bf16 v108, v38, v165
  v_dot2c_f32_bf16 v109, v38, v10
  v_dot2c_f32_bf16 v110, v39, v165
  v_dot2c_f32_bf16 v111, v39, v10
  s_waitcnt lgkmcnt(0)
  s_lshl_b32 s75, s76, 4
  s_sub_u32 s75, s75, s78
  s_and_b32 s75, s75, s72
  s_add_u32 s78, s78, s79
  s_waitcnt vmcnt(3)
  s_cmp_gt_i32 s75, 480
  s_cbranch_scc1 L_go_23
  s_waitcnt vmcnt(2)
  s_cmp_ge_i32 s75, 0
  s_cbranch_scc1 L_go_23
  s_waitcnt vmcnt(1)
L_go_23:
  buffer_load_dwordx4 v[56:59], v1, s[12:15], s67 offen offset:128 nt
  s_memrealtime s[76:77]
  v_lshlrev_b32 v10, 16, v166
  v_dot2c_f32_bf16 v88, v40, v166
  v_dot2c_f32_bf16 v89, v40, v10
  v_dot2c_f32_bf16 v90, v41, v166
  v_dot2c_f32_bf16 v91, v41, v10
  v_dot2c_f32_bf16 v92, v42, v166
  v_dot2c_f32_bf16 v93, v42, v10
  v_dot2c_f32_bf16 v94, v43, v166
  v_dot2c_f32_bf16 v95, v43, v10
  s_waitcnt lgkmcnt(0)
  s_lshl_b32 s75, s76, 4
  s_sub_u32 s75, s75, s78
  s_and_b32 s75, s75, s72
  s_add_u32 s78, s78, s79
  s_waitcnt vmcnt(3)
  s_cmp_gt_i32 s75, 480
  s_cbranch_scc1 L_go_24
  s_waitcnt vmcnt(2)
  s_cmp_ge_i32 s75, 0
  s_cbranch_scc1 L_go_24
  s_waitcnt vmcnt(1)
L_go_24:
  buffer_load_dwordx4 v[60:63], v1, s[12:15], s67 offen offset:256 nt
  v_dot2c_f32_bf16 v96, v44, v166
  v_dot2c_f32_bf16 v97, v44, v10
  v_dot2c_f32_bf16 v98, v45, v166
  v_dot2c_f32_bf16 v99, v45, v10
  v_dot2c_f32_bf16 v100, v46, v166
  v_dot2c_f32_bf16 v101, v46, v10
  v_dot2c_f32_bf16 v102, v47, v166
  v_dot2c_f32_bf16 v103, v47, v10
  s_waitcnt vmcnt(3)
  v_dot2c_f32_bf16 v104, v48, v166
  v_dot2c_f32_bf16 v105, v48, v10
  v_dot2c_f32_bf16 v106, v49, v166
  v_dot2c_f32_bf16 v107, v49, v10
  v_dot2c_f32_bf16 v108, v50, v166
  v_dot2c_f32_bf16 v109, v50, v10
  v_dot2c_f32_bf16 v110, v51, v166
  v_dot2c_f32_bf16 v111, v51, v10
  s_waitcnt vmcnt(2)
  v_lshlrev_b32 v10, 16, v167
  v_dot2c_f32_bf16 v88, v52, v167
  v_dot2c_f32_bf16 v89, v52, v10
  v_dot2c_f32_bf16 v90, v53, v167
  v_dot2c_f32_bf16 v91, v53, v10
  v_dot2c_f32_bf16 v92, v54, v167
  v_dot2c_f32_bf16 v93, v54, v10
  v_dot2c_f32_bf16 v94, v55, v167
  v_dot2c_f32_bf16 v95, v55, v10
  v_permlane32_swap_b32 v88, v92
  v_permlane32_swap_b32 v89, v93
  v_permlane32_swap_b32 v90, v94
  v_permlane32_swap_b32 v91, v95
  v_add_f32 v88, v88, v92
  v_add_f32 v89, v89, v93
  v_add_f32 v90, v90, v94
  v_add_f32 v91, v91, v95
  s_nop 0
  v_permlane16_swap_b32 v88, v90
  v_permlane16_swap_b32 v89, v91
  v_add_f32 v88, v88, v90
  v_add_f32 v89, v89, v91
  s_nop 0
  v_add_f32_dpp v88, v88, v88 row_ror:8 row_mask:0xf bank_mask:0xf
  v_add_f32_dpp v89, v89, v89 row_ror:8 row_mask:0xf bank_mask:0xf
  v_mul_f32 v88, v5, v88
  v_mul_f32 v89, v5, v89
  ds_write_b64 v8, v[88:89] offset:1024
  s_waitcnt vmcnt(1)
  v_dot2c_f32_bf16 v96, v56, v167
  v_dot2c_f32_bf16 v97, v56, v10
  v_dot2c_f32_bf16 v98, v57, v167
  v_dot2c_f32_bf16 v99, v57, v10
  v_dot2c_f32_bf16 v100, v58, v167
  v_dot2c_f32_bf16 v101, v58, v10
  v_dot2c_f32_bf16 v102, v59, v167
  v_dot2c_f32_bf16 v103, v59, v10
  v_permlane32_swap_b32 v96, v100
  v_permlane32_swap_b32 v97, v101
  v_permlane32_swap_b32 v98, v102
  v_permlane32_swap_b32 v99, v103
  v_add_f32 v96, v96, v100
  v_add_f32 v97, v97, v101
  v_add_f32 v98, v98, v102
  v_add_f32 v99, v99, v103
  s_nop 0
  v_permlane16_swap_b32 v96, v98
  v_permlane16_swap_b32 v97, v99
  v_add_f32 v96, v96, v98
  v_add_f32 v97, v97, v99
  s_nop 0
  v_add_f32_dpp v96, v96, v96 row_ror:8 row_mask:0xf bank_mask:0xf
  v_add_f32_dpp v97, v97, v97 row_ror:8 row_mask:0xf bank_mask:0xf
  v_mul_f32 v96, v5, v96
  v_mul_f32 v97, v5, v97
  ds_write_b64 v8, v[96:97] offset:1280
  s_waitcnt vmcnt(0)
  v_dot2c_f32_bf16 v104, v60, v167
  v_dot2c_f32_bf16 v105, v60, v10
  v_dot2c_f32_bf16 v106, v61, v167
  v_dot2c_f32_bf16 v107, v61, v10
  v_dot2c_f32_bf16 v108, v62, v167
  v_dot2c_f32_bf16 v109, v62, v10
  v_dot2c_f32_bf16 v110, v63, v167
  v_dot2c_f32_bf16 v111, v63, v10
  v_permlane32_swap_b32 v104, v108
  v_permlane32_swap_b32 v105, v109
  v_permlane32_swap_b32 v106, v110
  v_permlane32_swap_b32 v107, v111
  v_add_f32 v104, v104, v108
  v_add_f32 v105, v105, v109
  v_add_f32 v106, v106, v110
  v_add_f32 v107, v107, v111
  s_nop 0
  v_permlane16_swap_b32 v104, v106
  v_permlane16_swap_b32 v105, v107
  v_add_f32 v104, v104, v106
  v_add_f32 v105, v105, v107
  s_nop 0
  v_add_f32_dpp v104, v104, v104 row_ror:8 row_mask:0xf bank_mask:0xf
  v_add_f32_dpp v105, v105, v105 row_ror:8 row_mask:0xf bank_mask:0xf
  v_mul_f32 v104, v5, v104
  v_mul_f32 v105, v5, v105
  ds_write_b64 v8, v[104:105] offset:1536
  s_mov_b64 exec, 1
  ds_add_rtn_u32 v10, v2, v11 offset:640
  s_mov_b64 exec, -1
  ds_read_b128 v[16:19], v12 offset:1024
  ds_read_b128 v[20:23], v12 offset:1792
  ds_read_b128 v[24:27], v12 offset:2560
  ds_read_b128 v[28:31], v12 offset:3328
  ds_read_b128 v[32:35], v12 offset:4096
  ds_read_b128 v[36:39], v12 offset:4864
  ds_read_b128 v[40:43], v12 offset:5632
  ds_read_b128 v[44:47], v12 offset:6400
  s_waitcnt lgkmcnt(8)
  v_readfirstlane_b32 s68, v10
  s_nop 0
  s_cmp_lg_u32 s68, 7
  s_cbranch_scc1 L_nopub
  s_waitcnt lgkmcnt(6)
  v_pk_add_f32 v[16:17], v[16:17], v[20:21]
  v_pk_add_f32 v[18:19], v[18:19], v[22:23]
  s_waitcnt lgkmcnt(4)
  v_pk_add_f32 v[24:25], v[24:25], v[28:29]
  v_pk_add_f32 v[26:27], v[26:27], v[30:31]
  v_pk_add_f32 v[16:17], v[16:17], v[24:25]
  v_pk_add_f32 v[18:19], v[18:19], v[26:27]
  s_waitcnt lgkmcnt(2)
  v_pk_add_f32 v[32:33], v[32:33], v[36:37]
  v_pk_add_f32 v[34:35], v[34:35], v[38:39]
  s_waitcnt lgkmcnt(0)
  v_pk_add_f32 v[40:41], v[40:41], v[44:45]
  v_pk_add_f32 v[42:43], v[42:43], v[46:47]
  v_pk_add_f32 v[32:33], v[32:33], v[40:41]
  v_pk_add_f32 v[34:35], v[34:35], v[42:43]
  v_pk_add_f32 v[4:5], v[16:17], v[32:33]
  v_pk_add_f32 v[6:7], v[18:19], v[34:35]
  v_cvt_pk_bf16_f32 v8, v4, v5
  v_cvt_pk_bf16_f32 v9, v6, v7
  v_cndmask_b32 v4, v8, v14, s[22:23]
  v_cndmask_b32 v5, v9, v15, s[22:23]
  v_cndmask_b32 v6, v14, v8, s[22:23]
  v_cndmask_b32 v7, v15, v9, s[22:23]
  s_mov_b32 exec_lo, 0xffffffff
  s_mov_b32 exec_hi, 0xffff
  buffer_store_dwordx4 v[4:7], v13, s[32:35], s74 offen
  s_mov_b64 exec, -1
  s_cmp_lg_u32 s46, 1
  s_cbranch_scc1 L_slow_25
L_back_26:
  ds_write_b32 v2, v11 offset:668
L_nopub:
  s_waitcnt lgkmcnt(0)
  s_cmp_lt_u32 s5, 20
  s_cbranch_scc1 L_notf1
  s_cmp_lt_u32 s5, 30
  s_cbranch_scc1 L_f1
  s_branch L_stream_exit
L_notf1:
  s_cmp_gt_u32 s5, 11
  s_cbranch_scc1 L_stream_exit
  s_cmp_gt_u32 s3, 6
  s_cbranch_scc1 L_f2
  s_branch L_dry
L_stream_exit:
  s_endpgm
L_helper:
  s_setprio 3
  v_lshlrev_b32 v1, 2, v0
  v_lshrrev_b32 v2, 3, v0
  s_mul_i32 s68, s7, 80
  v_add_u32 v3, s68, v2
  v_lshlrev_b32 v3, 1, v3
  v_mul_u32_u24 v2, 12288, v2
  v_and_b32 v7, 7, v0
  v_lshl_add_u32 v2, v7, 4, v2
  s_mul_i32 s68, s68, 12288
  s_mul_i32 s69, s6, 384
  s_add_u32 s68, s68, s69
  s_lshl_b32 s69, s3, 7
  s_add_u32 s68, s68, s69
  s_waitcnt lgkmcnt(0)
  s_load_dword s12, s[36:37], 0
  s_load_dword s13, s[36:37], 128
  s_load_dword s14, s[36:37], 256
  s_load_dword s15, s[36:37], 384
  s_load_dword s16, s[36:37], 512
  s_load_dword s17, s[36:37], 640
  s_load_dword s18, s[36:37], 768
  s_load_dword s19, s[36:37], 896
  s_load_dword s20, s[36:37], 1024
  s_load_dword s21, s[36:37], 1152
  s_barrier
  s_mov_b32 s8, s42
  s_mov_b32 s9, s43
  s_mov_b32 s10, 7864320
  s_mov_b32 s11, 0x20000
  s_waitcnt lgkmcnt(0)
  global_load_dword v64, v1, s[36:37] offset:0
  global_load_dword v65, v1, s[36:37] offset:256
  global_load_dword v66, v1, s[36:37] offset:512
  global_load_dword v67, v1, s[36:37] offset:768
  global_load_dword v68, v1, s[36:37] offset:1024
  global_load_ushort v8, v3, s[36:37] offset:0
  global_load_ushort v9, v3, s[36:37] offset:16
  global_load_ushort v10, v3, s[36:37] offset:32
  global_load_ushort v11, v3, s[36:37] offset:48
  global_load_ushort v12, v3, s[36:37] offset:64
  global_load_ushort v13, v3, s[36:37] offset:80
  global_load_ushort v14, v3, s[36:37] offset:96
  global_load_ushort v15, v3, s[36:37] offset:112
  global_load_ushort v16, v3, s[36:37] offset:128
  global_load_ushort v17, v3, s[36:37] offset:144
  s_load_dwordx2 s[28:29], s[58:59], 917504
  s_mov_b32 s69, 0xffff0000
  s_mov_b32 s24, s58
  s_mov_b32 s25, s59
  s_mov_b32 s26, 4194304
  s_mov_b32 s27, 0x20000
  s_add_u32 s32, s58, 4194304
  s_addc_u32 s33, s59, 0
  s_mov_b32 s34, 4194304
  s_mov_b32 s35, 0x20000
  s_lshl3_add_u32 s71, s6, s7
  s_mul_i32 s5, s79, 5
  s_mul_i32 s47, s79, 3
  s_add_u32 s47, s47, 15
  s_cmp_lt_u32 s7, 5
  s_cselect_b32 s5, s5, s47
  s_add_u32 s5, s5, s7
  s_waitcnt lgkmcnt(0)
  s_mul_i32 s30, s28, 0x2c9277b5
  s_add_u32 s30, s30, 0xac564b05
  s_mul_i32 s31, s29, 0x0019660d
  s_add_u32 s31, s31, 0x3c6ef35f
  s_waitcnt vmcnt(10)
  v_lshlrev_b32 v70, 16, v64
  v_and_b32 v71, s69, v64
  v_lshlrev_b32 v72, 16, v65
  v_and_b32 v73, s69, v65
  v_lshlrev_b32 v74, 16, v66
  v_and_b32 v75, s69, v66
  v_lshlrev_b32 v76, 16, v67
  v_and_b32 v77, s69, v67
  v_lshlrev_b32 v78, 16, v68
  v_and_b32 v79, s69, v68
  v_add_f32 v4, v70, v71
  v_add_f32 v5, v72, v73
  v_add_f32 v6, v74, v75
  v_add_f32 v7, v76, v77
  v_add_f32 v4, v4, v5
  v_add_f32 v6, v6, v7
  v_add_f32 v5, v78, v79
  v_add_f32 v4, v4, v6
  v_add_f32 v4, v4, v5
  s_nop 1
  v_add_f32_dpp v4, v4, v4 quad_perm:[1,0,3,2] row_mask:0xf bank_mask:0xf
  s_nop 1
  v_add_f32_dpp v4, v4, v4 quad_perm:[2,3,0,1] row_mask:0xf bank_mask:0xf
  s_nop 1
  v_add_f32_dpp v4, v4, v4 row_half_mirror row_mask:0xf bank_mask:0xf
  s_nop 1
  v_add_f32_dpp v4, v4, v4 row_mirror row_mask:0xf bank_mask:0xf
  v_mov_b32 v5, v4
  s_nop 1
  v_permlane16_swap_b32 v4, v5
  v_add_f32 v4, v4, v5
  v_mov_b32 v5, v4
  s_nop 1
  v_permlane32_swap_b32 v4, v5
  v_add_f32 v4, v4, v5
  v_mul_f32 v4, 0x3acccccd, v4
  v_sub_f32 v70, v70, v4
  v_sub_f32 v71, v71, v4
  v_sub_f32 v72, v72, v4
  v_sub_f32 v73, v73, v4
  v_sub_f32 v74, v74, v4
  v_sub_f32 v75, v75, v4
  v_sub_f32 v76, v76, v4
  v_sub_f32 v77, v77, v4
  v_sub_f32 v78, v78, v4
  v_sub_f32 v79, v79, v4
  v_mul_f32 v5, v70, v70
  v_fmac_f32 v5, v71, v71
  v_fmac_f32 v5, v72, v72
  v_fmac_f32 v5, v73, v73
  v_fmac_f32 v5, v74, v74
  v_fmac_f32 v5, v75, v75
  v_fmac_f32 v5, v76, v76
  v_fmac_f32 v5, v77, v77
  v_fmac_f32 v5, v78, v78
  v_fmac_f32 v5, v79, v79
  s_nop 1
  v_add_f32_dpp v5, v5, v5 quad_perm:[1,0,3,2] row_mask:0xf bank_mask:0xf
  s_nop 1
  v_add_f32_dpp v5, v5, v5 quad_perm:[2,3,0,1] row_mask:0xf bank_mask:0xf
  s_nop 1
  v_add_f32_dpp v5, v5, v5 row_half_mirror row_mask:0xf bank_mask:0xf
  s_nop 1
  v_add_f32_dpp v5, v5, v5 row_mirror row_mask:0xf bank_mask:0xf
  v_mov_b32 v6, v5
  s_nop 1
  v_permlane16_swap_b32 v5, v6
  v_add_f32 v5, v5, v6
  v_mov_b32 v6, v5
  s_nop 1
  v_permlane32_swap_b32 v5, v6
  v_add_f32 v5, v5, v6
  v_mul_f32 v5, 0x3acccccd, v5
  v_cvt_pk_bf16_f32 v4, v4, v4
  v_lshlrev_b32 v4, 16, v4
  v_cvt_pk_bf16_f32 v5, v5, v5
  v_lshlrev_b32 v5, 16, v5
  v_add_f32 v5, 0x3727c5ac, v5
  v_cvt_pk_bf16_f32 v5, v5, v5
  v_lshlrev_b32 v5, 16, v5
  v_sqrt_f32 v5, v5
  s_nop 0
  v_cvt_pk_bf16_f32 v5, v5, v5
  v_lshlrev_b32 v5, 16, v5
  v_rcp_f32 v5, v5
  v_mov_b32 v6, 0
  s_waitcnt vmcnt(0)
  v_lshlrev_b32 v8, 16, v8
  v_lshlrev_b32 v9, 16, v9
  v_lshlrev_b32 v10, 16, v10
  v_lshlrev_b32 v11, 16, v11
  v_lshlrev_b32 v12, 16, v12
  v_lshlrev_b32 v13, 16, v13
  v_lshlrev_b32 v14, 16, v14
  v_lshlrev_b32 v15, 16, v15
  v_lshlrev_b32 v16, 16, v16
  v_lshlrev_b32 v17, 16, v17
  v_sub_f32 v8, v8, v4
  v_sub_f32 v9, v9, v4
  v_sub_f32 v10, v10, v4
  v_sub_f32 v11, v11, v4
  v_sub_f32 v12, v12, v4
  v_sub_f32 v13, v13, v4
  v_sub_f32 v14, v14, v4
  v_sub_f32 v15, v15, v4
  v_sub_f32 v16, v16, v4
  v_sub_f32 v17, v17, v4
  v_cvt_pk_bf16_f32 v8, v6, v8
  v_cvt_pk_bf16_f32 v9, v6, v9
  v_cvt_pk_bf16_f32 v10, v6, v10
  v_cvt_pk_bf16_f32 v11, v6, v11
  v_cvt_pk_bf16_f32 v12, v6, v12
  v_cvt_pk_bf16_f32 v13, v6, v13
  v_cvt_pk_bf16_f32 v14, v6, v14
  v_cvt_pk_bf16_f32 v15, v6, v15
  v_cvt_pk_bf16_f32 v16, v6, v16
  v_cvt_pk_bf16_f32 v17, v6, v17
  v_mul_f32 v8, v8, v5
  v_mul_f32 v9, v9, v5
  v_mul_f32 v10, v10, v5
  v_mul_f32 v11, v11, v5
  v_mul_f32 v12, v12, v5
  v_mul_f32 v13, v13, v5
  v_mul_f32 v14, v14, v5
  v_mul_f32 v15, v15, v5
  v_mul_f32 v16, v16, v5
  v_mul_f32 v17, v17, v5
  v_cvt_pk_bf16_f32 v70, v6, v8
  v_cvt_pk_bf16_f32 v8, v8, v6
  v_cvt_pk_bf16_f32 v71, v6, v9
  v_cvt_pk_bf16_f32 v9, v9, v6
  v_cvt_pk_bf16_f32 v72, v6, v10
  v_cvt_pk_bf16_f32 v10, v10, v6
  v_cvt_pk_bf16_f32 v73, v6, v11
  v_cvt_pk_bf16_f32 v11, v11, v6
  v_cvt_pk_bf16_f32 v74, v6, v12
  v_cvt_pk_bf16_f32 v12, v12, v6
  v_cvt_pk_bf16_f32 v75, v6, v13
  v_cvt_pk_bf16_f32 v13, v13, v6
  v_cvt_pk_bf16_f32 v76, v6, v14
  v_cvt_pk_bf16_f32 v14, v14, v6
  v_cvt_pk_bf16_f32 v77, v6, v15
  v_cvt_pk_bf16_f32 v15, v15, v6
  v_cvt_pk_bf16_f32 v78, v6, v16
  v_cvt_pk_bf16_f32 v16, v16, v6
  v_cvt_pk_bf16_f32 v79, v6, v17
  v_cvt_pk_bf16_f32 v17, v17, v6
  v_mov_b32 v80, 0
  v_mov_b32 v81, 0
  v_mov_b32 v82, 0
  v_mov_b32 v83, 0
  v_mov_b32 v84, 0
  v_mov_b32 v85, 0
  v_mov_b32 v86, 0
  v_mov_b32 v87, 0
  v_and_b32 v90, 7, v0
  v_lshrrev_b32 v6, 4, v0
  v_lshl_add_u32 v90, v90, 2, v6
  v_lshlrev_b32 v90, 4, v90
  s_lshl_b32 s64, s71, 11
  s_lshl_b32 s69, s3, 9
  s_add_u32 s64, s64, s69
  s_waitcnt vmcnt(9)
  v_dot2c_f32_bf16 v80, v24, v8
  v_dot2c_f32_bf16 v81, v24, v70
  v_dot2c_f32_bf16 v82, v25, v8
  v_dot2c_f32_bf16 v83, v25, v70
  v_dot2c_f32_bf16 v84, v26, v8
  v_dot2c_f32_bf16 v85, v26, v70
  v_dot2c_f32_bf16 v86, v27, v8
  v_dot2c_f32_bf16 v87, v27, v70
  s_waitcnt vmcnt(8)
  v_dot2c_f32_bf16 v80, v28, v9
  v_dot2c_f32_bf16 v81, v28, v71
  v_dot2c_f32_bf16 v82, v29, v9
  v_dot2c_f32_bf16 v83, v29, v71
  v_dot2c_f32_bf16 v84, v30, v9
  v_dot2c_f32_bf16 v85, v30, v71
  v_dot2c_f32_bf16 v86, v31, v9
  v_dot2c_f32_bf16 v87, v31, v71
  s_waitcnt vmcnt(7)
  v_dot2c_f32_bf16 v80, v32, v10
  v_dot2c_f32_bf16 v81, v32, v72
  v_dot2c_f32_bf16 v82, v33, v10
  v_dot2c_f32_bf16 v83, v33, v72
  v_dot2c_f32_bf16 v84, v34, v10
  v_dot2c_f32_bf16 v85, v34, v72
  v_dot2c_f32_bf16 v86, v35, v10
  v_dot2c_f32_bf16 v87, v35, v72
  s_waitcnt vmcnt(6)
  v_dot2c_f32_bf16 v80, v36, v11
  v_dot2c_f32_bf16 v81, v36, v73
  v_dot2c_f32_bf16 v82, v37, v11
  v_dot2c_f32_bf16 v83, v37, v73
  v_dot2c_f32_bf16 v84, v38, v11
  v_dot2c_f32_bf16 v85, v38, v73
  v_dot2c_f32_bf16 v86, v39, v11
  v_dot2c_f32_bf16 v87, v39, v73
  s_waitcnt vmcnt(5)
  v_dot2c_f32_bf16 v80, v40, v12
  v_dot2c_f32_bf16 v81, v40, v74
  v_dot2c_f32_bf16 v82, v41, v12
  v_dot2c_f32_bf16 v83, v41, v74
  v_dot2c_f32_bf16 v84, v42, v12
  v_dot2c_f32_bf16 v85, v42, v74
  v_dot2c_f32_bf16 v86, v43, v12
  v_dot2c_f32_bf16 v87, v43, v74
  s_waitcnt vmcnt(4)
  v_dot2c_f32_bf16 v80, v44, v13
  v_dot2c_f32_bf16 v81, v44, v75
  v_dot2c_f32_bf16 v82, v45, v13
  v_dot2c_f32_bf16 v83, v45, v75
  v_dot2c_f32_bf16 v84, v46, v13
  v_dot2c_f32_bf16 v85, v46, v75
  v_dot2c_f32_bf16 v86, v47, v13
  v_dot2c_f32_bf16 v87, v47, v75
  s_waitcnt vmcnt(3)
  v_dot2c_f32_bf16 v80, v48, v14
  v_dot2c_f32_bf16 v81, v48, v76
  v_dot2c_f32_bf16 v82, v49, v14
  v_dot2c_f32_bf16 v83, v49, v76
  v_dot2c_f32_bf16 v84, v50, v14
  v_dot2c_f32_bf16 v85, v50, v76
  v_dot2c_f32_bf16 v86, v51, v14
  v_dot2c_f32_bf16 v87, v51, v76
  s_waitcnt vmcnt(2)
  v_dot2c_f32_bf16 v80, v52, v15
  v_dot2c_f32_bf16 v81, v52, v77
  v_dot2c_f32_bf16 v82, v53, v15
  v_dot2c_f32_bf16 v83, v53, v77
  v_dot2c_f32_bf16 v84, v54, v15
  v_dot2c_f32_bf16 v85, v54, v77
  v_dot2c_f32_bf16 v86, v55, v15
  v_dot2c_f32_bf16 v87, v55, v77
  s_waitcnt vmcnt(1)
  v_dot2c_f32_bf16 v80, v56, v16
  v_dot2c_f32_bf16 v81, v56, v78
  v_dot2c_f32_bf16 v82, v57, v16
  v_dot2c_f32_bf16 v83, v57, v78
  v_dot2c_f32_bf16 v84, v58, v16
  v_dot2c_f32_bf16 v85, v58, v78
  v_dot2c_f32_bf16 v86, v59, v16
  v_dot2c_f32_bf16 v87, v59, v78
  s_waitcnt vmcnt(0)
  v_dot2c_f32_bf16 v80, v60, v17
  v_dot2c_f32_bf16 v81, v60, v79
  v_dot2c_f32_bf16 v82, v61, v17
  v_dot2c_f32_bf16 v83, v61, v79
  v_dot2c_f32_bf16 v84, v62, v17
  v_dot2c_f32_bf16 v85, v62, v79
  v_dot2c_f32_bf16 v86, v63, v17
  v_dot2c_f32_bf16 v87, v63, v79
  v_permlane32_swap_b32 v80, v84
  v_permlane32_swap_b32 v81, v85
  v_permlane32_swap_b32 v82, v86
  v_permlane32_swap_b32 v83, v87
  v_add_f32 v80, v80, v84
  v_add_f32 v81, v81, v85
  v_add_f32 v82, v82, v86
  v_add_f32 v83, v83, v87
  s_nop 0
  v_permlane16_swap_b32 v80, v82
  v_permlane16_swap_b32 v81, v83
  v_add_f32 v80, v80, v82
  v_add_f32 v81, v81, v83
  s_nop 0
  v_add_f32_dpp v80, v80, v80 row_ror:8 row_mask:0xf bank_mask:0xf
  v_add_f32_dpp v81, v81, v81 row_ror:8 row_mask:0xf bank_mask:0xf
  v_mov_b32 v82, s30
  v_mov_b32 v83, s31
  s_mov_b32 exec_lo, 0xff00ff
  s_mov_b32 exec_hi, 0xff00ff
  buffer_store_dwordx4 v[80:83], v90, s[32:35], s64 offen offset:0
  s_mov_b64 exec, -1
  v_and_b32 v3, 31, v0
  v_lshrrev_b32 v2, 5, v0
  v_lshlrev_b32 v2, 11, v2
  v_lshl_add_u32 v2, v3, 4, v2
  s_lshl_b32 s68, s6, 14
  s_add_u32 s60, s68, s69
  s_add_u32 s61, s60, 4096
  s_add_u32 s62, s60, 8192
  s_add_u32 s63, s60, 12288
  v_lshlrev_b32 v3, 2, v3
  s_lshl_b32 s69, s3, 7
  v_add_u32 v3, s69, v3
  v_mov_b32 v1, 0
  s_mov_b32 s65, 0
  s_add_u32 s68, s3, 5
  s_cmp_lg_u32 s68, s7
  s_cbranch_scc1 L_qwait
  s_mov_b32 s16, s32
  s_mov_b32 s17, s33
  s_mov_b32 s18, 4194304
  s_mov_b32 s19, 0x20000
  s_mov_b32 s70, 4000007
L_spin_27:
  buffer_load_dwordx4 v[8:11], v2, s[16:19], s60 offen offset:0 sc1 nt
  buffer_load_dwordx4 v[12:15], v2, s[16:19], s61 offen offset:0 sc1 nt
  buffer_load_dwordx4 v[16:19], v2, s[16:19], s62 offen offset:0 sc1 nt
  buffer_load_dwordx4 v[20:23], v2, s[16:19], s63 offen offset:0 sc1 nt
  s_waitcnt vmcnt(0)
  v_cmp_ne_u64 vcc, s[30:31], v[10:11]
  v_cmp_ne_u64 s[20:21], s[30:31], v[14:15]
  v_cmp_ne_u64 s[22:23], s[30:31], v[18:19]
  s_or_b64 vcc, vcc, s[20:21]
  v_cmp_ne_u64 s[20:21], s[30:31], v[22:23]
  s_or_b64 vcc, vcc, s[22:23]
  s_or_b64 vcc, vcc, s[20:21]
  s_nop 0
  s_cbranch_vccz L_sdone_28
  s_sleep 2
  ds_read_b32 v4, v1 offset:648
  s_waitcnt lgkmcnt(0)
  v_readfirstlane_b32 s46, v4
  s_nop 0
  s_sub_u32 s68, s46, s65
  s_cmp_lg_u32 s68, 2
  s_cbranch_scc1 L_qlazy_29
  s_mov_b32 exec_lo, 0xff00ff
  s_mov_b32 exec_hi, 0xff00ff
  buffer_store_dwordx4 v[80:83], v90, s[24:27], s64 offen offset:0 sc1
  s_mov_b64 exec, -1
  s_mov_b32 s65, 1
L_qlazy_29:
  s_and_b32 s99, s70, 7
  s_cselect_b32 s16, s32, s24
  s_cselect_b32 s17, s33, s25
  s_sub_u32 s70, s70, 1
  s_cbranch_scc0 L_spin_27
L_sdone_28:
  v_add_f32 v8, v8, v12
  v_add_f32 v9, v9, v13
  v_add_f32 v16, v16, v20
  v_add_f32 v17, v17, v21
  v_add_f32 v8, v8, v16
  v_add_f32 v9, v9, v17
  v_mov_b32 v10, v8
  v_mov_b32 v11, v9
  s_nop 0
  v_permlane32_swap_b32 v8, v10
  v_permlane32_swap_b32 v9, v11
  v_add_f32 v8, v8, v10
  v_add_f32 v9, v9, v11
  v_cvt_pk_bf16_f32 v8, v8, v9
  s_lshl_b32 s66, s6, 14
  s_lshl_b32 s68, s3, 11
  s_add_u32 s66, s66, s68
  v_mov_b32_dpp v9, v8 quad_perm:[1,0,3,2] row_mask:0xf bank_mask:0xf
  v_mov_b32 v10, s30
  v_mov_b32 v11, s31
  v_lshlrev_b32 v2, 3, v0
  v_mov_b32 v1, 0
  s_mov_b32 s70, 4000007
L_spin_30:
  ds_read_b32 v4, v1 offset:648
  s_waitcnt lgkmcnt(0)
  v_cmp_gt_u32 vcc, 1, v4
  s_nop 0
  s_cbranch_vccz L_sdone_31
  s_sleep 2
  s_sub_u32 s70, s70, 1
  s_cbranch_scc0 L_spin_30
L_sdone_31:
  v_readfirstlane_b32 s46, v4
  s_mov_b32 exec_lo, 0x55555555
  s_mov_b32 exec_hi, 0x0
  buffer_store_dwordx4 v[8:11], v2, s[32:35], s66 offen offset:1536
  s_mov_b64 exec, -1
  s_cmp_lg_u32 s46, 1
  s_cbranch_scc1 L_slow_32
L_back_33:
  s_branch L_qget
L_qwait:
  s_sleep 40
L_qget:
  s_lshr_b32 s66, s2, 7
  s_lshl2_add_u32 s66, s4, s66
  s_lshl_b32 s66, s66, 14
  s_lshl_b32 s68, s3, 11
  s_add_u32 s66, s66, s68
  v_and_b32 v2, 15, v0
  v_bfe_u32 v5, v0, 4, 1
  v_lshlrev_b32 v3, 3, v2
  v_add_u32 v3, s69, v3
  v_lshl_add_u32 v3, v5, 13, v3
  v_lshlrev_b32 v2, 4, v2
  v_lshl_add_u32 v2, v5, 15, v2
  s_mov_b32 s16, s32
  s_mov_b32 s17, s33
  s_mov_b32 s18, 4194304
  s_mov_b32 s19, 0x20000
  s_mov_b32 s70, 4000007
L_spin_34:
  buffer_load_dwordx4 v[12:15], v2, s[16:19], s66 offen offset:1536 sc1 nt
  s_waitcnt vmcnt(0)
  v_cmp_ne_u64 vcc, s[30:31], v[14:15]
  s_nop 0
  s_cbranch_vccz L_sdone_35
  s_sleep 8
  ds_read_b32 v4, v1 offset:648
  s_waitcnt lgkmcnt(0)
  v_readfirstlane_b32 s46, v4
  s_nop 0
  s_sub_u32 s68, s46, s65
  s_cmp_lg_u32 s68, 2
  s_cbranch_scc1 L_qlazy_36
  s_mov_b32 exec_lo, 0xff00ff
  s_mov_b32 exec_hi, 0xff00ff
  buffer_store_dwordx4 v[80:83], v90, s[24:27], s64 offen offset:0 sc1
  s_mov_b64 exec, -1
  s_mov_b32 s65, 1
L_qlazy_36:
  s_and_b32 s99, s70, 7
  s_cselect_b32 s16, s32, s24
  s_cselect_b32 s17, s33, s25
  s_sub_u32 s70, s70, 1
  s_cbranch_scc0 L_spin_34
L_sdone_35:
  ds_write_b64 v3, v[12:13] offset:0
  s_lshl_b32 s69, s3, 3
  v_mov_b32 v4, s69
  v_mov_b32 v6, 1
  s_waitcnt lgkmcnt(0)
  ds_write_b32 v4, v6 offset:384
  v_mov_b32 v1, 0
  s_mov_b32 s70, 4000007
L_spin_37:
  ds_read_b32 v4, v1 offset:648
  s_waitcnt lgkmcnt(0)
  v_cmp_gt_u32 vcc, 1, v4
  s_nop 0
  s_cbranch_vccz L_sdone_38
  s_sleep 2
  s_sub_u32 s70, s70, 1
  s_cbranch_scc0 L_spin_37
L_sdone_38:
  v_readfirstlane_b32 s46, v4
  ds_read_b32 v4, v1 offset:648
  s_waitcnt lgkmcnt(0)
  v_readfirstlane_b32 s46, v4
  s_nop 0
  s_sub_u32 s68, s46, s65
  s_cmp_lg_u32 s68, 2
  s_cbranch_scc1 L_qlazy_39
  s_mov_b32 exec_lo, 0xff00ff
  s_mov_b32 exec_hi, 0xff00ff
  buffer_store_dwordx4 v[80:83], v90, s[24:27], s64 offen offset:0 sc1
  s_mov_b64 exec, -1
  s_mov_b32 s65, 1
L_qlazy_39:
  s_branch L_stats
L_ids:
  s_setprio 3
  s_getreg_b32 s64, hwreg(HW_REG_XCC_ID)
  s_mov_b32 s24, s58
  s_mov_b32 s25, s59
  s_mov_b32 s26, 4194304
  s_mov_b32 s27, 0x20000
  s_add_u32 s32, s58, 4194304
  s_addc_u32 s33, s59, 0
  s_mov_b32 s34, 4194304
  s_mov_b32 s35, 0x20000
  s_lshl3_add_u32 s71, s6, s7
  s_mul_i32 s5, s79, 5
  s_mul_i32 s47, s79, 3
  s_add_u32 s47, s47, 15
  s_cmp_lt_u32 s7, 5
  s_cselect_b32 s5, s5, s47
  s_add_u32 s5, s5, s7
  s_waitcnt lgkmcnt(0)
  s_mul_i32 s30, s28, 0x2c9277b5
  s_add_u32 s30, s30, 0xac564b05
  s_mul_i32 s31, s29, 0x0019660d
  s_add_u32 s31, s31, 0x3c6ef35f
  s_and_b32 s64, s64, 15
  v_mov_b32 v4, s30
  v_mov_b32 v5, s31
  v_mov_b32 v6, s64
  v_mov_b32 v7, s64
  s_lshl_b32 s68, s4, 9
  s_add_u32 s68, s68, 2080768
  s_lshr_b32 s65, s2, 3
  s_lshl_b32 s69, s65, 4
  v_mov_b32 v1, s69
  s_mov_b64 exec, 1
  buffer_store_dwordx4 v[4:7], v1, s[32:35], s68 offen
  s_mov_b64 exec, -1
  s_cmp_lg_u32 s65, 31
  s_cbranch_scc1 L_noinit
  v_lshlrev_b32 v12, 8, v0
  s_lshl_b32 s69, s4, 15
  s_add_u32 s69, s69, 1703936
  s_mov_b32 exec_lo, 0x8040201
  s_mov_b32 exec_hi, 0x8040201
  buffer_store_dword v4, v12, s[24:27], s69 offen sc1
  s_mov_b64 exec, -1
L_noinit:
  v_and_b32 v1, 31, v0
  v_lshlrev_b32 v1, 4, v1
  s_mov_b32 s70, 12
  s_mov_b32 s46, 2
L_idpoll:
  s_sleep 16
  buffer_load_dwordx4 v[8:11], v1, s[32:35], s68 offen sc1 nt
  s_waitcnt vmcnt(0)
  v_cmp_ne_u64 vcc, s[30:31], v[8:9]
  s_nop 0
  s_cbranch_vccz L_iddone
  s_sub_u32 s70, s70, 1
  s_cbranch_scc0 L_idpoll
  s_branch L_idset
L_iddone:
  v_cmp_ne_u32 vcc, s64, v10
  s_nop 0
  s_cbranch_vccnz L_idset
  s_mov_b32 s46, 1
L_idset:
  v_mov_b32 v1, 0
  v_mov_b32 v4, s46
  ds_write_b32 v1, v4 offset:648
  s_cmp_lg_u32 s65, 31
  s_cbranch_scc1 L_pf
  s_lshl_b32 s69, s4, 15
  s_add_u32 s69, s69, 1703936
  s_add_u32 s22, s58, s69
  s_addc_u32 s23, s59, 0
  s_waitcnt lgkmcnt(0)
  s_mov_b32 s8, -1
  s_mov_b32 s9, -1
  s_memtime s[12:13]
  s_waitcnt lgkmcnt(0)
  s_load_dword s10, s[22:23], 0
  s_waitcnt lgkmcnt(0)
  s_memtime s[14:15]
  s_waitcnt lgkmcnt(0)
  s_sub_u32 s11, s14, s12
  s_min_u32 s8, s8, s11
  s_waitcnt lgkmcnt(0)
  s_load_dword s10, s[22:23], 8192
  s_waitcnt lgkmcnt(0)
  s_memtime s[12:13]
  s_waitcnt lgkmcnt(0)
  s_sub_u32 s11, s12, s14
  s_min_u32 s9, s9, s11
  s_waitcnt lgkmcnt(0)
  s_load_dword s10, s[22:23], 10496
  s_waitcnt lgkmcnt(0)
  s_memtime s[14:15]
  s_waitcnt lgkmcnt(0)
  s_sub_u32 s11, s14, s12
  s_min_u32 s9, s9, s11
  s_waitcnt lgkmcnt(0)
  s_load_dword s10, s[22:23], 2304
  s_waitcnt lgkmcnt(0)
  s_memtime s[12:13]
  s_waitcnt lgkmcnt(0)
  s_sub_u32 s11, s12, s14
  s_min_u32 s8, s8, s11
  s_waitcnt lgkmcnt(0)
  s_load_dword s10, s[22:23], 4608
  s_waitcnt lgkmcnt(0)
  s_memtime s[14:15]
  s_waitcnt lgkmcnt(0)
  s_sub_u32 s11, s14, s12
  s_min_u32 s8, s8, s11
  s_waitcnt lgkmcnt(0)
  s_load_dword s10, s[22:23], 12800
  s_waitcnt lgkmcnt(0)
  s_memtime s[12:13]
  s_waitcnt lgkmcnt(0)
  s_sub_u32 s11, s12, s14
  s_min_u32 s9, s9, s11
  s_waitcnt lgkmcnt(0)
  s_load_dword s10, s[22:23], 15104
  s_waitcnt lgkmcnt(0)
  s_memtime s[14:15]
  s_waitcnt lgkmcnt(0)
  s_sub_u32 s11, s14, s12
  s_min_u32 s9, s9, s11
  s_waitcnt lgkmcnt(0)
  s_load_dword s10, s[22:23], 6912
  s_waitcnt lgkmcnt(0)
  s_memtime s[12:13]
  s_waitcnt lgkmcnt(0)
  s_sub_u32 s11, s12, s14
  s_min_u32 s8, s8, s11
  s_cmp_gt_u32 s8, s9
  s_cselect_b32 s21, 1, 0
  v_mov_b32 v4, s21
  v_mov_b32 v5, s62
  v_mov_b32 v6, s30
  v_mov_b32 v7, s31
  s_lshl_b32 s69, s4, 4
  s_add_u32 s69, s69, 950272
  s_mov_b64 exec, 1
  buffer_store_dwordx4 v[4:7], v1, s[24:27], s69 offen sc1
  s_mov_b64 exec, -1
L_pf:
  s_cmp_lg_u32 s7, 6
  s_cbranch_scc1 L_nosample
  v_mov_b32 v1, 0
  s_mov_b32 s70, 4000007
L_spin_40:
  ds_read_b64 v[4:5], v1 offset:696
  s_waitcnt lgkmcnt(0)
  v_cmp_gt_u32 vcc, 8, v5
  s_nop 0
  s_cbranch_vccz L_sdone_41
  s_sleep 2
  s_sub_u32 s70, s70, 1
  s_cbranch_scc0 L_spin_40
L_sdone_41:
  v_mov_b32 v5, s31
  v_lshlrev_b32 v6, 9, v0
  s_lshl_b32 s68, s6, 3
  s_add_u32 s68, s68, 958464
  s_mov_b64 exec, 7
  buffer_store_dwordx2 v[4:5], v6, s[24:27], s68 offen sc1
  s_mov_b64 exec, -1
L_nosample:
  v_mov_b32 v1, 0
  s_mov_b32 s70, 4000007
L_spin_42:
  ds_read_b32 v12, v1 offset:692
  s_waitcnt lgkmcnt(0)
  v_cmp_gt_u32 vcc, 8, v12
  s_nop 0
  s_cbranch_vccz L_sdone_43
  s_sleep 4
  s_sub_u32 s70, s70, 1
  s_cbranch_scc0 L_spin_42
L_sdone_43:
  s_add_u32 s60, s58, 958464
  s_addc_u32 s61, s59, 0
  s_mov_b32 s70, 2
L_calpoll:
  s_lshl_b32 s96, s62, 8
  s_sub_u32 s96, 0, s96
  s_mov_b32 s97, 0
  s_load_dwordx16 s[8:23], s[60:61], 0
  s_load_dwordx16 s[80:95], s[60:61], 64
  s_waitcnt lgkmcnt(0)
  s_add_u32 s96, s96, s8
  s_cmp_lg_u32 s9, s31
  s_addc_u32 s97, s97, 0
  s_add_u32 s96, s96, s10
  s_cmp_lg_u32 s11, s31
  s_addc_u32 s97, s97, 0
  s_add_u32 s96, s96, s12
  s_cmp_lg_u32 s13, s31
  s_addc_u32 s97, s97, 0
  s_add_u32 s96, s96, s14
  s_cmp_lg_u32 s15, s31
  s_addc_u32 s97, s97, 0
  s_add_u32 s96, s96, s16
  s_cmp_lg_u32 s17, s31
  s_addc_u32 s97, s97, 0
  s_add_u32 s96, s96, s18
  s_cmp_lg_u32 s19, s31
  s_addc_u32 s97, s97, 0
  s_add_u32 s96, s96, s20
  s_cmp_lg_u32 s21, s31
  s_addc_u32 s97, s97, 0
  s_add_u32 s96, s96, s22
  s_cmp_lg_u32 s23, s31
  s_addc_u32 s97, s97, 0
  s_add_u32 s96, s96, s80
  s_cmp_lg_u32 s81, s31
  s_addc_u32 s97, s97, 0
  s_add_u32 s96, s96, s82
  s_cmp_lg_u32 s83, s31
  s_addc_u32 s97, s97, 0
  s_add_u32 s96, s96, s84
  s_cmp_lg_u32 s85, s31
  s_addc_u32 s97, s97, 0
  s_add_u32 s96, s96, s86
  s_cmp_lg_u32 s87, s31
  s_addc_u32 s97, s97, 0
  s_add_u32 s96, s96, s88
  s_cmp_lg_u32 s89, s31
  s_addc_u32 s97, s97, 0
  s_add_u32 s96, s96, s90
  s_cmp_lg_u32 s91, s31
  s_addc_u32 s97, s97, 0
  s_add_u32 s96, s96, s92
  s_cmp_lg_u32 s93, s31
  s_addc_u32 s97, s97, 0
  s_add_u32 s96, s96, s94
  s_cmp_lg_u32 s95, s31
  s_addc_u32 s97, s97, 0
  s_load_dwordx16 s[8:23], s[60:61], 128
  s_load_dwordx16 s[80:95], s[60:61], 192
  s_waitcnt lgkmcnt(0)
  s_add_u32 s96, s96, s8
  s_cmp_lg_u32 s9, s31
  s_addc_u32 s97, s97, 0
  s_add_u32 s96, s96, s10
  s_cmp_lg_u32 s11, s31
  s_addc_u32 s97, s97, 0
  s_add_u32 s96, s96, s12
  s_cmp_lg_u32 s13, s31
  s_addc_u32 s97, s97, 0
  s_add_u32 s96, s96, s14
  s_cmp_lg_u32 s15, s31
  s_addc_u32 s97, s97, 0
  s_add_u32 s96, s96, s16
  s_cmp_lg_u32 s17, s31
  s_addc_u32 s97, s97, 0
  s_add_u32 s96, s96, s18
  s_cmp_lg_u32 s19, s31
  s_addc_u32 s97, s97, 0
  s_add_u32 s96, s96, s20
  s_cmp_lg_u32 s21, s31
  s_addc_u32 s97, s97, 0
  s_add_u32 s96, s96, s22
  s_cmp_lg_u32 s23, s31
  s_addc_u32 s97, s97, 0
  s_add_u32 s96, s96, s80
  s_cmp_lg_u32 s81, s31
  s_addc_u32 s97, s97, 0
  s_add_u32 s96, s96, s82
  s_cmp_lg_u32 s83, s31
  s_addc_u32 s97, s97, 0
  s_add_u32 s96, s96, s84
  s_cmp_lg_u32 s85, s31
  s_addc_u32 s97, s97, 0
  s_add_u32 s96, s96, s86
  s_cmp_lg_u32 s87, s31
  s_addc_u32 s97, s97, 0
  s_add_u32 s96, s96, s88
  s_cmp_lg_u32 s89, s31
  s_addc_u32 s97, s97, 0
  s_add_u32 s96, s96, s90
  s_cmp_lg_u32 s91, s31
  s_addc_u32 s97, s97, 0
  s_add_u32 s96, s96, s92
  s_cmp_lg_u32 s93, s31
  s_addc_u32 s97, s97, 0
  s_add_u32 s96, s96, s94
  s_cmp_lg_u32 s95, s31
  s_addc_u32 s97, s97, 0
  s_cmp_eq_u32 s97, 0
  s_cbranch_scc1 L_calok
  s_add_u32 s60, s60, 512
  s_addc_u32 s61, s61, 0
  s_sub_u32 s70, s70, 1
  s_cbranch_scc1 L_stats
  s_sleep 20
  s_branch L_calpoll
L_calok:
  s_ashr_i32 s96, s96, 4
  s_mov_b32 s68, 112
  s_cmp_lt_u32 s5, 30
  s_cselect_b32 s68, -208, s68
  s_cmp_lt_u32 s5, 20
  s_cselect_b32 s68, 112, s68
  s_lshl4_add_u32 s68, s62, s68
  s_add_u32 s68, s68, s96
  v_mov_b32 v12, s68
  v_mov_b32 v13, -1
  ds_write_b64 v1, v[12:13] offset:680
L_stats:
  v_and_b32 v1, 7, v0
  v_lshlrev_b32 v1, 4, v1
  s_mov_b32 s70, 4000007
L_spin_44:
  ds_read_b128 v[4:7], v1 offset:512
  s_waitcnt lgkmcnt(0)
  v_cmp_eq_u32 vcc, 0, v7
  s_nop 0
  s_cbranch_vccz L_sdone_45
  s_sleep 4
  s_sub_u32 s70, s70, 1
  s_cbranch_scc0 L_spin_44
L_sdone_45:
  s_cmp_lg_u32 s3, 3
  s_cbranch_scc1 L_nostat
  v_and_b32 v12, 8, v0
  v_cmp_ne_u32 vcc, 0, v12
  v_lshlrev_b32 v12, 6, v12
  s_nop 0
  v_cndmask_b32 v4, v4, v6, vcc
  v_cndmask_b32 v5, v5, v7, vcc
  s_mov_b32 s68, 0x3fb8aa3b
  v_mov_b32 v2, v4
  s_nop 1
  v_max_f32_dpp v2, v2, v2 quad_perm:[1,0,3,2] row_mask:0xf bank_mask:0xf
  s_nop 1
  v_max_f32_dpp v2, v2, v2 quad_perm:[2,3,0,1] row_mask:0xf bank_mask:0xf
  s_nop 1
  v_max_f32_dpp v2, v2, v2 row_half_mirror row_mask:0xf bank_mask:0xf
  v_sub_f32 v4, v4, v2
  v_mul_f32 v4, s68, v4
  v_exp_f32 v4, v4
  s_nop 0
  v_mul_f32 v3, v4, v5
  s_nop 1
  v_add_f32_dpp v3, v3, v3 quad_perm:[1,0,3,2] row_mask:0xf bank_mask:0xf
  s_nop 1
  v_add_f32_dpp v3, v3, v3 quad_perm:[2,3,0,1] row_mask:0xf bank_mask:0xf
  s_nop 1
  v_add_f32_dpp v3, v3, v3 row_half_mirror row_mask:0xf bank_mask:0xf
  s_lshr_b32 s68, s2, 7
  s_lshl2_add_u32 s68, s4, s68
  s_bfe_u32 s69, s2, 0x40003
  s_lshl4_add_u32 s68, s68, s69
  s_lshl_b32 s68, s68, 4
  s_add_u32 s68, s68, 2064384
  v_mov_b32 v4, s30
  v_mov_b32 v5, s31
  s_mov_b32 exec_lo, 0x101
  s_mov_b32 exec_hi, 0x0
  buffer_store_dwordx4 v[2:5], v12, s[32:35], s68 offen
  s_mov_b64 exec, -1
  s_cmp_lg_u32 s46, 1
  s_cbranch_scc1 L_slow_46
L_back_47:
  s_mov_b32 s68, 950272
  s_mov_b32 s70, 4000007
L_spin_48:
  buffer_load_dwordx4 v[8:11], v1, s[24:27], s68 offen sc1
  s_waitcnt vmcnt(0)
  v_cmp_ne_u64 vcc, s[30:31], v[10:11]
  s_nop 0
  s_cbranch_vccz L_sdone_49
  s_sleep 8
  s_sub_u32 s70, s70, 1
  s_cbranch_scc0 L_spin_48
L_sdone_49:
  v_cmp_ne_u32 vcc, 0, v8
  s_nop 0
  s_and_b32 s67, vcc_lo, 0xff
  s_bitset1_b32 s67, 8
  v_mov_b32 v4, s67
  v_mov_b32 v1, 0
  ds_write_b32 v1, v4 offset:660
L_nostat:
  s_cmp_lg_u32 s3, 2
  s_cbranch_scc1 L_noa
  v_min_u32 v12, 47, v0
  v_lshrrev_b32 v13, 3, v12
  v_lshlrev_b32 v13, 11, v13
  v_and_b32 v14, 1, v12
  v_lshl_add_u32 v13, v14, 10, v13
  v_bfe_u32 v14, v12, 1, 2
  v_lshl_add_u32 v13, v14, 8, v13
  v_lshlrev_b32 v12, 4, v12
  s_lshr_b32 s74, s2, 7
  s_lshl2_add_u32 s74, s4, s74
  s_mul_i32 s74, s74, 12288
  s_bfe_u32 s69, s2, 0x40003
  s_lshl4_add_u32 s74, s69, s74
  s_add_u32 s74, s74, 524288
  s_mov_b32 s22, 0x55555555
  s_mov_b32 s23, 0x55555555
  v_mov_b32 v14, s30
  v_mov_b32 v15, s31
  v_mov_b32 v1, 0
  s_mov_b32 s70, 4000007
L_spin_50:
  ds_read_b32 v4, v1 offset:652
  s_waitcnt lgkmcnt(0)
  v_cmp_gt_u32 vcc, 8, v4
  s_nop 0
  s_cbranch_vccz L_sdone_51
  s_sleep 4
  s_sub_u32 s70, s70, 1
  s_cbranch_scc0 L_spin_50
L_sdone_51:
  v_mov_b32 v1, 0
  s_mov_b32 s70, 4000007
L_spin_52:
  ds_read_b32 v4, v1 offset:644
  s_waitcnt lgkmcnt(0)
  v_cmp_gt_u32 vcc, 1, v4
  s_nop 0
  s_cbranch_vccz L_sdone_53
  s_sleep 2
  s_sub_u32 s70, s70, 1
  s_cbranch_scc0 L_spin_52
L_sdone_53:
  ds_read_b128 v[16:19], v12 offset:57856
  ds_read_b128 v[20:23], v12 offset:58624
  ds_read_b128 v[24:27], v12 offset:59392
  ds_read_b128 v[28:31], v12 offset:60160
  ds_read_b128 v[32:35], v12 offset:60928
  ds_read_b128 v[36:39], v12 offset:61696
  ds_read_b128 v[40:43], v12 offset:62464
  ds_read_b128 v[44:47], v12 offset:63232
  s_waitcnt lgkmcnt(6)
  v_pk_add_f32 v[16:17], v[16:17], v[20:21]
  v_pk_add_f32 v[18:19], v[18:19], v[22:23]
  s_waitcnt lgkmcnt(4)
  v_pk_add_f32 v[24:25], v[24:25], v[28:29]
  v_pk_add_f32 v[26:27], v[26:27], v[30:31]
  v_pk_add_f32 v[16:17], v[16:17], v[24:25]
  v_pk_add_f32 v[18:19], v[18:19], v[26:27]
  s_waitcnt lgkmcnt(2)
  v_pk_add_f32 v[32:33], v[32:33], v[36:37]
  v_pk_add_f32 v[34:35], v[34:35], v[38:39]
  s_waitcnt lgkmcnt(0)
  v_pk_add_f32 v[40:41], v[40:41], v[44:45]
  v_pk_add_f32 v[42:43], v[42:43], v[46:47]
  v_pk_add_f32 v[32:33], v[32:33], v[40:41]
  v_pk_add_f32 v[34:35], v[34:35], v[42:43]
  v_pk_add_f32 v[4:5], v[16:17], v[32:33]
  v_pk_add_f32 v[6:7], v[18:19], v[34:35]
  v_cvt_pk_bf16_f32 v8, v4, v5
  v_cvt_pk_bf16_f32 v9, v6, v7
  v_cndmask_b32 v4, v8, v14, s[22:23]
  v_cndmask_b32 v5, v9, v15, s[22:23]
  v_cndmask_b32 v6, v14, v8, s[22:23]
  v_cndmask_b32 v7, v15, v9, s[22:23]
  s_mov_b32 exec_lo, 0xffffffff
  s_mov_b32 exec_hi, 0xffff
  buffer_store_dwordx4 v[4:7], v13, s[32:35], s74 offen
  s_mov_b64 exec, -1
  s_cmp_lg_u32 s46, 1
  s_cbranch_scc1 L_slow_54
L_back_55:
L_noa:
  s_cmp_lt_u32 s5, 20
  s_cbranch_scc0 L_helper_exit
  s_cmp_ge_u32 s5, 10
  s_cselect_b32 s76, 1, 0
  s_mul_i32 s77, s76, 10
  s_sub_u32 s77, s5, s77
  s_lshr_b32 s78, s3, 1
  v_and_b32 v2, 48, v0
  s_lshl_b32 s68, s78, 6
  v_add_u32 v22, s68, v2
  v_lshlrev_b32 v60, 4, v0
  s_lshl1_add_u32 s73, s4, s78
  s_lshl1_add_u32 s73, s73, s76
  s_lshl1_add_u32 s73, s73, s3
  s_lshl_b32 s68, s78, 1
  s_sub_u32 s73, s73, s68
  s_mul_i32 s73, s73, 6144
  s_add_u32 s73, s73, 524288
  s_add_u32 s74, s73, 4096
  v_lshlrev_b32 v62, 2, v0
  s_lshl_b32 s68, s3, 8
  v_add_u32 v61, s68, v62
  v_lshrrev_b32 v2, 5, v0
  v_lshlrev_b32 v2, 11, v2
  v_bfe_u32 v3, v0, 2, 3
  v_lshl_add_u32 v2, v3, 4, v2
  v_and_b32 v3, 1, v0
  v_lshl_add_u32 v63, v3, 13, v2
  s_lshr_b32 s75, s77, 1
  s_lshl_b32 s75, s75, 14
  s_and_b32 s68, s77, 1
  s_lshl_b32 s68, s68, 12
  s_add_u32 s75, s75, s68
  s_lshl1_add_u32 s68, s4, s76
  s_lshl_b32 s68, s68, 7
  s_add_u32 s75, s75, s68
  s_add_u32 s75, s75, 1966080
  s_mov_b32 s8, 0x33333333
  s_mov_b32 s9, 0x33333333
  v_mov_b32 v50, s30
  v_mov_b32 v51, s31
  v_lshrrev_b32 v24, 4, v0
  v_lshlrev_b32 v24, 10, v24
  v_bfe_u32 v25, v0, 2, 2
  v_lshl_add_u32 v24, v25, 7, v24
  v_and_b32 v25, 3, v0
  v_lshl_add_u32 v24, v25, 3, v24
  s_mul_i32 s69, s3, 12288
  v_add_u32 v24, s69, v24
  s_cmp_lg_u32 s3, 0
  s_cbranch_scc1 L_noc
  s_lshl2_add_u32 s72, s4, s76
  s_lshl_b32 s72, s72, 8
  s_add_u32 s72, s72, 2064384
  v_and_b32 v1, 15, v0
  v_lshlrev_b32 v1, 4, v1
  v_and_b32 v2, 16, v0
  v_lshl_add_u32 v1, v2, 5, v1
  s_mov_b32 s16, s32
  s_mov_b32 s17, s33
  s_mov_b32 s18, 4194304
  s_mov_b32 s19, 0x20000
  s_mov_b32 s70, 4000007
L_spin_56:
  s_sleep 24
  buffer_load_dwordx4 v[4:7], v1, s[16:19], s72 offen sc1 nt
  s_waitcnt vmcnt(0)
  v_cmp_ne_u64 vcc, s[30:31], v[6:7]
  s_nop 0
  s_cbranch_vccz L_sdone_57
  s_and_b32 s99, s70, 7
  s_cmp_eq_u32 s46, 1
  s_cselect_b32 s99, 1, s99
  s_cmp_lg_u32 s99, 0
  s_cselect_b32 s16, s32, s24
  s_cselect_b32 s17, s33, s25
  s_sub_u32 s70, s70, 1
  s_cbranch_scc0 L_spin_56
L_sdone_57:
  s_mov_b32 s68, 0x3fb8aa3b
  v_mov_b32 v2, v4
  s_nop 1
  v_max_f32_dpp v2, v2, v2 quad_perm:[1,0,3,2] row_mask:0xf bank_mask:0xf
  s_nop 1
  v_max_f32_dpp v2, v2, v2 quad_perm:[2,3,0,1] row_mask:0xf bank_mask:0xf
  s_nop 1
  v_max_f32_dpp v2, v2, v2 row_half_mirror row_mask:0xf bank_mask:0xf
  s_nop 1
  v_max_f32_dpp v2, v2, v2 row_mirror row_mask:0xf bank_mask:0xf
  v_sub_f32 v4, v4, v2
  v_mul_f32 v4, s68, v4
  v_exp_f32 v4, v4
  s_nop 0
  v_mul_f32 v3, v4, v5
  s_nop 1
  v_add_f32_dpp v3, v3, v3 quad_perm:[1,0,3,2] row_mask:0xf bank_mask:0xf
  s_nop 1
  v_add_f32_dpp v3, v3, v3 quad_perm:[2,3,0,1] row_mask:0xf bank_mask:0xf
  s_nop 1
  v_add_f32_dpp v3, v3, v3 row_half_mirror row_mask:0xf bank_mask:0xf
  s_nop 1
  v_add_f32_dpp v3, v3, v3 row_mirror row_mask:0xf bank_mask:0xf
  v_rcp_f32 v3, v3
  v_and_b32 v1, 0x7c, v62
  v_mul_f32 v4, v4, v3
  v_mov_b32 v2, 0
  v_mov_b32 v3, 1
  ds_write_b32 v1, v4 offset:768
  ds_write_b32 v2, v3 offset:664
L_noc:
  v_mov_b32 v1, 0
  s_mov_b32 s70, 4000007
L_spin_58:
  ds_read_b32 v4, v1 offset:664
  s_waitcnt lgkmcnt(0)
  v_cmp_gt_u32 vcc, 1, v4
  s_nop 0
  s_cbranch_vccz L_sdone_59
  s_sleep 2
  s_sub_u32 s70, s70, 1
  s_cbranch_scc0 L_spin_58
L_sdone_59:
  ds_read_b128 v[56:59], v22 offset:768
  s_mov_b32 s12, s44
  s_mov_b32 s13, s45
  s_mov_b32 s14, 7864320
  s_mov_b32 s15, 0x20000
  v_lshrrev_b32 v21, 3, v0
  v_mul_u32_u24 v21, 1280, v21
  v_and_b32 v3, 7, v0
  v_lshl_add_u32 v21, v3, 4, v21
  s_lshl1_add_u32 s60, s4, s76
  s_mul_i32 s68, s78, 16
  s_add_u32 s60, s60, s68
  s_add_u32 s60, s60, 0
  s_and_b32 s68, s3, 1
  s_lshl1_add_u32 s60, s60, s68
  s_mul_i32 s60, s60, 122880
  s_lshl_b32 s69, s77, 7
  s_add_u32 s60, s60, s69
  s_mul_i32 s61, s3, 12288
  s_add_u32 s61, s61, 8704
  v_mov_b32 v23, 1
  s_lshl_b32 s68, s3, 2
  v_mov_b32 v25, s68
  v_mov_b32 v1, 0
  s_mov_b32 s70, 4000007
L_spin_60:
  ds_read_b32 v4, v1 offset:660
  s_waitcnt lgkmcnt(0)
  v_cmp_gt_u32 vcc, 1, v4
  s_nop 0
  s_cbranch_vccz L_sdone_61
  s_sleep 4
  s_sub_u32 s70, s70, 1
  s_cbranch_scc0 L_spin_60
L_sdone_61:
  v_readfirstlane_b32 s47, v4
  v_mov_b32 v1, 0
  s_mov_b32 s70, 4000007
L_spin_62:
  ds_read_b32 v4, v1 offset:644
  s_waitcnt lgkmcnt(0)
  v_cmp_gt_u32 vcc, 8, v4
  s_nop 0
  s_cbranch_vccz L_sdone_63
  s_sleep 2
  s_sub_u32 s70, s70, 1
  s_cbranch_scc0 L_spin_62
L_sdone_63:
  s_cmp_lg_u32 s78, 0
  s_cbranch_scc1 L_nofirst
L_nofirst:
  s_mov_b32 m0, s61
  s_nop 0
  buffer_load_dwordx4 v21, s[12:15], s60 offen nt lds
  s_add_u32 s60, s60, 10240
  s_add_u32 s61, s61, 1024
  s_mov_b32 m0, s61
  s_nop 0
  buffer_load_dwordx4 v21, s[12:15], s60 offen nt lds
  s_add_u32 s60, s60, 10240
  s_add_u32 s61, s61, 1024
  s_mov_b32 m0, s61
  s_nop 0
  buffer_load_dwordx4 v21, s[12:15], s60 offen nt lds
  s_add_u32 s60, s60, 10240
  s_add_u32 s61, s61, 1024
  s_mov_b32 m0, s61
  s_nop 0
  buffer_load_dwordx4 v21, s[12:15], s60 offen nt lds
  s_add_u32 s60, s60, 10240
  s_add_u32 s61, s61, 1024
  s_mov_b32 m0, s61
  s_nop 0
  buffer_load_dwordx4 v21, s[12:15], s60 offen nt lds
  s_add_u32 s60, s60, 10240
  s_add_u32 s61, s61, 1024
  s_mov_b32 m0, s61
  s_nop 0
  buffer_load_dwordx4 v21, s[12:15], s60 offen nt lds
  s_add_u32 s60, s60, 10240
  s_add_u32 s61, s61, 1024
  s_waitcnt vmcnt(5)
  s_mov_b32 m0, s61
  s_nop 0
  buffer_load_dwordx4 v21, s[12:15], s60 offen nt lds
  s_add_u32 s60, s60, 10240
  s_add_u32 s61, s61, 1024
  s_waitcnt vmcnt(5)
  s_mov_b32 m0, s61
  s_nop 0
  buffer_load_dwordx4 v21, s[12:15], s60 offen nt lds
  s_add_u32 s60, s60, 10240
  s_add_u32 s61, s61, 1024
  s_waitcnt vmcnt(5)
  s_mov_b32 m0, s61
  s_nop 0
  buffer_load_dwordx4 v21, s[12:15], s60 offen nt lds
  s_add_u32 s60, s60, 10240
  s_add_u32 s61, s61, 1024
  s_waitcnt vmcnt(5)
  s_mov_b32 m0, s61
  s_nop 0
  buffer_load_dwordx4 v21, s[12:15], s60 offen nt lds
  s_add_u32 s60, s60, 10240
  s_add_u32 s61, s61, 1024
  s_waitcnt vmcnt(5)
  s_mov_b32 m0, s61
  s_nop 0
  buffer_load_dwordx4 v21, s[12:15], s60 offen nt lds
  s_add_u32 s60, s60, 10240
  s_add_u32 s61, s61, 1024
  s_waitcnt vmcnt(5)
  s_mov_b32 m0, s61
  s_nop 0
  buffer_load_dwordx4 v21, s[12:15], s60 offen nt lds
  s_waitcnt vmcnt(4)
  s_cmp_lg_u32 s78, 0
  s_cbranch_scc1 L_s2
  buffer_load_dwordx4 v[144:147], v60, s[32:35], s73 offen offset:0 sc1 nt
  buffer_load_dwordx4 v[148:151], v60, s[32:35], s73 offen offset:1024 sc1 nt
  buffer_load_dwordx4 v[152:155], v60, s[32:35], s73 offen offset:2048 sc1 nt
  buffer_load_dwordx4 v[156:159], v60, s[32:35], s73 offen offset:3072 sc1 nt
  buffer_load_dwordx4 v[160:163], v60, s[32:35], s74 offen offset:0 sc1 nt
  buffer_load_dwordx4 v[164:167], v60, s[32:35], s74 offen offset:1024 sc1 nt
L_s2:
  ds_read_b64_tr_b16 v[64:65], v24 offset:8704
  ds_read_b64_tr_b16 v[66:67], v24 offset:9216
  ds_read_b64_tr_b16 v[68:69], v24 offset:8736
  ds_read_b64_tr_b16 v[70:71], v24 offset:9248
  ds_read_b64_tr_b16 v[72:73], v24 offset:8768
  ds_read_b64_tr_b16 v[74:75], v24 offset:9280
  ds_read_b64_tr_b16 v[76:77], v24 offset:8800
  ds_read_b64_tr_b16 v[78:79], v24 offset:9312
  ds_read_b64_tr_b16 v[80:81], v24 offset:12800
  ds_read_b64_tr_b16 v[82:83], v24 offset:13312
  ds_read_b64_tr_b16 v[84:85], v24 offset:12832
  ds_read_b64_tr_b16 v[86:87], v24 offset:13344
  ds_read_b64_tr_b16 v[88:89], v24 offset:12864
  ds_read_b64_tr_b16 v[90:91], v24 offset:13376
  ds_read_b64_tr_b16 v[92:93], v24 offset:12896
  ds_read_b64_tr_b16 v[94:95], v24 offset:13408
  s_cmp_lg_u32 s78, 0
  s_cbranch_scc1 L_second
  s_waitcnt vmcnt(6) lgkmcnt(0)
  s_branch L_both
L_second:
  v_mov_b32 v1, 0
  s_mov_b32 s70, 4000007
L_spin_64:
  ds_read_b32 v4, v1 offset:668
  s_waitcnt lgkmcnt(0)
  v_cmp_gt_u32 vcc, 1, v4
  s_nop 0
  s_cbranch_vccz L_sdone_65
  s_sleep 1
  s_sub_u32 s70, s70, 1
  s_cbranch_scc0 L_spin_64
L_sdone_65:
  s_waitcnt vmcnt(2)
  buffer_load_dwordx4 v[144:147], v60, s[32:35], s73 offen offset:0 sc1
  buffer_load_dwordx4 v[148:151], v60, s[32:35], s73 offen offset:1024 sc1
  buffer_load_dwordx4 v[152:155], v60, s[32:35], s73 offen offset:2048 sc1
  buffer_load_dwordx4 v[156:159], v60, s[32:35], s73 offen offset:3072 sc1
  buffer_load_dwordx4 v[160:163], v60, s[32:35], s74 offen offset:0 sc1
  buffer_load_dwordx4 v[164:167], v60, s[32:35], s74 offen offset:1024 sc1
  s_waitcnt vmcnt(6)
L_both:
  ds_read_b64_tr_b16 v[96:97], v24 offset:16896
  ds_read_b64_tr_b16 v[98:99], v24 offset:17408
  ds_read_b64_tr_b16 v[100:101], v24 offset:16928
  ds_read_b64_tr_b16 v[102:103], v24 offset:17440
  ds_read_b64_tr_b16 v[104:105], v24 offset:16960
  ds_read_b64_tr_b16 v[106:107], v24 offset:17472
  ds_read_b64_tr_b16 v[108:109], v24 offset:16992
  ds_read_b64_tr_b16 v[110:111], v24 offset:17504
  s_mov_b32 s16, s32
  s_mov_b32 s17, s33
  s_mov_b32 s18, 4194304
  s_mov_b32 s19, 0x20000
  s_mov_b32 s70, 4000007
  s_branch L_opw
L_spin_66:
  buffer_load_dwordx4 v[144:147], v60, s[16:19], s73 offen offset:0 sc1
  buffer_load_dwordx4 v[148:151], v60, s[16:19], s73 offen offset:1024 sc1
  buffer_load_dwordx4 v[152:155], v60, s[16:19], s73 offen offset:2048 sc1
  buffer_load_dwordx4 v[156:159], v60, s[16:19], s73 offen offset:3072 sc1
  buffer_load_dwordx4 v[160:163], v60, s[16:19], s74 offen offset:0 sc1
  buffer_load_dwordx4 v[164:167], v60, s[16:19], s74 offen offset:1024 sc1
L_opw:
  s_waitcnt vmcnt(4)
  v_mfma_f32_16x16x32_bf16 v[32:35], v[146:149], v[64:67], 0
  v_cmp_ne_u64 vcc, s[30:31], v[144:145]
  v_cmp_ne_u64 s[22:23], s[30:31], v[150:151]
  v_mfma_f32_16x16x32_bf16 v[36:39], v[146:149], v[68:71], 0
  s_or_b64 vcc, vcc, s[22:23]
  v_mfma_f32_16x16x32_bf16 v[40:43], v[146:149], v[72:75], 0
  v_mfma_f32_16x16x32_bf16 v[44:47], v[146:149], v[76:79], 0
  s_waitcnt vmcnt(2)
  v_mfma_f32_16x16x32_bf16 v[32:35], v[154:157], v[80:83], v[32:35]
  v_cmp_ne_u64 s[20:21], s[30:31], v[152:153]
  v_cmp_ne_u64 s[22:23], s[30:31], v[158:159]
  v_mfma_f32_16x16x32_bf16 v[36:39], v[154:157], v[84:87], v[36:39]
  s_or_b64 vcc, vcc, s[20:21]
  s_or_b64 vcc, vcc, s[22:23]
  v_mfma_f32_16x16x32_bf16 v[40:43], v[154:157], v[88:91], v[40:43]
  v_mfma_f32_16x16x32_bf16 v[44:47], v[154:157], v[92:95], v[44:47]
  s_waitcnt vmcnt(0) lgkmcnt(0)
  v_mfma_f32_16x16x32_bf16 v[32:35], v[162:165], v[96:99], v[32:35]
  v_cmp_ne_u64 s[20:21], s[30:31], v[160:161]
  v_cmp_ne_u64 s[22:23], s[30:31], v[166:167]
  v_mfma_f32_16x16x32_bf16 v[36:39], v[162:165], v[100:103], v[36:39]
  s_or_b64 vcc, vcc, s[20:21]
  s_or_b64 vcc, vcc, s[22:23]
  v_mfma_f32_16x16x32_bf16 v[40:43], v[162:165], v[104:107], v[40:43]
  v_mfma_f32_16x16x32_bf16 v[44:47], v[162:165], v[108:111], v[44:47]
  s_nop 0
  s_cbranch_vccz L_sdone_67
  s_and_b32 s99, s70, 7
  s_cmp_eq_u32 s46, 1
  s_cselect_b32 s99, 1, s99
  s_cmp_lg_u32 s99, 0
  s_cselect_b32 s16, s32, s24
  s_cselect_b32 s17, s33, s25
  s_sub_u32 s70, s70, 1
  s_cbranch_scc0 L_spin_66
L_sdone_67:
  v_mul_f32 v4, v32, v56
  v_fmac_f32 v4, v33, v57
  v_fmac_f32 v4, v34, v58
  v_fmac_f32 v4, v35, v59
  v_mul_f32 v5, v36, v56
  v_fmac_f32 v5, v37, v57
  v_fmac_f32 v5, v38, v58
  v_fmac_f32 v5, v39, v59
  v_mul_f32 v6, v40, v56
  v_fmac_f32 v6, v41, v57
  v_fmac_f32 v6, v42, v58
  v_fmac_f32 v6, v43, v59
  v_mul_f32 v7, v44, v56
  v_fmac_f32 v7, v45, v57
  v_fmac_f32 v7, v46, v58
  v_fmac_f32 v7, v47, v59
  v_permlane32_swap_b32 v4, v6
  s_nop 0
  v_permlane32_swap_b32 v5, v7
  v_add_f32 v4, v4, v6
  v_add_f32 v5, v5, v7
  s_nop 1
  v_permlane16_swap_b32 v4, v5
  v_add_f32 v4, v4, v5
  ds_write_b32 v61, v4 offset:7168
  s_cmp_lg_u32 s3, 0
  s_waitcnt lgkmcnt(0)
  s_barrier
  s_cbranch_scc1 L_post_wo
  ds_read_b32 v5, v62 offset:7424
  ds_read_b32 v6, v62 offset:7680
  ds_read_b32 v7, v62 offset:7936
  s_waitcnt lgkmcnt(0)
  v_add_f32 v4, v4, v5
  v_add_f32 v6, v6, v7
  v_add_f32 v4, v4, v6
  s_nop 1
  v_mov_b32_dpp v5, v4 quad_perm:[1,0,3,2] row_mask:0xf bank_mask:0xf
  v_cvt_pk_bf16_f32 v4, v4, v5
  s_nop 1
  v_mov_b32_dpp v48, v4 quad_perm:[0,0,0,0] row_mask:0xf bank_mask:0xf
  v_mov_b32_dpp v49, v4 quad_perm:[2,2,2,2] row_mask:0xf bank_mask:0xf
  s_mov_b64 exec, s[8:9]
  buffer_store_dwordx4 v[48:51], v63, s[24:27], s75 offen sc1
  s_barrier
  s_endpgm
L_helper_exit:
  s_endpgm
L_f1:
  s_mov_b32 s12, s48
  s_mov_b32 s13, s49
  s_mov_b32 s14, 1966080
  s_mov_b32 s15, 0x20000
  s_mov_b32 s16, s50
  s_mov_b32 s17, s51
  s_mov_b32 s18, 1966080
  s_mov_b32 s19, 0x20000
  s_sub_u32 s74, s5, 20
  v_lshrrev_b32 v3, 4, v0
  v_and_b32 v2, 7, v0
  v_lshrrev_b32 v62, 3, v0
  v_mul_u32_u24 v62, 3072, v62
  v_lshl_add_u32 v62, v2, 4, v62
  s_lshl3_add_u32 s61, s74, s73
  s_mul_i32 s61, s61, 24576
  s_mul_i32 s68, s4, 384
  s_add_u32 s61, s61, s68
  s_add_u32 s62, s61, 128
  s_add_u32 s63, s61, 256
  s_lshl_b32 s79, s73, 10
  s_add_u32 s79, s79, 8704
  v_mov_b32 v57, 0
  v_mov_b32 v6, s30
  v_mov_b32 v7, s31
  v_mov_b32 v1, 0
  s_mov_b32 s70, 4000007
L_spin_68:
  ds_read_b32 v4, v1 offset:668
  s_waitcnt lgkmcnt(0)
  v_cmp_gt_u32 vcc, 1, v4
  s_nop 0
  s_cbranch_vccz L_sdone_69
  s_sleep 1
  s_sub_u32 s70, s70, 1
  s_cbranch_scc0 L_spin_68
L_sdone_69:
  s_add_u32 m0, s79, 0
  s_nop 0
  buffer_load_dwordx4 v62, s[12:15], s61 offen nt lds
  s_add_u32 m0, s79, 24576
  s_nop 0
  buffer_load_dwordx4 v62, s[16:19], s61 offen nt lds
  s_add_u32 m0, s79, 8192
  s_nop 0
  buffer_load_dwordx4 v62, s[12:15], s62 offen nt lds
  s_add_u32 m0, s79, 32768
  s_nop 0
  buffer_load_dwordx4 v62, s[16:19], s62 offen nt lds
  s_add_u32 m0, s79, 16384
  s_nop 0
  buffer_load_dwordx4 v62, s[12:15], s63 offen nt lds
  s_add_u32 m0, s79, 40960
  s_nop 0
  buffer_load_dwordx4 v62, s[16:19], s63 offen nt lds
  s_setprio 3
  s_cmp_gt_u32 s73, 1
  s_cbranch_scc1 L_f1m
  v_mov_b32 v1, 0
  s_mov_b32 s70, 4000007
L_spin_70:
  ds_read_b32 v4, v1 offset:660
  s_waitcnt lgkmcnt(0)
  v_cmp_gt_u32 vcc, 1, v4
  s_nop 0
  s_cbranch_vccz L_sdone_71
  s_sleep 1
  s_sub_u32 s70, s70, 1
  s_cbranch_scc0 L_spin_70
L_sdone_71:
  v_readfirstlane_b32 s47, v4
  s_lshl1_add_u32 s74, s74, s73
  v_lshl_add_u32 v61, v2, 2, v3
  v_lshlrev_b32 v61, 1, v61
  s_lshl_b32 s68, s74, 6
  v_add_u32 v61, s68, v61
  global_load_ushort v56, v61, s[36:37]
  v_lshlrev_b32 v54, 5, v3
  v_lshl_add_u32 v54, v2, 2, v54
  v_lshlrev_b32 v55, 4, v0
  s_lshl_b32 s72, s4, 9
  s_lshl4_add_u32 s72, s74, s72
  s_add_u32 s72, s72, 2752512
  s_mul_i32 s75, s4, 20
  s_add_u32 s75, s75, s74
  s_lshl_b32 s75, s75, 7
  s_add_u32 s75, s75, 2768896
  s_mov_b64 exec, 1
  buffer_load_dword v104, v54, s[32:35], s75 offen sc1
  buffer_load_dword v105, v55, s[32:35], s72 offen sc1
  s_mov_b64 exec, -1
  s_lshr_b32 s60, s74, 2
  s_lshl_b32 s60, s60, 14
  s_and_b32 s68, s74, 3
  s_lshl_b32 s68, s68, 11
  s_add_u32 s60, s60, s68
  s_lshr_b32 s68, s47, s4
  s_and_b32 s68, s68, 1
  s_lshl_b32 s68, s68, 13
  s_add_u32 s60, s60, s68
  s_add_u32 s60, s60, 1966080
  v_lshlrev_b32 v51, 4, v3
  v_lshl_add_u32 v51, v2, 1, v51
  v_and_b32 v4, 1, v0
  v_mul_u32_u24 v4, 126, v4
  v_add_u32 v51, v51, v4
  s_lshl_b32 s68, s73, 6
  v_add_u32 v51, s68, v51
  s_mov_b32 s77, 0x3f80
  s_mov_b32 s71, 0x3f800000
  v_mov_b32 v14, s30
  v_mov_b32 v15, s31
  v_mov_b32 v8, 0
  v_mov_b32 v9, 0
  v_mov_b32 v10, 0
  v_mov_b32 v11, 0
  v_not_b32 v98, s30
  v_not_b32 v102, s30
  s_waitcnt vmcnt(2)
  s_barrier
  v_lshlrev_b32 v56, 16, v56
  s_mov_b32 s70, 4000007
  s_mov_b64 s[20:21], -1
  s_mov_b64 s[22:23], -1
L_ypoll:
  s_mov_b64 exec, s[20:21]
  buffer_load_dwordx4 v[96:99], v55, s[24:27], s60 offen sc1
  s_mov_b64 exec, s[22:23]
  buffer_load_dwordx4 v[100:103], v55, s[24:27], s60 offen offset:1024 sc1
  s_mov_b64 exec, -1
  v_cmp_ne_u64 s[20:21], s[30:31], v[98:99]
  v_cmp_ne_u64 s[22:23], s[30:31], v[102:103]
  s_nop 0
  s_or_b64 vcc, s[20:21], s[22:23]
  s_cbranch_scc0 L_yok
  v_cmp_ne_u64 s[20:21], s[30:31], v[98:99]
  v_cmp_ne_u64 s[22:23], s[30:31], v[102:103]
  s_nop 0
  s_or_b64 vcc, s[20:21], s[22:23]
  s_cbranch_scc0 L_yok
  v_cmp_ne_u64 s[20:21], s[30:31], v[98:99]
  v_cmp_ne_u64 s[22:23], s[30:31], v[102:103]
  s_nop 0
  s_or_b64 vcc, s[20:21], s[22:23]
  s_cbranch_scc0 L_yok
  v_cmp_ne_u64 s[20:21], s[30:31], v[98:99]
  v_cmp_ne_u64 s[22:23], s[30:31], v[102:103]
  s_nop 0
  s_or_b64 vcc, s[20:21], s[22:23]
  s_cbranch_scc0 L_yok
  v_cmp_ne_u64 s[20:21], s[30:31], v[98:99]
  v_cmp_ne_u64 s[22:23], s[30:31], v[102:103]
  s_nop 0
  s_or_b64 vcc, s[20:21], s[22:23]
  s_cbranch_scc0 L_yok
  v_cmp_ne_u64 s[20:21], s[30:31], v[98:99]
  v_cmp_ne_u64 s[22:23], s[30:31], v[102:103]
  s_nop 0
  s_or_b64 vcc, s[20:21], s[22:23]
  s_cbranch_scc0 L_yok
  s_waitcnt vmcnt(16)
  s_sub_u32 s70, s70, 1
  s_cbranch_scc0 L_ypoll
L_yok:
  v_dot2c_f32_bf16 v8, s77, v96
  v_dot2c_f32_bf16 v10, s77, v97
  v_dot2c_f32_bf16 v9, s71, v96
  v_dot2c_f32_bf16 v11, s71, v97
  v_dot2c_f32_bf16 v8, s77, v100
  v_dot2c_f32_bf16 v10, s77, v101
  v_dot2c_f32_bf16 v9, s71, v100
  v_dot2c_f32_bf16 v11, s71, v101
  s_nop 0
  v_permlane32_swap_b32 v8, v10
  s_nop 0
  v_permlane32_swap_b32 v9, v11
  v_add_f32 v8, v8, v10
  v_add_f32 v9, v9, v11
  s_nop 1
  v_permlane16_swap_b32 v8, v9
  v_add_f32 v8, v8, v9
  s_nop 1
  v_add_f32_dpp v8, v8, v8 row_ror:8 row_mask:0xf bank_mask:0xf
  v_cvt_pk_bf16_f32 v8, v57, v8
  v_add_f32 v12, v8, v56
  s_nop 1
  v_mov_b32_dpp v13, v12 quad_perm:[1,0,3,2] row_mask:0xf bank_mask:0xf
  v_cvt_pk_bf16_f32 v12, v12, v13
  ds_write_b32 v51, v12 offset:7168
  v_lshlrev_b32 v4, 16, v12
  v_mul_f32 v5, v4, v4
  s_nop 0
  v_add_f32_dpp v4, v4, v4 quad_perm:[1,0,3,2] row_mask:0xf bank_mask:0xf
  v_add_f32_dpp v5, v5, v5 quad_perm:[1,0,3,2] row_mask:0xf bank_mask:0xf
  s_nop 0
  v_add_f32_dpp v4, v4, v4 quad_perm:[2,3,0,1] row_mask:0xf bank_mask:0xf
  v_add_f32_dpp v5, v5, v5 quad_perm:[2,3,0,1] row_mask:0xf bank_mask:0xf
  s_nop 0
  v_add_f32_dpp v4, v4, v4 row_half_mirror row_mask:0xf bank_mask:0xf
  v_add_f32_dpp v5, v5, v5 row_half_mirror row_mask:0xf bank_mask:0xf
  s_waitcnt lgkmcnt(0)
  s_barrier
  v_mov_b32_dpp v13, v12 quad_perm:[2,3,2,3] row_mask:0xf bank_mask:0xf
  v_mov_b32 v8, v4
  v_mov_b32 v9, v5
  s_nop 0
  v_permlane16_swap_b32 v4, v8
  v_permlane16_swap_b32 v5, v9
  v_add_f32 v4, v4, v8
  v_add_f32 v5, v5, v9
  v_mov_b32 v8, v4
  v_mov_b32 v9, v5
  s_nop 0
  v_permlane32_swap_b32 v4, v8
  v_permlane32_swap_b32 v5, v9
  v_add_f32 v4, v4, v8
  v_add_f32 v5, v5, v9
  s_mov_b32 exec_lo, 0x1
  s_mov_b32 exec_hi, 0x0
  buffer_store_dwordx4 v[4:7], v55, s[32:35], s72 offen
  s_mov_b32 exec_lo, 0x110011
  s_mov_b32 exec_hi, 0x110011
  buffer_store_dwordx4 v[12:15], v54, s[32:35], s75 offen
  s_mov_b64 exec, -1
  s_cmp_lg_u32 s46, 1
  s_cbranch_scc1 L_slow_72
L_back_73:
  s_endpgm
L_f1m:
  s_sub_u32 s68, s73, 2
  s_lshr_b32 s78, s68, 1
  s_and_b32 s69, s73, 1
  v_lshlrev_b32 v58, 7, v3
  v_bfe_u32 v4, v0, 2, 2
  v_lshl_add_u32 v58, v4, 9, v58
  v_and_b32 v4, 3, v0
  v_lshl_add_u32 v58, v4, 3, v58
  s_lshl_b32 s75, s78, 13
  s_lshl_b32 s68, s69, 6
  s_add_u32 s75, s75, s68
  v_add_u32 v58, s75, v58
  v_lshlrev_b32 v52, 4, v3
  v_and_b32 v59, 1, v3
  v_cmp_eq_u32 s[62:63], 1, v59
  v_mul_u32_u24 v59, 3072, v59
  v_bfe_u32 v4, v0, 3, 1
  v_lshl_add_u32 v59, v4, 9, v59
  v_lshl_add_u32 v59, v2, 4, v59
  s_mul_i32 s76, s4, 3
  s_add_u32 s76, s76, s78
  s_lshl1_add_u32 s76, s76, s69
  s_mul_i32 s76, s76, 6144
  s_lshr_b32 s68, s74, 2
  s_lshl_b32 s68, s68, 10
  s_add_u32 s76, s76, s68
  s_and_b32 s68, s74, 3
  s_lshl_b32 s68, s68, 7
  s_add_u32 s76, s76, s68
  s_add_u32 s77, s76, 3145728
  s_add_u32 s76, s76, 2228224
  v_mov_b32 v8, 0x3f803f80
  v_mov_b32 v9, 0x3f803f80
  v_mov_b32 v10, 0x3f803f80
  v_mov_b32 v11, 0x3f803f80
  v_mov_b32 v34, s30
  v_mov_b32 v35, s31
  s_waitcnt vmcnt(0)
  s_barrier
  ds_read_b64_tr_b16 v[64:65], v58 offset:8704
  ds_read_b64_tr_b16 v[66:67], v58 offset:10752
  ds_read_b64_tr_b16 v[68:69], v58 offset:8736
  ds_read_b64_tr_b16 v[70:71], v58 offset:10784
  ds_read_b64_tr_b16 v[72:73], v58 offset:33280
  ds_read_b64_tr_b16 v[74:75], v58 offset:35328
  ds_read_b64_tr_b16 v[76:77], v58 offset:33312
  ds_read_b64_tr_b16 v[78:79], v58 offset:35360
  ds_read_b64_tr_b16 v[80:81], v58 offset:12800
  ds_read_b64_tr_b16 v[82:83], v58 offset:14848
  ds_read_b64_tr_b16 v[84:85], v58 offset:12832
  ds_read_b64_tr_b16 v[86:87], v58 offset:14880
  ds_read_b64_tr_b16 v[88:89], v58 offset:37376
  ds_read_b64_tr_b16 v[90:91], v58 offset:39424
  ds_read_b64_tr_b16 v[92:93], v58 offset:37408
  ds_read_b64_tr_b16 v[94:95], v58 offset:39456
  s_waitcnt lgkmcnt(0)
  v_mfma_f32_16x16x32_bf16 v[16:19], v[8:11], v[64:67], 0
  v_mfma_f32_16x16x32_bf16 v[20:23], v[8:11], v[68:71], 0
  v_mfma_f32_16x16x32_bf16 v[24:27], v[8:11], v[72:75], 0
  v_mfma_f32_16x16x32_bf16 v[28:31], v[8:11], v[76:79], 0
  v_mfma_f32_16x16x32_bf16 v[16:19], v[8:11], v[80:83], v[16:19]
  v_mfma_f32_16x16x32_bf16 v[20:23], v[8:11], v[84:87], v[20:23]
  v_mfma_f32_16x16x32_bf16 v[24:27], v[8:11], v[88:91], v[24:27]
  v_mfma_f32_16x16x32_bf16 v[28:31], v[8:11], v[92:95], v[28:31]
  s_nop 5
  v_cndmask_b32 v32, v16, v20, s[62:63]
  s_nop 0
  v_cndmask_b32 v33, v24, v28, s[62:63]
  s_mov_b32 exec_lo, 0xffffffff
  s_mov_b32 exec_hi, 0x0
  buffer_store_dwordx4 v[32:35], v59, s[32:35], s77 offen
  s_mov_b64 exec, -1
  s_cmp_lg_u32 s46, 1
  s_cbranch_scc1 L_slow_74
L_back_75:
  s_barrier
  ds_read_b128 v[8:11], v52 offset:7168
  ds_read_b128 v[12:15], v52 offset:7232
  s_waitcnt lgkmcnt(1)
  v_mfma_f32_16x16x32_bf16 v[16:19], v[8:11], v[64:67], 0
  v_mfma_f32_16x16x32_bf16 v[20:23], v[8:11], v[68:71], 0
  v_mfma_f32_16x16x32_bf16 v[24:27], v[8:11], v[72:75], 0
  v_mfma_f32_16x16x32_bf16 v[28:31], v[8:11], v[76:79], 0
  s_waitcnt lgkmcnt(0)
  v_mfma_f32_16x16x32_bf16 v[16:19], v[12:15], v[80:83], v[16:19]
  v_mfma_f32_16x16x32_bf16 v[20:23], v[12:15], v[84:87], v[20:23]
  v_mfma_f32_16x16x32_bf16 v[24:27], v[12:15], v[88:91], v[24:27]
  v_mfma_f32_16x16x32_bf16 v[28:31], v[12:15], v[92:95], v[28:31]
  s_nop 5
  v_cndmask_b32 v4, v16, v20, s[62:63]
  s_nop 0
  v_cndmask_b32 v5, v24, v28, s[62:63]
  s_mov_b32 exec_lo, 0xffffffff
  s_mov_b32 exec_hi, 0x0
  buffer_store_dwordx4 v[4:7], v59, s[32:35], s76 offen
  s_mov_b64 exec, -1
  s_cmp_lg_u32 s46, 1
  s_cbranch_scc1 L_slow_76
L_back_77:
  s_endpgm
L_post_wo:
  s_cmp_gt_u32 s5, 11
  s_cbranch_scc1 L_end
  s_cmp_eq_u32 s3, 3
  s_cbranch_scc1 L_end
  v_mov_b32 v57, 0
  s_cmp_eq_u32 s3, 1
  s_cbranch_scc1 L_hid
  s_barrier
  s_and_b32 s68, s4, 1
  s_lshl_b32 s68, s68, 2
  s_sub_u32 s68, 12, s68
  s_cmp_ge_u32 s5, s68
  s_cbranch_scc1 L_end
  s_mul_i32 s72, s4, 5
  s_add_u32 s72, s72, 1
  s_lshr_b32 s72, s72, 1
  s_lshr_b32 s68, s5, 2
  s_add_u32 s72, s72, s68
  s_and_b32 s73, s5, 3
  v_lshrrev_b32 v2, 1, v0
  v_lshlrev_b32 v2, 7, v2
  v_and_b32 v3, 1, v0
  v_lshl_add_u32 v96, v3, 4, v2
  s_lshl_b32 s10, s72, 15
  s_lshr_b32 s68, s47, s4
  s_and_b32 s68, s68, 1
  s_lshl_b32 s68, s68, 13
  s_add_u32 s10, s10, s68
  s_lshl_b32 s68, s73, 5
  s_add_u32 s10, s10, s68
  s_add_u32 s10, s10, 1048576
  s_add_u32 s11, s10, 4096
  s_add_u32 s12, s10, 16384
  v_lshrrev_b32 v4, 4, v0
  v_lshl_add_u32 v97, v3, 2, v4
  v_lshlrev_b32 v97, 1, v97
  v_lshlrev_b32 v99, 5, v4
  s_and_b32 s68, s73, 1
  s_lshl_b32 s68, s68, 5
  v_lshl_add_u32 v98, v3, 4, s68
  s_mul_i32 s13, s4, 20
  s_add_u32 s13, s13, s72
  s_lshl_b32 s13, s13, 7
  s_lshr_b32 s68, s73, 1
  s_lshl4_add_u32 s13, s68, s13
  s_add_u32 s13, s13, 2768896
  s_lshl2_add_u32 s14, s72, s73
  s_lshl_b32 s14, s14, 4
  s_mov_b32 s8, 0x30003
  s_mov_b32 s9, 0x30003
  s_mov_b32 s77, 0x3f80
  s_mov_b32 s71, 0x3f800000
  v_mov_b32 v8, 0
  v_mov_b32 v9, 0
  v_mov_b32 v10, 0
  v_mov_b32 v11, 0
  s_mov_b32 s64, s54
  s_mov_b32 s65, s55
  s_mov_b32 s66, 1280
  s_mov_b32 s67, 0x20000
  s_setprio 0
  v_mov_b32 v1, 0
  s_mov_b32 s70, 4000007
L_spin_78:
  ds_read_b32 v4, v1 offset:736
  s_waitcnt lgkmcnt(0)
  v_cmp_gt_u32 vcc, 1, v4
  s_nop 0
  s_cbranch_vccz L_sdone_79
  s_sub_u32 s70, s70, 1
  s_cbranch_scc0 L_spin_78
L_sdone_79:
  s_sleep 16
  s_mov_b32 s16, s32
  s_mov_b32 s17, s33
  s_mov_b32 s18, 4194304
  s_mov_b32 s19, 0x20000
  s_mov_b32 s70, 4000007
L_spin_80:
  buffer_load_dwordx4 v[4:7], v99, s[16:19], s13 offen sc1
  buffer_load_dwordx4 v[16:19], v96, s[24:27], s10 offen sc1
  buffer_load_dwordx4 v[20:23], v96, s[24:27], s11 offen sc1
  buffer_load_dwordx4 v[24:27], v96, s[24:27], s12 offen sc1
  s_waitcnt vmcnt(0)
  v_cmp_ne_u64 vcc, s[30:31], v[6:7]
  v_cmp_ne_u64 s[20:21], s[30:31], v[18:19]
  v_cmp_ne_u64 s[22:23], s[30:31], v[22:23]
  s_or_b64 vcc, vcc, s[20:21]
  v_cmp_ne_u64 s[20:21], s[30:31], v[26:27]
  s_or_b64 vcc, vcc, s[22:23]
  s_or_b64 vcc, vcc, s[20:21]
  s_nop 0
  s_cbranch_vccz L_sdone_81
  s_and_b32 s99, s70, 7
  s_cmp_eq_u32 s46, 1
  s_cselect_b32 s99, 1, s99
  s_cmp_lg_u32 s99, 0
  s_cselect_b32 s16, s32, s24
  s_cselect_b32 s17, s33, s25
  s_sub_u32 s70, s70, 1
  s_cbranch_scc0 L_spin_80
L_sdone_81:
L_finc:
  v_dot2c_f32_bf16 v8, s77, v16
  v_dot2c_f32_bf16 v10, s77, v17
  v_dot2c_f32_bf16 v9, s71, v16
  v_dot2c_f32_bf16 v11, s71, v17
  v_dot2c_f32_bf16 v8, s77, v20
  v_dot2c_f32_bf16 v10, s77, v21
  v_dot2c_f32_bf16 v9, s71, v20
  v_dot2c_f32_bf16 v11, s71, v21
  v_dot2c_f32_bf16 v8, s77, v24
  v_dot2c_f32_bf16 v10, s77, v25
  v_dot2c_f32_bf16 v9, s71, v24
  v_dot2c_f32_bf16 v11, s71, v25
  v_lshrrev_b64 v[58:59], v98, v[4:5]
  v_permlane32_swap_b32 v8, v10
  s_nop 0
  v_permlane32_swap_b32 v9, v11
  v_add_f32 v8, v8, v10
  v_add_f32 v9, v9, v11
  v_lshlrev_b32 v58, 16, v58
  s_nop 0
  v_permlane16_swap_b32 v8, v9
  v_add_f32 v8, v8, v9
  s_nop 1
  v_add_f32_dpp v8, v8, v8 row_ror:8 row_mask:0xf bank_mask:0xf
  s_nop 1
  v_add_f32_dpp v8, v8, v8 row_ror:4 row_mask:0xf bank_mask:0xf
  s_nop 1
  v_add_f32_dpp v8, v8, v8 quad_perm:[2,3,0,1] row_mask:0xf bank_mask:0xf
  v_cvt_pk_bf16_f32 v8, v57, v8
  v_add_f32 v8, v8, v58
  v_cvt_pk_bf16_f32 v8, v8, v8
  s_mov_b64 exec, s[8:9]
  buffer_store_short v8, v97, s[64:67], s14 offen
  s_cmp_lg_u32 s14, 0
  s_cbranch_scc1 L_fin_exit
  s_mov_b64 exec, 1
  v_mov_b32 v4, s30
  v_mov_b32 v5, s31
  s_mov_b32 s68, 917504
  buffer_store_dwordx2 v[4:5], v57, s[24:27], s68 offen
L_fin_exit:
  s_endpgm
L_hid:
  s_mul_i32 s72, s4, 12
  s_add_u32 s72, s72, s5
  v_lshrrev_b32 v4, 5, v0
  v_and_b32 v2, 7, v0
  v_lshl_add_u32 v62, v4, 3, v2
  v_lshlrev_b32 v62, 1, v62
  v_lshlrev_b32 v63, 2, v2
  v_lshlrev_b32 v60, 4, v0
  v_and_b32 v3, 31, v0
  v_lshlrev_b32 v61, 4, v3
  s_lshl_b32 s65, s4, 9
  s_add_u32 s65, s65, 2752512
  s_mul_i32 s60, s72, 3072
  s_add_u32 s62, s60, 3145728
  s_add_u32 s60, s60, 2228224
  s_mov_b32 s8, 0xfffff
  s_mov_b32 s9, 0xfffff
  s_mov_b32 s10, 0xffff
  s_mov_b32 s11, 0xffff
  v_mov_b32 v59, 1
  v_mov_b32 v24, 0
  v_mov_b32 v25, 0
  v_mov_b32 v26, s30
  v_mov_b32 v27, s31
  v_mov_b32 v136, 0
  v_mov_b32 v137, 0
  v_mov_b32 v138, s30
  v_mov_b32 v139, s31
  v_mov_b32 v140, 0
  v_mov_b32 v141, 0
  v_mov_b32 v142, s30
  v_mov_b32 v143, s31
  v_not_b32 v18, s30
  v_not_b32 v22, s30
  v_not_b32 v130, s30
  v_not_b32 v134, s30
  s_mov_b64 exec, s[10:11]
  v_not_b32 v26, s30
  v_not_b32 v138, s30
  s_mov_b64 exec, s[8:9]
  v_not_b32 v142, s30
  s_mov_b64 exec, -1
  s_barrier
  v_cmp_ne_u64 vcc, s[30:31], v[18:19]
  v_cmp_ne_u64 s[20:21], s[30:31], v[22:23]
  v_cmp_ne_u64 s[22:23], s[30:31], v[26:27]
  s_or_b64 vcc, vcc, s[20:21]
  s_or_b64 vcc, vcc, s[22:23]
  s_nop 0
  s_cbranch_vccz L_pok_83
  s_cmp_lg_u32 s46, 1
  s_cbranch_scc1 L_pslow_82
  s_mov_b32 s70, 4000007
L_fp_84:
  buffer_load_dwordx4 v[16:19], v60, s[32:35], s62 offen sc1
  buffer_load_dwordx4 v[20:23], v60, s[32:35], s62 offen offset:1024 sc1
  s_mov_b64 exec, s[10:11]
  buffer_load_dwordx4 v[24:27], v60, s[32:35], s62 offen offset:2048 sc1
  s_mov_b64 exec, -1
  s_mov_b64 exec, s[8:9]
  buffer_load_dwordx4 v[140:143], v61, s[32:35], s65 offen sc1
  s_mov_b64 exec, -1
  buffer_load_dwordx4 v[128:131], v60, s[32:35], s60 offen sc1
  buffer_load_dwordx4 v[132:135], v60, s[32:35], s60 offen offset:1024 sc1
  s_mov_b64 exec, s[10:11]
  buffer_load_dwordx4 v[136:139], v60, s[32:35], s60 offen offset:2048 sc1
  s_mov_b64 exec, -1
  v_cmp_ne_u64 vcc, s[30:31], v[18:19]
  v_cmp_ne_u64 s[20:21], s[30:31], v[22:23]
  v_cmp_ne_u64 s[22:23], s[30:31], v[26:27]
  s_or_b64 vcc, vcc, s[20:21]
  s_or_b64 vcc, vcc, s[22:23]
  s_nop 0
  s_cbranch_vccz L_pok_83
  v_cmp_ne_u64 vcc, s[30:31], v[18:19]
  v_cmp_ne_u64 s[20:21], s[30:31], v[22:23]
  v_cmp_ne_u64 s[22:23], s[30:31], v[26:27]
  s_or_b64 vcc, vcc, s[20:21]
  s_or_b64 vcc, vcc, s[22:23]
  s_nop 0
  s_cbranch_vccz L_pok_83
  v_cmp_ne_u64 vcc, s[30:31], v[18:19]
  v_cmp_ne_u64 s[20:21], s[30:31], v[22:23]
  v_cmp_ne_u64 s[22:23], s[30:31], v[26:27]
  s_or_b64 vcc, vcc, s[20:21]
  s_or_b64 vcc, vcc, s[22:23]
  s_nop 0
  s_cbranch_vccz L_pok_83
  v_cmp_ne_u64 vcc, s[30:31], v[18:19]
  v_cmp_ne_u64 s[20:21], s[30:31], v[22:23]
  v_cmp_ne_u64 s[22:23], s[30:31], v[26:27]
  s_or_b64 vcc, vcc, s[20:21]
  s_or_b64 vcc, vcc, s[22:23]
  s_nop 0
  s_cbranch_vccz L_pok_83
  v_cmp_ne_u64 vcc, s[30:31], v[18:19]
  v_cmp_ne_u64 s[20:21], s[30:31], v[22:23]
  v_cmp_ne_u64 s[22:23], s[30:31], v[26:27]
  s_or_b64 vcc, vcc, s[20:21]
  s_or_b64 vcc, vcc, s[22:23]
  s_nop 0
  s_cbranch_vccz L_pok_83
  v_cmp_ne_u64 vcc, s[30:31], v[18:19]
  v_cmp_ne_u64 s[20:21], s[30:31], v[22:23]
  v_cmp_ne_u64 s[22:23], s[30:31], v[26:27]
  s_or_b64 vcc, vcc, s[20:21]
  s_or_b64 vcc, vcc, s[22:23]
  s_nop 0
  s_cbranch_vccz L_pok_83
  v_cmp_ne_u64 vcc, s[30:31], v[18:19]
  v_cmp_ne_u64 s[20:21], s[30:31], v[22:23]
  v_cmp_ne_u64 s[22:23], s[30:31], v[26:27]
  s_or_b64 vcc, vcc, s[20:21]
  s_or_b64 vcc, vcc, s[22:23]
  s_nop 0
  s_cbranch_vccz L_pok_83
  v_cmp_ne_u64 vcc, s[30:31], v[18:19]
  v_cmp_ne_u64 s[20:21], s[30:31], v[22:23]
  v_cmp_ne_u64 s[22:23], s[30:31], v[26:27]
  s_or_b64 vcc, vcc, s[20:21]
  s_or_b64 vcc, vcc, s[22:23]
  s_nop 0
  s_cbranch_vccz L_pok_83
  s_waitcnt vmcnt(14)
  s_sub_u32 s70, s70, 1
  s_cbranch_scc0 L_fp_84
L_pok_83:
  v_pk_add_f32 v[40:41], v[16:17], v[20:21]
  v_pk_add_f32 v[40:41], v[40:41], v[24:25]
  s_nop 1
  v_add_f32_dpp v40, v40, v40 row_ror:8 row_mask:0xf bank_mask:0xf
  v_add_f32_dpp v41, v41, v41 row_ror:8 row_mask:0xf bank_mask:0xf
  v_mov_b32 v42, v40
  v_mov_b32 v43, v41
  s_nop 0
  v_permlane16_swap_b32 v40, v42
  v_permlane16_swap_b32 v41, v43
  v_add_f32 v40, v40, v42
  v_add_f32 v41, v41, v43
  v_cmp_ne_u64 vcc, s[30:31], v[142:143]
  s_nop 0
  s_cbranch_vccz L_pok_88
  s_cmp_lg_u32 s46, 1
  s_cbranch_scc1 L_pslow_87
  s_mov_b32 s70, 4000007
L_fp_89:
  s_mov_b64 exec, s[8:9]
  buffer_load_dwordx4 v[140:143], v61, s[32:35], s65 offen sc1
  s_mov_b64 exec, -1
  v_cmp_ne_u64 vcc, s[30:31], v[142:143]
  s_nop 0
  s_cbranch_vccz L_pok_88
  v_cmp_ne_u64 vcc, s[30:31], v[142:143]
  s_nop 0
  s_cbranch_vccz L_pok_88
  s_waitcnt vmcnt(12)
  s_sub_u32 s70, s70, 1
  s_cbranch_scc0 L_fp_89
L_pok_88:
  s_cmp_lg_u32 s46, 1
  s_cbranch_scc1 L_nopre
  buffer_load_dwordx4 v[128:131], v60, s[32:35], s60 offen sc1
  buffer_load_dwordx4 v[132:135], v60, s[32:35], s60 offen offset:1024 sc1
  s_mov_b64 exec, s[10:11]
  buffer_load_dwordx4 v[136:139], v60, s[32:35], s60 offen offset:2048 sc1
  s_mov_b64 exec, -1
L_nopre:
  v_add_f32_dpp v36, v140, v140 quad_perm:[1,0,3,2] row_mask:0xf bank_mask:0xf
  v_add_f32_dpp v37, v141, v141 quad_perm:[1,0,3,2] row_mask:0xf bank_mask:0xf
  s_nop 0
  v_add_f32_dpp v36, v36, v36 quad_perm:[2,3,0,1] row_mask:0xf bank_mask:0xf
  v_add_f32_dpp v37, v37, v37 quad_perm:[2,3,0,1] row_mask:0xf bank_mask:0xf
  s_nop 0
  v_add_f32_dpp v36, v36, v36 row_half_mirror row_mask:0xf bank_mask:0xf
  v_add_f32_dpp v37, v37, v37 row_half_mirror row_mask:0xf bank_mask:0xf
  s_nop 0
  v_add_f32_dpp v46, v36, v36 row_mirror row_mask:0xf bank_mask:0xf
  v_add_f32_dpp v47, v37, v37 row_mirror row_mask:0xf bank_mask:0xf
  v_add_f32_dpp v36, v36, v36 row_mirror row_mask:0xf bank_mask:0xf
  v_add_f32_dpp v37, v37, v37 row_mirror row_mask:0xf bank_mask:0xf
  s_nop 0
  v_permlane16_swap_b32 v36, v46
  v_permlane16_swap_b32 v37, v47
  v_pk_add_f32 v[36:37], v[36:37], v[46:47]
  s_cbranch_scc1 L_nopre2
  buffer_load_dwordx4 v[128:131], v60, s[32:35], s60 offen sc1
  buffer_load_dwordx4 v[132:135], v60, s[32:35], s60 offen offset:1024 sc1
  s_mov_b64 exec, s[10:11]
  buffer_load_dwordx4 v[136:139], v60, s[32:35], s60 offen offset:2048 sc1
  s_mov_b64 exec, -1
L_nopre2:
  v_mul_f32 v44, 0x3acccccd, v36
  v_mul_f32 v45, 0x3acccccd, v37
  v_fma_f32 v45, -v44, v44, v45
  v_max_f32 v45, 0, v45
  v_cvt_pk_bf16_f32 v45, v57, v45
  v_cvt_pk_bf16_f32 v44, v57, v44
  v_add_f32 v45, 0x3727c5ac, v45
  v_cvt_pk_bf16_f32 v45, v57, v45
  v_sqrt_f32 v45, v45
  v_mul_f32 v40, v44, v40
  v_cvt_pk_bf16_f32 v45, v57, v45
  v_rcp_f32 v45, v45
  v_mul_f32 v41, v44, v41
  v_cmp_ne_u64 vcc, s[30:31], v[130:131]
  v_cmp_ne_u64 s[20:21], s[30:31], v[134:135]
  v_cmp_ne_u64 s[22:23], s[30:31], v[138:139]
  s_or_b64 vcc, vcc, s[20:21]
  s_or_b64 vcc, vcc, s[22:23]
  s_nop 0
  s_cbranch_vccz L_pok_93
  s_cmp_lg_u32 s46, 1
  s_cbranch_scc1 L_pslow_92
  s_mov_b32 s70, 4000007
L_fp_94:
  buffer_load_dwordx4 v[128:131], v60, s[32:35], s60 offen sc1
  buffer_load_dwordx4 v[132:135], v60, s[32:35], s60 offen offset:1024 sc1
  s_mov_b64 exec, s[10:11]
  buffer_load_dwordx4 v[136:139], v60, s[32:35], s60 offen offset:2048 sc1
  s_mov_b64 exec, -1
  v_cmp_ne_u64 vcc, s[30:31], v[130:131]
  v_cmp_ne_u64 s[20:21], s[30:31], v[134:135]
  v_cmp_ne_u64 s[22:23], s[30:31], v[138:139]
  s_or_b64 vcc, vcc, s[20:21]
  s_or_b64 vcc, vcc, s[22:23]
  s_nop 0
  s_cbranch_vccz L_pok_93
  s_waitcnt vmcnt(12)
  s_sub_u32 s70, s70, 1
  s_cbranch_scc0 L_fp_94
L_pok_93:
L_hidc:
  v_pk_add_f32 v[8:9], v[128:129], v[132:133]
  v_pk_add_f32 v[8:9], v[8:9], v[136:137]
  s_nop 1
  v_add_f32_dpp v10, v8, v8 row_ror:8 row_mask:0xf bank_mask:0xf
  v_add_f32_dpp v11, v9, v9 row_ror:8 row_mask:0xf bank_mask:0xf
  v_add_f32_dpp v8, v8, v8 row_ror:8 row_mask:0xf bank_mask:0xf
  v_add_f32_dpp v9, v9, v9 row_ror:8 row_mask:0xf bank_mask:0xf
  s_nop 0
  v_permlane16_swap_b32 v8, v10
  v_permlane16_swap_b32 v9, v11
  v_add_f32 v8, v8, v10
  v_sub_f32 v8, v8, v40
  v_mul_f32 v8, v8, v45
  v_cvt_pk_bf16_f32 v8, v57, v8
  v_mul_f32 v12, 0xbfb8aa3b, v8
  v_exp_f32 v12, v12
  v_add_f32 v9, v9, v11
  v_add_f32 v12, 1.0, v12
  v_rcp_f32 v12, v12
  v_sub_f32 v9, v9, v41
  v_mul_f32 v9, v9, v45
  v_mul_f32 v8, v8, v12
  v_cvt_pk_bf16_f32 v9, v57, v9
  v_cvt_pk_bf16_f32 v8, v57, v8
  v_mul_f32 v8, v8, v9
  v_cvt_pk_bf16_f32 v8, v8, v8
  ds_write_b16 v62, v8 offset:704
  ds_write_b32 v63, v59 offset:736
  s_endpgm
L_f2:
  s_mov_b32 s8, s52
  s_mov_b32 s9, s53
  s_mov_b32 s10, 1966080
  s_mov_b32 s11, 0x20000
  v_mov_b32 v17, 0
  s_mov_b32 s70, 4000007
L_spin_97:
  ds_read_b32 v16, v17 offset:660
  s_waitcnt lgkmcnt(0)
  v_cmp_gt_u32 vcc, 1, v16
  s_nop 0
  s_cbranch_vccz L_sdone_98
  s_sleep 1
  s_sub_u32 s70, s70, 1
  s_cbranch_scc0 L_spin_97
L_sdone_98:
  v_readfirstlane_b32 s47, v16
  s_mul_i32 s72, s4, 12
  s_add_u32 s72, s72, s5
  v_mov_b32 v57, 0
  s_sub_u32 s68, s3, 7
  s_lshl_b32 s69, s68, 8
  v_lshlrev_b32 v58, 2, v0
  v_add_u32 v58, s69, v58
  v_lshrrev_b32 v2, 4, v0
  v_lshl_add_u32 v2, s68, 2, v2
  v_mul_u32_u24 v3, 52, v2
  v_lshrrev_b32 v3, 8, v3
  v_mul_u32_u24 v4, 5, v3
  v_sub_u32 v4, v2, v4
  v_cmp_lt_u32 vcc, 2, v4
  v_lshlrev_b32 v3, 1, v3
  s_nop 0
  v_addc_co_u32 v3, vcc, 0, v3, vcc
  v_lshrrev_b32 v3, v3, s47
  v_and_b32 v3, 1, v3
  v_lshlrev_b32 v116, 15, v2
  v_lshl_add_u32 v116, v3, 13, v116
  v_bfe_u32 v3, v0, 1, 3
  v_lshl_add_u32 v116, v3, 4, v116
  s_lshr_b32 s79, s72, 6
  s_lshl_b32 s79, s79, 14
  s_and_b32 s68, s72, 63
  s_lshl_b32 s68, s68, 7
  s_add_u32 s79, s79, s68
  s_add_u32 s79, s79, 1048576
  s_mov_b32 s60, 0x05040100
  s_mov_b32 s61, 0x07060302
  s_mul_i32 s62, s72, 20480
  v_lshrrev_b32 v2, 4, v0
  v_mul_u32_u24 v2, 1280, v2
  v_and_b32 v3, 15, v0
  v_lshl_add_u32 v2, v3, 4, v2
  s_add_u32 s62, s62, s69
  s_lshl_b32 s63, s69, 4
  v_lshlrev_b32 v3, 2, v0
  v_add_u32 v3, s63, v3
  s_add_u32 s63, s63, 8704
  s_barrier
  s_add_u32 m0, s63, 0
  s_nop 0
  buffer_load_dwordx4 v2, s[8:11], s62 offen nt lds
  s_add_u32 s62, s62, 5120
  s_add_u32 m0, s63, 1024
  s_nop 0
  buffer_load_dwordx4 v2, s[8:11], s62 offen nt lds
  s_add_u32 s62, s62, 5120
  s_add_u32 m0, s63, 2048
  s_nop 0
  buffer_load_dwordx4 v2, s[8:11], s62 offen nt lds
  s_add_u32 s62, s62, 5120
  s_add_u32 m0, s63, 3072
  s_nop 0
  buffer_load_dwordx4 v2, s[8:11], s62 offen nt lds
  s_add_u32 s62, s62, 5120
  s_barrier
  s_waitcnt vmcnt(0)
  ds_read_b32 v64, v3 offset:8704
  ds_read_b32 v65, v3 offset:8960
  ds_read_b32 v66, v3 offset:9216
  ds_read_b32 v67, v3 offset:9472
  ds_read_b32 v68, v3 offset:9728
  ds_read_b32 v69, v3 offset:9984
  ds_read_b32 v70, v3 offset:10240
  ds_read_b32 v71, v3 offset:10496
  ds_read_b32 v72, v3 offset:10752
  ds_read_b32 v73, v3 offset:11008
  ds_read_b32 v74, v3 offset:11264
  ds_read_b32 v75, v3 offset:11520
  ds_read_b32 v76, v3 offset:11776
  ds_read_b32 v77, v3 offset:12032
  ds_read_b32 v78, v3 offset:12288
  ds_read_b32 v79, v3 offset:12544
  s_waitcnt lgkmcnt(0)
  v_perm_b32 v80, v65, v64, s60
  v_perm_b32 v88, v65, v64, s61
  v_perm_b32 v81, v67, v66, s60
  v_perm_b32 v89, v67, v66, s61
  v_perm_b32 v82, v69, v68, s60
  v_perm_b32 v90, v69, v68, s61
  v_perm_b32 v83, v71, v70, s60
  v_perm_b32 v91, v71, v70, s61
  v_perm_b32 v84, v73, v72, s60
  v_perm_b32 v92, v73, v72, s61
  v_perm_b32 v85, v75, v74, s60
  v_perm_b32 v93, v75, v74, s61
  v_perm_b32 v86, v77, v76, s60
  v_perm_b32 v94, v77, v76, s61
  v_perm_b32 v87, v79, v78, s60
  v_perm_b32 v95, v79, v78, s61
  v_mov_b32 v16, 0
  v_mov_b32 v17, 0
  v_mov_b32 v18, 0
  v_mov_b32 v19, 0
  s_mov_b32 s66, 0x55555555
  s_mov_b32 s67, 0x55555555
  v_mov_b32 v6, s30
  v_mov_b32 v7, s31
  v_and_b32 v9, 15, v0
  v_lshlrev_b32 v9, 2, v9
  v_mov_b32 v8, 0
  s_mov_b32 s64, 0xff00ff00
  s_mov_b32 s65, 0xff00ff00
  s_mov_b32 s70, 32000056
  s_waitcnt lgkmcnt(0)
L_f2poll:
  ds_read_b32 v8, v9 offset:704
  s_waitcnt lgkmcnt(4)
  v_cmp_eq_u32 vcc, 0, v8
  s_sub_u32 s70, s70, 1
  s_cbranch_scc1 L_f2go
  s_and_b64 vcc, vcc, s[64:65]
  s_cbranch_scc1 L_f2poll
L_f2go:
  v_dot2c_f32_bf16_dpp v16, v8, v80 row_newbcast:0 row_mask:0xf bank_mask:0xf
  v_dot2c_f32_bf16_dpp v17, v8, v88 row_newbcast:0 row_mask:0xf bank_mask:0xf
  v_dot2c_f32_bf16_dpp v18, v8, v81 row_newbcast:1 row_mask:0xf bank_mask:0xf
  v_dot2c_f32_bf16_dpp v19, v8, v89 row_newbcast:1 row_mask:0xf bank_mask:0xf
  v_dot2c_f32_bf16_dpp v16, v8, v82 row_newbcast:2 row_mask:0xf bank_mask:0xf
  v_dot2c_f32_bf16_dpp v17, v8, v90 row_newbcast:2 row_mask:0xf bank_mask:0xf
  v_dot2c_f32_bf16_dpp v18, v8, v83 row_newbcast:3 row_mask:0xf bank_mask:0xf
  v_dot2c_f32_bf16_dpp v19, v8, v91 row_newbcast:3 row_mask:0xf bank_mask:0xf
  v_dot2c_f32_bf16_dpp v16, v8, v84 row_newbcast:4 row_mask:0xf bank_mask:0xf
  v_dot2c_f32_bf16_dpp v17, v8, v92 row_newbcast:4 row_mask:0xf bank_mask:0xf
  v_dot2c_f32_bf16_dpp v18, v8, v85 row_newbcast:5 row_mask:0xf bank_mask:0xf
  v_dot2c_f32_bf16_dpp v19, v8, v93 row_newbcast:5 row_mask:0xf bank_mask:0xf
  v_dot2c_f32_bf16_dpp v16, v8, v86 row_newbcast:6 row_mask:0xf bank_mask:0xf
  v_dot2c_f32_bf16_dpp v17, v8, v94 row_newbcast:6 row_mask:0xf bank_mask:0xf
  v_dot2c_f32_bf16_dpp v18, v8, v87 row_newbcast:7 row_mask:0xf bank_mask:0xf
  v_dot2c_f32_bf16_dpp v19, v8, v95 row_newbcast:7 row_mask:0xf bank_mask:0xf
  s_nop 2
  v_pk_add_f32 v[16:17], v[16:17], v[18:19]
  v_cvt_pk_bf16_f32 v4, v16, v17
  s_nop 1
  v_mov_b32_dpp v5, v4 quad_perm:[1,0,3,2] row_mask:0xf bank_mask:0xf
  s_mov_b64 exec, s[66:67]
  buffer_store_dwordx4 v[4:7], v116, s[24:27], s79 offen sc1
L_end:
  s_endpgm
L_dry:
  s_endpgm
L_slow_25:
  s_mov_b32 exec_lo, 0xffffffff
  s_mov_b32 exec_hi, 0xffff
  buffer_store_dwordx4 v[4:7], v13, s[24:27], s74 offen sc1
  s_mov_b64 exec, -1
  s_nop 1
  s_branch L_back_26
L_slow_32:
  s_mov_b32 exec_lo, 0x55555555
  s_mov_b32 exec_hi, 0x0
  buffer_store_dwordx4 v[8:11], v2, s[24:27], s66 offen offset:1536 sc1
  s_mov_b64 exec, -1
  s_nop 1
  s_branch L_back_33
L_slow_46:
  s_mov_b32 exec_lo, 0x101
  s_mov_b32 exec_hi, 0x0
  buffer_store_dwordx4 v[2:5], v12, s[24:27], s68 offen sc1
  s_mov_b64 exec, -1
  s_nop 1
  s_branch L_back_47
L_slow_54:
  s_mov_b32 exec_lo, 0xffffffff
  s_mov_b32 exec_hi, 0xffff
  buffer_store_dwordx4 v[4:7], v13, s[24:27], s74 offen sc1
  s_mov_b64 exec, -1
  s_nop 1
  s_branch L_back_55
L_slow_72:
  s_mov_b32 exec_lo, 0x1
  s_mov_b32 exec_hi, 0x0
  buffer_store_dwordx4 v[4:7], v55, s[24:27], s72 offen sc1
  s_mov_b32 exec_lo, 0x110011
  s_mov_b32 exec_hi, 0x110011
  buffer_store_dwordx4 v[12:15], v54, s[24:27], s75 offen sc1
  s_mov_b64 exec, -1
  s_nop 1
  s_branch L_back_73
L_slow_74:
  s_mov_b32 exec_lo, 0xffffffff
  s_mov_b32 exec_hi, 0x0
  buffer_store_dwordx4 v[32:35], v59, s[24:27], s77 offen sc1
  s_mov_b64 exec, -1
  s_nop 1
  s_branch L_back_75
L_slow_76:
  s_mov_b32 exec_lo, 0xffffffff
  s_mov_b32 exec_hi, 0x0
  buffer_store_dwordx4 v[4:7], v59, s[24:27], s76 offen sc1
  s_mov_b64 exec, -1
  s_nop 1
  s_branch L_back_77
L_pslow_82:
  s_mov_b32 s16, s32
  s_mov_b32 s17, s33
  s_mov_b32 s18, 4194304
  s_mov_b32 s19, 0x20000
  s_mov_b32 s70, 4000007
L_spin_85:
  buffer_load_dwordx4 v[16:19], v60, s[16:19], s62 offen sc1
  buffer_load_dwordx4 v[20:23], v60, s[16:19], s62 offen offset:1024 sc1
  s_mov_b64 exec, s[10:11]
  buffer_load_dwordx4 v[24:27], v60, s[16:19], s62 offen offset:2048 sc1
  s_mov_b64 exec, -1
  s_mov_b64 exec, s[8:9]
  buffer_load_dwordx4 v[140:143], v61, s[16:19], s65 offen sc1
  s_mov_b64 exec, -1
  buffer_load_dwordx4 v[128:131], v60, s[16:19], s60 offen sc1
  buffer_load_dwordx4 v[132:135], v60, s[16:19], s60 offen offset:1024 sc1
  s_mov_b64 exec, s[10:11]
  buffer_load_dwordx4 v[136:139], v60, s[16:19], s60 offen offset:2048 sc1
  s_mov_b64 exec, -1
  s_waitcnt vmcnt(0)
  v_cmp_ne_u64 vcc, s[30:31], v[18:19]
  v_cmp_ne_u64 s[20:21], s[30:31], v[22:23]
  v_cmp_ne_u64 s[22:23], s[30:31], v[26:27]
  s_or_b64 vcc, vcc, s[20:21]
  s_or_b64 vcc, vcc, s[22:23]
  s_nop 0
  s_cbranch_vccz L_sdone_86
  s_and_b32 s99, s70, 7
  s_cmp_eq_u32 s46, 1
  s_cselect_b32 s99, 1, s99
  s_cmp_lg_u32 s99, 0
  s_cselect_b32 s16, s32, s24
  s_cselect_b32 s17, s33, s25
  s_sub_u32 s70, s70, 1
  s_cbranch_scc0 L_spin_85
L_sdone_86:
  s_branch L_pok_83
L_pslow_87:
  s_mov_b32 s16, s32
  s_mov_b32 s17, s33
  s_mov_b32 s18, 4194304
  s_mov_b32 s19, 0x20000
  s_mov_b32 s70, 4000007
L_spin_90:
  s_mov_b64 exec, s[8:9]
  buffer_load_dwordx4 v[140:143], v61, s[16:19], s65 offen sc1
  s_mov_b64 exec, -1
  s_waitcnt vmcnt(0)
  v_cmp_ne_u64 vcc, s[30:31], v[142:143]
  s_nop 0
  s_cbranch_vccz L_sdone_91
  s_and_b32 s99, s70, 7
  s_cmp_eq_u32 s46, 1
  s_cselect_b32 s99, 1, s99
  s_cmp_lg_u32 s99, 0
  s_cselect_b32 s16, s32, s24
  s_cselect_b32 s17, s33, s25
  s_sub_u32 s70, s70, 1
  s_cbranch_scc0 L_spin_90
L_sdone_91:
  s_branch L_pok_88
L_pslow_92:
  s_mov_b32 s16, s32
  s_mov_b32 s17, s33
  s_mov_b32 s18, 4194304
  s_mov_b32 s19, 0x20000
  s_mov_b32 s70, 4000007
L_spin_95:
  buffer_load_dwordx4 v[128:131], v60, s[16:19], s60 offen sc1
  buffer_load_dwordx4 v[132:135], v60, s[16:19], s60 offen offset:1024 sc1
  s_mov_b64 exec, s[10:11]
  buffer_load_dwordx4 v[136:139], v60, s[16:19], s60 offen offset:2048 sc1
  s_mov_b64 exec, -1
  s_waitcnt vmcnt(0)
  v_cmp_ne_u64 vcc, s[30:31], v[130:131]
  v_cmp_ne_u64 s[20:21], s[30:31], v[134:135]
  v_cmp_ne_u64 s[22:23], s[30:31], v[138:139]
  s_or_b64 vcc, vcc, s[20:21]
  s_or_b64 vcc, vcc, s[22:23]
  s_nop 0
  s_cbranch_vccz L_sdone_96
  s_and_b32 s99, s70, 7
  s_cmp_eq_u32 s46, 1
  s_cselect_b32 s99, 1, s99
  s_cmp_lg_u32 s99, 0
  s_cselect_b32 s16, s32, s24
  s_cselect_b32 s17, s33, s25
  s_sub_u32 s70, s70, 1
  s_cbranch_scc0 L_spin_95
L_sdone_96:
  s_branch L_pok_93
L_codeend:
.section .rodata,"a"
.p2align 6
.amdhsa_kernel sequential_preLN__sliding_block_cached__glu_gated_swiglu__decode_kernel
  .amdhsa_next_free_vgpr 168
  .amdhsa_next_free_sgpr 100
  .amdhsa_accum_offset 168
  .amdhsa_group_segment_fixed_size 0
  .amdhsa_kernarg_size 96
  .amdhsa_user_sgpr_count 2
  .amdhsa_user_sgpr_kernarg_segment_ptr 1
  .amdhsa_system_sgpr_workgroup_id_x 1
.end_amdhsa_kernel
```

```asm
; @launch grid=(256,1,1) block=(768,1,1) lds=64000
.amdgcn_target "amdgcn-amd-amdhsa--gfx950"
.text
.globl sequential_preLN__sliding_block_cached__glu_gated_swiglu__decode_kernel
.p2align 8
.type sequential_preLN__sliding_block_cached__glu_gated_swiglu__decode_kernel,@function
sequential_preLN__sliding_block_cached__glu_gated_swiglu__decode_kernel:
  s_load_dwordx2 s[8:9], s[0:1], 8
  v_readfirstlane_b32 s3, v0
  s_lshr_b32 s79, s2, 6
  s_cmp_gt_u32 s79, 3
  s_cbranch_scc1 L_end
  s_lshr_b32 s3, s3, 6
  s_cmp_gt_u32 s3, 3
  s_cbranch_scc1 L_str
  s_getpc_b64 s[20:21]
L_pc0:
  v_lshlrev_b32 v8, 7, v0
  v_min_u32 v8, L_codeend-L_pc0-4, v8
  global_load_dword v166, v8, s[20:21]
  s_branch L_helper0
L_str:
  s_and_b32 s4, s2, 7
  s_lshr_b32 s6, s2, 7
  s_bfe_u32 s7, s2, 0x40003
  s_lshl1_add_u32 s6, s4, s6
  s_lshl_b32 s6, s6, 10
  s_lshl1_add_u32 s64, s7, s6
  s_addk_i32 s64, 17279
  s_mulk_i32 s64, 12288
  v_lshlrev_b32 v3, 4, v0
  v_lshrrev_b32 v2, 3, v0
  v_lshl_add_u32 v1, v2, 8, v3
  s_lshl_b32 s10, 3, 27
  s_mov_b32 s11, 0x20000
  s_waitcnt lgkmcnt(0)
  buffer_load_dwordx4 v[64:67], v1, s[8:11], s64 offen offset:0 nt
  buffer_load_dwordx4 v[68:71], v1, s[8:11], s64 offen offset:128 nt
  buffer_load_dwordx4 v[72:75], v1, s[8:11], s64 offen offset:256 nt
  s_branch L_stream0
L_helper0:
  s_load_dwordx16 s[36:51], s[0:1], 0
  s_load_dwordx8 s[52:59], s[0:1], 64
  s_and_b32 s4, s2, 7
  s_lshl2_add_u32 s6, s4, s79
  s_bfe_u32 s7, s2, 0x30003
  v_and_b32 v0, 63, v0
  s_cmp_lg_u32 s3, 3
  s_cbranch_scc0 L_w3
  v_lshrrev_b32 v2, 3, v0
  v_mul_u32_u24 v2, 12160, v2
  v_lshl_add_u32 v2, v0, 4, v2
  s_mul_i32 s68, s7, 7680
  s_lshr_b32 s69, s79, 1
  s_mul_i32 s69, s69, 14
  s_add_u32 s69, s69, s79
  s_lshl1_add_u32 s69, s4, s69
  s_add_u32 s69, s69, 0
  s_mul_i32 s69, s69, 3
  s_add_u32 s68, s68, s69
  s_add_u32 s68, s68, s3
  s_lshl_b32 s68, s68, 7
  s_lshl_b32 s69, 3, 15
  s_mov_b32 s10, 7864320
  s_mov_b32 s11, 0x20000
  s_waitcnt lgkmcnt(0)
  s_mov_b64 s[8:9], s[42:43]
  buffer_load_dwordx4 v[24:27], v2, s[8:11], s68 offen nt
  s_add_u32 s68, s68, s69
  buffer_load_dwordx4 v[28:31], v2, s[8:11], s68 offen nt
  s_add_u32 s68, s68, s69
  buffer_load_dwordx4 v[32:35], v2, s[8:11], s68 offen nt
  s_add_u32 s68, s68, s69
  buffer_load_dwordx4 v[36:39], v2, s[8:11], s68 offen nt
  s_add_u32 s68, s68, s69
  buffer_load_dwordx4 v[40:43], v2, s[8:11], s68 offen nt
  s_add_u32 s68, s68, s69
  buffer_load_dwordx4 v[44:47], v2, s[8:11], s68 offen nt
  s_add_u32 s68, s68, s69
  buffer_load_dwordx4 v[48:51], v2, s[8:11], s68 offen nt
  s_add_u32 s68, s68, s69
  buffer_load_dwordx4 v[52:55], v2, s[8:11], s68 offen nt
  s_add_u32 s68, s68, s69
  buffer_load_dwordx4 v[56:59], v2, s[8:11], s68 offen nt
  s_add_u32 s68, s68, s69
  buffer_load_dwordx4 v[60:63], v2, s[8:11], s68 offen nt
  s_branch L_helper
L_w3:
  v_lshlrev_b32 v1, 3, v0
  v_mov_b32 v4, 0
  v_mov_b32 v5, 0
  ds_write_b64 v1, v[4:5] offset:384
  s_waitcnt lgkmcnt(0)
  s_memrealtime s[62:63]
  s_barrier
  s_load_dwordx2 s[28:29], s[58:59], 917504
  s_branch L_ids
L_stream0:
  s_load_dwordx16 s[36:51], s[0:1], 0
  s_load_dwordx8 s[52:59], s[0:1], 64
  v_and_b32 v0, 63, v0
  s_sub_u32 s73, s3, 4
  v_and_b32 v3, 0x70, v3
  s_lshl2_add_u32 s6, s4, s79
  s_and_b32 s7, s7, 7
  s_add_u32 s65, s64, 393216
  s_waitcnt lgkmcnt(0)
  s_barrier
  s_waitcnt vmcnt(2)
  buffer_load_dwordx4 v[76:79], v1, s[8:11], s65 offen offset:0 nt
  s_load_dwordx2 s[28:29], s[58:59], 917504
  s_mov_b32 s24, s58
  s_mov_b32 s25, s59
  s_mov_b32 s26, 4194304
  s_mov_b32 s27, 0x20000
  s_add_u32 s32, s58, 4194304
  s_addc_u32 s33, s59, 0
  s_mov_b32 s34, 4194304
  s_mov_b32 s35, 0x20000
  s_lshl3_add_u32 s71, s6, s7
  s_mul_i32 s5, s79, 5
  s_mul_i32 s47, s79, 3
  s_add_u32 s47, s47, 15
  s_cmp_lt_u32 s7, 5
  s_cselect_b32 s5, s5, s47
  s_add_u32 s5, s5, s7
  s_mov_b32 s12, s40
  s_mov_b32 s13, s41
  s_mov_b32 s14, 402653184
  s_mov_b32 s15, 0x20000
  s_waitcnt vmcnt(2)
  buffer_load_dwordx4 v[80:83], v1, s[8:11], s65 offen offset:128 nt
  s_waitcnt vmcnt(2)
  buffer_load_dwordx4 v[84:87], v1, s[8:11], s65 offen offset:256 nt
  s_add_u32 s66, s65, 393216
  s_waitcnt vmcnt(2)
  buffer_load_dwordx4 v[88:91], v1, s[8:11], s66 offen offset:0 nt
  s_waitcnt vmcnt(2)
  buffer_load_dwordx4 v[92:95], v1, s[8:11], s66 offen offset:128 nt
  s_waitcnt vmcnt(2)
  buffer_load_dwordx4 v[96:99], v1, s[8:11], s66 offen offset:256 nt
  s_add_u32 s67, s66, 393216
  s_waitcnt vmcnt(2)
  buffer_load_dwordx4 v[100:103], v1, s[8:11], s67 offen offset:0 nt
  s_waitcnt vmcnt(2)
  buffer_load_dwordx4 v[104:107], v1, s[8:11], s67 offen offset:128 nt
  s_waitcnt vmcnt(2)
  buffer_load_dwordx4 v[108:111], v1, s[8:11], s67 offen offset:256 nt
  s_add_u32 s60, s67, 4092461056
  s_waitcnt vmcnt(2)
  buffer_load_dwordx4 v[16:19], v1, s[8:11], s60 offen offset:0 nt
  s_waitcnt vmcnt(2)
  buffer_load_dwordx4 v[20:23], v1, s[8:11], s60 offen offset:128 nt
  s_waitcnt vmcnt(2)
  buffer_load_dwordx4 v[24:27], v1, s[8:11], s60 offen offset:256 nt
  s_add_u32 s61, s60, 393216
  s_waitcnt vmcnt(2)
  buffer_load_dwordx4 v[28:31], v1, s[8:11], s61 offen offset:0 nt
  s_waitcnt vmcnt(2)
  buffer_load_dwordx4 v[32:35], v1, s[8:11], s61 offen offset:128 nt
  s_waitcnt vmcnt(2)
  buffer_load_dwordx4 v[36:39], v1, s[8:11], s61 offen offset:256 nt
  s_memrealtime s[76:77]
  s_waitcnt lgkmcnt(0)
  v_mov_b32 v6, 0
  v_mov_b32 v8, s76
  v_mov_b32 v9, 1
  s_mov_b64 exec, 1
  ds_add_u32 v6, v8 offset:696
  ds_add_u32 v6, v9 offset:700
  s_mov_b64 exec, -1
  s_add_u32 s62, s61, 393216
  s_waitcnt vmcnt(2)
  buffer_load_dwordx4 v[40:43], v1, s[8:11], s62 offen offset:0 nt
  s_waitcnt vmcnt(2)
  buffer_load_dwordx4 v[44:47], v1, s[8:11], s62 offen offset:128 nt
  s_waitcnt vmcnt(2)
  buffer_load_dwordx4 v[48:51], v1, s[8:11], s62 offen offset:256 nt
  s_add_u32 s63, s62, 393216
  s_waitcnt vmcnt(2)
  buffer_load_dwordx4 v[52:55], v1, s[8:11], s63 offen offset:0 nt
  s_waitcnt vmcnt(2)
  buffer_load_dwordx4 v[56:59], v1, s[8:11], s63 offen offset:128 nt
  s_waitcnt vmcnt(2)
  buffer_load_dwordx4 v[60:63], v1, s[8:11], s63 offen offset:256 nt
  s_waitcnt vmcnt(2)
  buffer_load_dwordx4 v[112:115], v1, s[12:15], s60 offen offset:0 nt
  s_waitcnt vmcnt(2)
  buffer_load_dwordx4 v[116:119], v1, s[12:15], s60 offen offset:128 nt
  s_waitcnt vmcnt(2)
  buffer_load_dwordx4 v[120:123], v1, s[12:15], s60 offen offset:256 nt
  v_mov_b32 v6, 0
  v_mov_b32 v7, 1
  s_mov_b64 exec, 1
  ds_add_u32 v6, v7 offset:692
  s_mov_b64 exec, -1
  s_waitcnt lgkmcnt(0)
  s_mul_i32 s30, s28, 0x2c9277b5
  s_add_u32 s30, s30, 0xac564b05
  s_mul_i32 s31, s29, 0x0019660d
  s_add_u32 s31, s31, 0x3c6ef35f
  v_and_b32 v2, 3, v0
  v_min_u32 v2, 2, v2
  v_lshlrev_b32 v2, 3, v2
  s_mov_b32 s70, 4000007
L_spin_1:
  ds_read_b32 v4, v2 offset:384
  s_waitcnt lgkmcnt(0)
  v_cmp_eq_u32 vcc, 0, v4
  s_nop 0
  s_cbranch_vccz L_sdone_2
  s_sleep 1
  s_sub_u32 s70, s70, 1
  s_cbranch_scc0 L_spin_1
L_sdone_2:
  ds_read_b128 v[4:7], v3 offset:0
  ds_read_b128 v[8:11], v3 offset:128
  ds_read_b128 v[12:15], v3 offset:256
  ds_read_b128 v[148:151], v3 offset:8192
  ds_read_b128 v[152:155], v3 offset:8320
  ds_read_b128 v[156:159], v3 offset:8448
  v_mov_b32 v160, 0
  v_mov_b32 v161, 0
  v_mov_b32 v162, 0
  v_mov_b32 v163, 0
  v_mov_b32 v164, 0
  v_mov_b32 v165, 0
  v_mov_b32 v166, 0
  v_mov_b32 v167, 0
  s_waitcnt vmcnt(3) lgkmcnt(0)
  v_dot2c_f32_bf16 v160, v16, v4
  v_dot2c_f32_bf16 v161, v28, v4
  v_dot2c_f32_bf16 v162, v40, v4
  v_dot2c_f32_bf16 v163, v52, v4
  v_dot2c_f32_bf16 v160, v17, v5
  v_dot2c_f32_bf16 v161, v29, v5
  v_dot2c_f32_bf16 v162, v41, v5
  v_dot2c_f32_bf16 v163, v53, v5
  v_dot2c_f32_bf16 v160, v18, v6
  v_dot2c_f32_bf16 v161, v30, v6
  v_dot2c_f32_bf16 v162, v42, v6
  v_dot2c_f32_bf16 v163, v54, v6
  v_dot2c_f32_bf16 v160, v19, v7
  v_dot2c_f32_bf16 v161, v31, v7
  v_dot2c_f32_bf16 v162, v43, v7
  v_dot2c_f32_bf16 v163, v55, v7
  v_dot2c_f32_bf16 v160, v20, v8
  v_dot2c_f32_bf16 v161, v32, v8
  v_dot2c_f32_bf16 v162, v44, v8
  v_dot2c_f32_bf16 v163, v56, v8
  v_dot2c_f32_bf16 v160, v21, v9
  v_dot2c_f32_bf16 v161, v33, v9
  v_dot2c_f32_bf16 v162, v45, v9
  v_dot2c_f32_bf16 v163, v57, v9
  v_dot2c_f32_bf16 v160, v22, v10
  v_dot2c_f32_bf16 v161, v34, v10
  v_dot2c_f32_bf16 v162, v46, v10
  v_dot2c_f32_bf16 v163, v58, v10
  v_dot2c_f32_bf16 v160, v23, v11
  v_dot2c_f32_bf16 v161, v35, v11
  v_dot2c_f32_bf16 v162, v47, v11
  v_dot2c_f32_bf16 v163, v59, v11
  v_dot2c_f32_bf16 v160, v24, v12
  v_dot2c_f32_bf16 v161, v36, v12
  v_dot2c_f32_bf16 v162, v48, v12
  v_dot2c_f32_bf16 v163, v60, v12
  v_dot2c_f32_bf16 v160, v25, v13
  v_dot2c_f32_bf16 v161, v37, v13
  v_dot2c_f32_bf16 v162, v49, v13
  v_dot2c_f32_bf16 v163, v61, v13
  v_dot2c_f32_bf16 v160, v26, v14
  v_dot2c_f32_bf16 v161, v38, v14
  v_dot2c_f32_bf16 v162, v50, v14
  v_dot2c_f32_bf16 v163, v62, v14
  v_dot2c_f32_bf16 v160, v27, v15
  v_dot2c_f32_bf16 v161, v39, v15
  v_dot2c_f32_bf16 v162, v51, v15
  v_dot2c_f32_bf16 v163, v63, v15
  v_dot2c_f32_bf16 v164, v64, v148
  v_dot2c_f32_bf16 v165, v76, v148
  v_dot2c_f32_bf16 v166, v88, v148
  v_dot2c_f32_bf16 v167, v100, v148
  v_dot2c_f32_bf16 v164, v65, v149
  v_dot2c_f32_bf16 v165, v77, v149
  v_dot2c_f32_bf16 v166, v89, v149
  v_dot2c_f32_bf16 v167, v101, v149
  v_dot2c_f32_bf16 v164, v66, v150
  v_dot2c_f32_bf16 v165, v78, v150
  v_dot2c_f32_bf16 v166, v90, v150
  v_dot2c_f32_bf16 v167, v102, v150
  v_dot2c_f32_bf16 v164, v67, v151
  v_dot2c_f32_bf16 v165, v79, v151
  v_dot2c_f32_bf16 v166, v91, v151
  v_dot2c_f32_bf16 v167, v103, v151
  v_dot2c_f32_bf16 v164, v68, v152
  v_dot2c_f32_bf16 v165, v80, v152
  v_dot2c_f32_bf16 v166, v92, v152
  v_dot2c_f32_bf16 v167, v104, v152
  v_dot2c_f32_bf16 v164, v69, v153
  v_dot2c_f32_bf16 v165, v81, v153
  v_dot2c_f32_bf16 v166, v93, v153
  v_dot2c_f32_bf16 v167, v105, v153
  v_dot2c_f32_bf16 v164, v70, v154
  v_dot2c_f32_bf16 v165, v82, v154
  v_dot2c_f32_bf16 v166, v94, v154
  v_dot2c_f32_bf16 v167, v106, v154
  v_dot2c_f32_bf16 v164, v71, v155
  v_dot2c_f32_bf16 v165, v83, v155
  v_dot2c_f32_bf16 v166, v95, v155
  v_dot2c_f32_bf16 v167, v107, v155
  v_dot2c_f32_bf16 v164, v72, v156
  v_dot2c_f32_bf16 v165, v84, v156
  v_dot2c_f32_bf16 v166, v96, v156
  v_dot2c_f32_bf16 v167, v108, v156
  v_dot2c_f32_bf16 v164, v73, v157
  v_dot2c_f32_bf16 v165, v85, v157
  v_dot2c_f32_bf16 v166, v97, v157
  v_dot2c_f32_bf16 v167, v109, v157
  v_dot2c_f32_bf16 v164, v74, v158
  v_dot2c_f32_bf16 v165, v86, v158
  v_dot2c_f32_bf16 v166, v98, v158
  v_dot2c_f32_bf16 v167, v110, v158
  v_dot2c_f32_bf16 v164, v75, v159
  v_dot2c_f32_bf16 v165, v87, v159
  v_dot2c_f32_bf16 v166, v99, v159
  v_dot2c_f32_bf16 v167, v111, v159
  v_add_f32_dpp v160, v160, v160 quad_perm:[1,0,3,2] row_mask:0xf bank_mask:0xf
  v_add_f32_dpp v161, v161, v161 quad_perm:[1,0,3,2] row_mask:0xf bank_mask:0xf
  v_add_f32_dpp v162, v162, v162 quad_perm:[1,0,3,2] row_mask:0xf bank_mask:0xf
  v_add_f32_dpp v163, v163, v163 quad_perm:[1,0,3,2] row_mask:0xf bank_mask:0xf
  v_add_f32_dpp v164, v164, v164 quad_perm:[1,0,3,2] row_mask:0xf bank_mask:0xf
  v_add_f32_dpp v165, v165, v165 quad_perm:[1,0,3,2] row_mask:0xf bank_mask:0xf
  v_add_f32_dpp v166, v166, v166 quad_perm:[1,0,3,2] row_mask:0xf bank_mask:0xf
  v_add_f32_dpp v167, v167, v167 quad_perm:[1,0,3,2] row_mask:0xf bank_mask:0xf
  v_add_f32_dpp v160, v160, v160 quad_perm:[2,3,0,1] row_mask:0xf bank_mask:0xf
  v_add_f32_dpp v161, v161, v161 quad_perm:[2,3,0,1] row_mask:0xf bank_mask:0xf
  v_add_f32_dpp v162, v162, v162 quad_perm:[2,3,0,1] row_mask:0xf bank_mask:0xf
  v_add_f32_dpp v163, v163, v163 quad_perm:[2,3,0,1] row_mask:0xf bank_mask:0xf
  v_add_f32_dpp v164, v164, v164 quad_perm:[2,3,0,1] row_mask:0xf bank_mask:0xf
  v_add_f32_dpp v165, v165, v165 quad_perm:[2,3,0,1] row_mask:0xf bank_mask:0xf
  v_add_f32_dpp v166, v166, v166 quad_perm:[2,3,0,1] row_mask:0xf bank_mask:0xf
  v_add_f32_dpp v167, v167, v167 quad_perm:[2,3,0,1] row_mask:0xf bank_mask:0xf
  v_add_f32_dpp v160, v160, v160 row_half_mirror row_mask:0xf bank_mask:0xf
  v_add_f32_dpp v161, v161, v161 row_half_mirror row_mask:0xf bank_mask:0xf
  v_add_f32_dpp v162, v162, v162 row_half_mirror row_mask:0xf bank_mask:0xf
  v_add_f32_dpp v163, v163, v163 row_half_mirror row_mask:0xf bank_mask:0xf
  v_add_f32_dpp v164, v164, v164 row_half_mirror row_mask:0xf bank_mask:0xf
  v_add_f32_dpp v165, v165, v165 row_half_mirror row_mask:0xf bank_mask:0xf
  v_add_f32_dpp v166, v166, v166 row_half_mirror row_mask:0xf bank_mask:0xf
  v_add_f32_dpp v167, v167, v167 row_half_mirror row_mask:0xf bank_mask:0xf
  s_mov_b32 s68, 0x3d93cd3a
  v_mov_b32 v2, 0
  v_cvt_pk_bf16_f32 v160, v2, v160
  v_cvt_pk_bf16_f32 v161, v2, v161
  v_cvt_pk_bf16_f32 v162, v2, v162
  v_cvt_pk_bf16_f32 v163, v2, v163
  v_cvt_pk_bf16_f32 v164, v2, v164
  v_cvt_pk_bf16_f32 v165, v2, v165
  v_cvt_pk_bf16_f32 v166, v2, v166
  v_cvt_pk_bf16_f32 v167, v2, v167
  v_mul_f32 v160, s68, v160
  v_mul_f32 v161, s68, v161
  v_mul_f32 v162, s68, v162
  v_mul_f32 v163, s68, v163
  v_mul_f32 v164, s68, v164
  v_mul_f32 v165, s68, v165
  v_mul_f32 v166, s68, v166
  v_mul_f32 v167, s68, v167
  v_cvt_pk_bf16_f32 v160, v2, v160
  v_cvt_pk_bf16_f32 v161, v2, v161
  v_cvt_pk_bf16_f32 v162, v2, v162
  v_cvt_pk_bf16_f32 v163, v2, v163
  v_cvt_pk_bf16_f32 v164, v2, v164
  v_cvt_pk_bf16_f32 v165, v2, v165
  v_cvt_pk_bf16_f32 v166, v2, v166
  v_cvt_pk_bf16_f32 v167, v2, v167
  v_max_f32 v4, v160, v161
  v_max_f32 v6, v164, v165
  v_max3_f32 v4, v4, v162, v163
  v_max3_f32 v6, v6, v166, v167
  s_nop 0
  v_max_f32_dpp v4, v4, v4 row_ror:8 row_mask:0xf bank_mask:0xf
  v_max_f32_dpp v6, v6, v6 row_ror:8 row_mask:0xf bank_mask:0xf
  v_mov_b32 v88, v4
  v_mov_b32 v89, v6
  s_nop 0
  v_permlane16_swap_b32 v4, v88
  v_permlane16_swap_b32 v6, v89
  v_max_f32 v4, v4, v88
  v_max_f32 v6, v6, v89
  v_mov_b32 v88, v4
  v_mov_b32 v89, v6
  s_nop 0
  v_permlane32_swap_b32 v4, v88
  v_permlane32_swap_b32 v6, v89
  v_max_f32 v4, v4, v88
  v_max_f32 v6, v6, v89
  s_mov_b32 s68, 0x3fb8aa3b
  v_sub_f32 v160, v160, v4
  v_sub_f32 v161, v161, v4
  v_sub_f32 v162, v162, v4
  v_sub_f32 v163, v163, v4
  v_sub_f32 v164, v164, v6
  v_sub_f32 v165, v165, v6
  v_sub_f32 v166, v166, v6
  v_sub_f32 v167, v167, v6
  v_mul_f32 v160, s68, v160
  v_mul_f32 v161, s68, v161
  v_mul_f32 v162, s68, v162
  v_mul_f32 v163, s68, v163
  v_mul_f32 v164, s68, v164
  v_mul_f32 v165, s68, v165
  v_mul_f32 v166, s68, v166
  v_mul_f32 v167, s68, v167
  v_exp_f32 v160, v160
  v_exp_f32 v161, v161
  v_exp_f32 v162, v162
  v_exp_f32 v163, v163
  v_exp_f32 v164, v164
  v_exp_f32 v165, v165
  v_exp_f32 v166, v166
  v_exp_f32 v167, v167
  v_add_f32 v5, v160, v161
  v_add_f32 v7, v164, v165
  v_add_f32 v5, v5, v162
  v_add_f32 v7, v7, v166
  v_add_f32 v5, v5, v163
  v_add_f32 v7, v7, v167
  s_nop 0
  v_add_f32_dpp v5, v5, v5 row_ror:8 row_mask:0xf bank_mask:0xf
  v_add_f32_dpp v7, v7, v7 row_ror:8 row_mask:0xf bank_mask:0xf
  v_mov_b32 v88, v5
  v_mov_b32 v89, v7
  s_nop 0
  v_permlane16_swap_b32 v5, v88
  v_permlane16_swap_b32 v7, v89
  v_add_f32 v5, v5, v88
  v_add_f32 v7, v7, v89
  v_mov_b32 v88, v5
  v_mov_b32 v89, v7
  s_nop 0
  v_permlane32_swap_b32 v5, v88
  v_permlane32_swap_b32 v7, v89
  v_add_f32 v5, v5, v88
  v_add_f32 v7, v7, v89
  s_lshl_b32 s69, s73, 4
  v_mov_b32 v88, s69
  ds_write_b128 v88, v[4:7] offset:512
  v_cvt_pk_bf16_f32 v160, v160, v2
  v_cvt_pk_bf16_f32 v161, v161, v2
  v_cvt_pk_bf16_f32 v162, v162, v2
  v_cvt_pk_bf16_f32 v163, v163, v2
  v_cvt_pk_bf16_f32 v164, v164, v2
  v_cvt_pk_bf16_f32 v165, v165, v2
  v_cvt_pk_bf16_f32 v166, v166, v2
  v_cvt_pk_bf16_f32 v167, v167, v2
  v_mov_b32 v64, 0
  v_mov_b32 v65, 0
  v_mov_b32 v66, 0
  v_mov_b32 v67, 0
  v_mov_b32 v68, 0
  v_mov_b32 v69, 0
  v_mov_b32 v70, 0
  v_mov_b32 v71, 0
  v_mov_b32 v72, 0
  v_mov_b32 v73, 0
  v_mov_b32 v74, 0
  v_mov_b32 v75, 0
  v_mov_b32 v76, 0
  v_mov_b32 v77, 0
  v_mov_b32 v78, 0
  v_mov_b32 v79, 0
  v_mov_b32 v80, 0
  v_mov_b32 v81, 0
  v_mov_b32 v82, 0
  v_mov_b32 v83, 0
  v_mov_b32 v84, 0
  v_mov_b32 v85, 0
  v_mov_b32 v86, 0
  v_mov_b32 v87, 0
  v_mov_b32 v88, 0
  v_mov_b32 v89, 0
  v_mov_b32 v90, 0
  v_mov_b32 v91, 0
  v_mov_b32 v92, 0
  v_mov_b32 v93, 0
  v_mov_b32 v94, 0
  v_mov_b32 v95, 0
  v_mov_b32 v96, 0
  v_mov_b32 v97, 0
  v_mov_b32 v98, 0
  v_mov_b32 v99, 0
  v_mov_b32 v100, 0
  v_mov_b32 v101, 0
  v_mov_b32 v102, 0
  v_mov_b32 v103, 0
  v_mov_b32 v104, 0
  v_mov_b32 v105, 0
  v_mov_b32 v106, 0
  v_mov_b32 v107, 0
  v_mov_b32 v108, 0
  v_mov_b32 v109, 0
  v_mov_b32 v110, 0
  v_mov_b32 v111, 0
  v_mov_b32 v5, v6
  v_and_b32 v8, 7, v0
  v_lshlrev_b32 v8, 5, v8
  v_lshrrev_b32 v9, 4, v0
  v_lshl_add_u32 v8, v9, 3, v8
  s_mul_i32 s69, s73, 768
  v_add_u32 v8, s69, v8
  v_mov_b32 v11, 1
  s_waitcnt vmcnt(2)
  buffer_load_dwordx4 v[124:127], v1, s[12:15], s61 offen offset:0 nt
  s_waitcnt vmcnt(2)
  buffer_load_dwordx4 v[128:131], v1, s[12:15], s61 offen offset:128 nt
  v_lshlrev_b32 v10, 16, v160
  v_dot2c_f32_bf16 v64, v112, v160
  v_dot2c_f32_bf16 v65, v112, v10
  v_dot2c_f32_bf16 v66, v113, v160
  v_dot2c_f32_bf16 v67, v113, v10
  v_dot2c_f32_bf16 v68, v114, v160
  v_dot2c_f32_bf16 v69, v114, v10
  v_dot2c_f32_bf16 v70, v115, v160
  v_dot2c_f32_bf16 v71, v115, v10
  s_waitcnt vmcnt(2)
  buffer_load_dwordx4 v[132:135], v1, s[12:15], s61 offen offset:256 nt
  s_memrealtime s[76:77]
  v_mov_b32 v6, 0
  ds_read_b64 v[6:7], v6 offset:680
  s_movk_i32 s79, 457
  s_waitcnt lgkmcnt(0)
  v_readfirstlane_b32 s78, v6
  v_readfirstlane_b32 s72, v7
  s_add_u32 s78, s78, 5484
  v_dot2c_f32_bf16 v72, v116, v160
  v_dot2c_f32_bf16 v73, v116, v10
  v_dot2c_f32_bf16 v74, v117, v160
  v_dot2c_f32_bf16 v75, v117, v10
  v_dot2c_f32_bf16 v76, v118, v160
  v_dot2c_f32_bf16 v77, v118, v10
  v_dot2c_f32_bf16 v78, v119, v160
  v_dot2c_f32_bf16 v79, v119, v10
  s_waitcnt lgkmcnt(0)
  s_lshl_b32 s75, s76, 4
  s_sub_u32 s75, s75, s78
  s_and_b32 s75, s75, s72
  s_add_u32 s78, s78, s79
  s_waitcnt vmcnt(3)
  s_cmp_gt_i32 s75, 480
  s_cbranch_scc1 L_go_3
  s_waitcnt vmcnt(2)
  s_cmp_ge_i32 s75, 0
  s_cbranch_scc1 L_go_3
  s_waitcnt vmcnt(1)
L_go_3:
  buffer_load_dwordx4 v[136:139], v1, s[12:15], s62 offen offset:0 nt
  s_memrealtime s[76:77]
  v_dot2c_f32_bf16 v80, v120, v160
  v_dot2c_f32_bf16 v81, v120, v10
  v_dot2c_f32_bf16 v82, v121, v160
  v_dot2c_f32_bf16 v83, v121, v10
  v_dot2c_f32_bf16 v84, v122, v160
  v_dot2c_f32_bf16 v85, v122, v10
  v_dot2c_f32_bf16 v86, v123, v160
  v_dot2c_f32_bf16 v87, v123, v10
  s_waitcnt lgkmcnt(0)
  s_lshl_b32 s75, s76, 4
  s_sub_u32 s75, s75, s78
  s_and_b32 s75, s75, s72
  s_add_u32 s78, s78, s79
  s_waitcnt vmcnt(3)
  s_cmp_gt_i32 s75, 480
  s_cbranch_scc1 L_go_4
  s_waitcnt vmcnt(2)
  s_cmp_ge_i32 s75, 0
  s_cbranch_scc1 L_go_4
  s_waitcnt vmcnt(1)
L_go_4:
  buffer_load_dwordx4 v[140:143], v1, s[12:15], s62 offen offset:128 nt
  s_memrealtime s[76:77]
  v_lshlrev_b32 v10, 16, v161
  v_dot2c_f32_bf16 v64, v124, v161
  v_dot2c_f32_bf16 v65, v124, v10
  v_dot2c_f32_bf16 v66, v125, v161
  v_dot2c_f32_bf16 v67, v125, v10
  v_dot2c_f32_bf16 v68, v126, v161
  v_dot2c_f32_bf16 v69, v126, v10
  v_dot2c_f32_bf16 v70, v127, v161
  v_dot2c_f32_bf16 v71, v127, v10
  s_waitcnt lgkmcnt(0)
  s_lshl_b32 s75, s76, 4
  s_sub_u32 s75, s75, s78
  s_and_b32 s75, s75, s72
  s_add_u32 s78, s78, s79
  s_waitcnt vmcnt(3)
  s_cmp_gt_i32 s75, 480
  s_cbranch_scc1 L_go_5
  s_waitcnt vmcnt(2)
  s_cmp_ge_i32 s75, 0
  s_cbranch_scc1 L_go_5
  s_waitcnt vmcnt(1)
L_go_5:
  buffer_load_dwordx4 v[144:147], v1, s[12:15], s62 offen offset:256 nt
  s_memrealtime s[76:77]
  v_dot2c_f32_bf16 v72, v128, v161
  v_dot2c_f32_bf16 v73, v128, v10
  v_dot2c_f32_bf16 v74, v129, v161
  v_dot2c_f32_bf16 v75, v129, v10
  v_dot2c_f32_bf16 v76, v130, v161
  v_dot2c_f32_bf16 v77, v130, v10
  v_dot2c_f32_bf16 v78, v131, v161
  v_dot2c_f32_bf16 v79, v131, v10
  s_waitcnt lgkmcnt(0)
  s_lshl_b32 s75, s76, 4
  s_sub_u32 s75, s75, s78
  s_and_b32 s75, s75, s72
  s_add_u32 s78, s78, s79
  s_waitcnt vmcnt(3)
  s_cmp_gt_i32 s75, 480
  s_cbranch_scc1 L_go_6
  s_waitcnt vmcnt(2)
  s_cmp_ge_i32 s75, 0
  s_cbranch_scc1 L_go_6
  s_waitcnt vmcnt(1)
L_go_6:
  buffer_load_dwordx4 v[148:151], v1, s[12:15], s63 offen offset:0 nt
  s_memrealtime s[76:77]
  v_mov_b32 v6, 0
  ds_read_b64 v[6:7], v6 offset:680
  s_movk_i32 s79, 457
  s_waitcnt lgkmcnt(0)
  v_readfirstlane_b32 s78, v6
  v_readfirstlane_b32 s72, v7
  s_add_u32 s78, s78, 7312
  v_dot2c_f32_bf16 v80, v132, v161
  v_dot2c_f32_bf16 v81, v132, v10
  v_dot2c_f32_bf16 v82, v133, v161
  v_dot2c_f32_bf16 v83, v133, v10
  v_dot2c_f32_bf16 v84, v134, v161
  v_dot2c_f32_bf16 v85, v134, v10
  v_dot2c_f32_bf16 v86, v135, v161
  v_dot2c_f32_bf16 v87, v135, v10
  s_waitcnt lgkmcnt(0)
  s_lshl_b32 s75, s76, 4
  s_sub_u32 s75, s75, s78
  s_and_b32 s75, s75, s72
  s_add_u32 s78, s78, s79
  s_waitcnt vmcnt(3)
  s_cmp_gt_i32 s75, 480
  s_cbranch_scc1 L_go_7
  s_waitcnt vmcnt(2)
  s_cmp_ge_i32 s75, 0
  s_cbranch_scc1 L_go_7
  s_waitcnt vmcnt(1)
L_go_7:
  buffer_load_dwordx4 v[152:155], v1, s[12:15], s63 offen offset:128 nt
  s_memrealtime s[76:77]
  v_lshlrev_b32 v10, 16, v162
  v_dot2c_f32_bf16 v64, v136, v162
  v_dot2c_f32_bf16 v65, v136, v10
  v_dot2c_f32_bf16 v66, v137, v162
  v_dot2c_f32_bf16 v67, v137, v10
  v_dot2c_f32_bf16 v68, v138, v162
  v_dot2c_f32_bf16 v69, v138, v10
  v_dot2c_f32_bf16 v70, v139, v162
  v_dot2c_f32_bf16 v71, v139, v10
  s_waitcnt lgkmcnt(0)
  s_lshl_b32 s75, s76, 4
  s_sub_u32 s75, s75, s78
  s_and_b32 s75, s75, s72
  s_add_u32 s78, s78, s79
  s_waitcnt vmcnt(3)
  s_cmp_gt_i32 s75, 480
  s_cbranch_scc1 L_go_8
  s_waitcnt vmcnt(2)
  s_cmp_ge_i32 s75, 0
  s_cbranch_scc1 L_go_8
  s_waitcnt vmcnt(1)
L_go_8:
  buffer_load_dwordx4 v[156:159], v1, s[12:15], s63 offen offset:256 nt
  s_memrealtime s[76:77]
  v_dot2c_f32_bf16 v72, v140, v162
  v_dot2c_f32_bf16 v73, v140, v10
  v_dot2c_f32_bf16 v74, v141, v162
  v_dot2c_f32_bf16 v75, v141, v10
  v_dot2c_f32_bf16 v76, v142, v162
  v_dot2c_f32_bf16 v77, v142, v10
  v_dot2c_f32_bf16 v78, v143, v162
  v_dot2c_f32_bf16 v79, v143, v10
  s_waitcnt lgkmcnt(0)
  s_lshl_b32 s75, s76, 4
  s_sub_u32 s75, s75, s78
  s_and_b32 s75, s75, s72
  s_add_u32 s78, s78, s79
  s_waitcnt vmcnt(3)
  s_cmp_gt_i32 s75, 480
  s_cbranch_scc1 L_go_9
  s_waitcnt vmcnt(2)
  s_cmp_ge_i32 s75, 0
  s_cbranch_scc1 L_go_9
  s_waitcnt vmcnt(1)
L_go_9:
  buffer_load_dwordx4 v[16:19], v1, s[12:15], s64 offen offset:0 nt
  s_memrealtime s[76:77]
  v_dot2c_f32_bf16 v80, v144, v162
  v_dot2c_f32_bf16 v81, v144, v10
  v_dot2c_f32_bf16 v82, v145, v162
  v_dot2c_f32_bf16 v83, v145, v10
  v_dot2c_f32_bf16 v84, v146, v162
  v_dot2c_f32_bf16 v85, v146, v10
  v_dot2c_f32_bf16 v86, v147, v162
  v_dot2c_f32_bf16 v87, v147, v10
  s_waitcnt lgkmcnt(0)
  s_lshl_b32 s75, s76, 4
  s_sub_u32 s75, s75, s78
  s_and_b32 s75, s75, s72
  s_add_u32 s78, s78, s79
  s_waitcnt vmcnt(3)
  s_cmp_gt_i32 s75, 480
  s_cbranch_scc1 L_go_10
  s_waitcnt vmcnt(2)
  s_cmp_ge_i32 s75, 0
  s_cbranch_scc1 L_go_10
  s_waitcnt vmcnt(1)
L_go_10:
  buffer_load_dwordx4 v[20:23], v1, s[12:15], s64 offen offset:128 nt
  s_memrealtime s[76:77]
  v_lshlrev_b32 v10, 16, v163
  s_mov_b32 s70, 4000007
L_spin_11:
  ds_read_b128 v[12:15], v3 offset:512
  s_waitcnt lgkmcnt(0)
  v_cmp_eq_u32 vcc, 0, v15
  s_nop 0
  s_cbranch_vccz L_sdone_12
  s_sleep 1
  s_sub_u32 s70, s70, 1
  s_cbranch_scc0 L_spin_11
L_sdone_12:
  v_max_f32_dpp v12, v12, v12 quad_perm:[1,0,3,2] row_mask:0xf bank_mask:0xf
  v_max_f32_dpp v14, v14, v14 quad_perm:[1,0,3,2] row_mask:0xf bank_mask:0xf
  s_nop 0
  v_max_f32_dpp v12, v12, v12 quad_perm:[2,3,0,1] row_mask:0xf bank_mask:0xf
  v_max_f32_dpp v14, v14, v14 quad_perm:[2,3,0,1] row_mask:0xf bank_mask:0xf
  s_nop 0
  v_max_f32_dpp v12, v12, v12 row_half_mirror row_mask:0xf bank_mask:0xf
  v_max_f32_dpp v14, v14, v14 row_half_mirror row_mask:0xf bank_mask:0xf
  v_sub_f32 v4, v4, v12
  v_sub_f32 v5, v5, v14
  v_mul_f32 v4, s68, v4
  v_mul_f32 v5, s68, v5
  v_exp_f32 v4, v4
  v_exp_f32 v5, v5
  v_mov_b32 v2, 0
  s_mov_b32 s70, 4000007
L_spin_13:
  ds_read_b32 v13, v2 offset:648
  s_waitcnt lgkmcnt(0)
  v_cmp_gt_u32 vcc, 1, v13
  s_nop 0
  s_cbranch_vccz L_sdone_14
  s_sleep 2
  s_sub_u32 s70, s70, 1
  s_cbranch_scc0 L_spin_13
L_sdone_14:
  v_readfirstlane_b32 s46, v13
  v_min_u32 v12, 47, v0
  v_lshrrev_b32 v13, 3, v12
  v_lshlrev_b32 v13, 11, v13
  v_and_b32 v14, 1, v12
  v_lshl_add_u32 v13, v14, 10, v13
  v_bfe_u32 v14, v12, 1, 2
  v_lshl_add_u32 v13, v14, 8, v13
  v_lshlrev_b32 v12, 4, v12
  s_lshr_b32 s74, s2, 7
  s_lshl2_add_u32 s74, s4, s74
  s_mul_i32 s74, s74, 12288
  s_bfe_u32 s69, s2, 0x40003
  s_lshl4_add_u32 s74, s69, s74
  s_add_u32 s74, s74, 548864
  s_mov_b32 s22, 0x55555555
  s_mov_b32 s23, 0x55555555
  v_mov_b32 v14, s30
  v_mov_b32 v15, s31
  v_dot2c_f32_bf16 v64, v148, v163
  v_dot2c_f32_bf16 v65, v148, v10
  v_dot2c_f32_bf16 v66, v149, v163
  v_dot2c_f32_bf16 v67, v149, v10
  v_dot2c_f32_bf16 v68, v150, v163
  v_dot2c_f32_bf16 v69, v150, v10
  v_dot2c_f32_bf16 v70, v151, v163
  v_dot2c_f32_bf16 v71, v151, v10
  v_permlane32_swap_b32 v64, v68
  v_permlane32_swap_b32 v65, v69
  v_permlane32_swap_b32 v66, v70
  v_permlane32_swap_b32 v67, v71
  v_add_f32 v64, v64, v68
  v_add_f32 v65, v65, v69
  v_add_f32 v66, v66, v70
  v_add_f32 v67, v67, v71
  s_nop 0
  v_permlane16_swap_b32 v64, v66
  v_permlane16_swap_b32 v65, v67
  v_add_f32 v64, v64, v66
  v_add_f32 v65, v65, v67
  s_nop 0
  v_add_f32_dpp v64, v64, v64 row_ror:8 row_mask:0xf bank_mask:0xf
  v_add_f32_dpp v65, v65, v65 row_ror:8 row_mask:0xf bank_mask:0xf
  v_mul_f32 v64, v4, v64
  v_mul_f32 v65, v4, v65
  ds_write_b64 v8, v[64:65] offset:57856
  s_waitcnt lgkmcnt(0)
  s_lshl_b32 s75, s76, 4
  s_sub_u32 s75, s75, s78
  s_and_b32 s75, s75, s72
  s_add_u32 s78, s78, s79
  s_waitcnt vmcnt(3)
  s_cmp_gt_i32 s75, 480
  s_cbranch_scc1 L_go_15
  s_waitcnt vmcnt(2)
  s_cmp_ge_i32 s75, 0
  s_cbranch_scc1 L_go_15
  s_waitcnt vmcnt(1)
L_go_15:
  buffer_load_dwordx4 v[24:27], v1, s[12:15], s64 offen offset:256 nt
  s_memrealtime s[76:77]
  v_dot2c_f32_bf16 v72, v152, v163
  v_dot2c_f32_bf16 v73, v152, v10
  v_dot2c_f32_bf16 v74, v153, v163
  v_dot2c_f32_bf16 v75, v153, v10
  v_dot2c_f32_bf16 v76, v154, v163
  v_dot2c_f32_bf16 v77, v154, v10
  v_dot2c_f32_bf16 v78, v155, v163
  v_dot2c_f32_bf16 v79, v155, v10
  v_permlane32_swap_b32 v72, v76
  v_permlane32_swap_b32 v73, v77
  v_permlane32_swap_b32 v74, v78
  v_permlane32_swap_b32 v75, v79
  v_add_f32 v72, v72, v76
  v_add_f32 v73, v73, v77
  v_add_f32 v74, v74, v78
  v_add_f32 v75, v75, v79
  s_nop 0
  v_permlane16_swap_b32 v72, v74
  v_permlane16_swap_b32 v73, v75
  v_add_f32 v72, v72, v74
  v_add_f32 v73, v73, v75
  s_nop 0
  v_add_f32_dpp v72, v72, v72 row_ror:8 row_mask:0xf bank_mask:0xf
  v_add_f32_dpp v73, v73, v73 row_ror:8 row_mask:0xf bank_mask:0xf
  v_mul_f32 v72, v4, v72
  v_mul_f32 v73, v4, v73
  ds_write_b64 v8, v[72:73] offset:58112
  s_waitcnt lgkmcnt(0)
  s_lshl_b32 s75, s76, 4
  s_sub_u32 s75, s75, s78
  s_and_b32 s75, s75, s72
  s_add_u32 s78, s78, s79
  s_waitcnt vmcnt(3)
  s_cmp_gt_i32 s75, 480
  s_cbranch_scc1 L_go_16
  s_waitcnt vmcnt(2)
  s_cmp_ge_i32 s75, 0
  s_cbranch_scc1 L_go_16
  s_waitcnt vmcnt(1)
L_go_16:
  buffer_load_dwordx4 v[28:31], v1, s[12:15], s65 offen offset:0 nt
  s_memrealtime s[76:77]
  v_dot2c_f32_bf16 v80, v156, v163
  v_dot2c_f32_bf16 v81, v156, v10
  v_dot2c_f32_bf16 v82, v157, v163
  v_dot2c_f32_bf16 v83, v157, v10
  v_dot2c_f32_bf16 v84, v158, v163
  v_dot2c_f32_bf16 v85, v158, v10
  v_dot2c_f32_bf16 v86, v159, v163
  v_dot2c_f32_bf16 v87, v159, v10
  v_permlane32_swap_b32 v80, v84
  v_permlane32_swap_b32 v81, v85
  v_permlane32_swap_b32 v82, v86
  v_permlane32_swap_b32 v83, v87
  v_add_f32 v80, v80, v84
  v_add_f32 v81, v81, v85
  v_add_f32 v82, v82, v86
  v_add_f32 v83, v83, v87
  s_nop 0
  v_permlane16_swap_b32 v80, v82
  v_permlane16_swap_b32 v81, v83
  v_add_f32 v80, v80, v82
  v_add_f32 v81, v81, v83
  s_nop 0
  v_add_f32_dpp v80, v80, v80 row_ror:8 row_mask:0xf bank_mask:0xf
  v_add_f32_dpp v81, v81, v81 row_ror:8 row_mask:0xf bank_mask:0xf
  v_mul_f32 v80, v4, v80
  v_mul_f32 v81, v4, v81
  ds_write_b64 v8, v[80:81] offset:58368
  s_mov_b64 exec, 1
  ds_add_u32 v2, v11 offset:652
  s_mov_b64 exec, -1
  s_waitcnt lgkmcnt(0)
  s_lshl_b32 s75, s76, 4
  s_sub_u32 s75, s75, s78
  s_and_b32 s75, s75, s72
  s_add_u32 s78, s78, s79
  s_waitcnt vmcnt(3)
  s_cmp_gt_i32 s75, 480
  s_cbranch_scc1 L_go_17
  s_waitcnt vmcnt(2)
  s_cmp_ge_i32 s75, 0
  s_cbranch_scc1 L_go_17
  s_waitcnt vmcnt(1)
L_go_17:
  buffer_load_dwordx4 v[32:35], v1, s[12:15], s65 offen offset:128 nt
  s_memrealtime s[76:77]
  v_lshlrev_b32 v10, 16, v164
  v_dot2c_f32_bf16 v88, v16, v164
  v_dot2c_f32_bf16 v89, v16, v10
  v_dot2c_f32_bf16 v90, v17, v164
  v_dot2c_f32_bf16 v91, v17, v10
  v_dot2c_f32_bf16 v92, v18, v164
  v_dot2c_f32_bf16 v93, v18, v10
  v_dot2c_f32_bf16 v94, v19, v164
  v_dot2c_f32_bf16 v95, v19, v10
  s_waitcnt lgkmcnt(0)
  s_lshl_b32 s75, s76, 4
  s_sub_u32 s75, s75, s78
  s_and_b32 s75, s75, s72
  s_add_u32 s78, s78, s79
  s_waitcnt vmcnt(3)
  s_cmp_gt_i32 s75, 480
  s_cbranch_scc1 L_go_18
  s_waitcnt vmcnt(2)
  s_cmp_ge_i32 s75, 0
  s_cbranch_scc1 L_go_18
  s_waitcnt vmcnt(1)
L_go_18:
  buffer_load_dwordx4 v[36:39], v1, s[12:15], s65 offen offset:256 nt
  s_memrealtime s[76:77]
  v_dot2c_f32_bf16 v96, v20, v164
  v_dot2c_f32_bf16 v97, v20, v10
  v_dot2c_f32_bf16 v98, v21, v164
  v_dot2c_f32_bf16 v99, v21, v10
  v_dot2c_f32_bf16 v100, v22, v164
  v_dot2c_f32_bf16 v101, v22, v10
  v_dot2c_f32_bf16 v102, v23, v164
  v_dot2c_f32_bf16 v103, v23, v10
  s_waitcnt lgkmcnt(0)
  s_lshl_b32 s75, s76, 4
  s_sub_u32 s75, s75, s78
  s_and_b32 s75, s75, s72
  s_add_u32 s78, s78, s79
  s_waitcnt vmcnt(3)
  s_cmp_gt_i32 s75, 480
  s_cbranch_scc1 L_go_19
  s_waitcnt vmcnt(2)
  s_cmp_ge_i32 s75, 0
  s_cbranch_scc1 L_go_19
  s_waitcnt vmcnt(1)
L_go_19:
  buffer_load_dwordx4 v[40:43], v1, s[12:15], s66 offen offset:0 nt
  s_memrealtime s[76:77]
  v_dot2c_f32_bf16 v104, v24, v164
  v_dot2c_f32_bf16 v105, v24, v10
  v_dot2c_f32_bf16 v106, v25, v164
  v_dot2c_f32_bf16 v107, v25, v10
  v_dot2c_f32_bf16 v108, v26, v164
  v_dot2c_f32_bf16 v109, v26, v10
  v_dot2c_f32_bf16 v110, v27, v164
  v_dot2c_f32_bf16 v111, v27, v10
  s_waitcnt lgkmcnt(0)
  s_lshl_b32 s75, s76, 4
  s_sub_u32 s75, s75, s78
  s_and_b32 s75, s75, s72
  s_add_u32 s78, s78, s79
  s_waitcnt vmcnt(3)
  s_cmp_gt_i32 s75, 480
  s_cbranch_scc1 L_go_20
  s_waitcnt vmcnt(2)
  s_cmp_ge_i32 s75, 0
  s_cbranch_scc1 L_go_20
  s_waitcnt vmcnt(1)
L_go_20:
  buffer_load_dwordx4 v[44:47], v1, s[12:15], s66 offen offset:128 nt
  s_memrealtime s[76:77]
  v_lshlrev_b32 v10, 16, v165
  v_dot2c_f32_bf16 v88, v28, v165
  v_dot2c_f32_bf16 v89, v28, v10
  v_dot2c_f32_bf16 v90, v29, v165
  v_dot2c_f32_bf16 v91, v29, v10
  v_dot2c_f32_bf16 v92, v30, v165
  v_dot2c_f32_bf16 v93, v30, v10
  v_dot2c_f32_bf16 v94, v31, v165
  v_dot2c_f32_bf16 v95, v31, v10
  s_waitcnt lgkmcnt(0)
  s_lshl_b32 s75, s76, 4
  s_sub_u32 s75, s75, s78
  s_and_b32 s75, s75, s72
  s_add_u32 s78, s78, s79
  s_waitcnt vmcnt(3)
  s_cmp_gt_i32 s75, 480
  s_cbranch_scc1 L_go_21
  s_waitcnt vmcnt(2)
  s_cmp_ge_i32 s75, 0
  s_cbranch_scc1 L_go_21
  s_waitcnt vmcnt(1)
L_go_21:
  buffer_load_dwordx4 v[48:51], v1, s[12:15], s66 offen offset:256 nt
  s_memrealtime s[76:77]
  v_dot2c_f32_bf16 v96, v32, v165
  v_dot2c_f32_bf16 v97, v32, v10
  v_dot2c_f32_bf16 v98, v33, v165
  v_dot2c_f32_bf16 v99, v33, v10
  v_dot2c_f32_bf16 v100, v34, v165
  v_dot2c_f32_bf16 v101, v34, v10
  v_dot2c_f32_bf16 v102, v35, v165
  v_dot2c_f32_bf16 v103, v35, v10
  s_waitcnt lgkmcnt(0)
  s_lshl_b32 s75, s76, 4
  s_sub_u32 s75, s75, s78
  s_and_b32 s75, s75, s72
  s_add_u32 s78, s78, s79
  s_waitcnt vmcnt(3)
  s_cmp_gt_i32 s75, 480
  s_cbranch_scc1 L_go_22
  s_waitcnt vmcnt(2)
  s_cmp_ge_i32 s75, 0
  s_cbranch_scc1 L_go_22
  s_waitcnt vmcnt(1)
L_go_22:
  buffer_load_dwordx4 v[52:55], v1, s[12:15], s67 offen offset:0 nt
  s_memrealtime s[76:77]
  s_mov_b64 exec, 1
  ds_add_u32 v2, v11 offset:644
  s_mov_b64 exec, -1
  v_dot2c_f32_bf16 v104, v36, v165
  v_dot2c_f32_bf16 v105, v36, v10
  v_dot2c_f32_bf16 v106, v37, v165
  v_dot2c_f32_bf16 v107, v37, v10
  v_dot2c_f32_bf16 v108, v38, v165
  v_dot2c_f32_bf16 v109, v38, v10
  v_dot2c_f32_bf16 v110, v39, v165
  v_dot2c_f32_bf16 v111, v39, v10
  s_waitcnt lgkmcnt(0)
  s_lshl_b32 s75, s76, 4
  s_sub_u32 s75, s75, s78
  s_and_b32 s75, s75, s72
  s_add_u32 s78, s78, s79
  s_waitcnt vmcnt(3)
  s_cmp_gt_i32 s75, 480
  s_cbranch_scc1 L_go_23
  s_waitcnt vmcnt(2)
  s_cmp_ge_i32 s75, 0
  s_cbranch_scc1 L_go_23
  s_waitcnt vmcnt(1)
L_go_23:
  buffer_load_dwordx4 v[56:59], v1, s[12:15], s67 offen offset:128 nt
  s_memrealtime s[76:77]
  v_lshlrev_b32 v10, 16, v166
  v_dot2c_f32_bf16 v88, v40, v166
  v_dot2c_f32_bf16 v89, v40, v10
  v_dot2c_f32_bf16 v90, v41, v166
  v_dot2c_f32_bf16 v91, v41, v10
  v_dot2c_f32_bf16 v92, v42, v166
  v_dot2c_f32_bf16 v93, v42, v10
  v_dot2c_f32_bf16 v94, v43, v166
  v_dot2c_f32_bf16 v95, v43, v10
  s_waitcnt lgkmcnt(0)
  s_lshl_b32 s75, s76, 4
  s_sub_u32 s75, s75, s78
  s_and_b32 s75, s75, s72
  s_add_u32 s78, s78, s79
  s_waitcnt vmcnt(3)
  s_cmp_gt_i32 s75, 480
  s_cbranch_scc1 L_go_24
  s_waitcnt vmcnt(2)
  s_cmp_ge_i32 s75, 0
  s_cbranch_scc1 L_go_24
  s_waitcnt vmcnt(1)
L_go_24:
  buffer_load_dwordx4 v[60:63], v1, s[12:15], s67 offen offset:256 nt
  v_dot2c_f32_bf16 v96, v44, v166
  v_dot2c_f32_bf16 v97, v44, v10
  v_dot2c_f32_bf16 v98, v45, v166
  v_dot2c_f32_bf16 v99, v45, v10
  v_dot2c_f32_bf16 v100, v46, v166
  v_dot2c_f32_bf16 v101, v46, v10
  v_dot2c_f32_bf16 v102, v47, v166
  v_dot2c_f32_bf16 v103, v47, v10
  s_waitcnt vmcnt(3)
  v_dot2c_f32_bf16 v104, v48, v166
  v_dot2c_f32_bf16 v105, v48, v10
  v_dot2c_f32_bf16 v106, v49, v166
  v_dot2c_f32_bf16 v107, v49, v10
  v_dot2c_f32_bf16 v108, v50, v166
  v_dot2c_f32_bf16 v109, v50, v10
  v_dot2c_f32_bf16 v110, v51, v166
  v_dot2c_f32_bf16 v111, v51, v10
  s_waitcnt vmcnt(2)
  v_lshlrev_b32 v10, 16, v167
  v_dot2c_f32_bf16 v88, v52, v167
  v_dot2c_f32_bf16 v89, v52, v10
  v_dot2c_f32_bf16 v90, v53, v167
  v_dot2c_f32_bf16 v91, v53, v10
  v_dot2c_f32_bf16 v92, v54, v167
  v_dot2c_f32_bf16 v93, v54, v10
  v_dot2c_f32_bf16 v94, v55, v167
  v_dot2c_f32_bf16 v95, v55, v10
  v_permlane32_swap_b32 v88, v92
  v_permlane32_swap_b32 v89, v93
  v_permlane32_swap_b32 v90, v94
  v_permlane32_swap_b32 v91, v95
  v_add_f32 v88, v88, v92
  v_add_f32 v89, v89, v93
  v_add_f32 v90, v90, v94
  v_add_f32 v91, v91, v95
  s_nop 0
  v_permlane16_swap_b32 v88, v90
  v_permlane16_swap_b32 v89, v91
  v_add_f32 v88, v88, v90
  v_add_f32 v89, v89, v91
  s_nop 0
  v_add_f32_dpp v88, v88, v88 row_ror:8 row_mask:0xf bank_mask:0xf
  v_add_f32_dpp v89, v89, v89 row_ror:8 row_mask:0xf bank_mask:0xf
  v_mul_f32 v88, v5, v88
  v_mul_f32 v89, v5, v89
  ds_write_b64 v8, v[88:89] offset:1024
  s_waitcnt vmcnt(1)
  v_dot2c_f32_bf16 v96, v56, v167
  v_dot2c_f32_bf16 v97, v56, v10
  v_dot2c_f32_bf16 v98, v57, v167
  v_dot2c_f32_bf16 v99, v57, v10
  v_dot2c_f32_bf16 v100, v58, v167
  v_dot2c_f32_bf16 v101, v58, v10
  v_dot2c_f32_bf16 v102, v59, v167
  v_dot2c_f32_bf16 v103, v59, v10
  v_permlane32_swap_b32 v96, v100
  v_permlane32_swap_b32 v97, v101
  v_permlane32_swap_b32 v98, v102
  v_permlane32_swap_b32 v99, v103
  v_add_f32 v96, v96, v100
  v_add_f32 v97, v97, v101
  v_add_f32 v98, v98, v102
  v_add_f32 v99, v99, v103
  s_nop 0
  v_permlane16_swap_b32 v96, v98
  v_permlane16_swap_b32 v97, v99
  v_add_f32 v96, v96, v98
  v_add_f32 v97, v97, v99
  s_nop 0
  v_add_f32_dpp v96, v96, v96 row_ror:8 row_mask:0xf bank_mask:0xf
  v_add_f32_dpp v97, v97, v97 row_ror:8 row_mask:0xf bank_mask:0xf
  v_mul_f32 v96, v5, v96
  v_mul_f32 v97, v5, v97
  ds_write_b64 v8, v[96:97] offset:1280
  s_waitcnt vmcnt(0)
  v_dot2c_f32_bf16 v104, v60, v167
  v_dot2c_f32_bf16 v105, v60, v10
  v_dot2c_f32_bf16 v106, v61, v167
  v_dot2c_f32_bf16 v107, v61, v10
  v_dot2c_f32_bf16 v108, v62, v167
  v_dot2c_f32_bf16 v109, v62, v10
  v_dot2c_f32_bf16 v110, v63, v167
  v_dot2c_f32_bf16 v111, v63, v10
  v_permlane32_swap_b32 v104, v108
  v_permlane32_swap_b32 v105, v109
  v_permlane32_swap_b32 v106, v110
  v_permlane32_swap_b32 v107, v111
  v_add_f32 v104, v104, v108
  v_add_f32 v105, v105, v109
  v_add_f32 v106, v106, v110
  v_add_f32 v107, v107, v111
  s_nop 0
  v_permlane16_swap_b32 v104, v106
  v_permlane16_swap_b32 v105, v107
  v_add_f32 v104, v104, v106
  v_add_f32 v105, v105, v107
  s_nop 0
  v_add_f32_dpp v104, v104, v104 row_ror:8 row_mask:0xf bank_mask:0xf
  v_add_f32_dpp v105, v105, v105 row_ror:8 row_mask:0xf bank_mask:0xf
  v_mul_f32 v104, v5, v104
  v_mul_f32 v105, v5, v105
  ds_write_b64 v8, v[104:105] offset:1536
  s_mov_b64 exec, 1
  ds_add_rtn_u32 v10, v2, v11 offset:640
  s_mov_b64 exec, -1
  ds_read_b128 v[16:19], v12 offset:1024
  ds_read_b128 v[20:23], v12 offset:1792
  ds_read_b128 v[24:27], v12 offset:2560
  ds_read_b128 v[28:31], v12 offset:3328
  ds_read_b128 v[32:35], v12 offset:4096
  ds_read_b128 v[36:39], v12 offset:4864
  ds_read_b128 v[40:43], v12 offset:5632
  ds_read_b128 v[44:47], v12 offset:6400
  s_waitcnt lgkmcnt(8)
  v_readfirstlane_b32 s68, v10
  s_nop 0
  s_cmp_lg_u32 s68, 7
  s_cbranch_scc1 L_nopub
  s_waitcnt lgkmcnt(6)
  v_pk_add_f32 v[16:17], v[16:17], v[20:21]
  v_pk_add_f32 v[18:19], v[18:19], v[22:23]
  s_waitcnt lgkmcnt(4)
  v_pk_add_f32 v[24:25], v[24:25], v[28:29]
  v_pk_add_f32 v[26:27], v[26:27], v[30:31]
  v_pk_add_f32 v[16:17], v[16:17], v[24:25]
  v_pk_add_f32 v[18:19], v[18:19], v[26:27]
  s_waitcnt lgkmcnt(2)
  v_pk_add_f32 v[32:33], v[32:33], v[36:37]
  v_pk_add_f32 v[34:35], v[34:35], v[38:39]
  s_waitcnt lgkmcnt(0)
  v_pk_add_f32 v[40:41], v[40:41], v[44:45]
  v_pk_add_f32 v[42:43], v[42:43], v[46:47]
  v_pk_add_f32 v[32:33], v[32:33], v[40:41]
  v_pk_add_f32 v[34:35], v[34:35], v[42:43]
  v_pk_add_f32 v[4:5], v[16:17], v[32:33]
  v_pk_add_f32 v[6:7], v[18:19], v[34:35]
  v_cvt_pk_bf16_f32 v8, v4, v5
  v_cvt_pk_bf16_f32 v9, v6, v7
  v_cndmask_b32 v4, v8, v14, s[22:23]
  v_cndmask_b32 v5, v9, v15, s[22:23]
  v_cndmask_b32 v6, v14, v8, s[22:23]
  v_cndmask_b32 v7, v15, v9, s[22:23]
  s_mov_b32 exec_lo, 0xffffffff
  s_mov_b32 exec_hi, 0xffff
  buffer_store_dwordx4 v[4:7], v13, s[32:35], s74 offen
  s_mov_b64 exec, -1
  s_cmp_lg_u32 s46, 1
  s_cbranch_scc1 L_slow_25
L_back_26:
  ds_write_b32 v2, v11 offset:668
L_nopub:
  s_waitcnt lgkmcnt(0)
  s_cmp_lt_u32 s5, 20
  s_cbranch_scc1 L_notf1
  s_cmp_lt_u32 s5, 30
  s_cbranch_scc1 L_f1
  s_branch L_stream_exit
L_notf1:
  s_cmp_gt_u32 s5, 11
  s_cbranch_scc1 L_stream_exit
  s_cmp_gt_u32 s3, 6
  s_cbranch_scc1 L_f2
  s_branch L_dry
L_stream_exit:
  s_endpgm
L_helper:
  s_setprio 3
  v_lshlrev_b32 v1, 2, v0
  v_lshrrev_b32 v2, 3, v0
  s_mul_i32 s68, s7, 80
  v_add_u32 v3, s68, v2
  v_lshlrev_b32 v3, 1, v3
  v_mul_u32_u24 v2, 12288, v2
  v_and_b32 v7, 7, v0
  v_lshl_add_u32 v2, v7, 4, v2
  s_mul_i32 s68, s68, 12288
  s_mul_i32 s69, s6, 384
  s_add_u32 s68, s68, s69
  s_lshl_b32 s69, s3, 7
  s_add_u32 s68, s68, s69
  s_waitcnt lgkmcnt(0)
  s_load_dword s12, s[36:37], 0
  s_load_dword s13, s[36:37], 128
  s_load_dword s14, s[36:37], 256
  s_load_dword s15, s[36:37], 384
  s_load_dword s16, s[36:37], 512
  s_load_dword s17, s[36:37], 640
  s_load_dword s18, s[36:37], 768
  s_load_dword s19, s[36:37], 896
  s_load_dword s20, s[36:37], 1024
  s_load_dword s21, s[36:37], 1152
  s_barrier
  s_mov_b32 s8, s42
  s_mov_b32 s9, s43
  s_mov_b32 s10, 7864320
  s_mov_b32 s11, 0x20000
  s_waitcnt lgkmcnt(0)
  global_load_dword v64, v1, s[36:37] offset:0
  global_load_dword v65, v1, s[36:37] offset:256
  global_load_dword v66, v1, s[36:37] offset:512
  global_load_dword v67, v1, s[36:37] offset:768
  global_load_dword v68, v1, s[36:37] offset:1024
  global_load_ushort v8, v3, s[36:37] offset:0
  global_load_ushort v9, v3, s[36:37] offset:16
  global_load_ushort v10, v3, s[36:37] offset:32
  global_load_ushort v11, v3, s[36:37] offset:48
  global_load_ushort v12, v3, s[36:37] offset:64
  global_load_ushort v13, v3, s[36:37] offset:80
  global_load_ushort v14, v3, s[36:37] offset:96
  global_load_ushort v15, v3, s[36:37] offset:112
  global_load_ushort v16, v3, s[36:37] offset:128
  global_load_ushort v17, v3, s[36:37] offset:144
  s_load_dwordx2 s[28:29], s[58:59], 917504
  s_mov_b32 s69, 0xffff0000
  s_mov_b32 s24, s58
  s_mov_b32 s25, s59
  s_mov_b32 s26, 4194304
  s_mov_b32 s27, 0x20000
  s_add_u32 s32, s58, 4194304
  s_addc_u32 s33, s59, 0
  s_mov_b32 s34, 4194304
  s_mov_b32 s35, 0x20000
  s_lshl3_add_u32 s71, s6, s7
  s_mul_i32 s5, s79, 5
  s_mul_i32 s47, s79, 3
  s_add_u32 s47, s47, 15
  s_cmp_lt_u32 s7, 5
  s_cselect_b32 s5, s5, s47
  s_add_u32 s5, s5, s7
  s_waitcnt lgkmcnt(0)
  s_mul_i32 s30, s28, 0x2c9277b5
  s_add_u32 s30, s30, 0xac564b05
  s_mul_i32 s31, s29, 0x0019660d
  s_add_u32 s31, s31, 0x3c6ef35f
  s_waitcnt vmcnt(10)
  v_lshlrev_b32 v70, 16, v64
  v_and_b32 v71, s69, v64
  v_lshlrev_b32 v72, 16, v65
  v_and_b32 v73, s69, v65
  v_lshlrev_b32 v74, 16, v66
  v_and_b32 v75, s69, v66
  v_lshlrev_b32 v76, 16, v67
  v_and_b32 v77, s69, v67
  v_lshlrev_b32 v78, 16, v68
  v_and_b32 v79, s69, v68
  v_add_f32 v4, v70, v71
  v_add_f32 v5, v72, v73
  v_add_f32 v6, v74, v75
  v_add_f32 v7, v76, v77
  v_add_f32 v4, v4, v5
  v_add_f32 v6, v6, v7
  v_add_f32 v5, v78, v79
  v_add_f32 v4, v4, v6
  v_add_f32 v4, v4, v5
  s_nop 1
  v_add_f32_dpp v4, v4, v4 quad_perm:[1,0,3,2] row_mask:0xf bank_mask:0xf
  s_nop 1
  v_add_f32_dpp v4, v4, v4 quad_perm:[2,3,0,1] row_mask:0xf bank_mask:0xf
  s_nop 1
  v_add_f32_dpp v4, v4, v4 row_half_mirror row_mask:0xf bank_mask:0xf
  s_nop 1
  v_add_f32_dpp v4, v4, v4 row_mirror row_mask:0xf bank_mask:0xf
  v_mov_b32 v5, v4
  s_nop 1
  v_permlane16_swap_b32 v4, v5
  v_add_f32 v4, v4, v5
  v_mov_b32 v5, v4
  s_nop 1
  v_permlane32_swap_b32 v4, v5
  v_add_f32 v4, v4, v5
  v_mul_f32 v4, 0x3acccccd, v4
  v_sub_f32 v70, v70, v4
  v_sub_f32 v71, v71, v4
  v_sub_f32 v72, v72, v4
  v_sub_f32 v73, v73, v4
  v_sub_f32 v74, v74, v4
  v_sub_f32 v75, v75, v4
  v_sub_f32 v76, v76, v4
  v_sub_f32 v77, v77, v4
  v_sub_f32 v78, v78, v4
  v_sub_f32 v79, v79, v4
  v_mul_f32 v5, v70, v70
  v_fmac_f32 v5, v71, v71
  v_fmac_f32 v5, v72, v72
  v_fmac_f32 v5, v73, v73
  v_fmac_f32 v5, v74, v74
  v_fmac_f32 v5, v75, v75
  v_fmac_f32 v5, v76, v76
  v_fmac_f32 v5, v77, v77
  v_fmac_f32 v5, v78, v78
  v_fmac_f32 v5, v79, v79
  s_nop 1
  v_add_f32_dpp v5, v5, v5 quad_perm:[1,0,3,2] row_mask:0xf bank_mask:0xf
  s_nop 1
  v_add_f32_dpp v5, v5, v5 quad_perm:[2,3,0,1] row_mask:0xf bank_mask:0xf
  s_nop 1
  v_add_f32_dpp v5, v5, v5 row_half_mirror row_mask:0xf bank_mask:0xf
  s_nop 1
  v_add_f32_dpp v5, v5, v5 row_mirror row_mask:0xf bank_mask:0xf
  v_mov_b32 v6, v5
  s_nop 1
  v_permlane16_swap_b32 v5, v6
  v_add_f32 v5, v5, v6
  v_mov_b32 v6, v5
  s_nop 1
  v_permlane32_swap_b32 v5, v6
  v_add_f32 v5, v5, v6
  v_mul_f32 v5, 0x3acccccd, v5
  v_cvt_pk_bf16_f32 v4, v4, v4
  v_lshlrev_b32 v4, 16, v4
  v_cvt_pk_bf16_f32 v5, v5, v5
  v_lshlrev_b32 v5, 16, v5
  v_add_f32 v5, 0x3727c5ac, v5
  v_cvt_pk_bf16_f32 v5, v5, v5
  v_lshlrev_b32 v5, 16, v5
  v_sqrt_f32 v5, v5
  s_nop 0
  v_cvt_pk_bf16_f32 v5, v5, v5
  v_lshlrev_b32 v5, 16, v5
  v_rcp_f32 v5, v5
  v_mov_b32 v6, 0
  s_waitcnt vmcnt(0)
  v_lshlrev_b32 v8, 16, v8
  v_lshlrev_b32 v9, 16, v9
  v_lshlrev_b32 v10, 16, v10
  v_lshlrev_b32 v11, 16, v11
  v_lshlrev_b32 v12, 16, v12
  v_lshlrev_b32 v13, 16, v13
  v_lshlrev_b32 v14, 16, v14
  v_lshlrev_b32 v15, 16, v15
  v_lshlrev_b32 v16, 16, v16
  v_lshlrev_b32 v17, 16, v17
  v_sub_f32 v8, v8, v4
  v_sub_f32 v9, v9, v4
  v_sub_f32 v10, v10, v4
  v_sub_f32 v11, v11, v4
  v_sub_f32 v12, v12, v4
  v_sub_f32 v13, v13, v4
  v_sub_f32 v14, v14, v4
  v_sub_f32 v15, v15, v4
  v_sub_f32 v16, v16, v4
  v_sub_f32 v17, v17, v4
  v_cvt_pk_bf16_f32 v8, v6, v8
  v_cvt_pk_bf16_f32 v9, v6, v9
  v_cvt_pk_bf16_f32 v10, v6, v10
  v_cvt_pk_bf16_f32 v11, v6, v11
  v_cvt_pk_bf16_f32 v12, v6, v12
  v_cvt_pk_bf16_f32 v13, v6, v13
  v_cvt_pk_bf16_f32 v14, v6, v14
  v_cvt_pk_bf16_f32 v15, v6, v15
  v_cvt_pk_bf16_f32 v16, v6, v16
  v_cvt_pk_bf16_f32 v17, v6, v17
  v_mul_f32 v8, v8, v5
  v_mul_f32 v9, v9, v5
  v_mul_f32 v10, v10, v5
  v_mul_f32 v11, v11, v5
  v_mul_f32 v12, v12, v5
  v_mul_f32 v13, v13, v5
  v_mul_f32 v14, v14, v5
  v_mul_f32 v15, v15, v5
  v_mul_f32 v16, v16, v5
  v_mul_f32 v17, v17, v5
  v_cvt_pk_bf16_f32 v70, v6, v8
  v_cvt_pk_bf16_f32 v8, v8, v6
  v_cvt_pk_bf16_f32 v71, v6, v9
  v_cvt_pk_bf16_f32 v9, v9, v6
  v_cvt_pk_bf16_f32 v72, v6, v10
  v_cvt_pk_bf16_f32 v10, v10, v6
  v_cvt_pk_bf16_f32 v73, v6, v11
  v_cvt_pk_bf16_f32 v11, v11, v6
  v_cvt_pk_bf16_f32 v74, v6, v12
  v_cvt_pk_bf16_f32 v12, v12, v6
  v_cvt_pk_bf16_f32 v75, v6, v13
  v_cvt_pk_bf16_f32 v13, v13, v6
  v_cvt_pk_bf16_f32 v76, v6, v14
  v_cvt_pk_bf16_f32 v14, v14, v6
  v_cvt_pk_bf16_f32 v77, v6, v15
  v_cvt_pk_bf16_f32 v15, v15, v6
  v_cvt_pk_bf16_f32 v78, v6, v16
  v_cvt_pk_bf16_f32 v16, v16, v6
  v_cvt_pk_bf16_f32 v79, v6, v17
  v_cvt_pk_bf16_f32 v17, v17, v6
  v_mov_b32 v80, 0
  v_mov_b32 v81, 0
  v_mov_b32 v82, 0
  v_mov_b32 v83, 0
  v_mov_b32 v84, 0
  v_mov_b32 v85, 0
  v_mov_b32 v86, 0
  v_mov_b32 v87, 0
  v_and_b32 v90, 7, v0
  v_lshrrev_b32 v6, 4, v0
  v_lshl_add_u32 v90, v90, 2, v6
  v_lshlrev_b32 v90, 4, v90
  s_lshl_b32 s64, s71, 11
  s_lshl_b32 s69, s3, 9
  s_add_u32 s64, s64, s69
  s_waitcnt vmcnt(9)
  v_dot2c_f32_bf16 v80, v24, v8
  v_dot2c_f32_bf16 v81, v24, v70
  v_dot2c_f32_bf16 v82, v25, v8
  v_dot2c_f32_bf16 v83, v25, v70
  v_dot2c_f32_bf16 v84, v26, v8
  v_dot2c_f32_bf16 v85, v26, v70
  v_dot2c_f32_bf16 v86, v27, v8
  v_dot2c_f32_bf16 v87, v27, v70
  s_waitcnt vmcnt(8)
  v_dot2c_f32_bf16 v80, v28, v9
  v_dot2c_f32_bf16 v81, v28, v71
  v_dot2c_f32_bf16 v82, v29, v9
  v_dot2c_f32_bf16 v83, v29, v71
  v_dot2c_f32_bf16 v84, v30, v9
  v_dot2c_f32_bf16 v85, v30, v71
  v_dot2c_f32_bf16 v86, v31, v9
  v_dot2c_f32_bf16 v87, v31, v71
  s_waitcnt vmcnt(7)
  v_dot2c_f32_bf16 v80, v32, v10
  v_dot2c_f32_bf16 v81, v32, v72
  v_dot2c_f32_bf16 v82, v33, v10
  v_dot2c_f32_bf16 v83, v33, v72
  v_dot2c_f32_bf16 v84, v34, v10
  v_dot2c_f32_bf16 v85, v34, v72
  v_dot2c_f32_bf16 v86, v35, v10
  v_dot2c_f32_bf16 v87, v35, v72
  s_waitcnt vmcnt(6)
  v_dot2c_f32_bf16 v80, v36, v11
  v_dot2c_f32_bf16 v81, v36, v73
  v_dot2c_f32_bf16 v82, v37, v11
  v_dot2c_f32_bf16 v83, v37, v73
  v_dot2c_f32_bf16 v84, v38, v11
  v_dot2c_f32_bf16 v85, v38, v73
  v_dot2c_f32_bf16 v86, v39, v11
  v_dot2c_f32_bf16 v87, v39, v73
  s_waitcnt vmcnt(5)
  v_dot2c_f32_bf16 v80, v40, v12
  v_dot2c_f32_bf16 v81, v40, v74
  v_dot2c_f32_bf16 v82, v41, v12
  v_dot2c_f32_bf16 v83, v41, v74
  v_dot2c_f32_bf16 v84, v42, v12
  v_dot2c_f32_bf16 v85, v42, v74
  v_dot2c_f32_bf16 v86, v43, v12
  v_dot2c_f32_bf16 v87, v43, v74
  s_waitcnt vmcnt(4)
  v_dot2c_f32_bf16 v80, v44, v13
  v_dot2c_f32_bf16 v81, v44, v75
  v_dot2c_f32_bf16 v82, v45, v13
  v_dot2c_f32_bf16 v83, v45, v75
  v_dot2c_f32_bf16 v84, v46, v13
  v_dot2c_f32_bf16 v85, v46, v75
  v_dot2c_f32_bf16 v86, v47, v13
  v_dot2c_f32_bf16 v87, v47, v75
  s_waitcnt vmcnt(3)
  v_dot2c_f32_bf16 v80, v48, v14
  v_dot2c_f32_bf16 v81, v48, v76
  v_dot2c_f32_bf16 v82, v49, v14
  v_dot2c_f32_bf16 v83, v49, v76
  v_dot2c_f32_bf16 v84, v50, v14
  v_dot2c_f32_bf16 v85, v50, v76
  v_dot2c_f32_bf16 v86, v51, v14
  v_dot2c_f32_bf16 v87, v51, v76
  s_waitcnt vmcnt(2)
  v_dot2c_f32_bf16 v80, v52, v15
  v_dot2c_f32_bf16 v81, v52, v77
  v_dot2c_f32_bf16 v82, v53, v15
  v_dot2c_f32_bf16 v83, v53, v77
  v_dot2c_f32_bf16 v84, v54, v15
  v_dot2c_f32_bf16 v85, v54, v77
  v_dot2c_f32_bf16 v86, v55, v15
  v_dot2c_f32_bf16 v87, v55, v77
  s_waitcnt vmcnt(1)
  v_dot2c_f32_bf16 v80, v56, v16
  v_dot2c_f32_bf16 v81, v56, v78
  v_dot2c_f32_bf16 v82, v57, v16
  v_dot2c_f32_bf16 v83, v57, v78
  v_dot2c_f32_bf16 v84, v58, v16
  v_dot2c_f32_bf16 v85, v58, v78
  v_dot2c_f32_bf16 v86, v59, v16
  v_dot2c_f32_bf16 v87, v59, v78
  s_waitcnt vmcnt(0)
  v_dot2c_f32_bf16 v80, v60, v17
  v_dot2c_f32_bf16 v81, v60, v79
  v_dot2c_f32_bf16 v82, v61, v17
  v_dot2c_f32_bf16 v83, v61, v79
  v_dot2c_f32_bf16 v84, v62, v17
  v_dot2c_f32_bf16 v85, v62, v79
  v_dot2c_f32_bf16 v86, v63, v17
  v_dot2c_f32_bf16 v87, v63, v79
  v_permlane32_swap_b32 v80, v84
  v_permlane32_swap_b32 v81, v85
  v_permlane32_swap_b32 v82, v86
  v_permlane32_swap_b32 v83, v87
  v_add_f32 v80, v80, v84
  v_add_f32 v81, v81, v85
  v_add_f32 v82, v82, v86
  v_add_f32 v83, v83, v87
  s_nop 0
  v_permlane16_swap_b32 v80, v82
  v_permlane16_swap_b32 v81, v83
  v_add_f32 v80, v80, v82
  v_add_f32 v81, v81, v83
  s_nop 0
  v_add_f32_dpp v80, v80, v80 row_ror:8 row_mask:0xf bank_mask:0xf
  v_add_f32_dpp v81, v81, v81 row_ror:8 row_mask:0xf bank_mask:0xf
  v_mov_b32 v82, s30
  v_mov_b32 v83, s31
  s_mov_b32 exec_lo, 0xff00ff
  s_mov_b32 exec_hi, 0xff00ff
  buffer_store_dwordx4 v[80:83], v90, s[32:35], s64 offen offset:0
  s_mov_b64 exec, -1
  v_and_b32 v3, 31, v0
  v_lshrrev_b32 v2, 5, v0
  v_lshlrev_b32 v2, 11, v2
  v_lshl_add_u32 v2, v3, 4, v2
  s_lshl_b32 s68, s6, 14
  s_add_u32 s60, s68, s69
  s_add_u32 s61, s60, 4096
  s_add_u32 s62, s60, 8192
  s_add_u32 s63, s60, 12288
  v_lshlrev_b32 v3, 2, v3
  s_lshl_b32 s69, s3, 7
  v_add_u32 v3, s69, v3
  v_mov_b32 v1, 0
  s_mov_b32 s65, 0
  s_add_u32 s68, s3, 5
  s_cmp_lg_u32 s68, s7
  s_cbranch_scc1 L_qwait
  s_mov_b32 s16, s32
  s_mov_b32 s17, s33
  s_mov_b32 s18, 4194304
  s_mov_b32 s19, 0x20000
  s_mov_b32 s70, 4000007
L_spin_27:
  buffer_load_dwordx4 v[8:11], v2, s[16:19], s60 offen offset:0 sc1 nt
  buffer_load_dwordx4 v[12:15], v2, s[16:19], s61 offen offset:0 sc1 nt
  buffer_load_dwordx4 v[16:19], v2, s[16:19], s62 offen offset:0 sc1 nt
  buffer_load_dwordx4 v[20:23], v2, s[16:19], s63 offen offset:0 sc1 nt
  s_waitcnt vmcnt(0)
  v_cmp_ne_u64 vcc, s[30:31], v[10:11]
  v_cmp_ne_u64 s[20:21], s[30:31], v[14:15]
  v_cmp_ne_u64 s[22:23], s[30:31], v[18:19]
  s_or_b64 vcc, vcc, s[20:21]
  v_cmp_ne_u64 s[20:21], s[30:31], v[22:23]
  s_or_b64 vcc, vcc, s[22:23]
  s_or_b64 vcc, vcc, s[20:21]
  s_nop 0
  s_cbranch_vccz L_sdone_28
  s_sleep 2
  ds_read_b32 v4, v1 offset:648
  s_waitcnt lgkmcnt(0)
  v_readfirstlane_b32 s46, v4
  s_nop 0
  s_sub_u32 s68, s46, s65
  s_cmp_lg_u32 s68, 2
  s_cbranch_scc1 L_qlazy_29
  s_mov_b32 exec_lo, 0xff00ff
  s_mov_b32 exec_hi, 0xff00ff
  buffer_store_dwordx4 v[80:83], v90, s[24:27], s64 offen offset:0 sc1
  s_mov_b64 exec, -1
  s_mov_b32 s65, 1
L_qlazy_29:
  s_and_b32 s99, s70, 7
  s_cselect_b32 s16, s32, s24
  s_cselect_b32 s17, s33, s25
  s_sub_u32 s70, s70, 1
  s_cbranch_scc0 L_spin_27
L_sdone_28:
  v_add_f32 v8, v8, v12
  v_add_f32 v9, v9, v13
  v_add_f32 v16, v16, v20
  v_add_f32 v17, v17, v21
  v_add_f32 v8, v8, v16
  v_add_f32 v9, v9, v17
  v_mov_b32 v10, v8
  v_mov_b32 v11, v9
  s_nop 0
  v_permlane32_swap_b32 v8, v10
  v_permlane32_swap_b32 v9, v11
  v_add_f32 v8, v8, v10
  v_add_f32 v9, v9, v11
  v_cvt_pk_bf16_f32 v8, v8, v9
  s_lshl_b32 s66, s6, 14
  s_lshl_b32 s68, s3, 11
  s_add_u32 s66, s66, s68
  v_mov_b32_dpp v9, v8 quad_perm:[1,0,3,2] row_mask:0xf bank_mask:0xf
  v_mov_b32 v10, s30
  v_mov_b32 v11, s31
  v_lshlrev_b32 v2, 3, v0
  v_mov_b32 v1, 0
  s_mov_b32 s70, 4000007
L_spin_30:
  ds_read_b32 v4, v1 offset:648
  s_waitcnt lgkmcnt(0)
  v_cmp_gt_u32 vcc, 1, v4
  s_nop 0
  s_cbranch_vccz L_sdone_31
  s_sleep 2
  s_sub_u32 s70, s70, 1
  s_cbranch_scc0 L_spin_30
L_sdone_31:
  v_readfirstlane_b32 s46, v4
  s_mov_b32 exec_lo, 0x55555555
  s_mov_b32 exec_hi, 0x0
  buffer_store_dwordx4 v[8:11], v2, s[32:35], s66 offen offset:1536
  s_mov_b64 exec, -1
  s_cmp_lg_u32 s46, 1
  s_cbranch_scc1 L_slow_32
L_back_33:
  s_branch L_qget
L_qwait:
  s_sleep 40
L_qget:
  s_lshr_b32 s66, s2, 7
  s_lshl2_add_u32 s66, s4, s66
  s_lshl_b32 s66, s66, 14
  s_lshl_b32 s68, s3, 11
  s_add_u32 s66, s66, s68
  v_and_b32 v2, 15, v0
  v_bfe_u32 v5, v0, 4, 1
  v_lshlrev_b32 v3, 3, v2
  v_add_u32 v3, s69, v3
  v_lshl_add_u32 v3, v5, 13, v3
  v_lshlrev_b32 v2, 4, v2
  v_lshl_add_u32 v2, v5, 15, v2
  s_mov_b32 s16, s32
  s_mov_b32 s17, s33
  s_mov_b32 s18, 4194304
  s_mov_b32 s19, 0x20000
  s_mov_b32 s70, 4000007
L_spin_34:
  buffer_load_dwordx4 v[12:15], v2, s[16:19], s66 offen offset:1536 sc1 nt
  s_waitcnt vmcnt(0)
  v_cmp_ne_u64 vcc, s[30:31], v[14:15]
  s_nop 0
  s_cbranch_vccz L_sdone_35
  s_sleep 8
  ds_read_b32 v4, v1 offset:648
  s_waitcnt lgkmcnt(0)
  v_readfirstlane_b32 s46, v4
  s_nop 0
  s_sub_u32 s68, s46, s65
  s_cmp_lg_u32 s68, 2
  s_cbranch_scc1 L_qlazy_36
  s_mov_b32 exec_lo, 0xff00ff
  s_mov_b32 exec_hi, 0xff00ff
  buffer_store_dwordx4 v[80:83], v90, s[24:27], s64 offen offset:0 sc1
  s_mov_b64 exec, -1
  s_mov_b32 s65, 1
L_qlazy_36:
  s_and_b32 s99, s70, 7
  s_cselect_b32 s16, s32, s24
  s_cselect_b32 s17, s33, s25
  s_sub_u32 s70, s70, 1
  s_cbranch_scc0 L_spin_34
L_sdone_35:
  ds_write_b64 v3, v[12:13] offset:0
  s_lshl_b32 s69, s3, 3
  v_mov_b32 v4, s69
  v_mov_b32 v6, 1
  s_waitcnt lgkmcnt(0)
  ds_write_b32 v4, v6 offset:384
  v_mov_b32 v1, 0
  s_mov_b32 s70, 4000007
L_spin_37:
  ds_read_b32 v4, v1 offset:648
  s_waitcnt lgkmcnt(0)
  v_cmp_gt_u32 vcc, 1, v4
  s_nop 0
  s_cbranch_vccz L_sdone_38
  s_sleep 2
  s_sub_u32 s70, s70, 1
  s_cbranch_scc0 L_spin_37
L_sdone_38:
  v_readfirstlane_b32 s46, v4
  ds_read_b32 v4, v1 offset:648
  s_waitcnt lgkmcnt(0)
  v_readfirstlane_b32 s46, v4
  s_nop 0
  s_sub_u32 s68, s46, s65
  s_cmp_lg_u32 s68, 2
  s_cbranch_scc1 L_qlazy_39
  s_mov_b32 exec_lo, 0xff00ff
  s_mov_b32 exec_hi, 0xff00ff
  buffer_store_dwordx4 v[80:83], v90, s[24:27], s64 offen offset:0 sc1
  s_mov_b64 exec, -1
  s_mov_b32 s65, 1
L_qlazy_39:
  s_branch L_stats
L_ids:
  s_setprio 3
  s_getreg_b32 s64, hwreg(HW_REG_XCC_ID)
  s_mov_b32 s24, s58
  s_mov_b32 s25, s59
  s_mov_b32 s26, 4194304
  s_mov_b32 s27, 0x20000
  s_add_u32 s32, s58, 4194304
  s_addc_u32 s33, s59, 0
  s_mov_b32 s34, 4194304
  s_mov_b32 s35, 0x20000
  s_lshl3_add_u32 s71, s6, s7
  s_mul_i32 s5, s79, 5
  s_mul_i32 s47, s79, 3
  s_add_u32 s47, s47, 15
  s_cmp_lt_u32 s7, 5
  s_cselect_b32 s5, s5, s47
  s_add_u32 s5, s5, s7
  s_waitcnt lgkmcnt(0)
  s_mul_i32 s30, s28, 0x2c9277b5
  s_add_u32 s30, s30, 0xac564b05
  s_mul_i32 s31, s29, 0x0019660d
  s_add_u32 s31, s31, 0x3c6ef35f
  s_and_b32 s64, s64, 15
  v_mov_b32 v4, s30
  v_mov_b32 v5, s31
  v_mov_b32 v6, s64
  v_mov_b32 v7, s64
  s_lshl_b32 s68, s4, 9
  s_add_u32 s68, s68, 2080768
  s_lshr_b32 s65, s2, 3
  s_lshl_b32 s69, s65, 4
  v_mov_b32 v1, s69
  s_mov_b64 exec, 1
  buffer_store_dwordx4 v[4:7], v1, s[32:35], s68 offen
  s_mov_b64 exec, -1
  s_cmp_lg_u32 s65, 31
  s_cbranch_scc1 L_noinit
  v_lshlrev_b32 v12, 8, v0
  s_lshl_b32 s69, s4, 15
  s_add_u32 s69, s69, 1703936
  s_mov_b32 exec_lo, 0x8040201
  s_mov_b32 exec_hi, 0x8040201
  buffer_store_dword v4, v12, s[24:27], s69 offen sc1
  s_mov_b64 exec, -1
L_noinit:
  v_and_b32 v1, 31, v0
  v_lshlrev_b32 v1, 4, v1
  s_mov_b32 s70, 12
  s_mov_b32 s46, 2
L_idpoll:
  s_sleep 16
  buffer_load_dwordx4 v[8:11], v1, s[32:35], s68 offen sc1 nt
  s_waitcnt vmcnt(0)
  v_cmp_ne_u64 vcc, s[30:31], v[8:9]
  s_nop 0
  s_cbranch_vccz L_iddone
  s_sub_u32 s70, s70, 1
  s_cbranch_scc0 L_idpoll
  s_branch L_idset
L_iddone:
  v_cmp_ne_u32 vcc, s64, v10
  s_nop 0
  s_cbranch_vccnz L_idset
  s_mov_b32 s46, 1
L_idset:
  v_mov_b32 v1, 0
  v_mov_b32 v4, s46
  ds_write_b32 v1, v4 offset:648
  s_cmp_lg_u32 s65, 31
  s_cbranch_scc1 L_pf
  s_lshl_b32 s69, s4, 15
  s_add_u32 s69, s69, 1703936
  s_add_u32 s22, s58, s69
  s_addc_u32 s23, s59, 0
  s_waitcnt lgkmcnt(0)
  s_mov_b32 s8, -1
  s_mov_b32 s9, -1
  s_memtime s[12:13]
  s_waitcnt lgkmcnt(0)
  s_load_dword s10, s[22:23], 0
  s_waitcnt lgkmcnt(0)
  s_memtime s[14:15]
  s_waitcnt lgkmcnt(0)
  s_sub_u32 s11, s14, s12
  s_min_u32 s8, s8, s11
  s_waitcnt lgkmcnt(0)
  s_load_dword s10, s[22:23], 8192
  s_waitcnt lgkmcnt(0)
  s_memtime s[12:13]
  s_waitcnt lgkmcnt(0)
  s_sub_u32 s11, s12, s14
  s_min_u32 s9, s9, s11
  s_waitcnt lgkmcnt(0)
  s_load_dword s10, s[22:23], 10496
  s_waitcnt lgkmcnt(0)
  s_memtime s[14:15]
  s_waitcnt lgkmcnt(0)
  s_sub_u32 s11, s14, s12
  s_min_u32 s9, s9, s11
  s_waitcnt lgkmcnt(0)
  s_load_dword s10, s[22:23], 2304
  s_waitcnt lgkmcnt(0)
  s_memtime s[12:13]
  s_waitcnt lgkmcnt(0)
  s_sub_u32 s11, s12, s14
  s_min_u32 s8, s8, s11
  s_waitcnt lgkmcnt(0)
  s_load_dword s10, s[22:23], 4608
  s_waitcnt lgkmcnt(0)
  s_memtime s[14:15]
  s_waitcnt lgkmcnt(0)
  s_sub_u32 s11, s14, s12
  s_min_u32 s8, s8, s11
  s_waitcnt lgkmcnt(0)
  s_load_dword s10, s[22:23], 12800
  s_waitcnt lgkmcnt(0)
  s_memtime s[12:13]
  s_waitcnt lgkmcnt(0)
  s_sub_u32 s11, s12, s14
  s_min_u32 s9, s9, s11
  s_waitcnt lgkmcnt(0)
  s_load_dword s10, s[22:23], 15104
  s_waitcnt lgkmcnt(0)
  s_memtime s[14:15]
  s_waitcnt lgkmcnt(0)
  s_sub_u32 s11, s14, s12
  s_min_u32 s9, s9, s11
  s_waitcnt lgkmcnt(0)
  s_load_dword s10, s[22:23], 6912
  s_waitcnt lgkmcnt(0)
  s_memtime s[12:13]
  s_waitcnt lgkmcnt(0)
  s_sub_u32 s11, s12, s14
  s_min_u32 s8, s8, s11
  s_cmp_gt_u32 s8, s9
  s_cselect_b32 s21, 1, 0
  v_mov_b32 v4, s21
  v_mov_b32 v5, s62
  v_mov_b32 v6, s30
  v_mov_b32 v7, s31
  s_lshl_b32 s69, s4, 4
  s_add_u32 s69, s69, 950272
  s_mov_b64 exec, 1
  buffer_store_dwordx4 v[4:7], v1, s[24:27], s69 offen sc1
  s_mov_b64 exec, -1
L_pf:
  s_mov_b32 s65, 0
  s_cmp_lg_u32 s7, 6
  s_cbranch_scc1 L_nosample0
  v_mov_b32 v1, 0
  s_mov_b32 s70, 4000007
L_spin_40:
  ds_read_b64 v[4:5], v1 offset:696
  s_waitcnt lgkmcnt(0)
  v_cmp_gt_u32 vcc, 8, v5
  s_nop 0
  s_cbranch_vccz L_sdone_41
  s_sleep 2
  s_sub_u32 s70, s70, 1
  s_cbranch_scc0 L_spin_40
L_sdone_41:
  v_mov_b32 v5, s31
  v_lshlrev_b32 v6, 9, v0
  s_lshl_b32 s68, s6, 3
  s_add_u32 s68, s68, 958464
  s_mov_b64 exec, 7
  buffer_store_dwordx2 v[4:5], v6, s[24:27], s68 offen sc1
  s_mov_b64 exec, -1
L_nosample0:
  v_mov_b32 v1, 0
  s_mov_b32 s70, 4000007
L_spin_42:
  ds_read_b32 v12, v1 offset:692
  s_waitcnt lgkmcnt(0)
  v_cmp_gt_u32 vcc, 8, v12
  s_nop 0
  s_cbranch_vccz L_sdone_43
  s_sleep 4
  s_sub_u32 s70, s70, 1
  s_cbranch_scc0 L_spin_42
L_sdone_43:
  s_add_u32 s60, s58, 958464
  s_addc_u32 s61, s59, 0
  s_mov_b32 s70, 2
L_calpoll0:
  s_lshl_b32 s96, s62, 8
  s_sub_u32 s96, 0, s96
  s_mov_b32 s97, 0
  s_load_dwordx16 s[8:23], s[60:61], 0
  s_load_dwordx16 s[80:95], s[60:61], 64
  s_waitcnt lgkmcnt(0)
  s_add_u32 s96, s96, s8
  s_cmp_lg_u32 s9, s31
  s_addc_u32 s97, s97, 0
  s_add_u32 s96, s96, s10
  s_cmp_lg_u32 s11, s31
  s_addc_u32 s97, s97, 0
  s_add_u32 s96, s96, s12
  s_cmp_lg_u32 s13, s31
  s_addc_u32 s97, s97, 0
  s_add_u32 s96, s96, s14
  s_cmp_lg_u32 s15, s31
  s_addc_u32 s97, s97, 0
  s_add_u32 s96, s96, s16
  s_cmp_lg_u32 s17, s31
  s_addc_u32 s97, s97, 0
  s_add_u32 s96, s96, s18
  s_cmp_lg_u32 s19, s31
  s_addc_u32 s97, s97, 0
  s_add_u32 s96, s96, s20
  s_cmp_lg_u32 s21, s31
  s_addc_u32 s97, s97, 0
  s_add_u32 s96, s96, s22
  s_cmp_lg_u32 s23, s31
  s_addc_u32 s97, s97, 0
  s_add_u32 s96, s96, s80
  s_cmp_lg_u32 s81, s31
  s_addc_u32 s97, s97, 0
  s_add_u32 s96, s96, s82
  s_cmp_lg_u32 s83, s31
  s_addc_u32 s97, s97, 0
  s_add_u32 s96, s96, s84
  s_cmp_lg_u32 s85, s31
  s_addc_u32 s97, s97, 0
  s_add_u32 s96, s96, s86
  s_cmp_lg_u32 s87, s31
  s_addc_u32 s97, s97, 0
  s_add_u32 s96, s96, s88
  s_cmp_lg_u32 s89, s31
  s_addc_u32 s97, s97, 0
  s_add_u32 s96, s96, s90
  s_cmp_lg_u32 s91, s31
  s_addc_u32 s97, s97, 0
  s_add_u32 s96, s96, s92
  s_cmp_lg_u32 s93, s31
  s_addc_u32 s97, s97, 0
  s_add_u32 s96, s96, s94
  s_cmp_lg_u32 s95, s31
  s_addc_u32 s97, s97, 0
  s_load_dwordx16 s[8:23], s[60:61], 128
  s_load_dwordx16 s[80:95], s[60:61], 192
  s_waitcnt lgkmcnt(0)
  s_add_u32 s96, s96, s8
  s_cmp_lg_u32 s9, s31
  s_addc_u32 s97, s97, 0
  s_add_u32 s96, s96, s10
  s_cmp_lg_u32 s11, s31
  s_addc_u32 s97, s97, 0
  s_add_u32 s96, s96, s12
  s_cmp_lg_u32 s13, s31
  s_addc_u32 s97, s97, 0
  s_add_u32 s96, s96, s14
  s_cmp_lg_u32 s15, s31
  s_addc_u32 s97, s97, 0
  s_add_u32 s96, s96, s16
  s_cmp_lg_u32 s17, s31
  s_addc_u32 s97, s97, 0
  s_add_u32 s96, s96, s18
  s_cmp_lg_u32 s19, s31
  s_addc_u32 s97, s97, 0
  s_add_u32 s96, s96, s20
  s_cmp_lg_u32 s21, s31
  s_addc_u32 s97, s97, 0
  s_add_u32 s96, s96, s22
  s_cmp_lg_u32 s23, s31
  s_addc_u32 s97, s97, 0
  s_add_u32 s96, s96, s80
  s_cmp_lg_u32 s81, s31
  s_addc_u32 s97, s97, 0
  s_add_u32 s96, s96, s82
  s_cmp_lg_u32 s83, s31
  s_addc_u32 s97, s97, 0
  s_add_u32 s96, s96, s84
  s_cmp_lg_u32 s85, s31
  s_addc_u32 s97, s97, 0
  s_add_u32 s96, s96, s86
  s_cmp_lg_u32 s87, s31
  s_addc_u32 s97, s97, 0
  s_add_u32 s96, s96, s88
  s_cmp_lg_u32 s89, s31
  s_addc_u32 s97, s97, 0
  s_add_u32 s96, s96, s90
  s_cmp_lg_u32 s91, s31
  s_addc_u32 s97, s97, 0
  s_add_u32 s96, s96, s92
  s_cmp_lg_u32 s93, s31
  s_addc_u32 s97, s97, 0
  s_add_u32 s96, s96, s94
  s_cmp_lg_u32 s95, s31
  s_addc_u32 s97, s97, 0
  s_cmp_eq_u32 s97, 0
  s_cbranch_scc1 L_calok0
  s_add_u32 s60, s60, 512
  s_addc_u32 s61, s61, 0
  s_sub_u32 s70, s70, 1
  s_cbranch_scc1 L_stats
  s_sleep 20
  s_branch L_calpoll0
L_calok0:
  s_ashr_i32 s96, s96, 4
  s_mov_b32 s68, 112
  s_cmp_lt_u32 s5, 30
  s_cselect_b32 s68, -208, s68
  s_cmp_lt_u32 s5, 20
  s_cselect_b32 s68, 112, s68
  s_lshl4_add_u32 s68, s62, s68
  s_add_u32 s68, s68, s96
  s_mov_b32 s66, s68
  s_mov_b32 s65, -1
  v_mov_b32 v12, s68
  v_mov_b32 v13, -1
  ds_write_b64 v1, v[12:13] offset:680
L_stats:
  v_and_b32 v1, 7, v0
  v_lshlrev_b32 v1, 4, v1
  s_mov_b32 s70, 4000007
L_spin_44:
  ds_read_b128 v[4:7], v1 offset:512
  s_waitcnt lgkmcnt(0)
  v_cmp_eq_u32 vcc, 0, v7
  s_nop 0
  s_cbranch_vccz L_sdone_45
  s_sleep 4
  s_sub_u32 s70, s70, 1
  s_cbranch_scc0 L_spin_44
L_sdone_45:
  s_cmp_lg_u32 s3, 3
  s_cbranch_scc1 L_nostat
  v_and_b32 v12, 8, v0
  v_cmp_ne_u32 vcc, 0, v12
  v_lshlrev_b32 v12, 6, v12
  s_nop 0
  v_cndmask_b32 v4, v4, v6, vcc
  v_cndmask_b32 v5, v5, v7, vcc
  s_mov_b32 s68, 0x3fb8aa3b
  v_mov_b32 v2, v4
  s_nop 1
  v_max_f32_dpp v2, v2, v2 quad_perm:[1,0,3,2] row_mask:0xf bank_mask:0xf
  s_nop 1
  v_max_f32_dpp v2, v2, v2 quad_perm:[2,3,0,1] row_mask:0xf bank_mask:0xf
  s_nop 1
  v_max_f32_dpp v2, v2, v2 row_half_mirror row_mask:0xf bank_mask:0xf
  v_sub_f32 v4, v4, v2
  v_mul_f32 v4, s68, v4
  v_exp_f32 v4, v4
  s_nop 0
  v_mul_f32 v3, v4, v5
  s_nop 1
  v_add_f32_dpp v3, v3, v3 quad_perm:[1,0,3,2] row_mask:0xf bank_mask:0xf
  s_nop 1
  v_add_f32_dpp v3, v3, v3 quad_perm:[2,3,0,1] row_mask:0xf bank_mask:0xf
  s_nop 1
  v_add_f32_dpp v3, v3, v3 row_half_mirror row_mask:0xf bank_mask:0xf
  s_lshr_b32 s68, s2, 7
  s_lshl2_add_u32 s68, s4, s68
  s_bfe_u32 s69, s2, 0x40003
  s_lshl4_add_u32 s68, s68, s69
  s_lshl_b32 s68, s68, 4
  s_add_u32 s68, s68, 2064384
  v_mov_b32 v4, s30
  v_mov_b32 v5, s31
  s_mov_b32 exec_lo, 0x101
  s_mov_b32 exec_hi, 0x0
  buffer_store_dwordx4 v[2:5], v12, s[32:35], s68 offen
  s_mov_b64 exec, -1
  s_cmp_lg_u32 s46, 1
  s_cbranch_scc1 L_slow_46
L_back_47:
  s_mov_b32 s68, 950272
  s_mov_b32 s70, 4000007
L_spin_48:
  buffer_load_dwordx4 v[8:11], v1, s[24:27], s68 offen sc1
  s_waitcnt vmcnt(0)
  v_cmp_ne_u64 vcc, s[30:31], v[10:11]
  s_nop 0
  s_cbranch_vccz L_sdone_49
  s_sleep 8
  s_sub_u32 s70, s70, 1
  s_cbranch_scc0 L_spin_48
L_sdone_49:
  v_cmp_ne_u32 vcc, 0, v8
  s_nop 0
  s_and_b32 s67, vcc_lo, 0xff
  s_bitset1_b32 s67, 8
  v_mov_b32 v4, s67
  v_mov_b32 v1, 0
  ds_write_b32 v1, v4 offset:660
L_nostat:
  s_cmp_lg_u32 s3, 2
  s_cbranch_scc1 L_noa
  v_min_u32 v12, 47, v0
  v_lshrrev_b32 v13, 3, v12
  v_lshlrev_b32 v13, 11, v13
  v_and_b32 v14, 1, v12
  v_lshl_add_u32 v13, v14, 10, v13
  v_bfe_u32 v14, v12, 1, 2
  v_lshl_add_u32 v13, v14, 8, v13
  v_lshlrev_b32 v12, 4, v12
  s_lshr_b32 s74, s2, 7
  s_lshl2_add_u32 s74, s4, s74
  s_mul_i32 s74, s74, 12288
  s_bfe_u32 s69, s2, 0x40003
  s_lshl4_add_u32 s74, s69, s74
  s_add_u32 s74, s74, 524288
  s_mov_b32 s22, 0x55555555
  s_mov_b32 s23, 0x55555555
  v_mov_b32 v14, s30
  v_mov_b32 v15, s31
  v_mov_b32 v1, 0
  s_mov_b32 s70, 4000007
L_spin_50:
  ds_read_b32 v4, v1 offset:652
  s_waitcnt lgkmcnt(0)
  v_cmp_gt_u32 vcc, 8, v4
  s_nop 0
  s_cbranch_vccz L_sdone_51
  s_sleep 4
  s_sub_u32 s70, s70, 1
  s_cbranch_scc0 L_spin_50
L_sdone_51:
  v_mov_b32 v1, 0
  s_mov_b32 s70, 4000007
L_spin_52:
  ds_read_b32 v4, v1 offset:644
  s_waitcnt lgkmcnt(0)
  v_cmp_gt_u32 vcc, 1, v4
  s_nop 0
  s_cbranch_vccz L_sdone_53
  s_sleep 2
  s_sub_u32 s70, s70, 1
  s_cbranch_scc0 L_spin_52
L_sdone_53:
  ds_read_b128 v[16:19], v12 offset:57856
  ds_read_b128 v[20:23], v12 offset:58624
  ds_read_b128 v[24:27], v12 offset:59392
  ds_read_b128 v[28:31], v12 offset:60160
  ds_read_b128 v[32:35], v12 offset:60928
  ds_read_b128 v[36:39], v12 offset:61696
  ds_read_b128 v[40:43], v12 offset:62464
  ds_read_b128 v[44:47], v12 offset:63232
  s_waitcnt lgkmcnt(6)
  v_pk_add_f32 v[16:17], v[16:17], v[20:21]
  v_pk_add_f32 v[18:19], v[18:19], v[22:23]
  s_waitcnt lgkmcnt(4)
  v_pk_add_f32 v[24:25], v[24:25], v[28:29]
  v_pk_add_f32 v[26:27], v[26:27], v[30:31]
  v_pk_add_f32 v[16:17], v[16:17], v[24:25]
  v_pk_add_f32 v[18:19], v[18:19], v[26:27]
  s_waitcnt lgkmcnt(2)
  v_pk_add_f32 v[32:33], v[32:33], v[36:37]
  v_pk_add_f32 v[34:35], v[34:35], v[38:39]
  s_waitcnt lgkmcnt(0)
  v_pk_add_f32 v[40:41], v[40:41], v[44:45]
  v_pk_add_f32 v[42:43], v[42:43], v[46:47]
  v_pk_add_f32 v[32:33], v[32:33], v[40:41]
  v_pk_add_f32 v[34:35], v[34:35], v[42:43]
  v_pk_add_f32 v[4:5], v[16:17], v[32:33]
  v_pk_add_f32 v[6:7], v[18:19], v[34:35]
  v_cvt_pk_bf16_f32 v8, v4, v5
  v_cvt_pk_bf16_f32 v9, v6, v7
  v_cndmask_b32 v4, v8, v14, s[22:23]
  v_cndmask_b32 v5, v9, v15, s[22:23]
  v_cndmask_b32 v6, v14, v8, s[22:23]
  v_cndmask_b32 v7, v15, v9, s[22:23]
  s_mov_b32 exec_lo, 0xffffffff
  s_mov_b32 exec_hi, 0xffff
  buffer_store_dwordx4 v[4:7], v13, s[32:35], s74 offen
  s_mov_b64 exec, -1
  s_cmp_lg_u32 s46, 1
  s_cbranch_scc1 L_slow_54
L_back_55:
L_noa:
  s_cmp_lt_u32 s5, 20
  s_cbranch_scc0 L_helper_exit
  s_cmp_ge_u32 s5, 10
  s_cselect_b32 s76, 1, 0
  s_mul_i32 s77, s76, 10
  s_sub_u32 s77, s5, s77
  s_lshr_b32 s78, s3, 1
  v_and_b32 v2, 48, v0
  s_lshl_b32 s68, s78, 6
  v_add_u32 v22, s68, v2
  v_lshlrev_b32 v60, 4, v0
  s_lshl1_add_u32 s73, s4, s78
  s_lshl1_add_u32 s73, s73, s76
  s_lshl1_add_u32 s73, s73, s3
  s_lshl_b32 s68, s78, 1
  s_sub_u32 s73, s73, s68
  s_mul_i32 s73, s73, 6144
  s_add_u32 s73, s73, 524288
  s_add_u32 s74, s73, 4096
  v_lshlrev_b32 v62, 2, v0
  s_lshl_b32 s68, s3, 8
  v_add_u32 v61, s68, v62
  v_lshrrev_b32 v2, 5, v0
  v_lshlrev_b32 v2, 11, v2
  v_bfe_u32 v3, v0, 2, 3
  v_lshl_add_u32 v2, v3, 4, v2
  v_and_b32 v3, 1, v0
  v_lshl_add_u32 v63, v3, 13, v2
  s_lshr_b32 s75, s77, 1
  s_lshl_b32 s75, s75, 14
  s_and_b32 s68, s77, 1
  s_lshl_b32 s68, s68, 12
  s_add_u32 s75, s75, s68
  s_lshl1_add_u32 s68, s4, s76
  s_lshl_b32 s68, s68, 7
  s_add_u32 s75, s75, s68
  s_add_u32 s75, s75, 1966080
  s_mov_b32 s8, 0x33333333
  s_mov_b32 s9, 0x33333333
  v_mov_b32 v50, s30
  v_mov_b32 v51, s31
  v_lshrrev_b32 v24, 4, v0
  v_lshlrev_b32 v24, 10, v24
  v_bfe_u32 v25, v0, 2, 2
  v_lshl_add_u32 v24, v25, 7, v24
  v_and_b32 v25, 3, v0
  v_lshl_add_u32 v24, v25, 3, v24
  s_mul_i32 s69, s3, 12288
  v_add_u32 v24, s69, v24
  s_cmp_lg_u32 s3, 0
  s_cbranch_scc1 L_noc
  s_lshl2_add_u32 s72, s4, s76
  s_lshl_b32 s72, s72, 8
  s_add_u32 s72, s72, 2064384
  v_and_b32 v1, 15, v0
  v_lshlrev_b32 v1, 4, v1
  v_and_b32 v2, 16, v0
  v_lshl_add_u32 v1, v2, 5, v1
  s_mov_b32 s16, s32
  s_mov_b32 s17, s33
  s_mov_b32 s18, 4194304
  s_mov_b32 s19, 0x20000
  s_mov_b32 s70, 4000007
L_spin_56:
  s_sleep 24
  buffer_load_dwordx4 v[4:7], v1, s[16:19], s72 offen sc1 nt
  s_waitcnt vmcnt(0)
  v_cmp_ne_u64 vcc, s[30:31], v[6:7]
  s_nop 0
  s_cbranch_vccz L_sdone_57
  s_and_b32 s99, s70, 7
  s_cmp_eq_u32 s46, 1
  s_cselect_b32 s99, 1, s99
  s_cmp_lg_u32 s99, 0
  s_cselect_b32 s16, s32, s24
  s_cselect_b32 s17, s33, s25
  s_sub_u32 s70, s70, 1
  s_cbranch_scc0 L_spin_56
L_sdone_57:
  s_mov_b32 s68, 0x3fb8aa3b
  v_mov_b32 v2, v4
  s_nop 1
  v_max_f32_dpp v2, v2, v2 quad_perm:[1,0,3,2] row_mask:0xf bank_mask:0xf
  s_nop 1
  v_max_f32_dpp v2, v2, v2 quad_perm:[2,3,0,1] row_mask:0xf bank_mask:0xf
  s_nop 1
  v_max_f32_dpp v2, v2, v2 row_half_mirror row_mask:0xf bank_mask:0xf
  s_nop 1
  v_max_f32_dpp v2, v2, v2 row_mirror row_mask:0xf bank_mask:0xf
  v_sub_f32 v4, v4, v2
  v_mul_f32 v4, s68, v4
  v_exp_f32 v4, v4
  s_nop 0
  v_mul_f32 v3, v4, v5
  s_nop 1
  v_add_f32_dpp v3, v3, v3 quad_perm:[1,0,3,2] row_mask:0xf bank_mask:0xf
  s_nop 1
  v_add_f32_dpp v3, v3, v3 quad_perm:[2,3,0,1] row_mask:0xf bank_mask:0xf
  s_nop 1
  v_add_f32_dpp v3, v3, v3 row_half_mirror row_mask:0xf bank_mask:0xf
  s_nop 1
  v_add_f32_dpp v3, v3, v3 row_mirror row_mask:0xf bank_mask:0xf
  v_rcp_f32 v3, v3
  v_and_b32 v1, 0x7c, v62
  v_mul_f32 v4, v4, v3
  v_mov_b32 v2, 0
  v_mov_b32 v3, 1
  ds_write_b32 v1, v4 offset:768
  ds_write_b32 v2, v3 offset:664
L_noc:
  v_mov_b32 v1, 0
  s_mov_b32 s70, 4000007
L_spin_58:
  ds_read_b32 v4, v1 offset:664
  s_waitcnt lgkmcnt(0)
  v_cmp_gt_u32 vcc, 1, v4
  s_nop 0
  s_cbranch_vccz L_sdone_59
  s_sleep 2
  s_sub_u32 s70, s70, 1
  s_cbranch_scc0 L_spin_58
L_sdone_59:
  ds_read_b128 v[56:59], v22 offset:768
  s_mov_b32 s12, s44
  s_mov_b32 s13, s45
  s_mov_b32 s14, 7864320
  s_mov_b32 s15, 0x20000
  v_lshrrev_b32 v21, 3, v0
  v_mul_u32_u24 v21, 1280, v21
  v_and_b32 v3, 7, v0
  v_lshl_add_u32 v21, v3, 4, v21
  s_lshl1_add_u32 s60, s4, s76
  s_mul_i32 s68, s78, 16
  s_add_u32 s60, s60, s68
  s_add_u32 s60, s60, 0
  s_and_b32 s68, s3, 1
  s_lshl1_add_u32 s60, s60, s68
  s_mul_i32 s60, s60, 122880
  s_lshl_b32 s69, s77, 7
  s_add_u32 s60, s60, s69
  s_mul_i32 s61, s3, 12288
  s_add_u32 s61, s61, 8704
  v_mov_b32 v23, 1
  s_lshl_b32 s68, s3, 2
  v_mov_b32 v25, s68
  v_mov_b32 v1, 0
  s_mov_b32 s70, 4000007
L_spin_60:
  ds_read_b32 v4, v1 offset:660
  s_waitcnt lgkmcnt(0)
  v_cmp_gt_u32 vcc, 1, v4
  s_nop 0
  s_cbranch_vccz L_sdone_61
  s_sleep 4
  s_sub_u32 s70, s70, 1
  s_cbranch_scc0 L_spin_60
L_sdone_61:
  v_readfirstlane_b32 s47, v4
  v_mov_b32 v1, 0
  s_mov_b32 s70, 4000007
L_spin_62:
  ds_read_b32 v4, v1 offset:644
  s_waitcnt lgkmcnt(0)
  v_cmp_gt_u32 vcc, 8, v4
  s_nop 0
  s_cbranch_vccz L_sdone_63
  s_sleep 2
  s_sub_u32 s70, s70, 1
  s_cbranch_scc0 L_spin_62
L_sdone_63:
  s_cmp_lg_u32 s78, 0
  s_cbranch_scc1 L_nofirst
L_nofirst:
  s_mov_b32 m0, s61
  s_nop 0
  buffer_load_dwordx4 v21, s[12:15], s60 offen nt lds
  s_add_u32 s60, s60, 10240
  s_add_u32 s61, s61, 1024
  s_mov_b32 m0, s61
  s_nop 0
  buffer_load_dwordx4 v21, s[12:15], s60 offen nt lds
  s_add_u32 s60, s60, 10240
  s_add_u32 s61, s61, 1024
  s_mov_b32 m0, s61
  s_nop 0
  buffer_load_dwordx4 v21, s[12:15], s60 offen nt lds
  s_add_u32 s60, s60, 10240
  s_add_u32 s61, s61, 1024
  s_mov_b32 m0, s61
  s_nop 0
  buffer_load_dwordx4 v21, s[12:15], s60 offen nt lds
  s_add_u32 s60, s60, 10240
  s_add_u32 s61, s61, 1024
  s_mov_b32 m0, s61
  s_nop 0
  buffer_load_dwordx4 v21, s[12:15], s60 offen nt lds
  s_add_u32 s60, s60, 10240
  s_add_u32 s61, s61, 1024
  s_mov_b32 m0, s61
  s_nop 0
  buffer_load_dwordx4 v21, s[12:15], s60 offen nt lds
  s_add_u32 s60, s60, 10240
  s_add_u32 s61, s61, 1024
  s_waitcnt vmcnt(5)
  s_mov_b32 m0, s61
  s_nop 0
  buffer_load_dwordx4 v21, s[12:15], s60 offen nt lds
  s_add_u32 s60, s60, 10240
  s_add_u32 s61, s61, 1024
  s_waitcnt vmcnt(5)
  s_mov_b32 m0, s61
  s_nop 0
  buffer_load_dwordx4 v21, s[12:15], s60 offen nt lds
  s_add_u32 s60, s60, 10240
  s_add_u32 s61, s61, 1024
  s_waitcnt vmcnt(5)
  s_mov_b32 m0, s61
  s_nop 0
  buffer_load_dwordx4 v21, s[12:15], s60 offen nt lds
  s_add_u32 s60, s60, 10240
  s_add_u32 s61, s61, 1024
  s_waitcnt vmcnt(5)
  s_mov_b32 m0, s61
  s_nop 0
  buffer_load_dwordx4 v21, s[12:15], s60 offen nt lds
  s_add_u32 s60, s60, 10240
  s_add_u32 s61, s61, 1024
  s_waitcnt vmcnt(5)
  s_mov_b32 m0, s61
  s_nop 0
  buffer_load_dwordx4 v21, s[12:15], s60 offen nt lds
  s_add_u32 s60, s60, 10240
  s_add_u32 s61, s61, 1024
  s_waitcnt vmcnt(5)
  s_mov_b32 m0, s61
  s_nop 0
  buffer_load_dwordx4 v21, s[12:15], s60 offen nt lds
  s_waitcnt vmcnt(4)
  s_cmp_lg_u32 s78, 0
  s_cbranch_scc1 L_s2
  buffer_load_dwordx4 v[144:147], v60, s[32:35], s73 offen offset:0 sc1 nt
  buffer_load_dwordx4 v[148:151], v60, s[32:35], s73 offen offset:1024 sc1 nt
  buffer_load_dwordx4 v[152:155], v60, s[32:35], s73 offen offset:2048 sc1 nt
  buffer_load_dwordx4 v[156:159], v60, s[32:35], s73 offen offset:3072 sc1 nt
  buffer_load_dwordx4 v[160:163], v60, s[32:35], s74 offen offset:0 sc1 nt
  buffer_load_dwordx4 v[164:167], v60, s[32:35], s74 offen offset:1024 sc1 nt
L_s2:
  ds_read_b64_tr_b16 v[64:65], v24 offset:8704
  ds_read_b64_tr_b16 v[66:67], v24 offset:9216
  ds_read_b64_tr_b16 v[68:69], v24 offset:8736
  ds_read_b64_tr_b16 v[70:71], v24 offset:9248
  ds_read_b64_tr_b16 v[72:73], v24 offset:8768
  ds_read_b64_tr_b16 v[74:75], v24 offset:9280
  ds_read_b64_tr_b16 v[76:77], v24 offset:8800
  ds_read_b64_tr_b16 v[78:79], v24 offset:9312
  ds_read_b64_tr_b16 v[80:81], v24 offset:12800
  ds_read_b64_tr_b16 v[82:83], v24 offset:13312
  ds_read_b64_tr_b16 v[84:85], v24 offset:12832
  ds_read_b64_tr_b16 v[86:87], v24 offset:13344
  ds_read_b64_tr_b16 v[88:89], v24 offset:12864
  ds_read_b64_tr_b16 v[90:91], v24 offset:13376
  ds_read_b64_tr_b16 v[92:93], v24 offset:12896
  ds_read_b64_tr_b16 v[94:95], v24 offset:13408
  s_cmp_lg_u32 s78, 0
  s_cbranch_scc1 L_second
  s_waitcnt vmcnt(6) lgkmcnt(0)
  s_branch L_both
L_second:
  v_mov_b32 v1, 0
  s_mov_b32 s70, 4000007
L_spin_64:
  ds_read_b32 v4, v1 offset:668
  s_waitcnt lgkmcnt(0)
  v_cmp_gt_u32 vcc, 1, v4
  s_nop 0
  s_cbranch_vccz L_sdone_65
  s_sleep 1
  s_sub_u32 s70, s70, 1
  s_cbranch_scc0 L_spin_64
L_sdone_65:
  s_waitcnt vmcnt(2)
  buffer_load_dwordx4 v[144:147], v60, s[32:35], s73 offen offset:0 sc1
  buffer_load_dwordx4 v[148:151], v60, s[32:35], s73 offen offset:1024 sc1
  buffer_load_dwordx4 v[152:155], v60, s[32:35], s73 offen offset:2048 sc1
  buffer_load_dwordx4 v[156:159], v60, s[32:35], s73 offen offset:3072 sc1
  buffer_load_dwordx4 v[160:163], v60, s[32:35], s74 offen offset:0 sc1
  buffer_load_dwordx4 v[164:167], v60, s[32:35], s74 offen offset:1024 sc1
  s_waitcnt vmcnt(6)
L_both:
  ds_read_b64_tr_b16 v[96:97], v24 offset:16896
  ds_read_b64_tr_b16 v[98:99], v24 offset:17408
  ds_read_b64_tr_b16 v[100:101], v24 offset:16928
  ds_read_b64_tr_b16 v[102:103], v24 offset:17440
  ds_read_b64_tr_b16 v[104:105], v24 offset:16960
  ds_read_b64_tr_b16 v[106:107], v24 offset:17472
  ds_read_b64_tr_b16 v[108:109], v24 offset:16992
  ds_read_b64_tr_b16 v[110:111], v24 offset:17504
  s_mov_b32 s16, s32
  s_mov_b32 s17, s33
  s_mov_b32 s18, 4194304
  s_mov_b32 s19, 0x20000
  s_mov_b32 s70, 4000007
  s_branch L_opw
L_spin_66:
  buffer_load_dwordx4 v[144:147], v60, s[16:19], s73 offen offset:0 sc1
  buffer_load_dwordx4 v[148:151], v60, s[16:19], s73 offen offset:1024 sc1
  buffer_load_dwordx4 v[152:155], v60, s[16:19], s73 offen offset:2048 sc1
  buffer_load_dwordx4 v[156:159], v60, s[16:19], s73 offen offset:3072 sc1
  buffer_load_dwordx4 v[160:163], v60, s[16:19], s74 offen offset:0 sc1
  buffer_load_dwordx4 v[164:167], v60, s[16:19], s74 offen offset:1024 sc1
L_opw:
  s_waitcnt vmcnt(4)
  v_mfma_f32_16x16x32_bf16 v[32:35], v[146:149], v[64:67], 0
  v_cmp_ne_u64 vcc, s[30:31], v[144:145]
  v_cmp_ne_u64 s[22:23], s[30:31], v[150:151]
  v_mfma_f32_16x16x32_bf16 v[36:39], v[146:149], v[68:71], 0
  s_or_b64 vcc, vcc, s[22:23]
  v_mfma_f32_16x16x32_bf16 v[40:43], v[146:149], v[72:75], 0
  v_mfma_f32_16x16x32_bf16 v[44:47], v[146:149], v[76:79], 0
  s_waitcnt vmcnt(2)
  v_mfma_f32_16x16x32_bf16 v[32:35], v[154:157], v[80:83], v[32:35]
  v_cmp_ne_u64 s[20:21], s[30:31], v[152:153]
  v_cmp_ne_u64 s[22:23], s[30:31], v[158:159]
  v_mfma_f32_16x16x32_bf16 v[36:39], v[154:157], v[84:87], v[36:39]
  s_or_b64 vcc, vcc, s[20:21]
  s_or_b64 vcc, vcc, s[22:23]
  v_mfma_f32_16x16x32_bf16 v[40:43], v[154:157], v[88:91], v[40:43]
  v_mfma_f32_16x16x32_bf16 v[44:47], v[154:157], v[92:95], v[44:47]
  s_waitcnt vmcnt(0) lgkmcnt(0)
  v_mfma_f32_16x16x32_bf16 v[32:35], v[162:165], v[96:99], v[32:35]
  v_cmp_ne_u64 s[20:21], s[30:31], v[160:161]
  v_cmp_ne_u64 s[22:23], s[30:31], v[166:167]
  v_mfma_f32_16x16x32_bf16 v[36:39], v[162:165], v[100:103], v[36:39]
  s_or_b64 vcc, vcc, s[20:21]
  s_or_b64 vcc, vcc, s[22:23]
  v_mfma_f32_16x16x32_bf16 v[40:43], v[162:165], v[104:107], v[40:43]
  v_mfma_f32_16x16x32_bf16 v[44:47], v[162:165], v[108:111], v[44:47]
  s_nop 0
  s_cbranch_vccz L_sdone_67
  s_and_b32 s99, s70, 7
  s_cmp_eq_u32 s46, 1
  s_cselect_b32 s99, 1, s99
  s_cmp_lg_u32 s99, 0
  s_cselect_b32 s16, s32, s24
  s_cselect_b32 s17, s33, s25
  s_sub_u32 s70, s70, 1
  s_cbranch_scc0 L_spin_66
L_sdone_67:
  v_mul_f32 v4, v32, v56
  v_fmac_f32 v4, v33, v57
  v_fmac_f32 v4, v34, v58
  v_fmac_f32 v4, v35, v59
  v_mul_f32 v5, v36, v56
  v_fmac_f32 v5, v37, v57
  v_fmac_f32 v5, v38, v58
  v_fmac_f32 v5, v39, v59
  v_mul_f32 v6, v40, v56
  v_fmac_f32 v6, v41, v57
  v_fmac_f32 v6, v42, v58
  v_fmac_f32 v6, v43, v59
  v_mul_f32 v7, v44, v56
  v_fmac_f32 v7, v45, v57
  v_fmac_f32 v7, v46, v58
  v_fmac_f32 v7, v47, v59
  v_permlane32_swap_b32 v4, v6
  s_nop 0
  v_permlane32_swap_b32 v5, v7
  v_add_f32 v4, v4, v6
  v_add_f32 v5, v5, v7
  s_nop 1
  v_permlane16_swap_b32 v4, v5
  v_add_f32 v4, v4, v5
  ds_write_b32 v61, v4 offset:7168
  s_cmp_lg_u32 s3, 0
  s_waitcnt lgkmcnt(0)
  s_barrier
  s_cbranch_scc1 L_post_wo
  ds_read_b32 v5, v62 offset:7424
  ds_read_b32 v6, v62 offset:7680
  ds_read_b32 v7, v62 offset:7936
  s_waitcnt lgkmcnt(0)
  v_add_f32 v4, v4, v5
  v_add_f32 v6, v6, v7
  v_add_f32 v4, v4, v6
  s_nop 1
  v_mov_b32_dpp v5, v4 quad_perm:[1,0,3,2] row_mask:0xf bank_mask:0xf
  v_cvt_pk_bf16_f32 v4, v4, v5
  s_nop 1
  v_mov_b32_dpp v48, v4 quad_perm:[0,0,0,0] row_mask:0xf bank_mask:0xf
  v_mov_b32_dpp v49, v4 quad_perm:[2,2,2,2] row_mask:0xf bank_mask:0xf
  s_mov_b64 exec, s[8:9]
  buffer_store_dwordx4 v[48:51], v63, s[24:27], s75 offen sc1
  s_barrier
  s_endpgm
L_helper_exit:
  s_endpgm
L_f1:
  s_mov_b32 s12, s48
  s_mov_b32 s13, s49
  s_mov_b32 s14, 1966080
  s_mov_b32 s15, 0x20000
  s_mov_b32 s16, s50
  s_mov_b32 s17, s51
  s_mov_b32 s18, 1966080
  s_mov_b32 s19, 0x20000
  s_sub_u32 s74, s5, 20
  v_lshrrev_b32 v3, 4, v0
  v_and_b32 v2, 7, v0
  v_lshrrev_b32 v62, 3, v0
  v_mul_u32_u24 v62, 3072, v62
  v_lshl_add_u32 v62, v2, 4, v62
  s_lshl3_add_u32 s61, s74, s73
  s_mul_i32 s61, s61, 24576
  s_mul_i32 s68, s4, 384
  s_add_u32 s61, s61, s68
  s_add_u32 s62, s61, 128
  s_add_u32 s63, s61, 256
  s_lshl_b32 s79, s73, 10
  s_add_u32 s79, s79, 8704
  v_mov_b32 v57, 0
  v_mov_b32 v6, s30
  v_mov_b32 v7, s31
  v_mov_b32 v1, 0
  s_mov_b32 s70, 4000007
L_spin_68:
  ds_read_b32 v4, v1 offset:668
  s_waitcnt lgkmcnt(0)
  v_cmp_gt_u32 vcc, 1, v4
  s_nop 0
  s_cbranch_vccz L_sdone_69
  s_sleep 1
  s_sub_u32 s70, s70, 1
  s_cbranch_scc0 L_spin_68
L_sdone_69:
  s_add_u32 m0, s79, 0
  s_nop 0
  buffer_load_dwordx4 v62, s[12:15], s61 offen nt lds
  s_add_u32 m0, s79, 24576
  s_nop 0
  buffer_load_dwordx4 v62, s[16:19], s61 offen nt lds
  s_add_u32 m0, s79, 8192
  s_nop 0
  buffer_load_dwordx4 v62, s[12:15], s62 offen nt lds
  s_add_u32 m0, s79, 32768
  s_nop 0
  buffer_load_dwordx4 v62, s[16:19], s62 offen nt lds
  s_add_u32 m0, s79, 16384
  s_nop 0
  buffer_load_dwordx4 v62, s[12:15], s63 offen nt lds
  s_add_u32 m0, s79, 40960
  s_nop 0
  buffer_load_dwordx4 v62, s[16:19], s63 offen nt lds
  s_setprio 3
  s_cmp_gt_u32 s73, 1
  s_cbranch_scc1 L_f1m
  v_mov_b32 v1, 0
  s_mov_b32 s70, 4000007
L_spin_70:
  ds_read_b32 v4, v1 offset:660
  s_waitcnt lgkmcnt(0)
  v_cmp_gt_u32 vcc, 1, v4
  s_nop 0
  s_cbranch_vccz L_sdone_71
  s_sleep 1
  s_sub_u32 s70, s70, 1
  s_cbranch_scc0 L_spin_70
L_sdone_71:
  v_readfirstlane_b32 s47, v4
  s_lshl1_add_u32 s74, s74, s73
  v_lshl_add_u32 v61, v2, 2, v3
  v_lshlrev_b32 v61, 1, v61
  s_lshl_b32 s68, s74, 6
  v_add_u32 v61, s68, v61
  global_load_ushort v56, v61, s[36:37]
  v_lshlrev_b32 v54, 5, v3
  v_lshl_add_u32 v54, v2, 2, v54
  v_lshlrev_b32 v55, 4, v0
  s_lshl_b32 s72, s4, 9
  s_lshl4_add_u32 s72, s74, s72
  s_add_u32 s72, s72, 2752512
  s_mul_i32 s75, s4, 20
  s_add_u32 s75, s75, s74
  s_lshl_b32 s75, s75, 7
  s_add_u32 s75, s75, 2768896
  s_mov_b64 exec, 1
  buffer_load_dword v104, v54, s[32:35], s75 offen sc1
  buffer_load_dword v105, v55, s[32:35], s72 offen sc1
  s_mov_b64 exec, -1
  s_lshr_b32 s60, s74, 2
  s_lshl_b32 s60, s60, 14
  s_and_b32 s68, s74, 3
  s_lshl_b32 s68, s68, 11
  s_add_u32 s60, s60, s68
  s_lshr_b32 s68, s47, s4
  s_and_b32 s68, s68, 1
  s_lshl_b32 s68, s68, 13
  s_add_u32 s60, s60, s68
  s_add_u32 s60, s60, 1966080
  v_lshlrev_b32 v51, 4, v3
  v_lshl_add_u32 v51, v2, 1, v51
  v_and_b32 v4, 1, v0
  v_mul_u32_u24 v4, 126, v4
  v_add_u32 v51, v51, v4
  s_lshl_b32 s68, s73, 6
  v_add_u32 v51, s68, v51
  s_mov_b32 s77, 0x3f80
  s_mov_b32 s71, 0x3f800000
  v_mov_b32 v14, s30
  v_mov_b32 v15, s31
  v_mov_b32 v8, 0
  v_mov_b32 v9, 0
  v_mov_b32 v10, 0
  v_mov_b32 v11, 0
  v_not_b32 v98, s30
  v_not_b32 v102, s30
  s_waitcnt vmcnt(2)
  s_barrier
  v_lshlrev_b32 v56, 16, v56
  s_mov_b32 s70, 4000007
  s_mov_b64 s[20:21], -1
  s_mov_b64 s[22:23], -1
L_ypoll:
  s_mov_b64 exec, s[20:21]
  buffer_load_dwordx4 v[96:99], v55, s[24:27], s60 offen sc1
  s_mov_b64 exec, s[22:23]
  buffer_load_dwordx4 v[100:103], v55, s[24:27], s60 offen offset:1024 sc1
  s_mov_b64 exec, -1
  v_cmp_ne_u64 s[20:21], s[30:31], v[98:99]
  v_cmp_ne_u64 s[22:23], s[30:31], v[102:103]
  s_nop 0
  s_or_b64 vcc, s[20:21], s[22:23]
  s_cbranch_scc0 L_yok
  v_cmp_ne_u64 s[20:21], s[30:31], v[98:99]
  v_cmp_ne_u64 s[22:23], s[30:31], v[102:103]
  s_nop 0
  s_or_b64 vcc, s[20:21], s[22:23]
  s_cbranch_scc0 L_yok
  v_cmp_ne_u64 s[20:21], s[30:31], v[98:99]
  v_cmp_ne_u64 s[22:23], s[30:31], v[102:103]
  s_nop 0
  s_or_b64 vcc, s[20:21], s[22:23]
  s_cbranch_scc0 L_yok
  v_cmp_ne_u64 s[20:21], s[30:31], v[98:99]
  v_cmp_ne_u64 s[22:23], s[30:31], v[102:103]
  s_nop 0
  s_or_b64 vcc, s[20:21], s[22:23]
  s_cbranch_scc0 L_yok
  v_cmp_ne_u64 s[20:21], s[30:31], v[98:99]
  v_cmp_ne_u64 s[22:23], s[30:31], v[102:103]
  s_nop 0
  s_or_b64 vcc, s[20:21], s[22:23]
  s_cbranch_scc0 L_yok
  v_cmp_ne_u64 s[20:21], s[30:31], v[98:99]
  v_cmp_ne_u64 s[22:23], s[30:31], v[102:103]
  s_nop 0
  s_or_b64 vcc, s[20:21], s[22:23]
  s_cbranch_scc0 L_yok
  s_waitcnt vmcnt(16)
  s_sub_u32 s70, s70, 1
  s_cbranch_scc0 L_ypoll
L_yok:
  v_dot2c_f32_bf16 v8, s77, v96
  v_dot2c_f32_bf16 v10, s77, v97
  v_dot2c_f32_bf16 v9, s71, v96
  v_dot2c_f32_bf16 v11, s71, v97
  v_dot2c_f32_bf16 v8, s77, v100
  v_dot2c_f32_bf16 v10, s77, v101
  v_dot2c_f32_bf16 v9, s71, v100
  v_dot2c_f32_bf16 v11, s71, v101
  s_nop 0
  v_permlane32_swap_b32 v8, v10
  s_nop 0
  v_permlane32_swap_b32 v9, v11
  v_add_f32 v8, v8, v10
  v_add_f32 v9, v9, v11
  s_nop 1
  v_permlane16_swap_b32 v8, v9
  v_add_f32 v8, v8, v9
  s_nop 1
  v_add_f32_dpp v8, v8, v8 row_ror:8 row_mask:0xf bank_mask:0xf
  v_cvt_pk_bf16_f32 v8, v57, v8
  v_add_f32 v12, v8, v56
  s_nop 1
  v_mov_b32_dpp v13, v12 quad_perm:[1,0,3,2] row_mask:0xf bank_mask:0xf
  v_cvt_pk_bf16_f32 v12, v12, v13
  ds_write_b32 v51, v12 offset:7168
  v_lshlrev_b32 v4, 16, v12
  v_mul_f32 v5, v4, v4
  s_nop 0
  v_add_f32_dpp v4, v4, v4 quad_perm:[1,0,3,2] row_mask:0xf bank_mask:0xf
  v_add_f32_dpp v5, v5, v5 quad_perm:[1,0,3,2] row_mask:0xf bank_mask:0xf
  s_nop 0
  v_add_f32_dpp v4, v4, v4 quad_perm:[2,3,0,1] row_mask:0xf bank_mask:0xf
  v_add_f32_dpp v5, v5, v5 quad_perm:[2,3,0,1] row_mask:0xf bank_mask:0xf
  s_nop 0
  v_add_f32_dpp v4, v4, v4 row_half_mirror row_mask:0xf bank_mask:0xf
  v_add_f32_dpp v5, v5, v5 row_half_mirror row_mask:0xf bank_mask:0xf
  s_waitcnt lgkmcnt(0)
  s_barrier
  v_mov_b32_dpp v13, v12 quad_perm:[2,3,2,3] row_mask:0xf bank_mask:0xf
  v_mov_b32 v8, v4
  v_mov_b32 v9, v5
  s_nop 0
  v_permlane16_swap_b32 v4, v8
  v_permlane16_swap_b32 v5, v9
  v_add_f32 v4, v4, v8
  v_add_f32 v5, v5, v9
  v_mov_b32 v8, v4
  v_mov_b32 v9, v5
  s_nop 0
  v_permlane32_swap_b32 v4, v8
  v_permlane32_swap_b32 v5, v9
  v_add_f32 v4, v4, v8
  v_add_f32 v5, v5, v9
  s_mov_b32 exec_lo, 0x1
  s_mov_b32 exec_hi, 0x0
  buffer_store_dwordx4 v[4:7], v55, s[32:35], s72 offen
  s_mov_b32 exec_lo, 0x110011
  s_mov_b32 exec_hi, 0x110011
  buffer_store_dwordx4 v[12:15], v54, s[32:35], s75 offen
  s_mov_b64 exec, -1
  s_cmp_lg_u32 s46, 1
  s_cbranch_scc1 L_slow_72
L_back_73:
  s_endpgm
L_f1m:
  s_sub_u32 s68, s73, 2
  s_lshr_b32 s78, s68, 1
  s_and_b32 s69, s73, 1
  v_lshlrev_b32 v58, 7, v3
  v_bfe_u32 v4, v0, 2, 2
  v_lshl_add_u32 v58, v4, 9, v58
  v_and_b32 v4, 3, v0
  v_lshl_add_u32 v58, v4, 3, v58
  s_lshl_b32 s75, s78, 13
  s_lshl_b32 s68, s69, 6
  s_add_u32 s75, s75, s68
  v_add_u32 v58, s75, v58
  v_lshlrev_b32 v52, 4, v3
  v_and_b32 v59, 1, v3
  v_cmp_eq_u32 s[62:63], 1, v59
  v_mul_u32_u24 v59, 3072, v59
  v_bfe_u32 v4, v0, 3, 1
  v_lshl_add_u32 v59, v4, 9, v59
  v_lshl_add_u32 v59, v2, 4, v59
  s_mul_i32 s76, s4, 3
  s_add_u32 s76, s76, s78
  s_lshl1_add_u32 s76, s76, s69
  s_mul_i32 s76, s76, 6144
  s_lshr_b32 s68, s74, 2
  s_lshl_b32 s68, s68, 10
  s_add_u32 s76, s76, s68
  s_and_b32 s68, s74, 3
  s_lshl_b32 s68, s68, 7
  s_add_u32 s76, s76, s68
  s_add_u32 s77, s76, 3145728
  s_add_u32 s76, s76, 2228224
  v_mov_b32 v8, 0x3f803f80
  v_mov_b32 v9, 0x3f803f80
  v_mov_b32 v10, 0x3f803f80
  v_mov_b32 v11, 0x3f803f80
  v_mov_b32 v34, s30
  v_mov_b32 v35, s31
  s_waitcnt vmcnt(0)
  s_barrier
  ds_read_b64_tr_b16 v[64:65], v58 offset:8704
  ds_read_b64_tr_b16 v[66:67], v58 offset:10752
  ds_read_b64_tr_b16 v[68:69], v58 offset:8736
  ds_read_b64_tr_b16 v[70:71], v58 offset:10784
  ds_read_b64_tr_b16 v[72:73], v58 offset:33280
  ds_read_b64_tr_b16 v[74:75], v58 offset:35328
  ds_read_b64_tr_b16 v[76:77], v58 offset:33312
  ds_read_b64_tr_b16 v[78:79], v58 offset:35360
  ds_read_b64_tr_b16 v[80:81], v58 offset:12800
  ds_read_b64_tr_b16 v[82:83], v58 offset:14848
  ds_read_b64_tr_b16 v[84:85], v58 offset:12832
  ds_read_b64_tr_b16 v[86:87], v58 offset:14880
  ds_read_b64_tr_b16 v[88:89], v58 offset:37376
  ds_read_b64_tr_b16 v[90:91], v58 offset:39424
  ds_read_b64_tr_b16 v[92:93], v58 offset:37408
  ds_read_b64_tr_b16 v[94:95], v58 offset:39456
  s_waitcnt lgkmcnt(0)
  v_mfma_f32_16x16x32_bf16 v[16:19], v[8:11], v[64:67], 0
  v_mfma_f32_16x16x32_bf16 v[20:23], v[8:11], v[68:71], 0
  v_mfma_f32_16x16x32_bf16 v[24:27], v[8:11], v[72:75], 0
  v_mfma_f32_16x16x32_bf16 v[28:31], v[8:11], v[76:79], 0
  v_mfma_f32_16x16x32_bf16 v[16:19], v[8:11], v[80:83], v[16:19]
  v_mfma_f32_16x16x32_bf16 v[20:23], v[8:11], v[84:87], v[20:23]
  v_mfma_f32_16x16x32_bf16 v[24:27], v[8:11], v[88:91], v[24:27]
  v_mfma_f32_16x16x32_bf16 v[28:31], v[8:11], v[92:95], v[28:31]
  s_nop 5
  v_cndmask_b32 v32, v16, v20, s[62:63]
  s_nop 0
  v_cndmask_b32 v33, v24, v28, s[62:63]
  s_mov_b32 exec_lo, 0xffffffff
  s_mov_b32 exec_hi, 0x0
  buffer_store_dwordx4 v[32:35], v59, s[32:35], s77 offen
  s_mov_b64 exec, -1
  s_cmp_lg_u32 s46, 1
  s_cbranch_scc1 L_slow_74
L_back_75:
  s_barrier
  ds_read_b128 v[8:11], v52 offset:7168
  ds_read_b128 v[12:15], v52 offset:7232
  s_waitcnt lgkmcnt(1)
  v_mfma_f32_16x16x32_bf16 v[16:19], v[8:11], v[64:67], 0
  v_mfma_f32_16x16x32_bf16 v[20:23], v[8:11], v[68:71], 0
  v_mfma_f32_16x16x32_bf16 v[24:27], v[8:11], v[72:75], 0
  v_mfma_f32_16x16x32_bf16 v[28:31], v[8:11], v[76:79], 0
  s_waitcnt lgkmcnt(0)
  v_mfma_f32_16x16x32_bf16 v[16:19], v[12:15], v[80:83], v[16:19]
  v_mfma_f32_16x16x32_bf16 v[20:23], v[12:15], v[84:87], v[20:23]
  v_mfma_f32_16x16x32_bf16 v[24:27], v[12:15], v[88:91], v[24:27]
  v_mfma_f32_16x16x32_bf16 v[28:31], v[12:15], v[92:95], v[28:31]
  s_nop 5
  v_cndmask_b32 v4, v16, v20, s[62:63]
  s_nop 0
  v_cndmask_b32 v5, v24, v28, s[62:63]
  s_mov_b32 exec_lo, 0xffffffff
  s_mov_b32 exec_hi, 0x0
  buffer_store_dwordx4 v[4:7], v59, s[32:35], s76 offen
  s_mov_b64 exec, -1
  s_cmp_lg_u32 s46, 1
  s_cbranch_scc1 L_slow_76
L_back_77:
  s_endpgm
L_post_wo:
  s_cmp_gt_u32 s5, 11
  s_cbranch_scc1 L_end
  s_cmp_eq_u32 s3, 3
  s_cbranch_scc1 L_end
  v_mov_b32 v57, 0
  s_cmp_eq_u32 s3, 1
  s_cbranch_scc1 L_hid
  s_barrier
  s_and_b32 s68, s4, 1
  s_lshl_b32 s68, s68, 2
  s_sub_u32 s68, 12, s68
  s_cmp_ge_u32 s5, s68
  s_cbranch_scc1 L_end
  s_mul_i32 s72, s4, 5
  s_add_u32 s72, s72, 1
  s_lshr_b32 s72, s72, 1
  s_lshr_b32 s68, s5, 2
  s_add_u32 s72, s72, s68
  s_and_b32 s73, s5, 3
  v_lshrrev_b32 v2, 1, v0
  v_lshlrev_b32 v2, 7, v2
  v_and_b32 v3, 1, v0
  v_lshl_add_u32 v96, v3, 4, v2
  s_lshl_b32 s10, s72, 15
  s_lshr_b32 s68, s47, s4
  s_and_b32 s68, s68, 1
  s_lshl_b32 s68, s68, 13
  s_add_u32 s10, s10, s68
  s_lshl_b32 s68, s73, 5
  s_add_u32 s10, s10, s68
  s_add_u32 s10, s10, 1048576
  s_add_u32 s11, s10, 4096
  s_add_u32 s12, s10, 16384
  v_lshrrev_b32 v4, 4, v0
  v_lshl_add_u32 v97, v3, 2, v4
  v_lshlrev_b32 v97, 1, v97
  v_lshlrev_b32 v99, 5, v4
  s_and_b32 s68, s73, 1
  s_lshl_b32 s68, s68, 5
  v_lshl_add_u32 v98, v3, 4, s68
  s_mul_i32 s13, s4, 20
  s_add_u32 s13, s13, s72
  s_lshl_b32 s13, s13, 7
  s_lshr_b32 s68, s73, 1
  s_lshl4_add_u32 s13, s68, s13
  s_add_u32 s13, s13, 2768896
  s_lshl2_add_u32 s14, s72, s73
  s_lshl_b32 s14, s14, 4
  s_mov_b32 s8, 0x30003
  s_mov_b32 s9, 0x30003
  s_mov_b32 s77, 0x3f80
  s_mov_b32 s71, 0x3f800000
  v_mov_b32 v8, 0
  v_mov_b32 v9, 0
  v_mov_b32 v10, 0
  v_mov_b32 v11, 0
  s_mov_b32 s64, s54
  s_mov_b32 s65, s55
  s_mov_b32 s66, 1280
  s_mov_b32 s67, 0x20000
  s_setprio 0
  v_mov_b32 v1, 0
  s_mov_b32 s70, 4000007
L_spin_78:
  ds_read_b32 v4, v1 offset:736
  s_waitcnt lgkmcnt(0)
  v_cmp_gt_u32 vcc, 1, v4
  s_nop 0
  s_cbranch_vccz L_sdone_79
  s_sub_u32 s70, s70, 1
  s_cbranch_scc0 L_spin_78
L_sdone_79:
  s_sleep 16
  s_mov_b32 s16, s32
  s_mov_b32 s17, s33
  s_mov_b32 s18, 4194304
  s_mov_b32 s19, 0x20000
  s_mov_b32 s70, 4000007
L_spin_80:
  buffer_load_dwordx4 v[4:7], v99, s[16:19], s13 offen sc1
  buffer_load_dwordx4 v[16:19], v96, s[24:27], s10 offen sc1
  buffer_load_dwordx4 v[20:23], v96, s[24:27], s11 offen sc1
  buffer_load_dwordx4 v[24:27], v96, s[24:27], s12 offen sc1
  s_waitcnt vmcnt(0)
  v_cmp_ne_u64 vcc, s[30:31], v[6:7]
  v_cmp_ne_u64 s[20:21], s[30:31], v[18:19]
  v_cmp_ne_u64 s[22:23], s[30:31], v[22:23]
  s_or_b64 vcc, vcc, s[20:21]
  v_cmp_ne_u64 s[20:21], s[30:31], v[26:27]
  s_or_b64 vcc, vcc, s[22:23]
  s_or_b64 vcc, vcc, s[20:21]
  s_nop 0
  s_cbranch_vccz L_sdone_81
  s_and_b32 s99, s70, 7
  s_cmp_eq_u32 s46, 1
  s_cselect_b32 s99, 1, s99
  s_cmp_lg_u32 s99, 0
  s_cselect_b32 s16, s32, s24
  s_cselect_b32 s17, s33, s25
  s_sub_u32 s70, s70, 1
  s_cbranch_scc0 L_spin_80
L_sdone_81:
L_finc:
  v_dot2c_f32_bf16 v8, s77, v16
  v_dot2c_f32_bf16 v10, s77, v17
  v_dot2c_f32_bf16 v9, s71, v16
  v_dot2c_f32_bf16 v11, s71, v17
  v_dot2c_f32_bf16 v8, s77, v20
  v_dot2c_f32_bf16 v10, s77, v21
  v_dot2c_f32_bf16 v9, s71, v20
  v_dot2c_f32_bf16 v11, s71, v21
  v_dot2c_f32_bf16 v8, s77, v24
  v_dot2c_f32_bf16 v10, s77, v25
  v_dot2c_f32_bf16 v9, s71, v24
  v_dot2c_f32_bf16 v11, s71, v25
  v_lshrrev_b64 v[58:59], v98, v[4:5]
  v_permlane32_swap_b32 v8, v10
  s_nop 0
  v_permlane32_swap_b32 v9, v11
  v_add_f32 v8, v8, v10
  v_add_f32 v9, v9, v11
  v_lshlrev_b32 v58, 16, v58
  s_nop 0
  v_permlane16_swap_b32 v8, v9
  v_add_f32 v8, v8, v9
  s_nop 1
  v_add_f32_dpp v8, v8, v8 row_ror:8 row_mask:0xf bank_mask:0xf
  s_nop 1
  v_add_f32_dpp v8, v8, v8 row_ror:4 row_mask:0xf bank_mask:0xf
  s_nop 1
  v_add_f32_dpp v8, v8, v8 quad_perm:[2,3,0,1] row_mask:0xf bank_mask:0xf
  v_cvt_pk_bf16_f32 v8, v57, v8
  v_add_f32 v8, v8, v58
  v_cvt_pk_bf16_f32 v8, v8, v8
  s_mov_b64 exec, s[8:9]
  buffer_store_short v8, v97, s[64:67], s14 offen
  s_cmp_lg_u32 s14, 0
  s_cbranch_scc1 L_fin_exit
  s_mov_b64 exec, 1
  v_mov_b32 v4, s30
  v_mov_b32 v5, s31
  s_mov_b32 s68, 917504
  buffer_store_dwordx2 v[4:5], v57, s[24:27], s68 offen
L_fin_exit:
  s_endpgm
L_hid:
  s_mul_i32 s72, s4, 12
  s_add_u32 s72, s72, s5
  v_lshrrev_b32 v4, 5, v0
  v_and_b32 v2, 7, v0
  v_lshl_add_u32 v62, v4, 3, v2
  v_lshlrev_b32 v62, 1, v62
  v_lshlrev_b32 v63, 2, v2
  v_lshlrev_b32 v60, 4, v0
  v_and_b32 v3, 31, v0
  v_lshlrev_b32 v61, 4, v3
  s_lshl_b32 s65, s4, 9
  s_add_u32 s65, s65, 2752512
  s_mul_i32 s60, s72, 3072
  s_add_u32 s62, s60, 3145728
  s_add_u32 s60, s60, 2228224
  s_mov_b32 s8, 0xfffff
  s_mov_b32 s9, 0xfffff
  s_mov_b32 s10, 0xffff
  s_mov_b32 s11, 0xffff
  v_mov_b32 v59, 1
  v_mov_b32 v24, 0
  v_mov_b32 v25, 0
  v_mov_b32 v26, s30
  v_mov_b32 v27, s31
  v_mov_b32 v136, 0
  v_mov_b32 v137, 0
  v_mov_b32 v138, s30
  v_mov_b32 v139, s31
  v_mov_b32 v140, 0
  v_mov_b32 v141, 0
  v_mov_b32 v142, s30
  v_mov_b32 v143, s31
  v_not_b32 v18, s30
  v_not_b32 v22, s30
  v_not_b32 v130, s30
  v_not_b32 v134, s30
  s_mov_b64 exec, s[10:11]
  v_not_b32 v26, s30
  v_not_b32 v138, s30
  s_mov_b64 exec, s[8:9]
  v_not_b32 v142, s30
  s_mov_b64 exec, -1
  s_barrier
  v_cmp_ne_u64 vcc, s[30:31], v[18:19]
  v_cmp_ne_u64 s[20:21], s[30:31], v[22:23]
  v_cmp_ne_u64 s[22:23], s[30:31], v[26:27]
  s_or_b64 vcc, vcc, s[20:21]
  s_or_b64 vcc, vcc, s[22:23]
  s_nop 0
  s_cbranch_vccz L_pok_83
  s_cmp_lg_u32 s46, 1
  s_cbranch_scc1 L_pslow_82
  s_mov_b32 s70, 4000007
L_fp_84:
  buffer_load_dwordx4 v[16:19], v60, s[32:35], s62 offen sc1
  buffer_load_dwordx4 v[20:23], v60, s[32:35], s62 offen offset:1024 sc1
  s_mov_b64 exec, s[10:11]
  buffer_load_dwordx4 v[24:27], v60, s[32:35], s62 offen offset:2048 sc1
  s_mov_b64 exec, -1
  s_mov_b64 exec, s[8:9]
  buffer_load_dwordx4 v[140:143], v61, s[32:35], s65 offen sc1
  s_mov_b64 exec, -1
  buffer_load_dwordx4 v[128:131], v60, s[32:35], s60 offen sc1
  buffer_load_dwordx4 v[132:135], v60, s[32:35], s60 offen offset:1024 sc1
  s_mov_b64 exec, s[10:11]
  buffer_load_dwordx4 v[136:139], v60, s[32:35], s60 offen offset:2048 sc1
  s_mov_b64 exec, -1
  v_cmp_ne_u64 vcc, s[30:31], v[18:19]
  v_cmp_ne_u64 s[20:21], s[30:31], v[22:23]
  v_cmp_ne_u64 s[22:23], s[30:31], v[26:27]
  s_or_b64 vcc, vcc, s[20:21]
  s_or_b64 vcc, vcc, s[22:23]
  s_nop 0
  s_cbranch_vccz L_pok_83
  v_cmp_ne_u64 vcc, s[30:31], v[18:19]
  v_cmp_ne_u64 s[20:21], s[30:31], v[22:23]
  v_cmp_ne_u64 s[22:23], s[30:31], v[26:27]
  s_or_b64 vcc, vcc, s[20:21]
  s_or_b64 vcc, vcc, s[22:23]
  s_nop 0
  s_cbranch_vccz L_pok_83
  v_cmp_ne_u64 vcc, s[30:31], v[18:19]
  v_cmp_ne_u64 s[20:21], s[30:31], v[22:23]
  v_cmp_ne_u64 s[22:23], s[30:31], v[26:27]
  s_or_b64 vcc, vcc, s[20:21]
  s_or_b64 vcc, vcc, s[22:23]
  s_nop 0
  s_cbranch_vccz L_pok_83
  v_cmp_ne_u64 vcc, s[30:31], v[18:19]
  v_cmp_ne_u64 s[20:21], s[30:31], v[22:23]
  v_cmp_ne_u64 s[22:23], s[30:31], v[26:27]
  s_or_b64 vcc, vcc, s[20:21]
  s_or_b64 vcc, vcc, s[22:23]
  s_nop 0
  s_cbranch_vccz L_pok_83
  v_cmp_ne_u64 vcc, s[30:31], v[18:19]
  v_cmp_ne_u64 s[20:21], s[30:31], v[22:23]
  v_cmp_ne_u64 s[22:23], s[30:31], v[26:27]
  s_or_b64 vcc, vcc, s[20:21]
  s_or_b64 vcc, vcc, s[22:23]
  s_nop 0
  s_cbranch_vccz L_pok_83
  v_cmp_ne_u64 vcc, s[30:31], v[18:19]
  v_cmp_ne_u64 s[20:21], s[30:31], v[22:23]
  v_cmp_ne_u64 s[22:23], s[30:31], v[26:27]
  s_or_b64 vcc, vcc, s[20:21]
  s_or_b64 vcc, vcc, s[22:23]
  s_nop 0
  s_cbranch_vccz L_pok_83
  v_cmp_ne_u64 vcc, s[30:31], v[18:19]
  v_cmp_ne_u64 s[20:21], s[30:31], v[22:23]
  v_cmp_ne_u64 s[22:23], s[30:31], v[26:27]
  s_or_b64 vcc, vcc, s[20:21]
  s_or_b64 vcc, vcc, s[22:23]
  s_nop 0
  s_cbranch_vccz L_pok_83
  v_cmp_ne_u64 vcc, s[30:31], v[18:19]
  v_cmp_ne_u64 s[20:21], s[30:31], v[22:23]
  v_cmp_ne_u64 s[22:23], s[30:31], v[26:27]
  s_or_b64 vcc, vcc, s[20:21]
  s_or_b64 vcc, vcc, s[22:23]
  s_nop 0
  s_cbranch_vccz L_pok_83
  s_waitcnt vmcnt(14)
  s_sub_u32 s70, s70, 1
  s_cbranch_scc0 L_fp_84
L_pok_83:
  v_pk_add_f32 v[40:41], v[16:17], v[20:21]
  v_pk_add_f32 v[40:41], v[40:41], v[24:25]
  s_nop 1
  v_add_f32_dpp v40, v40, v40 row_ror:8 row_mask:0xf bank_mask:0xf
  v_add_f32_dpp v41, v41, v41 row_ror:8 row_mask:0xf bank_mask:0xf
  v_mov_b32 v42, v40
  v_mov_b32 v43, v41
  s_nop 0
  v_permlane16_swap_b32 v40, v42
  v_permlane16_swap_b32 v41, v43
  v_add_f32 v40, v40, v42
  v_add_f32 v41, v41, v43
  v_cmp_ne_u64 vcc, s[30:31], v[142:143]
  s_nop 0
  s_cbranch_vccz L_pok_88
  s_cmp_lg_u32 s46, 1
  s_cbranch_scc1 L_pslow_87
  s_mov_b32 s70, 4000007
L_fp_89:
  s_mov_b64 exec, s[8:9]
  buffer_load_dwordx4 v[140:143], v61, s[32:35], s65 offen sc1
  s_mov_b64 exec, -1
  v_cmp_ne_u64 vcc, s[30:31], v[142:143]
  s_nop 0
  s_cbranch_vccz L_pok_88
  v_cmp_ne_u64 vcc, s[30:31], v[142:143]
  s_nop 0
  s_cbranch_vccz L_pok_88
  s_waitcnt vmcnt(12)
  s_sub_u32 s70, s70, 1
  s_cbranch_scc0 L_fp_89
L_pok_88:
  s_cmp_lg_u32 s46, 1
  s_cbranch_scc1 L_nopre
  buffer_load_dwordx4 v[128:131], v60, s[32:35], s60 offen sc1
  buffer_load_dwordx4 v[132:135], v60, s[32:35], s60 offen offset:1024 sc1
  s_mov_b64 exec, s[10:11]
  buffer_load_dwordx4 v[136:139], v60, s[32:35], s60 offen offset:2048 sc1
  s_mov_b64 exec, -1
L_nopre:
  v_add_f32_dpp v36, v140, v140 quad_perm:[1,0,3,2] row_mask:0xf bank_mask:0xf
  v_add_f32_dpp v37, v141, v141 quad_perm:[1,0,3,2] row_mask:0xf bank_mask:0xf
  s_nop 0
  v_add_f32_dpp v36, v36, v36 quad_perm:[2,3,0,1] row_mask:0xf bank_mask:0xf
  v_add_f32_dpp v37, v37, v37 quad_perm:[2,3,0,1] row_mask:0xf bank_mask:0xf
  s_nop 0
  v_add_f32_dpp v36, v36, v36 row_half_mirror row_mask:0xf bank_mask:0xf
  v_add_f32_dpp v37, v37, v37 row_half_mirror row_mask:0xf bank_mask:0xf
  s_nop 0
  v_add_f32_dpp v46, v36, v36 row_mirror row_mask:0xf bank_mask:0xf
  v_add_f32_dpp v47, v37, v37 row_mirror row_mask:0xf bank_mask:0xf
  v_add_f32_dpp v36, v36, v36 row_mirror row_mask:0xf bank_mask:0xf
  v_add_f32_dpp v37, v37, v37 row_mirror row_mask:0xf bank_mask:0xf
  s_nop 0
  v_permlane16_swap_b32 v36, v46
  v_permlane16_swap_b32 v37, v47
  v_pk_add_f32 v[36:37], v[36:37], v[46:47]
  s_cbranch_scc1 L_nopre2
  buffer_load_dwordx4 v[128:131], v60, s[32:35], s60 offen sc1
  buffer_load_dwordx4 v[132:135], v60, s[32:35], s60 offen offset:1024 sc1
  s_mov_b64 exec, s[10:11]
  buffer_load_dwordx4 v[136:139], v60, s[32:35], s60 offen offset:2048 sc1
  s_mov_b64 exec, -1
L_nopre2:
  v_mul_f32 v44, 0x3acccccd, v36
  v_mul_f32 v45, 0x3acccccd, v37
  v_fma_f32 v45, -v44, v44, v45
  v_max_f32 v45, 0, v45
  v_cvt_pk_bf16_f32 v45, v57, v45
  v_cvt_pk_bf16_f32 v44, v57, v44
  v_add_f32 v45, 0x3727c5ac, v45
  v_cvt_pk_bf16_f32 v45, v57, v45
  v_sqrt_f32 v45, v45
  v_mul_f32 v40, v44, v40
  v_cvt_pk_bf16_f32 v45, v57, v45
  v_rcp_f32 v45, v45
  v_mul_f32 v41, v44, v41
  v_cmp_ne_u64 vcc, s[30:31], v[130:131]
  v_cmp_ne_u64 s[20:21], s[30:31], v[134:135]
  v_cmp_ne_u64 s[22:23], s[30:31], v[138:139]
  s_or_b64 vcc, vcc, s[20:21]
  s_or_b64 vcc, vcc, s[22:23]
  s_nop 0
  s_cbranch_vccz L_pok_93
  s_cmp_lg_u32 s46, 1
  s_cbranch_scc1 L_pslow_92
  s_mov_b32 s70, 4000007
L_fp_94:
  buffer_load_dwordx4 v[128:131], v60, s[32:35], s60 offen sc1
  buffer_load_dwordx4 v[132:135], v60, s[32:35], s60 offen offset:1024 sc1
  s_mov_b64 exec, s[10:11]
  buffer_load_dwordx4 v[136:139], v60, s[32:35], s60 offen offset:2048 sc1
  s_mov_b64 exec, -1
  v_cmp_ne_u64 vcc, s[30:31], v[130:131]
  v_cmp_ne_u64 s[20:21], s[30:31], v[134:135]
  v_cmp_ne_u64 s[22:23], s[30:31], v[138:139]
  s_or_b64 vcc, vcc, s[20:21]
  s_or_b64 vcc, vcc, s[22:23]
  s_nop 0
  s_cbranch_vccz L_pok_93
  s_waitcnt vmcnt(12)
  s_sub_u32 s70, s70, 1
  s_cbranch_scc0 L_fp_94
L_pok_93:
L_hidc:
  v_pk_add_f32 v[8:9], v[128:129], v[132:133]
  v_pk_add_f32 v[8:9], v[8:9], v[136:137]
  s_nop 1
  v_add_f32_dpp v10, v8, v8 row_ror:8 row_mask:0xf bank_mask:0xf
  v_add_f32_dpp v11, v9, v9 row_ror:8 row_mask:0xf bank_mask:0xf
  v_add_f32_dpp v8, v8, v8 row_ror:8 row_mask:0xf bank_mask:0xf
  v_add_f32_dpp v9, v9, v9 row_ror:8 row_mask:0xf bank_mask:0xf
  s_nop 0
  v_permlane16_swap_b32 v8, v10
  v_permlane16_swap_b32 v9, v11
  v_add_f32 v8, v8, v10
  v_sub_f32 v8, v8, v40
  v_mul_f32 v8, v8, v45
  v_cvt_pk_bf16_f32 v8, v57, v8
  v_mul_f32 v12, 0xbfb8aa3b, v8
  v_exp_f32 v12, v12
  v_add_f32 v9, v9, v11
  v_add_f32 v12, 1.0, v12
  v_rcp_f32 v12, v12
  v_sub_f32 v9, v9, v41
  v_mul_f32 v9, v9, v45
  v_mul_f32 v8, v8, v12
  v_cvt_pk_bf16_f32 v9, v57, v9
  v_cvt_pk_bf16_f32 v8, v57, v8
  v_mul_f32 v8, v8, v9
  v_cvt_pk_bf16_f32 v8, v8, v8
  ds_write_b16 v62, v8 offset:704
  ds_write_b32 v63, v59 offset:736
  s_endpgm
L_f2:
  s_mov_b32 s8, s52
  s_mov_b32 s9, s53
  s_mov_b32 s10, 1966080
  s_mov_b32 s11, 0x20000
  v_mov_b32 v17, 0
  s_mov_b32 s70, 4000007
L_spin_97:
  ds_read_b32 v16, v17 offset:660
  s_waitcnt lgkmcnt(0)
  v_cmp_gt_u32 vcc, 1, v16
  s_nop 0
  s_cbranch_vccz L_sdone_98
  s_sleep 1
  s_sub_u32 s70, s70, 1
  s_cbranch_scc0 L_spin_97
L_sdone_98:
  v_readfirstlane_b32 s47, v16
  s_mul_i32 s72, s4, 12
  s_add_u32 s72, s72, s5
  v_mov_b32 v57, 0
  s_sub_u32 s68, s3, 7
  s_lshl_b32 s69, s68, 8
  v_lshlrev_b32 v58, 2, v0
  v_add_u32 v58, s69, v58
  v_lshrrev_b32 v2, 4, v0
  v_lshl_add_u32 v2, s68, 2, v2
  v_mul_u32_u24 v3, 52, v2
  v_lshrrev_b32 v3, 8, v3
  v_mul_u32_u24 v4, 5, v3
  v_sub_u32 v4, v2, v4
  v_cmp_lt_u32 vcc, 2, v4
  v_lshlrev_b32 v3, 1, v3
  s_nop 0
  v_addc_co_u32 v3, vcc, 0, v3, vcc
  v_lshrrev_b32 v3, v3, s47
  v_and_b32 v3, 1, v3
  v_lshlrev_b32 v116, 15, v2
  v_lshl_add_u32 v116, v3, 13, v116
  v_bfe_u32 v3, v0, 1, 3
  v_lshl_add_u32 v116, v3, 4, v116
  s_lshr_b32 s79, s72, 6
  s_lshl_b32 s79, s79, 14
  s_and_b32 s68, s72, 63
  s_lshl_b32 s68, s68, 7
  s_add_u32 s79, s79, s68
  s_add_u32 s79, s79, 1048576
  s_mov_b32 s60, 0x05040100
  s_mov_b32 s61, 0x07060302
  s_mul_i32 s62, s72, 20480
  v_lshrrev_b32 v2, 4, v0
  v_mul_u32_u24 v2, 1280, v2
  v_and_b32 v3, 15, v0
  v_lshl_add_u32 v2, v3, 4, v2
  s_add_u32 s62, s62, s69
  s_lshl_b32 s63, s69, 4
  v_lshlrev_b32 v3, 2, v0
  v_add_u32 v3, s63, v3
  s_add_u32 s63, s63, 8704
  s_barrier
  s_add_u32 m0, s63, 0
  s_nop 0
  buffer_load_dwordx4 v2, s[8:11], s62 offen nt lds
  s_add_u32 s62, s62, 5120
  s_add_u32 m0, s63, 1024
  s_nop 0
  buffer_load_dwordx4 v2, s[8:11], s62 offen nt lds
  s_add_u32 s62, s62, 5120
  s_add_u32 m0, s63, 2048
  s_nop 0
  buffer_load_dwordx4 v2, s[8:11], s62 offen nt lds
  s_add_u32 s62, s62, 5120
  s_add_u32 m0, s63, 3072
  s_nop 0
  buffer_load_dwordx4 v2, s[8:11], s62 offen nt lds
  s_add_u32 s62, s62, 5120
  s_barrier
  s_waitcnt vmcnt(0)
  ds_read_b32 v64, v3 offset:8704
  ds_read_b32 v65, v3 offset:8960
  ds_read_b32 v66, v3 offset:9216
  ds_read_b32 v67, v3 offset:9472
  ds_read_b32 v68, v3 offset:9728
  ds_read_b32 v69, v3 offset:9984
  ds_read_b32 v70, v3 offset:10240
  ds_read_b32 v71, v3 offset:10496
  ds_read_b32 v72, v3 offset:10752
  ds_read_b32 v73, v3 offset:11008
  ds_read_b32 v74, v3 offset:11264
  ds_read_b32 v75, v3 offset:11520
  ds_read_b32 v76, v3 offset:11776
  ds_read_b32 v77, v3 offset:12032
  ds_read_b32 v78, v3 offset:12288
  ds_read_b32 v79, v3 offset:12544
  s_waitcnt lgkmcnt(0)
  v_perm_b32 v80, v65, v64, s60
  v_perm_b32 v88, v65, v64, s61
  v_perm_b32 v81, v67, v66, s60
  v_perm_b32 v89, v67, v66, s61
  v_perm_b32 v82, v69, v68, s60
  v_perm_b32 v90, v69, v68, s61
  v_perm_b32 v83, v71, v70, s60
  v_perm_b32 v91, v71, v70, s61
  v_perm_b32 v84, v73, v72, s60
  v_perm_b32 v92, v73, v72, s61
  v_perm_b32 v85, v75, v74, s60
  v_perm_b32 v93, v75, v74, s61
  v_perm_b32 v86, v77, v76, s60
  v_perm_b32 v94, v77, v76, s61
  v_perm_b32 v87, v79, v78, s60
  v_perm_b32 v95, v79, v78, s61
  v_mov_b32 v16, 0
  v_mov_b32 v17, 0
  v_mov_b32 v18, 0
  v_mov_b32 v19, 0
  s_mov_b32 s66, 0x55555555
  s_mov_b32 s67, 0x55555555
  v_mov_b32 v6, s30
  v_mov_b32 v7, s31
  v_and_b32 v9, 15, v0
  v_lshlrev_b32 v9, 2, v9
  v_mov_b32 v8, 0
  s_mov_b32 s64, 0xff00ff00
  s_mov_b32 s65, 0xff00ff00
  s_mov_b32 s70, 32000056
  s_waitcnt lgkmcnt(0)
L_f2poll:
  ds_read_b32 v8, v9 offset:704
  s_waitcnt lgkmcnt(4)
  v_cmp_eq_u32 vcc, 0, v8
  s_sub_u32 s70, s70, 1
  s_cbranch_scc1 L_f2go
  s_and_b64 vcc, vcc, s[64:65]
  s_cbranch_scc1 L_f2poll
L_f2go:
  v_dot2c_f32_bf16_dpp v16, v8, v80 row_newbcast:0 row_mask:0xf bank_mask:0xf
  v_dot2c_f32_bf16_dpp v17, v8, v88 row_newbcast:0 row_mask:0xf bank_mask:0xf
  v_dot2c_f32_bf16_dpp v18, v8, v81 row_newbcast:1 row_mask:0xf bank_mask:0xf
  v_dot2c_f32_bf16_dpp v19, v8, v89 row_newbcast:1 row_mask:0xf bank_mask:0xf
  v_dot2c_f32_bf16_dpp v16, v8, v82 row_newbcast:2 row_mask:0xf bank_mask:0xf
  v_dot2c_f32_bf16_dpp v17, v8, v90 row_newbcast:2 row_mask:0xf bank_mask:0xf
  v_dot2c_f32_bf16_dpp v18, v8, v83 row_newbcast:3 row_mask:0xf bank_mask:0xf
  v_dot2c_f32_bf16_dpp v19, v8, v91 row_newbcast:3 row_mask:0xf bank_mask:0xf
  v_dot2c_f32_bf16_dpp v16, v8, v84 row_newbcast:4 row_mask:0xf bank_mask:0xf
  v_dot2c_f32_bf16_dpp v17, v8, v92 row_newbcast:4 row_mask:0xf bank_mask:0xf
  v_dot2c_f32_bf16_dpp v18, v8, v85 row_newbcast:5 row_mask:0xf bank_mask:0xf
  v_dot2c_f32_bf16_dpp v19, v8, v93 row_newbcast:5 row_mask:0xf bank_mask:0xf
  v_dot2c_f32_bf16_dpp v16, v8, v86 row_newbcast:6 row_mask:0xf bank_mask:0xf
  v_dot2c_f32_bf16_dpp v17, v8, v94 row_newbcast:6 row_mask:0xf bank_mask:0xf
  v_dot2c_f32_bf16_dpp v18, v8, v87 row_newbcast:7 row_mask:0xf bank_mask:0xf
  v_dot2c_f32_bf16_dpp v19, v8, v95 row_newbcast:7 row_mask:0xf bank_mask:0xf
  s_nop 2
  v_pk_add_f32 v[16:17], v[16:17], v[18:19]
  v_cvt_pk_bf16_f32 v4, v16, v17
  s_nop 1
  v_mov_b32_dpp v5, v4 quad_perm:[1,0,3,2] row_mask:0xf bank_mask:0xf
  s_mov_b64 exec, s[66:67]
  buffer_store_dwordx4 v[4:7], v116, s[24:27], s79 offen sc1
L_end:
  s_endpgm
L_dry:
  s_endpgm
L_slow_25:
  s_mov_b32 exec_lo, 0xffffffff
  s_mov_b32 exec_hi, 0xffff
  buffer_store_dwordx4 v[4:7], v13, s[24:27], s74 offen sc1
  s_mov_b64 exec, -1
  s_nop 1
  s_branch L_back_26
L_slow_32:
  s_mov_b32 exec_lo, 0x55555555
  s_mov_b32 exec_hi, 0x0
  buffer_store_dwordx4 v[8:11], v2, s[24:27], s66 offen offset:1536 sc1
  s_mov_b64 exec, -1
  s_nop 1
  s_branch L_back_33
L_slow_46:
  s_mov_b32 exec_lo, 0x101
  s_mov_b32 exec_hi, 0x0
  buffer_store_dwordx4 v[2:5], v12, s[24:27], s68 offen sc1
  s_mov_b64 exec, -1
  s_nop 1
  s_branch L_back_47
L_slow_54:
  s_mov_b32 exec_lo, 0xffffffff
  s_mov_b32 exec_hi, 0xffff
  buffer_store_dwordx4 v[4:7], v13, s[24:27], s74 offen sc1
  s_mov_b64 exec, -1
  s_nop 1
  s_branch L_back_55
L_slow_72:
  s_mov_b32 exec_lo, 0x1
  s_mov_b32 exec_hi, 0x0
  buffer_store_dwordx4 v[4:7], v55, s[24:27], s72 offen sc1
  s_mov_b32 exec_lo, 0x110011
  s_mov_b32 exec_hi, 0x110011
  buffer_store_dwordx4 v[12:15], v54, s[24:27], s75 offen sc1
  s_mov_b64 exec, -1
  s_nop 1
  s_branch L_back_73
L_slow_74:
  s_mov_b32 exec_lo, 0xffffffff
  s_mov_b32 exec_hi, 0x0
  buffer_store_dwordx4 v[32:35], v59, s[24:27], s77 offen sc1
  s_mov_b64 exec, -1
  s_nop 1
  s_branch L_back_75
L_slow_76:
  s_mov_b32 exec_lo, 0xffffffff
  s_mov_b32 exec_hi, 0x0
  buffer_store_dwordx4 v[4:7], v59, s[24:27], s76 offen sc1
  s_mov_b64 exec, -1
  s_nop 1
  s_branch L_back_77
L_pslow_82:
  s_mov_b32 s16, s32
  s_mov_b32 s17, s33
  s_mov_b32 s18, 4194304
  s_mov_b32 s19, 0x20000
  s_mov_b32 s70, 4000007
L_spin_85:
  buffer_load_dwordx4 v[16:19], v60, s[16:19], s62 offen sc1
  buffer_load_dwordx4 v[20:23], v60, s[16:19], s62 offen offset:1024 sc1
  s_mov_b64 exec, s[10:11]
  buffer_load_dwordx4 v[24:27], v60, s[16:19], s62 offen offset:2048 sc1
  s_mov_b64 exec, -1
  s_mov_b64 exec, s[8:9]
  buffer_load_dwordx4 v[140:143], v61, s[16:19], s65 offen sc1
  s_mov_b64 exec, -1
  buffer_load_dwordx4 v[128:131], v60, s[16:19], s60 offen sc1
  buffer_load_dwordx4 v[132:135], v60, s[16:19], s60 offen offset:1024 sc1
  s_mov_b64 exec, s[10:11]
  buffer_load_dwordx4 v[136:139], v60, s[16:19], s60 offen offset:2048 sc1
  s_mov_b64 exec, -1
  s_waitcnt vmcnt(0)
  v_cmp_ne_u64 vcc, s[30:31], v[18:19]
  v_cmp_ne_u64 s[20:21], s[30:31], v[22:23]
  v_cmp_ne_u64 s[22:23], s[30:31], v[26:27]
  s_or_b64 vcc, vcc, s[20:21]
  s_or_b64 vcc, vcc, s[22:23]
  s_nop 0
  s_cbranch_vccz L_sdone_86
  s_and_b32 s99, s70, 7
  s_cmp_eq_u32 s46, 1
  s_cselect_b32 s99, 1, s99
  s_cmp_lg_u32 s99, 0
  s_cselect_b32 s16, s32, s24
  s_cselect_b32 s17, s33, s25
  s_sub_u32 s70, s70, 1
  s_cbranch_scc0 L_spin_85
L_sdone_86:
  s_branch L_pok_83
L_pslow_87:
  s_mov_b32 s16, s32
  s_mov_b32 s17, s33
  s_mov_b32 s18, 4194304
  s_mov_b32 s19, 0x20000
  s_mov_b32 s70, 4000007
L_spin_90:
  s_mov_b64 exec, s[8:9]
  buffer_load_dwordx4 v[140:143], v61, s[16:19], s65 offen sc1
  s_mov_b64 exec, -1
  s_waitcnt vmcnt(0)
  v_cmp_ne_u64 vcc, s[30:31], v[142:143]
  s_nop 0
  s_cbranch_vccz L_sdone_91
  s_and_b32 s99, s70, 7
  s_cmp_eq_u32 s46, 1
  s_cselect_b32 s99, 1, s99
  s_cmp_lg_u32 s99, 0
  s_cselect_b32 s16, s32, s24
  s_cselect_b32 s17, s33, s25
  s_sub_u32 s70, s70, 1
  s_cbranch_scc0 L_spin_90
L_sdone_91:
  s_branch L_pok_88
L_pslow_92:
  s_mov_b32 s16, s32
  s_mov_b32 s17, s33
  s_mov_b32 s18, 4194304
  s_mov_b32 s19, 0x20000
  s_mov_b32 s70, 4000007
L_spin_95:
  buffer_load_dwordx4 v[128:131], v60, s[16:19], s60 offen sc1
  buffer_load_dwordx4 v[132:135], v60, s[16:19], s60 offen offset:1024 sc1
  s_mov_b64 exec, s[10:11]
  buffer_load_dwordx4 v[136:139], v60, s[16:19], s60 offen offset:2048 sc1
  s_mov_b64 exec, -1
  s_waitcnt vmcnt(0)
  v_cmp_ne_u64 vcc, s[30:31], v[130:131]
  v_cmp_ne_u64 s[20:21], s[30:31], v[134:135]
  v_cmp_ne_u64 s[22:23], s[30:31], v[138:139]
  s_or_b64 vcc, vcc, s[20:21]
  s_or_b64 vcc, vcc, s[22:23]
  s_nop 0
  s_cbranch_vccz L_sdone_96
  s_and_b32 s99, s70, 7
  s_cmp_eq_u32 s46, 1
  s_cselect_b32 s99, 1, s99
  s_cmp_lg_u32 s99, 0
  s_cselect_b32 s16, s32, s24
  s_cselect_b32 s17, s33, s25
  s_sub_u32 s70, s70, 1
  s_cbranch_scc0 L_spin_95
L_sdone_96:
  s_branch L_pok_93
L_codeend:
.section .rodata,"a"
.p2align 6
.amdhsa_kernel sequential_preLN__sliding_block_cached__glu_gated_swiglu__decode_kernel
  .amdhsa_next_free_vgpr 168
  .amdhsa_next_free_sgpr 100
  .amdhsa_accum_offset 168
  .amdhsa_group_segment_fixed_size 0
  .amdhsa_kernarg_size 96
  .amdhsa_user_sgpr_count 2
  .amdhsa_user_sgpr_kernarg_segment_ptr 1
  .amdhsa_system_sgpr_workgroup_id_x 1
.end_amdhsa_kernel
```

```asm
; @launch grid=(256,1,1) block=(768,1,1) lds=64000
.amdgcn_target "amdgcn-amd-amdhsa--gfx950"
.text
.globl sequential_preLN__sliding_block_cached__glu_gated_swiglu__decode_kernel
.p2align 8
.type sequential_preLN__sliding_block_cached__glu_gated_swiglu__decode_kernel,@function
sequential_preLN__sliding_block_cached__glu_gated_swiglu__decode_kernel:
  s_load_dwordx2 s[8:9], s[0:1], 8
  v_readfirstlane_b32 s3, v0
  s_lshr_b32 s79, s2, 6
  s_cmp_gt_u32 s79, 3
  s_cbranch_scc1 L_end
  s_lshr_b32 s3, s3, 6
  s_cmp_gt_u32 s3, 3
  s_cbranch_scc1 L_str
  s_getpc_b64 s[20:21]
L_pc0:
  v_lshlrev_b32 v8, 7, v0
  v_min_u32 v8, L_codeend-L_pc0-4, v8
  global_load_dword v166, v8, s[20:21]
  s_branch L_helper0
L_str:
  s_and_b32 s4, s2, 7
  s_lshr_b32 s6, s2, 7
  s_bfe_u32 s7, s2, 0x40003
  s_lshl1_add_u32 s6, s4, s6
  s_lshl_b32 s6, s6, 10
  s_lshl1_add_u32 s64, s7, s6
  s_addk_i32 s64, 17279
  s_mulk_i32 s64, 12288
  v_lshlrev_b32 v3, 4, v0
  v_lshrrev_b32 v2, 3, v0
  v_lshl_add_u32 v1, v2, 8, v3
  s_lshl_b32 s10, 3, 27
  s_mov_b32 s11, 0x20000
  s_waitcnt lgkmcnt(0)
  buffer_load_dwordx4 v[64:67], v1, s[8:11], s64 offen offset:0 nt
  buffer_load_dwordx4 v[68:71], v1, s[8:11], s64 offen offset:128 nt
  buffer_load_dwordx4 v[72:75], v1, s[8:11], s64 offen offset:256 nt
  s_branch L_stream0
L_helper0:
  s_load_dwordx16 s[36:51], s[0:1], 0
  s_load_dwordx8 s[52:59], s[0:1], 64
  s_and_b32 s4, s2, 7
  s_lshl2_add_u32 s6, s4, s79
  s_bfe_u32 s7, s2, 0x30003
  v_and_b32 v0, 63, v0
  s_cmp_lg_u32 s3, 3
  s_cbranch_scc0 L_w3
  v_lshrrev_b32 v2, 3, v0
  v_mul_u32_u24 v2, 12160, v2
  v_lshl_add_u32 v2, v0, 4, v2
  s_mul_i32 s68, s7, 7680
  s_lshr_b32 s69, s79, 1
  s_mul_i32 s69, s69, 14
  s_add_u32 s69, s69, s79
  s_lshl1_add_u32 s69, s4, s69
  s_add_u32 s69, s69, 0
  s_mul_i32 s69, s69, 3
  s_add_u32 s68, s68, s69
  s_add_u32 s68, s68, s3
  s_lshl_b32 s68, s68, 7
  s_lshl_b32 s69, 3, 15
  s_mov_b32 s10, 7864320
  s_mov_b32 s11, 0x20000
  s_waitcnt lgkmcnt(0)
  s_mov_b64 s[8:9], s[42:43]
  buffer_load_dwordx4 v[24:27], v2, s[8:11], s68 offen nt
  s_add_u32 s68, s68, s69
  buffer_load_dwordx4 v[28:31], v2, s[8:11], s68 offen nt
  s_add_u32 s68, s68, s69
  buffer_load_dwordx4 v[32:35], v2, s[8:11], s68 offen nt
  s_add_u32 s68, s68, s69
  buffer_load_dwordx4 v[36:39], v2, s[8:11], s68 offen nt
  s_add_u32 s68, s68, s69
  buffer_load_dwordx4 v[40:43], v2, s[8:11], s68 offen nt
  s_add_u32 s68, s68, s69
  buffer_load_dwordx4 v[44:47], v2, s[8:11], s68 offen nt
  s_add_u32 s68, s68, s69
  buffer_load_dwordx4 v[48:51], v2, s[8:11], s68 offen nt
  s_add_u32 s68, s68, s69
  buffer_load_dwordx4 v[52:55], v2, s[8:11], s68 offen nt
  s_add_u32 s68, s68, s69
  buffer_load_dwordx4 v[56:59], v2, s[8:11], s68 offen nt
  s_add_u32 s68, s68, s69
  buffer_load_dwordx4 v[60:63], v2, s[8:11], s68 offen nt
  s_branch L_helper
L_w3:
  v_lshlrev_b32 v1, 3, v0
  v_mov_b32 v4, 0
  v_mov_b32 v5, 0
  ds_write_b64 v1, v[4:5] offset:384
  s_waitcnt lgkmcnt(0)
  s_memrealtime s[62:63]
  s_barrier
  s_load_dwordx2 s[28:29], s[58:59], 917504
  s_branch L_ids
L_stream0:
  s_load_dwordx16 s[36:51], s[0:1], 0
  s_load_dwordx8 s[52:59], s[0:1], 64
  v_and_b32 v0, 63, v0
  s_sub_u32 s73, s3, 4
  v_and_b32 v3, 0x70, v3
  s_lshl2_add_u32 s6, s4, s79
  s_and_b32 s7, s7, 7
  s_add_u32 s65, s64, 393216
  s_waitcnt lgkmcnt(0)
  s_barrier
  s_waitcnt vmcnt(2)
  buffer_load_dwordx4 v[76:79], v1, s[8:11], s65 offen offset:0 nt
  s_load_dwordx2 s[28:29], s[58:59], 917504
  s_mov_b32 s24, s58
  s_mov_b32 s25, s59
  s_mov_b32 s26, 4194304
  s_mov_b32 s27, 0x20000
  s_add_u32 s32, s58, 4194304
  s_addc_u32 s33, s59, 0
  s_mov_b32 s34, 4194304
  s_mov_b32 s35, 0x20000
  s_lshl3_add_u32 s71, s6, s7
  s_mul_i32 s5, s79, 5
  s_mul_i32 s47, s79, 3
  s_add_u32 s47, s47, 15
  s_cmp_lt_u32 s7, 5
  s_cselect_b32 s5, s5, s47
  s_add_u32 s5, s5, s7
  s_mov_b32 s12, s40
  s_mov_b32 s13, s41
  s_mov_b32 s14, 402653184
  s_mov_b32 s15, 0x20000
  s_waitcnt vmcnt(2)
  buffer_load_dwordx4 v[80:83], v1, s[8:11], s65 offen offset:128 nt
  s_waitcnt vmcnt(2)
  buffer_load_dwordx4 v[84:87], v1, s[8:11], s65 offen offset:256 nt
  s_add_u32 s66, s65, 393216
  s_waitcnt vmcnt(2)
  buffer_load_dwordx4 v[88:91], v1, s[8:11], s66 offen offset:0 nt
  s_waitcnt vmcnt(2)
  buffer_load_dwordx4 v[92:95], v1, s[8:11], s66 offen offset:128 nt
  s_waitcnt vmcnt(2)
  buffer_load_dwordx4 v[96:99], v1, s[8:11], s66 offen offset:256 nt
  s_add_u32 s67, s66, 393216
  s_waitcnt vmcnt(2)
  buffer_load_dwordx4 v[100:103], v1, s[8:11], s67 offen offset:0 nt
  s_waitcnt vmcnt(2)
  buffer_load_dwordx4 v[104:107], v1, s[8:11], s67 offen offset:128 nt
  s_waitcnt vmcnt(2)
  buffer_load_dwordx4 v[108:111], v1, s[8:11], s67 offen offset:256 nt
  s_add_u32 s60, s67, 4092461056
  s_waitcnt vmcnt(2)
  buffer_load_dwordx4 v[16:19], v1, s[8:11], s60 offen offset:0 nt
  s_waitcnt vmcnt(2)
  buffer_load_dwordx4 v[20:23], v1, s[8:11], s60 offen offset:128 nt
  s_waitcnt vmcnt(2)
  buffer_load_dwordx4 v[24:27], v1, s[8:11], s60 offen offset:256 nt
  s_add_u32 s61, s60, 393216
  s_waitcnt vmcnt(2)
  buffer_load_dwordx4 v[28:31], v1, s[8:11], s61 offen offset:0 nt
  s_waitcnt vmcnt(2)
  buffer_load_dwordx4 v[32:35], v1, s[8:11], s61 offen offset:128 nt
  s_waitcnt vmcnt(2)
  buffer_load_dwordx4 v[36:39], v1, s[8:11], s61 offen offset:256 nt
  s_memrealtime s[76:77]
  s_waitcnt lgkmcnt(0)
  v_mov_b32 v6, 0
  v_mov_b32 v8, s76
  v_mov_b32 v9, 1
  s_mov_b64 exec, 1
  ds_add_u32 v6, v8 offset:696
  ds_add_u32 v6, v9 offset:700
  s_mov_b64 exec, -1
  s_add_u32 s62, s61, 393216
  s_waitcnt vmcnt(2)
  buffer_load_dwordx4 v[40:43], v1, s[8:11], s62 offen offset:0 nt
  s_waitcnt vmcnt(2)
  buffer_load_dwordx4 v[44:47], v1, s[8:11], s62 offen offset:128 nt
  s_waitcnt vmcnt(2)
  buffer_load_dwordx4 v[48:51], v1, s[8:11], s62 offen offset:256 nt
  s_add_u32 s63, s62, 393216
  s_waitcnt vmcnt(2)
  buffer_load_dwordx4 v[52:55], v1, s[8:11], s63 offen offset:0 nt
  s_waitcnt vmcnt(2)
  buffer_load_dwordx4 v[56:59], v1, s[8:11], s63 offen offset:128 nt
  s_waitcnt vmcnt(2)
  buffer_load_dwordx4 v[60:63], v1, s[8:11], s63 offen offset:256 nt
  s_waitcnt vmcnt(2)
  buffer_load_dwordx4 v[112:115], v1, s[12:15], s60 offen offset:0 nt
  s_waitcnt vmcnt(2)
  buffer_load_dwordx4 v[116:119], v1, s[12:15], s60 offen offset:128 nt
  s_waitcnt vmcnt(2)
  buffer_load_dwordx4 v[120:123], v1, s[12:15], s60 offen offset:256 nt
  v_mov_b32 v6, 0
  v_mov_b32 v7, 1
  s_mov_b64 exec, 1
  ds_add_u32 v6, v7 offset:692
  s_mov_b64 exec, -1
  s_waitcnt lgkmcnt(0)
  s_mul_i32 s30, s28, 0x2c9277b5
  s_add_u32 s30, s30, 0xac564b05
  s_mul_i32 s31, s29, 0x0019660d
  s_add_u32 s31, s31, 0x3c6ef35f
  v_and_b32 v2, 3, v0
  v_min_u32 v2, 2, v2
  v_lshlrev_b32 v2, 3, v2
  s_mov_b32 s70, 4000007
L_spin_1:
  ds_read_b32 v4, v2 offset:384
  s_waitcnt lgkmcnt(0)
  v_cmp_eq_u32 vcc, 0, v4
  s_nop 0
  s_cbranch_vccz L_sdone_2
  s_sleep 1
  s_sub_u32 s70, s70, 1
  s_cbranch_scc0 L_spin_1
L_sdone_2:
  ds_read_b128 v[4:7], v3 offset:0
  ds_read_b128 v[8:11], v3 offset:128
  ds_read_b128 v[12:15], v3 offset:256
  ds_read_b128 v[148:151], v3 offset:8192
  ds_read_b128 v[152:155], v3 offset:8320
  ds_read_b128 v[156:159], v3 offset:8448
  v_mov_b32 v160, 0
  v_mov_b32 v161, 0
  v_mov_b32 v162, 0
  v_mov_b32 v163, 0
  v_mov_b32 v164, 0
  v_mov_b32 v165, 0
  v_mov_b32 v166, 0
  v_mov_b32 v167, 0
  s_waitcnt vmcnt(3) lgkmcnt(0)
  v_dot2c_f32_bf16 v160, v16, v4
  v_dot2c_f32_bf16 v161, v28, v4
  v_dot2c_f32_bf16 v162, v40, v4
  v_dot2c_f32_bf16 v163, v52, v4
  v_dot2c_f32_bf16 v160, v17, v5
  v_dot2c_f32_bf16 v161, v29, v5
  v_dot2c_f32_bf16 v162, v41, v5
  v_dot2c_f32_bf16 v163, v53, v5
  v_dot2c_f32_bf16 v160, v18, v6
  v_dot2c_f32_bf16 v161, v30, v6
  v_dot2c_f32_bf16 v162, v42, v6
  v_dot2c_f32_bf16 v163, v54, v6
  v_dot2c_f32_bf16 v160, v19, v7
  v_dot2c_f32_bf16 v161, v31, v7
  v_dot2c_f32_bf16 v162, v43, v7
  v_dot2c_f32_bf16 v163, v55, v7
  v_dot2c_f32_bf16 v160, v20, v8
  v_dot2c_f32_bf16 v161, v32, v8
  v_dot2c_f32_bf16 v162, v44, v8
  v_dot2c_f32_bf16 v163, v56, v8
  v_dot2c_f32_bf16 v160, v21, v9
  v_dot2c_f32_bf16 v161, v33, v9
  v_dot2c_f32_bf16 v162, v45, v9
  v_dot2c_f32_bf16 v163, v57, v9
  v_dot2c_f32_bf16 v160, v22, v10
  v_dot2c_f32_bf16 v161, v34, v10
  v_dot2c_f32_bf16 v162, v46, v10
  v_dot2c_f32_bf16 v163, v58, v10
  v_dot2c_f32_bf16 v160, v23, v11
  v_dot2c_f32_bf16 v161, v35, v11
  v_dot2c_f32_bf16 v162, v47, v11
  v_dot2c_f32_bf16 v163, v59, v11
  v_dot2c_f32_bf16 v160, v24, v12
  v_dot2c_f32_bf16 v161, v36, v12
  v_dot2c_f32_bf16 v162, v48, v12
  v_dot2c_f32_bf16 v163, v60, v12
  v_dot2c_f32_bf16 v160, v25, v13
  v_dot2c_f32_bf16 v161, v37, v13
  v_dot2c_f32_bf16 v162, v49, v13
  v_dot2c_f32_bf16 v163, v61, v13
  v_dot2c_f32_bf16 v160, v26, v14
  v_dot2c_f32_bf16 v161, v38, v14
  v_dot2c_f32_bf16 v162, v50, v14
  v_dot2c_f32_bf16 v163, v62, v14
  v_dot2c_f32_bf16 v160, v27, v15
  v_dot2c_f32_bf16 v161, v39, v15
  v_dot2c_f32_bf16 v162, v51, v15
  v_dot2c_f32_bf16 v163, v63, v15
  v_dot2c_f32_bf16 v164, v64, v148
  v_dot2c_f32_bf16 v165, v76, v148
  v_dot2c_f32_bf16 v166, v88, v148
  v_dot2c_f32_bf16 v167, v100, v148
  v_dot2c_f32_bf16 v164, v65, v149
  v_dot2c_f32_bf16 v165, v77, v149
  v_dot2c_f32_bf16 v166, v89, v149
  v_dot2c_f32_bf16 v167, v101, v149
  v_dot2c_f32_bf16 v164, v66, v150
  v_dot2c_f32_bf16 v165, v78, v150
  v_dot2c_f32_bf16 v166, v90, v150
  v_dot2c_f32_bf16 v167, v102, v150
  v_dot2c_f32_bf16 v164, v67, v151
  v_dot2c_f32_bf16 v165, v79, v151
  v_dot2c_f32_bf16 v166, v91, v151
  v_dot2c_f32_bf16 v167, v103, v151
  v_dot2c_f32_bf16 v164, v68, v152
  v_dot2c_f32_bf16 v165, v80, v152
  v_dot2c_f32_bf16 v166, v92, v152
  v_dot2c_f32_bf16 v167, v104, v152
  v_dot2c_f32_bf16 v164, v69, v153
  v_dot2c_f32_bf16 v165, v81, v153
  v_dot2c_f32_bf16 v166, v93, v153
  v_dot2c_f32_bf16 v167, v105, v153
  v_dot2c_f32_bf16 v164, v70, v154
  v_dot2c_f32_bf16 v165, v82, v154
  v_dot2c_f32_bf16 v166, v94, v154
  v_dot2c_f32_bf16 v167, v106, v154
  v_dot2c_f32_bf16 v164, v71, v155
  v_dot2c_f32_bf16 v165, v83, v155
  v_dot2c_f32_bf16 v166, v95, v155
  v_dot2c_f32_bf16 v167, v107, v155
  v_dot2c_f32_bf16 v164, v72, v156
  v_dot2c_f32_bf16 v165, v84, v156
  v_dot2c_f32_bf16 v166, v96, v156
  v_dot2c_f32_bf16 v167, v108, v156
  v_dot2c_f32_bf16 v164, v73, v157
  v_dot2c_f32_bf16 v165, v85, v157
  v_dot2c_f32_bf16 v166, v97, v157
  v_dot2c_f32_bf16 v167, v109, v157
  v_dot2c_f32_bf16 v164, v74, v158
  v_dot2c_f32_bf16 v165, v86, v158
  v_dot2c_f32_bf16 v166, v98, v158
  v_dot2c_f32_bf16 v167, v110, v158
  v_dot2c_f32_bf16 v164, v75, v159
  v_dot2c_f32_bf16 v165, v87, v159
  v_dot2c_f32_bf16 v166, v99, v159
  v_dot2c_f32_bf16 v167, v111, v159
  v_add_f32_dpp v160, v160, v160 quad_perm:[1,0,3,2] row_mask:0xf bank_mask:0xf
  v_add_f32_dpp v161, v161, v161 quad_perm:[1,0,3,2] row_mask:0xf bank_mask:0xf
  v_add_f32_dpp v162, v162, v162 quad_perm:[1,0,3,2] row_mask:0xf bank_mask:0xf
  v_add_f32_dpp v163, v163, v163 quad_perm:[1,0,3,2] row_mask:0xf bank_mask:0xf
  v_add_f32_dpp v164, v164, v164 quad_perm:[1,0,3,2] row_mask:0xf bank_mask:0xf
  v_add_f32_dpp v165, v165, v165 quad_perm:[1,0,3,2] row_mask:0xf bank_mask:0xf
  v_add_f32_dpp v166, v166, v166 quad_perm:[1,0,3,2] row_mask:0xf bank_mask:0xf
  v_add_f32_dpp v167, v167, v167 quad_perm:[1,0,3,2] row_mask:0xf bank_mask:0xf
  v_add_f32_dpp v160, v160, v160 quad_perm:[2,3,0,1] row_mask:0xf bank_mask:0xf
  v_add_f32_dpp v161, v161, v161 quad_perm:[2,3,0,1] row_mask:0xf bank_mask:0xf
  v_add_f32_dpp v162, v162, v162 quad_perm:[2,3,0,1] row_mask:0xf bank_mask:0xf
  v_add_f32_dpp v163, v163, v163 quad_perm:[2,3,0,1] row_mask:0xf bank_mask:0xf
  v_add_f32_dpp v164, v164, v164 quad_perm:[2,3,0,1] row_mask:0xf bank_mask:0xf
  v_add_f32_dpp v165, v165, v165 quad_perm:[2,3,0,1] row_mask:0xf bank_mask:0xf
  v_add_f32_dpp v166, v166, v166 quad_perm:[2,3,0,1] row_mask:0xf bank_mask:0xf
  v_add_f32_dpp v167, v167, v167 quad_perm:[2,3,0,1] row_mask:0xf bank_mask:0xf
  v_add_f32_dpp v160, v160, v160 row_half_mirror row_mask:0xf bank_mask:0xf
  v_add_f32_dpp v161, v161, v161 row_half_mirror row_mask:0xf bank_mask:0xf
  v_add_f32_dpp v162, v162, v162 row_half_mirror row_mask:0xf bank_mask:0xf
  v_add_f32_dpp v163, v163, v163 row_half_mirror row_mask:0xf bank_mask:0xf
  v_add_f32_dpp v164, v164, v164 row_half_mirror row_mask:0xf bank_mask:0xf
  v_add_f32_dpp v165, v165, v165 row_half_mirror row_mask:0xf bank_mask:0xf
  v_add_f32_dpp v166, v166, v166 row_half_mirror row_mask:0xf bank_mask:0xf
  v_add_f32_dpp v167, v167, v167 row_half_mirror row_mask:0xf bank_mask:0xf
  s_mov_b32 s68, 0x3d93cd3a
  v_mov_b32 v2, 0
  v_cvt_pk_bf16_f32 v160, v2, v160
  v_cvt_pk_bf16_f32 v161, v2, v161
  v_cvt_pk_bf16_f32 v162, v2, v162
  v_cvt_pk_bf16_f32 v163, v2, v163
  v_cvt_pk_bf16_f32 v164, v2, v164
  v_cvt_pk_bf16_f32 v165, v2, v165
  v_cvt_pk_bf16_f32 v166, v2, v166
  v_cvt_pk_bf16_f32 v167, v2, v167
  v_mul_f32 v160, s68, v160
  v_mul_f32 v161, s68, v161
  v_mul_f32 v162, s68, v162
  v_mul_f32 v163, s68, v163
  v_mul_f32 v164, s68, v164
  v_mul_f32 v165, s68, v165
  v_mul_f32 v166, s68, v166
  v_mul_f32 v167, s68, v167
  v_cvt_pk_bf16_f32 v160, v2, v160
  v_cvt_pk_bf16_f32 v161, v2, v161
  v_cvt_pk_bf16_f32 v162, v2, v162
  v_cvt_pk_bf16_f32 v163, v2, v163
  v_cvt_pk_bf16_f32 v164, v2, v164
  v_cvt_pk_bf16_f32 v165, v2, v165
  v_cvt_pk_bf16_f32 v166, v2, v166
  v_cvt_pk_bf16_f32 v167, v2, v167
  v_max_f32 v4, v160, v161
  v_max_f32 v6, v164, v165
  v_max3_f32 v4, v4, v162, v163
  v_max3_f32 v6, v6, v166, v167
  s_nop 0
  v_max_f32_dpp v4, v4, v4 row_ror:8 row_mask:0xf bank_mask:0xf
  v_max_f32_dpp v6, v6, v6 row_ror:8 row_mask:0xf bank_mask:0xf
  v_mov_b32 v88, v4
  v_mov_b32 v89, v6
  s_nop 0
  v_permlane16_swap_b32 v4, v88
  v_permlane16_swap_b32 v6, v89
  v_max_f32 v4, v4, v88
  v_max_f32 v6, v6, v89
  v_mov_b32 v88, v4
  v_mov_b32 v89, v6
  s_nop 0
  v_permlane32_swap_b32 v4, v88
  v_permlane32_swap_b32 v6, v89
  v_max_f32 v4, v4, v88
  v_max_f32 v6, v6, v89
  s_mov_b32 s68, 0x3fb8aa3b
  v_sub_f32 v160, v160, v4
  v_sub_f32 v161, v161, v4
  v_sub_f32 v162, v162, v4
  v_sub_f32 v163, v163, v4
  v_sub_f32 v164, v164, v6
  v_sub_f32 v165, v165, v6
  v_sub_f32 v166, v166, v6
  v_sub_f32 v167, v167, v6
  v_mul_f32 v160, s68, v160
  v_mul_f32 v161, s68, v161
  v_mul_f32 v162, s68, v162
  v_mul_f32 v163, s68, v163
  v_mul_f32 v164, s68, v164
  v_mul_f32 v165, s68, v165
  v_mul_f32 v166, s68, v166
  v_mul_f32 v167, s68, v167
  v_exp_f32 v160, v160
  v_exp_f32 v161, v161
  v_exp_f32 v162, v162
  v_exp_f32 v163, v163
  v_exp_f32 v164, v164
  v_exp_f32 v165, v165
  v_exp_f32 v166, v166
  v_exp_f32 v167, v167
  v_add_f32 v5, v160, v161
  v_add_f32 v7, v164, v165
  v_add_f32 v5, v5, v162
  v_add_f32 v7, v7, v166
  v_add_f32 v5, v5, v163
  v_add_f32 v7, v7, v167
  s_nop 0
  v_add_f32_dpp v5, v5, v5 row_ror:8 row_mask:0xf bank_mask:0xf
  v_add_f32_dpp v7, v7, v7 row_ror:8 row_mask:0xf bank_mask:0xf
  v_mov_b32 v88, v5
  v_mov_b32 v89, v7
  s_nop 0
  v_permlane16_swap_b32 v5, v88
  v_permlane16_swap_b32 v7, v89
  v_add_f32 v5, v5, v88
  v_add_f32 v7, v7, v89
  v_mov_b32 v88, v5
  v_mov_b32 v89, v7
  s_nop 0
  v_permlane32_swap_b32 v5, v88
  v_permlane32_swap_b32 v7, v89
  v_add_f32 v5, v5, v88
  v_add_f32 v7, v7, v89
  s_lshl_b32 s69, s73, 4
  v_mov_b32 v88, s69
  ds_write_b128 v88, v[4:7] offset:512
  v_cvt_pk_bf16_f32 v160, v160, v2
  v_cvt_pk_bf16_f32 v161, v161, v2
  v_cvt_pk_bf16_f32 v162, v162, v2
  v_cvt_pk_bf16_f32 v163, v163, v2
  v_cvt_pk_bf16_f32 v164, v164, v2
  v_cvt_pk_bf16_f32 v165, v165, v2
  v_cvt_pk_bf16_f32 v166, v166, v2
  v_cvt_pk_bf16_f32 v167, v167, v2
  v_mov_b32 v64, 0
  v_mov_b32 v65, 0
  v_mov_b32 v66, 0
  v_mov_b32 v67, 0
  v_mov_b32 v68, 0
  v_mov_b32 v69, 0
  v_mov_b32 v70, 0
  v_mov_b32 v71, 0
  v_mov_b32 v72, 0
  v_mov_b32 v73, 0
  v_mov_b32 v74, 0
  v_mov_b32 v75, 0
  v_mov_b32 v76, 0
  v_mov_b32 v77, 0
  v_mov_b32 v78, 0
  v_mov_b32 v79, 0
  v_mov_b32 v80, 0
  v_mov_b32 v81, 0
  v_mov_b32 v82, 0
  v_mov_b32 v83, 0
  v_mov_b32 v84, 0
  v_mov_b32 v85, 0
  v_mov_b32 v86, 0
  v_mov_b32 v87, 0
  v_mov_b32 v88, 0
  v_mov_b32 v89, 0
  v_mov_b32 v90, 0
  v_mov_b32 v91, 0
  v_mov_b32 v92, 0
  v_mov_b32 v93, 0
  v_mov_b32 v94, 0
  v_mov_b32 v95, 0
  v_mov_b32 v96, 0
  v_mov_b32 v97, 0
  v_mov_b32 v98, 0
  v_mov_b32 v99, 0
  v_mov_b32 v100, 0
  v_mov_b32 v101, 0
  v_mov_b32 v102, 0
  v_mov_b32 v103, 0
  v_mov_b32 v104, 0
  v_mov_b32 v105, 0
  v_mov_b32 v106, 0
  v_mov_b32 v107, 0
  v_mov_b32 v108, 0
  v_mov_b32 v109, 0
  v_mov_b32 v110, 0
  v_mov_b32 v111, 0
  v_mov_b32 v5, v6
  v_and_b32 v8, 7, v0
  v_lshlrev_b32 v8, 5, v8
  v_lshrrev_b32 v9, 4, v0
  v_lshl_add_u32 v8, v9, 3, v8
  s_mul_i32 s69, s73, 768
  v_add_u32 v8, s69, v8
  v_mov_b32 v11, 1
  s_waitcnt vmcnt(2)
  buffer_load_dwordx4 v[124:127], v1, s[12:15], s61 offen offset:0 nt
  s_waitcnt vmcnt(2)
  buffer_load_dwordx4 v[128:131], v1, s[12:15], s61 offen offset:128 nt
  v_lshlrev_b32 v10, 16, v160
  v_dot2c_f32_bf16 v64, v112, v160
  v_dot2c_f32_bf16 v65, v112, v10
  v_dot2c_f32_bf16 v66, v113, v160
  v_dot2c_f32_bf16 v67, v113, v10
  v_dot2c_f32_bf16 v68, v114, v160
  v_dot2c_f32_bf16 v69, v114, v10
  v_dot2c_f32_bf16 v70, v115, v160
  v_dot2c_f32_bf16 v71, v115, v10
  s_waitcnt vmcnt(2)
  buffer_load_dwordx4 v[132:135], v1, s[12:15], s61 offen offset:256 nt
  s_memrealtime s[76:77]
  v_mov_b32 v6, 0
  ds_read_b64 v[6:7], v6 offset:680
  s_movk_i32 s79, 457
  s_waitcnt lgkmcnt(0)
  v_readfirstlane_b32 s78, v6
  v_readfirstlane_b32 s72, v7
  s_add_u32 s78, s78, 5484
  v_dot2c_f32_bf16 v72, v116, v160
  v_dot2c_f32_bf16 v73, v116, v10
  v_dot2c_f32_bf16 v74, v117, v160
  v_dot2c_f32_bf16 v75, v117, v10
  v_dot2c_f32_bf16 v76, v118, v160
  v_dot2c_f32_bf16 v77, v118, v10
  v_dot2c_f32_bf16 v78, v119, v160
  v_dot2c_f32_bf16 v79, v119, v10
  s_waitcnt lgkmcnt(0)
  s_lshl_b32 s75, s76, 4
  s_sub_u32 s75, s75, s78
  s_and_b32 s75, s75, s72
  s_add_u32 s78, s78, s79
  s_waitcnt vmcnt(3)
  s_cmp_gt_i32 s75, 480
  s_cbranch_scc1 L_go_3
  s_waitcnt vmcnt(2)
  s_cmp_ge_i32 s75, 0
  s_cbranch_scc1 L_go_3
  s_waitcnt vmcnt(1)
L_go_3:
  buffer_load_dwordx4 v[136:139], v1, s[12:15], s62 offen offset:0 nt
  s_memrealtime s[76:77]
  v_dot2c_f32_bf16 v80, v120, v160
  v_dot2c_f32_bf16 v81, v120, v10
  v_dot2c_f32_bf16 v82, v121, v160
  v_dot2c_f32_bf16 v83, v121, v10
  v_dot2c_f32_bf16 v84, v122, v160
  v_dot2c_f32_bf16 v85, v122, v10
  v_dot2c_f32_bf16 v86, v123, v160
  v_dot2c_f32_bf16 v87, v123, v10
  s_waitcnt lgkmcnt(0)
  s_lshl_b32 s75, s76, 4
  s_sub_u32 s75, s75, s78
  s_and_b32 s75, s75, s72
  s_add_u32 s78, s78, s79
  s_waitcnt vmcnt(3)
  s_cmp_gt_i32 s75, 480
  s_cbranch_scc1 L_go_4
  s_waitcnt vmcnt(2)
  s_cmp_ge_i32 s75, 0
  s_cbranch_scc1 L_go_4
  s_waitcnt vmcnt(1)
L_go_4:
  buffer_load_dwordx4 v[140:143], v1, s[12:15], s62 offen offset:128 nt
  s_memrealtime s[76:77]
  v_lshlrev_b32 v10, 16, v161
  v_dot2c_f32_bf16 v64, v124, v161
  v_dot2c_f32_bf16 v65, v124, v10
  v_dot2c_f32_bf16 v66, v125, v161
  v_dot2c_f32_bf16 v67, v125, v10
  v_dot2c_f32_bf16 v68, v126, v161
  v_dot2c_f32_bf16 v69, v126, v10
  v_dot2c_f32_bf16 v70, v127, v161
  v_dot2c_f32_bf16 v71, v127, v10
  s_waitcnt lgkmcnt(0)
  s_lshl_b32 s75, s76, 4
  s_sub_u32 s75, s75, s78
  s_and_b32 s75, s75, s72
  s_add_u32 s78, s78, s79
  s_waitcnt vmcnt(3)
  s_cmp_gt_i32 s75, 480
  s_cbranch_scc1 L_go_5
  s_waitcnt vmcnt(2)
  s_cmp_ge_i32 s75, 0
  s_cbranch_scc1 L_go_5
  s_waitcnt vmcnt(1)
L_go_5:
  buffer_load_dwordx4 v[144:147], v1, s[12:15], s62 offen offset:256 nt
  s_memrealtime s[76:77]
  v_dot2c_f32_bf16 v72, v128, v161
  v_dot2c_f32_bf16 v73, v128, v10
  v_dot2c_f32_bf16 v74, v129, v161
  v_dot2c_f32_bf16 v75, v129, v10
  v_dot2c_f32_bf16 v76, v130, v161
  v_dot2c_f32_bf16 v77, v130, v10
  v_dot2c_f32_bf16 v78, v131, v161
  v_dot2c_f32_bf16 v79, v131, v10
  s_waitcnt lgkmcnt(0)
  s_lshl_b32 s75, s76, 4
  s_sub_u32 s75, s75, s78
  s_and_b32 s75, s75, s72
  s_add_u32 s78, s78, s79
  s_waitcnt vmcnt(3)
  s_cmp_gt_i32 s75, 480
  s_cbranch_scc1 L_go_6
  s_waitcnt vmcnt(2)
  s_cmp_ge_i32 s75, 0
  s_cbranch_scc1 L_go_6
  s_waitcnt vmcnt(1)
L_go_6:
  buffer_load_dwordx4 v[148:151], v1, s[12:15], s63 offen offset:0 nt
  s_memrealtime s[76:77]
  v_mov_b32 v6, 0
  ds_read_b64 v[6:7], v6 offset:680
  s_movk_i32 s79, 457
  s_waitcnt lgkmcnt(0)
  v_readfirstlane_b32 s78, v6
  v_readfirstlane_b32 s72, v7
  s_add_u32 s78, s78, 7312
  v_dot2c_f32_bf16 v80, v132, v161
  v_dot2c_f32_bf16 v81, v132, v10
  v_dot2c_f32_bf16 v82, v133, v161
  v_dot2c_f32_bf16 v83, v133, v10
  v_dot2c_f32_bf16 v84, v134, v161
  v_dot2c_f32_bf16 v85, v134, v10
  v_dot2c_f32_bf16 v86, v135, v161
  v_dot2c_f32_bf16 v87, v135, v10
  s_waitcnt lgkmcnt(0)
  s_lshl_b32 s75, s76, 4
  s_sub_u32 s75, s75, s78
  s_and_b32 s75, s75, s72
  s_add_u32 s78, s78, s79
  s_waitcnt vmcnt(3)
  s_cmp_gt_i32 s75, 480
  s_cbranch_scc1 L_go_7
  s_waitcnt vmcnt(2)
  s_cmp_ge_i32 s75, 0
  s_cbranch_scc1 L_go_7
  s_waitcnt vmcnt(1)
L_go_7:
  buffer_load_dwordx4 v[152:155], v1, s[12:15], s63 offen offset:128 nt
  s_memrealtime s[76:77]
  v_lshlrev_b32 v10, 16, v162
  v_dot2c_f32_bf16 v64, v136, v162
  v_dot2c_f32_bf16 v65, v136, v10
  v_dot2c_f32_bf16 v66, v137, v162
  v_dot2c_f32_bf16 v67, v137, v10
  v_dot2c_f32_bf16 v68, v138, v162
  v_dot2c_f32_bf16 v69, v138, v10
  v_dot2c_f32_bf16 v70, v139, v162
  v_dot2c_f32_bf16 v71, v139, v10
  s_waitcnt lgkmcnt(0)
  s_lshl_b32 s75, s76, 4
  s_sub_u32 s75, s75, s78
  s_and_b32 s75, s75, s72
  s_add_u32 s78, s78, s79
  s_waitcnt vmcnt(3)
  s_cmp_gt_i32 s75, 480
  s_cbranch_scc1 L_go_8
  s_waitcnt vmcnt(2)
  s_cmp_ge_i32 s75, 0
  s_cbranch_scc1 L_go_8
  s_waitcnt vmcnt(1)
L_go_8:
  buffer_load_dwordx4 v[156:159], v1, s[12:15], s63 offen offset:256 nt
  s_memrealtime s[76:77]
  v_dot2c_f32_bf16 v72, v140, v162
  v_dot2c_f32_bf16 v73, v140, v10
  v_dot2c_f32_bf16 v74, v141, v162
  v_dot2c_f32_bf16 v75, v141, v10
  v_dot2c_f32_bf16 v76, v142, v162
  v_dot2c_f32_bf16 v77, v142, v10
  v_dot2c_f32_bf16 v78, v143, v162
  v_dot2c_f32_bf16 v79, v143, v10
  s_waitcnt lgkmcnt(0)
  s_lshl_b32 s75, s76, 4
  s_sub_u32 s75, s75, s78
  s_and_b32 s75, s75, s72
  s_add_u32 s78, s78, s79
  s_waitcnt vmcnt(3)
  s_cmp_gt_i32 s75, 480
  s_cbranch_scc1 L_go_9
  s_waitcnt vmcnt(2)
  s_cmp_ge_i32 s75, 0
  s_cbranch_scc1 L_go_9
  s_waitcnt vmcnt(1)
L_go_9:
  buffer_load_dwordx4 v[16:19], v1, s[12:15], s64 offen offset:0 nt
  s_memrealtime s[76:77]
  v_dot2c_f32_bf16 v80, v144, v162
  v_dot2c_f32_bf16 v81, v144, v10
  v_dot2c_f32_bf16 v82, v145, v162
  v_dot2c_f32_bf16 v83, v145, v10
  v_dot2c_f32_bf16 v84, v146, v162
  v_dot2c_f32_bf16 v85, v146, v10
  v_dot2c_f32_bf16 v86, v147, v162
  v_dot2c_f32_bf16 v87, v147, v10
  s_waitcnt lgkmcnt(0)
  s_lshl_b32 s75, s76, 4
  s_sub_u32 s75, s75, s78
  s_and_b32 s75, s75, s72
  s_add_u32 s78, s78, s79
  s_waitcnt vmcnt(3)
  s_cmp_gt_i32 s75, 480
  s_cbranch_scc1 L_go_10
  s_waitcnt vmcnt(2)
  s_cmp_ge_i32 s75, 0
  s_cbranch_scc1 L_go_10
  s_waitcnt vmcnt(1)
L_go_10:
  buffer_load_dwordx4 v[20:23], v1, s[12:15], s64 offen offset:128 nt
  s_memrealtime s[76:77]
  v_lshlrev_b32 v10, 16, v163
  s_mov_b32 s70, 4000007
L_spin_11:
  ds_read_b128 v[12:15], v3 offset:512
  s_waitcnt lgkmcnt(0)
  v_cmp_eq_u32 vcc, 0, v15
  s_nop 0
  s_cbranch_vccz L_sdone_12
  s_sleep 1
  s_sub_u32 s70, s70, 1
  s_cbranch_scc0 L_spin_11
L_sdone_12:
  v_max_f32_dpp v12, v12, v12 quad_perm:[1,0,3,2] row_mask:0xf bank_mask:0xf
  v_max_f32_dpp v14, v14, v14 quad_perm:[1,0,3,2] row_mask:0xf bank_mask:0xf
  s_nop 0
  v_max_f32_dpp v12, v12, v12 quad_perm:[2,3,0,1] row_mask:0xf bank_mask:0xf
  v_max_f32_dpp v14, v14, v14 quad_perm:[2,3,0,1] row_mask:0xf bank_mask:0xf
  s_nop 0
  v_max_f32_dpp v12, v12, v12 row_half_mirror row_mask:0xf bank_mask:0xf
  v_max_f32_dpp v14, v14, v14 row_half_mirror row_mask:0xf bank_mask:0xf
  v_sub_f32 v4, v4, v12
  v_sub_f32 v5, v5, v14
  v_mul_f32 v4, s68, v4
  v_mul_f32 v5, s68, v5
  v_exp_f32 v4, v4
  v_exp_f32 v5, v5
  v_mov_b32 v2, 0
  s_mov_b32 s70, 4000007
L_spin_13:
  ds_read_b32 v13, v2 offset:648
  s_waitcnt lgkmcnt(0)
  v_cmp_gt_u32 vcc, 1, v13
  s_nop 0
  s_cbranch_vccz L_sdone_14
  s_sleep 2
  s_sub_u32 s70, s70, 1
  s_cbranch_scc0 L_spin_13
L_sdone_14:
  v_readfirstlane_b32 s46, v13
  v_min_u32 v12, 47, v0
  v_lshrrev_b32 v13, 3, v12
  v_lshlrev_b32 v13, 11, v13
  v_and_b32 v14, 1, v12
  v_lshl_add_u32 v13, v14, 10, v13
  v_bfe_u32 v14, v12, 1, 2
  v_lshl_add_u32 v13, v14, 8, v13
  v_lshlrev_b32 v12, 4, v12
  s_lshr_b32 s74, s2, 7
  s_lshl2_add_u32 s74, s4, s74
  s_mul_i32 s74, s74, 12288
  s_bfe_u32 s69, s2, 0x40003
  s_lshl4_add_u32 s74, s69, s74
  s_add_u32 s74, s74, 548864
  s_mov_b32 s22, 0x55555555
  s_mov_b32 s23, 0x55555555
  v_mov_b32 v14, s30
  v_mov_b32 v15, s31
  v_dot2c_f32_bf16 v64, v148, v163
  v_dot2c_f32_bf16 v65, v148, v10
  v_dot2c_f32_bf16 v66, v149, v163
  v_dot2c_f32_bf16 v67, v149, v10
  v_dot2c_f32_bf16 v68, v150, v163
  v_dot2c_f32_bf16 v69, v150, v10
  v_dot2c_f32_bf16 v70, v151, v163
  v_dot2c_f32_bf16 v71, v151, v10
  v_permlane32_swap_b32 v64, v68
  v_permlane32_swap_b32 v65, v69
  v_permlane32_swap_b32 v66, v70
  v_permlane32_swap_b32 v67, v71
  v_add_f32 v64, v64, v68
  v_add_f32 v65, v65, v69
  v_add_f32 v66, v66, v70
  v_add_f32 v67, v67, v71
  s_nop 0
  v_permlane16_swap_b32 v64, v66
  v_permlane16_swap_b32 v65, v67
  v_add_f32 v64, v64, v66
  v_add_f32 v65, v65, v67
  s_nop 0
  v_add_f32_dpp v64, v64, v64 row_ror:8 row_mask:0xf bank_mask:0xf
  v_add_f32_dpp v65, v65, v65 row_ror:8 row_mask:0xf bank_mask:0xf
  v_mul_f32 v64, v4, v64
  v_mul_f32 v65, v4, v65
  ds_write_b64 v8, v[64:65] offset:57856
  s_waitcnt lgkmcnt(0)
  s_lshl_b32 s75, s76, 4
  s_sub_u32 s75, s75, s78
  s_and_b32 s75, s75, s72
  s_add_u32 s78, s78, s79
  s_waitcnt vmcnt(3)
  s_cmp_gt_i32 s75, 480
  s_cbranch_scc1 L_go_15
  s_waitcnt vmcnt(2)
  s_cmp_ge_i32 s75, 0
  s_cbranch_scc1 L_go_15
  s_waitcnt vmcnt(1)
L_go_15:
  buffer_load_dwordx4 v[24:27], v1, s[12:15], s64 offen offset:256 nt
  s_memrealtime s[76:77]
  v_dot2c_f32_bf16 v72, v152, v163
  v_dot2c_f32_bf16 v73, v152, v10
  v_dot2c_f32_bf16 v74, v153, v163
  v_dot2c_f32_bf16 v75, v153, v10
  v_dot2c_f32_bf16 v76, v154, v163
  v_dot2c_f32_bf16 v77, v154, v10
  v_dot2c_f32_bf16 v78, v155, v163
  v_dot2c_f32_bf16 v79, v155, v10
  v_permlane32_swap_b32 v72, v76
  v_permlane32_swap_b32 v73, v77
  v_permlane32_swap_b32 v74, v78
  v_permlane32_swap_b32 v75, v79
  v_add_f32 v72, v72, v76
  v_add_f32 v73, v73, v77
  v_add_f32 v74, v74, v78
  v_add_f32 v75, v75, v79
  s_nop 0
  v_permlane16_swap_b32 v72, v74
  v_permlane16_swap_b32 v73, v75
  v_add_f32 v72, v72, v74
  v_add_f32 v73, v73, v75
  s_nop 0
  v_add_f32_dpp v72, v72, v72 row_ror:8 row_mask:0xf bank_mask:0xf
  v_add_f32_dpp v73, v73, v73 row_ror:8 row_mask:0xf bank_mask:0xf
  v_mul_f32 v72, v4, v72
  v_mul_f32 v73, v4, v73
  ds_write_b64 v8, v[72:73] offset:58112
  s_waitcnt lgkmcnt(0)
  s_lshl_b32 s75, s76, 4
  s_sub_u32 s75, s75, s78
  s_and_b32 s75, s75, s72
  s_add_u32 s78, s78, s79
  s_waitcnt vmcnt(3)
  s_cmp_gt_i32 s75, 480
  s_cbranch_scc1 L_go_16
  s_waitcnt vmcnt(2)
  s_cmp_ge_i32 s75, 0
  s_cbranch_scc1 L_go_16
  s_waitcnt vmcnt(1)
L_go_16:
  buffer_load_dwordx4 v[28:31], v1, s[12:15], s65 offen offset:0 nt
  s_memrealtime s[76:77]
  v_dot2c_f32_bf16 v80, v156, v163
  v_dot2c_f32_bf16 v81, v156, v10
  v_dot2c_f32_bf16 v82, v157, v163
  v_dot2c_f32_bf16 v83, v157, v10
  v_dot2c_f32_bf16 v84, v158, v163
  v_dot2c_f32_bf16 v85, v158, v10
  v_dot2c_f32_bf16 v86, v159, v163
  v_dot2c_f32_bf16 v87, v159, v10
  v_permlane32_swap_b32 v80, v84
  v_permlane32_swap_b32 v81, v85
  v_permlane32_swap_b32 v82, v86
  v_permlane32_swap_b32 v83, v87
  v_add_f32 v80, v80, v84
  v_add_f32 v81, v81, v85
  v_add_f32 v82, v82, v86
  v_add_f32 v83, v83, v87
  s_nop 0
  v_permlane16_swap_b32 v80, v82
  v_permlane16_swap_b32 v81, v83
  v_add_f32 v80, v80, v82
  v_add_f32 v81, v81, v83
  s_nop 0
  v_add_f32_dpp v80, v80, v80 row_ror:8 row_mask:0xf bank_mask:0xf
  v_add_f32_dpp v81, v81, v81 row_ror:8 row_mask:0xf bank_mask:0xf
  v_mul_f32 v80, v4, v80
  v_mul_f32 v81, v4, v81
  ds_write_b64 v8, v[80:81] offset:58368
  s_mov_b64 exec, 1
  ds_add_u32 v2, v11 offset:652
  s_mov_b64 exec, -1
  s_waitcnt lgkmcnt(0)
  s_lshl_b32 s75, s76, 4
  s_sub_u32 s75, s75, s78
  s_and_b32 s75, s75, s72
  s_add_u32 s78, s78, s79
  s_waitcnt vmcnt(3)
  s_cmp_gt_i32 s75, 480
  s_cbranch_scc1 L_go_17
  s_waitcnt vmcnt(2)
  s_cmp_ge_i32 s75, 0
  s_cbranch_scc1 L_go_17
  s_waitcnt vmcnt(1)
L_go_17:
  buffer_load_dwordx4 v[32:35], v1, s[12:15], s65 offen offset:128 nt
  s_memrealtime s[76:77]
  v_lshlrev_b32 v10, 16, v164
  v_dot2c_f32_bf16 v88, v16, v164
  v_dot2c_f32_bf16 v89, v16, v10
  v_dot2c_f32_bf16 v90, v17, v164
  v_dot2c_f32_bf16 v91, v17, v10
  v_dot2c_f32_bf16 v92, v18, v164
  v_dot2c_f32_bf16 v93, v18, v10
  v_dot2c_f32_bf16 v94, v19, v164
  v_dot2c_f32_bf16 v95, v19, v10
  s_waitcnt lgkmcnt(0)
  s_lshl_b32 s75, s76, 4
  s_sub_u32 s75, s75, s78
  s_and_b32 s75, s75, s72
  s_add_u32 s78, s78, s79
  s_waitcnt vmcnt(3)
  s_cmp_gt_i32 s75, 480
  s_cbranch_scc1 L_go_18
  s_waitcnt vmcnt(2)
  s_cmp_ge_i32 s75, 0
  s_cbranch_scc1 L_go_18
  s_waitcnt vmcnt(1)
L_go_18:
  buffer_load_dwordx4 v[36:39], v1, s[12:15], s65 offen offset:256 nt
  s_memrealtime s[76:77]
  v_dot2c_f32_bf16 v96, v20, v164
  v_dot2c_f32_bf16 v97, v20, v10
  v_dot2c_f32_bf16 v98, v21, v164
  v_dot2c_f32_bf16 v99, v21, v10
  v_dot2c_f32_bf16 v100, v22, v164
  v_dot2c_f32_bf16 v101, v22, v10
  v_dot2c_f32_bf16 v102, v23, v164
  v_dot2c_f32_bf16 v103, v23, v10
  s_waitcnt lgkmcnt(0)
  s_lshl_b32 s75, s76, 4
  s_sub_u32 s75, s75, s78
  s_and_b32 s75, s75, s72
  s_add_u32 s78, s78, s79
  s_waitcnt vmcnt(3)
  s_cmp_gt_i32 s75, 480
  s_cbranch_scc1 L_go_19
  s_waitcnt vmcnt(2)
  s_cmp_ge_i32 s75, 0
  s_cbranch_scc1 L_go_19
  s_waitcnt vmcnt(1)
L_go_19:
  buffer_load_dwordx4 v[40:43], v1, s[12:15], s66 offen offset:0 nt
  s_memrealtime s[76:77]
  v_dot2c_f32_bf16 v104, v24, v164
  v_dot2c_f32_bf16 v105, v24, v10
  v_dot2c_f32_bf16 v106, v25, v164
  v_dot2c_f32_bf16 v107, v25, v10
  v_dot2c_f32_bf16 v108, v26, v164
  v_dot2c_f32_bf16 v109, v26, v10
  v_dot2c_f32_bf16 v110, v27, v164
  v_dot2c_f32_bf16 v111, v27, v10
  s_waitcnt lgkmcnt(0)
  s_lshl_b32 s75, s76, 4
  s_sub_u32 s75, s75, s78
  s_and_b32 s75, s75, s72
  s_add_u32 s78, s78, s79
  s_waitcnt vmcnt(3)
  s_cmp_gt_i32 s75, 480
  s_cbranch_scc1 L_go_20
  s_waitcnt vmcnt(2)
  s_cmp_ge_i32 s75, 0
  s_cbranch_scc1 L_go_20
  s_waitcnt vmcnt(1)
L_go_20:
  buffer_load_dwordx4 v[44:47], v1, s[12:15], s66 offen offset:128 nt
  s_memrealtime s[76:77]
  v_lshlrev_b32 v10, 16, v165
  v_dot2c_f32_bf16 v88, v28, v165
  v_dot2c_f32_bf16 v89, v28, v10
  v_dot2c_f32_bf16 v90, v29, v165
  v_dot2c_f32_bf16 v91, v29, v10
  v_dot2c_f32_bf16 v92, v30, v165
  v_dot2c_f32_bf16 v93, v30, v10
  v_dot2c_f32_bf16 v94, v31, v165
  v_dot2c_f32_bf16 v95, v31, v10
  s_waitcnt lgkmcnt(0)
  s_lshl_b32 s75, s76, 4
  s_sub_u32 s75, s75, s78
  s_and_b32 s75, s75, s72
  s_add_u32 s78, s78, s79
  s_waitcnt vmcnt(3)
  s_cmp_gt_i32 s75, 480
  s_cbranch_scc1 L_go_21
  s_waitcnt vmcnt(2)
  s_cmp_ge_i32 s75, 0
  s_cbranch_scc1 L_go_21
  s_waitcnt vmcnt(1)
L_go_21:
  buffer_load_dwordx4 v[48:51], v1, s[12:15], s66 offen offset:256 nt
  s_memrealtime s[76:77]
  v_dot2c_f32_bf16 v96, v32, v165
  v_dot2c_f32_bf16 v97, v32, v10
  v_dot2c_f32_bf16 v98, v33, v165
  v_dot2c_f32_bf16 v99, v33, v10
  v_dot2c_f32_bf16 v100, v34, v165
  v_dot2c_f32_bf16 v101, v34, v10
  v_dot2c_f32_bf16 v102, v35, v165
  v_dot2c_f32_bf16 v103, v35, v10
  s_waitcnt lgkmcnt(0)
  s_lshl_b32 s75, s76, 4
  s_sub_u32 s75, s75, s78
  s_and_b32 s75, s75, s72
  s_add_u32 s78, s78, s79
  s_waitcnt vmcnt(3)
  s_cmp_gt_i32 s75, 480
  s_cbranch_scc1 L_go_22
  s_waitcnt vmcnt(2)
  s_cmp_ge_i32 s75, 0
  s_cbranch_scc1 L_go_22
  s_waitcnt vmcnt(1)
L_go_22:
  buffer_load_dwordx4 v[52:55], v1, s[12:15], s67 offen offset:0 nt
  s_memrealtime s[76:77]
  s_mov_b64 exec, 1
  ds_add_u32 v2, v11 offset:644
  s_mov_b64 exec, -1
  v_dot2c_f32_bf16 v104, v36, v165
  v_dot2c_f32_bf16 v105, v36, v10
  v_dot2c_f32_bf16 v106, v37, v165
  v_dot2c_f32_bf16 v107, v37, v10
  v_dot2c_f32_bf16 v108, v38, v165
  v_dot2c_f32_bf16 v109, v38, v10
  v_dot2c_f32_bf16 v110, v39, v165
  v_dot2c_f32_bf16 v111, v39, v10
  s_waitcnt lgkmcnt(0)
  s_lshl_b32 s75, s76, 4
  s_sub_u32 s75, s75, s78
  s_and_b32 s75, s75, s72
  s_add_u32 s78, s78, s79
  s_waitcnt vmcnt(3)
  s_cmp_gt_i32 s75, 480
  s_cbranch_scc1 L_go_23
  s_waitcnt vmcnt(2)
  s_cmp_ge_i32 s75, 0
  s_cbranch_scc1 L_go_23
  s_waitcnt vmcnt(1)
L_go_23:
  buffer_load_dwordx4 v[56:59], v1, s[12:15], s67 offen offset:128 nt
  s_memrealtime s[76:77]
  v_lshlrev_b32 v10, 16, v166
  v_dot2c_f32_bf16 v88, v40, v166
  v_dot2c_f32_bf16 v89, v40, v10
  v_dot2c_f32_bf16 v90, v41, v166
  v_dot2c_f32_bf16 v91, v41, v10
  v_dot2c_f32_bf16 v92, v42, v166
  v_dot2c_f32_bf16 v93, v42, v10
  v_dot2c_f32_bf16 v94, v43, v166
  v_dot2c_f32_bf16 v95, v43, v10
  s_waitcnt lgkmcnt(0)
  s_lshl_b32 s75, s76, 4
  s_sub_u32 s75, s75, s78
  s_and_b32 s75, s75, s72
  s_add_u32 s78, s78, s79
  s_waitcnt vmcnt(3)
  s_cmp_gt_i32 s75, 480
  s_cbranch_scc1 L_go_24
  s_waitcnt vmcnt(2)
  s_cmp_ge_i32 s75, 0
  s_cbranch_scc1 L_go_24
  s_waitcnt vmcnt(1)
L_go_24:
  buffer_load_dwordx4 v[60:63], v1, s[12:15], s67 offen offset:256 nt
  v_dot2c_f32_bf16 v96, v44, v166
  v_dot2c_f32_bf16 v97, v44, v10
  v_dot2c_f32_bf16 v98, v45, v166
  v_dot2c_f32_bf16 v99, v45, v10
  v_dot2c_f32_bf16 v100, v46, v166
  v_dot2c_f32_bf16 v101, v46, v10
  v_dot2c_f32_bf16 v102, v47, v166
  v_dot2c_f32_bf16 v103, v47, v10
  s_waitcnt vmcnt(3)
  v_dot2c_f32_bf16 v104, v48, v166
  v_dot2c_f32_bf16 v105, v48, v10
  v_dot2c_f32_bf16 v106, v49, v166
  v_dot2c_f32_bf16 v107, v49, v10
  v_dot2c_f32_bf16 v108, v50, v166
  v_dot2c_f32_bf16 v109, v50, v10
  v_dot2c_f32_bf16 v110, v51, v166
  v_dot2c_f32_bf16 v111, v51, v10
  s_waitcnt vmcnt(2)
  v_lshlrev_b32 v10, 16, v167
  v_dot2c_f32_bf16 v88, v52, v167
  v_dot2c_f32_bf16 v89, v52, v10
  v_dot2c_f32_bf16 v90, v53, v167
  v_dot2c_f32_bf16 v91, v53, v10
  v_dot2c_f32_bf16 v92, v54, v167
  v_dot2c_f32_bf16 v93, v54, v10
  v_dot2c_f32_bf16 v94, v55, v167
  v_dot2c_f32_bf16 v95, v55, v10
  v_permlane32_swap_b32 v88, v92
  v_permlane32_swap_b32 v89, v93
  v_permlane32_swap_b32 v90, v94
  v_permlane32_swap_b32 v91, v95
  v_add_f32 v88, v88, v92
  v_add_f32 v89, v89, v93
  v_add_f32 v90, v90, v94
  v_add_f32 v91, v91, v95
  s_nop 0
  v_permlane16_swap_b32 v88, v90
  v_permlane16_swap_b32 v89, v91
  v_add_f32 v88, v88, v90
  v_add_f32 v89, v89, v91
  s_nop 0
  v_add_f32_dpp v88, v88, v88 row_ror:8 row_mask:0xf bank_mask:0xf
  v_add_f32_dpp v89, v89, v89 row_ror:8 row_mask:0xf bank_mask:0xf
  v_mul_f32 v88, v5, v88
  v_mul_f32 v89, v5, v89
  ds_write_b64 v8, v[88:89] offset:1024
  s_waitcnt vmcnt(1)
  v_dot2c_f32_bf16 v96, v56, v167
  v_dot2c_f32_bf16 v97, v56, v10
  v_dot2c_f32_bf16 v98, v57, v167
  v_dot2c_f32_bf16 v99, v57, v10
  v_dot2c_f32_bf16 v100, v58, v167
  v_dot2c_f32_bf16 v101, v58, v10
  v_dot2c_f32_bf16 v102, v59, v167
  v_dot2c_f32_bf16 v103, v59, v10
  v_permlane32_swap_b32 v96, v100
  v_permlane32_swap_b32 v97, v101
  v_permlane32_swap_b32 v98, v102
  v_permlane32_swap_b32 v99, v103
  v_add_f32 v96, v96, v100
  v_add_f32 v97, v97, v101
  v_add_f32 v98, v98, v102
  v_add_f32 v99, v99, v103
  s_nop 0
  v_permlane16_swap_b32 v96, v98
  v_permlane16_swap_b32 v97, v99
  v_add_f32 v96, v96, v98
  v_add_f32 v97, v97, v99
  s_nop 0
  v_add_f32_dpp v96, v96, v96 row_ror:8 row_mask:0xf bank_mask:0xf
  v_add_f32_dpp v97, v97, v97 row_ror:8 row_mask:0xf bank_mask:0xf
  v_mul_f32 v96, v5, v96
  v_mul_f32 v97, v5, v97
  ds_write_b64 v8, v[96:97] offset:1280
  s_waitcnt vmcnt(0)
  v_dot2c_f32_bf16 v104, v60, v167
  v_dot2c_f32_bf16 v105, v60, v10
  v_dot2c_f32_bf16 v106, v61, v167
  v_dot2c_f32_bf16 v107, v61, v10
  v_dot2c_f32_bf16 v108, v62, v167
  v_dot2c_f32_bf16 v109, v62, v10
  v_dot2c_f32_bf16 v110, v63, v167
  v_dot2c_f32_bf16 v111, v63, v10
  v_permlane32_swap_b32 v104, v108
  v_permlane32_swap_b32 v105, v109
  v_permlane32_swap_b32 v106, v110
  v_permlane32_swap_b32 v107, v111
  v_add_f32 v104, v104, v108
  v_add_f32 v105, v105, v109
  v_add_f32 v106, v106, v110
  v_add_f32 v107, v107, v111
  s_nop 0
  v_permlane16_swap_b32 v104, v106
  v_permlane16_swap_b32 v105, v107
  v_add_f32 v104, v104, v106
  v_add_f32 v105, v105, v107
  s_nop 0
  v_add_f32_dpp v104, v104, v104 row_ror:8 row_mask:0xf bank_mask:0xf
  v_add_f32_dpp v105, v105, v105 row_ror:8 row_mask:0xf bank_mask:0xf
  v_mul_f32 v104, v5, v104
  v_mul_f32 v105, v5, v105
  ds_write_b64 v8, v[104:105] offset:1536
  s_mov_b64 exec, 1
  ds_add_rtn_u32 v10, v2, v11 offset:640
  s_mov_b64 exec, -1
  ds_read_b128 v[16:19], v12 offset:1024
  ds_read_b128 v[20:23], v12 offset:1792
  ds_read_b128 v[24:27], v12 offset:2560
  ds_read_b128 v[28:31], v12 offset:3328
  ds_read_b128 v[32:35], v12 offset:4096
  ds_read_b128 v[36:39], v12 offset:4864
  ds_read_b128 v[40:43], v12 offset:5632
  ds_read_b128 v[44:47], v12 offset:6400
  s_waitcnt lgkmcnt(8)
  v_readfirstlane_b32 s68, v10
  s_nop 0
  s_cmp_lg_u32 s68, 7
  s_cbranch_scc1 L_nopub
  s_waitcnt lgkmcnt(6)
  v_pk_add_f32 v[16:17], v[16:17], v[20:21]
  v_pk_add_f32 v[18:19], v[18:19], v[22:23]
  s_waitcnt lgkmcnt(4)
  v_pk_add_f32 v[24:25], v[24:25], v[28:29]
  v_pk_add_f32 v[26:27], v[26:27], v[30:31]
  v_pk_add_f32 v[16:17], v[16:17], v[24:25]
  v_pk_add_f32 v[18:19], v[18:19], v[26:27]
  s_waitcnt lgkmcnt(2)
  v_pk_add_f32 v[32:33], v[32:33], v[36:37]
  v_pk_add_f32 v[34:35], v[34:35], v[38:39]
  s_waitcnt lgkmcnt(0)
  v_pk_add_f32 v[40:41], v[40:41], v[44:45]
  v_pk_add_f32 v[42:43], v[42:43], v[46:47]
  v_pk_add_f32 v[32:33], v[32:33], v[40:41]
  v_pk_add_f32 v[34:35], v[34:35], v[42:43]
  v_pk_add_f32 v[4:5], v[16:17], v[32:33]
  v_pk_add_f32 v[6:7], v[18:19], v[34:35]
  v_cvt_pk_bf16_f32 v8, v4, v5
  v_cvt_pk_bf16_f32 v9, v6, v7
  v_cndmask_b32 v4, v8, v14, s[22:23]
  v_cndmask_b32 v5, v9, v15, s[22:23]
  v_cndmask_b32 v6, v14, v8, s[22:23]
  v_cndmask_b32 v7, v15, v9, s[22:23]
  s_mov_b32 exec_lo, 0xffffffff
  s_mov_b32 exec_hi, 0xffff
  buffer_store_dwordx4 v[4:7], v13, s[32:35], s74 offen
  s_mov_b64 exec, -1
  s_cmp_lg_u32 s46, 1
  s_cbranch_scc1 L_slow_25
L_back_26:
  ds_write_b32 v2, v11 offset:668
L_nopub:
  s_waitcnt lgkmcnt(0)
  s_cmp_lt_u32 s5, 20
  s_cbranch_scc1 L_notf1
  s_cmp_lt_u32 s5, 30
  s_cbranch_scc1 L_f1
  s_branch L_spare
L_notf1:
  s_cmp_gt_u32 s5, 11
  s_cbranch_scc1 L_stream_exit
  s_cmp_gt_u32 s3, 6
  s_cbranch_scc1 L_f2
  s_branch L_dry
L_stream_exit:
  s_endpgm
L_helper:
  s_setprio 3
  v_lshlrev_b32 v1, 2, v0
  v_lshrrev_b32 v2, 3, v0
  s_mul_i32 s68, s7, 80
  v_add_u32 v3, s68, v2
  v_lshlrev_b32 v3, 1, v3
  v_mul_u32_u24 v2, 12288, v2
  v_and_b32 v7, 7, v0
  v_lshl_add_u32 v2, v7, 4, v2
  s_mul_i32 s68, s68, 12288
  s_mul_i32 s69, s6, 384
  s_add_u32 s68, s68, s69
  s_lshl_b32 s69, s3, 7
  s_add_u32 s68, s68, s69
  s_waitcnt lgkmcnt(0)
  s_load_dword s12, s[36:37], 0
  s_load_dword s13, s[36:37], 128
  s_load_dword s14, s[36:37], 256
  s_load_dword s15, s[36:37], 384
  s_load_dword s16, s[36:37], 512
  s_load_dword s17, s[36:37], 640
  s_load_dword s18, s[36:37], 768
  s_load_dword s19, s[36:37], 896
  s_load_dword s20, s[36:37], 1024
  s_load_dword s21, s[36:37], 1152
  s_barrier
  s_mov_b32 s8, s42
  s_mov_b32 s9, s43
  s_mov_b32 s10, 7864320
  s_mov_b32 s11, 0x20000
  s_waitcnt lgkmcnt(0)
  global_load_dword v64, v1, s[36:37] offset:0
  global_load_dword v65, v1, s[36:37] offset:256
  global_load_dword v66, v1, s[36:37] offset:512
  global_load_dword v67, v1, s[36:37] offset:768
  global_load_dword v68, v1, s[36:37] offset:1024
  global_load_ushort v8, v3, s[36:37] offset:0
  global_load_ushort v9, v3, s[36:37] offset:16
  global_load_ushort v10, v3, s[36:37] offset:32
  global_load_ushort v11, v3, s[36:37] offset:48
  global_load_ushort v12, v3, s[36:37] offset:64
  global_load_ushort v13, v3, s[36:37] offset:80
  global_load_ushort v14, v3, s[36:37] offset:96
  global_load_ushort v15, v3, s[36:37] offset:112
  global_load_ushort v16, v3, s[36:37] offset:128
  global_load_ushort v17, v3, s[36:37] offset:144
  s_load_dwordx2 s[28:29], s[58:59], 917504
  s_mov_b32 s69, 0xffff0000
  s_mov_b32 s24, s58
  s_mov_b32 s25, s59
  s_mov_b32 s26, 4194304
  s_mov_b32 s27, 0x20000
  s_add_u32 s32, s58, 4194304
  s_addc_u32 s33, s59, 0
  s_mov_b32 s34, 4194304
  s_mov_b32 s35, 0x20000
  s_lshl3_add_u32 s71, s6, s7
  s_mul_i32 s5, s79, 5
  s_mul_i32 s47, s79, 3
  s_add_u32 s47, s47, 15
  s_cmp_lt_u32 s7, 5
  s_cselect_b32 s5, s5, s47
  s_add_u32 s5, s5, s7
  s_waitcnt lgkmcnt(0)
  s_mul_i32 s30, s28, 0x2c9277b5
  s_add_u32 s30, s30, 0xac564b05
  s_mul_i32 s31, s29, 0x0019660d
  s_add_u32 s31, s31, 0x3c6ef35f
  s_waitcnt vmcnt(10)
  v_lshlrev_b32 v70, 16, v64
  v_and_b32 v71, s69, v64
  v_lshlrev_b32 v72, 16, v65
  v_and_b32 v73, s69, v65
  v_lshlrev_b32 v74, 16, v66
  v_and_b32 v75, s69, v66
  v_lshlrev_b32 v76, 16, v67
  v_and_b32 v77, s69, v67
  v_lshlrev_b32 v78, 16, v68
  v_and_b32 v79, s69, v68
  v_add_f32 v4, v70, v71
  v_add_f32 v5, v72, v73
  v_add_f32 v6, v74, v75
  v_add_f32 v7, v76, v77
  v_add_f32 v4, v4, v5
  v_add_f32 v6, v6, v7
  v_add_f32 v5, v78, v79
  v_add_f32 v4, v4, v6
  v_add_f32 v4, v4, v5
  s_nop 1
  v_add_f32_dpp v4, v4, v4 quad_perm:[1,0,3,2] row_mask:0xf bank_mask:0xf
  s_nop 1
  v_add_f32_dpp v4, v4, v4 quad_perm:[2,3,0,1] row_mask:0xf bank_mask:0xf
  s_nop 1
  v_add_f32_dpp v4, v4, v4 row_half_mirror row_mask:0xf bank_mask:0xf
  s_nop 1
  v_add_f32_dpp v4, v4, v4 row_mirror row_mask:0xf bank_mask:0xf
  v_mov_b32 v5, v4
  s_nop 1
  v_permlane16_swap_b32 v4, v5
  v_add_f32 v4, v4, v5
  v_mov_b32 v5, v4
  s_nop 1
  v_permlane32_swap_b32 v4, v5
  v_add_f32 v4, v4, v5
  v_mul_f32 v4, 0x3acccccd, v4
  v_sub_f32 v70, v70, v4
  v_sub_f32 v71, v71, v4
  v_sub_f32 v72, v72, v4
  v_sub_f32 v73, v73, v4
  v_sub_f32 v74, v74, v4
  v_sub_f32 v75, v75, v4
  v_sub_f32 v76, v76, v4
  v_sub_f32 v77, v77, v4
  v_sub_f32 v78, v78, v4
  v_sub_f32 v79, v79, v4
  v_mul_f32 v5, v70, v70
  v_fmac_f32 v5, v71, v71
  v_fmac_f32 v5, v72, v72
  v_fmac_f32 v5, v73, v73
  v_fmac_f32 v5, v74, v74
  v_fmac_f32 v5, v75, v75
  v_fmac_f32 v5, v76, v76
  v_fmac_f32 v5, v77, v77
  v_fmac_f32 v5, v78, v78
  v_fmac_f32 v5, v79, v79
  s_nop 1
  v_add_f32_dpp v5, v5, v5 quad_perm:[1,0,3,2] row_mask:0xf bank_mask:0xf
  s_nop 1
  v_add_f32_dpp v5, v5, v5 quad_perm:[2,3,0,1] row_mask:0xf bank_mask:0xf
  s_nop 1
  v_add_f32_dpp v5, v5, v5 row_half_mirror row_mask:0xf bank_mask:0xf
  s_nop 1
  v_add_f32_dpp v5, v5, v5 row_mirror row_mask:0xf bank_mask:0xf
  v_mov_b32 v6, v5
  s_nop 1
  v_permlane16_swap_b32 v5, v6
  v_add_f32 v5, v5, v6
  v_mov_b32 v6, v5
  s_nop 1
  v_permlane32_swap_b32 v5, v6
  v_add_f32 v5, v5, v6
  v_mul_f32 v5, 0x3acccccd, v5
  v_cvt_pk_bf16_f32 v4, v4, v4
  v_lshlrev_b32 v4, 16, v4
  v_cvt_pk_bf16_f32 v5, v5, v5
  v_lshlrev_b32 v5, 16, v5
  v_add_f32 v5, 0x3727c5ac, v5
  v_cvt_pk_bf16_f32 v5, v5, v5
  v_lshlrev_b32 v5, 16, v5
  v_sqrt_f32 v5, v5
  s_nop 0
  v_cvt_pk_bf16_f32 v5, v5, v5
  v_lshlrev_b32 v5, 16, v5
  v_rcp_f32 v5, v5
  v_mov_b32 v6, 0
  s_waitcnt vmcnt(0)
  v_lshlrev_b32 v8, 16, v8
  v_lshlrev_b32 v9, 16, v9
  v_lshlrev_b32 v10, 16, v10
  v_lshlrev_b32 v11, 16, v11
  v_lshlrev_b32 v12, 16, v12
  v_lshlrev_b32 v13, 16, v13
  v_lshlrev_b32 v14, 16, v14
  v_lshlrev_b32 v15, 16, v15
  v_lshlrev_b32 v16, 16, v16
  v_lshlrev_b32 v17, 16, v17
  v_sub_f32 v8, v8, v4
  v_sub_f32 v9, v9, v4
  v_sub_f32 v10, v10, v4
  v_sub_f32 v11, v11, v4
  v_sub_f32 v12, v12, v4
  v_sub_f32 v13, v13, v4
  v_sub_f32 v14, v14, v4
  v_sub_f32 v15, v15, v4
  v_sub_f32 v16, v16, v4
  v_sub_f32 v17, v17, v4
  v_cvt_pk_bf16_f32 v8, v6, v8
  v_cvt_pk_bf16_f32 v9, v6, v9
  v_cvt_pk_bf16_f32 v10, v6, v10
  v_cvt_pk_bf16_f32 v11, v6, v11
  v_cvt_pk_bf16_f32 v12, v6, v12
  v_cvt_pk_bf16_f32 v13, v6, v13
  v_cvt_pk_bf16_f32 v14, v6, v14
  v_cvt_pk_bf16_f32 v15, v6, v15
  v_cvt_pk_bf16_f32 v16, v6, v16
  v_cvt_pk_bf16_f32 v17, v6, v17
  v_mul_f32 v8, v8, v5
  v_mul_f32 v9, v9, v5
  v_mul_f32 v10, v10, v5
  v_mul_f32 v11, v11, v5
  v_mul_f32 v12, v12, v5
  v_mul_f32 v13, v13, v5
  v_mul_f32 v14, v14, v5
  v_mul_f32 v15, v15, v5
  v_mul_f32 v16, v16, v5
  v_mul_f32 v17, v17, v5
  v_cvt_pk_bf16_f32 v70, v6, v8
  v_cvt_pk_bf16_f32 v8, v8, v6
  v_cvt_pk_bf16_f32 v71, v6, v9
  v_cvt_pk_bf16_f32 v9, v9, v6
  v_cvt_pk_bf16_f32 v72, v6, v10
  v_cvt_pk_bf16_f32 v10, v10, v6
  v_cvt_pk_bf16_f32 v73, v6, v11
  v_cvt_pk_bf16_f32 v11, v11, v6
  v_cvt_pk_bf16_f32 v74, v6, v12
  v_cvt_pk_bf16_f32 v12, v12, v6
  v_cvt_pk_bf16_f32 v75, v6, v13
  v_cvt_pk_bf16_f32 v13, v13, v6
  v_cvt_pk_bf16_f32 v76, v6, v14
  v_cvt_pk_bf16_f32 v14, v14, v6
  v_cvt_pk_bf16_f32 v77, v6, v15
  v_cvt_pk_bf16_f32 v15, v15, v6
  v_cvt_pk_bf16_f32 v78, v6, v16
  v_cvt_pk_bf16_f32 v16, v16, v6
  v_cvt_pk_bf16_f32 v79, v6, v17
  v_cvt_pk_bf16_f32 v17, v17, v6
  v_mov_b32 v80, 0
  v_mov_b32 v81, 0
  v_mov_b32 v82, 0
  v_mov_b32 v83, 0
  v_mov_b32 v84, 0
  v_mov_b32 v85, 0
  v_mov_b32 v86, 0
  v_mov_b32 v87, 0
  v_and_b32 v90, 7, v0
  v_lshrrev_b32 v6, 4, v0
  v_lshl_add_u32 v90, v90, 2, v6
  v_lshlrev_b32 v90, 4, v90
  s_lshl_b32 s64, s71, 11
  s_lshl_b32 s69, s3, 9
  s_add_u32 s64, s64, s69
  s_waitcnt vmcnt(9)
  v_dot2c_f32_bf16 v80, v24, v8
  v_dot2c_f32_bf16 v81, v24, v70
  v_dot2c_f32_bf16 v82, v25, v8
  v_dot2c_f32_bf16 v83, v25, v70
  v_dot2c_f32_bf16 v84, v26, v8
  v_dot2c_f32_bf16 v85, v26, v70
  v_dot2c_f32_bf16 v86, v27, v8
  v_dot2c_f32_bf16 v87, v27, v70
  s_waitcnt vmcnt(8)
  v_dot2c_f32_bf16 v80, v28, v9
  v_dot2c_f32_bf16 v81, v28, v71
  v_dot2c_f32_bf16 v82, v29, v9
  v_dot2c_f32_bf16 v83, v29, v71
  v_dot2c_f32_bf16 v84, v30, v9
  v_dot2c_f32_bf16 v85, v30, v71
  v_dot2c_f32_bf16 v86, v31, v9
  v_dot2c_f32_bf16 v87, v31, v71
  s_waitcnt vmcnt(7)
  v_dot2c_f32_bf16 v80, v32, v10
  v_dot2c_f32_bf16 v81, v32, v72
  v_dot2c_f32_bf16 v82, v33, v10
  v_dot2c_f32_bf16 v83, v33, v72
  v_dot2c_f32_bf16 v84, v34, v10
  v_dot2c_f32_bf16 v85, v34, v72
  v_dot2c_f32_bf16 v86, v35, v10
  v_dot2c_f32_bf16 v87, v35, v72
  s_waitcnt vmcnt(6)
  v_dot2c_f32_bf16 v80, v36, v11
  v_dot2c_f32_bf16 v81, v36, v73
  v_dot2c_f32_bf16 v82, v37, v11
  v_dot2c_f32_bf16 v83, v37, v73
  v_dot2c_f32_bf16 v84, v38, v11
  v_dot2c_f32_bf16 v85, v38, v73
  v_dot2c_f32_bf16 v86, v39, v11
  v_dot2c_f32_bf16 v87, v39, v73
  s_waitcnt vmcnt(5)
  v_dot2c_f32_bf16 v80, v40, v12
  v_dot2c_f32_bf16 v81, v40, v74
  v_dot2c_f32_bf16 v82, v41, v12
  v_dot2c_f32_bf16 v83, v41, v74
  v_dot2c_f32_bf16 v84, v42, v12
  v_dot2c_f32_bf16 v85, v42, v74
  v_dot2c_f32_bf16 v86, v43, v12
  v_dot2c_f32_bf16 v87, v43, v74
  s_waitcnt vmcnt(4)
  v_dot2c_f32_bf16 v80, v44, v13
  v_dot2c_f32_bf16 v81, v44, v75
  v_dot2c_f32_bf16 v82, v45, v13
  v_dot2c_f32_bf16 v83, v45, v75
  v_dot2c_f32_bf16 v84, v46, v13
  v_dot2c_f32_bf16 v85, v46, v75
  v_dot2c_f32_bf16 v86, v47, v13
  v_dot2c_f32_bf16 v87, v47, v75
  s_waitcnt vmcnt(3)
  v_dot2c_f32_bf16 v80, v48, v14
  v_dot2c_f32_bf16 v81, v48, v76
  v_dot2c_f32_bf16 v82, v49, v14
  v_dot2c_f32_bf16 v83, v49, v76
  v_dot2c_f32_bf16 v84, v50, v14
  v_dot2c_f32_bf16 v85, v50, v76
  v_dot2c_f32_bf16 v86, v51, v14
  v_dot2c_f32_bf16 v87, v51, v76
  s_waitcnt vmcnt(2)
  v_dot2c_f32_bf16 v80, v52, v15
  v_dot2c_f32_bf16 v81, v52, v77
  v_dot2c_f32_bf16 v82, v53, v15
  v_dot2c_f32_bf16 v83, v53, v77
  v_dot2c_f32_bf16 v84, v54, v15
  v_dot2c_f32_bf16 v85, v54, v77
  v_dot2c_f32_bf16 v86, v55, v15
  v_dot2c_f32_bf16 v87, v55, v77
  s_waitcnt vmcnt(1)
  v_dot2c_f32_bf16 v80, v56, v16
  v_dot2c_f32_bf16 v81, v56, v78
  v_dot2c_f32_bf16 v82, v57, v16
  v_dot2c_f32_bf16 v83, v57, v78
  v_dot2c_f32_bf16 v84, v58, v16
  v_dot2c_f32_bf16 v85, v58, v78
  v_dot2c_f32_bf16 v86, v59, v16
  v_dot2c_f32_bf16 v87, v59, v78
  s_waitcnt vmcnt(0)
  v_dot2c_f32_bf16 v80, v60, v17
  v_dot2c_f32_bf16 v81, v60, v79
  v_dot2c_f32_bf16 v82, v61, v17
  v_dot2c_f32_bf16 v83, v61, v79
  v_dot2c_f32_bf16 v84, v62, v17
  v_dot2c_f32_bf16 v85, v62, v79
  v_dot2c_f32_bf16 v86, v63, v17
  v_dot2c_f32_bf16 v87, v63, v79
  v_permlane32_swap_b32 v80, v84
  v_permlane32_swap_b32 v81, v85
  v_permlane32_swap_b32 v82, v86
  v_permlane32_swap_b32 v83, v87
  v_add_f32 v80, v80, v84
  v_add_f32 v81, v81, v85
  v_add_f32 v82, v82, v86
  v_add_f32 v83, v83, v87
  s_nop 0
  v_permlane16_swap_b32 v80, v82
  v_permlane16_swap_b32 v81, v83
  v_add_f32 v80, v80, v82
  v_add_f32 v81, v81, v83
  s_nop 0
  v_add_f32_dpp v80, v80, v80 row_ror:8 row_mask:0xf bank_mask:0xf
  v_add_f32_dpp v81, v81, v81 row_ror:8 row_mask:0xf bank_mask:0xf
  v_mov_b32 v82, s30
  v_mov_b32 v83, s31
  s_mov_b32 exec_lo, 0xff00ff
  s_mov_b32 exec_hi, 0xff00ff
  buffer_store_dwordx4 v[80:83], v90, s[32:35], s64 offen offset:0
  s_mov_b64 exec, -1
  v_and_b32 v3, 31, v0
  v_lshrrev_b32 v2, 5, v0
  v_lshlrev_b32 v2, 11, v2
  v_lshl_add_u32 v2, v3, 4, v2
  s_lshl_b32 s68, s6, 14
  s_add_u32 s60, s68, s69
  s_add_u32 s61, s60, 4096
  s_add_u32 s62, s60, 8192
  s_add_u32 s63, s60, 12288
  v_lshlrev_b32 v3, 2, v3
  s_lshl_b32 s69, s3, 7
  v_add_u32 v3, s69, v3
  v_mov_b32 v1, 0
  s_mov_b32 s65, 0
  s_add_u32 s68, s3, 5
  s_cmp_lg_u32 s68, s7
  s_cbranch_scc1 L_qwait
  s_mov_b32 s16, s32
  s_mov_b32 s17, s33
  s_mov_b32 s18, 4194304
  s_mov_b32 s19, 0x20000
  s_mov_b32 s70, 4000007
L_spin_27:
  buffer_load_dwordx4 v[8:11], v2, s[16:19], s60 offen offset:0 sc1 nt
  buffer_load_dwordx4 v[12:15], v2, s[16:19], s61 offen offset:0 sc1 nt
  buffer_load_dwordx4 v[16:19], v2, s[16:19], s62 offen offset:0 sc1 nt
  buffer_load_dwordx4 v[20:23], v2, s[16:19], s63 offen offset:0 sc1 nt
  s_waitcnt vmcnt(0)
  v_cmp_ne_u64 vcc, s[30:31], v[10:11]
  v_cmp_ne_u64 s[20:21], s[30:31], v[14:15]
  v_cmp_ne_u64 s[22:23], s[30:31], v[18:19]
  s_or_b64 vcc, vcc, s[20:21]
  v_cmp_ne_u64 s[20:21], s[30:31], v[22:23]
  s_or_b64 vcc, vcc, s[22:23]
  s_or_b64 vcc, vcc, s[20:21]
  s_nop 0
  s_cbranch_vccz L_sdone_28
  s_sleep 2
  ds_read_b32 v4, v1 offset:648
  s_waitcnt lgkmcnt(0)
  v_readfirstlane_b32 s46, v4
  s_nop 0
  s_sub_u32 s68, s46, s65
  s_cmp_lg_u32 s68, 2
  s_cbranch_scc1 L_qlazy_29
  s_mov_b32 exec_lo, 0xff00ff
  s_mov_b32 exec_hi, 0xff00ff
  buffer_store_dwordx4 v[80:83], v90, s[24:27], s64 offen offset:0 sc1
  s_mov_b64 exec, -1
  s_mov_b32 s65, 1
L_qlazy_29:
  s_and_b32 s99, s70, 7
  s_cselect_b32 s16, s32, s24
  s_cselect_b32 s17, s33, s25
  s_sub_u32 s70, s70, 1
  s_cbranch_scc0 L_spin_27
L_sdone_28:
  v_add_f32 v8, v8, v12
  v_add_f32 v9, v9, v13
  v_add_f32 v16, v16, v20
  v_add_f32 v17, v17, v21
  v_add_f32 v8, v8, v16
  v_add_f32 v9, v9, v17
  v_mov_b32 v10, v8
  v_mov_b32 v11, v9
  s_nop 0
  v_permlane32_swap_b32 v8, v10
  v_permlane32_swap_b32 v9, v11
  v_add_f32 v8, v8, v10
  v_add_f32 v9, v9, v11
  v_cvt_pk_bf16_f32 v8, v8, v9
  s_lshl_b32 s66, s6, 14
  s_lshl_b32 s68, s3, 11
  s_add_u32 s66, s66, s68
  v_mov_b32_dpp v9, v8 quad_perm:[1,0,3,2] row_mask:0xf bank_mask:0xf
  v_mov_b32 v10, s30
  v_mov_b32 v11, s31
  v_lshlrev_b32 v2, 3, v0
  v_mov_b32 v1, 0
  s_mov_b32 s70, 4000007
L_spin_30:
  ds_read_b32 v4, v1 offset:648
  s_waitcnt lgkmcnt(0)
  v_cmp_gt_u32 vcc, 1, v4
  s_nop 0
  s_cbranch_vccz L_sdone_31
  s_sleep 2
  s_sub_u32 s70, s70, 1
  s_cbranch_scc0 L_spin_30
L_sdone_31:
  v_readfirstlane_b32 s46, v4
  s_mov_b32 exec_lo, 0x55555555
  s_mov_b32 exec_hi, 0x0
  buffer_store_dwordx4 v[8:11], v2, s[32:35], s66 offen offset:1536
  s_mov_b64 exec, -1
  s_cmp_lg_u32 s46, 1
  s_cbranch_scc1 L_slow_32
L_back_33:
  s_branch L_qget
L_qwait:
  s_sleep 40
L_qget:
  s_lshr_b32 s66, s2, 7
  s_lshl2_add_u32 s66, s4, s66
  s_lshl_b32 s66, s66, 14
  s_lshl_b32 s68, s3, 11
  s_add_u32 s66, s66, s68
  v_and_b32 v2, 15, v0
  v_bfe_u32 v5, v0, 4, 1
  v_lshlrev_b32 v3, 3, v2
  v_add_u32 v3, s69, v3
  v_lshl_add_u32 v3, v5, 13, v3
  v_lshlrev_b32 v2, 4, v2
  v_lshl_add_u32 v2, v5, 15, v2
  s_mov_b32 s16, s32
  s_mov_b32 s17, s33
  s_mov_b32 s18, 4194304
  s_mov_b32 s19, 0x20000
  s_mov_b32 s70, 4000007
L_spin_34:
  buffer_load_dwordx4 v[12:15], v2, s[16:19], s66 offen offset:1536 sc1 nt
  s_waitcnt vmcnt(0)
  v_cmp_ne_u64 vcc, s[30:31], v[14:15]
  s_nop 0
  s_cbranch_vccz L_sdone_35
  s_sleep 8
  ds_read_b32 v4, v1 offset:648
  s_waitcnt lgkmcnt(0)
  v_readfirstlane_b32 s46, v4
  s_nop 0
  s_sub_u32 s68, s46, s65
  s_cmp_lg_u32 s68, 2
  s_cbranch_scc1 L_qlazy_36
  s_mov_b32 exec_lo, 0xff00ff
  s_mov_b32 exec_hi, 0xff00ff
  buffer_store_dwordx4 v[80:83], v90, s[24:27], s64 offen offset:0 sc1
  s_mov_b64 exec, -1
  s_mov_b32 s65, 1
L_qlazy_36:
  s_and_b32 s99, s70, 7
  s_cselect_b32 s16, s32, s24
  s_cselect_b32 s17, s33, s25
  s_sub_u32 s70, s70, 1
  s_cbranch_scc0 L_spin_34
L_sdone_35:
  ds_write_b64 v3, v[12:13] offset:0
  s_lshl_b32 s69, s3, 3
  v_mov_b32 v4, s69
  v_mov_b32 v6, 1
  s_waitcnt lgkmcnt(0)
  ds_write_b32 v4, v6 offset:384
  v_mov_b32 v1, 0
  s_mov_b32 s70, 4000007
L_spin_37:
  ds_read_b32 v4, v1 offset:648
  s_waitcnt lgkmcnt(0)
  v_cmp_gt_u32 vcc, 1, v4
  s_nop 0
  s_cbranch_vccz L_sdone_38
  s_sleep 2
  s_sub_u32 s70, s70, 1
  s_cbranch_scc0 L_spin_37
L_sdone_38:
  v_readfirstlane_b32 s46, v4
  ds_read_b32 v4, v1 offset:648
  s_waitcnt lgkmcnt(0)
  v_readfirstlane_b32 s46, v4
  s_nop 0
  s_sub_u32 s68, s46, s65
  s_cmp_lg_u32 s68, 2
  s_cbranch_scc1 L_qlazy_39
  s_mov_b32 exec_lo, 0xff00ff
  s_mov_b32 exec_hi, 0xff00ff
  buffer_store_dwordx4 v[80:83], v90, s[24:27], s64 offen offset:0 sc1
  s_mov_b64 exec, -1
  s_mov_b32 s65, 1
L_qlazy_39:
  s_branch L_stats
L_ids:
  s_setprio 3
  s_getreg_b32 s64, hwreg(HW_REG_XCC_ID)
  s_mov_b32 s24, s58
  s_mov_b32 s25, s59
  s_mov_b32 s26, 4194304
  s_mov_b32 s27, 0x20000
  s_add_u32 s32, s58, 4194304
  s_addc_u32 s33, s59, 0
  s_mov_b32 s34, 4194304
  s_mov_b32 s35, 0x20000
  s_lshl3_add_u32 s71, s6, s7
  s_mul_i32 s5, s79, 5
  s_mul_i32 s47, s79, 3
  s_add_u32 s47, s47, 15
  s_cmp_lt_u32 s7, 5
  s_cselect_b32 s5, s5, s47
  s_add_u32 s5, s5, s7
  s_waitcnt lgkmcnt(0)
  s_mul_i32 s30, s28, 0x2c9277b5
  s_add_u32 s30, s30, 0xac564b05
  s_mul_i32 s31, s29, 0x0019660d
  s_add_u32 s31, s31, 0x3c6ef35f
  s_and_b32 s64, s64, 15
  v_mov_b32 v4, s30
  v_mov_b32 v5, s31
  v_mov_b32 v6, s64
  v_mov_b32 v7, s64
  s_lshl_b32 s68, s4, 9
  s_add_u32 s68, s68, 2080768
  s_lshr_b32 s65, s2, 3
  s_lshl_b32 s69, s65, 4
  v_mov_b32 v1, s69
  s_mov_b64 exec, 1
  buffer_store_dwordx4 v[4:7], v1, s[32:35], s68 offen
  s_mov_b64 exec, -1
  s_cmp_lg_u32 s65, 31
  s_cbranch_scc1 L_noinit
  v_lshlrev_b32 v12, 8, v0
  s_lshl_b32 s69, s4, 15
  s_add_u32 s69, s69, 1703936
  s_mov_b32 exec_lo, 0x8040201
  s_mov_b32 exec_hi, 0x8040201
  buffer_store_dword v4, v12, s[24:27], s69 offen sc1
  s_mov_b64 exec, -1
L_noinit:
  v_and_b32 v1, 31, v0
  v_lshlrev_b32 v1, 4, v1
  s_mov_b32 s70, 12
  s_mov_b32 s46, 2
L_idpoll:
  s_sleep 16
  buffer_load_dwordx4 v[8:11], v1, s[32:35], s68 offen sc1 nt
  s_waitcnt vmcnt(0)
  v_cmp_ne_u64 vcc, s[30:31], v[8:9]
  s_nop 0
  s_cbranch_vccz L_iddone
  s_sub_u32 s70, s70, 1
  s_cbranch_scc0 L_idpoll
  s_branch L_idset
L_iddone:
  v_cmp_ne_u32 vcc, s64, v10
  s_nop 0
  s_cbranch_vccnz L_idset
  s_mov_b32 s46, 1
L_idset:
  v_mov_b32 v1, 0
  v_mov_b32 v4, s46
  ds_write_b32 v1, v4 offset:648
  s_cmp_lg_u32 s65, 31
  s_cbranch_scc1 L_pf
  s_lshl_b32 s69, s4, 15
  s_add_u32 s69, s69, 1703936
  s_add_u32 s22, s58, s69
  s_addc_u32 s23, s59, 0
  s_waitcnt lgkmcnt(0)
  s_mov_b32 s8, -1
  s_mov_b32 s9, -1
  s_memtime s[12:13]
  s_waitcnt lgkmcnt(0)
  s_load_dword s10, s[22:23], 0
  s_waitcnt lgkmcnt(0)
  s_memtime s[14:15]
  s_waitcnt lgkmcnt(0)
  s_sub_u32 s11, s14, s12
  s_min_u32 s8, s8, s11
  s_waitcnt lgkmcnt(0)
  s_load_dword s10, s[22:23], 8192
  s_waitcnt lgkmcnt(0)
  s_memtime s[12:13]
  s_waitcnt lgkmcnt(0)
  s_sub_u32 s11, s12, s14
  s_min_u32 s9, s9, s11
  s_waitcnt lgkmcnt(0)
  s_load_dword s10, s[22:23], 10496
  s_waitcnt lgkmcnt(0)
  s_memtime s[14:15]
  s_waitcnt lgkmcnt(0)
  s_sub_u32 s11, s14, s12
  s_min_u32 s9, s9, s11
  s_waitcnt lgkmcnt(0)
  s_load_dword s10, s[22:23], 2304
  s_waitcnt lgkmcnt(0)
  s_memtime s[12:13]
  s_waitcnt lgkmcnt(0)
  s_sub_u32 s11, s12, s14
  s_min_u32 s8, s8, s11
  s_waitcnt lgkmcnt(0)
  s_load_dword s10, s[22:23], 4608
  s_waitcnt lgkmcnt(0)
  s_memtime s[14:15]
  s_waitcnt lgkmcnt(0)
  s_sub_u32 s11, s14, s12
  s_min_u32 s8, s8, s11
  s_waitcnt lgkmcnt(0)
  s_load_dword s10, s[22:23], 12800
  s_waitcnt lgkmcnt(0)
  s_memtime s[12:13]
  s_waitcnt lgkmcnt(0)
  s_sub_u32 s11, s12, s14
  s_min_u32 s9, s9, s11
  s_waitcnt lgkmcnt(0)
  s_load_dword s10, s[22:23], 15104
  s_waitcnt lgkmcnt(0)
  s_memtime s[14:15]
  s_waitcnt lgkmcnt(0)
  s_sub_u32 s11, s14, s12
  s_min_u32 s9, s9, s11
  s_waitcnt lgkmcnt(0)
  s_load_dword s10, s[22:23], 6912
  s_waitcnt lgkmcnt(0)
  s_memtime s[12:13]
  s_waitcnt lgkmcnt(0)
  s_sub_u32 s11, s12, s14
  s_min_u32 s8, s8, s11
  s_cmp_gt_u32 s8, s9
  s_cselect_b32 s21, 1, 0
  v_mov_b32 v4, s21
  v_mov_b32 v5, s62
  v_mov_b32 v6, s30
  v_mov_b32 v7, s31
  s_lshl_b32 s69, s4, 4
  s_add_u32 s69, s69, 950272
  s_mov_b64 exec, 1
  buffer_store_dwordx4 v[4:7], v1, s[24:27], s69 offen sc1
  s_mov_b64 exec, -1
L_pf:
  s_mov_b32 s65, 0
  s_cmp_lg_u32 s7, 6
  s_cbranch_scc1 L_nosample0
  v_mov_b32 v1, 0
  s_mov_b32 s70, 4000007
L_spin_40:
  ds_read_b64 v[4:5], v1 offset:696
  s_waitcnt lgkmcnt(0)
  v_cmp_gt_u32 vcc, 8, v5
  s_nop 0
  s_cbranch_vccz L_sdone_41
  s_sleep 2
  s_sub_u32 s70, s70, 1
  s_cbranch_scc0 L_spin_40
L_sdone_41:
  v_mov_b32 v5, s31
  v_lshlrev_b32 v6, 9, v0
  s_lshl_b32 s68, s6, 3
  s_add_u32 s68, s68, 958464
  s_mov_b64 exec, 7
  buffer_store_dwordx2 v[4:5], v6, s[24:27], s68 offen sc1
  s_mov_b64 exec, -1
L_nosample0:
  v_mov_b32 v1, 0
  s_mov_b32 s70, 4000007
L_spin_42:
  ds_read_b32 v12, v1 offset:692
  s_waitcnt lgkmcnt(0)
  v_cmp_gt_u32 vcc, 8, v12
  s_nop 0
  s_cbranch_vccz L_sdone_43
  s_sleep 4
  s_sub_u32 s70, s70, 1
  s_cbranch_scc0 L_spin_42
L_sdone_43:
  s_add_u32 s60, s58, 958464
  s_addc_u32 s61, s59, 0
  s_mov_b32 s70, 2
L_calpoll0:
  s_lshl_b32 s96, s62, 8
  s_sub_u32 s96, 0, s96
  s_mov_b32 s97, 0
  s_load_dwordx16 s[8:23], s[60:61], 0
  s_load_dwordx16 s[80:95], s[60:61], 64
  s_waitcnt lgkmcnt(0)
  s_add_u32 s96, s96, s8
  s_cmp_lg_u32 s9, s31
  s_addc_u32 s97, s97, 0
  s_add_u32 s96, s96, s10
  s_cmp_lg_u32 s11, s31
  s_addc_u32 s97, s97, 0
  s_add_u32 s96, s96, s12
  s_cmp_lg_u32 s13, s31
  s_addc_u32 s97, s97, 0
  s_add_u32 s96, s96, s14
  s_cmp_lg_u32 s15, s31
  s_addc_u32 s97, s97, 0
  s_add_u32 s96, s96, s16
  s_cmp_lg_u32 s17, s31
  s_addc_u32 s97, s97, 0
  s_add_u32 s96, s96, s18
  s_cmp_lg_u32 s19, s31
  s_addc_u32 s97, s97, 0
  s_add_u32 s96, s96, s20
  s_cmp_lg_u32 s21, s31
  s_addc_u32 s97, s97, 0
  s_add_u32 s96, s96, s22
  s_cmp_lg_u32 s23, s31
  s_addc_u32 s97, s97, 0
  s_add_u32 s96, s96, s80
  s_cmp_lg_u32 s81, s31
  s_addc_u32 s97, s97, 0
  s_add_u32 s96, s96, s82
  s_cmp_lg_u32 s83, s31
  s_addc_u32 s97, s97, 0
  s_add_u32 s96, s96, s84
  s_cmp_lg_u32 s85, s31
  s_addc_u32 s97, s97, 0
  s_add_u32 s96, s96, s86
  s_cmp_lg_u32 s87, s31
  s_addc_u32 s97, s97, 0
  s_add_u32 s96, s96, s88
  s_cmp_lg_u32 s89, s31
  s_addc_u32 s97, s97, 0
  s_add_u32 s96, s96, s90
  s_cmp_lg_u32 s91, s31
  s_addc_u32 s97, s97, 0
  s_add_u32 s96, s96, s92
  s_cmp_lg_u32 s93, s31
  s_addc_u32 s97, s97, 0
  s_add_u32 s96, s96, s94
  s_cmp_lg_u32 s95, s31
  s_addc_u32 s97, s97, 0
  s_load_dwordx16 s[8:23], s[60:61], 128
  s_load_dwordx16 s[80:95], s[60:61], 192
  s_waitcnt lgkmcnt(0)
  s_add_u32 s96, s96, s8
  s_cmp_lg_u32 s9, s31
  s_addc_u32 s97, s97, 0
  s_add_u32 s96, s96, s10
  s_cmp_lg_u32 s11, s31
  s_addc_u32 s97, s97, 0
  s_add_u32 s96, s96, s12
  s_cmp_lg_u32 s13, s31
  s_addc_u32 s97, s97, 0
  s_add_u32 s96, s96, s14
  s_cmp_lg_u32 s15, s31
  s_addc_u32 s97, s97, 0
  s_add_u32 s96, s96, s16
  s_cmp_lg_u32 s17, s31
  s_addc_u32 s97, s97, 0
  s_add_u32 s96, s96, s18
  s_cmp_lg_u32 s19, s31
  s_addc_u32 s97, s97, 0
  s_add_u32 s96, s96, s20
  s_cmp_lg_u32 s21, s31
  s_addc_u32 s97, s97, 0
  s_add_u32 s96, s96, s22
  s_cmp_lg_u32 s23, s31
  s_addc_u32 s97, s97, 0
  s_add_u32 s96, s96, s80
  s_cmp_lg_u32 s81, s31
  s_addc_u32 s97, s97, 0
  s_add_u32 s96, s96, s82
  s_cmp_lg_u32 s83, s31
  s_addc_u32 s97, s97, 0
  s_add_u32 s96, s96, s84
  s_cmp_lg_u32 s85, s31
  s_addc_u32 s97, s97, 0
  s_add_u32 s96, s96, s86
  s_cmp_lg_u32 s87, s31
  s_addc_u32 s97, s97, 0
  s_add_u32 s96, s96, s88
  s_cmp_lg_u32 s89, s31
  s_addc_u32 s97, s97, 0
  s_add_u32 s96, s96, s90
  s_cmp_lg_u32 s91, s31
  s_addc_u32 s97, s97, 0
  s_add_u32 s96, s96, s92
  s_cmp_lg_u32 s93, s31
  s_addc_u32 s97, s97, 0
  s_add_u32 s96, s96, s94
  s_cmp_lg_u32 s95, s31
  s_addc_u32 s97, s97, 0
  s_cmp_eq_u32 s97, 0
  s_cbranch_scc1 L_calok0
  s_add_u32 s60, s60, 512
  s_addc_u32 s61, s61, 0
  s_sub_u32 s70, s70, 1
  s_cbranch_scc1 L_stats
  s_sleep 20
  s_branch L_calpoll0
L_calok0:
  s_ashr_i32 s96, s96, 4
  s_mov_b32 s68, 352
  s_cmp_lt_u32 s5, 30
  s_cselect_b32 s68, -208, s68
  s_cmp_lt_u32 s5, 20
  s_cselect_b32 s68, 112, s68
  s_lshl4_add_u32 s68, s62, s68
  s_add_u32 s68, s68, s96
  s_mov_b32 s66, s68
  s_mov_b32 s65, -1
  v_mov_b32 v12, s68
  v_mov_b32 v13, -1
  ds_write_b64 v1, v[12:13] offset:680
L_stats:
  v_and_b32 v1, 7, v0
  v_lshlrev_b32 v1, 4, v1
  s_mov_b32 s70, 4000007
L_spin_44:
  ds_read_b128 v[4:7], v1 offset:512
  s_waitcnt lgkmcnt(0)
  v_cmp_eq_u32 vcc, 0, v7
  s_nop 0
  s_cbranch_vccz L_sdone_45
  s_sleep 4
  s_sub_u32 s70, s70, 1
  s_cbranch_scc0 L_spin_44
L_sdone_45:
  s_cmp_lg_u32 s3, 3
  s_cbranch_scc1 L_nostat
  v_and_b32 v12, 8, v0
  v_cmp_ne_u32 vcc, 0, v12
  v_lshlrev_b32 v12, 6, v12
  s_nop 0
  v_cndmask_b32 v4, v4, v6, vcc
  v_cndmask_b32 v5, v5, v7, vcc
  s_mov_b32 s68, 0x3fb8aa3b
  v_mov_b32 v2, v4
  s_nop 1
  v_max_f32_dpp v2, v2, v2 quad_perm:[1,0,3,2] row_mask:0xf bank_mask:0xf
  s_nop 1
  v_max_f32_dpp v2, v2, v2 quad_perm:[2,3,0,1] row_mask:0xf bank_mask:0xf
  s_nop 1
  v_max_f32_dpp v2, v2, v2 row_half_mirror row_mask:0xf bank_mask:0xf
  v_sub_f32 v4, v4, v2
  v_mul_f32 v4, s68, v4
  v_exp_f32 v4, v4
  s_nop 0
  v_mul_f32 v3, v4, v5
  s_nop 1
  v_add_f32_dpp v3, v3, v3 quad_perm:[1,0,3,2] row_mask:0xf bank_mask:0xf
  s_nop 1
  v_add_f32_dpp v3, v3, v3 quad_perm:[2,3,0,1] row_mask:0xf bank_mask:0xf
  s_nop 1
  v_add_f32_dpp v3, v3, v3 row_half_mirror row_mask:0xf bank_mask:0xf
  s_lshr_b32 s68, s2, 7
  s_lshl2_add_u32 s68, s4, s68
  s_bfe_u32 s69, s2, 0x40003
  s_lshl4_add_u32 s68, s68, s69
  s_lshl_b32 s68, s68, 4
  s_add_u32 s68, s68, 2064384
  v_mov_b32 v4, s30
  v_mov_b32 v5, s31
  s_mov_b32 exec_lo, 0x101
  s_mov_b32 exec_hi, 0x0
  buffer_store_dwordx4 v[2:5], v12, s[32:35], s68 offen
  s_mov_b64 exec, -1
  s_cmp_lg_u32 s46, 1
  s_cbranch_scc1 L_slow_46
L_back_47:
  s_mov_b32 s68, 950272
  s_mov_b32 s70, 4000007
L_spin_48:
  buffer_load_dwordx4 v[8:11], v1, s[24:27], s68 offen sc1
  s_waitcnt vmcnt(0)
  v_cmp_ne_u64 vcc, s[30:31], v[10:11]
  s_nop 0
  s_cbranch_vccz L_sdone_49
  s_sleep 8
  s_sub_u32 s70, s70, 1
  s_cbranch_scc0 L_spin_48
L_sdone_49:
  v_cmp_ne_u32 vcc, 0, v8
  s_nop 0
  s_and_b32 s67, vcc_lo, 0xff
  s_bitset1_b32 s67, 8
  v_mov_b32 v4, s67
  v_mov_b32 v1, 0
  ds_write_b32 v1, v4 offset:660
L_nostat:
  s_cmp_lg_u32 s3, 2
  s_cbranch_scc1 L_noa
  v_min_u32 v12, 47, v0
  v_lshrrev_b32 v13, 3, v12
  v_lshlrev_b32 v13, 11, v13
  v_and_b32 v14, 1, v12
  v_lshl_add_u32 v13, v14, 10, v13
  v_bfe_u32 v14, v12, 1, 2
  v_lshl_add_u32 v13, v14, 8, v13
  v_lshlrev_b32 v12, 4, v12
  s_lshr_b32 s74, s2, 7
  s_lshl2_add_u32 s74, s4, s74
  s_mul_i32 s74, s74, 12288
  s_bfe_u32 s69, s2, 0x40003
  s_lshl4_add_u32 s74, s69, s74
  s_add_u32 s74, s74, 524288
  s_mov_b32 s22, 0x55555555
  s_mov_b32 s23, 0x55555555
  v_mov_b32 v14, s30
  v_mov_b32 v15, s31
  v_mov_b32 v1, 0
  s_mov_b32 s70, 4000007
L_spin_50:
  ds_read_b32 v4, v1 offset:652
  s_waitcnt lgkmcnt(0)
  v_cmp_gt_u32 vcc, 8, v4
  s_nop 0
  s_cbranch_vccz L_sdone_51
  s_sleep 4
  s_sub_u32 s70, s70, 1
  s_cbranch_scc0 L_spin_50
L_sdone_51:
  v_mov_b32 v1, 0
  s_mov_b32 s70, 4000007
L_spin_52:
  ds_read_b32 v4, v1 offset:644
  s_waitcnt lgkmcnt(0)
  v_cmp_gt_u32 vcc, 1, v4
  s_nop 0
  s_cbranch_vccz L_sdone_53
  s_sleep 2
  s_sub_u32 s70, s70, 1
  s_cbranch_scc0 L_spin_52
L_sdone_53:
  ds_read_b128 v[16:19], v12 offset:57856
  ds_read_b128 v[20:23], v12 offset:58624
  ds_read_b128 v[24:27], v12 offset:59392
  ds_read_b128 v[28:31], v12 offset:60160
  ds_read_b128 v[32:35], v12 offset:60928
  ds_read_b128 v[36:39], v12 offset:61696
  ds_read_b128 v[40:43], v12 offset:62464
  ds_read_b128 v[44:47], v12 offset:63232
  s_waitcnt lgkmcnt(6)
  v_pk_add_f32 v[16:17], v[16:17], v[20:21]
  v_pk_add_f32 v[18:19], v[18:19], v[22:23]
  s_waitcnt lgkmcnt(4)
  v_pk_add_f32 v[24:25], v[24:25], v[28:29]
  v_pk_add_f32 v[26:27], v[26:27], v[30:31]
  v_pk_add_f32 v[16:17], v[16:17], v[24:25]
  v_pk_add_f32 v[18:19], v[18:19], v[26:27]
  s_waitcnt lgkmcnt(2)
  v_pk_add_f32 v[32:33], v[32:33], v[36:37]
  v_pk_add_f32 v[34:35], v[34:35], v[38:39]
  s_waitcnt lgkmcnt(0)
  v_pk_add_f32 v[40:41], v[40:41], v[44:45]
  v_pk_add_f32 v[42:43], v[42:43], v[46:47]
  v_pk_add_f32 v[32:33], v[32:33], v[40:41]
  v_pk_add_f32 v[34:35], v[34:35], v[42:43]
  v_pk_add_f32 v[4:5], v[16:17], v[32:33]
  v_pk_add_f32 v[6:7], v[18:19], v[34:35]
  v_cvt_pk_bf16_f32 v8, v4, v5
  v_cvt_pk_bf16_f32 v9, v6, v7
  v_cndmask_b32 v4, v8, v14, s[22:23]
  v_cndmask_b32 v5, v9, v15, s[22:23]
  v_cndmask_b32 v6, v14, v8, s[22:23]
  v_cndmask_b32 v7, v15, v9, s[22:23]
  s_mov_b32 exec_lo, 0xffffffff
  s_mov_b32 exec_hi, 0xffff
  buffer_store_dwordx4 v[4:7], v13, s[32:35], s74 offen
  s_mov_b64 exec, -1
  s_cmp_lg_u32 s46, 1
  s_cbranch_scc1 L_slow_54
L_back_55:
L_noa:
  s_cmp_lt_u32 s5, 20
  s_cbranch_scc0 L_helper_exit
  s_cmp_ge_u32 s5, 10
  s_cselect_b32 s76, 1, 0
  s_mul_i32 s77, s76, 10
  s_sub_u32 s77, s5, s77
  s_lshr_b32 s78, s3, 1
  v_and_b32 v2, 48, v0
  s_lshl_b32 s68, s78, 6
  v_add_u32 v22, s68, v2
  v_lshlrev_b32 v60, 4, v0
  s_lshl1_add_u32 s73, s4, s78
  s_lshl1_add_u32 s73, s73, s76
  s_lshl1_add_u32 s73, s73, s3
  s_lshl_b32 s68, s78, 1
  s_sub_u32 s73, s73, s68
  s_mul_i32 s73, s73, 6144
  s_add_u32 s73, s73, 524288
  s_add_u32 s74, s73, 4096
  v_lshlrev_b32 v62, 2, v0
  s_lshl_b32 s68, s3, 8
  v_add_u32 v61, s68, v62
  v_lshrrev_b32 v2, 5, v0
  v_lshlrev_b32 v2, 11, v2
  v_bfe_u32 v3, v0, 2, 3
  v_lshl_add_u32 v2, v3, 4, v2
  v_and_b32 v3, 1, v0
  v_lshl_add_u32 v63, v3, 13, v2
  s_lshr_b32 s75, s77, 1
  s_lshl_b32 s75, s75, 14
  s_and_b32 s68, s77, 1
  s_lshl_b32 s68, s68, 12
  s_add_u32 s75, s75, s68
  s_lshl1_add_u32 s68, s4, s76
  s_lshl_b32 s68, s68, 7
  s_add_u32 s75, s75, s68
  s_add_u32 s75, s75, 1966080
  s_mov_b32 s8, 0x33333333
  s_mov_b32 s9, 0x33333333
  v_mov_b32 v50, s30
  v_mov_b32 v51, s31
  v_lshrrev_b32 v24, 4, v0
  v_lshlrev_b32 v24, 10, v24
  v_bfe_u32 v25, v0, 2, 2
  v_lshl_add_u32 v24, v25, 7, v24
  v_and_b32 v25, 3, v0
  v_lshl_add_u32 v24, v25, 3, v24
  s_mul_i32 s69, s3, 12288
  v_add_u32 v24, s69, v24
  s_cmp_lg_u32 s3, 0
  s_cbranch_scc1 L_noc
  s_lshl2_add_u32 s72, s4, s76
  s_lshl_b32 s72, s72, 8
  s_add_u32 s72, s72, 2064384
  v_and_b32 v1, 15, v0
  v_lshlrev_b32 v1, 4, v1
  v_and_b32 v2, 16, v0
  v_lshl_add_u32 v1, v2, 5, v1
  s_mov_b32 s16, s32
  s_mov_b32 s17, s33
  s_mov_b32 s18, 4194304
  s_mov_b32 s19, 0x20000
  s_mov_b32 s70, 4000007
L_spin_56:
  s_sleep 24
  buffer_load_dwordx4 v[4:7], v1, s[16:19], s72 offen sc1 nt
  s_waitcnt vmcnt(0)
  v_cmp_ne_u64 vcc, s[30:31], v[6:7]
  s_nop 0
  s_cbranch_vccz L_sdone_57
  s_and_b32 s99, s70, 7
  s_cmp_eq_u32 s46, 1
  s_cselect_b32 s99, 1, s99
  s_cmp_lg_u32 s99, 0
  s_cselect_b32 s16, s32, s24
  s_cselect_b32 s17, s33, s25
  s_sub_u32 s70, s70, 1
  s_cbranch_scc0 L_spin_56
L_sdone_57:
  s_mov_b32 s68, 0x3fb8aa3b
  v_mov_b32 v2, v4
  s_nop 1
  v_max_f32_dpp v2, v2, v2 quad_perm:[1,0,3,2] row_mask:0xf bank_mask:0xf
  s_nop 1
  v_max_f32_dpp v2, v2, v2 quad_perm:[2,3,0,1] row_mask:0xf bank_mask:0xf
  s_nop 1
  v_max_f32_dpp v2, v2, v2 row_half_mirror row_mask:0xf bank_mask:0xf
  s_nop 1
  v_max_f32_dpp v2, v2, v2 row_mirror row_mask:0xf bank_mask:0xf
  v_sub_f32 v4, v4, v2
  v_mul_f32 v4, s68, v4
  v_exp_f32 v4, v4
  s_nop 0
  v_mul_f32 v3, v4, v5
  s_nop 1
  v_add_f32_dpp v3, v3, v3 quad_perm:[1,0,3,2] row_mask:0xf bank_mask:0xf
  s_nop 1
  v_add_f32_dpp v3, v3, v3 quad_perm:[2,3,0,1] row_mask:0xf bank_mask:0xf
  s_nop 1
  v_add_f32_dpp v3, v3, v3 row_half_mirror row_mask:0xf bank_mask:0xf
  s_nop 1
  v_add_f32_dpp v3, v3, v3 row_mirror row_mask:0xf bank_mask:0xf
  v_rcp_f32 v3, v3
  v_and_b32 v1, 0x7c, v62
  v_mul_f32 v4, v4, v3
  v_mov_b32 v2, 0
  v_mov_b32 v3, 1
  ds_write_b32 v1, v4 offset:768
  ds_write_b32 v2, v3 offset:664
L_noc:
  v_mov_b32 v1, 0
  s_mov_b32 s70, 4000007
L_spin_58:
  ds_read_b32 v4, v1 offset:664
  s_waitcnt lgkmcnt(0)
  v_cmp_gt_u32 vcc, 1, v4
  s_nop 0
  s_cbranch_vccz L_sdone_59
  s_sleep 2
  s_sub_u32 s70, s70, 1
  s_cbranch_scc0 L_spin_58
L_sdone_59:
  ds_read_b128 v[56:59], v22 offset:768
  s_mov_b32 s12, s44
  s_mov_b32 s13, s45
  s_mov_b32 s14, 7864320
  s_mov_b32 s15, 0x20000
  v_lshrrev_b32 v21, 3, v0
  v_mul_u32_u24 v21, 1280, v21
  v_and_b32 v3, 7, v0
  v_lshl_add_u32 v21, v3, 4, v21
  s_lshl1_add_u32 s60, s4, s76
  s_mul_i32 s68, s78, 16
  s_add_u32 s60, s60, s68
  s_add_u32 s60, s60, 0
  s_and_b32 s68, s3, 1
  s_lshl1_add_u32 s60, s60, s68
  s_mul_i32 s60, s60, 122880
  s_lshl_b32 s69, s77, 7
  s_add_u32 s60, s60, s69
  s_mul_i32 s61, s3, 12288
  s_add_u32 s61, s61, 8704
  v_mov_b32 v23, 1
  s_lshl_b32 s68, s3, 2
  v_mov_b32 v25, s68
  v_mov_b32 v1, 0
  s_mov_b32 s70, 4000007
L_spin_60:
  ds_read_b32 v4, v1 offset:660
  s_waitcnt lgkmcnt(0)
  v_cmp_gt_u32 vcc, 1, v4
  s_nop 0
  s_cbranch_vccz L_sdone_61
  s_sleep 4
  s_sub_u32 s70, s70, 1
  s_cbranch_scc0 L_spin_60
L_sdone_61:
  v_readfirstlane_b32 s47, v4
  v_mov_b32 v1, 0
  s_mov_b32 s70, 4000007
L_spin_62:
  ds_read_b32 v4, v1 offset:644
  s_waitcnt lgkmcnt(0)
  v_cmp_gt_u32 vcc, 8, v4
  s_nop 0
  s_cbranch_vccz L_sdone_63
  s_sleep 2
  s_sub_u32 s70, s70, 1
  s_cbranch_scc0 L_spin_62
L_sdone_63:
  s_cmp_lg_u32 s78, 0
  s_cbranch_scc1 L_nofirst
L_nofirst:
  s_mov_b32 m0, s61
  s_nop 0
  buffer_load_dwordx4 v21, s[12:15], s60 offen nt lds
  s_add_u32 s60, s60, 10240
  s_add_u32 s61, s61, 1024
  s_mov_b32 m0, s61
  s_nop 0
  buffer_load_dwordx4 v21, s[12:15], s60 offen nt lds
  s_add_u32 s60, s60, 10240
  s_add_u32 s61, s61, 1024
  s_mov_b32 m0, s61
  s_nop 0
  buffer_load_dwordx4 v21, s[12:15], s60 offen nt lds
  s_add_u32 s60, s60, 10240
  s_add_u32 s61, s61, 1024
  s_mov_b32 m0, s61
  s_nop 0
  buffer_load_dwordx4 v21, s[12:15], s60 offen nt lds
  s_add_u32 s60, s60, 10240
  s_add_u32 s61, s61, 1024
  s_mov_b32 m0, s61
  s_nop 0
  buffer_load_dwordx4 v21, s[12:15], s60 offen nt lds
  s_add_u32 s60, s60, 10240
  s_add_u32 s61, s61, 1024
  s_mov_b32 m0, s61
  s_nop 0
  buffer_load_dwordx4 v21, s[12:15], s60 offen nt lds
  s_add_u32 s60, s60, 10240
  s_add_u32 s61, s61, 1024
  s_waitcnt vmcnt(5)
  s_mov_b32 m0, s61
  s_nop 0
  buffer_load_dwordx4 v21, s[12:15], s60 offen nt lds
  s_add_u32 s60, s60, 10240
  s_add_u32 s61, s61, 1024
  s_waitcnt vmcnt(5)
  s_mov_b32 m0, s61
  s_nop 0
  buffer_load_dwordx4 v21, s[12:15], s60 offen nt lds
  s_add_u32 s60, s60, 10240
  s_add_u32 s61, s61, 1024
  s_waitcnt vmcnt(5)
  s_mov_b32 m0, s61
  s_nop 0
  buffer_load_dwordx4 v21, s[12:15], s60 offen nt lds
  s_add_u32 s60, s60, 10240
  s_add_u32 s61, s61, 1024
  s_waitcnt vmcnt(5)
  s_mov_b32 m0, s61
  s_nop 0
  buffer_load_dwordx4 v21, s[12:15], s60 offen nt lds
  s_add_u32 s60, s60, 10240
  s_add_u32 s61, s61, 1024
  s_waitcnt vmcnt(5)
  s_mov_b32 m0, s61
  s_nop 0
  buffer_load_dwordx4 v21, s[12:15], s60 offen nt lds
  s_add_u32 s60, s60, 10240
  s_add_u32 s61, s61, 1024
  s_waitcnt vmcnt(5)
  s_mov_b32 m0, s61
  s_nop 0
  buffer_load_dwordx4 v21, s[12:15], s60 offen nt lds
  s_waitcnt vmcnt(4)
  ds_read_b64_tr_b16 v[64:65], v24 offset:8704
  ds_read_b64_tr_b16 v[66:67], v24 offset:9216
  ds_read_b64_tr_b16 v[68:69], v24 offset:8736
  ds_read_b64_tr_b16 v[70:71], v24 offset:9248
  ds_read_b64_tr_b16 v[72:73], v24 offset:8768
  ds_read_b64_tr_b16 v[74:75], v24 offset:9280
  ds_read_b64_tr_b16 v[76:77], v24 offset:8800
  ds_read_b64_tr_b16 v[78:79], v24 offset:9312
  ds_read_b64_tr_b16 v[80:81], v24 offset:12800
  ds_read_b64_tr_b16 v[82:83], v24 offset:13312
  ds_read_b64_tr_b16 v[84:85], v24 offset:12832
  ds_read_b64_tr_b16 v[86:87], v24 offset:13344
  ds_read_b64_tr_b16 v[88:89], v24 offset:12864
  ds_read_b64_tr_b16 v[90:91], v24 offset:13376
  ds_read_b64_tr_b16 v[92:93], v24 offset:12896
  ds_read_b64_tr_b16 v[94:95], v24 offset:13408
  v_mov_b32 v1, 0
  s_mov_b32 s70, 4000007
L_spin_64:
  ds_read_b32 v4, v1 offset:668
  s_waitcnt lgkmcnt(0)
  v_cmp_gt_u32 vcc, 1, v4
  s_nop 0
  s_cbranch_vccz L_sdone_65
  s_sleep 1
  s_sub_u32 s70, s70, 1
  s_cbranch_scc0 L_spin_64
L_sdone_65:
  s_waitcnt vmcnt(0)
  buffer_load_dwordx4 v[144:147], v60, s[32:35], s73 offen offset:0 sc1
  buffer_load_dwordx4 v[148:151], v60, s[32:35], s73 offen offset:1024 sc1
  buffer_load_dwordx4 v[152:155], v60, s[32:35], s73 offen offset:2048 sc1
  buffer_load_dwordx4 v[156:159], v60, s[32:35], s73 offen offset:3072 sc1
  buffer_load_dwordx4 v[160:163], v60, s[32:35], s74 offen offset:0 sc1
  buffer_load_dwordx4 v[164:167], v60, s[32:35], s74 offen offset:1024 sc1
  s_waitcnt vmcnt(6)
L_both:
  ds_read_b64_tr_b16 v[96:97], v24 offset:16896
  ds_read_b64_tr_b16 v[98:99], v24 offset:17408
  ds_read_b64_tr_b16 v[100:101], v24 offset:16928
  ds_read_b64_tr_b16 v[102:103], v24 offset:17440
  ds_read_b64_tr_b16 v[104:105], v24 offset:16960
  ds_read_b64_tr_b16 v[106:107], v24 offset:17472
  ds_read_b64_tr_b16 v[108:109], v24 offset:16992
  ds_read_b64_tr_b16 v[110:111], v24 offset:17504
  s_mov_b32 s16, s32
  s_mov_b32 s17, s33
  s_mov_b32 s18, 4194304
  s_mov_b32 s19, 0x20000
  s_mov_b32 s70, 4000007
  s_branch L_opw
L_spin_66:
  buffer_load_dwordx4 v[144:147], v60, s[16:19], s73 offen offset:0 sc1
  buffer_load_dwordx4 v[148:151], v60, s[16:19], s73 offen offset:1024 sc1
  buffer_load_dwordx4 v[152:155], v60, s[16:19], s73 offen offset:2048 sc1
  buffer_load_dwordx4 v[156:159], v60, s[16:19], s73 offen offset:3072 sc1
  buffer_load_dwordx4 v[160:163], v60, s[16:19], s74 offen offset:0 sc1
  buffer_load_dwordx4 v[164:167], v60, s[16:19], s74 offen offset:1024 sc1
L_opw:
  s_waitcnt vmcnt(4)
  v_mfma_f32_16x16x32_bf16 v[32:35], v[146:149], v[64:67], 0
  v_cmp_ne_u64 vcc, s[30:31], v[144:145]
  v_cmp_ne_u64 s[22:23], s[30:31], v[150:151]
  v_mfma_f32_16x16x32_bf16 v[36:39], v[146:149], v[68:71], 0
  s_or_b64 vcc, vcc, s[22:23]
  v_mfma_f32_16x16x32_bf16 v[40:43], v[146:149], v[72:75], 0
  v_mfma_f32_16x16x32_bf16 v[44:47], v[146:149], v[76:79], 0
  s_waitcnt vmcnt(2)
  v_mfma_f32_16x16x32_bf16 v[32:35], v[154:157], v[80:83], v[32:35]
  v_cmp_ne_u64 s[20:21], s[30:31], v[152:153]
  v_cmp_ne_u64 s[22:23], s[30:31], v[158:159]
  v_mfma_f32_16x16x32_bf16 v[36:39], v[154:157], v[84:87], v[36:39]
  s_or_b64 vcc, vcc, s[20:21]
  s_or_b64 vcc, vcc, s[22:23]
  v_mfma_f32_16x16x32_bf16 v[40:43], v[154:157], v[88:91], v[40:43]
  v_mfma_f32_16x16x32_bf16 v[44:47], v[154:157], v[92:95], v[44:47]
  s_waitcnt vmcnt(0) lgkmcnt(0)
  v_mfma_f32_16x16x32_bf16 v[32:35], v[162:165], v[96:99], v[32:35]
  v_cmp_ne_u64 s[20:21], s[30:31], v[160:161]
  v_cmp_ne_u64 s[22:23], s[30:31], v[166:167]
  v_mfma_f32_16x16x32_bf16 v[36:39], v[162:165], v[100:103], v[36:39]
  s_or_b64 vcc, vcc, s[20:21]
  s_or_b64 vcc, vcc, s[22:23]
  v_mfma_f32_16x16x32_bf16 v[40:43], v[162:165], v[104:107], v[40:43]
  v_mfma_f32_16x16x32_bf16 v[44:47], v[162:165], v[108:111], v[44:47]
  s_nop 0
  s_cbranch_vccz L_sdone_67
  s_and_b32 s99, s70, 7
  s_cmp_eq_u32 s46, 1
  s_cselect_b32 s99, 1, s99
  s_cmp_lg_u32 s99, 0
  s_cselect_b32 s16, s32, s24
  s_cselect_b32 s17, s33, s25
  s_sub_u32 s70, s70, 1
  s_cbranch_scc0 L_spin_66
L_sdone_67:
  v_mul_f32 v4, v32, v56
  v_fmac_f32 v4, v33, v57
  v_fmac_f32 v4, v34, v58
  v_fmac_f32 v4, v35, v59
  v_mul_f32 v5, v36, v56
  v_fmac_f32 v5, v37, v57
  v_fmac_f32 v5, v38, v58
  v_fmac_f32 v5, v39, v59
  v_mul_f32 v6, v40, v56
  v_fmac_f32 v6, v41, v57
  v_fmac_f32 v6, v42, v58
  v_fmac_f32 v6, v43, v59
  v_mul_f32 v7, v44, v56
  v_fmac_f32 v7, v45, v57
  v_fmac_f32 v7, v46, v58
  v_fmac_f32 v7, v47, v59
  v_permlane32_swap_b32 v4, v6
  s_nop 0
  v_permlane32_swap_b32 v5, v7
  v_add_f32 v4, v4, v6
  v_add_f32 v5, v5, v7
  s_nop 1
  v_permlane16_swap_b32 v4, v5
  v_add_f32 v4, v4, v5
  ds_write_b32 v61, v4 offset:7168
  s_cmp_lg_u32 s3, 0
  s_waitcnt lgkmcnt(0)
  s_barrier
  s_cbranch_scc1 L_post_wo
  ds_read_b32 v5, v62 offset:7424
  ds_read_b32 v6, v62 offset:7680
  ds_read_b32 v7, v62 offset:7936
  s_waitcnt lgkmcnt(0)
  v_add_f32 v4, v4, v5
  v_add_f32 v6, v6, v7
  v_add_f32 v4, v4, v6
  s_nop 1
  v_mov_b32_dpp v5, v4 quad_perm:[1,0,3,2] row_mask:0xf bank_mask:0xf
  v_cvt_pk_bf16_f32 v4, v4, v5
  s_nop 1
  v_mov_b32_dpp v48, v4 quad_perm:[0,0,0,0] row_mask:0xf bank_mask:0xf
  v_mov_b32_dpp v49, v4 quad_perm:[2,2,2,2] row_mask:0xf bank_mask:0xf
  s_mov_b64 exec, s[8:9]
  buffer_store_dwordx4 v[48:51], v63, s[24:27], s75 offen sc1
  s_barrier
  s_endpgm
L_helper_exit:
  s_endpgm
L_f1:
  s_mov_b32 s12, s48
  s_mov_b32 s13, s49
  s_mov_b32 s14, 1966080
  s_mov_b32 s15, 0x20000
  s_mov_b32 s16, s50
  s_mov_b32 s17, s51
  s_mov_b32 s18, 1966080
  s_mov_b32 s19, 0x20000
  s_sub_u32 s74, s5, 20
  v_lshrrev_b32 v3, 4, v0
  v_and_b32 v2, 7, v0
  v_lshrrev_b32 v62, 3, v0
  v_mul_u32_u24 v62, 3072, v62
  v_lshl_add_u32 v62, v2, 4, v62
  s_lshl3_add_u32 s61, s74, s73
  s_mul_i32 s61, s61, 24576
  s_mul_i32 s68, s4, 384
  s_add_u32 s61, s61, s68
  s_add_u32 s62, s61, 128
  s_add_u32 s63, s61, 256
  s_lshl_b32 s79, s73, 10
  s_add_u32 s79, s79, 8704
  v_mov_b32 v57, 0
  v_mov_b32 v6, s30
  v_mov_b32 v7, s31
  v_mov_b32 v1, 0
  s_mov_b32 s70, 4000007
L_spin_68:
  ds_read_b32 v4, v1 offset:668
  s_waitcnt lgkmcnt(0)
  v_cmp_gt_u32 vcc, 1, v4
  s_nop 0
  s_cbranch_vccz L_sdone_69
  s_sleep 1
  s_sub_u32 s70, s70, 1
  s_cbranch_scc0 L_spin_68
L_sdone_69:
  s_add_u32 m0, s79, 0
  s_nop 0
  buffer_load_dwordx4 v62, s[12:15], s61 offen nt lds
  s_add_u32 m0, s79, 24576
  s_nop 0
  buffer_load_dwordx4 v62, s[16:19], s61 offen nt lds
  s_add_u32 m0, s79, 8192
  s_nop 0
  buffer_load_dwordx4 v62, s[12:15], s62 offen nt lds
  s_add_u32 m0, s79, 32768
  s_nop 0
  buffer_load_dwordx4 v62, s[16:19], s62 offen nt lds
  s_add_u32 m0, s79, 16384
  s_nop 0
  buffer_load_dwordx4 v62, s[12:15], s63 offen nt lds
  s_add_u32 m0, s79, 40960
  s_nop 0
  buffer_load_dwordx4 v62, s[16:19], s63 offen nt lds
  s_setprio 3
  s_cmp_gt_u32 s73, 1
  s_cbranch_scc1 L_f1m
  v_mov_b32 v1, 0
  s_mov_b32 s70, 4000007
L_spin_70:
  ds_read_b32 v4, v1 offset:660
  s_waitcnt lgkmcnt(0)
  v_cmp_gt_u32 vcc, 1, v4
  s_nop 0
  s_cbranch_vccz L_sdone_71
  s_sleep 1
  s_sub_u32 s70, s70, 1
  s_cbranch_scc0 L_spin_70
L_sdone_71:
  v_readfirstlane_b32 s47, v4
  s_lshl1_add_u32 s74, s74, s73
  v_lshl_add_u32 v61, v2, 2, v3
  v_lshlrev_b32 v61, 1, v61
  s_lshl_b32 s68, s74, 6
  v_add_u32 v61, s68, v61
  global_load_ushort v56, v61, s[36:37]
  v_lshlrev_b32 v54, 5, v3
  v_lshl_add_u32 v54, v2, 2, v54
  v_lshlrev_b32 v55, 4, v0
  s_lshl_b32 s72, s4, 9
  s_lshl4_add_u32 s72, s74, s72
  s_add_u32 s72, s72, 2752512
  s_mul_i32 s75, s4, 20
  s_add_u32 s75, s75, s74
  s_lshl_b32 s75, s75, 7
  s_add_u32 s75, s75, 2768896
  s_mov_b64 exec, 1
  buffer_load_dword v104, v54, s[32:35], s75 offen sc1
  buffer_load_dword v105, v55, s[32:35], s72 offen sc1
  s_mov_b64 exec, -1
  s_lshr_b32 s60, s74, 2
  s_lshl_b32 s60, s60, 14
  s_and_b32 s68, s74, 3
  s_lshl_b32 s68, s68, 11
  s_add_u32 s60, s60, s68
  s_lshr_b32 s68, s47, s4
  s_and_b32 s68, s68, 1
  s_lshl_b32 s68, s68, 13
  s_add_u32 s60, s60, s68
  s_add_u32 s60, s60, 1966080
  v_lshlrev_b32 v51, 4, v3
  v_lshl_add_u32 v51, v2, 1, v51
  v_and_b32 v4, 1, v0
  v_mul_u32_u24 v4, 126, v4
  v_add_u32 v51, v51, v4
  s_lshl_b32 s68, s73, 6
  v_add_u32 v51, s68, v51
  s_mov_b32 s77, 0x3f80
  s_mov_b32 s71, 0x3f800000
  v_mov_b32 v14, s30
  v_mov_b32 v15, s31
  v_mov_b32 v8, 0
  v_mov_b32 v9, 0
  v_mov_b32 v10, 0
  v_mov_b32 v11, 0
  v_not_b32 v98, s30
  v_not_b32 v102, s30
  s_waitcnt vmcnt(2)
  s_barrier
  v_lshlrev_b32 v56, 16, v56
  s_mov_b32 s70, 4000007
  s_mov_b64 s[20:21], -1
  s_mov_b64 s[22:23], -1
L_ypoll:
  s_mov_b64 exec, s[20:21]
  buffer_load_dwordx4 v[96:99], v55, s[24:27], s60 offen sc1
  s_mov_b64 exec, s[22:23]
  buffer_load_dwordx4 v[100:103], v55, s[24:27], s60 offen offset:1024 sc1
  s_mov_b64 exec, -1
  v_cmp_ne_u64 s[20:21], s[30:31], v[98:99]
  v_cmp_ne_u64 s[22:23], s[30:31], v[102:103]
  s_nop 0
  s_or_b64 vcc, s[20:21], s[22:23]
  s_cbranch_scc0 L_yok
  v_cmp_ne_u64 s[20:21], s[30:31], v[98:99]
  v_cmp_ne_u64 s[22:23], s[30:31], v[102:103]
  s_nop 0
  s_or_b64 vcc, s[20:21], s[22:23]
  s_cbranch_scc0 L_yok
  v_cmp_ne_u64 s[20:21], s[30:31], v[98:99]
  v_cmp_ne_u64 s[22:23], s[30:31], v[102:103]
  s_nop 0
  s_or_b64 vcc, s[20:21], s[22:23]
  s_cbranch_scc0 L_yok
  v_cmp_ne_u64 s[20:21], s[30:31], v[98:99]
  v_cmp_ne_u64 s[22:23], s[30:31], v[102:103]
  s_nop 0
  s_or_b64 vcc, s[20:21], s[22:23]
  s_cbranch_scc0 L_yok
  v_cmp_ne_u64 s[20:21], s[30:31], v[98:99]
  v_cmp_ne_u64 s[22:23], s[30:31], v[102:103]
  s_nop 0
  s_or_b64 vcc, s[20:21], s[22:23]
  s_cbranch_scc0 L_yok
  v_cmp_ne_u64 s[20:21], s[30:31], v[98:99]
  v_cmp_ne_u64 s[22:23], s[30:31], v[102:103]
  s_nop 0
  s_or_b64 vcc, s[20:21], s[22:23]
  s_cbranch_scc0 L_yok
  s_waitcnt vmcnt(16)
  s_sub_u32 s70, s70, 1
  s_cbranch_scc0 L_ypoll
L_yok:
  v_dot2c_f32_bf16 v8, s77, v96
  v_dot2c_f32_bf16 v10, s77, v97
  v_dot2c_f32_bf16 v9, s71, v96
  v_dot2c_f32_bf16 v11, s71, v97
  v_dot2c_f32_bf16 v8, s77, v100
  v_dot2c_f32_bf16 v10, s77, v101
  v_dot2c_f32_bf16 v9, s71, v100
  v_dot2c_f32_bf16 v11, s71, v101
  s_nop 0
  v_permlane32_swap_b32 v8, v10
  s_nop 0
  v_permlane32_swap_b32 v9, v11
  v_add_f32 v8, v8, v10
  v_add_f32 v9, v9, v11
  s_nop 1
  v_permlane16_swap_b32 v8, v9
  v_add_f32 v8, v8, v9
  s_nop 1
  v_add_f32_dpp v8, v8, v8 row_ror:8 row_mask:0xf bank_mask:0xf
  v_cvt_pk_bf16_f32 v8, v57, v8
  v_add_f32 v12, v8, v56
  s_nop 1
  v_mov_b32_dpp v13, v12 quad_perm:[1,0,3,2] row_mask:0xf bank_mask:0xf
  v_cvt_pk_bf16_f32 v12, v12, v13
  ds_write_b32 v51, v12 offset:7168
  v_lshlrev_b32 v4, 16, v12
  v_mul_f32 v5, v4, v4
  s_nop 0
  v_add_f32_dpp v4, v4, v4 quad_perm:[1,0,3,2] row_mask:0xf bank_mask:0xf
  v_add_f32_dpp v5, v5, v5 quad_perm:[1,0,3,2] row_mask:0xf bank_mask:0xf
  s_nop 0
  v_add_f32_dpp v4, v4, v4 quad_perm:[2,3,0,1] row_mask:0xf bank_mask:0xf
  v_add_f32_dpp v5, v5, v5 quad_perm:[2,3,0,1] row_mask:0xf bank_mask:0xf
  s_nop 0
  v_add_f32_dpp v4, v4, v4 row_half_mirror row_mask:0xf bank_mask:0xf
  v_add_f32_dpp v5, v5, v5 row_half_mirror row_mask:0xf bank_mask:0xf
  s_waitcnt lgkmcnt(0)
  s_barrier
  v_mov_b32_dpp v13, v12 quad_perm:[2,3,2,3] row_mask:0xf bank_mask:0xf
  v_mov_b32 v8, v4
  v_mov_b32 v9, v5
  s_nop 0
  v_permlane16_swap_b32 v4, v8
  v_permlane16_swap_b32 v5, v9
  v_add_f32 v4, v4, v8
  v_add_f32 v5, v5, v9
  v_mov_b32 v8, v4
  v_mov_b32 v9, v5
  s_nop 0
  v_permlane32_swap_b32 v4, v8
  v_permlane32_swap_b32 v5, v9
  v_add_f32 v4, v4, v8
  v_add_f32 v5, v5, v9
  s_mov_b32 exec_lo, 0x1
  s_mov_b32 exec_hi, 0x0
  buffer_store_dwordx4 v[4:7], v55, s[32:35], s72 offen
  s_mov_b32 exec_lo, 0x110011
  s_mov_b32 exec_hi, 0x110011
  buffer_store_dwordx4 v[12:15], v54, s[32:35], s75 offen
  s_mov_b64 exec, -1
  s_cmp_lg_u32 s46, 1
  s_cbranch_scc1 L_slow_72
L_back_73:
  s_endpgm
L_f1m:
  s_sub_u32 s68, s73, 2
  s_lshr_b32 s78, s68, 1
  s_and_b32 s69, s73, 1
  v_lshlrev_b32 v58, 7, v3
  v_bfe_u32 v4, v0, 2, 2
  v_lshl_add_u32 v58, v4, 9, v58
  v_and_b32 v4, 3, v0
  v_lshl_add_u32 v58, v4, 3, v58
  s_lshl_b32 s75, s78, 13
  s_lshl_b32 s68, s69, 6
  s_add_u32 s75, s75, s68
  v_add_u32 v58, s75, v58
  v_lshlrev_b32 v52, 4, v3
  v_and_b32 v59, 1, v3
  v_cmp_eq_u32 s[62:63], 1, v59
  v_mul_u32_u24 v59, 3072, v59
  v_bfe_u32 v4, v0, 3, 1
  v_lshl_add_u32 v59, v4, 9, v59
  v_lshl_add_u32 v59, v2, 4, v59
  s_mul_i32 s76, s4, 3
  s_add_u32 s76, s76, s78
  s_lshl1_add_u32 s76, s76, s69
  s_mul_i32 s76, s76, 6144
  s_lshr_b32 s68, s74, 2
  s_lshl_b32 s68, s68, 10
  s_add_u32 s76, s76, s68
  s_and_b32 s68, s74, 3
  s_lshl_b32 s68, s68, 7
  s_add_u32 s76, s76, s68
  s_add_u32 s77, s76, 3145728
  s_add_u32 s76, s76, 2228224
  v_mov_b32 v8, 0x3f803f80
  v_mov_b32 v9, 0x3f803f80
  v_mov_b32 v10, 0x3f803f80
  v_mov_b32 v11, 0x3f803f80
  v_mov_b32 v34, s30
  v_mov_b32 v35, s31
  s_waitcnt vmcnt(0)
  s_barrier
  ds_read_b64_tr_b16 v[64:65], v58 offset:8704
  ds_read_b64_tr_b16 v[66:67], v58 offset:10752
  ds_read_b64_tr_b16 v[68:69], v58 offset:8736
  ds_read_b64_tr_b16 v[70:71], v58 offset:10784
  ds_read_b64_tr_b16 v[72:73], v58 offset:33280
  ds_read_b64_tr_b16 v[74:75], v58 offset:35328
  ds_read_b64_tr_b16 v[76:77], v58 offset:33312
  ds_read_b64_tr_b16 v[78:79], v58 offset:35360
  ds_read_b64_tr_b16 v[80:81], v58 offset:12800
  ds_read_b64_tr_b16 v[82:83], v58 offset:14848
  ds_read_b64_tr_b16 v[84:85], v58 offset:12832
  ds_read_b64_tr_b16 v[86:87], v58 offset:14880
  ds_read_b64_tr_b16 v[88:89], v58 offset:37376
  ds_read_b64_tr_b16 v[90:91], v58 offset:39424
  ds_read_b64_tr_b16 v[92:93], v58 offset:37408
  ds_read_b64_tr_b16 v[94:95], v58 offset:39456
  s_waitcnt lgkmcnt(0)
  v_mfma_f32_16x16x32_bf16 v[16:19], v[8:11], v[64:67], 0
  v_mfma_f32_16x16x32_bf16 v[20:23], v[8:11], v[68:71], 0
  v_mfma_f32_16x16x32_bf16 v[24:27], v[8:11], v[72:75], 0
  v_mfma_f32_16x16x32_bf16 v[28:31], v[8:11], v[76:79], 0
  v_mfma_f32_16x16x32_bf16 v[16:19], v[8:11], v[80:83], v[16:19]
  v_mfma_f32_16x16x32_bf16 v[20:23], v[8:11], v[84:87], v[20:23]
  v_mfma_f32_16x16x32_bf16 v[24:27], v[8:11], v[88:91], v[24:27]
  v_mfma_f32_16x16x32_bf16 v[28:31], v[8:11], v[92:95], v[28:31]
  s_nop 5
  v_cndmask_b32 v32, v16, v20, s[62:63]
  s_nop 0
  v_cndmask_b32 v33, v24, v28, s[62:63]
  s_mov_b32 exec_lo, 0xffffffff
  s_mov_b32 exec_hi, 0x0
  buffer_store_dwordx4 v[32:35], v59, s[32:35], s77 offen
  s_mov_b64 exec, -1
  s_cmp_lg_u32 s46, 1
  s_cbranch_scc1 L_slow_74
L_back_75:
  s_barrier
  ds_read_b128 v[8:11], v52 offset:7168
  ds_read_b128 v[12:15], v52 offset:7232
  s_waitcnt lgkmcnt(1)
  v_mfma_f32_16x16x32_bf16 v[16:19], v[8:11], v[64:67], 0
  v_mfma_f32_16x16x32_bf16 v[20:23], v[8:11], v[68:71], 0
  v_mfma_f32_16x16x32_bf16 v[24:27], v[8:11], v[72:75], 0
  v_mfma_f32_16x16x32_bf16 v[28:31], v[8:11], v[76:79], 0
  s_waitcnt lgkmcnt(0)
  v_mfma_f32_16x16x32_bf16 v[16:19], v[12:15], v[80:83], v[16:19]
  v_mfma_f32_16x16x32_bf16 v[20:23], v[12:15], v[84:87], v[20:23]
  v_mfma_f32_16x16x32_bf16 v[24:27], v[12:15], v[88:91], v[24:27]
  v_mfma_f32_16x16x32_bf16 v[28:31], v[12:15], v[92:95], v[28:31]
  s_nop 5
  v_cndmask_b32 v4, v16, v20, s[62:63]
  s_nop 0
  v_cndmask_b32 v5, v24, v28, s[62:63]
  s_mov_b32 exec_lo, 0xffffffff
  s_mov_b32 exec_hi, 0x0
  buffer_store_dwordx4 v[4:7], v59, s[32:35], s76 offen
  s_mov_b64 exec, -1
  s_cmp_lg_u32 s46, 1
  s_cbranch_scc1 L_slow_76
L_back_77:
  s_endpgm
L_post_wo:
  s_cmp_gt_u32 s5, 11
  s_cbranch_scc1 L_end
  s_cmp_eq_u32 s3, 3
  s_cbranch_scc1 L_end
  v_mov_b32 v57, 0
  s_cmp_eq_u32 s3, 1
  s_cbranch_scc1 L_hid
  s_barrier
  s_and_b32 s68, s4, 1
  s_lshl_b32 s68, s68, 2
  s_sub_u32 s68, 12, s68
  s_cmp_ge_u32 s5, s68
  s_cbranch_scc1 L_end
  s_mul_i32 s72, s4, 5
  s_add_u32 s72, s72, 1
  s_lshr_b32 s72, s72, 1
  s_lshr_b32 s68, s5, 2
  s_add_u32 s72, s72, s68
  s_and_b32 s73, s5, 3
  v_lshrrev_b32 v2, 1, v0
  v_lshlrev_b32 v2, 7, v2
  v_and_b32 v3, 1, v0
  v_lshl_add_u32 v96, v3, 4, v2
  s_lshl_b32 s10, s72, 15
  s_lshr_b32 s68, s47, s4
  s_and_b32 s68, s68, 1
  s_lshl_b32 s68, s68, 13
  s_add_u32 s10, s10, s68
  s_lshl_b32 s68, s73, 5
  s_add_u32 s10, s10, s68
  s_add_u32 s10, s10, 1048576
  s_add_u32 s11, s10, 4096
  s_add_u32 s12, s10, 16384
  v_lshrrev_b32 v4, 4, v0
  v_lshl_add_u32 v97, v3, 2, v4
  v_lshlrev_b32 v97, 1, v97
  v_lshlrev_b32 v99, 5, v4
  s_and_b32 s68, s73, 1
  s_lshl_b32 s68, s68, 5
  v_lshl_add_u32 v98, v3, 4, s68
  s_mul_i32 s13, s4, 20
  s_add_u32 s13, s13, s72
  s_lshl_b32 s13, s13, 7
  s_lshr_b32 s68, s73, 1
  s_lshl4_add_u32 s13, s68, s13
  s_add_u32 s13, s13, 2768896
  s_lshl2_add_u32 s14, s72, s73
  s_lshl_b32 s14, s14, 4
  s_mov_b32 s8, 0x30003
  s_mov_b32 s9, 0x30003
  s_mov_b32 s77, 0x3f80
  s_mov_b32 s71, 0x3f800000
  v_mov_b32 v8, 0
  v_mov_b32 v9, 0
  v_mov_b32 v10, 0
  v_mov_b32 v11, 0
  s_mov_b32 s64, s54
  s_mov_b32 s65, s55
  s_mov_b32 s66, 1280
  s_mov_b32 s67, 0x20000
  s_setprio 0
  v_mov_b32 v1, 0
  s_mov_b32 s70, 4000007
L_spin_78:
  ds_read_b32 v4, v1 offset:736
  s_waitcnt lgkmcnt(0)
  v_cmp_gt_u32 vcc, 1, v4
  s_nop 0
  s_cbranch_vccz L_sdone_79
  s_sub_u32 s70, s70, 1
  s_cbranch_scc0 L_spin_78
L_sdone_79:
  s_sleep 16
  s_mov_b32 s16, s32
  s_mov_b32 s17, s33
  s_mov_b32 s18, 4194304
  s_mov_b32 s19, 0x20000
  s_mov_b32 s70, 4000007
L_spin_80:
  buffer_load_dwordx4 v[4:7], v99, s[16:19], s13 offen sc1
  buffer_load_dwordx4 v[16:19], v96, s[24:27], s10 offen sc1
  buffer_load_dwordx4 v[20:23], v96, s[24:27], s11 offen sc1
  buffer_load_dwordx4 v[24:27], v96, s[24:27], s12 offen sc1
  s_waitcnt vmcnt(0)
  v_cmp_ne_u64 vcc, s[30:31], v[6:7]
  v_cmp_ne_u64 s[20:21], s[30:31], v[18:19]
  v_cmp_ne_u64 s[22:23], s[30:31], v[22:23]
  s_or_b64 vcc, vcc, s[20:21]
  v_cmp_ne_u64 s[20:21], s[30:31], v[26:27]
  s_or_b64 vcc, vcc, s[22:23]
  s_or_b64 vcc, vcc, s[20:21]
  s_nop 0
  s_cbranch_vccz L_sdone_81
  s_and_b32 s99, s70, 7
  s_cmp_eq_u32 s46, 1
  s_cselect_b32 s99, 1, s99
  s_cmp_lg_u32 s99, 0
  s_cselect_b32 s16, s32, s24
  s_cselect_b32 s17, s33, s25
  s_sub_u32 s70, s70, 1
  s_cbranch_scc0 L_spin_80
L_sdone_81:
L_finc:
  v_dot2c_f32_bf16 v8, s77, v16
  v_dot2c_f32_bf16 v10, s77, v17
  v_dot2c_f32_bf16 v9, s71, v16
  v_dot2c_f32_bf16 v11, s71, v17
  v_dot2c_f32_bf16 v8, s77, v20
  v_dot2c_f32_bf16 v10, s77, v21
  v_dot2c_f32_bf16 v9, s71, v20
  v_dot2c_f32_bf16 v11, s71, v21
  v_dot2c_f32_bf16 v8, s77, v24
  v_dot2c_f32_bf16 v10, s77, v25
  v_dot2c_f32_bf16 v9, s71, v24
  v_dot2c_f32_bf16 v11, s71, v25
  v_lshrrev_b64 v[58:59], v98, v[4:5]
  v_permlane32_swap_b32 v8, v10
  s_nop 0
  v_permlane32_swap_b32 v9, v11
  v_add_f32 v8, v8, v10
  v_add_f32 v9, v9, v11
  v_lshlrev_b32 v58, 16, v58
  s_nop 0
  v_permlane16_swap_b32 v8, v9
  v_add_f32 v8, v8, v9
  s_nop 1
  v_add_f32_dpp v8, v8, v8 row_ror:8 row_mask:0xf bank_mask:0xf
  s_nop 1
  v_add_f32_dpp v8, v8, v8 row_ror:4 row_mask:0xf bank_mask:0xf
  s_nop 1
  v_add_f32_dpp v8, v8, v8 quad_perm:[2,3,0,1] row_mask:0xf bank_mask:0xf
  v_cvt_pk_bf16_f32 v8, v57, v8
  v_add_f32 v8, v8, v58
  v_cvt_pk_bf16_f32 v8, v8, v8
  s_mov_b64 exec, s[8:9]
  buffer_store_short v8, v97, s[64:67], s14 offen
  s_cmp_lg_u32 s14, 0
  s_cbranch_scc1 L_fin_exit
  s_mov_b64 exec, 1
  v_mov_b32 v4, s30
  v_mov_b32 v5, s31
  s_mov_b32 s68, 917504
  buffer_store_dwordx2 v[4:5], v57, s[24:27], s68 offen
L_fin_exit:
  s_endpgm
L_hid:
  s_mul_i32 s72, s4, 12
  s_add_u32 s72, s72, s5
  v_lshrrev_b32 v4, 5, v0
  v_and_b32 v2, 7, v0
  v_lshl_add_u32 v62, v4, 3, v2
  v_lshlrev_b32 v62, 1, v62
  v_lshlrev_b32 v63, 2, v2
  v_lshlrev_b32 v60, 4, v0
  v_and_b32 v3, 31, v0
  v_lshlrev_b32 v61, 4, v3
  s_lshl_b32 s65, s4, 9
  s_add_u32 s65, s65, 2752512
  s_mul_i32 s60, s72, 3072
  s_add_u32 s62, s60, 3145728
  s_add_u32 s60, s60, 2228224
  s_mov_b32 s8, 0xfffff
  s_mov_b32 s9, 0xfffff
  s_mov_b32 s10, 0xffff
  s_mov_b32 s11, 0xffff
  v_mov_b32 v59, 1
  v_mov_b32 v24, 0
  v_mov_b32 v25, 0
  v_mov_b32 v26, s30
  v_mov_b32 v27, s31
  v_mov_b32 v136, 0
  v_mov_b32 v137, 0
  v_mov_b32 v138, s30
  v_mov_b32 v139, s31
  v_mov_b32 v140, 0
  v_mov_b32 v141, 0
  v_mov_b32 v142, s30
  v_mov_b32 v143, s31
  v_not_b32 v18, s30
  v_not_b32 v22, s30
  v_not_b32 v130, s30
  v_not_b32 v134, s30
  s_mov_b64 exec, s[10:11]
  v_not_b32 v26, s30
  v_not_b32 v138, s30
  s_mov_b64 exec, s[8:9]
  v_not_b32 v142, s30
  s_mov_b64 exec, -1
  s_barrier
  v_cmp_ne_u64 vcc, s[30:31], v[18:19]
  v_cmp_ne_u64 s[20:21], s[30:31], v[22:23]
  v_cmp_ne_u64 s[22:23], s[30:31], v[26:27]
  s_or_b64 vcc, vcc, s[20:21]
  s_or_b64 vcc, vcc, s[22:23]
  s_nop 0
  s_cbranch_vccz L_pok_83
  s_cmp_lg_u32 s46, 1
  s_cbranch_scc1 L_pslow_82
  s_mov_b32 s70, 4000007
L_fp_84:
  buffer_load_dwordx4 v[16:19], v60, s[32:35], s62 offen sc1
  buffer_load_dwordx4 v[20:23], v60, s[32:35], s62 offen offset:1024 sc1
  s_mov_b64 exec, s[10:11]
  buffer_load_dwordx4 v[24:27], v60, s[32:35], s62 offen offset:2048 sc1
  s_mov_b64 exec, -1
  s_mov_b64 exec, s[8:9]
  buffer_load_dwordx4 v[140:143], v61, s[32:35], s65 offen sc1
  s_mov_b64 exec, -1
  buffer_load_dwordx4 v[128:131], v60, s[32:35], s60 offen sc1
  buffer_load_dwordx4 v[132:135], v60, s[32:35], s60 offen offset:1024 sc1
  s_mov_b64 exec, s[10:11]
  buffer_load_dwordx4 v[136:139], v60, s[32:35], s60 offen offset:2048 sc1
  s_mov_b64 exec, -1
  v_cmp_ne_u64 vcc, s[30:31], v[18:19]
  v_cmp_ne_u64 s[20:21], s[30:31], v[22:23]
  v_cmp_ne_u64 s[22:23], s[30:31], v[26:27]
  s_or_b64 vcc, vcc, s[20:21]
  s_or_b64 vcc, vcc, s[22:23]
  s_nop 0
  s_cbranch_vccz L_pok_83
  v_cmp_ne_u64 vcc, s[30:31], v[18:19]
  v_cmp_ne_u64 s[20:21], s[30:31], v[22:23]
  v_cmp_ne_u64 s[22:23], s[30:31], v[26:27]
  s_or_b64 vcc, vcc, s[20:21]
  s_or_b64 vcc, vcc, s[22:23]
  s_nop 0
  s_cbranch_vccz L_pok_83
  v_cmp_ne_u64 vcc, s[30:31], v[18:19]
  v_cmp_ne_u64 s[20:21], s[30:31], v[22:23]
  v_cmp_ne_u64 s[22:23], s[30:31], v[26:27]
  s_or_b64 vcc, vcc, s[20:21]
  s_or_b64 vcc, vcc, s[22:23]
  s_nop 0
  s_cbranch_vccz L_pok_83
  v_cmp_ne_u64 vcc, s[30:31], v[18:19]
  v_cmp_ne_u64 s[20:21], s[30:31], v[22:23]
  v_cmp_ne_u64 s[22:23], s[30:31], v[26:27]
  s_or_b64 vcc, vcc, s[20:21]
  s_or_b64 vcc, vcc, s[22:23]
  s_nop 0
  s_cbranch_vccz L_pok_83
  v_cmp_ne_u64 vcc, s[30:31], v[18:19]
  v_cmp_ne_u64 s[20:21], s[30:31], v[22:23]
  v_cmp_ne_u64 s[22:23], s[30:31], v[26:27]
  s_or_b64 vcc, vcc, s[20:21]
  s_or_b64 vcc, vcc, s[22:23]
  s_nop 0
  s_cbranch_vccz L_pok_83
  v_cmp_ne_u64 vcc, s[30:31], v[18:19]
  v_cmp_ne_u64 s[20:21], s[30:31], v[22:23]
  v_cmp_ne_u64 s[22:23], s[30:31], v[26:27]
  s_or_b64 vcc, vcc, s[20:21]
  s_or_b64 vcc, vcc, s[22:23]
  s_nop 0
  s_cbranch_vccz L_pok_83
  v_cmp_ne_u64 vcc, s[30:31], v[18:19]
  v_cmp_ne_u64 s[20:21], s[30:31], v[22:23]
  v_cmp_ne_u64 s[22:23], s[30:31], v[26:27]
  s_or_b64 vcc, vcc, s[20:21]
  s_or_b64 vcc, vcc, s[22:23]
  s_nop 0
  s_cbranch_vccz L_pok_83
  v_cmp_ne_u64 vcc, s[30:31], v[18:19]
  v_cmp_ne_u64 s[20:21], s[30:31], v[22:23]
  v_cmp_ne_u64 s[22:23], s[30:31], v[26:27]
  s_or_b64 vcc, vcc, s[20:21]
  s_or_b64 vcc, vcc, s[22:23]
  s_nop 0
  s_cbranch_vccz L_pok_83
  s_waitcnt vmcnt(14)
  s_sub_u32 s70, s70, 1
  s_cbranch_scc0 L_fp_84
L_pok_83:
  v_pk_add_f32 v[40:41], v[16:17], v[20:21]
  v_pk_add_f32 v[40:41], v[40:41], v[24:25]
  s_nop 1
  v_add_f32_dpp v40, v40, v40 row_ror:8 row_mask:0xf bank_mask:0xf
  v_add_f32_dpp v41, v41, v41 row_ror:8 row_mask:0xf bank_mask:0xf
  v_mov_b32 v42, v40
  v_mov_b32 v43, v41
  s_nop 0
  v_permlane16_swap_b32 v40, v42
  v_permlane16_swap_b32 v41, v43
  v_add_f32 v40, v40, v42
  v_add_f32 v41, v41, v43
  v_cmp_ne_u64 vcc, s[30:31], v[142:143]
  s_nop 0
  s_cbranch_vccz L_pok_88
  s_cmp_lg_u32 s46, 1
  s_cbranch_scc1 L_pslow_87
  s_mov_b32 s70, 4000007
L_fp_89:
  s_mov_b64 exec, s[8:9]
  buffer_load_dwordx4 v[140:143], v61, s[32:35], s65 offen sc1
  s_mov_b64 exec, -1
  v_cmp_ne_u64 vcc, s[30:31], v[142:143]
  s_nop 0
  s_cbranch_vccz L_pok_88
  v_cmp_ne_u64 vcc, s[30:31], v[142:143]
  s_nop 0
  s_cbranch_vccz L_pok_88
  s_waitcnt vmcnt(12)
  s_sub_u32 s70, s70, 1
  s_cbranch_scc0 L_fp_89
L_pok_88:
  s_cmp_lg_u32 s46, 1
  s_cbranch_scc1 L_nopre
  buffer_load_dwordx4 v[128:131], v60, s[32:35], s60 offen sc1
  buffer_load_dwordx4 v[132:135], v60, s[32:35], s60 offen offset:1024 sc1
  s_mov_b64 exec, s[10:11]
  buffer_load_dwordx4 v[136:139], v60, s[32:35], s60 offen offset:2048 sc1
  s_mov_b64 exec, -1
L_nopre:
  v_add_f32_dpp v36, v140, v140 quad_perm:[1,0,3,2] row_mask:0xf bank_mask:0xf
  v_add_f32_dpp v37, v141, v141 quad_perm:[1,0,3,2] row_mask:0xf bank_mask:0xf
  s_nop 0
  v_add_f32_dpp v36, v36, v36 quad_perm:[2,3,0,1] row_mask:0xf bank_mask:0xf
  v_add_f32_dpp v37, v37, v37 quad_perm:[2,3,0,1] row_mask:0xf bank_mask:0xf
  s_nop 0
  v_add_f32_dpp v36, v36, v36 row_half_mirror row_mask:0xf bank_mask:0xf
  v_add_f32_dpp v37, v37, v37 row_half_mirror row_mask:0xf bank_mask:0xf
  s_nop 0
  v_add_f32_dpp v46, v36, v36 row_mirror row_mask:0xf bank_mask:0xf
  v_add_f32_dpp v47, v37, v37 row_mirror row_mask:0xf bank_mask:0xf
  v_add_f32_dpp v36, v36, v36 row_mirror row_mask:0xf bank_mask:0xf
  v_add_f32_dpp v37, v37, v37 row_mirror row_mask:0xf bank_mask:0xf
  s_nop 0
  v_permlane16_swap_b32 v36, v46
  v_permlane16_swap_b32 v37, v47
  v_pk_add_f32 v[36:37], v[36:37], v[46:47]
  s_cbranch_scc1 L_nopre2
  buffer_load_dwordx4 v[128:131], v60, s[32:35], s60 offen sc1
  buffer_load_dwordx4 v[132:135], v60, s[32:35], s60 offen offset:1024 sc1
  s_mov_b64 exec, s[10:11]
  buffer_load_dwordx4 v[136:139], v60, s[32:35], s60 offen offset:2048 sc1
  s_mov_b64 exec, -1
L_nopre2:
  v_mul_f32 v44, 0x3acccccd, v36
  v_mul_f32 v45, 0x3acccccd, v37
  v_fma_f32 v45, -v44, v44, v45
  v_max_f32 v45, 0, v45
  v_cvt_pk_bf16_f32 v45, v57, v45
  v_cvt_pk_bf16_f32 v44, v57, v44
  v_add_f32 v45, 0x3727c5ac, v45
  v_cvt_pk_bf16_f32 v45, v57, v45
  v_sqrt_f32 v45, v45
  v_mul_f32 v40, v44, v40
  v_cvt_pk_bf16_f32 v45, v57, v45
  v_rcp_f32 v45, v45
  v_mul_f32 v41, v44, v41
  v_cmp_ne_u64 vcc, s[30:31], v[130:131]
  v_cmp_ne_u64 s[20:21], s[30:31], v[134:135]
  v_cmp_ne_u64 s[22:23], s[30:31], v[138:139]
  s_or_b64 vcc, vcc, s[20:21]
  s_or_b64 vcc, vcc, s[22:23]
  s_nop 0
  s_cbranch_vccz L_pok_93
  s_cmp_lg_u32 s46, 1
  s_cbranch_scc1 L_pslow_92
  s_mov_b32 s70, 4000007
L_fp_94:
  buffer_load_dwordx4 v[128:131], v60, s[32:35], s60 offen sc1
  buffer_load_dwordx4 v[132:135], v60, s[32:35], s60 offen offset:1024 sc1
  s_mov_b64 exec, s[10:11]
  buffer_load_dwordx4 v[136:139], v60, s[32:35], s60 offen offset:2048 sc1
  s_mov_b64 exec, -1
  v_cmp_ne_u64 vcc, s[30:31], v[130:131]
  v_cmp_ne_u64 s[20:21], s[30:31], v[134:135]
  v_cmp_ne_u64 s[22:23], s[30:31], v[138:139]
  s_or_b64 vcc, vcc, s[20:21]
  s_or_b64 vcc, vcc, s[22:23]
  s_nop 0
  s_cbranch_vccz L_pok_93
  s_waitcnt vmcnt(12)
  s_sub_u32 s70, s70, 1
  s_cbranch_scc0 L_fp_94
L_pok_93:
L_hidc:
  v_pk_add_f32 v[8:9], v[128:129], v[132:133]
  v_pk_add_f32 v[8:9], v[8:9], v[136:137]
  s_nop 1
  v_add_f32_dpp v10, v8, v8 row_ror:8 row_mask:0xf bank_mask:0xf
  v_add_f32_dpp v11, v9, v9 row_ror:8 row_mask:0xf bank_mask:0xf
  v_add_f32_dpp v8, v8, v8 row_ror:8 row_mask:0xf bank_mask:0xf
  v_add_f32_dpp v9, v9, v9 row_ror:8 row_mask:0xf bank_mask:0xf
  s_nop 0
  v_permlane16_swap_b32 v8, v10
  v_permlane16_swap_b32 v9, v11
  v_add_f32 v8, v8, v10
  v_sub_f32 v8, v8, v40
  v_mul_f32 v8, v8, v45
  v_cvt_pk_bf16_f32 v8, v57, v8
  v_mul_f32 v12, 0xbfb8aa3b, v8
  v_exp_f32 v12, v12
  v_add_f32 v9, v9, v11
  v_add_f32 v12, 1.0, v12
  v_rcp_f32 v12, v12
  v_sub_f32 v9, v9, v41
  v_mul_f32 v9, v9, v45
  v_mul_f32 v8, v8, v12
  v_cvt_pk_bf16_f32 v9, v57, v9
  v_cvt_pk_bf16_f32 v8, v57, v8
  v_mul_f32 v8, v8, v9
  v_cvt_pk_bf16_f32 v8, v8, v8
  ds_write_b16 v62, v8 offset:704
  ds_write_b32 v63, v59 offset:736
  s_endpgm
L_f2:
  s_mov_b32 s8, s52
  s_mov_b32 s9, s53
  s_mov_b32 s10, 1966080
  s_mov_b32 s11, 0x20000
  v_mov_b32 v17, 0
  s_mov_b32 s70, 4000007
L_spin_97:
  ds_read_b32 v16, v17 offset:660
  s_waitcnt lgkmcnt(0)
  v_cmp_gt_u32 vcc, 1, v16
  s_nop 0
  s_cbranch_vccz L_sdone_98
  s_sleep 1
  s_sub_u32 s70, s70, 1
  s_cbranch_scc0 L_spin_97
L_sdone_98:
  v_readfirstlane_b32 s47, v16
  s_mul_i32 s72, s4, 12
  s_add_u32 s72, s72, s5
  v_mov_b32 v57, 0
  s_sub_u32 s68, s3, 7
  s_lshl_b32 s69, s68, 8
  v_lshlrev_b32 v58, 2, v0
  v_add_u32 v58, s69, v58
  v_lshrrev_b32 v2, 4, v0
  v_lshl_add_u32 v2, s68, 2, v2
  v_mul_u32_u24 v3, 52, v2
  v_lshrrev_b32 v3, 8, v3
  v_mul_u32_u24 v4, 5, v3
  v_sub_u32 v4, v2, v4
  v_cmp_lt_u32 vcc, 2, v4
  v_lshlrev_b32 v3, 1, v3
  s_nop 0
  v_addc_co_u32 v3, vcc, 0, v3, vcc
  v_lshrrev_b32 v3, v3, s47
  v_and_b32 v3, 1, v3
  v_lshlrev_b32 v116, 15, v2
  v_lshl_add_u32 v116, v3, 13, v116
  v_bfe_u32 v3, v0, 1, 3
  v_lshl_add_u32 v116, v3, 4, v116
  s_lshr_b32 s79, s72, 6
  s_lshl_b32 s79, s79, 14
  s_and_b32 s68, s72, 63
  s_lshl_b32 s68, s68, 7
  s_add_u32 s79, s79, s68
  s_add_u32 s79, s79, 1048576
  s_mov_b32 s60, 0x05040100
  s_mov_b32 s61, 0x07060302
  s_mul_i32 s62, s72, 20480
  v_lshrrev_b32 v2, 4, v0
  v_mul_u32_u24 v2, 1280, v2
  v_and_b32 v3, 15, v0
  v_lshl_add_u32 v2, v3, 4, v2
  s_add_u32 s62, s62, s69
  s_lshl_b32 s63, s69, 4
  v_lshlrev_b32 v3, 2, v0
  v_add_u32 v3, s63, v3
  s_add_u32 s63, s63, 8704
  s_barrier
  s_add_u32 m0, s63, 0
  s_nop 0
  buffer_load_dwordx4 v2, s[8:11], s62 offen nt lds
  s_add_u32 s62, s62, 5120
  s_add_u32 m0, s63, 1024
  s_nop 0
  buffer_load_dwordx4 v2, s[8:11], s62 offen nt lds
  s_add_u32 s62, s62, 5120
  s_add_u32 m0, s63, 2048
  s_nop 0
  buffer_load_dwordx4 v2, s[8:11], s62 offen nt lds
  s_add_u32 s62, s62, 5120
  s_add_u32 m0, s63, 3072
  s_nop 0
  buffer_load_dwordx4 v2, s[8:11], s62 offen nt lds
  s_add_u32 s62, s62, 5120
  s_barrier
  s_waitcnt vmcnt(0)
  ds_read_b32 v64, v3 offset:8704
  ds_read_b32 v65, v3 offset:8960
  ds_read_b32 v66, v3 offset:9216
  ds_read_b32 v67, v3 offset:9472
  ds_read_b32 v68, v3 offset:9728
  ds_read_b32 v69, v3 offset:9984
  ds_read_b32 v70, v3 offset:10240
  ds_read_b32 v71, v3 offset:10496
  ds_read_b32 v72, v3 offset:10752
  ds_read_b32 v73, v3 offset:11008
  ds_read_b32 v74, v3 offset:11264
  ds_read_b32 v75, v3 offset:11520
  ds_read_b32 v76, v3 offset:11776
  ds_read_b32 v77, v3 offset:12032
  ds_read_b32 v78, v3 offset:12288
  ds_read_b32 v79, v3 offset:12544
  s_waitcnt lgkmcnt(0)
  v_perm_b32 v80, v65, v64, s60
  v_perm_b32 v88, v65, v64, s61
  v_perm_b32 v81, v67, v66, s60
  v_perm_b32 v89, v67, v66, s61
  v_perm_b32 v82, v69, v68, s60
  v_perm_b32 v90, v69, v68, s61
  v_perm_b32 v83, v71, v70, s60
  v_perm_b32 v91, v71, v70, s61
  v_perm_b32 v84, v73, v72, s60
  v_perm_b32 v92, v73, v72, s61
  v_perm_b32 v85, v75, v74, s60
  v_perm_b32 v93, v75, v74, s61
  v_perm_b32 v86, v77, v76, s60
  v_perm_b32 v94, v77, v76, s61
  v_perm_b32 v87, v79, v78, s60
  v_perm_b32 v95, v79, v78, s61
  v_mov_b32 v16, 0
  v_mov_b32 v17, 0
  v_mov_b32 v18, 0
  v_mov_b32 v19, 0
  s_mov_b32 s66, 0x55555555
  s_mov_b32 s67, 0x55555555
  v_mov_b32 v6, s30
  v_mov_b32 v7, s31
  v_and_b32 v9, 15, v0
  v_lshlrev_b32 v9, 2, v9
  v_mov_b32 v8, 0
  s_mov_b32 s64, 0xff00ff00
  s_mov_b32 s65, 0xff00ff00
  s_mov_b32 s70, 32000056
  s_waitcnt lgkmcnt(0)
L_f2poll:
  ds_read_b32 v8, v9 offset:704
  s_waitcnt lgkmcnt(4)
  v_cmp_eq_u32 vcc, 0, v8
  s_sub_u32 s70, s70, 1
  s_cbranch_scc1 L_f2go
  s_and_b64 vcc, vcc, s[64:65]
  s_cbranch_scc1 L_f2poll
L_f2go:
  v_dot2c_f32_bf16_dpp v16, v8, v80 row_newbcast:0 row_mask:0xf bank_mask:0xf
  v_dot2c_f32_bf16_dpp v17, v8, v88 row_newbcast:0 row_mask:0xf bank_mask:0xf
  v_dot2c_f32_bf16_dpp v18, v8, v81 row_newbcast:1 row_mask:0xf bank_mask:0xf
  v_dot2c_f32_bf16_dpp v19, v8, v89 row_newbcast:1 row_mask:0xf bank_mask:0xf
  v_dot2c_f32_bf16_dpp v16, v8, v82 row_newbcast:2 row_mask:0xf bank_mask:0xf
  v_dot2c_f32_bf16_dpp v17, v8, v90 row_newbcast:2 row_mask:0xf bank_mask:0xf
  v_dot2c_f32_bf16_dpp v18, v8, v83 row_newbcast:3 row_mask:0xf bank_mask:0xf
  v_dot2c_f32_bf16_dpp v19, v8, v91 row_newbcast:3 row_mask:0xf bank_mask:0xf
  v_dot2c_f32_bf16_dpp v16, v8, v84 row_newbcast:4 row_mask:0xf bank_mask:0xf
  v_dot2c_f32_bf16_dpp v17, v8, v92 row_newbcast:4 row_mask:0xf bank_mask:0xf
  v_dot2c_f32_bf16_dpp v18, v8, v85 row_newbcast:5 row_mask:0xf bank_mask:0xf
  v_dot2c_f32_bf16_dpp v19, v8, v93 row_newbcast:5 row_mask:0xf bank_mask:0xf
  v_dot2c_f32_bf16_dpp v16, v8, v86 row_newbcast:6 row_mask:0xf bank_mask:0xf
  v_dot2c_f32_bf16_dpp v17, v8, v94 row_newbcast:6 row_mask:0xf bank_mask:0xf
  v_dot2c_f32_bf16_dpp v18, v8, v87 row_newbcast:7 row_mask:0xf bank_mask:0xf
  v_dot2c_f32_bf16_dpp v19, v8, v95 row_newbcast:7 row_mask:0xf bank_mask:0xf
  s_nop 2
  v_pk_add_f32 v[16:17], v[16:17], v[18:19]
  v_cvt_pk_bf16_f32 v4, v16, v17
  s_nop 1
  v_mov_b32_dpp v5, v4 quad_perm:[1,0,3,2] row_mask:0xf bank_mask:0xf
  s_mov_b64 exec, s[66:67]
  buffer_store_dwordx4 v[4:7], v116, s[24:27], s79 offen sc1
L_end:
  s_endpgm
L_spare:
  v_mov_b32 v1, 0
  s_mov_b32 s70, 4000007
L_spin_99:
  ds_read_b32 v4, v1 offset:668
  s_waitcnt lgkmcnt(0)
  v_cmp_gt_u32 vcc, 1, v4
  s_nop 0
  s_cbranch_vccz L_sdone_100
  s_sleep 2
  s_sub_u32 s70, s70, 1
  s_cbranch_scc0 L_spin_99
L_sdone_100:
  v_lshlrev_b32 v1, 7, v0
  s_sub_u32 s76, s5, 30
  s_lshl1_add_u32 s68, s4, s76
  s_lshl3_add_u32 s68, s68, s73
  s_mul_i32 s68, s68, 3072
  s_add_u32 s68, s68, 524288
  s_mov_b64 exec, 0xffffff
  buffer_load_dword v5, v1, s[32:35], s68 offen nt
  s_waitcnt vmcnt(0)
  buffer_load_dword v5, v1, s[32:35], s68 offen sc1
  s_mov_b64 exec, -1
  s_cmp_gt_u32 s73, 5
  s_cbranch_scc1 L_nopa
  s_mul_i32 s68, s4, 6
  s_add_u32 s68, s68, s73
  s_mul_i32 s68, s68, 6144
  s_mul_i32 s69, s76, 917504
  s_add_u32 s68, s68, s69
  s_add_u32 s68, s68, 2228224
  s_mov_b32 exec_lo, 0xff33ffff
  s_mov_b32 exec_hi, 0x33ff
  buffer_load_dword v4, v1, s[32:35], s68 offen nt
  s_waitcnt vmcnt(0)
  buffer_load_dword v4, v1, s[32:35], s68 offen sc1
  s_mov_b64 exec, -1
L_nopa:
  s_endpgm
L_dry:
  s_endpgm
L_slow_25:
  s_mov_b32 exec_lo, 0xffffffff
  s_mov_b32 exec_hi, 0xffff
  buffer_store_dwordx4 v[4:7], v13, s[24:27], s74 offen sc1
  s_mov_b64 exec, -1
  s_nop 1
  s_branch L_back_26
L_slow_32:
  s_mov_b32 exec_lo, 0x55555555
  s_mov_b32 exec_hi, 0x0
  buffer_store_dwordx4 v[8:11], v2, s[24:27], s66 offen offset:1536 sc1
  s_mov_b64 exec, -1
  s_nop 1
  s_branch L_back_33
L_slow_46:
  s_mov_b32 exec_lo, 0x101
  s_mov_b32 exec_hi, 0x0
  buffer_store_dwordx4 v[2:5], v12, s[24:27], s68 offen sc1
  s_mov_b64 exec, -1
  s_nop 1
  s_branch L_back_47
L_slow_54:
  s_mov_b32 exec_lo, 0xffffffff
  s_mov_b32 exec_hi, 0xffff
  buffer_store_dwordx4 v[4:7], v13, s[24:27], s74 offen sc1
  s_mov_b64 exec, -1
  s_nop 1
  s_branch L_back_55
L_slow_72:
  s_mov_b32 exec_lo, 0x1
  s_mov_b32 exec_hi, 0x0
  buffer_store_dwordx4 v[4:7], v55, s[24:27], s72 offen sc1
  s_mov_b32 exec_lo, 0x110011
  s_mov_b32 exec_hi, 0x110011
  buffer_store_dwordx4 v[12:15], v54, s[24:27], s75 offen sc1
  s_mov_b64 exec, -1
  s_nop 1
  s_branch L_back_73
L_slow_74:
  s_mov_b32 exec_lo, 0xffffffff
  s_mov_b32 exec_hi, 0x0
  buffer_store_dwordx4 v[32:35], v59, s[24:27], s77 offen sc1
  s_mov_b64 exec, -1
  s_nop 1
  s_branch L_back_75
L_slow_76:
  s_mov_b32 exec_lo, 0xffffffff
  s_mov_b32 exec_hi, 0x0
  buffer_store_dwordx4 v[4:7], v59, s[24:27], s76 offen sc1
  s_mov_b64 exec, -1
  s_nop 1
  s_branch L_back_77
L_pslow_82:
  s_mov_b32 s16, s32
  s_mov_b32 s17, s33
  s_mov_b32 s18, 4194304
  s_mov_b32 s19, 0x20000
  s_mov_b32 s70, 4000007
L_spin_85:
  buffer_load_dwordx4 v[16:19], v60, s[16:19], s62 offen sc1
  buffer_load_dwordx4 v[20:23], v60, s[16:19], s62 offen offset:1024 sc1
  s_mov_b64 exec, s[10:11]
  buffer_load_dwordx4 v[24:27], v60, s[16:19], s62 offen offset:2048 sc1
  s_mov_b64 exec, -1
  s_mov_b64 exec, s[8:9]
  buffer_load_dwordx4 v[140:143], v61, s[16:19], s65 offen sc1
  s_mov_b64 exec, -1
  buffer_load_dwordx4 v[128:131], v60, s[16:19], s60 offen sc1
  buffer_load_dwordx4 v[132:135], v60, s[16:19], s60 offen offset:1024 sc1
  s_mov_b64 exec, s[10:11]
  buffer_load_dwordx4 v[136:139], v60, s[16:19], s60 offen offset:2048 sc1
  s_mov_b64 exec, -1
  s_waitcnt vmcnt(0)
  v_cmp_ne_u64 vcc, s[30:31], v[18:19]
  v_cmp_ne_u64 s[20:21], s[30:31], v[22:23]
  v_cmp_ne_u64 s[22:23], s[30:31], v[26:27]
  s_or_b64 vcc, vcc, s[20:21]
  s_or_b64 vcc, vcc, s[22:23]
  s_nop 0
  s_cbranch_vccz L_sdone_86
  s_and_b32 s99, s70, 7
  s_cmp_eq_u32 s46, 1
  s_cselect_b32 s99, 1, s99
  s_cmp_lg_u32 s99, 0
  s_cselect_b32 s16, s32, s24
  s_cselect_b32 s17, s33, s25
  s_sub_u32 s70, s70, 1
  s_cbranch_scc0 L_spin_85
L_sdone_86:
  s_branch L_pok_83
L_pslow_87:
  s_mov_b32 s16, s32
  s_mov_b32 s17, s33
  s_mov_b32 s18, 4194304
  s_mov_b32 s19, 0x20000
  s_mov_b32 s70, 4000007
L_spin_90:
  s_mov_b64 exec, s[8:9]
  buffer_load_dwordx4 v[140:143], v61, s[16:19], s65 offen sc1
  s_mov_b64 exec, -1
  s_waitcnt vmcnt(0)
  v_cmp_ne_u64 vcc, s[30:31], v[142:143]
  s_nop 0
  s_cbranch_vccz L_sdone_91
  s_and_b32 s99, s70, 7
  s_cmp_eq_u32 s46, 1
  s_cselect_b32 s99, 1, s99
  s_cmp_lg_u32 s99, 0
  s_cselect_b32 s16, s32, s24
  s_cselect_b32 s17, s33, s25
  s_sub_u32 s70, s70, 1
  s_cbranch_scc0 L_spin_90
L_sdone_91:
  s_branch L_pok_88
L_pslow_92:
  s_mov_b32 s16, s32
  s_mov_b32 s17, s33
  s_mov_b32 s18, 4194304
  s_mov_b32 s19, 0x20000
  s_mov_b32 s70, 4000007
L_spin_95:
  buffer_load_dwordx4 v[128:131], v60, s[16:19], s60 offen sc1
  buffer_load_dwordx4 v[132:135], v60, s[16:19], s60 offen offset:1024 sc1
  s_mov_b64 exec, s[10:11]
  buffer_load_dwordx4 v[136:139], v60, s[16:19], s60 offen offset:2048 sc1
  s_mov_b64 exec, -1
  s_waitcnt vmcnt(0)
  v_cmp_ne_u64 vcc, s[30:31], v[130:131]
  v_cmp_ne_u64 s[20:21], s[30:31], v[134:135]
  v_cmp_ne_u64 s[22:23], s[30:31], v[138:139]
  s_or_b64 vcc, vcc, s[20:21]
  s_or_b64 vcc, vcc, s[22:23]
  s_nop 0
  s_cbranch_vccz L_sdone_96
  s_and_b32 s99, s70, 7
  s_cmp_eq_u32 s46, 1
  s_cselect_b32 s99, 1, s99
  s_cmp_lg_u32 s99, 0
  s_cselect_b32 s16, s32, s24
  s_cselect_b32 s17, s33, s25
  s_sub_u32 s70, s70, 1
  s_cbranch_scc0 L_spin_95
L_sdone_96:
  s_branch L_pok_93
L_codeend:
.section .rodata,"a"
.p2align 6
.amdhsa_kernel sequential_preLN__sliding_block_cached__glu_gated_swiglu__decode_kernel
  .amdhsa_next_free_vgpr 168
  .amdhsa_next_free_sgpr 100
  .amdhsa_accum_offset 168
  .amdhsa_group_segment_fixed_size 0
  .amdhsa_kernarg_size 96
  .amdhsa_user_sgpr_count 2
  .amdhsa_user_sgpr_kernarg_segment_ptr 1
  .amdhsa_system_sgpr_workgroup_id_x 1
.end_amdhsa_kernel
```

```asm
; @launch grid=(256,1,1) block=(768,1,1) lds=64000
.amdgcn_target "amdgcn-amd-amdhsa--gfx950"
.text
.globl sequential_preLN__sliding_block_cached__glu_gated_swiglu__decode_kernel
.p2align 8
.type sequential_preLN__sliding_block_cached__glu_gated_swiglu__decode_kernel,@function
sequential_preLN__sliding_block_cached__glu_gated_swiglu__decode_kernel:
  s_load_dwordx2 s[8:9], s[0:1], 8
  v_readfirstlane_b32 s3, v0
  s_lshr_b32 s79, s2, 6
  s_cmp_gt_u32 s79, 3
  s_cbranch_scc1 L_end
  s_lshr_b32 s3, s3, 6
  s_cmp_gt_u32 s3, 3
  s_cbranch_scc1 L_str
  s_getpc_b64 s[20:21]
L_pc0:
  v_lshlrev_b32 v8, 7, v0
  v_min_u32 v8, L_codeend-L_pc0-4, v8
  global_load_dword v166, v8, s[20:21]
  s_branch L_helper0
L_str:
  s_and_b32 s4, s2, 7
  s_lshr_b32 s6, s2, 7
  s_bfe_u32 s7, s2, 0x40003
  s_lshl1_add_u32 s6, s4, s6
  s_lshl_b32 s6, s6, 10
  s_lshl1_add_u32 s64, s7, s6
  s_addk_i32 s64, 17279
  s_mulk_i32 s64, 12288
  v_lshlrev_b32 v3, 4, v0
  v_lshrrev_b32 v2, 3, v0
  v_lshl_add_u32 v1, v2, 8, v3
  s_lshl_b32 s10, 3, 27
  s_mov_b32 s11, 0x20000
  s_waitcnt lgkmcnt(0)
  buffer_load_dwordx4 v[64:67], v1, s[8:11], s64 offen offset:0 nt
  buffer_load_dwordx4 v[68:71], v1, s[8:11], s64 offen offset:128 nt
  buffer_load_dwordx4 v[72:75], v1, s[8:11], s64 offen offset:256 nt
  s_branch L_stream0
L_helper0:
  s_load_dwordx16 s[36:51], s[0:1], 0
  s_load_dwordx8 s[52:59], s[0:1], 64
  s_and_b32 s4, s2, 7
  s_lshl2_add_u32 s6, s4, s79
  s_bfe_u32 s7, s2, 0x30003
  v_and_b32 v0, 63, v0
  s_cmp_lg_u32 s3, 3
  s_cbranch_scc0 L_w3
  v_lshrrev_b32 v2, 3, v0
  v_mul_u32_u24 v2, 12160, v2
  v_lshl_add_u32 v2, v0, 4, v2
  s_mul_i32 s68, s7, 7680
  s_lshr_b32 s69, s79, 1
  s_mul_i32 s69, s69, 14
  s_add_u32 s69, s69, s79
  s_lshl1_add_u32 s69, s4, s69
  s_add_u32 s69, s69, 0
  s_mul_i32 s69, s69, 3
  s_add_u32 s68, s68, s69
  s_add_u32 s68, s68, s3
  s_lshl_b32 s68, s68, 7
  s_lshl_b32 s69, 3, 15
  s_mov_b32 s10, 7864320
  s_mov_b32 s11, 0x20000
  s_waitcnt lgkmcnt(0)
  s_mov_b64 s[8:9], s[42:43]
  buffer_load_dwordx4 v[24:27], v2, s[8:11], s68 offen nt
  s_add_u32 s68, s68, s69
  buffer_load_dwordx4 v[28:31], v2, s[8:11], s68 offen nt
  s_add_u32 s68, s68, s69
  buffer_load_dwordx4 v[32:35], v2, s[8:11], s68 offen nt
  s_add_u32 s68, s68, s69
  buffer_load_dwordx4 v[36:39], v2, s[8:11], s68 offen nt
  s_add_u32 s68, s68, s69
  buffer_load_dwordx4 v[40:43], v2, s[8:11], s68 offen nt
  s_add_u32 s68, s68, s69
  buffer_load_dwordx4 v[44:47], v2, s[8:11], s68 offen nt
  s_add_u32 s68, s68, s69
  buffer_load_dwordx4 v[48:51], v2, s[8:11], s68 offen nt
  s_add_u32 s68, s68, s69
  buffer_load_dwordx4 v[52:55], v2, s[8:11], s68 offen nt
  s_add_u32 s68, s68, s69
  buffer_load_dwordx4 v[56:59], v2, s[8:11], s68 offen nt
  s_add_u32 s68, s68, s69
  buffer_load_dwordx4 v[60:63], v2, s[8:11], s68 offen nt
  s_branch L_helper
L_w3:
  v_lshlrev_b32 v1, 3, v0
  v_mov_b32 v4, 0
  v_mov_b32 v5, 0
  ds_write_b64 v1, v[4:5] offset:384
  s_waitcnt lgkmcnt(0)
  s_memrealtime s[62:63]
  s_barrier
  s_load_dwordx2 s[28:29], s[58:59], 917504
  s_branch L_ids
L_stream0:
  s_load_dwordx16 s[36:51], s[0:1], 0
  s_load_dwordx8 s[52:59], s[0:1], 64
  v_and_b32 v0, 63, v0
  s_sub_u32 s73, s3, 4
  v_and_b32 v3, 0x70, v3
  s_lshl2_add_u32 s6, s4, s79
  s_and_b32 s7, s7, 7
  s_add_u32 s65, s64, 393216
  s_waitcnt lgkmcnt(0)
  s_barrier
  s_waitcnt vmcnt(2)
  buffer_load_dwordx4 v[76:79], v1, s[8:11], s65 offen offset:0 nt
  s_load_dwordx2 s[28:29], s[58:59], 917504
  s_mov_b32 s24, s58
  s_mov_b32 s25, s59
  s_mov_b32 s26, 4194304
  s_mov_b32 s27, 0x20000
  s_add_u32 s32, s58, 4194304
  s_addc_u32 s33, s59, 0
  s_mov_b32 s34, 4194304
  s_mov_b32 s35, 0x20000
  s_lshl3_add_u32 s71, s6, s7
  s_mul_i32 s5, s79, 5
  s_mul_i32 s47, s79, 3
  s_add_u32 s47, s47, 15
  s_cmp_lt_u32 s7, 5
  s_cselect_b32 s5, s5, s47
  s_add_u32 s5, s5, s7
  s_mov_b32 s12, s40
  s_mov_b32 s13, s41
  s_mov_b32 s14, 402653184
  s_mov_b32 s15, 0x20000
  s_waitcnt vmcnt(2)
  buffer_load_dwordx4 v[80:83], v1, s[8:11], s65 offen offset:128 nt
  s_waitcnt vmcnt(2)
  buffer_load_dwordx4 v[84:87], v1, s[8:11], s65 offen offset:256 nt
  s_add_u32 s66, s65, 393216
  s_waitcnt vmcnt(2)
  buffer_load_dwordx4 v[88:91], v1, s[8:11], s66 offen offset:0 nt
  s_waitcnt vmcnt(2)
  buffer_load_dwordx4 v[92:95], v1, s[8:11], s66 offen offset:128 nt
  s_waitcnt vmcnt(2)
  buffer_load_dwordx4 v[96:99], v1, s[8:11], s66 offen offset:256 nt
  s_add_u32 s67, s66, 393216
  s_waitcnt vmcnt(2)
  buffer_load_dwordx4 v[100:103], v1, s[8:11], s67 offen offset:0 nt
  s_waitcnt vmcnt(2)
  buffer_load_dwordx4 v[104:107], v1, s[8:11], s67 offen offset:128 nt
  s_waitcnt vmcnt(2)
  buffer_load_dwordx4 v[108:111], v1, s[8:11], s67 offen offset:256 nt
  s_add_u32 s60, s67, 4092461056
  s_waitcnt vmcnt(2)
  buffer_load_dwordx4 v[16:19], v1, s[8:11], s60 offen offset:0 nt
  s_waitcnt vmcnt(2)
  buffer_load_dwordx4 v[20:23], v1, s[8:11], s60 offen offset:128 nt
  s_waitcnt vmcnt(2)
  buffer_load_dwordx4 v[24:27], v1, s[8:11], s60 offen offset:256 nt
  s_add_u32 s61, s60, 393216
  s_waitcnt vmcnt(2)
  buffer_load_dwordx4 v[28:31], v1, s[8:11], s61 offen offset:0 nt
  s_waitcnt vmcnt(2)
  buffer_load_dwordx4 v[32:35], v1, s[8:11], s61 offen offset:128 nt
  s_waitcnt vmcnt(2)
  buffer_load_dwordx4 v[36:39], v1, s[8:11], s61 offen offset:256 nt
  s_memrealtime s[76:77]
  s_waitcnt lgkmcnt(0)
  v_mov_b32 v6, 0
  v_mov_b32 v8, s76
  v_mov_b32 v9, 1
  s_mov_b64 exec, 1
  ds_add_u32 v6, v8 offset:696
  ds_add_u32 v6, v9 offset:700
  s_mov_b64 exec, -1
  s_add_u32 s62, s61, 393216
  s_waitcnt vmcnt(2)
  buffer_load_dwordx4 v[40:43], v1, s[8:11], s62 offen offset:0 nt
  s_waitcnt vmcnt(2)
  buffer_load_dwordx4 v[44:47], v1, s[8:11], s62 offen offset:128 nt
  s_waitcnt vmcnt(2)
  buffer_load_dwordx4 v[48:51], v1, s[8:11], s62 offen offset:256 nt
  s_add_u32 s63, s62, 393216
  s_waitcnt vmcnt(2)
  buffer_load_dwordx4 v[52:55], v1, s[8:11], s63 offen offset:0 nt
  s_waitcnt vmcnt(2)
  buffer_load_dwordx4 v[56:59], v1, s[8:11], s63 offen offset:128 nt
  s_waitcnt vmcnt(2)
  buffer_load_dwordx4 v[60:63], v1, s[8:11], s63 offen offset:256 nt
  s_waitcnt vmcnt(2)
  buffer_load_dwordx4 v[112:115], v1, s[12:15], s60 offen offset:0 nt
  s_waitcnt vmcnt(2)
  buffer_load_dwordx4 v[116:119], v1, s[12:15], s60 offen offset:128 nt
  s_waitcnt vmcnt(2)
  buffer_load_dwordx4 v[120:123], v1, s[12:15], s60 offen offset:256 nt
  v_mov_b32 v6, 0
  v_mov_b32 v7, 1
  s_mov_b64 exec, 1
  ds_add_u32 v6, v7 offset:692
  s_mov_b64 exec, -1
  s_waitcnt lgkmcnt(0)
  s_mul_i32 s30, s28, 0x2c9277b5
  s_add_u32 s30, s30, 0xac564b05
  s_mul_i32 s31, s29, 0x0019660d
  s_add_u32 s31, s31, 0x3c6ef35f
  v_and_b32 v2, 3, v0
  v_min_u32 v2, 2, v2
  v_lshlrev_b32 v2, 3, v2
  s_mov_b32 s70, 4000007
L_spin_1:
  ds_read_b32 v4, v2 offset:384
  s_waitcnt lgkmcnt(0)
  v_cmp_eq_u32 vcc, 0, v4
  s_nop 0
  s_cbranch_vccz L_sdone_2
  s_sleep 1
  s_sub_u32 s70, s70, 1
  s_cbranch_scc0 L_spin_1
L_sdone_2:
  ds_read_b128 v[4:7], v3 offset:0
  ds_read_b128 v[8:11], v3 offset:128
  ds_read_b128 v[12:15], v3 offset:256
  ds_read_b128 v[148:151], v3 offset:8192
  ds_read_b128 v[152:155], v3 offset:8320
  ds_read_b128 v[156:159], v3 offset:8448
  v_mov_b32 v160, 0
  v_mov_b32 v161, 0
  v_mov_b32 v162, 0
  v_mov_b32 v163, 0
  v_mov_b32 v164, 0
  v_mov_b32 v165, 0
  v_mov_b32 v166, 0
  v_mov_b32 v167, 0
  s_waitcnt vmcnt(3) lgkmcnt(0)
  v_dot2c_f32_bf16 v160, v16, v4
  v_dot2c_f32_bf16 v161, v28, v4
  v_dot2c_f32_bf16 v162, v40, v4
  v_dot2c_f32_bf16 v163, v52, v4
  v_dot2c_f32_bf16 v160, v17, v5
  v_dot2c_f32_bf16 v161, v29, v5
  v_dot2c_f32_bf16 v162, v41, v5
  v_dot2c_f32_bf16 v163, v53, v5
  v_dot2c_f32_bf16 v160, v18, v6
  v_dot2c_f32_bf16 v161, v30, v6
  v_dot2c_f32_bf16 v162, v42, v6
  v_dot2c_f32_bf16 v163, v54, v6
  v_dot2c_f32_bf16 v160, v19, v7
  v_dot2c_f32_bf16 v161, v31, v7
  v_dot2c_f32_bf16 v162, v43, v7
  v_dot2c_f32_bf16 v163, v55, v7
  v_dot2c_f32_bf16 v160, v20, v8
  v_dot2c_f32_bf16 v161, v32, v8
  v_dot2c_f32_bf16 v162, v44, v8
  v_dot2c_f32_bf16 v163, v56, v8
  v_dot2c_f32_bf16 v160, v21, v9
  v_dot2c_f32_bf16 v161, v33, v9
  v_dot2c_f32_bf16 v162, v45, v9
  v_dot2c_f32_bf16 v163, v57, v9
  v_dot2c_f32_bf16 v160, v22, v10
  v_dot2c_f32_bf16 v161, v34, v10
  v_dot2c_f32_bf16 v162, v46, v10
  v_dot2c_f32_bf16 v163, v58, v10
  v_dot2c_f32_bf16 v160, v23, v11
  v_dot2c_f32_bf16 v161, v35, v11
  v_dot2c_f32_bf16 v162, v47, v11
  v_dot2c_f32_bf16 v163, v59, v11
  v_dot2c_f32_bf16 v160, v24, v12
  v_dot2c_f32_bf16 v161, v36, v12
  v_dot2c_f32_bf16 v162, v48, v12
  v_dot2c_f32_bf16 v163, v60, v12
  v_dot2c_f32_bf16 v160, v25, v13
  v_dot2c_f32_bf16 v161, v37, v13
  v_dot2c_f32_bf16 v162, v49, v13
  v_dot2c_f32_bf16 v163, v61, v13
  v_dot2c_f32_bf16 v160, v26, v14
  v_dot2c_f32_bf16 v161, v38, v14
  v_dot2c_f32_bf16 v162, v50, v14
  v_dot2c_f32_bf16 v163, v62, v14
  v_dot2c_f32_bf16 v160, v27, v15
  v_dot2c_f32_bf16 v161, v39, v15
  v_dot2c_f32_bf16 v162, v51, v15
  v_dot2c_f32_bf16 v163, v63, v15
  v_dot2c_f32_bf16 v164, v64, v148
  v_dot2c_f32_bf16 v165, v76, v148
  v_dot2c_f32_bf16 v166, v88, v148
  v_dot2c_f32_bf16 v167, v100, v148
  v_dot2c_f32_bf16 v164, v65, v149
  v_dot2c_f32_bf16 v165, v77, v149
  v_dot2c_f32_bf16 v166, v89, v149
  v_dot2c_f32_bf16 v167, v101, v149
  v_dot2c_f32_bf16 v164, v66, v150
  v_dot2c_f32_bf16 v165, v78, v150
  v_dot2c_f32_bf16 v166, v90, v150
  v_dot2c_f32_bf16 v167, v102, v150
  v_dot2c_f32_bf16 v164, v67, v151
  v_dot2c_f32_bf16 v165, v79, v151
  v_dot2c_f32_bf16 v166, v91, v151
  v_dot2c_f32_bf16 v167, v103, v151
  v_dot2c_f32_bf16 v164, v68, v152
  v_dot2c_f32_bf16 v165, v80, v152
  v_dot2c_f32_bf16 v166, v92, v152
  v_dot2c_f32_bf16 v167, v104, v152
  v_dot2c_f32_bf16 v164, v69, v153
  v_dot2c_f32_bf16 v165, v81, v153
  v_dot2c_f32_bf16 v166, v93, v153
  v_dot2c_f32_bf16 v167, v105, v153
  v_dot2c_f32_bf16 v164, v70, v154
  v_dot2c_f32_bf16 v165, v82, v154
  v_dot2c_f32_bf16 v166, v94, v154
  v_dot2c_f32_bf16 v167, v106, v154
  v_dot2c_f32_bf16 v164, v71, v155
  v_dot2c_f32_bf16 v165, v83, v155
  v_dot2c_f32_bf16 v166, v95, v155
  v_dot2c_f32_bf16 v167, v107, v155
  v_dot2c_f32_bf16 v164, v72, v156
  v_dot2c_f32_bf16 v165, v84, v156
  v_dot2c_f32_bf16 v166, v96, v156
  v_dot2c_f32_bf16 v167, v108, v156
  v_dot2c_f32_bf16 v164, v73, v157
  v_dot2c_f32_bf16 v165, v85, v157
  v_dot2c_f32_bf16 v166, v97, v157
  v_dot2c_f32_bf16 v167, v109, v157
  v_dot2c_f32_bf16 v164, v74, v158
  v_dot2c_f32_bf16 v165, v86, v158
  v_dot2c_f32_bf16 v166, v98, v158
  v_dot2c_f32_bf16 v167, v110, v158
  v_dot2c_f32_bf16 v164, v75, v159
  v_dot2c_f32_bf16 v165, v87, v159
  v_dot2c_f32_bf16 v166, v99, v159
  v_dot2c_f32_bf16 v167, v111, v159
  v_add_f32_dpp v160, v160, v160 quad_perm:[1,0,3,2] row_mask:0xf bank_mask:0xf
  v_add_f32_dpp v161, v161, v161 quad_perm:[1,0,3,2] row_mask:0xf bank_mask:0xf
  v_add_f32_dpp v162, v162, v162 quad_perm:[1,0,3,2] row_mask:0xf bank_mask:0xf
  v_add_f32_dpp v163, v163, v163 quad_perm:[1,0,3,2] row_mask:0xf bank_mask:0xf
  v_add_f32_dpp v164, v164, v164 quad_perm:[1,0,3,2] row_mask:0xf bank_mask:0xf
  v_add_f32_dpp v165, v165, v165 quad_perm:[1,0,3,2] row_mask:0xf bank_mask:0xf
  v_add_f32_dpp v166, v166, v166 quad_perm:[1,0,3,2] row_mask:0xf bank_mask:0xf
  v_add_f32_dpp v167, v167, v167 quad_perm:[1,0,3,2] row_mask:0xf bank_mask:0xf
  v_add_f32_dpp v160, v160, v160 quad_perm:[2,3,0,1] row_mask:0xf bank_mask:0xf
  v_add_f32_dpp v161, v161, v161 quad_perm:[2,3,0,1] row_mask:0xf bank_mask:0xf
  v_add_f32_dpp v162, v162, v162 quad_perm:[2,3,0,1] row_mask:0xf bank_mask:0xf
  v_add_f32_dpp v163, v163, v163 quad_perm:[2,3,0,1] row_mask:0xf bank_mask:0xf
  v_add_f32_dpp v164, v164, v164 quad_perm:[2,3,0,1] row_mask:0xf bank_mask:0xf
  v_add_f32_dpp v165, v165, v165 quad_perm:[2,3,0,1] row_mask:0xf bank_mask:0xf
  v_add_f32_dpp v166, v166, v166 quad_perm:[2,3,0,1] row_mask:0xf bank_mask:0xf
  v_add_f32_dpp v167, v167, v167 quad_perm:[2,3,0,1] row_mask:0xf bank_mask:0xf
  v_add_f32_dpp v160, v160, v160 row_half_mirror row_mask:0xf bank_mask:0xf
  v_add_f32_dpp v161, v161, v161 row_half_mirror row_mask:0xf bank_mask:0xf
  v_add_f32_dpp v162, v162, v162 row_half_mirror row_mask:0xf bank_mask:0xf
  v_add_f32_dpp v163, v163, v163 row_half_mirror row_mask:0xf bank_mask:0xf
  v_add_f32_dpp v164, v164, v164 row_half_mirror row_mask:0xf bank_mask:0xf
  v_add_f32_dpp v165, v165, v165 row_half_mirror row_mask:0xf bank_mask:0xf
  v_add_f32_dpp v166, v166, v166 row_half_mirror row_mask:0xf bank_mask:0xf
  v_add_f32_dpp v167, v167, v167 row_half_mirror row_mask:0xf bank_mask:0xf
  s_mov_b32 s68, 0x3d93cd3a
  v_mov_b32 v2, 0
  v_cvt_pk_bf16_f32 v160, v2, v160
  v_cvt_pk_bf16_f32 v161, v2, v161
  v_cvt_pk_bf16_f32 v162, v2, v162
  v_cvt_pk_bf16_f32 v163, v2, v163
  v_cvt_pk_bf16_f32 v164, v2, v164
  v_cvt_pk_bf16_f32 v165, v2, v165
  v_cvt_pk_bf16_f32 v166, v2, v166
  v_cvt_pk_bf16_f32 v167, v2, v167
  v_mul_f32 v160, s68, v160
  v_mul_f32 v161, s68, v161
  v_mul_f32 v162, s68, v162
  v_mul_f32 v163, s68, v163
  v_mul_f32 v164, s68, v164
  v_mul_f32 v165, s68, v165
  v_mul_f32 v166, s68, v166
  v_mul_f32 v167, s68, v167
  v_cvt_pk_bf16_f32 v160, v2, v160
  v_cvt_pk_bf16_f32 v161, v2, v161
  v_cvt_pk_bf16_f32 v162, v2, v162
  v_cvt_pk_bf16_f32 v163, v2, v163
  v_cvt_pk_bf16_f32 v164, v2, v164
  v_cvt_pk_bf16_f32 v165, v2, v165
  v_cvt_pk_bf16_f32 v166, v2, v166
  v_cvt_pk_bf16_f32 v167, v2, v167
  v_max_f32 v4, v160, v161
  v_max_f32 v6, v164, v165
  v_max3_f32 v4, v4, v162, v163
  v_max3_f32 v6, v6, v166, v167
  s_nop 0
  v_max_f32_dpp v4, v4, v4 row_ror:8 row_mask:0xf bank_mask:0xf
  v_max_f32_dpp v6, v6, v6 row_ror:8 row_mask:0xf bank_mask:0xf
  v_mov_b32 v88, v4
  v_mov_b32 v89, v6
  s_nop 0
  v_permlane16_swap_b32 v4, v88
  v_permlane16_swap_b32 v6, v89
  v_max_f32 v4, v4, v88
  v_max_f32 v6, v6, v89
  v_mov_b32 v88, v4
  v_mov_b32 v89, v6
  s_nop 0
  v_permlane32_swap_b32 v4, v88
  v_permlane32_swap_b32 v6, v89
  v_max_f32 v4, v4, v88
  v_max_f32 v6, v6, v89
  s_mov_b32 s68, 0x3fb8aa3b
  v_sub_f32 v160, v160, v4
  v_sub_f32 v161, v161, v4
  v_sub_f32 v162, v162, v4
  v_sub_f32 v163, v163, v4
  v_sub_f32 v164, v164, v6
  v_sub_f32 v165, v165, v6
  v_sub_f32 v166, v166, v6
  v_sub_f32 v167, v167, v6
  v_mul_f32 v160, s68, v160
  v_mul_f32 v161, s68, v161
  v_mul_f32 v162, s68, v162
  v_mul_f32 v163, s68, v163
  v_mul_f32 v164, s68, v164
  v_mul_f32 v165, s68, v165
  v_mul_f32 v166, s68, v166
  v_mul_f32 v167, s68, v167
  v_exp_f32 v160, v160
  v_exp_f32 v161, v161
  v_exp_f32 v162, v162
  v_exp_f32 v163, v163
  v_exp_f32 v164, v164
  v_exp_f32 v165, v165
  v_exp_f32 v166, v166
  v_exp_f32 v167, v167
  v_add_f32 v5, v160, v161
  v_add_f32 v7, v164, v165
  v_add_f32 v5, v5, v162
  v_add_f32 v7, v7, v166
  v_add_f32 v5, v5, v163
  v_add_f32 v7, v7, v167
  s_nop 0
  v_add_f32_dpp v5, v5, v5 row_ror:8 row_mask:0xf bank_mask:0xf
  v_add_f32_dpp v7, v7, v7 row_ror:8 row_mask:0xf bank_mask:0xf
  v_mov_b32 v88, v5
  v_mov_b32 v89, v7
  s_nop 0
  v_permlane16_swap_b32 v5, v88
  v_permlane16_swap_b32 v7, v89
  v_add_f32 v5, v5, v88
  v_add_f32 v7, v7, v89
  v_mov_b32 v88, v5
  v_mov_b32 v89, v7
  s_nop 0
  v_permlane32_swap_b32 v5, v88
  v_permlane32_swap_b32 v7, v89
  v_add_f32 v5, v5, v88
  v_add_f32 v7, v7, v89
  s_lshl_b32 s69, s73, 4
  v_mov_b32 v88, s69
  ds_write_b128 v88, v[4:7] offset:512
  v_cvt_pk_bf16_f32 v160, v160, v2
  v_cvt_pk_bf16_f32 v161, v161, v2
  v_cvt_pk_bf16_f32 v162, v162, v2
  v_cvt_pk_bf16_f32 v163, v163, v2
  v_cvt_pk_bf16_f32 v164, v164, v2
  v_cvt_pk_bf16_f32 v165, v165, v2
  v_cvt_pk_bf16_f32 v166, v166, v2
  v_cvt_pk_bf16_f32 v167, v167, v2
  v_mov_b32 v64, 0
  v_mov_b32 v65, 0
  v_mov_b32 v66, 0
  v_mov_b32 v67, 0
  v_mov_b32 v68, 0
  v_mov_b32 v69, 0
  v_mov_b32 v70, 0
  v_mov_b32 v71, 0
  v_mov_b32 v72, 0
  v_mov_b32 v73, 0
  v_mov_b32 v74, 0
  v_mov_b32 v75, 0
  v_mov_b32 v76, 0
  v_mov_b32 v77, 0
  v_mov_b32 v78, 0
  v_mov_b32 v79, 0
  v_mov_b32 v80, 0
  v_mov_b32 v81, 0
  v_mov_b32 v82, 0
  v_mov_b32 v83, 0
  v_mov_b32 v84, 0
  v_mov_b32 v85, 0
  v_mov_b32 v86, 0
  v_mov_b32 v87, 0
  v_mov_b32 v88, 0
  v_mov_b32 v89, 0
  v_mov_b32 v90, 0
  v_mov_b32 v91, 0
  v_mov_b32 v92, 0
  v_mov_b32 v93, 0
  v_mov_b32 v94, 0
  v_mov_b32 v95, 0
  v_mov_b32 v96, 0
  v_mov_b32 v97, 0
  v_mov_b32 v98, 0
  v_mov_b32 v99, 0
  v_mov_b32 v100, 0
  v_mov_b32 v101, 0
  v_mov_b32 v102, 0
  v_mov_b32 v103, 0
  v_mov_b32 v104, 0
  v_mov_b32 v105, 0
  v_mov_b32 v106, 0
  v_mov_b32 v107, 0
  v_mov_b32 v108, 0
  v_mov_b32 v109, 0
  v_mov_b32 v110, 0
  v_mov_b32 v111, 0
  v_mov_b32 v5, v6
  v_and_b32 v8, 7, v0
  v_lshlrev_b32 v8, 5, v8
  v_lshrrev_b32 v9, 4, v0
  v_lshl_add_u32 v8, v9, 3, v8
  s_mul_i32 s69, s73, 768
  v_add_u32 v8, s69, v8
  v_mov_b32 v11, 1
  s_waitcnt vmcnt(2)
  buffer_load_dwordx4 v[124:127], v1, s[12:15], s61 offen offset:0 nt
  s_waitcnt vmcnt(2)
  buffer_load_dwordx4 v[128:131], v1, s[12:15], s61 offen offset:128 nt
  v_lshlrev_b32 v10, 16, v160
  v_dot2c_f32_bf16 v64, v112, v160
  v_dot2c_f32_bf16 v65, v112, v10
  v_dot2c_f32_bf16 v66, v113, v160
  v_dot2c_f32_bf16 v67, v113, v10
  v_dot2c_f32_bf16 v68, v114, v160
  v_dot2c_f32_bf16 v69, v114, v10
  v_dot2c_f32_bf16 v70, v115, v160
  v_dot2c_f32_bf16 v71, v115, v10
  s_waitcnt vmcnt(2)
  buffer_load_dwordx4 v[132:135], v1, s[12:15], s61 offen offset:256 nt
  s_memrealtime s[76:77]
  v_mov_b32 v6, 0
  ds_read_b64 v[6:7], v6 offset:680
  s_movk_i32 s79, 457
  s_waitcnt lgkmcnt(0)
  v_readfirstlane_b32 s78, v6
  v_readfirstlane_b32 s72, v7
  s_add_u32 s78, s78, 5484
  v_dot2c_f32_bf16 v72, v116, v160
  v_dot2c_f32_bf16 v73, v116, v10
  v_dot2c_f32_bf16 v74, v117, v160
  v_dot2c_f32_bf16 v75, v117, v10
  v_dot2c_f32_bf16 v76, v118, v160
  v_dot2c_f32_bf16 v77, v118, v10
  v_dot2c_f32_bf16 v78, v119, v160
  v_dot2c_f32_bf16 v79, v119, v10
  s_waitcnt lgkmcnt(0)
  s_lshl_b32 s75, s76, 4
  s_sub_u32 s75, s75, s78
  s_and_b32 s75, s75, s72
  s_add_u32 s78, s78, s79
  s_waitcnt vmcnt(3)
  s_cmp_gt_i32 s75, 480
  s_cbranch_scc1 L_go_3
  s_waitcnt vmcnt(2)
  s_cmp_ge_i32 s75, 0
  s_cbranch_scc1 L_go_3
  s_waitcnt vmcnt(1)
L_go_3:
  buffer_load_dwordx4 v[136:139], v1, s[12:15], s62 offen offset:0 nt
  s_memrealtime s[76:77]
  v_dot2c_f32_bf16 v80, v120, v160
  v_dot2c_f32_bf16 v81, v120, v10
  v_dot2c_f32_bf16 v82, v121, v160
  v_dot2c_f32_bf16 v83, v121, v10
  v_dot2c_f32_bf16 v84, v122, v160
  v_dot2c_f32_bf16 v85, v122, v10
  v_dot2c_f32_bf16 v86, v123, v160
  v_dot2c_f32_bf16 v87, v123, v10
  s_waitcnt lgkmcnt(0)
  s_lshl_b32 s75, s76, 4
  s_sub_u32 s75, s75, s78
  s_and_b32 s75, s75, s72
  s_add_u32 s78, s78, s79
  s_waitcnt vmcnt(3)
  s_cmp_gt_i32 s75, 480
  s_cbranch_scc1 L_go_4
  s_waitcnt vmcnt(2)
  s_cmp_ge_i32 s75, 0
  s_cbranch_scc1 L_go_4
  s_waitcnt vmcnt(1)
L_go_4:
  buffer_load_dwordx4 v[140:143], v1, s[12:15], s62 offen offset:128 nt
  s_memrealtime s[76:77]
  v_lshlrev_b32 v10, 16, v161
  v_dot2c_f32_bf16 v64, v124, v161
  v_dot2c_f32_bf16 v65, v124, v10
  v_dot2c_f32_bf16 v66, v125, v161
  v_dot2c_f32_bf16 v67, v125, v10
  v_dot2c_f32_bf16 v68, v126, v161
  v_dot2c_f32_bf16 v69, v126, v10
  v_dot2c_f32_bf16 v70, v127, v161
  v_dot2c_f32_bf16 v71, v127, v10
  s_waitcnt lgkmcnt(0)
  s_lshl_b32 s75, s76, 4
  s_sub_u32 s75, s75, s78
  s_and_b32 s75, s75, s72
  s_add_u32 s78, s78, s79
  s_waitcnt vmcnt(3)
  s_cmp_gt_i32 s75, 480
  s_cbranch_scc1 L_go_5
  s_waitcnt vmcnt(2)
  s_cmp_ge_i32 s75, 0
  s_cbranch_scc1 L_go_5
  s_waitcnt vmcnt(1)
L_go_5:
  buffer_load_dwordx4 v[144:147], v1, s[12:15], s62 offen offset:256 nt
  s_memrealtime s[76:77]
  v_dot2c_f32_bf16 v72, v128, v161
  v_dot2c_f32_bf16 v73, v128, v10
  v_dot2c_f32_bf16 v74, v129, v161
  v_dot2c_f32_bf16 v75, v129, v10
  v_dot2c_f32_bf16 v76, v130, v161
  v_dot2c_f32_bf16 v77, v130, v10
  v_dot2c_f32_bf16 v78, v131, v161
  v_dot2c_f32_bf16 v79, v131, v10
  s_waitcnt lgkmcnt(0)
  s_lshl_b32 s75, s76, 4
  s_sub_u32 s75, s75, s78
  s_and_b32 s75, s75, s72
  s_add_u32 s78, s78, s79
  s_waitcnt vmcnt(3)
  s_cmp_gt_i32 s75, 480
  s_cbranch_scc1 L_go_6
  s_waitcnt vmcnt(2)
  s_cmp_ge_i32 s75, 0
  s_cbranch_scc1 L_go_6
  s_waitcnt vmcnt(1)
L_go_6:
  buffer_load_dwordx4 v[148:151], v1, s[12:15], s63 offen offset:0 nt
  s_memrealtime s[76:77]
  v_mov_b32 v6, 0
  ds_read_b64 v[6:7], v6 offset:680
  s_movk_i32 s79, 457
  s_waitcnt lgkmcnt(0)
  v_readfirstlane_b32 s78, v6
  v_readfirstlane_b32 s72, v7
  s_add_u32 s78, s78, 7312
  v_dot2c_f32_bf16 v80, v132, v161
  v_dot2c_f32_bf16 v81, v132, v10
  v_dot2c_f32_bf16 v82, v133, v161
  v_dot2c_f32_bf16 v83, v133, v10
  v_dot2c_f32_bf16 v84, v134, v161
  v_dot2c_f32_bf16 v85, v134, v10
  v_dot2c_f32_bf16 v86, v135, v161
  v_dot2c_f32_bf16 v87, v135, v10
  s_waitcnt lgkmcnt(0)
  s_lshl_b32 s75, s76, 4
  s_sub_u32 s75, s75, s78
  s_and_b32 s75, s75, s72
  s_add_u32 s78, s78, s79
  s_waitcnt vmcnt(3)
  s_cmp_gt_i32 s75, 480
  s_cbranch_scc1 L_go_7
  s_waitcnt vmcnt(2)
  s_cmp_ge_i32 s75, 0
  s_cbranch_scc1 L_go_7
  s_waitcnt vmcnt(1)
L_go_7:
  buffer_load_dwordx4 v[152:155], v1, s[12:15], s63 offen offset:128 nt
  s_memrealtime s[76:77]
  v_lshlrev_b32 v10, 16, v162
  v_dot2c_f32_bf16 v64, v136, v162
  v_dot2c_f32_bf16 v65, v136, v10
  v_dot2c_f32_bf16 v66, v137, v162
  v_dot2c_f32_bf16 v67, v137, v10
  v_dot2c_f32_bf16 v68, v138, v162
  v_dot2c_f32_bf16 v69, v138, v10
  v_dot2c_f32_bf16 v70, v139, v162
  v_dot2c_f32_bf16 v71, v139, v10
  s_waitcnt lgkmcnt(0)
  s_lshl_b32 s75, s76, 4
  s_sub_u32 s75, s75, s78
  s_and_b32 s75, s75, s72
  s_add_u32 s78, s78, s79
  s_waitcnt vmcnt(3)
  s_cmp_gt_i32 s75, 480
  s_cbranch_scc1 L_go_8
  s_waitcnt vmcnt(2)
  s_cmp_ge_i32 s75, 0
  s_cbranch_scc1 L_go_8
  s_waitcnt vmcnt(1)
L_go_8:
  buffer_load_dwordx4 v[156:159], v1, s[12:15], s63 offen offset:256 nt
  s_memrealtime s[76:77]
  v_dot2c_f32_bf16 v72, v140, v162
  v_dot2c_f32_bf16 v73, v140, v10
  v_dot2c_f32_bf16 v74, v141, v162
  v_dot2c_f32_bf16 v75, v141, v10
  v_dot2c_f32_bf16 v76, v142, v162
  v_dot2c_f32_bf16 v77, v142, v10
  v_dot2c_f32_bf16 v78, v143, v162
  v_dot2c_f32_bf16 v79, v143, v10
  s_waitcnt lgkmcnt(0)
  s_lshl_b32 s75, s76, 4
  s_sub_u32 s75, s75, s78
  s_and_b32 s75, s75, s72
  s_add_u32 s78, s78, s79
  s_waitcnt vmcnt(3)
  s_cmp_gt_i32 s75, 480
  s_cbranch_scc1 L_go_9
  s_waitcnt vmcnt(2)
  s_cmp_ge_i32 s75, 0
  s_cbranch_scc1 L_go_9
  s_waitcnt vmcnt(1)
L_go_9:
  buffer_load_dwordx4 v[16:19], v1, s[12:15], s64 offen offset:0 nt
  s_memrealtime s[76:77]
  v_dot2c_f32_bf16 v80, v144, v162
  v_dot2c_f32_bf16 v81, v144, v10
  v_dot2c_f32_bf16 v82, v145, v162
  v_dot2c_f32_bf16 v83, v145, v10
  v_dot2c_f32_bf16 v84, v146, v162
  v_dot2c_f32_bf16 v85, v146, v10
  v_dot2c_f32_bf16 v86, v147, v162
  v_dot2c_f32_bf16 v87, v147, v10
  s_waitcnt lgkmcnt(0)
  s_lshl_b32 s75, s76, 4
  s_sub_u32 s75, s75, s78
  s_and_b32 s75, s75, s72
  s_add_u32 s78, s78, s79
  s_waitcnt vmcnt(3)
  s_cmp_gt_i32 s75, 480
  s_cbranch_scc1 L_go_10
  s_waitcnt vmcnt(2)
  s_cmp_ge_i32 s75, 0
  s_cbranch_scc1 L_go_10
  s_waitcnt vmcnt(1)
L_go_10:
  buffer_load_dwordx4 v[20:23], v1, s[12:15], s64 offen offset:128 nt
  s_memrealtime s[76:77]
  v_lshlrev_b32 v10, 16, v163
  s_mov_b32 s70, 4000007
L_spin_11:
  ds_read_b128 v[12:15], v3 offset:512
  s_waitcnt lgkmcnt(0)
  v_cmp_eq_u32 vcc, 0, v15
  s_nop 0
  s_cbranch_vccz L_sdone_12
  s_sleep 1
  s_sub_u32 s70, s70, 1
  s_cbranch_scc0 L_spin_11
L_sdone_12:
  v_max_f32_dpp v12, v12, v12 quad_perm:[1,0,3,2] row_mask:0xf bank_mask:0xf
  v_max_f32_dpp v14, v14, v14 quad_perm:[1,0,3,2] row_mask:0xf bank_mask:0xf
  s_nop 0
  v_max_f32_dpp v12, v12, v12 quad_perm:[2,3,0,1] row_mask:0xf bank_mask:0xf
  v_max_f32_dpp v14, v14, v14 quad_perm:[2,3,0,1] row_mask:0xf bank_mask:0xf
  s_nop 0
  v_max_f32_dpp v12, v12, v12 row_half_mirror row_mask:0xf bank_mask:0xf
  v_max_f32_dpp v14, v14, v14 row_half_mirror row_mask:0xf bank_mask:0xf
  v_sub_f32 v4, v4, v12
  v_sub_f32 v5, v5, v14
  v_mul_f32 v4, s68, v4
  v_mul_f32 v5, s68, v5
  v_exp_f32 v4, v4
  v_exp_f32 v5, v5
  v_mov_b32 v2, 0
  s_mov_b32 s70, 4000007
L_spin_13:
  ds_read_b32 v13, v2 offset:648
  s_waitcnt lgkmcnt(0)
  v_cmp_gt_u32 vcc, 1, v13
  s_nop 0
  s_cbranch_vccz L_sdone_14
  s_sleep 2
  s_sub_u32 s70, s70, 1
  s_cbranch_scc0 L_spin_13
L_sdone_14:
  v_readfirstlane_b32 s46, v13
  v_min_u32 v12, 47, v0
  v_lshrrev_b32 v13, 3, v12
  v_lshlrev_b32 v13, 11, v13
  v_and_b32 v14, 1, v12
  v_lshl_add_u32 v13, v14, 10, v13
  v_bfe_u32 v14, v12, 1, 2
  v_lshl_add_u32 v13, v14, 8, v13
  v_lshlrev_b32 v12, 4, v12
  s_lshr_b32 s74, s2, 7
  s_lshl2_add_u32 s74, s4, s74
  s_mul_i32 s74, s74, 12288
  s_bfe_u32 s69, s2, 0x40003
  s_lshl4_add_u32 s74, s69, s74
  s_add_u32 s74, s74, 548864
  s_mov_b32 s22, 0x55555555
  s_mov_b32 s23, 0x55555555
  v_mov_b32 v14, s30
  v_mov_b32 v15, s31
  v_dot2c_f32_bf16 v64, v148, v163
  v_dot2c_f32_bf16 v65, v148, v10
  v_dot2c_f32_bf16 v66, v149, v163
  v_dot2c_f32_bf16 v67, v149, v10
  v_dot2c_f32_bf16 v68, v150, v163
  v_dot2c_f32_bf16 v69, v150, v10
  v_dot2c_f32_bf16 v70, v151, v163
  v_dot2c_f32_bf16 v71, v151, v10
  v_permlane32_swap_b32 v64, v68
  v_permlane32_swap_b32 v65, v69
  v_permlane32_swap_b32 v66, v70
  v_permlane32_swap_b32 v67, v71
  v_add_f32 v64, v64, v68
  v_add_f32 v65, v65, v69
  v_add_f32 v66, v66, v70
  v_add_f32 v67, v67, v71
  s_nop 0
  v_permlane16_swap_b32 v64, v66
  v_permlane16_swap_b32 v65, v67
  v_add_f32 v64, v64, v66
  v_add_f32 v65, v65, v67
  s_nop 0
  v_add_f32_dpp v64, v64, v64 row_ror:8 row_mask:0xf bank_mask:0xf
  v_add_f32_dpp v65, v65, v65 row_ror:8 row_mask:0xf bank_mask:0xf
  v_mul_f32 v64, v4, v64
  v_mul_f32 v65, v4, v65
  ds_write_b64 v8, v[64:65] offset:57856
  s_waitcnt lgkmcnt(0)
  s_lshl_b32 s75, s76, 4
  s_sub_u32 s75, s75, s78
  s_and_b32 s75, s75, s72
  s_add_u32 s78, s78, s79
  s_waitcnt vmcnt(3)
  s_cmp_gt_i32 s75, 480
  s_cbranch_scc1 L_go_15
  s_waitcnt vmcnt(2)
  s_cmp_ge_i32 s75, 0
  s_cbranch_scc1 L_go_15
  s_waitcnt vmcnt(1)
L_go_15:
  buffer_load_dwordx4 v[24:27], v1, s[12:15], s64 offen offset:256 nt
  s_memrealtime s[76:77]
  v_dot2c_f32_bf16 v72, v152, v163
  v_dot2c_f32_bf16 v73, v152, v10
  v_dot2c_f32_bf16 v74, v153, v163
  v_dot2c_f32_bf16 v75, v153, v10
  v_dot2c_f32_bf16 v76, v154, v163
  v_dot2c_f32_bf16 v77, v154, v10
  v_dot2c_f32_bf16 v78, v155, v163
  v_dot2c_f32_bf16 v79, v155, v10
  v_permlane32_swap_b32 v72, v76
  v_permlane32_swap_b32 v73, v77
  v_permlane32_swap_b32 v74, v78
  v_permlane32_swap_b32 v75, v79
  v_add_f32 v72, v72, v76
  v_add_f32 v73, v73, v77
  v_add_f32 v74, v74, v78
  v_add_f32 v75, v75, v79
  s_nop 0
  v_permlane16_swap_b32 v72, v74
  v_permlane16_swap_b32 v73, v75
  v_add_f32 v72, v72, v74
  v_add_f32 v73, v73, v75
  s_nop 0
  v_add_f32_dpp v72, v72, v72 row_ror:8 row_mask:0xf bank_mask:0xf
  v_add_f32_dpp v73, v73, v73 row_ror:8 row_mask:0xf bank_mask:0xf
  v_mul_f32 v72, v4, v72
  v_mul_f32 v73, v4, v73
  ds_write_b64 v8, v[72:73] offset:58112
  s_waitcnt lgkmcnt(0)
  s_lshl_b32 s75, s76, 4
  s_sub_u32 s75, s75, s78
  s_and_b32 s75, s75, s72
  s_add_u32 s78, s78, s79
  s_waitcnt vmcnt(3)
  s_cmp_gt_i32 s75, 480
  s_cbranch_scc1 L_go_16
  s_waitcnt vmcnt(2)
  s_cmp_ge_i32 s75, 0
  s_cbranch_scc1 L_go_16
  s_waitcnt vmcnt(1)
L_go_16:
  buffer_load_dwordx4 v[28:31], v1, s[12:15], s65 offen offset:0 nt
  s_memrealtime s[76:77]
  v_dot2c_f32_bf16 v80, v156, v163
  v_dot2c_f32_bf16 v81, v156, v10
  v_dot2c_f32_bf16 v82, v157, v163
  v_dot2c_f32_bf16 v83, v157, v10
  v_dot2c_f32_bf16 v84, v158, v163
  v_dot2c_f32_bf16 v85, v158, v10
  v_dot2c_f32_bf16 v86, v159, v163
  v_dot2c_f32_bf16 v87, v159, v10
  v_permlane32_swap_b32 v80, v84
  v_permlane32_swap_b32 v81, v85
  v_permlane32_swap_b32 v82, v86
  v_permlane32_swap_b32 v83, v87
  v_add_f32 v80, v80, v84
  v_add_f32 v81, v81, v85
  v_add_f32 v82, v82, v86
  v_add_f32 v83, v83, v87
  s_nop 0
  v_permlane16_swap_b32 v80, v82
  v_permlane16_swap_b32 v81, v83
  v_add_f32 v80, v80, v82
  v_add_f32 v81, v81, v83
  s_nop 0
  v_add_f32_dpp v80, v80, v80 row_ror:8 row_mask:0xf bank_mask:0xf
  v_add_f32_dpp v81, v81, v81 row_ror:8 row_mask:0xf bank_mask:0xf
  v_mul_f32 v80, v4, v80
  v_mul_f32 v81, v4, v81
  ds_write_b64 v8, v[80:81] offset:58368
  s_mov_b64 exec, 1
  ds_add_u32 v2, v11 offset:652
  s_mov_b64 exec, -1
  s_waitcnt lgkmcnt(0)
  s_lshl_b32 s75, s76, 4
  s_sub_u32 s75, s75, s78
  s_and_b32 s75, s75, s72
  s_add_u32 s78, s78, s79
  s_waitcnt vmcnt(3)
  s_cmp_gt_i32 s75, 480
  s_cbranch_scc1 L_go_17
  s_waitcnt vmcnt(2)
  s_cmp_ge_i32 s75, 0
  s_cbranch_scc1 L_go_17
  s_waitcnt vmcnt(1)
L_go_17:
  buffer_load_dwordx4 v[32:35], v1, s[12:15], s65 offen offset:128 nt
  s_memrealtime s[76:77]
  v_lshlrev_b32 v10, 16, v164
  v_dot2c_f32_bf16 v88, v16, v164
  v_dot2c_f32_bf16 v89, v16, v10
  v_dot2c_f32_bf16 v90, v17, v164
  v_dot2c_f32_bf16 v91, v17, v10
  v_dot2c_f32_bf16 v92, v18, v164
  v_dot2c_f32_bf16 v93, v18, v10
  v_dot2c_f32_bf16 v94, v19, v164
  v_dot2c_f32_bf16 v95, v19, v10
  s_waitcnt lgkmcnt(0)
  s_lshl_b32 s75, s76, 4
  s_sub_u32 s75, s75, s78
  s_and_b32 s75, s75, s72
  s_add_u32 s78, s78, s79
  s_waitcnt vmcnt(3)
  s_cmp_gt_i32 s75, 480
  s_cbranch_scc1 L_go_18
  s_waitcnt vmcnt(2)
  s_cmp_ge_i32 s75, 0
  s_cbranch_scc1 L_go_18
  s_waitcnt vmcnt(1)
L_go_18:
  buffer_load_dwordx4 v[36:39], v1, s[12:15], s65 offen offset:256 nt
  s_memrealtime s[76:77]
  v_dot2c_f32_bf16 v96, v20, v164
  v_dot2c_f32_bf16 v97, v20, v10
  v_dot2c_f32_bf16 v98, v21, v164
  v_dot2c_f32_bf16 v99, v21, v10
  v_dot2c_f32_bf16 v100, v22, v164
  v_dot2c_f32_bf16 v101, v22, v10
  v_dot2c_f32_bf16 v102, v23, v164
  v_dot2c_f32_bf16 v103, v23, v10
  s_waitcnt lgkmcnt(0)
  s_lshl_b32 s75, s76, 4
  s_sub_u32 s75, s75, s78
  s_and_b32 s75, s75, s72
  s_add_u32 s78, s78, s79
  s_waitcnt vmcnt(3)
  s_cmp_gt_i32 s75, 480
  s_cbranch_scc1 L_go_19
  s_waitcnt vmcnt(2)
  s_cmp_ge_i32 s75, 0
  s_cbranch_scc1 L_go_19
  s_waitcnt vmcnt(1)
L_go_19:
  buffer_load_dwordx4 v[40:43], v1, s[12:15], s66 offen offset:0 nt
  s_memrealtime s[76:77]
  v_dot2c_f32_bf16 v104, v24, v164
  v_dot2c_f32_bf16 v105, v24, v10
  v_dot2c_f32_bf16 v106, v25, v164
  v_dot2c_f32_bf16 v107, v25, v10
  v_dot2c_f32_bf16 v108, v26, v164
  v_dot2c_f32_bf16 v109, v26, v10
  v_dot2c_f32_bf16 v110, v27, v164
  v_dot2c_f32_bf16 v111, v27, v10
  s_waitcnt lgkmcnt(0)
  s_lshl_b32 s75, s76, 4
  s_sub_u32 s75, s75, s78
  s_and_b32 s75, s75, s72
  s_add_u32 s78, s78, s79
  s_waitcnt vmcnt(3)
  s_cmp_gt_i32 s75, 480
  s_cbranch_scc1 L_go_20
  s_waitcnt vmcnt(2)
  s_cmp_ge_i32 s75, 0
  s_cbranch_scc1 L_go_20
  s_waitcnt vmcnt(1)
L_go_20:
  buffer_load_dwordx4 v[44:47], v1, s[12:15], s66 offen offset:128 nt
  s_memrealtime s[76:77]
  v_lshlrev_b32 v10, 16, v165
  v_dot2c_f32_bf16 v88, v28, v165
  v_dot2c_f32_bf16 v89, v28, v10
  v_dot2c_f32_bf16 v90, v29, v165
  v_dot2c_f32_bf16 v91, v29, v10
  v_dot2c_f32_bf16 v92, v30, v165
  v_dot2c_f32_bf16 v93, v30, v10
  v_dot2c_f32_bf16 v94, v31, v165
  v_dot2c_f32_bf16 v95, v31, v10
  s_waitcnt lgkmcnt(0)
  s_lshl_b32 s75, s76, 4
  s_sub_u32 s75, s75, s78
  s_and_b32 s75, s75, s72
  s_add_u32 s78, s78, s79
  s_waitcnt vmcnt(3)
  s_cmp_gt_i32 s75, 480
  s_cbranch_scc1 L_go_21
  s_waitcnt vmcnt(2)
  s_cmp_ge_i32 s75, 0
  s_cbranch_scc1 L_go_21
  s_waitcnt vmcnt(1)
L_go_21:
  buffer_load_dwordx4 v[48:51], v1, s[12:15], s66 offen offset:256 nt
  s_memrealtime s[76:77]
  v_dot2c_f32_bf16 v96, v32, v165
  v_dot2c_f32_bf16 v97, v32, v10
  v_dot2c_f32_bf16 v98, v33, v165
  v_dot2c_f32_bf16 v99, v33, v10
  v_dot2c_f32_bf16 v100, v34, v165
  v_dot2c_f32_bf16 v101, v34, v10
  v_dot2c_f32_bf16 v102, v35, v165
  v_dot2c_f32_bf16 v103, v35, v10
  s_waitcnt lgkmcnt(0)
  s_lshl_b32 s75, s76, 4
  s_sub_u32 s75, s75, s78
  s_and_b32 s75, s75, s72
  s_add_u32 s78, s78, s79
  s_waitcnt vmcnt(3)
  s_cmp_gt_i32 s75, 480
  s_cbranch_scc1 L_go_22
  s_waitcnt vmcnt(2)
  s_cmp_ge_i32 s75, 0
  s_cbranch_scc1 L_go_22
  s_waitcnt vmcnt(1)
L_go_22:
  buffer_load_dwordx4 v[52:55], v1, s[12:15], s67 offen offset:0 nt
  s_memrealtime s[76:77]
  s_mov_b64 exec, 1
  ds_add_u32 v2, v11 offset:644
  s_mov_b64 exec, -1
  v_dot2c_f32_bf16 v104, v36, v165
  v_dot2c_f32_bf16 v105, v36, v10
  v_dot2c_f32_bf16 v106, v37, v165
  v_dot2c_f32_bf16 v107, v37, v10
  v_dot2c_f32_bf16 v108, v38, v165
  v_dot2c_f32_bf16 v109, v38, v10
  v_dot2c_f32_bf16 v110, v39, v165
  v_dot2c_f32_bf16 v111, v39, v10
  s_waitcnt lgkmcnt(0)
  s_lshl_b32 s75, s76, 4
  s_sub_u32 s75, s75, s78
  s_and_b32 s75, s75, s72
  s_add_u32 s78, s78, s79
  s_waitcnt vmcnt(3)
  s_cmp_gt_i32 s75, 480
  s_cbranch_scc1 L_go_23
  s_waitcnt vmcnt(2)
  s_cmp_ge_i32 s75, 0
  s_cbranch_scc1 L_go_23
  s_waitcnt vmcnt(1)
L_go_23:
  buffer_load_dwordx4 v[56:59], v1, s[12:15], s67 offen offset:128 nt
  s_memrealtime s[76:77]
  v_lshlrev_b32 v10, 16, v166
  v_dot2c_f32_bf16 v88, v40, v166
  v_dot2c_f32_bf16 v89, v40, v10
  v_dot2c_f32_bf16 v90, v41, v166
  v_dot2c_f32_bf16 v91, v41, v10
  v_dot2c_f32_bf16 v92, v42, v166
  v_dot2c_f32_bf16 v93, v42, v10
  v_dot2c_f32_bf16 v94, v43, v166
  v_dot2c_f32_bf16 v95, v43, v10
  s_waitcnt lgkmcnt(0)
  s_lshl_b32 s75, s76, 4
  s_sub_u32 s75, s75, s78
  s_and_b32 s75, s75, s72
  s_add_u32 s78, s78, s79
  s_waitcnt vmcnt(3)
  s_cmp_gt_i32 s75, 480
  s_cbranch_scc1 L_go_24
  s_waitcnt vmcnt(2)
  s_cmp_ge_i32 s75, 0
  s_cbranch_scc1 L_go_24
  s_waitcnt vmcnt(1)
L_go_24:
  buffer_load_dwordx4 v[60:63], v1, s[12:15], s67 offen offset:256 nt
  v_dot2c_f32_bf16 v96, v44, v166
  v_dot2c_f32_bf16 v97, v44, v10
  v_dot2c_f32_bf16 v98, v45, v166
  v_dot2c_f32_bf16 v99, v45, v10
  v_dot2c_f32_bf16 v100, v46, v166
  v_dot2c_f32_bf16 v101, v46, v10
  v_dot2c_f32_bf16 v102, v47, v166
  v_dot2c_f32_bf16 v103, v47, v10
  s_waitcnt vmcnt(3)
  v_dot2c_f32_bf16 v104, v48, v166
  v_dot2c_f32_bf16 v105, v48, v10
  v_dot2c_f32_bf16 v106, v49, v166
  v_dot2c_f32_bf16 v107, v49, v10
  v_dot2c_f32_bf16 v108, v50, v166
  v_dot2c_f32_bf16 v109, v50, v10
  v_dot2c_f32_bf16 v110, v51, v166
  v_dot2c_f32_bf16 v111, v51, v10
  s_waitcnt vmcnt(2)
  v_lshlrev_b32 v10, 16, v167
  v_dot2c_f32_bf16 v88, v52, v167
  v_dot2c_f32_bf16 v89, v52, v10
  v_dot2c_f32_bf16 v90, v53, v167
  v_dot2c_f32_bf16 v91, v53, v10
  v_dot2c_f32_bf16 v92, v54, v167
  v_dot2c_f32_bf16 v93, v54, v10
  v_dot2c_f32_bf16 v94, v55, v167
  v_dot2c_f32_bf16 v95, v55, v10
  v_permlane32_swap_b32 v88, v92
  v_permlane32_swap_b32 v89, v93
  v_permlane32_swap_b32 v90, v94
  v_permlane32_swap_b32 v91, v95
  v_add_f32 v88, v88, v92
  v_add_f32 v89, v89, v93
  v_add_f32 v90, v90, v94
  v_add_f32 v91, v91, v95
  s_nop 0
  v_permlane16_swap_b32 v88, v90
  v_permlane16_swap_b32 v89, v91
  v_add_f32 v88, v88, v90
  v_add_f32 v89, v89, v91
  s_nop 0
  v_add_f32_dpp v88, v88, v88 row_ror:8 row_mask:0xf bank_mask:0xf
  v_add_f32_dpp v89, v89, v89 row_ror:8 row_mask:0xf bank_mask:0xf
  v_mul_f32 v88, v5, v88
  v_mul_f32 v89, v5, v89
  ds_write_b64 v8, v[88:89] offset:1024
  s_waitcnt vmcnt(1)
  v_dot2c_f32_bf16 v96, v56, v167
  v_dot2c_f32_bf16 v97, v56, v10
  v_dot2c_f32_bf16 v98, v57, v167
  v_dot2c_f32_bf16 v99, v57, v10
  v_dot2c_f32_bf16 v100, v58, v167
  v_dot2c_f32_bf16 v101, v58, v10
  v_dot2c_f32_bf16 v102, v59, v167
  v_dot2c_f32_bf16 v103, v59, v10
  v_permlane32_swap_b32 v96, v100
  v_permlane32_swap_b32 v97, v101
  v_permlane32_swap_b32 v98, v102
  v_permlane32_swap_b32 v99, v103
  v_add_f32 v96, v96, v100
  v_add_f32 v97, v97, v101
  v_add_f32 v98, v98, v102
  v_add_f32 v99, v99, v103
  s_nop 0
  v_permlane16_swap_b32 v96, v98
  v_permlane16_swap_b32 v97, v99
  v_add_f32 v96, v96, v98
  v_add_f32 v97, v97, v99
  s_nop 0
  v_add_f32_dpp v96, v96, v96 row_ror:8 row_mask:0xf bank_mask:0xf
  v_add_f32_dpp v97, v97, v97 row_ror:8 row_mask:0xf bank_mask:0xf
  v_mul_f32 v96, v5, v96
  v_mul_f32 v97, v5, v97
  ds_write_b64 v8, v[96:97] offset:1280
  s_waitcnt vmcnt(0)
  v_dot2c_f32_bf16 v104, v60, v167
  v_dot2c_f32_bf16 v105, v60, v10
  v_dot2c_f32_bf16 v106, v61, v167
  v_dot2c_f32_bf16 v107, v61, v10
  v_dot2c_f32_bf16 v108, v62, v167
  v_dot2c_f32_bf16 v109, v62, v10
  v_dot2c_f32_bf16 v110, v63, v167
  v_dot2c_f32_bf16 v111, v63, v10
  v_permlane32_swap_b32 v104, v108
  v_permlane32_swap_b32 v105, v109
  v_permlane32_swap_b32 v106, v110
  v_permlane32_swap_b32 v107, v111
  v_add_f32 v104, v104, v108
  v_add_f32 v105, v105, v109
  v_add_f32 v106, v106, v110
  v_add_f32 v107, v107, v111
  s_nop 0
  v_permlane16_swap_b32 v104, v106
  v_permlane16_swap_b32 v105, v107
  v_add_f32 v104, v104, v106
  v_add_f32 v105, v105, v107
  s_nop 0
  v_add_f32_dpp v104, v104, v104 row_ror:8 row_mask:0xf bank_mask:0xf
  v_add_f32_dpp v105, v105, v105 row_ror:8 row_mask:0xf bank_mask:0xf
  v_mul_f32 v104, v5, v104
  v_mul_f32 v105, v5, v105
  ds_write_b64 v8, v[104:105] offset:1536
  s_mov_b64 exec, 1
  ds_add_rtn_u32 v10, v2, v11 offset:640
  s_mov_b64 exec, -1
  ds_read_b128 v[16:19], v12 offset:1024
  ds_read_b128 v[20:23], v12 offset:1792
  ds_read_b128 v[24:27], v12 offset:2560
  ds_read_b128 v[28:31], v12 offset:3328
  ds_read_b128 v[32:35], v12 offset:4096
  ds_read_b128 v[36:39], v12 offset:4864
  ds_read_b128 v[40:43], v12 offset:5632
  ds_read_b128 v[44:47], v12 offset:6400
  s_waitcnt lgkmcnt(8)
  v_readfirstlane_b32 s68, v10
  s_nop 0
  s_cmp_lg_u32 s68, 7
  s_cbranch_scc1 L_nopub
  s_waitcnt lgkmcnt(6)
  v_pk_add_f32 v[16:17], v[16:17], v[20:21]
  v_pk_add_f32 v[18:19], v[18:19], v[22:23]
  s_waitcnt lgkmcnt(4)
  v_pk_add_f32 v[24:25], v[24:25], v[28:29]
  v_pk_add_f32 v[26:27], v[26:27], v[30:31]
  v_pk_add_f32 v[16:17], v[16:17], v[24:25]
  v_pk_add_f32 v[18:19], v[18:19], v[26:27]
  s_waitcnt lgkmcnt(2)
  v_pk_add_f32 v[32:33], v[32:33], v[36:37]
  v_pk_add_f32 v[34:35], v[34:35], v[38:39]
  s_waitcnt lgkmcnt(0)
  v_pk_add_f32 v[40:41], v[40:41], v[44:45]
  v_pk_add_f32 v[42:43], v[42:43], v[46:47]
  v_pk_add_f32 v[32:33], v[32:33], v[40:41]
  v_pk_add_f32 v[34:35], v[34:35], v[42:43]
  v_pk_add_f32 v[4:5], v[16:17], v[32:33]
  v_pk_add_f32 v[6:7], v[18:19], v[34:35]
  v_cvt_pk_bf16_f32 v8, v4, v5
  v_cvt_pk_bf16_f32 v9, v6, v7
  v_cndmask_b32 v4, v8, v14, s[22:23]
  v_cndmask_b32 v5, v9, v15, s[22:23]
  v_cndmask_b32 v6, v14, v8, s[22:23]
  v_cndmask_b32 v7, v15, v9, s[22:23]
  s_mov_b32 exec_lo, 0xffffffff
  s_mov_b32 exec_hi, 0xffff
  buffer_store_dwordx4 v[4:7], v13, s[32:35], s74 offen
  s_mov_b64 exec, -1
  s_cmp_lg_u32 s46, 1
  s_cbranch_scc1 L_slow_25
L_back_26:
  ds_write_b32 v2, v11 offset:668
L_nopub:
  s_waitcnt lgkmcnt(0)
  s_cmp_lt_u32 s5, 20
  s_cbranch_scc1 L_notf1
  s_cmp_lt_u32 s5, 30
  s_cbranch_scc1 L_f1
  s_branch L_spare
L_notf1:
  s_cmp_gt_u32 s5, 11
  s_cbranch_scc1 L_stream_exit
  s_cmp_gt_u32 s3, 6
  s_cbranch_scc1 L_f2
  s_branch L_dry
L_stream_exit:
  s_endpgm
L_helper:
  s_setprio 3
  v_lshlrev_b32 v1, 2, v0
  v_lshrrev_b32 v2, 3, v0
  s_mul_i32 s68, s7, 80
  v_add_u32 v3, s68, v2
  v_lshlrev_b32 v3, 1, v3
  v_mul_u32_u24 v2, 12288, v2
  v_and_b32 v7, 7, v0
  v_lshl_add_u32 v2, v7, 4, v2
  s_mul_i32 s68, s68, 12288
  s_mul_i32 s69, s6, 384
  s_add_u32 s68, s68, s69
  s_lshl_b32 s69, s3, 7
  s_add_u32 s68, s68, s69
  s_waitcnt lgkmcnt(0)
  s_load_dword s12, s[36:37], 0
  s_load_dword s13, s[36:37], 128
  s_load_dword s14, s[36:37], 256
  s_load_dword s15, s[36:37], 384
  s_load_dword s16, s[36:37], 512
  s_load_dword s17, s[36:37], 640
  s_load_dword s18, s[36:37], 768
  s_load_dword s19, s[36:37], 896
  s_load_dword s20, s[36:37], 1024
  s_load_dword s21, s[36:37], 1152
  s_barrier
  s_mov_b32 s8, s42
  s_mov_b32 s9, s43
  s_mov_b32 s10, 7864320
  s_mov_b32 s11, 0x20000
  s_waitcnt lgkmcnt(0)
  global_load_dword v64, v1, s[36:37] offset:0
  global_load_dword v65, v1, s[36:37] offset:256
  global_load_dword v66, v1, s[36:37] offset:512
  global_load_dword v67, v1, s[36:37] offset:768
  global_load_dword v68, v1, s[36:37] offset:1024
  global_load_ushort v8, v3, s[36:37] offset:0
  global_load_ushort v9, v3, s[36:37] offset:16
  global_load_ushort v10, v3, s[36:37] offset:32
  global_load_ushort v11, v3, s[36:37] offset:48
  global_load_ushort v12, v3, s[36:37] offset:64
  global_load_ushort v13, v3, s[36:37] offset:80
  global_load_ushort v14, v3, s[36:37] offset:96
  global_load_ushort v15, v3, s[36:37] offset:112
  global_load_ushort v16, v3, s[36:37] offset:128
  global_load_ushort v17, v3, s[36:37] offset:144
  s_load_dwordx2 s[28:29], s[58:59], 917504
  s_mov_b32 s69, 0xffff0000
  s_mov_b32 s24, s58
  s_mov_b32 s25, s59
  s_mov_b32 s26, 4194304
  s_mov_b32 s27, 0x20000
  s_add_u32 s32, s58, 4194304
  s_addc_u32 s33, s59, 0
  s_mov_b32 s34, 4194304
  s_mov_b32 s35, 0x20000
  s_lshl3_add_u32 s71, s6, s7
  s_mul_i32 s5, s79, 5
  s_mul_i32 s47, s79, 3
  s_add_u32 s47, s47, 15
  s_cmp_lt_u32 s7, 5
  s_cselect_b32 s5, s5, s47
  s_add_u32 s5, s5, s7
  s_waitcnt lgkmcnt(0)
  s_mul_i32 s30, s28, 0x2c9277b5
  s_add_u32 s30, s30, 0xac564b05
  s_mul_i32 s31, s29, 0x0019660d
  s_add_u32 s31, s31, 0x3c6ef35f
  s_waitcnt vmcnt(10)
  v_lshlrev_b32 v70, 16, v64
  v_and_b32 v71, s69, v64
  v_lshlrev_b32 v72, 16, v65
  v_and_b32 v73, s69, v65
  v_lshlrev_b32 v74, 16, v66
  v_and_b32 v75, s69, v66
  v_lshlrev_b32 v76, 16, v67
  v_and_b32 v77, s69, v67
  v_lshlrev_b32 v78, 16, v68
  v_and_b32 v79, s69, v68
  v_add_f32 v4, v70, v71
  v_add_f32 v5, v72, v73
  v_add_f32 v6, v74, v75
  v_add_f32 v7, v76, v77
  v_add_f32 v4, v4, v5
  v_add_f32 v6, v6, v7
  v_add_f32 v5, v78, v79
  v_add_f32 v4, v4, v6
  v_add_f32 v4, v4, v5
  s_nop 1
  v_add_f32_dpp v4, v4, v4 quad_perm:[1,0,3,2] row_mask:0xf bank_mask:0xf
  s_nop 1
  v_add_f32_dpp v4, v4, v4 quad_perm:[2,3,0,1] row_mask:0xf bank_mask:0xf
  s_nop 1
  v_add_f32_dpp v4, v4, v4 row_half_mirror row_mask:0xf bank_mask:0xf
  s_nop 1
  v_add_f32_dpp v4, v4, v4 row_mirror row_mask:0xf bank_mask:0xf
  v_mov_b32 v5, v4
  s_nop 1
  v_permlane16_swap_b32 v4, v5
  v_add_f32 v4, v4, v5
  v_mov_b32 v5, v4
  s_nop 1
  v_permlane32_swap_b32 v4, v5
  v_add_f32 v4, v4, v5
  v_mul_f32 v4, 0x3acccccd, v4
  v_sub_f32 v70, v70, v4
  v_sub_f32 v71, v71, v4
  v_sub_f32 v72, v72, v4
  v_sub_f32 v73, v73, v4
  v_sub_f32 v74, v74, v4
  v_sub_f32 v75, v75, v4
  v_sub_f32 v76, v76, v4
  v_sub_f32 v77, v77, v4
  v_sub_f32 v78, v78, v4
  v_sub_f32 v79, v79, v4
  v_mul_f32 v5, v70, v70
  v_fmac_f32 v5, v71, v71
  v_fmac_f32 v5, v72, v72
  v_fmac_f32 v5, v73, v73
  v_fmac_f32 v5, v74, v74
  v_fmac_f32 v5, v75, v75
  v_fmac_f32 v5, v76, v76
  v_fmac_f32 v5, v77, v77
  v_fmac_f32 v5, v78, v78
  v_fmac_f32 v5, v79, v79
  s_nop 1
  v_add_f32_dpp v5, v5, v5 quad_perm:[1,0,3,2] row_mask:0xf bank_mask:0xf
  s_nop 1
  v_add_f32_dpp v5, v5, v5 quad_perm:[2,3,0,1] row_mask:0xf bank_mask:0xf
  s_nop 1
  v_add_f32_dpp v5, v5, v5 row_half_mirror row_mask:0xf bank_mask:0xf
  s_nop 1
  v_add_f32_dpp v5, v5, v5 row_mirror row_mask:0xf bank_mask:0xf
  v_mov_b32 v6, v5
  s_nop 1
  v_permlane16_swap_b32 v5, v6
  v_add_f32 v5, v5, v6
  v_mov_b32 v6, v5
  s_nop 1
  v_permlane32_swap_b32 v5, v6
  v_add_f32 v5, v5, v6
  v_mul_f32 v5, 0x3acccccd, v5
  v_cvt_pk_bf16_f32 v4, v4, v4
  v_lshlrev_b32 v4, 16, v4
  v_cvt_pk_bf16_f32 v5, v5, v5
  v_lshlrev_b32 v5, 16, v5
  v_add_f32 v5, 0x3727c5ac, v5
  v_cvt_pk_bf16_f32 v5, v5, v5
  v_lshlrev_b32 v5, 16, v5
  v_sqrt_f32 v5, v5
  s_nop 0
  v_cvt_pk_bf16_f32 v5, v5, v5
  v_lshlrev_b32 v5, 16, v5
  v_rcp_f32 v5, v5
  v_mov_b32 v6, 0
  s_waitcnt vmcnt(0)
  v_lshlrev_b32 v8, 16, v8
  v_lshlrev_b32 v9, 16, v9
  v_lshlrev_b32 v10, 16, v10
  v_lshlrev_b32 v11, 16, v11
  v_lshlrev_b32 v12, 16, v12
  v_lshlrev_b32 v13, 16, v13
  v_lshlrev_b32 v14, 16, v14
  v_lshlrev_b32 v15, 16, v15
  v_lshlrev_b32 v16, 16, v16
  v_lshlrev_b32 v17, 16, v17
  v_sub_f32 v8, v8, v4
  v_sub_f32 v9, v9, v4
  v_sub_f32 v10, v10, v4
  v_sub_f32 v11, v11, v4
  v_sub_f32 v12, v12, v4
  v_sub_f32 v13, v13, v4
  v_sub_f32 v14, v14, v4
  v_sub_f32 v15, v15, v4
  v_sub_f32 v16, v16, v4
  v_sub_f32 v17, v17, v4
  v_cvt_pk_bf16_f32 v8, v6, v8
  v_cvt_pk_bf16_f32 v9, v6, v9
  v_cvt_pk_bf16_f32 v10, v6, v10
  v_cvt_pk_bf16_f32 v11, v6, v11
  v_cvt_pk_bf16_f32 v12, v6, v12
  v_cvt_pk_bf16_f32 v13, v6, v13
  v_cvt_pk_bf16_f32 v14, v6, v14
  v_cvt_pk_bf16_f32 v15, v6, v15
  v_cvt_pk_bf16_f32 v16, v6, v16
  v_cvt_pk_bf16_f32 v17, v6, v17
  v_mul_f32 v8, v8, v5
  v_mul_f32 v9, v9, v5
  v_mul_f32 v10, v10, v5
  v_mul_f32 v11, v11, v5
  v_mul_f32 v12, v12, v5
  v_mul_f32 v13, v13, v5
  v_mul_f32 v14, v14, v5
  v_mul_f32 v15, v15, v5
  v_mul_f32 v16, v16, v5
  v_mul_f32 v17, v17, v5
  v_cvt_pk_bf16_f32 v70, v6, v8
  v_cvt_pk_bf16_f32 v8, v8, v6
  v_cvt_pk_bf16_f32 v71, v6, v9
  v_cvt_pk_bf16_f32 v9, v9, v6
  v_cvt_pk_bf16_f32 v72, v6, v10
  v_cvt_pk_bf16_f32 v10, v10, v6
  v_cvt_pk_bf16_f32 v73, v6, v11
  v_cvt_pk_bf16_f32 v11, v11, v6
  v_cvt_pk_bf16_f32 v74, v6, v12
  v_cvt_pk_bf16_f32 v12, v12, v6
  v_cvt_pk_bf16_f32 v75, v6, v13
  v_cvt_pk_bf16_f32 v13, v13, v6
  v_cvt_pk_bf16_f32 v76, v6, v14
  v_cvt_pk_bf16_f32 v14, v14, v6
  v_cvt_pk_bf16_f32 v77, v6, v15
  v_cvt_pk_bf16_f32 v15, v15, v6
  v_cvt_pk_bf16_f32 v78, v6, v16
  v_cvt_pk_bf16_f32 v16, v16, v6
  v_cvt_pk_bf16_f32 v79, v6, v17
  v_cvt_pk_bf16_f32 v17, v17, v6
  v_mov_b32 v80, 0
  v_mov_b32 v81, 0
  v_mov_b32 v82, 0
  v_mov_b32 v83, 0
  v_mov_b32 v84, 0
  v_mov_b32 v85, 0
  v_mov_b32 v86, 0
  v_mov_b32 v87, 0
  v_and_b32 v90, 7, v0
  v_lshrrev_b32 v6, 4, v0
  v_lshl_add_u32 v90, v90, 2, v6
  v_lshlrev_b32 v90, 4, v90
  s_lshl_b32 s64, s71, 11
  s_lshl_b32 s69, s3, 9
  s_add_u32 s64, s64, s69
  v_dot2c_f32_bf16 v80, v24, v8
  v_dot2c_f32_bf16 v81, v24, v70
  v_dot2c_f32_bf16 v82, v25, v8
  v_dot2c_f32_bf16 v83, v25, v70
  v_dot2c_f32_bf16 v84, v26, v8
  v_dot2c_f32_bf16 v85, v26, v70
  v_dot2c_f32_bf16 v86, v27, v8
  v_dot2c_f32_bf16 v87, v27, v70
  v_dot2c_f32_bf16 v80, v28, v9
  v_dot2c_f32_bf16 v81, v28, v71
  v_dot2c_f32_bf16 v82, v29, v9
  v_dot2c_f32_bf16 v83, v29, v71
  v_dot2c_f32_bf16 v84, v30, v9
  v_dot2c_f32_bf16 v85, v30, v71
  v_dot2c_f32_bf16 v86, v31, v9
  v_dot2c_f32_bf16 v87, v31, v71
  v_dot2c_f32_bf16 v80, v32, v10
  v_dot2c_f32_bf16 v81, v32, v72
  v_dot2c_f32_bf16 v82, v33, v10
  v_dot2c_f32_bf16 v83, v33, v72
  v_dot2c_f32_bf16 v84, v34, v10
  v_dot2c_f32_bf16 v85, v34, v72
  v_dot2c_f32_bf16 v86, v35, v10
  v_dot2c_f32_bf16 v87, v35, v72
  v_dot2c_f32_bf16 v80, v36, v11
  v_dot2c_f32_bf16 v81, v36, v73
  v_dot2c_f32_bf16 v82, v37, v11
  v_dot2c_f32_bf16 v83, v37, v73
  v_dot2c_f32_bf16 v84, v38, v11
  v_dot2c_f32_bf16 v85, v38, v73
  v_dot2c_f32_bf16 v86, v39, v11
  v_dot2c_f32_bf16 v87, v39, v73
  v_dot2c_f32_bf16 v80, v40, v12
  v_dot2c_f32_bf16 v81, v40, v74
  v_dot2c_f32_bf16 v82, v41, v12
  v_dot2c_f32_bf16 v83, v41, v74
  v_dot2c_f32_bf16 v84, v42, v12
  v_dot2c_f32_bf16 v85, v42, v74
  v_dot2c_f32_bf16 v86, v43, v12
  v_dot2c_f32_bf16 v87, v43, v74
  v_dot2c_f32_bf16 v80, v44, v13
  v_dot2c_f32_bf16 v81, v44, v75
  v_dot2c_f32_bf16 v82, v45, v13
  v_dot2c_f32_bf16 v83, v45, v75
  v_dot2c_f32_bf16 v84, v46, v13
  v_dot2c_f32_bf16 v85, v46, v75
  v_dot2c_f32_bf16 v86, v47, v13
  v_dot2c_f32_bf16 v87, v47, v75
  v_dot2c_f32_bf16 v80, v48, v14
  v_dot2c_f32_bf16 v81, v48, v76
  v_dot2c_f32_bf16 v82, v49, v14
  v_dot2c_f32_bf16 v83, v49, v76
  v_dot2c_f32_bf16 v84, v50, v14
  v_dot2c_f32_bf16 v85, v50, v76
  v_dot2c_f32_bf16 v86, v51, v14
  v_dot2c_f32_bf16 v87, v51, v76
  v_dot2c_f32_bf16 v80, v52, v15
  v_dot2c_f32_bf16 v81, v52, v77
  v_dot2c_f32_bf16 v82, v53, v15
  v_dot2c_f32_bf16 v83, v53, v77
  v_dot2c_f32_bf16 v84, v54, v15
  v_dot2c_f32_bf16 v85, v54, v77
  v_dot2c_f32_bf16 v86, v55, v15
  v_dot2c_f32_bf16 v87, v55, v77
  v_dot2c_f32_bf16 v80, v56, v16
  v_dot2c_f32_bf16 v81, v56, v78
  v_dot2c_f32_bf16 v82, v57, v16
  v_dot2c_f32_bf16 v83, v57, v78
  v_dot2c_f32_bf16 v84, v58, v16
  v_dot2c_f32_bf16 v85, v58, v78
  v_dot2c_f32_bf16 v86, v59, v16
  v_dot2c_f32_bf16 v87, v59, v78
  v_dot2c_f32_bf16 v80, v60, v17
  v_dot2c_f32_bf16 v81, v60, v79
  v_dot2c_f32_bf16 v82, v61, v17
  v_dot2c_f32_bf16 v83, v61, v79
  v_dot2c_f32_bf16 v84, v62, v17
  v_dot2c_f32_bf16 v85, v62, v79
  v_dot2c_f32_bf16 v86, v63, v17
  v_dot2c_f32_bf16 v87, v63, v79
  v_permlane32_swap_b32 v80, v84
  v_permlane32_swap_b32 v81, v85
  v_permlane32_swap_b32 v82, v86
  v_permlane32_swap_b32 v83, v87
  v_add_f32 v80, v80, v84
  v_add_f32 v81, v81, v85
  v_add_f32 v82, v82, v86
  v_add_f32 v83, v83, v87
  s_nop 0
  v_permlane16_swap_b32 v80, v82
  v_permlane16_swap_b32 v81, v83
  v_add_f32 v80, v80, v82
  v_add_f32 v81, v81, v83
  s_nop 0
  v_add_f32_dpp v80, v80, v80 row_ror:8 row_mask:0xf bank_mask:0xf
  v_add_f32_dpp v81, v81, v81 row_ror:8 row_mask:0xf bank_mask:0xf
  v_mov_b32 v82, s30
  v_mov_b32 v83, s31
  s_mov_b32 exec_lo, 0xff00ff
  s_mov_b32 exec_hi, 0xff00ff
  buffer_store_dwordx4 v[80:83], v90, s[32:35], s64 offen offset:0
  s_mov_b64 exec, -1
  v_and_b32 v3, 31, v0
  v_lshrrev_b32 v2, 5, v0
  v_lshlrev_b32 v2, 11, v2
  v_lshl_add_u32 v2, v3, 4, v2
  s_lshl_b32 s68, s6, 14
  s_add_u32 s60, s68, s69
  s_add_u32 s61, s60, 4096
  s_add_u32 s62, s60, 8192
  s_add_u32 s63, s60, 12288
  v_lshlrev_b32 v3, 2, v3
  s_lshl_b32 s69, s3, 7
  v_add_u32 v3, s69, v3
  v_mov_b32 v1, 0
  s_mov_b32 s65, 0
  s_add_u32 s68, s3, 5
  s_cmp_lg_u32 s68, s7
  s_cbranch_scc1 L_qwait
  s_mov_b32 s16, s32
  s_mov_b32 s17, s33
  s_mov_b32 s18, 4194304
  s_mov_b32 s19, 0x20000
  s_mov_b32 s70, 4000007
L_spin_27:
  buffer_load_dwordx4 v[8:11], v2, s[16:19], s60 offen offset:0 sc1 nt
  buffer_load_dwordx4 v[12:15], v2, s[16:19], s61 offen offset:0 sc1 nt
  buffer_load_dwordx4 v[16:19], v2, s[16:19], s62 offen offset:0 sc1 nt
  buffer_load_dwordx4 v[20:23], v2, s[16:19], s63 offen offset:0 sc1 nt
  s_waitcnt vmcnt(0)
  v_cmp_ne_u64 vcc, s[30:31], v[10:11]
  v_cmp_ne_u64 s[20:21], s[30:31], v[14:15]
  v_cmp_ne_u64 s[22:23], s[30:31], v[18:19]
  s_or_b64 vcc, vcc, s[20:21]
  v_cmp_ne_u64 s[20:21], s[30:31], v[22:23]
  s_or_b64 vcc, vcc, s[22:23]
  s_or_b64 vcc, vcc, s[20:21]
  s_nop 0
  s_cbranch_vccz L_sdone_28
  s_sleep 2
  ds_read_b32 v4, v1 offset:648
  s_waitcnt lgkmcnt(0)
  v_readfirstlane_b32 s46, v4
  s_nop 0
  s_sub_u32 s68, s46, s65
  s_cmp_lg_u32 s68, 2
  s_cbranch_scc1 L_qlazy_29
  s_mov_b32 exec_lo, 0xff00ff
  s_mov_b32 exec_hi, 0xff00ff
  buffer_store_dwordx4 v[80:83], v90, s[24:27], s64 offen offset:0 sc1
  s_mov_b64 exec, -1
  s_mov_b32 s65, 1
L_qlazy_29:
  s_and_b32 s99, s70, 7
  s_cselect_b32 s16, s32, s24
  s_cselect_b32 s17, s33, s25
  s_sub_u32 s70, s70, 1
  s_cbranch_scc0 L_spin_27
L_sdone_28:
  v_add_f32 v8, v8, v12
  v_add_f32 v9, v9, v13
  v_add_f32 v16, v16, v20
  v_add_f32 v17, v17, v21
  v_add_f32 v8, v8, v16
  v_add_f32 v9, v9, v17
  v_mov_b32 v10, v8
  v_mov_b32 v11, v9
  s_nop 0
  v_permlane32_swap_b32 v8, v10
  v_permlane32_swap_b32 v9, v11
  v_add_f32 v8, v8, v10
  v_add_f32 v9, v9, v11
  v_cvt_pk_bf16_f32 v8, v8, v9
  s_lshl_b32 s66, s6, 14
  s_lshl_b32 s68, s3, 11
  s_add_u32 s66, s66, s68
  v_mov_b32_dpp v9, v8 quad_perm:[1,0,3,2] row_mask:0xf bank_mask:0xf
  v_mov_b32 v10, s30
  v_mov_b32 v11, s31
  v_lshlrev_b32 v2, 3, v0
  v_mov_b32 v1, 0
  s_mov_b32 s70, 4000007
L_spin_30:
  ds_read_b32 v4, v1 offset:648
  s_waitcnt lgkmcnt(0)
  v_cmp_gt_u32 vcc, 1, v4
  s_nop 0
  s_cbranch_vccz L_sdone_31
  s_sleep 2
  s_sub_u32 s70, s70, 1
  s_cbranch_scc0 L_spin_30
L_sdone_31:
  v_readfirstlane_b32 s46, v4
  s_mov_b32 exec_lo, 0x55555555
  s_mov_b32 exec_hi, 0x0
  buffer_store_dwordx4 v[8:11], v2, s[32:35], s66 offen offset:1536
  s_mov_b64 exec, -1
  s_cmp_lg_u32 s46, 1
  s_cbranch_scc1 L_slow_32
L_back_33:
  s_branch L_qget
L_qwait:
  s_sleep 40
L_qget:
  s_lshr_b32 s66, s2, 7
  s_lshl2_add_u32 s66, s4, s66
  s_lshl_b32 s66, s66, 14
  s_lshl_b32 s68, s3, 11
  s_add_u32 s66, s66, s68
  v_and_b32 v2, 15, v0
  v_bfe_u32 v5, v0, 4, 1
  v_lshlrev_b32 v3, 3, v2
  v_add_u32 v3, s69, v3
  v_lshl_add_u32 v3, v5, 13, v3
  v_lshlrev_b32 v2, 4, v2
  v_lshl_add_u32 v2, v5, 15, v2
  s_mov_b32 s16, s32
  s_mov_b32 s17, s33
  s_mov_b32 s18, 4194304
  s_mov_b32 s19, 0x20000
  s_mov_b32 s70, 4000007
L_spin_34:
  buffer_load_dwordx4 v[12:15], v2, s[16:19], s66 offen offset:1536 sc1 nt
  s_waitcnt vmcnt(0)
  v_cmp_ne_u64 vcc, s[30:31], v[14:15]
  s_nop 0
  s_cbranch_vccz L_sdone_35
  s_sleep 8
  ds_read_b32 v4, v1 offset:648
  s_waitcnt lgkmcnt(0)
  v_readfirstlane_b32 s46, v4
  s_nop 0
  s_sub_u32 s68, s46, s65
  s_cmp_lg_u32 s68, 2
  s_cbranch_scc1 L_qlazy_36
  s_mov_b32 exec_lo, 0xff00ff
  s_mov_b32 exec_hi, 0xff00ff
  buffer_store_dwordx4 v[80:83], v90, s[24:27], s64 offen offset:0 sc1
  s_mov_b64 exec, -1
  s_mov_b32 s65, 1
L_qlazy_36:
  s_and_b32 s99, s70, 7
  s_cselect_b32 s16, s32, s24
  s_cselect_b32 s17, s33, s25
  s_sub_u32 s70, s70, 1
  s_cbranch_scc0 L_spin_34
L_sdone_35:
  ds_write_b64 v3, v[12:13] offset:0
  s_lshl_b32 s69, s3, 3
  v_mov_b32 v4, s69
  v_mov_b32 v6, 1
  s_waitcnt lgkmcnt(0)
  ds_write_b32 v4, v6 offset:384
  v_mov_b32 v1, 0
  s_mov_b32 s70, 4000007
L_spin_37:
  ds_read_b32 v4, v1 offset:648
  s_waitcnt lgkmcnt(0)
  v_cmp_gt_u32 vcc, 1, v4
  s_nop 0
  s_cbranch_vccz L_sdone_38
  s_sleep 2
  s_sub_u32 s70, s70, 1
  s_cbranch_scc0 L_spin_37
L_sdone_38:
  v_readfirstlane_b32 s46, v4
  ds_read_b32 v4, v1 offset:648
  s_waitcnt lgkmcnt(0)
  v_readfirstlane_b32 s46, v4
  s_nop 0
  s_sub_u32 s68, s46, s65
  s_cmp_lg_u32 s68, 2
  s_cbranch_scc1 L_qlazy_39
  s_mov_b32 exec_lo, 0xff00ff
  s_mov_b32 exec_hi, 0xff00ff
  buffer_store_dwordx4 v[80:83], v90, s[24:27], s64 offen offset:0 sc1
  s_mov_b64 exec, -1
  s_mov_b32 s65, 1
L_qlazy_39:
  s_branch L_stats
L_ids:
  s_setprio 3
  s_getreg_b32 s64, hwreg(HW_REG_XCC_ID)
  s_mov_b32 s24, s58
  s_mov_b32 s25, s59
  s_mov_b32 s26, 4194304
  s_mov_b32 s27, 0x20000
  s_add_u32 s32, s58, 4194304
  s_addc_u32 s33, s59, 0
  s_mov_b32 s34, 4194304
  s_mov_b32 s35, 0x20000
  s_lshl3_add_u32 s71, s6, s7
  s_mul_i32 s5, s79, 5
  s_mul_i32 s47, s79, 3
  s_add_u32 s47, s47, 15
  s_cmp_lt_u32 s7, 5
  s_cselect_b32 s5, s5, s47
  s_add_u32 s5, s5, s7
  s_waitcnt lgkmcnt(0)
  s_mul_i32 s30, s28, 0x2c9277b5
  s_add_u32 s30, s30, 0xac564b05
  s_mul_i32 s31, s29, 0x0019660d
  s_add_u32 s31, s31, 0x3c6ef35f
  s_and_b32 s64, s64, 15
  v_mov_b32 v4, s30
  v_mov_b32 v5, s31
  v_mov_b32 v6, s64
  v_mov_b32 v7, s64
  s_lshl_b32 s68, s4, 9
  s_add_u32 s68, s68, 2080768
  s_lshr_b32 s65, s2, 3
  s_lshl_b32 s69, s65, 4
  v_mov_b32 v1, s69
  s_mov_b64 exec, 1
  buffer_store_dwordx4 v[4:7], v1, s[32:35], s68 offen
  s_mov_b64 exec, -1
  s_cmp_lg_u32 s65, 31
  s_cbranch_scc1 L_noinit
  v_lshlrev_b32 v12, 8, v0
  s_lshl_b32 s69, s4, 15
  s_add_u32 s69, s69, 1703936
  s_mov_b32 exec_lo, 0x8040201
  s_mov_b32 exec_hi, 0x8040201
  buffer_store_dword v4, v12, s[24:27], s69 offen sc1
  s_mov_b64 exec, -1
L_noinit:
  v_and_b32 v1, 31, v0
  v_lshlrev_b32 v1, 4, v1
  s_mov_b32 s70, 12
  s_mov_b32 s46, 2
L_idpoll:
  s_sleep 16
  buffer_load_dwordx4 v[8:11], v1, s[32:35], s68 offen sc1 nt
  s_waitcnt vmcnt(0)
  v_cmp_ne_u64 vcc, s[30:31], v[8:9]
  s_nop 0
  s_cbranch_vccz L_iddone
  s_sub_u32 s70, s70, 1
  s_cbranch_scc0 L_idpoll
  s_branch L_idset
L_iddone:
  v_cmp_ne_u32 vcc, s64, v10
  s_nop 0
  s_cbranch_vccnz L_idset
  s_mov_b32 s46, 1
L_idset:
  v_mov_b32 v1, 0
  v_mov_b32 v4, s46
  ds_write_b32 v1, v4 offset:648
  s_cmp_lg_u32 s65, 31
  s_cbranch_scc1 L_pf
  s_lshl_b32 s69, s4, 15
  s_add_u32 s69, s69, 1703936
  s_add_u32 s22, s58, s69
  s_addc_u32 s23, s59, 0
  s_waitcnt lgkmcnt(0)
  s_mov_b32 s8, -1
  s_mov_b32 s9, -1
  s_memtime s[12:13]
  s_waitcnt lgkmcnt(0)
  s_load_dword s10, s[22:23], 0
  s_waitcnt lgkmcnt(0)
  s_memtime s[14:15]
  s_waitcnt lgkmcnt(0)
  s_sub_u32 s11, s14, s12
  s_min_u32 s8, s8, s11
  s_waitcnt lgkmcnt(0)
  s_load_dword s10, s[22:23], 8192
  s_waitcnt lgkmcnt(0)
  s_memtime s[12:13]
  s_waitcnt lgkmcnt(0)
  s_sub_u32 s11, s12, s14
  s_min_u32 s9, s9, s11
  s_waitcnt lgkmcnt(0)
  s_load_dword s10, s[22:23], 10496
  s_waitcnt lgkmcnt(0)
  s_memtime s[14:15]
  s_waitcnt lgkmcnt(0)
  s_sub_u32 s11, s14, s12
  s_min_u32 s9, s9, s11
  s_waitcnt lgkmcnt(0)
  s_load_dword s10, s[22:23], 2304
  s_waitcnt lgkmcnt(0)
  s_memtime s[12:13]
  s_waitcnt lgkmcnt(0)
  s_sub_u32 s11, s12, s14
  s_min_u32 s8, s8, s11
  s_waitcnt lgkmcnt(0)
  s_load_dword s10, s[22:23], 4608
  s_waitcnt lgkmcnt(0)
  s_memtime s[14:15]
  s_waitcnt lgkmcnt(0)
  s_sub_u32 s11, s14, s12
  s_min_u32 s8, s8, s11
  s_waitcnt lgkmcnt(0)
  s_load_dword s10, s[22:23], 12800
  s_waitcnt lgkmcnt(0)
  s_memtime s[12:13]
  s_waitcnt lgkmcnt(0)
  s_sub_u32 s11, s12, s14
  s_min_u32 s9, s9, s11
  s_waitcnt lgkmcnt(0)
  s_load_dword s10, s[22:23], 15104
  s_waitcnt lgkmcnt(0)
  s_memtime s[14:15]
  s_waitcnt lgkmcnt(0)
  s_sub_u32 s11, s14, s12
  s_min_u32 s9, s9, s11
  s_waitcnt lgkmcnt(0)
  s_load_dword s10, s[22:23], 6912
  s_waitcnt lgkmcnt(0)
  s_memtime s[12:13]
  s_waitcnt lgkmcnt(0)
  s_sub_u32 s11, s12, s14
  s_min_u32 s8, s8, s11
  s_cmp_gt_u32 s8, s9
  s_cselect_b32 s21, 1, 0
  v_mov_b32 v4, s21
  v_mov_b32 v5, s62
  v_mov_b32 v6, s30
  v_mov_b32 v7, s31
  s_lshl_b32 s69, s4, 4
  s_add_u32 s69, s69, 950272
  s_mov_b64 exec, 1
  buffer_store_dwordx4 v[4:7], v1, s[24:27], s69 offen sc1
  s_mov_b64 exec, -1
L_pf:
  s_mov_b32 s65, 0
  s_cmp_lg_u32 s7, 6
  s_cbranch_scc1 L_nosample0
  v_mov_b32 v1, 0
  s_mov_b32 s70, 4000007
L_spin_40:
  ds_read_b64 v[4:5], v1 offset:696
  s_waitcnt lgkmcnt(0)
  v_cmp_gt_u32 vcc, 8, v5
  s_nop 0
  s_cbranch_vccz L_sdone_41
  s_sleep 2
  s_sub_u32 s70, s70, 1
  s_cbranch_scc0 L_spin_40
L_sdone_41:
  v_mov_b32 v5, s31
  v_lshlrev_b32 v6, 9, v0
  s_lshl_b32 s68, s6, 3
  s_add_u32 s68, s68, 958464
  s_mov_b64 exec, 7
  buffer_store_dwordx2 v[4:5], v6, s[24:27], s68 offen sc1
  s_mov_b64 exec, -1
L_nosample0:
  v_mov_b32 v1, 0
  s_mov_b32 s70, 4000007
L_spin_42:
  ds_read_b32 v12, v1 offset:692
  s_waitcnt lgkmcnt(0)
  v_cmp_gt_u32 vcc, 8, v12
  s_nop 0
  s_cbranch_vccz L_sdone_43
  s_sleep 4
  s_sub_u32 s70, s70, 1
  s_cbranch_scc0 L_spin_42
L_sdone_43:
  s_add_u32 s60, s58, 958464
  s_addc_u32 s61, s59, 0
  s_mov_b32 s70, 2
L_calpoll0:
  s_lshl_b32 s96, s62, 8
  s_sub_u32 s96, 0, s96
  s_mov_b32 s97, 0
  s_load_dwordx16 s[8:23], s[60:61], 0
  s_load_dwordx16 s[80:95], s[60:61], 64
  s_waitcnt lgkmcnt(0)
  s_add_u32 s96, s96, s8
  s_cmp_lg_u32 s9, s31
  s_addc_u32 s97, s97, 0
  s_add_u32 s96, s96, s10
  s_cmp_lg_u32 s11, s31
  s_addc_u32 s97, s97, 0
  s_add_u32 s96, s96, s12
  s_cmp_lg_u32 s13, s31
  s_addc_u32 s97, s97, 0
  s_add_u32 s96, s96, s14
  s_cmp_lg_u32 s15, s31
  s_addc_u32 s97, s97, 0
  s_add_u32 s96, s96, s16
  s_cmp_lg_u32 s17, s31
  s_addc_u32 s97, s97, 0
  s_add_u32 s96, s96, s18
  s_cmp_lg_u32 s19, s31
  s_addc_u32 s97, s97, 0
  s_add_u32 s96, s96, s20
  s_cmp_lg_u32 s21, s31
  s_addc_u32 s97, s97, 0
  s_add_u32 s96, s96, s22
  s_cmp_lg_u32 s23, s31
  s_addc_u32 s97, s97, 0
  s_add_u32 s96, s96, s80
  s_cmp_lg_u32 s81, s31
  s_addc_u32 s97, s97, 0
  s_add_u32 s96, s96, s82
  s_cmp_lg_u32 s83, s31
  s_addc_u32 s97, s97, 0
  s_add_u32 s96, s96, s84
  s_cmp_lg_u32 s85, s31
  s_addc_u32 s97, s97, 0
  s_add_u32 s96, s96, s86
  s_cmp_lg_u32 s87, s31
  s_addc_u32 s97, s97, 0
  s_add_u32 s96, s96, s88
  s_cmp_lg_u32 s89, s31
  s_addc_u32 s97, s97, 0
  s_add_u32 s96, s96, s90
  s_cmp_lg_u32 s91, s31
  s_addc_u32 s97, s97, 0
  s_add_u32 s96, s96, s92
  s_cmp_lg_u32 s93, s31
  s_addc_u32 s97, s97, 0
  s_add_u32 s96, s96, s94
  s_cmp_lg_u32 s95, s31
  s_addc_u32 s97, s97, 0
  s_load_dwordx16 s[8:23], s[60:61], 128
  s_load_dwordx16 s[80:95], s[60:61], 192
  s_waitcnt lgkmcnt(0)
  s_add_u32 s96, s96, s8
  s_cmp_lg_u32 s9, s31
  s_addc_u32 s97, s97, 0
  s_add_u32 s96, s96, s10
  s_cmp_lg_u32 s11, s31
  s_addc_u32 s97, s97, 0
  s_add_u32 s96, s96, s12
  s_cmp_lg_u32 s13, s31
  s_addc_u32 s97, s97, 0
  s_add_u32 s96, s96, s14
  s_cmp_lg_u32 s15, s31
  s_addc_u32 s97, s97, 0
  s_add_u32 s96, s96, s16
  s_cmp_lg_u32 s17, s31
  s_addc_u32 s97, s97, 0
  s_add_u32 s96, s96, s18
  s_cmp_lg_u32 s19, s31
  s_addc_u32 s97, s97, 0
  s_add_u32 s96, s96, s20
  s_cmp_lg_u32 s21, s31
  s_addc_u32 s97, s97, 0
  s_add_u32 s96, s96, s22
  s_cmp_lg_u32 s23, s31
  s_addc_u32 s97, s97, 0
  s_add_u32 s96, s96, s80
  s_cmp_lg_u32 s81, s31
  s_addc_u32 s97, s97, 0
  s_add_u32 s96, s96, s82
  s_cmp_lg_u32 s83, s31
  s_addc_u32 s97, s97, 0
  s_add_u32 s96, s96, s84
  s_cmp_lg_u32 s85, s31
  s_addc_u32 s97, s97, 0
  s_add_u32 s96, s96, s86
  s_cmp_lg_u32 s87, s31
  s_addc_u32 s97, s97, 0
  s_add_u32 s96, s96, s88
  s_cmp_lg_u32 s89, s31
  s_addc_u32 s97, s97, 0
  s_add_u32 s96, s96, s90
  s_cmp_lg_u32 s91, s31
  s_addc_u32 s97, s97, 0
  s_add_u32 s96, s96, s92
  s_cmp_lg_u32 s93, s31
  s_addc_u32 s97, s97, 0
  s_add_u32 s96, s96, s94
  s_cmp_lg_u32 s95, s31
  s_addc_u32 s97, s97, 0
  s_cmp_eq_u32 s97, 0
  s_cbranch_scc1 L_calok0
  s_add_u32 s60, s60, 512
  s_addc_u32 s61, s61, 0
  s_sub_u32 s70, s70, 1
  s_cbranch_scc1 L_stats
  s_sleep 20
  s_branch L_calpoll0
L_calok0:
  s_ashr_i32 s96, s96, 4
  s_mov_b32 s68, 352
  s_cmp_lt_u32 s5, 30
  s_cselect_b32 s68, -208, s68
  s_cmp_lt_u32 s5, 20
  s_cselect_b32 s68, 112, s68
  s_lshl4_add_u32 s68, s62, s68
  s_add_u32 s68, s68, s96
  s_mov_b32 s66, s68
  s_mov_b32 s65, -1
  v_mov_b32 v12, s68
  v_mov_b32 v13, -1
  ds_write_b64 v1, v[12:13] offset:680
L_stats:
  v_and_b32 v1, 7, v0
  v_lshlrev_b32 v1, 4, v1
  s_mov_b32 s70, 4000007
L_spin_44:
  ds_read_b128 v[4:7], v1 offset:512
  s_waitcnt lgkmcnt(0)
  v_cmp_eq_u32 vcc, 0, v7
  s_nop 0
  s_cbranch_vccz L_sdone_45
  s_sleep 4
  s_sub_u32 s70, s70, 1
  s_cbranch_scc0 L_spin_44
L_sdone_45:
  s_cmp_lg_u32 s3, 3
  s_cbranch_scc1 L_nostat
  v_and_b32 v12, 8, v0
  v_cmp_ne_u32 vcc, 0, v12
  v_lshlrev_b32 v12, 6, v12
  s_nop 0
  v_cndmask_b32 v4, v4, v6, vcc
  v_cndmask_b32 v5, v5, v7, vcc
  s_mov_b32 s68, 0x3fb8aa3b
  v_mov_b32 v2, v4
  s_nop 1
  v_max_f32_dpp v2, v2, v2 quad_perm:[1,0,3,2] row_mask:0xf bank_mask:0xf
  s_nop 1
  v_max_f32_dpp v2, v2, v2 quad_perm:[2,3,0,1] row_mask:0xf bank_mask:0xf
  s_nop 1
  v_max_f32_dpp v2, v2, v2 row_half_mirror row_mask:0xf bank_mask:0xf
  v_sub_f32 v4, v4, v2
  v_mul_f32 v4, s68, v4
  v_exp_f32 v4, v4
  s_nop 0
  v_mul_f32 v3, v4, v5
  s_nop 1
  v_add_f32_dpp v3, v3, v3 quad_perm:[1,0,3,2] row_mask:0xf bank_mask:0xf
  s_nop 1
  v_add_f32_dpp v3, v3, v3 quad_perm:[2,3,0,1] row_mask:0xf bank_mask:0xf
  s_nop 1
  v_add_f32_dpp v3, v3, v3 row_half_mirror row_mask:0xf bank_mask:0xf
  s_lshr_b32 s68, s2, 7
  s_lshl2_add_u32 s68, s4, s68
  s_bfe_u32 s69, s2, 0x40003
  s_lshl4_add_u32 s68, s68, s69
  s_lshl_b32 s68, s68, 4
  s_add_u32 s68, s68, 2064384
  v_mov_b32 v4, s30
  v_mov_b32 v5, s31
  s_mov_b32 exec_lo, 0x101
  s_mov_b32 exec_hi, 0x0
  buffer_store_dwordx4 v[2:5], v12, s[32:35], s68 offen
  s_mov_b64 exec, -1
  s_cmp_lg_u32 s46, 1
  s_cbranch_scc1 L_slow_46
L_back_47:
  s_mov_b32 s68, 950272
  s_mov_b32 s70, 4000007
L_spin_48:
  buffer_load_dwordx4 v[8:11], v1, s[24:27], s68 offen sc1
  s_waitcnt vmcnt(0)
  v_cmp_ne_u64 vcc, s[30:31], v[10:11]
  s_nop 0
  s_cbranch_vccz L_sdone_49
  s_sleep 8
  s_sub_u32 s70, s70, 1
  s_cbranch_scc0 L_spin_48
L_sdone_49:
  v_cmp_ne_u32 vcc, 0, v8
  s_nop 0
  s_and_b32 s67, vcc_lo, 0xff
  s_bitset1_b32 s67, 8
  v_mov_b32 v4, s67
  v_mov_b32 v1, 0
  ds_write_b32 v1, v4 offset:660
L_nostat:
  s_cmp_lg_u32 s3, 2
  s_cbranch_scc1 L_noa
  v_min_u32 v12, 47, v0
  v_lshrrev_b32 v13, 3, v12
  v_lshlrev_b32 v13, 11, v13
  v_and_b32 v14, 1, v12
  v_lshl_add_u32 v13, v14, 10, v13
  v_bfe_u32 v14, v12, 1, 2
  v_lshl_add_u32 v13, v14, 8, v13
  v_lshlrev_b32 v12, 4, v12
  s_lshr_b32 s74, s2, 7
  s_lshl2_add_u32 s74, s4, s74
  s_mul_i32 s74, s74, 12288
  s_bfe_u32 s69, s2, 0x40003
  s_lshl4_add_u32 s74, s69, s74
  s_add_u32 s74, s74, 524288
  s_mov_b32 s22, 0x55555555
  s_mov_b32 s23, 0x55555555
  v_mov_b32 v14, s30
  v_mov_b32 v15, s31
  v_mov_b32 v1, 0
  s_mov_b32 s70, 4000007
L_spin_50:
  ds_read_b32 v4, v1 offset:652
  s_waitcnt lgkmcnt(0)
  v_cmp_gt_u32 vcc, 8, v4
  s_nop 0
  s_cbranch_vccz L_sdone_51
  s_sleep 4
  s_sub_u32 s70, s70, 1
  s_cbranch_scc0 L_spin_50
L_sdone_51:
  v_mov_b32 v1, 0
  s_mov_b32 s70, 4000007
L_spin_52:
  ds_read_b32 v4, v1 offset:644
  s_waitcnt lgkmcnt(0)
  v_cmp_gt_u32 vcc, 1, v4
  s_nop 0
  s_cbranch_vccz L_sdone_53
  s_sleep 2
  s_sub_u32 s70, s70, 1
  s_cbranch_scc0 L_spin_52
L_sdone_53:
  ds_read_b128 v[16:19], v12 offset:57856
  ds_read_b128 v[20:23], v12 offset:58624
  ds_read_b128 v[24:27], v12 offset:59392
  ds_read_b128 v[28:31], v12 offset:60160
  ds_read_b128 v[32:35], v12 offset:60928
  ds_read_b128 v[36:39], v12 offset:61696
  ds_read_b128 v[40:43], v12 offset:62464
  ds_read_b128 v[44:47], v12 offset:63232
  s_waitcnt lgkmcnt(6)
  v_pk_add_f32 v[16:17], v[16:17], v[20:21]
  v_pk_add_f32 v[18:19], v[18:19], v[22:23]
  s_waitcnt lgkmcnt(4)
  v_pk_add_f32 v[24:25], v[24:25], v[28:29]
  v_pk_add_f32 v[26:27], v[26:27], v[30:31]
  v_pk_add_f32 v[16:17], v[16:17], v[24:25]
  v_pk_add_f32 v[18:19], v[18:19], v[26:27]
  s_waitcnt lgkmcnt(2)
  v_pk_add_f32 v[32:33], v[32:33], v[36:37]
  v_pk_add_f32 v[34:35], v[34:35], v[38:39]
  s_waitcnt lgkmcnt(0)
  v_pk_add_f32 v[40:41], v[40:41], v[44:45]
  v_pk_add_f32 v[42:43], v[42:43], v[46:47]
  v_pk_add_f32 v[32:33], v[32:33], v[40:41]
  v_pk_add_f32 v[34:35], v[34:35], v[42:43]
  v_pk_add_f32 v[4:5], v[16:17], v[32:33]
  v_pk_add_f32 v[6:7], v[18:19], v[34:35]
  v_cvt_pk_bf16_f32 v8, v4, v5
  v_cvt_pk_bf16_f32 v9, v6, v7
  v_cndmask_b32 v4, v8, v14, s[22:23]
  v_cndmask_b32 v5, v9, v15, s[22:23]
  v_cndmask_b32 v6, v14, v8, s[22:23]
  v_cndmask_b32 v7, v15, v9, s[22:23]
  s_mov_b32 exec_lo, 0xffffffff
  s_mov_b32 exec_hi, 0xffff
  buffer_store_dwordx4 v[4:7], v13, s[32:35], s74 offen
  s_mov_b64 exec, -1
  s_cmp_lg_u32 s46, 1
  s_cbranch_scc1 L_slow_54
L_back_55:
L_noa:
  s_cmp_lt_u32 s5, 20
  s_cbranch_scc0 L_helper_exit
  s_cmp_ge_u32 s5, 10
  s_cselect_b32 s76, 1, 0
  s_mul_i32 s77, s76, 10
  s_sub_u32 s77, s5, s77
  s_lshr_b32 s78, s3, 1
  v_and_b32 v2, 48, v0
  s_lshl_b32 s68, s78, 6
  v_add_u32 v22, s68, v2
  v_lshlrev_b32 v60, 4, v0
  s_lshl1_add_u32 s73, s4, s78
  s_lshl1_add_u32 s73, s73, s76
  s_lshl1_add_u32 s73, s73, s3
  s_lshl_b32 s68, s78, 1
  s_sub_u32 s73, s73, s68
  s_mul_i32 s73, s73, 6144
  s_add_u32 s73, s73, 524288
  s_add_u32 s74, s73, 4096
  v_lshlrev_b32 v62, 2, v0
  s_lshl_b32 s68, s3, 8
  v_add_u32 v61, s68, v62
  v_lshrrev_b32 v2, 5, v0
  v_lshlrev_b32 v2, 11, v2
  v_bfe_u32 v3, v0, 2, 3
  v_lshl_add_u32 v2, v3, 4, v2
  v_and_b32 v3, 1, v0
  v_lshl_add_u32 v63, v3, 13, v2
  s_lshr_b32 s75, s77, 1
  s_lshl_b32 s75, s75, 14
  s_and_b32 s68, s77, 1
  s_lshl_b32 s68, s68, 12
  s_add_u32 s75, s75, s68
  s_lshl1_add_u32 s68, s4, s76
  s_lshl_b32 s68, s68, 7
  s_add_u32 s75, s75, s68
  s_add_u32 s75, s75, 1966080
  s_mov_b32 s8, 0x33333333
  s_mov_b32 s9, 0x33333333
  v_mov_b32 v50, s30
  v_mov_b32 v51, s31
  v_lshrrev_b32 v24, 4, v0
  v_lshlrev_b32 v24, 10, v24
  v_bfe_u32 v25, v0, 2, 2
  v_lshl_add_u32 v24, v25, 7, v24
  v_and_b32 v25, 3, v0
  v_lshl_add_u32 v24, v25, 3, v24
  s_mul_i32 s69, s3, 12288
  v_add_u32 v24, s69, v24
  s_cmp_lg_u32 s3, 0
  s_cbranch_scc1 L_noc
  s_lshl2_add_u32 s72, s4, s76
  s_lshl_b32 s72, s72, 8
  s_add_u32 s72, s72, 2064384
  v_and_b32 v1, 15, v0
  v_lshlrev_b32 v1, 4, v1
  v_and_b32 v2, 16, v0
  v_lshl_add_u32 v1, v2, 5, v1
  s_mov_b32 s16, s32
  s_mov_b32 s17, s33
  s_mov_b32 s18, 4194304
  s_mov_b32 s19, 0x20000
  s_mov_b32 s70, 4000007
L_spin_56:
  s_sleep 24
  buffer_load_dwordx4 v[4:7], v1, s[16:19], s72 offen sc1 nt
  s_waitcnt vmcnt(0)
  v_cmp_ne_u64 vcc, s[30:31], v[6:7]
  s_nop 0
  s_cbranch_vccz L_sdone_57
  s_and_b32 s99, s70, 7
  s_cmp_eq_u32 s46, 1
  s_cselect_b32 s99, 1, s99
  s_cmp_lg_u32 s99, 0
  s_cselect_b32 s16, s32, s24
  s_cselect_b32 s17, s33, s25
  s_sub_u32 s70, s70, 1
  s_cbranch_scc0 L_spin_56
L_sdone_57:
  s_mov_b32 s68, 0x3fb8aa3b
  v_mov_b32 v2, v4
  s_nop 1
  v_max_f32_dpp v2, v2, v2 quad_perm:[1,0,3,2] row_mask:0xf bank_mask:0xf
  s_nop 1
  v_max_f32_dpp v2, v2, v2 quad_perm:[2,3,0,1] row_mask:0xf bank_mask:0xf
  s_nop 1
  v_max_f32_dpp v2, v2, v2 row_half_mirror row_mask:0xf bank_mask:0xf
  s_nop 1
  v_max_f32_dpp v2, v2, v2 row_mirror row_mask:0xf bank_mask:0xf
  v_sub_f32 v4, v4, v2
  v_mul_f32 v4, s68, v4
  v_exp_f32 v4, v4
  s_nop 0
  v_mul_f32 v3, v4, v5
  s_nop 1
  v_add_f32_dpp v3, v3, v3 quad_perm:[1,0,3,2] row_mask:0xf bank_mask:0xf
  s_nop 1
  v_add_f32_dpp v3, v3, v3 quad_perm:[2,3,0,1] row_mask:0xf bank_mask:0xf
  s_nop 1
  v_add_f32_dpp v3, v3, v3 row_half_mirror row_mask:0xf bank_mask:0xf
  s_nop 1
  v_add_f32_dpp v3, v3, v3 row_mirror row_mask:0xf bank_mask:0xf
  v_rcp_f32 v3, v3
  v_and_b32 v1, 0x7c, v62
  v_mul_f32 v4, v4, v3
  v_mov_b32 v2, 0
  v_mov_b32 v3, 1
  ds_write_b32 v1, v4 offset:768
  ds_write_b32 v2, v3 offset:664
L_noc:
  v_mov_b32 v1, 0
  s_mov_b32 s70, 4000007
L_spin_58:
  ds_read_b32 v4, v1 offset:664
  s_waitcnt lgkmcnt(0)
  v_cmp_gt_u32 vcc, 1, v4
  s_nop 0
  s_cbranch_vccz L_sdone_59
  s_sleep 2
  s_sub_u32 s70, s70, 1
  s_cbranch_scc0 L_spin_58
L_sdone_59:
  ds_read_b128 v[56:59], v22 offset:768
  s_mov_b32 s12, s44
  s_mov_b32 s13, s45
  s_mov_b32 s14, 7864320
  s_mov_b32 s15, 0x20000
  v_lshrrev_b32 v21, 3, v0
  v_mul_u32_u24 v21, 1280, v21
  v_and_b32 v3, 7, v0
  v_lshl_add_u32 v21, v3, 4, v21
  s_lshl1_add_u32 s60, s4, s76
  s_mul_i32 s68, s78, 16
  s_add_u32 s60, s60, s68
  s_add_u32 s60, s60, 0
  s_and_b32 s68, s3, 1
  s_lshl1_add_u32 s60, s60, s68
  s_mul_i32 s60, s60, 122880
  s_lshl_b32 s69, s77, 7
  s_add_u32 s60, s60, s69
  s_mul_i32 s61, s3, 12288
  s_add_u32 s61, s61, 8704
  v_mov_b32 v23, 1
  s_lshl_b32 s68, s3, 2
  v_mov_b32 v25, s68
  v_mov_b32 v1, 0
  s_mov_b32 s70, 4000007
L_spin_60:
  ds_read_b32 v4, v1 offset:660
  s_waitcnt lgkmcnt(0)
  v_cmp_gt_u32 vcc, 1, v4
  s_nop 0
  s_cbranch_vccz L_sdone_61
  s_sleep 4
  s_sub_u32 s70, s70, 1
  s_cbranch_scc0 L_spin_60
L_sdone_61:
  v_readfirstlane_b32 s47, v4
  v_mov_b32 v1, 0
  s_mov_b32 s70, 4000007
L_spin_62:
  ds_read_b32 v4, v1 offset:644
  s_waitcnt lgkmcnt(0)
  v_cmp_gt_u32 vcc, 8, v4
  s_nop 0
  s_cbranch_vccz L_sdone_63
  s_sleep 2
  s_sub_u32 s70, s70, 1
  s_cbranch_scc0 L_spin_62
L_sdone_63:
  s_cmp_lg_u32 s78, 0
  s_cbranch_scc1 L_nofirst
L_nofirst:
  s_mov_b32 m0, s61
  s_nop 0
  buffer_load_dwordx4 v21, s[12:15], s60 offen nt lds
  s_add_u32 s60, s60, 10240
  s_add_u32 s61, s61, 1024
  s_mov_b32 m0, s61
  s_nop 0
  buffer_load_dwordx4 v21, s[12:15], s60 offen nt lds
  s_add_u32 s60, s60, 10240
  s_add_u32 s61, s61, 1024
  s_mov_b32 m0, s61
  s_nop 0
  buffer_load_dwordx4 v21, s[12:15], s60 offen nt lds
  s_add_u32 s60, s60, 10240
  s_add_u32 s61, s61, 1024
  s_mov_b32 m0, s61
  s_nop 0
  buffer_load_dwordx4 v21, s[12:15], s60 offen nt lds
  s_add_u32 s60, s60, 10240
  s_add_u32 s61, s61, 1024
  s_mov_b32 m0, s61
  s_nop 0
  buffer_load_dwordx4 v21, s[12:15], s60 offen nt lds
  s_add_u32 s60, s60, 10240
  s_add_u32 s61, s61, 1024
  s_mov_b32 m0, s61
  s_nop 0
  buffer_load_dwordx4 v21, s[12:15], s60 offen nt lds
  s_add_u32 s60, s60, 10240
  s_add_u32 s61, s61, 1024
  s_waitcnt vmcnt(5)
  s_mov_b32 m0, s61
  s_nop 0
  buffer_load_dwordx4 v21, s[12:15], s60 offen nt lds
  s_add_u32 s60, s60, 10240
  s_add_u32 s61, s61, 1024
  s_waitcnt vmcnt(5)
  s_mov_b32 m0, s61
  s_nop 0
  buffer_load_dwordx4 v21, s[12:15], s60 offen nt lds
  s_add_u32 s60, s60, 10240
  s_add_u32 s61, s61, 1024
  s_waitcnt vmcnt(5)
  s_mov_b32 m0, s61
  s_nop 0
  buffer_load_dwordx4 v21, s[12:15], s60 offen nt lds
  s_add_u32 s60, s60, 10240
  s_add_u32 s61, s61, 1024
  s_waitcnt vmcnt(5)
  s_mov_b32 m0, s61
  s_nop 0
  buffer_load_dwordx4 v21, s[12:15], s60 offen nt lds
  s_add_u32 s60, s60, 10240
  s_add_u32 s61, s61, 1024
  s_waitcnt vmcnt(5)
  s_mov_b32 m0, s61
  s_nop 0
  buffer_load_dwordx4 v21, s[12:15], s60 offen nt lds
  s_add_u32 s60, s60, 10240
  s_add_u32 s61, s61, 1024
  s_waitcnt vmcnt(5)
  s_mov_b32 m0, s61
  s_nop 0
  buffer_load_dwordx4 v21, s[12:15], s60 offen nt lds
  s_waitcnt vmcnt(4)
  ds_read_b64_tr_b16 v[64:65], v24 offset:8704
  ds_read_b64_tr_b16 v[66:67], v24 offset:9216
  ds_read_b64_tr_b16 v[68:69], v24 offset:8736
  ds_read_b64_tr_b16 v[70:71], v24 offset:9248
  ds_read_b64_tr_b16 v[72:73], v24 offset:8768
  ds_read_b64_tr_b16 v[74:75], v24 offset:9280
  ds_read_b64_tr_b16 v[76:77], v24 offset:8800
  ds_read_b64_tr_b16 v[78:79], v24 offset:9312
  ds_read_b64_tr_b16 v[80:81], v24 offset:12800
  ds_read_b64_tr_b16 v[82:83], v24 offset:13312
  ds_read_b64_tr_b16 v[84:85], v24 offset:12832
  ds_read_b64_tr_b16 v[86:87], v24 offset:13344
  ds_read_b64_tr_b16 v[88:89], v24 offset:12864
  ds_read_b64_tr_b16 v[90:91], v24 offset:13376
  ds_read_b64_tr_b16 v[92:93], v24 offset:12896
  ds_read_b64_tr_b16 v[94:95], v24 offset:13408
  v_mov_b32 v1, 0
  s_mov_b32 s70, 4000007
L_spin_64:
  ds_read_b32 v4, v1 offset:668
  s_waitcnt lgkmcnt(0)
  v_cmp_gt_u32 vcc, 1, v4
  s_nop 0
  s_cbranch_vccz L_sdone_65
  s_sleep 1
  s_sub_u32 s70, s70, 1
  s_cbranch_scc0 L_spin_64
L_sdone_65:
  s_waitcnt vmcnt(0)
  buffer_load_dwordx4 v[144:147], v60, s[32:35], s73 offen offset:0 sc1
  buffer_load_dwordx4 v[148:151], v60, s[32:35], s73 offen offset:1024 sc1
  buffer_load_dwordx4 v[152:155], v60, s[32:35], s73 offen offset:2048 sc1
  buffer_load_dwordx4 v[156:159], v60, s[32:35], s73 offen offset:3072 sc1
  buffer_load_dwordx4 v[160:163], v60, s[32:35], s74 offen offset:0 sc1
  buffer_load_dwordx4 v[164:167], v60, s[32:35], s74 offen offset:1024 sc1
  s_waitcnt vmcnt(6)
L_both:
  ds_read_b64_tr_b16 v[96:97], v24 offset:16896
  ds_read_b64_tr_b16 v[98:99], v24 offset:17408
  ds_read_b64_tr_b16 v[100:101], v24 offset:16928
  ds_read_b64_tr_b16 v[102:103], v24 offset:17440
  ds_read_b64_tr_b16 v[104:105], v24 offset:16960
  ds_read_b64_tr_b16 v[106:107], v24 offset:17472
  ds_read_b64_tr_b16 v[108:109], v24 offset:16992
  ds_read_b64_tr_b16 v[110:111], v24 offset:17504
  s_mov_b32 s16, s32
  s_mov_b32 s17, s33
  s_mov_b32 s18, 4194304
  s_mov_b32 s19, 0x20000
  s_mov_b32 s70, 4000007
  s_branch L_opw
L_spin_66:
  buffer_load_dwordx4 v[144:147], v60, s[16:19], s73 offen offset:0 sc1
  buffer_load_dwordx4 v[148:151], v60, s[16:19], s73 offen offset:1024 sc1
  buffer_load_dwordx4 v[152:155], v60, s[16:19], s73 offen offset:2048 sc1
  buffer_load_dwordx4 v[156:159], v60, s[16:19], s73 offen offset:3072 sc1
  buffer_load_dwordx4 v[160:163], v60, s[16:19], s74 offen offset:0 sc1
  buffer_load_dwordx4 v[164:167], v60, s[16:19], s74 offen offset:1024 sc1
L_opw:
  s_waitcnt vmcnt(4)
  v_mfma_f32_16x16x32_bf16 v[32:35], v[146:149], v[64:67], 0
  v_cmp_ne_u64 vcc, s[30:31], v[144:145]
  v_cmp_ne_u64 s[22:23], s[30:31], v[150:151]
  v_mfma_f32_16x16x32_bf16 v[36:39], v[146:149], v[68:71], 0
  s_or_b64 vcc, vcc, s[22:23]
  v_mfma_f32_16x16x32_bf16 v[40:43], v[146:149], v[72:75], 0
  v_mfma_f32_16x16x32_bf16 v[44:47], v[146:149], v[76:79], 0
  s_waitcnt vmcnt(2)
  v_mfma_f32_16x16x32_bf16 v[32:35], v[154:157], v[80:83], v[32:35]
  v_cmp_ne_u64 s[20:21], s[30:31], v[152:153]
  v_cmp_ne_u64 s[22:23], s[30:31], v[158:159]
  v_mfma_f32_16x16x32_bf16 v[36:39], v[154:157], v[84:87], v[36:39]
  s_or_b64 vcc, vcc, s[20:21]
  s_or_b64 vcc, vcc, s[22:23]
  v_mfma_f32_16x16x32_bf16 v[40:43], v[154:157], v[88:91], v[40:43]
  v_mfma_f32_16x16x32_bf16 v[44:47], v[154:157], v[92:95], v[44:47]
  s_waitcnt vmcnt(0) lgkmcnt(0)
  v_mfma_f32_16x16x32_bf16 v[32:35], v[162:165], v[96:99], v[32:35]
  v_cmp_ne_u64 s[20:21], s[30:31], v[160:161]
  v_cmp_ne_u64 s[22:23], s[30:31], v[166:167]
  v_mfma_f32_16x16x32_bf16 v[36:39], v[162:165], v[100:103], v[36:39]
  s_or_b64 vcc, vcc, s[20:21]
  s_or_b64 vcc, vcc, s[22:23]
  v_mfma_f32_16x16x32_bf16 v[40:43], v[162:165], v[104:107], v[40:43]
  v_mfma_f32_16x16x32_bf16 v[44:47], v[162:165], v[108:111], v[44:47]
  s_nop 0
  s_cbranch_vccz L_sdone_67
  s_and_b32 s99, s70, 7
  s_cmp_eq_u32 s46, 1
  s_cselect_b32 s99, 1, s99
  s_cmp_lg_u32 s99, 0
  s_cselect_b32 s16, s32, s24
  s_cselect_b32 s17, s33, s25
  s_sub_u32 s70, s70, 1
  s_cbranch_scc0 L_spin_66
L_sdone_67:
  v_mul_f32 v4, v32, v56
  v_fmac_f32 v4, v33, v57
  v_fmac_f32 v4, v34, v58
  v_fmac_f32 v4, v35, v59
  v_mul_f32 v5, v36, v56
  v_fmac_f32 v5, v37, v57
  v_fmac_f32 v5, v38, v58
  v_fmac_f32 v5, v39, v59
  v_mul_f32 v6, v40, v56
  v_fmac_f32 v6, v41, v57
  v_fmac_f32 v6, v42, v58
  v_fmac_f32 v6, v43, v59
  v_mul_f32 v7, v44, v56
  v_fmac_f32 v7, v45, v57
  v_fmac_f32 v7, v46, v58
  v_fmac_f32 v7, v47, v59
  v_permlane32_swap_b32 v4, v6
  s_nop 0
  v_permlane32_swap_b32 v5, v7
  v_add_f32 v4, v4, v6
  v_add_f32 v5, v5, v7
  s_nop 1
  v_permlane16_swap_b32 v4, v5
  v_add_f32 v4, v4, v5
  ds_write_b32 v61, v4 offset:7168
  s_cmp_lg_u32 s3, 0
  s_waitcnt lgkmcnt(0)
  s_barrier
  s_cbranch_scc1 L_post_wo
  ds_read_b32 v5, v62 offset:7424
  ds_read_b32 v6, v62 offset:7680
  ds_read_b32 v7, v62 offset:7936
  s_waitcnt lgkmcnt(0)
  v_add_f32 v4, v4, v5
  v_add_f32 v6, v6, v7
  v_add_f32 v4, v4, v6
  s_nop 1
  v_mov_b32_dpp v5, v4 quad_perm:[1,0,3,2] row_mask:0xf bank_mask:0xf
  v_cvt_pk_bf16_f32 v4, v4, v5
  s_nop 1
  v_mov_b32_dpp v48, v4 quad_perm:[0,0,0,0] row_mask:0xf bank_mask:0xf
  v_mov_b32_dpp v49, v4 quad_perm:[2,2,2,2] row_mask:0xf bank_mask:0xf
  s_mov_b64 exec, s[8:9]
  buffer_store_dwordx4 v[48:51], v63, s[24:27], s75 offen sc1
  s_barrier
  s_endpgm
L_helper_exit:
  s_endpgm
L_f1:
  s_mov_b32 s12, s48
  s_mov_b32 s13, s49
  s_mov_b32 s14, 1966080
  s_mov_b32 s15, 0x20000
  s_mov_b32 s16, s50
  s_mov_b32 s17, s51
  s_mov_b32 s18, 1966080
  s_mov_b32 s19, 0x20000
  s_sub_u32 s74, s5, 20
  v_lshrrev_b32 v3, 4, v0
  v_and_b32 v2, 7, v0
  v_lshrrev_b32 v62, 3, v0
  v_mul_u32_u24 v62, 3072, v62
  v_lshl_add_u32 v62, v2, 4, v62
  s_lshl3_add_u32 s61, s74, s73
  s_mul_i32 s61, s61, 24576
  s_mul_i32 s68, s4, 384
  s_add_u32 s61, s61, s68
  s_add_u32 s62, s61, 128
  s_add_u32 s63, s61, 256
  s_lshl_b32 s79, s73, 10
  s_add_u32 s79, s79, 8704
  v_mov_b32 v57, 0
  v_mov_b32 v6, s30
  v_mov_b32 v7, s31
  v_mov_b32 v1, 0
  s_mov_b32 s70, 4000007
L_spin_68:
  ds_read_b32 v4, v1 offset:668
  s_waitcnt lgkmcnt(0)
  v_cmp_gt_u32 vcc, 1, v4
  s_nop 0
  s_cbranch_vccz L_sdone_69
  s_sleep 1
  s_sub_u32 s70, s70, 1
  s_cbranch_scc0 L_spin_68
L_sdone_69:
  s_add_u32 m0, s79, 0
  s_nop 0
  buffer_load_dwordx4 v62, s[12:15], s61 offen nt lds
  s_add_u32 m0, s79, 24576
  s_nop 0
  buffer_load_dwordx4 v62, s[16:19], s61 offen nt lds
  s_add_u32 m0, s79, 8192
  s_nop 0
  buffer_load_dwordx4 v62, s[12:15], s62 offen nt lds
  s_add_u32 m0, s79, 32768
  s_nop 0
  buffer_load_dwordx4 v62, s[16:19], s62 offen nt lds
  s_add_u32 m0, s79, 16384
  s_nop 0
  buffer_load_dwordx4 v62, s[12:15], s63 offen nt lds
  s_add_u32 m0, s79, 40960
  s_nop 0
  buffer_load_dwordx4 v62, s[16:19], s63 offen nt lds
  s_setprio 3
  s_cmp_gt_u32 s73, 1
  s_cbranch_scc1 L_f1m
  v_mov_b32 v1, 0
  s_mov_b32 s70, 4000007
L_spin_70:
  ds_read_b32 v4, v1 offset:660
  s_waitcnt lgkmcnt(0)
  v_cmp_gt_u32 vcc, 1, v4
  s_nop 0
  s_cbranch_vccz L_sdone_71
  s_sleep 1
  s_sub_u32 s70, s70, 1
  s_cbranch_scc0 L_spin_70
L_sdone_71:
  v_readfirstlane_b32 s47, v4
  s_lshl1_add_u32 s74, s74, s73
  v_lshl_add_u32 v61, v2, 2, v3
  v_lshlrev_b32 v61, 1, v61
  s_lshl_b32 s68, s74, 6
  v_add_u32 v61, s68, v61
  global_load_ushort v56, v61, s[36:37]
  v_lshlrev_b32 v54, 5, v3
  v_lshl_add_u32 v54, v2, 2, v54
  v_lshlrev_b32 v55, 4, v0
  s_lshl_b32 s72, s4, 9
  s_lshl4_add_u32 s72, s74, s72
  s_add_u32 s72, s72, 2752512
  s_mul_i32 s75, s4, 20
  s_add_u32 s75, s75, s74
  s_lshl_b32 s75, s75, 7
  s_add_u32 s75, s75, 2768896
  s_mov_b64 exec, 1
  buffer_load_dword v104, v54, s[32:35], s75 offen sc1
  buffer_load_dword v105, v55, s[32:35], s72 offen sc1
  s_mov_b64 exec, -1
  s_lshr_b32 s60, s74, 2
  s_lshl_b32 s60, s60, 14
  s_and_b32 s68, s74, 3
  s_lshl_b32 s68, s68, 11
  s_add_u32 s60, s60, s68
  s_lshr_b32 s68, s47, s4
  s_and_b32 s68, s68, 1
  s_lshl_b32 s68, s68, 13
  s_add_u32 s60, s60, s68
  s_add_u32 s60, s60, 1966080
  v_lshlrev_b32 v51, 4, v3
  v_lshl_add_u32 v51, v2, 1, v51
  v_and_b32 v4, 1, v0
  v_mul_u32_u24 v4, 126, v4
  v_add_u32 v51, v51, v4
  s_lshl_b32 s68, s73, 6
  v_add_u32 v51, s68, v51
  s_mov_b32 s77, 0x3f80
  s_mov_b32 s71, 0x3f800000
  v_mov_b32 v14, s30
  v_mov_b32 v15, s31
  v_mov_b32 v8, 0
  v_mov_b32 v9, 0
  v_mov_b32 v10, 0
  v_mov_b32 v11, 0
  v_not_b32 v98, s30
  v_not_b32 v102, s30
  s_waitcnt vmcnt(2)
  s_barrier
  v_lshlrev_b32 v56, 16, v56
  s_mov_b32 s70, 4000007
  s_mov_b64 s[20:21], -1
  s_mov_b64 s[22:23], -1
L_ypoll:
  s_mov_b64 exec, s[20:21]
  buffer_load_dwordx4 v[96:99], v55, s[24:27], s60 offen sc1
  s_mov_b64 exec, s[22:23]
  buffer_load_dwordx4 v[100:103], v55, s[24:27], s60 offen offset:1024 sc1
  s_mov_b64 exec, -1
  v_cmp_ne_u64 s[20:21], s[30:31], v[98:99]
  v_cmp_ne_u64 s[22:23], s[30:31], v[102:103]
  s_nop 0
  s_or_b64 vcc, s[20:21], s[22:23]
  s_cbranch_scc0 L_yok
  v_cmp_ne_u64 s[20:21], s[30:31], v[98:99]
  v_cmp_ne_u64 s[22:23], s[30:31], v[102:103]
  s_nop 0
  s_or_b64 vcc, s[20:21], s[22:23]
  s_cbranch_scc0 L_yok
  v_cmp_ne_u64 s[20:21], s[30:31], v[98:99]
  v_cmp_ne_u64 s[22:23], s[30:31], v[102:103]
  s_nop 0
  s_or_b64 vcc, s[20:21], s[22:23]
  s_cbranch_scc0 L_yok
  v_cmp_ne_u64 s[20:21], s[30:31], v[98:99]
  v_cmp_ne_u64 s[22:23], s[30:31], v[102:103]
  s_nop 0
  s_or_b64 vcc, s[20:21], s[22:23]
  s_cbranch_scc0 L_yok
  v_cmp_ne_u64 s[20:21], s[30:31], v[98:99]
  v_cmp_ne_u64 s[22:23], s[30:31], v[102:103]
  s_nop 0
  s_or_b64 vcc, s[20:21], s[22:23]
  s_cbranch_scc0 L_yok
  v_cmp_ne_u64 s[20:21], s[30:31], v[98:99]
  v_cmp_ne_u64 s[22:23], s[30:31], v[102:103]
  s_nop 0
  s_or_b64 vcc, s[20:21], s[22:23]
  s_cbranch_scc0 L_yok
  s_waitcnt vmcnt(16)
  s_sub_u32 s70, s70, 1
  s_cbranch_scc0 L_ypoll
L_yok:
  v_dot2c_f32_bf16 v8, s77, v96
  v_dot2c_f32_bf16 v10, s77, v97
  v_dot2c_f32_bf16 v9, s71, v96
  v_dot2c_f32_bf16 v11, s71, v97
  v_dot2c_f32_bf16 v8, s77, v100
  v_dot2c_f32_bf16 v10, s77, v101
  v_dot2c_f32_bf16 v9, s71, v100
  v_dot2c_f32_bf16 v11, s71, v101
  s_nop 0
  v_permlane32_swap_b32 v8, v10
  s_nop 0
  v_permlane32_swap_b32 v9, v11
  v_add_f32 v8, v8, v10
  v_add_f32 v9, v9, v11
  s_nop 1
  v_permlane16_swap_b32 v8, v9
  v_add_f32 v8, v8, v9
  s_nop 1
  v_add_f32_dpp v8, v8, v8 row_ror:8 row_mask:0xf bank_mask:0xf
  v_cvt_pk_bf16_f32 v8, v57, v8
  v_add_f32 v12, v8, v56
  s_nop 1
  v_mov_b32_dpp v13, v12 quad_perm:[1,0,3,2] row_mask:0xf bank_mask:0xf
  v_cvt_pk_bf16_f32 v12, v12, v13
  ds_write_b32 v51, v12 offset:7168
  v_lshlrev_b32 v4, 16, v12
  v_mul_f32 v5, v4, v4
  s_nop 0
  v_add_f32_dpp v4, v4, v4 quad_perm:[1,0,3,2] row_mask:0xf bank_mask:0xf
  v_add_f32_dpp v5, v5, v5 quad_perm:[1,0,3,2] row_mask:0xf bank_mask:0xf
  s_nop 0
  v_add_f32_dpp v4, v4, v4 quad_perm:[2,3,0,1] row_mask:0xf bank_mask:0xf
  v_add_f32_dpp v5, v5, v5 quad_perm:[2,3,0,1] row_mask:0xf bank_mask:0xf
  s_nop 0
  v_add_f32_dpp v4, v4, v4 row_half_mirror row_mask:0xf bank_mask:0xf
  v_add_f32_dpp v5, v5, v5 row_half_mirror row_mask:0xf bank_mask:0xf
  s_waitcnt lgkmcnt(0)
  s_barrier
  v_mov_b32_dpp v13, v12 quad_perm:[2,3,2,3] row_mask:0xf bank_mask:0xf
  v_mov_b32 v8, v4
  v_mov_b32 v9, v5
  s_nop 0
  v_permlane16_swap_b32 v4, v8
  v_permlane16_swap_b32 v5, v9
  v_add_f32 v4, v4, v8
  v_add_f32 v5, v5, v9
  v_mov_b32 v8, v4
  v_mov_b32 v9, v5
  s_nop 0
  v_permlane32_swap_b32 v4, v8
  v_permlane32_swap_b32 v5, v9
  v_add_f32 v4, v4, v8
  v_add_f32 v5, v5, v9
  s_mov_b32 exec_lo, 0x1
  s_mov_b32 exec_hi, 0x0
  buffer_store_dwordx4 v[4:7], v55, s[32:35], s72 offen
  s_mov_b32 exec_lo, 0x110011
  s_mov_b32 exec_hi, 0x110011
  buffer_store_dwordx4 v[12:15], v54, s[32:35], s75 offen
  s_mov_b64 exec, -1
  s_cmp_lg_u32 s46, 1
  s_cbranch_scc1 L_slow_72
L_back_73:
  s_endpgm
L_f1m:
  s_sub_u32 s68, s73, 2
  s_lshr_b32 s78, s68, 1
  s_and_b32 s69, s73, 1
  v_lshlrev_b32 v58, 7, v3
  v_bfe_u32 v4, v0, 2, 2
  v_lshl_add_u32 v58, v4, 9, v58
  v_and_b32 v4, 3, v0
  v_lshl_add_u32 v58, v4, 3, v58
  s_lshl_b32 s75, s78, 13
  s_lshl_b32 s68, s69, 6
  s_add_u32 s75, s75, s68
  v_add_u32 v58, s75, v58
  v_lshlrev_b32 v52, 4, v3
  v_and_b32 v59, 1, v3
  v_cmp_eq_u32 s[62:63], 1, v59
  v_mul_u32_u24 v59, 3072, v59
  v_bfe_u32 v4, v0, 3, 1
  v_lshl_add_u32 v59, v4, 9, v59
  v_lshl_add_u32 v59, v2, 4, v59
  s_mul_i32 s76, s4, 3
  s_add_u32 s76, s76, s78
  s_lshl1_add_u32 s76, s76, s69
  s_mul_i32 s76, s76, 6144
  s_lshr_b32 s68, s74, 2
  s_lshl_b32 s68, s68, 10
  s_add_u32 s76, s76, s68
  s_and_b32 s68, s74, 3
  s_lshl_b32 s68, s68, 7
  s_add_u32 s76, s76, s68
  s_add_u32 s77, s76, 3145728
  s_add_u32 s76, s76, 2228224
  v_mov_b32 v8, 0x3f803f80
  v_mov_b32 v9, 0x3f803f80
  v_mov_b32 v10, 0x3f803f80
  v_mov_b32 v11, 0x3f803f80
  v_mov_b32 v34, s30
  v_mov_b32 v35, s31
  s_waitcnt vmcnt(0)
  s_barrier
  ds_read_b64_tr_b16 v[64:65], v58 offset:8704
  ds_read_b64_tr_b16 v[66:67], v58 offset:10752
  ds_read_b64_tr_b16 v[68:69], v58 offset:8736
  ds_read_b64_tr_b16 v[70:71], v58 offset:10784
  ds_read_b64_tr_b16 v[72:73], v58 offset:33280
  ds_read_b64_tr_b16 v[74:75], v58 offset:35328
  ds_read_b64_tr_b16 v[76:77], v58 offset:33312
  ds_read_b64_tr_b16 v[78:79], v58 offset:35360
  ds_read_b64_tr_b16 v[80:81], v58 offset:12800
  ds_read_b64_tr_b16 v[82:83], v58 offset:14848
  ds_read_b64_tr_b16 v[84:85], v58 offset:12832
  ds_read_b64_tr_b16 v[86:87], v58 offset:14880
  ds_read_b64_tr_b16 v[88:89], v58 offset:37376
  ds_read_b64_tr_b16 v[90:91], v58 offset:39424
  ds_read_b64_tr_b16 v[92:93], v58 offset:37408
  ds_read_b64_tr_b16 v[94:95], v58 offset:39456
  s_waitcnt lgkmcnt(0)
  v_mfma_f32_16x16x32_bf16 v[16:19], v[8:11], v[64:67], 0
  v_mfma_f32_16x16x32_bf16 v[20:23], v[8:11], v[68:71], 0
  v_mfma_f32_16x16x32_bf16 v[24:27], v[8:11], v[72:75], 0
  v_mfma_f32_16x16x32_bf16 v[28:31], v[8:11], v[76:79], 0
  v_mfma_f32_16x16x32_bf16 v[16:19], v[8:11], v[80:83], v[16:19]
  v_mfma_f32_16x16x32_bf16 v[20:23], v[8:11], v[84:87], v[20:23]
  v_mfma_f32_16x16x32_bf16 v[24:27], v[8:11], v[88:91], v[24:27]
  v_mfma_f32_16x16x32_bf16 v[28:31], v[8:11], v[92:95], v[28:31]
  s_nop 5
  v_cndmask_b32 v32, v16, v20, s[62:63]
  s_nop 0
  v_cndmask_b32 v33, v24, v28, s[62:63]
  s_mov_b32 exec_lo, 0xffffffff
  s_mov_b32 exec_hi, 0x0
  buffer_store_dwordx4 v[32:35], v59, s[32:35], s77 offen
  s_mov_b64 exec, -1
  s_cmp_lg_u32 s46, 1
  s_cbranch_scc1 L_slow_74
L_back_75:
  s_barrier
  ds_read_b128 v[8:11], v52 offset:7168
  ds_read_b128 v[12:15], v52 offset:7232
  s_waitcnt lgkmcnt(1)
  v_mfma_f32_16x16x32_bf16 v[16:19], v[8:11], v[64:67], 0
  v_mfma_f32_16x16x32_bf16 v[20:23], v[8:11], v[68:71], 0
  v_mfma_f32_16x16x32_bf16 v[24:27], v[8:11], v[72:75], 0
  v_mfma_f32_16x16x32_bf16 v[28:31], v[8:11], v[76:79], 0
  s_waitcnt lgkmcnt(0)
  v_mfma_f32_16x16x32_bf16 v[16:19], v[12:15], v[80:83], v[16:19]
  v_mfma_f32_16x16x32_bf16 v[20:23], v[12:15], v[84:87], v[20:23]
  v_mfma_f32_16x16x32_bf16 v[24:27], v[12:15], v[88:91], v[24:27]
  v_mfma_f32_16x16x32_bf16 v[28:31], v[12:15], v[92:95], v[28:31]
  s_nop 5
  v_cndmask_b32 v4, v16, v20, s[62:63]
  s_nop 0
  v_cndmask_b32 v5, v24, v28, s[62:63]
  s_mov_b32 exec_lo, 0xffffffff
  s_mov_b32 exec_hi, 0x0
  buffer_store_dwordx4 v[4:7], v59, s[32:35], s76 offen
  s_mov_b64 exec, -1
  s_cmp_lg_u32 s46, 1
  s_cbranch_scc1 L_slow_76
L_back_77:
  s_endpgm
L_post_wo:
  s_cmp_gt_u32 s5, 11
  s_cbranch_scc1 L_end
  s_cmp_eq_u32 s3, 3
  s_cbranch_scc1 L_end
  v_mov_b32 v57, 0
  s_cmp_eq_u32 s3, 1
  s_cbranch_scc1 L_hid
  s_barrier
  s_and_b32 s68, s4, 1
  s_lshl_b32 s68, s68, 2
  s_sub_u32 s68, 12, s68
  s_cmp_ge_u32 s5, s68
  s_cbranch_scc1 L_end
  s_mul_i32 s72, s4, 5
  s_add_u32 s72, s72, 1
  s_lshr_b32 s72, s72, 1
  s_lshr_b32 s68, s5, 2
  s_add_u32 s72, s72, s68
  s_and_b32 s73, s5, 3
  v_lshrrev_b32 v2, 1, v0
  v_lshlrev_b32 v2, 7, v2
  v_and_b32 v3, 1, v0
  v_lshl_add_u32 v96, v3, 4, v2
  s_lshl_b32 s10, s72, 15
  s_lshr_b32 s68, s47, s4
  s_and_b32 s68, s68, 1
  s_lshl_b32 s68, s68, 13
  s_add_u32 s10, s10, s68
  s_lshl_b32 s68, s73, 5
  s_add_u32 s10, s10, s68
  s_add_u32 s10, s10, 1048576
  s_add_u32 s11, s10, 4096
  s_add_u32 s12, s10, 16384
  v_lshrrev_b32 v4, 4, v0
  v_lshl_add_u32 v97, v3, 2, v4
  v_lshlrev_b32 v97, 1, v97
  v_lshlrev_b32 v99, 5, v4
  s_and_b32 s68, s73, 1
  s_lshl_b32 s68, s68, 5
  v_lshl_add_u32 v98, v3, 4, s68
  s_mul_i32 s13, s4, 20
  s_add_u32 s13, s13, s72
  s_lshl_b32 s13, s13, 7
  s_lshr_b32 s68, s73, 1
  s_lshl4_add_u32 s13, s68, s13
  s_add_u32 s13, s13, 2768896
  s_lshl2_add_u32 s14, s72, s73
  s_lshl_b32 s14, s14, 4
  s_mov_b32 s8, 0x30003
  s_mov_b32 s9, 0x30003
  s_mov_b32 s77, 0x3f80
  s_mov_b32 s71, 0x3f800000
  v_mov_b32 v8, 0
  v_mov_b32 v9, 0
  v_mov_b32 v10, 0
  v_mov_b32 v11, 0
  s_mov_b32 s64, s54
  s_mov_b32 s65, s55
  s_mov_b32 s66, 1280
  s_mov_b32 s67, 0x20000
  s_setprio 0
  v_mov_b32 v1, 0
  s_mov_b32 s70, 4000007
L_spin_78:
  ds_read_b32 v4, v1 offset:736
  s_waitcnt lgkmcnt(0)
  v_cmp_gt_u32 vcc, 1, v4
  s_nop 0
  s_cbranch_vccz L_sdone_79
  s_sub_u32 s70, s70, 1
  s_cbranch_scc0 L_spin_78
L_sdone_79:
  s_sleep 16
  s_mov_b32 s16, s32
  s_mov_b32 s17, s33
  s_mov_b32 s18, 4194304
  s_mov_b32 s19, 0x20000
  s_mov_b32 s70, 4000007
L_spin_80:
  buffer_load_dwordx4 v[4:7], v99, s[16:19], s13 offen sc1
  buffer_load_dwordx4 v[16:19], v96, s[24:27], s10 offen sc1
  buffer_load_dwordx4 v[20:23], v96, s[24:27], s11 offen sc1
  buffer_load_dwordx4 v[24:27], v96, s[24:27], s12 offen sc1
  s_waitcnt vmcnt(0)
  v_cmp_ne_u64 vcc, s[30:31], v[6:7]
  v_cmp_ne_u64 s[20:21], s[30:31], v[18:19]
  v_cmp_ne_u64 s[22:23], s[30:31], v[22:23]
  s_or_b64 vcc, vcc, s[20:21]
  v_cmp_ne_u64 s[20:21], s[30:31], v[26:27]
  s_or_b64 vcc, vcc, s[22:23]
  s_or_b64 vcc, vcc, s[20:21]
  s_nop 0
  s_cbranch_vccz L_sdone_81
  s_and_b32 s99, s70, 7
  s_cmp_eq_u32 s46, 1
  s_cselect_b32 s99, 1, s99
  s_cmp_lg_u32 s99, 0
  s_cselect_b32 s16, s32, s24
  s_cselect_b32 s17, s33, s25
  s_sub_u32 s70, s70, 1
  s_cbranch_scc0 L_spin_80
L_sdone_81:
L_finc:
  v_dot2c_f32_bf16 v8, s77, v16
  v_dot2c_f32_bf16 v10, s77, v17
  v_dot2c_f32_bf16 v9, s71, v16
  v_dot2c_f32_bf16 v11, s71, v17
  v_dot2c_f32_bf16 v8, s77, v20
  v_dot2c_f32_bf16 v10, s77, v21
  v_dot2c_f32_bf16 v9, s71, v20
  v_dot2c_f32_bf16 v11, s71, v21
  v_dot2c_f32_bf16 v8, s77, v24
  v_dot2c_f32_bf16 v10, s77, v25
  v_dot2c_f32_bf16 v9, s71, v24
  v_dot2c_f32_bf16 v11, s71, v25
  v_lshrrev_b64 v[58:59], v98, v[4:5]
  v_permlane32_swap_b32 v8, v10
  s_nop 0
  v_permlane32_swap_b32 v9, v11
  v_add_f32 v8, v8, v10
  v_add_f32 v9, v9, v11
  v_lshlrev_b32 v58, 16, v58
  s_nop 0
  v_permlane16_swap_b32 v8, v9
  v_add_f32 v8, v8, v9
  s_nop 1
  v_add_f32_dpp v8, v8, v8 row_ror:8 row_mask:0xf bank_mask:0xf
  s_nop 1
  v_add_f32_dpp v8, v8, v8 row_ror:4 row_mask:0xf bank_mask:0xf
  s_nop 1
  v_add_f32_dpp v8, v8, v8 quad_perm:[2,3,0,1] row_mask:0xf bank_mask:0xf
  v_cvt_pk_bf16_f32 v8, v57, v8
  v_add_f32 v8, v8, v58
  v_cvt_pk_bf16_f32 v8, v8, v8
  s_mov_b64 exec, s[8:9]
  buffer_store_short v8, v97, s[64:67], s14 offen
  s_cmp_lg_u32 s14, 0
  s_cbranch_scc1 L_fin_exit
  s_mov_b64 exec, 1
  v_mov_b32 v4, s30
  v_mov_b32 v5, s31
  s_mov_b32 s68, 917504
  buffer_store_dwordx2 v[4:5], v57, s[24:27], s68 offen
L_fin_exit:
  s_endpgm
L_hid:
  s_mul_i32 s72, s4, 12
  s_add_u32 s72, s72, s5
  v_lshrrev_b32 v4, 5, v0
  v_and_b32 v2, 7, v0
  v_lshl_add_u32 v62, v4, 3, v2
  v_lshlrev_b32 v62, 1, v62
  v_lshlrev_b32 v63, 2, v2
  v_lshlrev_b32 v60, 4, v0
  v_and_b32 v3, 31, v0
  v_lshlrev_b32 v61, 4, v3
  s_lshl_b32 s65, s4, 9
  s_add_u32 s65, s65, 2752512
  s_mul_i32 s60, s72, 3072
  s_add_u32 s62, s60, 3145728
  s_add_u32 s60, s60, 2228224
  s_mov_b32 s8, 0xfffff
  s_mov_b32 s9, 0xfffff
  s_mov_b32 s10, 0xffff
  s_mov_b32 s11, 0xffff
  v_mov_b32 v59, 1
  v_mov_b32 v24, 0
  v_mov_b32 v25, 0
  v_mov_b32 v26, s30
  v_mov_b32 v27, s31
  v_mov_b32 v136, 0
  v_mov_b32 v137, 0
  v_mov_b32 v138, s30
  v_mov_b32 v139, s31
  v_mov_b32 v140, 0
  v_mov_b32 v141, 0
  v_mov_b32 v142, s30
  v_mov_b32 v143, s31
  v_not_b32 v18, s30
  v_not_b32 v22, s30
  v_not_b32 v130, s30
  v_not_b32 v134, s30
  s_mov_b64 exec, s[10:11]
  v_not_b32 v26, s30
  v_not_b32 v138, s30
  s_mov_b64 exec, s[8:9]
  v_not_b32 v142, s30
  s_mov_b64 exec, -1
  s_barrier
  v_cmp_ne_u64 vcc, s[30:31], v[18:19]
  v_cmp_ne_u64 s[20:21], s[30:31], v[22:23]
  v_cmp_ne_u64 s[22:23], s[30:31], v[26:27]
  s_or_b64 vcc, vcc, s[20:21]
  s_or_b64 vcc, vcc, s[22:23]
  s_nop 0
  s_cbranch_vccz L_pok_83
  s_cmp_lg_u32 s46, 1
  s_cbranch_scc1 L_pslow_82
  s_mov_b32 s70, 4000007
L_fp_84:
  buffer_load_dwordx4 v[16:19], v60, s[32:35], s62 offen sc1
  buffer_load_dwordx4 v[20:23], v60, s[32:35], s62 offen offset:1024 sc1
  s_mov_b64 exec, s[10:11]
  buffer_load_dwordx4 v[24:27], v60, s[32:35], s62 offen offset:2048 sc1
  s_mov_b64 exec, -1
  s_mov_b64 exec, s[8:9]
  buffer_load_dwordx4 v[140:143], v61, s[32:35], s65 offen sc1
  s_mov_b64 exec, -1
  buffer_load_dwordx4 v[128:131], v60, s[32:35], s60 offen sc1
  buffer_load_dwordx4 v[132:135], v60, s[32:35], s60 offen offset:1024 sc1
  s_mov_b64 exec, s[10:11]
  buffer_load_dwordx4 v[136:139], v60, s[32:35], s60 offen offset:2048 sc1
  s_mov_b64 exec, -1
  v_cmp_ne_u64 vcc, s[30:31], v[18:19]
  v_cmp_ne_u64 s[20:21], s[30:31], v[22:23]
  v_cmp_ne_u64 s[22:23], s[30:31], v[26:27]
  s_or_b64 vcc, vcc, s[20:21]
  s_or_b64 vcc, vcc, s[22:23]
  s_nop 0
  s_cbranch_vccz L_pok_83
  v_cmp_ne_u64 vcc, s[30:31], v[18:19]
  v_cmp_ne_u64 s[20:21], s[30:31], v[22:23]
  v_cmp_ne_u64 s[22:23], s[30:31], v[26:27]
  s_or_b64 vcc, vcc, s[20:21]
  s_or_b64 vcc, vcc, s[22:23]
  s_nop 0
  s_cbranch_vccz L_pok_83
  v_cmp_ne_u64 vcc, s[30:31], v[18:19]
  v_cmp_ne_u64 s[20:21], s[30:31], v[22:23]
  v_cmp_ne_u64 s[22:23], s[30:31], v[26:27]
  s_or_b64 vcc, vcc, s[20:21]
  s_or_b64 vcc, vcc, s[22:23]
  s_nop 0
  s_cbranch_vccz L_pok_83
  v_cmp_ne_u64 vcc, s[30:31], v[18:19]
  v_cmp_ne_u64 s[20:21], s[30:31], v[22:23]
  v_cmp_ne_u64 s[22:23], s[30:31], v[26:27]
  s_or_b64 vcc, vcc, s[20:21]
  s_or_b64 vcc, vcc, s[22:23]
  s_nop 0
  s_cbranch_vccz L_pok_83
  v_cmp_ne_u64 vcc, s[30:31], v[18:19]
  v_cmp_ne_u64 s[20:21], s[30:31], v[22:23]
  v_cmp_ne_u64 s[22:23], s[30:31], v[26:27]
  s_or_b64 vcc, vcc, s[20:21]
  s_or_b64 vcc, vcc, s[22:23]
  s_nop 0
  s_cbranch_vccz L_pok_83
  v_cmp_ne_u64 vcc, s[30:31], v[18:19]
  v_cmp_ne_u64 s[20:21], s[30:31], v[22:23]
  v_cmp_ne_u64 s[22:23], s[30:31], v[26:27]
  s_or_b64 vcc, vcc, s[20:21]
  s_or_b64 vcc, vcc, s[22:23]
  s_nop 0
  s_cbranch_vccz L_pok_83
  v_cmp_ne_u64 vcc, s[30:31], v[18:19]
  v_cmp_ne_u64 s[20:21], s[30:31], v[22:23]
  v_cmp_ne_u64 s[22:23], s[30:31], v[26:27]
  s_or_b64 vcc, vcc, s[20:21]
  s_or_b64 vcc, vcc, s[22:23]
  s_nop 0
  s_cbranch_vccz L_pok_83
  v_cmp_ne_u64 vcc, s[30:31], v[18:19]
  v_cmp_ne_u64 s[20:21], s[30:31], v[22:23]
  v_cmp_ne_u64 s[22:23], s[30:31], v[26:27]
  s_or_b64 vcc, vcc, s[20:21]
  s_or_b64 vcc, vcc, s[22:23]
  s_nop 0
  s_cbranch_vccz L_pok_83
  s_waitcnt vmcnt(14)
  s_sub_u32 s70, s70, 1
  s_cbranch_scc0 L_fp_84
L_pok_83:
  v_pk_add_f32 v[40:41], v[16:17], v[20:21]
  v_pk_add_f32 v[40:41], v[40:41], v[24:25]
  s_nop 1
  v_add_f32_dpp v40, v40, v40 row_ror:8 row_mask:0xf bank_mask:0xf
  v_add_f32_dpp v41, v41, v41 row_ror:8 row_mask:0xf bank_mask:0xf
  v_mov_b32 v42, v40
  v_mov_b32 v43, v41
  s_nop 0
  v_permlane16_swap_b32 v40, v42
  v_permlane16_swap_b32 v41, v43
  v_add_f32 v40, v40, v42
  v_add_f32 v41, v41, v43
  v_cmp_ne_u64 vcc, s[30:31], v[142:143]
  s_nop 0
  s_cbranch_vccz L_pok_88
  s_cmp_lg_u32 s46, 1
  s_cbranch_scc1 L_pslow_87
  s_mov_b32 s70, 4000007
L_fp_89:
  s_mov_b64 exec, s[8:9]
  buffer_load_dwordx4 v[140:143], v61, s[32:35], s65 offen sc1
  s_mov_b64 exec, -1
  v_cmp_ne_u64 vcc, s[30:31], v[142:143]
  s_nop 0
  s_cbranch_vccz L_pok_88
  v_cmp_ne_u64 vcc, s[30:31], v[142:143]
  s_nop 0
  s_cbranch_vccz L_pok_88
  s_waitcnt vmcnt(12)
  s_sub_u32 s70, s70, 1
  s_cbranch_scc0 L_fp_89
L_pok_88:
  s_cmp_lg_u32 s46, 1
  s_cbranch_scc1 L_nopre
  buffer_load_dwordx4 v[128:131], v60, s[32:35], s60 offen sc1
  buffer_load_dwordx4 v[132:135], v60, s[32:35], s60 offen offset:1024 sc1
  s_mov_b64 exec, s[10:11]
  buffer_load_dwordx4 v[136:139], v60, s[32:35], s60 offen offset:2048 sc1
  s_mov_b64 exec, -1
L_nopre:
  v_add_f32_dpp v36, v140, v140 quad_perm:[1,0,3,2] row_mask:0xf bank_mask:0xf
  v_add_f32_dpp v37, v141, v141 quad_perm:[1,0,3,2] row_mask:0xf bank_mask:0xf
  s_nop 0
  v_add_f32_dpp v36, v36, v36 quad_perm:[2,3,0,1] row_mask:0xf bank_mask:0xf
  v_add_f32_dpp v37, v37, v37 quad_perm:[2,3,0,1] row_mask:0xf bank_mask:0xf
  s_nop 0
  v_add_f32_dpp v36, v36, v36 row_half_mirror row_mask:0xf bank_mask:0xf
  v_add_f32_dpp v37, v37, v37 row_half_mirror row_mask:0xf bank_mask:0xf
  s_nop 0
  v_add_f32_dpp v46, v36, v36 row_mirror row_mask:0xf bank_mask:0xf
  v_add_f32_dpp v47, v37, v37 row_mirror row_mask:0xf bank_mask:0xf
  v_add_f32_dpp v36, v36, v36 row_mirror row_mask:0xf bank_mask:0xf
  v_add_f32_dpp v37, v37, v37 row_mirror row_mask:0xf bank_mask:0xf
  s_nop 0
  v_permlane16_swap_b32 v36, v46
  v_permlane16_swap_b32 v37, v47
  v_pk_add_f32 v[36:37], v[36:37], v[46:47]
  s_cbranch_scc1 L_nopre2
  buffer_load_dwordx4 v[128:131], v60, s[32:35], s60 offen sc1
  buffer_load_dwordx4 v[132:135], v60, s[32:35], s60 offen offset:1024 sc1
  s_mov_b64 exec, s[10:11]
  buffer_load_dwordx4 v[136:139], v60, s[32:35], s60 offen offset:2048 sc1
  s_mov_b64 exec, -1
L_nopre2:
  v_mul_f32 v44, 0x3acccccd, v36
  v_mul_f32 v45, 0x3acccccd, v37
  v_fma_f32 v45, -v44, v44, v45
  v_max_f32 v45, 0, v45
  v_cvt_pk_bf16_f32 v45, v57, v45
  v_cvt_pk_bf16_f32 v44, v57, v44
  v_add_f32 v45, 0x3727c5ac, v45
  v_cvt_pk_bf16_f32 v45, v57, v45
  v_sqrt_f32 v45, v45
  v_mul_f32 v40, v44, v40
  v_cvt_pk_bf16_f32 v45, v57, v45
  v_rcp_f32 v45, v45
  v_mul_f32 v41, v44, v41
  v_cmp_ne_u64 vcc, s[30:31], v[130:131]
  v_cmp_ne_u64 s[20:21], s[30:31], v[134:135]
  v_cmp_ne_u64 s[22:23], s[30:31], v[138:139]
  s_or_b64 vcc, vcc, s[20:21]
  s_or_b64 vcc, vcc, s[22:23]
  s_nop 0
  s_cbranch_vccz L_pok_93
  s_cmp_lg_u32 s46, 1
  s_cbranch_scc1 L_pslow_92
  s_mov_b32 s70, 4000007
L_fp_94:
  buffer_load_dwordx4 v[128:131], v60, s[32:35], s60 offen sc1
  buffer_load_dwordx4 v[132:135], v60, s[32:35], s60 offen offset:1024 sc1
  s_mov_b64 exec, s[10:11]
  buffer_load_dwordx4 v[136:139], v60, s[32:35], s60 offen offset:2048 sc1
  s_mov_b64 exec, -1
  v_cmp_ne_u64 vcc, s[30:31], v[130:131]
  v_cmp_ne_u64 s[20:21], s[30:31], v[134:135]
  v_cmp_ne_u64 s[22:23], s[30:31], v[138:139]
  s_or_b64 vcc, vcc, s[20:21]
  s_or_b64 vcc, vcc, s[22:23]
  s_nop 0
  s_cbranch_vccz L_pok_93
  s_waitcnt vmcnt(12)
  s_sub_u32 s70, s70, 1
  s_cbranch_scc0 L_fp_94
L_pok_93:
L_hidc:
  v_pk_add_f32 v[8:9], v[128:129], v[132:133]
  v_pk_add_f32 v[8:9], v[8:9], v[136:137]
  s_nop 1
  v_add_f32_dpp v10, v8, v8 row_ror:8 row_mask:0xf bank_mask:0xf
  v_add_f32_dpp v11, v9, v9 row_ror:8 row_mask:0xf bank_mask:0xf
  v_add_f32_dpp v8, v8, v8 row_ror:8 row_mask:0xf bank_mask:0xf
  v_add_f32_dpp v9, v9, v9 row_ror:8 row_mask:0xf bank_mask:0xf
  s_nop 0
  v_permlane16_swap_b32 v8, v10
  v_permlane16_swap_b32 v9, v11
  v_add_f32 v8, v8, v10
  v_sub_f32 v8, v8, v40
  v_mul_f32 v8, v8, v45
  v_cvt_pk_bf16_f32 v8, v57, v8
  v_mul_f32 v12, 0xbfb8aa3b, v8
  v_exp_f32 v12, v12
  v_add_f32 v9, v9, v11
  v_add_f32 v12, 1.0, v12
  v_rcp_f32 v12, v12
  v_sub_f32 v9, v9, v41
  v_mul_f32 v9, v9, v45
  v_mul_f32 v8, v8, v12
  v_cvt_pk_bf16_f32 v9, v57, v9
  v_cvt_pk_bf16_f32 v8, v57, v8
  v_mul_f32 v8, v8, v9
  v_cvt_pk_bf16_f32 v8, v8, v8
  ds_write_b16 v62, v8 offset:704
  ds_write_b32 v63, v59 offset:736
  s_endpgm
L_f2:
  s_mov_b32 s8, s52
  s_mov_b32 s9, s53
  s_mov_b32 s10, 1966080
  s_mov_b32 s11, 0x20000
  v_mov_b32 v17, 0
  s_mov_b32 s70, 4000007
L_spin_97:
  ds_read_b32 v16, v17 offset:660
  s_waitcnt lgkmcnt(0)
  v_cmp_gt_u32 vcc, 1, v16
  s_nop 0
  s_cbranch_vccz L_sdone_98
  s_sleep 1
  s_sub_u32 s70, s70, 1
  s_cbranch_scc0 L_spin_97
L_sdone_98:
  v_readfirstlane_b32 s47, v16
  s_mul_i32 s72, s4, 12
  s_add_u32 s72, s72, s5
  v_mov_b32 v57, 0
  s_sub_u32 s68, s3, 7
  s_lshl_b32 s69, s68, 8
  v_lshlrev_b32 v58, 2, v0
  v_add_u32 v58, s69, v58
  v_lshrrev_b32 v2, 4, v0
  v_lshl_add_u32 v2, s68, 2, v2
  v_mul_u32_u24 v3, 52, v2
  v_lshrrev_b32 v3, 8, v3
  v_mul_u32_u24 v4, 5, v3
  v_sub_u32 v4, v2, v4
  v_cmp_lt_u32 vcc, 2, v4
  v_lshlrev_b32 v3, 1, v3
  s_nop 0
  v_addc_co_u32 v3, vcc, 0, v3, vcc
  v_lshrrev_b32 v3, v3, s47
  v_and_b32 v3, 1, v3
  v_lshlrev_b32 v116, 15, v2
  v_lshl_add_u32 v116, v3, 13, v116
  v_bfe_u32 v3, v0, 1, 3
  v_lshl_add_u32 v116, v3, 4, v116
  s_lshr_b32 s79, s72, 6
  s_lshl_b32 s79, s79, 14
  s_and_b32 s68, s72, 63
  s_lshl_b32 s68, s68, 7
  s_add_u32 s79, s79, s68
  s_add_u32 s79, s79, 1048576
  s_mov_b32 s60, 0x05040100
  s_mov_b32 s61, 0x07060302
  s_mul_i32 s62, s72, 20480
  v_lshrrev_b32 v2, 4, v0
  v_mul_u32_u24 v2, 1280, v2
  v_and_b32 v3, 15, v0
  v_lshl_add_u32 v2, v3, 4, v2
  s_add_u32 s62, s62, s69
  s_lshl_b32 s63, s69, 4
  v_lshlrev_b32 v3, 2, v0
  v_add_u32 v3, s63, v3
  s_add_u32 s63, s63, 8704
  s_barrier
  s_add_u32 m0, s63, 0
  s_nop 0
  buffer_load_dwordx4 v2, s[8:11], s62 offen nt lds
  s_add_u32 s62, s62, 5120
  s_add_u32 m0, s63, 1024
  s_nop 0
  buffer_load_dwordx4 v2, s[8:11], s62 offen nt lds
  s_add_u32 s62, s62, 5120
  s_add_u32 m0, s63, 2048
  s_nop 0
  buffer_load_dwordx4 v2, s[8:11], s62 offen nt lds
  s_add_u32 s62, s62, 5120
  s_add_u32 m0, s63, 3072
  s_nop 0
  buffer_load_dwordx4 v2, s[8:11], s62 offen nt lds
  s_add_u32 s62, s62, 5120
  s_barrier
  s_waitcnt vmcnt(0)
  ds_read_b32 v64, v3 offset:8704
  ds_read_b32 v65, v3 offset:8960
  ds_read_b32 v66, v3 offset:9216
  ds_read_b32 v67, v3 offset:9472
  ds_read_b32 v68, v3 offset:9728
  ds_read_b32 v69, v3 offset:9984
  ds_read_b32 v70, v3 offset:10240
  ds_read_b32 v71, v3 offset:10496
  ds_read_b32 v72, v3 offset:10752
  ds_read_b32 v73, v3 offset:11008
  ds_read_b32 v74, v3 offset:11264
  ds_read_b32 v75, v3 offset:11520
  ds_read_b32 v76, v3 offset:11776
  ds_read_b32 v77, v3 offset:12032
  ds_read_b32 v78, v3 offset:12288
  ds_read_b32 v79, v3 offset:12544
  s_waitcnt lgkmcnt(0)
  v_perm_b32 v80, v65, v64, s60
  v_perm_b32 v88, v65, v64, s61
  v_perm_b32 v81, v67, v66, s60
  v_perm_b32 v89, v67, v66, s61
  v_perm_b32 v82, v69, v68, s60
  v_perm_b32 v90, v69, v68, s61
  v_perm_b32 v83, v71, v70, s60
  v_perm_b32 v91, v71, v70, s61
  v_perm_b32 v84, v73, v72, s60
  v_perm_b32 v92, v73, v72, s61
  v_perm_b32 v85, v75, v74, s60
  v_perm_b32 v93, v75, v74, s61
  v_perm_b32 v86, v77, v76, s60
  v_perm_b32 v94, v77, v76, s61
  v_perm_b32 v87, v79, v78, s60
  v_perm_b32 v95, v79, v78, s61
  v_mov_b32 v16, 0
  v_mov_b32 v17, 0
  v_mov_b32 v18, 0
  v_mov_b32 v19, 0
  s_mov_b32 s66, 0x55555555
  s_mov_b32 s67, 0x55555555
  v_mov_b32 v6, s30
  v_mov_b32 v7, s31
  v_and_b32 v9, 15, v0
  v_lshlrev_b32 v9, 2, v9
  v_mov_b32 v8, 0
  s_mov_b32 s64, 0xff00ff00
  s_mov_b32 s65, 0xff00ff00
  s_mov_b32 s70, 32000056
  s_waitcnt lgkmcnt(0)
L_f2poll:
  ds_read_b32 v8, v9 offset:704
  s_waitcnt lgkmcnt(4)
  v_cmp_eq_u32 vcc, 0, v8
  s_sub_u32 s70, s70, 1
  s_cbranch_scc1 L_f2go
  s_and_b64 vcc, vcc, s[64:65]
  s_cbranch_scc1 L_f2poll
L_f2go:
  v_dot2c_f32_bf16_dpp v16, v8, v80 row_newbcast:0 row_mask:0xf bank_mask:0xf
  v_dot2c_f32_bf16_dpp v17, v8, v88 row_newbcast:0 row_mask:0xf bank_mask:0xf
  v_dot2c_f32_bf16_dpp v18, v8, v81 row_newbcast:1 row_mask:0xf bank_mask:0xf
  v_dot2c_f32_bf16_dpp v19, v8, v89 row_newbcast:1 row_mask:0xf bank_mask:0xf
  v_dot2c_f32_bf16_dpp v16, v8, v82 row_newbcast:2 row_mask:0xf bank_mask:0xf
  v_dot2c_f32_bf16_dpp v17, v8, v90 row_newbcast:2 row_mask:0xf bank_mask:0xf
  v_dot2c_f32_bf16_dpp v18, v8, v83 row_newbcast:3 row_mask:0xf bank_mask:0xf
  v_dot2c_f32_bf16_dpp v19, v8, v91 row_newbcast:3 row_mask:0xf bank_mask:0xf
  v_dot2c_f32_bf16_dpp v16, v8, v84 row_newbcast:4 row_mask:0xf bank_mask:0xf
  v_dot2c_f32_bf16_dpp v17, v8, v92 row_newbcast:4 row_mask:0xf bank_mask:0xf
  v_dot2c_f32_bf16_dpp v18, v8, v85 row_newbcast:5 row_mask:0xf bank_mask:0xf
  v_dot2c_f32_bf16_dpp v19, v8, v93 row_newbcast:5 row_mask:0xf bank_mask:0xf
  v_dot2c_f32_bf16_dpp v16, v8, v86 row_newbcast:6 row_mask:0xf bank_mask:0xf
  v_dot2c_f32_bf16_dpp v17, v8, v94 row_newbcast:6 row_mask:0xf bank_mask:0xf
  v_dot2c_f32_bf16_dpp v18, v8, v87 row_newbcast:7 row_mask:0xf bank_mask:0xf
  v_dot2c_f32_bf16_dpp v19, v8, v95 row_newbcast:7 row_mask:0xf bank_mask:0xf
  s_nop 2
  v_pk_add_f32 v[16:17], v[16:17], v[18:19]
  v_cvt_pk_bf16_f32 v4, v16, v17
  s_nop 1
  v_mov_b32_dpp v5, v4 quad_perm:[1,0,3,2] row_mask:0xf bank_mask:0xf
  s_mov_b64 exec, s[66:67]
  buffer_store_dwordx4 v[4:7], v116, s[24:27], s79 offen sc1
L_end:
  s_endpgm
L_spare:
  v_mov_b32 v1, 0
  s_mov_b32 s70, 4000007
L_spin_99:
  ds_read_b32 v4, v1 offset:668
  s_waitcnt lgkmcnt(0)
  v_cmp_gt_u32 vcc, 1, v4
  s_nop 0
  s_cbranch_vccz L_sdone_100
  s_sleep 2
  s_sub_u32 s70, s70, 1
  s_cbranch_scc0 L_spin_99
L_sdone_100:
  v_lshlrev_b32 v1, 7, v0
  s_sub_u32 s76, s5, 30
  s_lshl1_add_u32 s68, s4, s76
  s_lshl3_add_u32 s68, s68, s73
  s_mul_i32 s68, s68, 3072
  s_add_u32 s68, s68, 524288
  s_mov_b64 exec, 0xffffff
  buffer_load_dword v5, v1, s[32:35], s68 offen nt
  s_waitcnt vmcnt(0)
  buffer_load_dword v5, v1, s[32:35], s68 offen sc1
  s_mov_b64 exec, -1
  s_cmp_gt_u32 s73, 5
  s_cbranch_scc1 L_nopa
  s_mul_i32 s68, s4, 6
  s_add_u32 s68, s68, s73
  s_mul_i32 s68, s68, 6144
  s_mul_i32 s69, s76, 917504
  s_add_u32 s68, s68, s69
  s_add_u32 s68, s68, 2228224
  s_mov_b32 exec_lo, 0xff33ffff
  s_mov_b32 exec_hi, 0x33ff
  buffer_load_dword v4, v1, s[32:35], s68 offen nt
  s_waitcnt vmcnt(0)
  buffer_load_dword v4, v1, s[32:35], s68 offen sc1
  s_mov_b64 exec, -1
L_nopa:
  s_endpgm
L_dry:
  s_endpgm
L_slow_25:
  s_mov_b32 exec_lo, 0xffffffff
  s_mov_b32 exec_hi, 0xffff
  buffer_store_dwordx4 v[4:7], v13, s[24:27], s74 offen sc1
  s_mov_b64 exec, -1
  s_nop 1
  s_branch L_back_26
L_slow_32:
  s_mov_b32 exec_lo, 0x55555555
  s_mov_b32 exec_hi, 0x0
  buffer_store_dwordx4 v[8:11], v2, s[24:27], s66 offen offset:1536 sc1
  s_mov_b64 exec, -1
  s_nop 1
  s_branch L_back_33
L_slow_46:
  s_mov_b32 exec_lo, 0x101
  s_mov_b32 exec_hi, 0x0
  buffer_store_dwordx4 v[2:5], v12, s[24:27], s68 offen sc1
  s_mov_b64 exec, -1
  s_nop 1
  s_branch L_back_47
L_slow_54:
  s_mov_b32 exec_lo, 0xffffffff
  s_mov_b32 exec_hi, 0xffff
  buffer_store_dwordx4 v[4:7], v13, s[24:27], s74 offen sc1
  s_mov_b64 exec, -1
  s_nop 1
  s_branch L_back_55
L_slow_72:
  s_mov_b32 exec_lo, 0x1
  s_mov_b32 exec_hi, 0x0
  buffer_store_dwordx4 v[4:7], v55, s[24:27], s72 offen sc1
  s_mov_b32 exec_lo, 0x110011
  s_mov_b32 exec_hi, 0x110011
  buffer_store_dwordx4 v[12:15], v54, s[24:27], s75 offen sc1
  s_mov_b64 exec, -1
  s_nop 1
  s_branch L_back_73
L_slow_74:
  s_mov_b32 exec_lo, 0xffffffff
  s_mov_b32 exec_hi, 0x0
  buffer_store_dwordx4 v[32:35], v59, s[24:27], s77 offen sc1
  s_mov_b64 exec, -1
  s_nop 1
  s_branch L_back_75
L_slow_76:
  s_mov_b32 exec_lo, 0xffffffff
  s_mov_b32 exec_hi, 0x0
  buffer_store_dwordx4 v[4:7], v59, s[24:27], s76 offen sc1
  s_mov_b64 exec, -1
  s_nop 1
  s_branch L_back_77
L_pslow_82:
  s_mov_b32 s16, s32
  s_mov_b32 s17, s33
  s_mov_b32 s18, 4194304
  s_mov_b32 s19, 0x20000
  s_mov_b32 s70, 4000007
L_spin_85:
  buffer_load_dwordx4 v[16:19], v60, s[16:19], s62 offen sc1
  buffer_load_dwordx4 v[20:23], v60, s[16:19], s62 offen offset:1024 sc1
  s_mov_b64 exec, s[10:11]
  buffer_load_dwordx4 v[24:27], v60, s[16:19], s62 offen offset:2048 sc1
  s_mov_b64 exec, -1
  s_mov_b64 exec, s[8:9]
  buffer_load_dwordx4 v[140:143], v61, s[16:19], s65 offen sc1
  s_mov_b64 exec, -1
  buffer_load_dwordx4 v[128:131], v60, s[16:19], s60 offen sc1
  buffer_load_dwordx4 v[132:135], v60, s[16:19], s60 offen offset:1024 sc1
  s_mov_b64 exec, s[10:11]
  buffer_load_dwordx4 v[136:139], v60, s[16:19], s60 offen offset:2048 sc1
  s_mov_b64 exec, -1
  s_waitcnt vmcnt(0)
  v_cmp_ne_u64 vcc, s[30:31], v[18:19]
  v_cmp_ne_u64 s[20:21], s[30:31], v[22:23]
  v_cmp_ne_u64 s[22:23], s[30:31], v[26:27]
  s_or_b64 vcc, vcc, s[20:21]
  s_or_b64 vcc, vcc, s[22:23]
  s_nop 0
  s_cbranch_vccz L_sdone_86
  s_and_b32 s99, s70, 7
  s_cmp_eq_u32 s46, 1
  s_cselect_b32 s99, 1, s99
  s_cmp_lg_u32 s99, 0
  s_cselect_b32 s16, s32, s24
  s_cselect_b32 s17, s33, s25
  s_sub_u32 s70, s70, 1
  s_cbranch_scc0 L_spin_85
L_sdone_86:
  s_branch L_pok_83
L_pslow_87:
  s_mov_b32 s16, s32
  s_mov_b32 s17, s33
  s_mov_b32 s18, 4194304
  s_mov_b32 s19, 0x20000
  s_mov_b32 s70, 4000007
L_spin_90:
  s_mov_b64 exec, s[8:9]
  buffer_load_dwordx4 v[140:143], v61, s[16:19], s65 offen sc1
  s_mov_b64 exec, -1
  s_waitcnt vmcnt(0)
  v_cmp_ne_u64 vcc, s[30:31], v[142:143]
  s_nop 0
  s_cbranch_vccz L_sdone_91
  s_and_b32 s99, s70, 7
  s_cmp_eq_u32 s46, 1
  s_cselect_b32 s99, 1, s99
  s_cmp_lg_u32 s99, 0
  s_cselect_b32 s16, s32, s24
  s_cselect_b32 s17, s33, s25
  s_sub_u32 s70, s70, 1
  s_cbranch_scc0 L_spin_90
L_sdone_91:
  s_branch L_pok_88
L_pslow_92:
  s_mov_b32 s16, s32
  s_mov_b32 s17, s33
  s_mov_b32 s18, 4194304
  s_mov_b32 s19, 0x20000
  s_mov_b32 s70, 4000007
L_spin_95:
  buffer_load_dwordx4 v[128:131], v60, s[16:19], s60 offen sc1
  buffer_load_dwordx4 v[132:135], v60, s[16:19], s60 offen offset:1024 sc1
  s_mov_b64 exec, s[10:11]
  buffer_load_dwordx4 v[136:139], v60, s[16:19], s60 offen offset:2048 sc1
  s_mov_b64 exec, -1
  s_waitcnt vmcnt(0)
  v_cmp_ne_u64 vcc, s[30:31], v[130:131]
  v_cmp_ne_u64 s[20:21], s[30:31], v[134:135]
  v_cmp_ne_u64 s[22:23], s[30:31], v[138:139]
  s_or_b64 vcc, vcc, s[20:21]
  s_or_b64 vcc, vcc, s[22:23]
  s_nop 0
  s_cbranch_vccz L_sdone_96
  s_and_b32 s99, s70, 7
  s_cmp_eq_u32 s46, 1
  s_cselect_b32 s99, 1, s99
  s_cmp_lg_u32 s99, 0
  s_cselect_b32 s16, s32, s24
  s_cselect_b32 s17, s33, s25
  s_sub_u32 s70, s70, 1
  s_cbranch_scc0 L_spin_95
L_sdone_96:
  s_branch L_pok_93
L_codeend:
.section .rodata,"a"
.p2align 6
.amdhsa_kernel sequential_preLN__sliding_block_cached__glu_gated_swiglu__decode_kernel
  .amdhsa_next_free_vgpr 168
  .amdhsa_next_free_sgpr 100
  .amdhsa_accum_offset 168
  .amdhsa_group_segment_fixed_size 0
  .amdhsa_kernarg_size 96
  .amdhsa_user_sgpr_count 2
  .amdhsa_user_sgpr_kernarg_segment_ptr 1
  .amdhsa_system_sgpr_workgroup_id_x 1
.end_amdhsa_kernel
```

```asm
; @launch grid=(256,1,1) block=(768,1,1) lds=64000
.amdgcn_target "amdgcn-amd-amdhsa--gfx950"
.text
.globl sequential_preLN__sliding_block_cached__glu_gated_swiglu__decode_kernel
.p2align 8
.type sequential_preLN__sliding_block_cached__glu_gated_swiglu__decode_kernel,@function
sequential_preLN__sliding_block_cached__glu_gated_swiglu__decode_kernel:
  s_load_dwordx2 s[8:9], s[0:1], 8
  v_readfirstlane_b32 s3, v0
  s_lshr_b32 s79, s2, 6
  s_cmp_gt_u32 s79, 3
  s_cbranch_scc1 L_end
  s_lshr_b32 s3, s3, 6
  s_cmp_gt_u32 s3, 3
  s_cbranch_scc1 L_str
  s_getpc_b64 s[20:21]
L_pc0:
  v_lshlrev_b32 v8, 7, v0
  v_min_u32 v8, L_codeend-L_pc0-4, v8
  global_load_dword v166, v8, s[20:21]
  s_branch L_helper0
L_str:
  s_and_b32 s4, s2, 7
  s_lshr_b32 s6, s2, 7
  s_bfe_u32 s7, s2, 0x40003
  s_lshl1_add_u32 s6, s4, s6
  s_lshl_b32 s6, s6, 10
  s_lshl1_add_u32 s64, s7, s6
  s_addk_i32 s64, 17279
  s_mulk_i32 s64, 12288
  v_lshlrev_b32 v3, 4, v0
  v_lshrrev_b32 v2, 3, v0
  v_lshl_add_u32 v1, v2, 8, v3
  s_lshl_b32 s10, 3, 27
  s_mov_b32 s11, 0x20000
  s_waitcnt lgkmcnt(0)
  buffer_load_dwordx4 v[64:67], v1, s[8:11], s64 offen offset:0 nt
  buffer_load_dwordx4 v[68:71], v1, s[8:11], s64 offen offset:128 nt
  buffer_load_dwordx4 v[72:75], v1, s[8:11], s64 offen offset:256 nt
  s_branch L_stream0
L_helper0:
  s_load_dwordx16 s[36:51], s[0:1], 0
  s_load_dwordx8 s[52:59], s[0:1], 64
  s_and_b32 s4, s2, 7
  s_lshl2_add_u32 s6, s4, s79
  s_bfe_u32 s7, s2, 0x30003
  v_and_b32 v0, 63, v0
  s_cmp_lg_u32 s3, 3
  s_cbranch_scc0 L_w3
  v_lshrrev_b32 v2, 3, v0
  v_mul_u32_u24 v2, 12160, v2
  v_lshl_add_u32 v2, v0, 4, v2
  s_mul_i32 s68, s7, 7680
  s_lshr_b32 s69, s79, 1
  s_mul_i32 s69, s69, 14
  s_add_u32 s69, s69, s79
  s_lshl1_add_u32 s69, s4, s69
  s_add_u32 s69, s69, 0
  s_mul_i32 s69, s69, 3
  s_add_u32 s68, s68, s69
  s_add_u32 s68, s68, s3
  s_lshl_b32 s68, s68, 7
  s_lshl_b32 s69, 3, 15
  s_mov_b32 s10, 7864320
  s_mov_b32 s11, 0x20000
  s_waitcnt lgkmcnt(0)
  s_mov_b64 s[8:9], s[42:43]
  buffer_load_dwordx4 v[24:27], v2, s[8:11], s68 offen nt
  s_add_u32 s68, s68, s69
  buffer_load_dwordx4 v[28:31], v2, s[8:11], s68 offen nt
  s_add_u32 s68, s68, s69
  buffer_load_dwordx4 v[32:35], v2, s[8:11], s68 offen nt
  s_add_u32 s68, s68, s69
  buffer_load_dwordx4 v[36:39], v2, s[8:11], s68 offen nt
  s_add_u32 s68, s68, s69
  buffer_load_dwordx4 v[40:43], v2, s[8:11], s68 offen nt
  s_add_u32 s68, s68, s69
  buffer_load_dwordx4 v[44:47], v2, s[8:11], s68 offen nt
  s_add_u32 s68, s68, s69
  buffer_load_dwordx4 v[48:51], v2, s[8:11], s68 offen nt
  s_add_u32 s68, s68, s69
  buffer_load_dwordx4 v[52:55], v2, s[8:11], s68 offen nt
  s_add_u32 s68, s68, s69
  buffer_load_dwordx4 v[56:59], v2, s[8:11], s68 offen nt
  s_add_u32 s68, s68, s69
  buffer_load_dwordx4 v[60:63], v2, s[8:11], s68 offen nt
  s_branch L_helper
L_w3:
  v_lshlrev_b32 v1, 3, v0
  v_mov_b32 v4, 0
  v_mov_b32 v5, 0
  ds_write_b64 v1, v[4:5] offset:384
  s_waitcnt lgkmcnt(0)
  s_memrealtime s[62:63]
  s_barrier
  s_load_dwordx2 s[28:29], s[58:59], 917504
  s_branch L_ids
L_stream0:
  s_load_dwordx16 s[36:51], s[0:1], 0
  s_load_dwordx8 s[52:59], s[0:1], 64
  v_and_b32 v0, 63, v0
  s_sub_u32 s73, s3, 4
  v_and_b32 v3, 0x70, v3
  s_lshl2_add_u32 s6, s4, s79
  s_and_b32 s7, s7, 7
  s_add_u32 s65, s64, 393216
  s_waitcnt lgkmcnt(0)
  s_barrier
  s_waitcnt vmcnt(2)
  buffer_load_dwordx4 v[76:79], v1, s[8:11], s65 offen offset:0 nt
  s_load_dwordx2 s[28:29], s[58:59], 917504
  s_mov_b32 s24, s58
  s_mov_b32 s25, s59
  s_mov_b32 s26, 4194304
  s_mov_b32 s27, 0x20000
  s_add_u32 s32, s58, 4194304
  s_addc_u32 s33, s59, 0
  s_mov_b32 s34, 4194304
  s_mov_b32 s35, 0x20000
  s_lshl3_add_u32 s71, s6, s7
  s_mul_i32 s5, s79, 5
  s_mul_i32 s47, s79, 3
  s_add_u32 s47, s47, 15
  s_cmp_lt_u32 s7, 5
  s_cselect_b32 s5, s5, s47
  s_add_u32 s5, s5, s7
  s_mov_b32 s12, s40
  s_mov_b32 s13, s41
  s_mov_b32 s14, 402653184
  s_mov_b32 s15, 0x20000
  s_waitcnt vmcnt(2)
  buffer_load_dwordx4 v[80:83], v1, s[8:11], s65 offen offset:128 nt
  s_waitcnt vmcnt(2)
  buffer_load_dwordx4 v[84:87], v1, s[8:11], s65 offen offset:256 nt
  s_add_u32 s66, s65, 393216
  s_waitcnt vmcnt(2)
  buffer_load_dwordx4 v[88:91], v1, s[8:11], s66 offen offset:0 nt
  s_waitcnt vmcnt(2)
  buffer_load_dwordx4 v[92:95], v1, s[8:11], s66 offen offset:128 nt
  s_waitcnt vmcnt(2)
  buffer_load_dwordx4 v[96:99], v1, s[8:11], s66 offen offset:256 nt
  s_add_u32 s67, s66, 393216
  s_waitcnt vmcnt(2)
  buffer_load_dwordx4 v[100:103], v1, s[8:11], s67 offen offset:0 nt
  s_waitcnt vmcnt(2)
  buffer_load_dwordx4 v[104:107], v1, s[8:11], s67 offen offset:128 nt
  s_waitcnt vmcnt(2)
  buffer_load_dwordx4 v[108:111], v1, s[8:11], s67 offen offset:256 nt
  s_add_u32 s60, s67, 4092461056
  s_waitcnt vmcnt(2)
  buffer_load_dwordx4 v[16:19], v1, s[8:11], s60 offen offset:0 nt
  s_waitcnt vmcnt(2)
  buffer_load_dwordx4 v[20:23], v1, s[8:11], s60 offen offset:128 nt
  s_waitcnt vmcnt(2)
  buffer_load_dwordx4 v[24:27], v1, s[8:11], s60 offen offset:256 nt
  s_add_u32 s61, s60, 393216
  s_waitcnt vmcnt(2)
  buffer_load_dwordx4 v[28:31], v1, s[8:11], s61 offen offset:0 nt
  s_waitcnt vmcnt(2)
  buffer_load_dwordx4 v[32:35], v1, s[8:11], s61 offen offset:128 nt
  s_waitcnt vmcnt(2)
  buffer_load_dwordx4 v[36:39], v1, s[8:11], s61 offen offset:256 nt
  s_memrealtime s[76:77]
  s_waitcnt lgkmcnt(0)
  v_mov_b32 v6, 0
  v_mov_b32 v8, s76
  v_mov_b32 v9, 1
  s_mov_b64 exec, 1
  ds_add_u32 v6, v8 offset:696
  ds_add_u32 v6, v9 offset:700
  s_mov_b64 exec, -1
  s_add_u32 s62, s61, 393216
  s_waitcnt vmcnt(2)
  buffer_load_dwordx4 v[40:43], v1, s[8:11], s62 offen offset:0 nt
  s_waitcnt vmcnt(2)
  buffer_load_dwordx4 v[44:47], v1, s[8:11], s62 offen offset:128 nt
  s_waitcnt vmcnt(2)
  buffer_load_dwordx4 v[48:51], v1, s[8:11], s62 offen offset:256 nt
  s_add_u32 s63, s62, 393216
  s_waitcnt vmcnt(2)
  buffer_load_dwordx4 v[52:55], v1, s[8:11], s63 offen offset:0 nt
  s_waitcnt vmcnt(2)
  buffer_load_dwordx4 v[56:59], v1, s[8:11], s63 offen offset:128 nt
  s_waitcnt vmcnt(2)
  buffer_load_dwordx4 v[60:63], v1, s[8:11], s63 offen offset:256 nt
  s_waitcnt vmcnt(2)
  buffer_load_dwordx4 v[112:115], v1, s[12:15], s60 offen offset:0 nt
  s_waitcnt vmcnt(2)
  buffer_load_dwordx4 v[116:119], v1, s[12:15], s60 offen offset:128 nt
  s_waitcnt vmcnt(2)
  buffer_load_dwordx4 v[120:123], v1, s[12:15], s60 offen offset:256 nt
  v_mov_b32 v6, 0
  v_mov_b32 v7, 1
  s_mov_b64 exec, 1
  ds_add_u32 v6, v7 offset:692
  s_mov_b64 exec, -1
  s_waitcnt lgkmcnt(0)
  s_mul_i32 s30, s28, 0x2c9277b5
  s_add_u32 s30, s30, 0xac564b05
  s_mul_i32 s31, s29, 0x0019660d
  s_add_u32 s31, s31, 0x3c6ef35f
  v_and_b32 v2, 3, v0
  v_min_u32 v2, 2, v2
  v_lshlrev_b32 v2, 3, v2
  s_mov_b32 s70, 4000007
L_spin_1:
  ds_read_b32 v4, v2 offset:384
  s_waitcnt lgkmcnt(0)
  v_cmp_eq_u32 vcc, 0, v4
  s_nop 0
  s_cbranch_vccz L_sdone_2
  s_sleep 1
  s_sub_u32 s70, s70, 1
  s_cbranch_scc0 L_spin_1
L_sdone_2:
  ds_read_b128 v[4:7], v3 offset:0
  ds_read_b128 v[8:11], v3 offset:128
  ds_read_b128 v[12:15], v3 offset:256
  ds_read_b128 v[148:151], v3 offset:8192
  ds_read_b128 v[152:155], v3 offset:8320
  ds_read_b128 v[156:159], v3 offset:8448
  v_mov_b32 v160, 0
  v_mov_b32 v161, 0
  v_mov_b32 v162, 0
  v_mov_b32 v163, 0
  v_mov_b32 v164, 0
  v_mov_b32 v165, 0
  v_mov_b32 v166, 0
  v_mov_b32 v167, 0
  s_waitcnt vmcnt(3) lgkmcnt(0)
  v_dot2c_f32_bf16 v160, v16, v4
  v_dot2c_f32_bf16 v161, v28, v4
  v_dot2c_f32_bf16 v162, v40, v4
  v_dot2c_f32_bf16 v163, v52, v4
  v_dot2c_f32_bf16 v160, v17, v5
  v_dot2c_f32_bf16 v161, v29, v5
  v_dot2c_f32_bf16 v162, v41, v5
  v_dot2c_f32_bf16 v163, v53, v5
  v_dot2c_f32_bf16 v160, v18, v6
  v_dot2c_f32_bf16 v161, v30, v6
  v_dot2c_f32_bf16 v162, v42, v6
  v_dot2c_f32_bf16 v163, v54, v6
  v_dot2c_f32_bf16 v160, v19, v7
  v_dot2c_f32_bf16 v161, v31, v7
  v_dot2c_f32_bf16 v162, v43, v7
  v_dot2c_f32_bf16 v163, v55, v7
  v_dot2c_f32_bf16 v160, v20, v8
  v_dot2c_f32_bf16 v161, v32, v8
  v_dot2c_f32_bf16 v162, v44, v8
  v_dot2c_f32_bf16 v163, v56, v8
  v_dot2c_f32_bf16 v160, v21, v9
  v_dot2c_f32_bf16 v161, v33, v9
  v_dot2c_f32_bf16 v162, v45, v9
  v_dot2c_f32_bf16 v163, v57, v9
  v_dot2c_f32_bf16 v160, v22, v10
  v_dot2c_f32_bf16 v161, v34, v10
  v_dot2c_f32_bf16 v162, v46, v10
  v_dot2c_f32_bf16 v163, v58, v10
  v_dot2c_f32_bf16 v160, v23, v11
  v_dot2c_f32_bf16 v161, v35, v11
  v_dot2c_f32_bf16 v162, v47, v11
  v_dot2c_f32_bf16 v163, v59, v11
  v_dot2c_f32_bf16 v160, v24, v12
  v_dot2c_f32_bf16 v161, v36, v12
  v_dot2c_f32_bf16 v162, v48, v12
  v_dot2c_f32_bf16 v163, v60, v12
  v_dot2c_f32_bf16 v160, v25, v13
  v_dot2c_f32_bf16 v161, v37, v13
  v_dot2c_f32_bf16 v162, v49, v13
  v_dot2c_f32_bf16 v163, v61, v13
  v_dot2c_f32_bf16 v160, v26, v14
  v_dot2c_f32_bf16 v161, v38, v14
  v_dot2c_f32_bf16 v162, v50, v14
  v_dot2c_f32_bf16 v163, v62, v14
  v_dot2c_f32_bf16 v160, v27, v15
  v_dot2c_f32_bf16 v161, v39, v15
  v_dot2c_f32_bf16 v162, v51, v15
  v_dot2c_f32_bf16 v163, v63, v15
  v_dot2c_f32_bf16 v164, v64, v148
  v_dot2c_f32_bf16 v165, v76, v148
  v_dot2c_f32_bf16 v166, v88, v148
  v_dot2c_f32_bf16 v167, v100, v148
  v_dot2c_f32_bf16 v164, v65, v149
  v_dot2c_f32_bf16 v165, v77, v149
  v_dot2c_f32_bf16 v166, v89, v149
  v_dot2c_f32_bf16 v167, v101, v149
  v_dot2c_f32_bf16 v164, v66, v150
  v_dot2c_f32_bf16 v165, v78, v150
  v_dot2c_f32_bf16 v166, v90, v150
  v_dot2c_f32_bf16 v167, v102, v150
  v_dot2c_f32_bf16 v164, v67, v151
  v_dot2c_f32_bf16 v165, v79, v151
  v_dot2c_f32_bf16 v166, v91, v151
  v_dot2c_f32_bf16 v167, v103, v151
  v_dot2c_f32_bf16 v164, v68, v152
  v_dot2c_f32_bf16 v165, v80, v152
  v_dot2c_f32_bf16 v166, v92, v152
  v_dot2c_f32_bf16 v167, v104, v152
  v_dot2c_f32_bf16 v164, v69, v153
  v_dot2c_f32_bf16 v165, v81, v153
  v_dot2c_f32_bf16 v166, v93, v153
  v_dot2c_f32_bf16 v167, v105, v153
  v_dot2c_f32_bf16 v164, v70, v154
  v_dot2c_f32_bf16 v165, v82, v154
  v_dot2c_f32_bf16 v166, v94, v154
  v_dot2c_f32_bf16 v167, v106, v154
  v_dot2c_f32_bf16 v164, v71, v155
  v_dot2c_f32_bf16 v165, v83, v155
  v_dot2c_f32_bf16 v166, v95, v155
  v_dot2c_f32_bf16 v167, v107, v155
  v_dot2c_f32_bf16 v164, v72, v156
  v_dot2c_f32_bf16 v165, v84, v156
  v_dot2c_f32_bf16 v166, v96, v156
  v_dot2c_f32_bf16 v167, v108, v156
  v_dot2c_f32_bf16 v164, v73, v157
  v_dot2c_f32_bf16 v165, v85, v157
  v_dot2c_f32_bf16 v166, v97, v157
  v_dot2c_f32_bf16 v167, v109, v157
  v_dot2c_f32_bf16 v164, v74, v158
  v_dot2c_f32_bf16 v165, v86, v158
  v_dot2c_f32_bf16 v166, v98, v158
  v_dot2c_f32_bf16 v167, v110, v158
  v_dot2c_f32_bf16 v164, v75, v159
  v_dot2c_f32_bf16 v165, v87, v159
  v_dot2c_f32_bf16 v166, v99, v159
  v_dot2c_f32_bf16 v167, v111, v159
  v_add_f32_dpp v160, v160, v160 quad_perm:[1,0,3,2] row_mask:0xf bank_mask:0xf
  v_add_f32_dpp v161, v161, v161 quad_perm:[1,0,3,2] row_mask:0xf bank_mask:0xf
  v_add_f32_dpp v162, v162, v162 quad_perm:[1,0,3,2] row_mask:0xf bank_mask:0xf
  v_add_f32_dpp v163, v163, v163 quad_perm:[1,0,3,2] row_mask:0xf bank_mask:0xf
  v_add_f32_dpp v164, v164, v164 quad_perm:[1,0,3,2] row_mask:0xf bank_mask:0xf
  v_add_f32_dpp v165, v165, v165 quad_perm:[1,0,3,2] row_mask:0xf bank_mask:0xf
  v_add_f32_dpp v166, v166, v166 quad_perm:[1,0,3,2] row_mask:0xf bank_mask:0xf
  v_add_f32_dpp v167, v167, v167 quad_perm:[1,0,3,2] row_mask:0xf bank_mask:0xf
  v_add_f32_dpp v160, v160, v160 quad_perm:[2,3,0,1] row_mask:0xf bank_mask:0xf
  v_add_f32_dpp v161, v161, v161 quad_perm:[2,3,0,1] row_mask:0xf bank_mask:0xf
  v_add_f32_dpp v162, v162, v162 quad_perm:[2,3,0,1] row_mask:0xf bank_mask:0xf
  v_add_f32_dpp v163, v163, v163 quad_perm:[2,3,0,1] row_mask:0xf bank_mask:0xf
  v_add_f32_dpp v164, v164, v164 quad_perm:[2,3,0,1] row_mask:0xf bank_mask:0xf
  v_add_f32_dpp v165, v165, v165 quad_perm:[2,3,0,1] row_mask:0xf bank_mask:0xf
  v_add_f32_dpp v166, v166, v166 quad_perm:[2,3,0,1] row_mask:0xf bank_mask:0xf
  v_add_f32_dpp v167, v167, v167 quad_perm:[2,3,0,1] row_mask:0xf bank_mask:0xf
  v_add_f32_dpp v160, v160, v160 row_half_mirror row_mask:0xf bank_mask:0xf
  v_add_f32_dpp v161, v161, v161 row_half_mirror row_mask:0xf bank_mask:0xf
  v_add_f32_dpp v162, v162, v162 row_half_mirror row_mask:0xf bank_mask:0xf
  v_add_f32_dpp v163, v163, v163 row_half_mirror row_mask:0xf bank_mask:0xf
  v_add_f32_dpp v164, v164, v164 row_half_mirror row_mask:0xf bank_mask:0xf
  v_add_f32_dpp v165, v165, v165 row_half_mirror row_mask:0xf bank_mask:0xf
  v_add_f32_dpp v166, v166, v166 row_half_mirror row_mask:0xf bank_mask:0xf
  v_add_f32_dpp v167, v167, v167 row_half_mirror row_mask:0xf bank_mask:0xf
  s_mov_b32 s68, 0x3d93cd3a
  v_mov_b32 v2, 0
  v_cvt_pk_bf16_f32 v160, v2, v160
  v_cvt_pk_bf16_f32 v161, v2, v161
  v_cvt_pk_bf16_f32 v162, v2, v162
  v_cvt_pk_bf16_f32 v163, v2, v163
  v_cvt_pk_bf16_f32 v164, v2, v164
  v_cvt_pk_bf16_f32 v165, v2, v165
  v_cvt_pk_bf16_f32 v166, v2, v166
  v_cvt_pk_bf16_f32 v167, v2, v167
  v_mul_f32 v160, s68, v160
  v_mul_f32 v161, s68, v161
  v_mul_f32 v162, s68, v162
  v_mul_f32 v163, s68, v163
  v_mul_f32 v164, s68, v164
  v_mul_f32 v165, s68, v165
  v_mul_f32 v166, s68, v166
  v_mul_f32 v167, s68, v167
  v_cvt_pk_bf16_f32 v160, v2, v160
  v_cvt_pk_bf16_f32 v161, v2, v161
  v_cvt_pk_bf16_f32 v162, v2, v162
  v_cvt_pk_bf16_f32 v163, v2, v163
  v_cvt_pk_bf16_f32 v164, v2, v164
  v_cvt_pk_bf16_f32 v165, v2, v165
  v_cvt_pk_bf16_f32 v166, v2, v166
  v_cvt_pk_bf16_f32 v167, v2, v167
  v_max_f32 v4, v160, v161
  v_max_f32 v6, v164, v165
  v_max3_f32 v4, v4, v162, v163
  v_max3_f32 v6, v6, v166, v167
  s_nop 0
  v_max_f32_dpp v4, v4, v4 row_ror:8 row_mask:0xf bank_mask:0xf
  v_max_f32_dpp v6, v6, v6 row_ror:8 row_mask:0xf bank_mask:0xf
  v_mov_b32 v88, v4
  v_mov_b32 v89, v6
  s_nop 0
  v_permlane16_swap_b32 v4, v88
  v_permlane16_swap_b32 v6, v89
  v_max_f32 v4, v4, v88
  v_max_f32 v6, v6, v89
  v_mov_b32 v88, v4
  v_mov_b32 v89, v6
  s_nop 0
  v_permlane32_swap_b32 v4, v88
  v_permlane32_swap_b32 v6, v89
  v_max_f32 v4, v4, v88
  v_max_f32 v6, v6, v89
  s_mov_b32 s68, 0x3fb8aa3b
  v_sub_f32 v160, v160, v4
  v_sub_f32 v161, v161, v4
  v_sub_f32 v162, v162, v4
  v_sub_f32 v163, v163, v4
  v_sub_f32 v164, v164, v6
  v_sub_f32 v165, v165, v6
  v_sub_f32 v166, v166, v6
  v_sub_f32 v167, v167, v6
  v_mul_f32 v160, s68, v160
  v_mul_f32 v161, s68, v161
  v_mul_f32 v162, s68, v162
  v_mul_f32 v163, s68, v163
  v_mul_f32 v164, s68, v164
  v_mul_f32 v165, s68, v165
  v_mul_f32 v166, s68, v166
  v_mul_f32 v167, s68, v167
  v_exp_f32 v160, v160
  v_exp_f32 v161, v161
  v_exp_f32 v162, v162
  v_exp_f32 v163, v163
  v_exp_f32 v164, v164
  v_exp_f32 v165, v165
  v_exp_f32 v166, v166
  v_exp_f32 v167, v167
  v_add_f32 v5, v160, v161
  v_add_f32 v7, v164, v165
  v_add_f32 v5, v5, v162
  v_add_f32 v7, v7, v166
  v_add_f32 v5, v5, v163
  v_add_f32 v7, v7, v167
  s_nop 0
  v_add_f32_dpp v5, v5, v5 row_ror:8 row_mask:0xf bank_mask:0xf
  v_add_f32_dpp v7, v7, v7 row_ror:8 row_mask:0xf bank_mask:0xf
  v_mov_b32 v88, v5
  v_mov_b32 v89, v7
  s_nop 0
  v_permlane16_swap_b32 v5, v88
  v_permlane16_swap_b32 v7, v89
  v_add_f32 v5, v5, v88
  v_add_f32 v7, v7, v89
  v_mov_b32 v88, v5
  v_mov_b32 v89, v7
  s_nop 0
  v_permlane32_swap_b32 v5, v88
  v_permlane32_swap_b32 v7, v89
  v_add_f32 v5, v5, v88
  v_add_f32 v7, v7, v89
  s_lshl_b32 s69, s73, 4
  v_mov_b32 v88, s69
  ds_write_b128 v88, v[4:7] offset:512
  v_cvt_pk_bf16_f32 v160, v160, v2
  v_cvt_pk_bf16_f32 v161, v161, v2
  v_cvt_pk_bf16_f32 v162, v162, v2
  v_cvt_pk_bf16_f32 v163, v163, v2
  v_cvt_pk_bf16_f32 v164, v164, v2
  v_cvt_pk_bf16_f32 v165, v165, v2
  v_cvt_pk_bf16_f32 v166, v166, v2
  v_cvt_pk_bf16_f32 v167, v167, v2
  v_mov_b32 v64, 0
  v_mov_b32 v65, 0
  v_mov_b32 v66, 0
  v_mov_b32 v67, 0
  v_mov_b32 v68, 0
  v_mov_b32 v69, 0
  v_mov_b32 v70, 0
  v_mov_b32 v71, 0
  v_mov_b32 v72, 0
  v_mov_b32 v73, 0
  v_mov_b32 v74, 0
  v_mov_b32 v75, 0
  v_mov_b32 v76, 0
  v_mov_b32 v77, 0
  v_mov_b32 v78, 0
  v_mov_b32 v79, 0
  v_mov_b32 v80, 0
  v_mov_b32 v81, 0
  v_mov_b32 v82, 0
  v_mov_b32 v83, 0
  v_mov_b32 v84, 0
  v_mov_b32 v85, 0
  v_mov_b32 v86, 0
  v_mov_b32 v87, 0
  v_mov_b32 v88, 0
  v_mov_b32 v89, 0
  v_mov_b32 v90, 0
  v_mov_b32 v91, 0
  v_mov_b32 v92, 0
  v_mov_b32 v93, 0
  v_mov_b32 v94, 0
  v_mov_b32 v95, 0
  v_mov_b32 v96, 0
  v_mov_b32 v97, 0
  v_mov_b32 v98, 0
  v_mov_b32 v99, 0
  v_mov_b32 v100, 0
  v_mov_b32 v101, 0
  v_mov_b32 v102, 0
  v_mov_b32 v103, 0
  v_mov_b32 v104, 0
  v_mov_b32 v105, 0
  v_mov_b32 v106, 0
  v_mov_b32 v107, 0
  v_mov_b32 v108, 0
  v_mov_b32 v109, 0
  v_mov_b32 v110, 0
  v_mov_b32 v111, 0
  v_mov_b32 v5, v6
  v_and_b32 v8, 7, v0
  v_lshlrev_b32 v8, 5, v8
  v_lshrrev_b32 v9, 4, v0
  v_lshl_add_u32 v8, v9, 3, v8
  s_mul_i32 s69, s73, 768
  v_add_u32 v8, s69, v8
  v_mov_b32 v11, 1
  s_waitcnt vmcnt(2)
  buffer_load_dwordx4 v[124:127], v1, s[12:15], s61 offen offset:0 nt
  s_waitcnt vmcnt(2)
  buffer_load_dwordx4 v[128:131], v1, s[12:15], s61 offen offset:128 nt
  v_lshlrev_b32 v10, 16, v160
  v_dot2c_f32_bf16 v64, v112, v160
  v_dot2c_f32_bf16 v65, v112, v10
  v_dot2c_f32_bf16 v66, v113, v160
  v_dot2c_f32_bf16 v67, v113, v10
  v_dot2c_f32_bf16 v68, v114, v160
  v_dot2c_f32_bf16 v69, v114, v10
  v_dot2c_f32_bf16 v70, v115, v160
  v_dot2c_f32_bf16 v71, v115, v10
  s_waitcnt vmcnt(2)
  buffer_load_dwordx4 v[132:135], v1, s[12:15], s61 offen offset:256 nt
  s_memrealtime s[76:77]
  v_mov_b32 v6, 0
  ds_read_b64 v[6:7], v6 offset:680
  s_movk_i32 s79, 457
  s_waitcnt lgkmcnt(0)
  v_readfirstlane_b32 s78, v6
  v_readfirstlane_b32 s72, v7
  s_add_u32 s78, s78, 5484
  v_dot2c_f32_bf16 v72, v116, v160
  v_dot2c_f32_bf16 v73, v116, v10
  v_dot2c_f32_bf16 v74, v117, v160
  v_dot2c_f32_bf16 v75, v117, v10
  v_dot2c_f32_bf16 v76, v118, v160
  v_dot2c_f32_bf16 v77, v118, v10
  v_dot2c_f32_bf16 v78, v119, v160
  v_dot2c_f32_bf16 v79, v119, v10
  s_waitcnt lgkmcnt(0)
  s_lshl_b32 s75, s76, 4
  s_sub_u32 s75, s75, s78
  s_and_b32 s75, s75, s72
  s_add_u32 s78, s78, s79
  s_waitcnt vmcnt(3)
  s_cmp_gt_i32 s75, 480
  s_cbranch_scc1 L_go_3
  s_waitcnt vmcnt(2)
  s_cmp_ge_i32 s75, 0
  s_cbranch_scc1 L_go_3
  s_waitcnt vmcnt(1)
L_go_3:
  buffer_load_dwordx4 v[136:139], v1, s[12:15], s62 offen offset:0 nt
  s_memrealtime s[76:77]
  v_dot2c_f32_bf16 v80, v120, v160
  v_dot2c_f32_bf16 v81, v120, v10
  v_dot2c_f32_bf16 v82, v121, v160
  v_dot2c_f32_bf16 v83, v121, v10
  v_dot2c_f32_bf16 v84, v122, v160
  v_dot2c_f32_bf16 v85, v122, v10
  v_dot2c_f32_bf16 v86, v123, v160
  v_dot2c_f32_bf16 v87, v123, v10
  s_waitcnt lgkmcnt(0)
  s_lshl_b32 s75, s76, 4
  s_sub_u32 s75, s75, s78
  s_and_b32 s75, s75, s72
  s_add_u32 s78, s78, s79
  s_waitcnt vmcnt(3)
  s_cmp_gt_i32 s75, 480
  s_cbranch_scc1 L_go_4
  s_waitcnt vmcnt(2)
  s_cmp_ge_i32 s75, 0
  s_cbranch_scc1 L_go_4
  s_waitcnt vmcnt(1)
L_go_4:
  buffer_load_dwordx4 v[140:143], v1, s[12:15], s62 offen offset:128 nt
  s_memrealtime s[76:77]
  v_lshlrev_b32 v10, 16, v161
  v_dot2c_f32_bf16 v64, v124, v161
  v_dot2c_f32_bf16 v65, v124, v10
  v_dot2c_f32_bf16 v66, v125, v161
  v_dot2c_f32_bf16 v67, v125, v10
  v_dot2c_f32_bf16 v68, v126, v161
  v_dot2c_f32_bf16 v69, v126, v10
  v_dot2c_f32_bf16 v70, v127, v161
  v_dot2c_f32_bf16 v71, v127, v10
  s_waitcnt lgkmcnt(0)
  s_lshl_b32 s75, s76, 4
  s_sub_u32 s75, s75, s78
  s_and_b32 s75, s75, s72
  s_add_u32 s78, s78, s79
  s_waitcnt vmcnt(3)
  s_cmp_gt_i32 s75, 480
  s_cbranch_scc1 L_go_5
  s_waitcnt vmcnt(2)
  s_cmp_ge_i32 s75, 0
  s_cbranch_scc1 L_go_5
  s_waitcnt vmcnt(1)
L_go_5:
  buffer_load_dwordx4 v[144:147], v1, s[12:15], s62 offen offset:256 nt
  s_memrealtime s[76:77]
  v_dot2c_f32_bf16 v72, v128, v161
  v_dot2c_f32_bf16 v73, v128, v10
  v_dot2c_f32_bf16 v74, v129, v161
  v_dot2c_f32_bf16 v75, v129, v10
  v_dot2c_f32_bf16 v76, v130, v161
  v_dot2c_f32_bf16 v77, v130, v10
  v_dot2c_f32_bf16 v78, v131, v161
  v_dot2c_f32_bf16 v79, v131, v10
  s_waitcnt lgkmcnt(0)
  s_lshl_b32 s75, s76, 4
  s_sub_u32 s75, s75, s78
  s_and_b32 s75, s75, s72
  s_add_u32 s78, s78, s79
  s_waitcnt vmcnt(3)
  s_cmp_gt_i32 s75, 480
  s_cbranch_scc1 L_go_6
  s_waitcnt vmcnt(2)
  s_cmp_ge_i32 s75, 0
  s_cbranch_scc1 L_go_6
  s_waitcnt vmcnt(1)
L_go_6:
  buffer_load_dwordx4 v[148:151], v1, s[12:15], s63 offen offset:0 nt
  s_memrealtime s[76:77]
  v_mov_b32 v6, 0
  ds_read_b64 v[6:7], v6 offset:680
  s_movk_i32 s79, 457
  s_waitcnt lgkmcnt(0)
  v_readfirstlane_b32 s78, v6
  v_readfirstlane_b32 s72, v7
  s_add_u32 s78, s78, 7312
  v_dot2c_f32_bf16 v80, v132, v161
  v_dot2c_f32_bf16 v81, v132, v10
  v_dot2c_f32_bf16 v82, v133, v161
  v_dot2c_f32_bf16 v83, v133, v10
  v_dot2c_f32_bf16 v84, v134, v161
  v_dot2c_f32_bf16 v85, v134, v10
  v_dot2c_f32_bf16 v86, v135, v161
  v_dot2c_f32_bf16 v87, v135, v10
  s_waitcnt lgkmcnt(0)
  s_lshl_b32 s75, s76, 4
  s_sub_u32 s75, s75, s78
  s_and_b32 s75, s75, s72
  s_add_u32 s78, s78, s79
  s_waitcnt vmcnt(3)
  s_cmp_gt_i32 s75, 480
  s_cbranch_scc1 L_go_7
  s_waitcnt vmcnt(2)
  s_cmp_ge_i32 s75, 0
  s_cbranch_scc1 L_go_7
  s_waitcnt vmcnt(1)
L_go_7:
  buffer_load_dwordx4 v[152:155], v1, s[12:15], s63 offen offset:128 nt
  s_memrealtime s[76:77]
  v_lshlrev_b32 v10, 16, v162
  v_dot2c_f32_bf16 v64, v136, v162
  v_dot2c_f32_bf16 v65, v136, v10
  v_dot2c_f32_bf16 v66, v137, v162
  v_dot2c_f32_bf16 v67, v137, v10
  v_dot2c_f32_bf16 v68, v138, v162
  v_dot2c_f32_bf16 v69, v138, v10
  v_dot2c_f32_bf16 v70, v139, v162
  v_dot2c_f32_bf16 v71, v139, v10
  s_waitcnt lgkmcnt(0)
  s_lshl_b32 s75, s76, 4
  s_sub_u32 s75, s75, s78
  s_and_b32 s75, s75, s72
  s_add_u32 s78, s78, s79
  s_waitcnt vmcnt(3)
  s_cmp_gt_i32 s75, 480
  s_cbranch_scc1 L_go_8
  s_waitcnt vmcnt(2)
  s_cmp_ge_i32 s75, 0
  s_cbranch_scc1 L_go_8
  s_waitcnt vmcnt(1)
L_go_8:
  buffer_load_dwordx4 v[156:159], v1, s[12:15], s63 offen offset:256 nt
  s_memrealtime s[76:77]
  v_dot2c_f32_bf16 v72, v140, v162
  v_dot2c_f32_bf16 v73, v140, v10
  v_dot2c_f32_bf16 v74, v141, v162
  v_dot2c_f32_bf16 v75, v141, v10
  v_dot2c_f32_bf16 v76, v142, v162
  v_dot2c_f32_bf16 v77, v142, v10
  v_dot2c_f32_bf16 v78, v143, v162
  v_dot2c_f32_bf16 v79, v143, v10
  s_waitcnt lgkmcnt(0)
  s_lshl_b32 s75, s76, 4
  s_sub_u32 s75, s75, s78
  s_and_b32 s75, s75, s72
  s_add_u32 s78, s78, s79
  s_waitcnt vmcnt(3)
  s_cmp_gt_i32 s75, 480
  s_cbranch_scc1 L_go_9
  s_waitcnt vmcnt(2)
  s_cmp_ge_i32 s75, 0
  s_cbranch_scc1 L_go_9
  s_waitcnt vmcnt(1)
L_go_9:
  buffer_load_dwordx4 v[16:19], v1, s[12:15], s64 offen offset:0 nt
  s_memrealtime s[76:77]
  v_dot2c_f32_bf16 v80, v144, v162
  v_dot2c_f32_bf16 v81, v144, v10
  v_dot2c_f32_bf16 v82, v145, v162
  v_dot2c_f32_bf16 v83, v145, v10
  v_dot2c_f32_bf16 v84, v146, v162
  v_dot2c_f32_bf16 v85, v146, v10
  v_dot2c_f32_bf16 v86, v147, v162
  v_dot2c_f32_bf16 v87, v147, v10
  s_waitcnt lgkmcnt(0)
  s_lshl_b32 s75, s76, 4
  s_sub_u32 s75, s75, s78
  s_and_b32 s75, s75, s72
  s_add_u32 s78, s78, s79
  s_waitcnt vmcnt(3)
  s_cmp_gt_i32 s75, 480
  s_cbranch_scc1 L_go_10
  s_waitcnt vmcnt(2)
  s_cmp_ge_i32 s75, 0
  s_cbranch_scc1 L_go_10
  s_waitcnt vmcnt(1)
L_go_10:
  buffer_load_dwordx4 v[20:23], v1, s[12:15], s64 offen offset:128 nt
  s_memrealtime s[76:77]
  v_lshlrev_b32 v10, 16, v163
  s_mov_b32 s70, 4000007
L_spin_11:
  ds_read_b128 v[12:15], v3 offset:512
  s_waitcnt lgkmcnt(0)
  v_cmp_eq_u32 vcc, 0, v15
  s_nop 0
  s_cbranch_vccz L_sdone_12
  s_sleep 1
  s_sub_u32 s70, s70, 1
  s_cbranch_scc0 L_spin_11
L_sdone_12:
  v_max_f32_dpp v12, v12, v12 quad_perm:[1,0,3,2] row_mask:0xf bank_mask:0xf
  v_max_f32_dpp v14, v14, v14 quad_perm:[1,0,3,2] row_mask:0xf bank_mask:0xf
  s_nop 0
  v_max_f32_dpp v12, v12, v12 quad_perm:[2,3,0,1] row_mask:0xf bank_mask:0xf
  v_max_f32_dpp v14, v14, v14 quad_perm:[2,3,0,1] row_mask:0xf bank_mask:0xf
  s_nop 0
  v_max_f32_dpp v12, v12, v12 row_half_mirror row_mask:0xf bank_mask:0xf
  v_max_f32_dpp v14, v14, v14 row_half_mirror row_mask:0xf bank_mask:0xf
  v_sub_f32 v4, v4, v12
  v_sub_f32 v5, v5, v14
  v_mul_f32 v4, s68, v4
  v_mul_f32 v5, s68, v5
  v_exp_f32 v4, v4
  v_exp_f32 v5, v5
  v_mov_b32 v2, 0
  s_mov_b32 s70, 4000007
L_spin_13:
  ds_read_b32 v13, v2 offset:648
  s_waitcnt lgkmcnt(0)
  v_cmp_gt_u32 vcc, 1, v13
  s_nop 0
  s_cbranch_vccz L_sdone_14
  s_sleep 2
  s_sub_u32 s70, s70, 1
  s_cbranch_scc0 L_spin_13
L_sdone_14:
  v_readfirstlane_b32 s46, v13
  v_min_u32 v12, 47, v0
  v_lshrrev_b32 v13, 3, v12
  v_lshlrev_b32 v13, 11, v13
  v_and_b32 v14, 1, v12
  v_lshl_add_u32 v13, v14, 10, v13
  v_bfe_u32 v14, v12, 1, 2
  v_lshl_add_u32 v13, v14, 8, v13
  v_lshlrev_b32 v12, 4, v12
  s_lshr_b32 s74, s2, 7
  s_lshl2_add_u32 s74, s4, s74
  s_mul_i32 s74, s74, 12288
  s_bfe_u32 s69, s2, 0x40003
  s_lshl4_add_u32 s74, s69, s74
  s_add_u32 s74, s74, 548864
  s_mov_b32 s22, 0x55555555
  s_mov_b32 s23, 0x55555555
  v_mov_b32 v14, s30
  v_mov_b32 v15, s31
  v_dot2c_f32_bf16 v64, v148, v163
  v_dot2c_f32_bf16 v65, v148, v10
  v_dot2c_f32_bf16 v66, v149, v163
  v_dot2c_f32_bf16 v67, v149, v10
  v_dot2c_f32_bf16 v68, v150, v163
  v_dot2c_f32_bf16 v69, v150, v10
  v_dot2c_f32_bf16 v70, v151, v163
  v_dot2c_f32_bf16 v71, v151, v10
  v_permlane32_swap_b32 v64, v68
  v_permlane32_swap_b32 v65, v69
  v_permlane32_swap_b32 v66, v70
  v_permlane32_swap_b32 v67, v71
  v_add_f32 v64, v64, v68
  v_add_f32 v65, v65, v69
  v_add_f32 v66, v66, v70
  v_add_f32 v67, v67, v71
  s_nop 0
  v_permlane16_swap_b32 v64, v66
  v_permlane16_swap_b32 v65, v67
  v_add_f32 v64, v64, v66
  v_add_f32 v65, v65, v67
  s_nop 0
  v_add_f32_dpp v64, v64, v64 row_ror:8 row_mask:0xf bank_mask:0xf
  v_add_f32_dpp v65, v65, v65 row_ror:8 row_mask:0xf bank_mask:0xf
  v_mul_f32 v64, v4, v64
  v_mul_f32 v65, v4, v65
  ds_write_b64 v8, v[64:65] offset:57856
  s_waitcnt lgkmcnt(0)
  s_lshl_b32 s75, s76, 4
  s_sub_u32 s75, s75, s78
  s_and_b32 s75, s75, s72
  s_add_u32 s78, s78, s79
  s_waitcnt vmcnt(3)
  s_cmp_gt_i32 s75, 480
  s_cbranch_scc1 L_go_15
  s_waitcnt vmcnt(2)
  s_cmp_ge_i32 s75, 0
  s_cbranch_scc1 L_go_15
  s_waitcnt vmcnt(1)
L_go_15:
  buffer_load_dwordx4 v[24:27], v1, s[12:15], s64 offen offset:256 nt
  s_memrealtime s[76:77]
  v_dot2c_f32_bf16 v72, v152, v163
  v_dot2c_f32_bf16 v73, v152, v10
  v_dot2c_f32_bf16 v74, v153, v163
  v_dot2c_f32_bf16 v75, v153, v10
  v_dot2c_f32_bf16 v76, v154, v163
  v_dot2c_f32_bf16 v77, v154, v10
  v_dot2c_f32_bf16 v78, v155, v163
  v_dot2c_f32_bf16 v79, v155, v10
  v_permlane32_swap_b32 v72, v76
  v_permlane32_swap_b32 v73, v77
  v_permlane32_swap_b32 v74, v78
  v_permlane32_swap_b32 v75, v79
  v_add_f32 v72, v72, v76
  v_add_f32 v73, v73, v77
  v_add_f32 v74, v74, v78
  v_add_f32 v75, v75, v79
  s_nop 0
  v_permlane16_swap_b32 v72, v74
  v_permlane16_swap_b32 v73, v75
  v_add_f32 v72, v72, v74
  v_add_f32 v73, v73, v75
  s_nop 0
  v_add_f32_dpp v72, v72, v72 row_ror:8 row_mask:0xf bank_mask:0xf
  v_add_f32_dpp v73, v73, v73 row_ror:8 row_mask:0xf bank_mask:0xf
  v_mul_f32 v72, v4, v72
  v_mul_f32 v73, v4, v73
  ds_write_b64 v8, v[72:73] offset:58112
  s_waitcnt lgkmcnt(0)
  s_lshl_b32 s75, s76, 4
  s_sub_u32 s75, s75, s78
  s_and_b32 s75, s75, s72
  s_add_u32 s78, s78, s79
  s_waitcnt vmcnt(3)
  s_cmp_gt_i32 s75, 480
  s_cbranch_scc1 L_go_16
  s_waitcnt vmcnt(2)
  s_cmp_ge_i32 s75, 0
  s_cbranch_scc1 L_go_16
  s_waitcnt vmcnt(1)
L_go_16:
  buffer_load_dwordx4 v[28:31], v1, s[12:15], s65 offen offset:0 nt
  s_memrealtime s[76:77]
  v_dot2c_f32_bf16 v80, v156, v163
  v_dot2c_f32_bf16 v81, v156, v10
  v_dot2c_f32_bf16 v82, v157, v163
  v_dot2c_f32_bf16 v83, v157, v10
  v_dot2c_f32_bf16 v84, v158, v163
  v_dot2c_f32_bf16 v85, v158, v10
  v_dot2c_f32_bf16 v86, v159, v163
  v_dot2c_f32_bf16 v87, v159, v10
  v_permlane32_swap_b32 v80, v84
  v_permlane32_swap_b32 v81, v85
  v_permlane32_swap_b32 v82, v86
  v_permlane32_swap_b32 v83, v87
  v_add_f32 v80, v80, v84
  v_add_f32 v81, v81, v85
  v_add_f32 v82, v82, v86
  v_add_f32 v83, v83, v87
  s_nop 0
  v_permlane16_swap_b32 v80, v82
  v_permlane16_swap_b32 v81, v83
  v_add_f32 v80, v80, v82
  v_add_f32 v81, v81, v83
  s_nop 0
  v_add_f32_dpp v80, v80, v80 row_ror:8 row_mask:0xf bank_mask:0xf
  v_add_f32_dpp v81, v81, v81 row_ror:8 row_mask:0xf bank_mask:0xf
  v_mul_f32 v80, v4, v80
  v_mul_f32 v81, v4, v81
  ds_write_b64 v8, v[80:81] offset:58368
  s_mov_b64 exec, 1
  ds_add_u32 v2, v11 offset:652
  s_mov_b64 exec, -1
  s_waitcnt lgkmcnt(0)
  s_lshl_b32 s75, s76, 4
  s_sub_u32 s75, s75, s78
  s_and_b32 s75, s75, s72
  s_add_u32 s78, s78, s79
  s_waitcnt vmcnt(3)
  s_cmp_gt_i32 s75, 480
  s_cbranch_scc1 L_go_17
  s_waitcnt vmcnt(2)
  s_cmp_ge_i32 s75, 0
  s_cbranch_scc1 L_go_17
  s_waitcnt vmcnt(1)
L_go_17:
  buffer_load_dwordx4 v[32:35], v1, s[12:15], s65 offen offset:128 nt
  s_memrealtime s[76:77]
  v_lshlrev_b32 v10, 16, v164
  v_dot2c_f32_bf16 v88, v16, v164
  v_dot2c_f32_bf16 v89, v16, v10
  v_dot2c_f32_bf16 v90, v17, v164
  v_dot2c_f32_bf16 v91, v17, v10
  v_dot2c_f32_bf16 v92, v18, v164
  v_dot2c_f32_bf16 v93, v18, v10
  v_dot2c_f32_bf16 v94, v19, v164
  v_dot2c_f32_bf16 v95, v19, v10
  s_waitcnt lgkmcnt(0)
  s_lshl_b32 s75, s76, 4
  s_sub_u32 s75, s75, s78
  s_and_b32 s75, s75, s72
  s_add_u32 s78, s78, s79
  s_waitcnt vmcnt(3)
  s_cmp_gt_i32 s75, 480
  s_cbranch_scc1 L_go_18
  s_waitcnt vmcnt(2)
  s_cmp_ge_i32 s75, 0
  s_cbranch_scc1 L_go_18
  s_waitcnt vmcnt(1)
L_go_18:
  buffer_load_dwordx4 v[36:39], v1, s[12:15], s65 offen offset:256 nt
  s_memrealtime s[76:77]
  v_dot2c_f32_bf16 v96, v20, v164
  v_dot2c_f32_bf16 v97, v20, v10
  v_dot2c_f32_bf16 v98, v21, v164
  v_dot2c_f32_bf16 v99, v21, v10
  v_dot2c_f32_bf16 v100, v22, v164
  v_dot2c_f32_bf16 v101, v22, v10
  v_dot2c_f32_bf16 v102, v23, v164
  v_dot2c_f32_bf16 v103, v23, v10
  s_waitcnt lgkmcnt(0)
  s_lshl_b32 s75, s76, 4
  s_sub_u32 s75, s75, s78
  s_and_b32 s75, s75, s72
  s_add_u32 s78, s78, s79
  s_waitcnt vmcnt(3)
  s_cmp_gt_i32 s75, 480
  s_cbranch_scc1 L_go_19
  s_waitcnt vmcnt(2)
  s_cmp_ge_i32 s75, 0
  s_cbranch_scc1 L_go_19
  s_waitcnt vmcnt(1)
L_go_19:
  buffer_load_dwordx4 v[40:43], v1, s[12:15], s66 offen offset:0 nt
  s_memrealtime s[76:77]
  v_dot2c_f32_bf16 v104, v24, v164
  v_dot2c_f32_bf16 v105, v24, v10
  v_dot2c_f32_bf16 v106, v25, v164
  v_dot2c_f32_bf16 v107, v25, v10
  v_dot2c_f32_bf16 v108, v26, v164
  v_dot2c_f32_bf16 v109, v26, v10
  v_dot2c_f32_bf16 v110, v27, v164
  v_dot2c_f32_bf16 v111, v27, v10
  s_waitcnt lgkmcnt(0)
  s_lshl_b32 s75, s76, 4
  s_sub_u32 s75, s75, s78
  s_and_b32 s75, s75, s72
  s_add_u32 s78, s78, s79
  s_waitcnt vmcnt(3)
  s_cmp_gt_i32 s75, 480
  s_cbranch_scc1 L_go_20
  s_waitcnt vmcnt(2)
  s_cmp_ge_i32 s75, 0
  s_cbranch_scc1 L_go_20
  s_waitcnt vmcnt(1)
L_go_20:
  buffer_load_dwordx4 v[44:47], v1, s[12:15], s66 offen offset:128 nt
  s_memrealtime s[76:77]
  v_lshlrev_b32 v10, 16, v165
  v_dot2c_f32_bf16 v88, v28, v165
  v_dot2c_f32_bf16 v89, v28, v10
  v_dot2c_f32_bf16 v90, v29, v165
  v_dot2c_f32_bf16 v91, v29, v10
  v_dot2c_f32_bf16 v92, v30, v165
  v_dot2c_f32_bf16 v93, v30, v10
  v_dot2c_f32_bf16 v94, v31, v165
  v_dot2c_f32_bf16 v95, v31, v10
  s_waitcnt lgkmcnt(0)
  s_lshl_b32 s75, s76, 4
  s_sub_u32 s75, s75, s78
  s_and_b32 s75, s75, s72
  s_add_u32 s78, s78, s79
  s_waitcnt vmcnt(3)
  s_cmp_gt_i32 s75, 480
  s_cbranch_scc1 L_go_21
  s_waitcnt vmcnt(2)
  s_cmp_ge_i32 s75, 0
  s_cbranch_scc1 L_go_21
  s_waitcnt vmcnt(1)
L_go_21:
  buffer_load_dwordx4 v[48:51], v1, s[12:15], s66 offen offset:256 nt
  s_memrealtime s[76:77]
  v_dot2c_f32_bf16 v96, v32, v165
  v_dot2c_f32_bf16 v97, v32, v10
  v_dot2c_f32_bf16 v98, v33, v165
  v_dot2c_f32_bf16 v99, v33, v10
  v_dot2c_f32_bf16 v100, v34, v165
  v_dot2c_f32_bf16 v101, v34, v10
  v_dot2c_f32_bf16 v102, v35, v165
  v_dot2c_f32_bf16 v103, v35, v10
  s_waitcnt lgkmcnt(0)
  s_lshl_b32 s75, s76, 4
  s_sub_u32 s75, s75, s78
  s_and_b32 s75, s75, s72
  s_add_u32 s78, s78, s79
  s_waitcnt vmcnt(3)
  s_cmp_gt_i32 s75, 480
  s_cbranch_scc1 L_go_22
  s_waitcnt vmcnt(2)
  s_cmp_ge_i32 s75, 0
  s_cbranch_scc1 L_go_22
  s_waitcnt vmcnt(1)
L_go_22:
  buffer_load_dwordx4 v[52:55], v1, s[12:15], s67 offen offset:0 nt
  s_memrealtime s[76:77]
  s_mov_b64 exec, 1
  ds_add_u32 v2, v11 offset:644
  s_mov_b64 exec, -1
  v_dot2c_f32_bf16 v104, v36, v165
  v_dot2c_f32_bf16 v105, v36, v10
  v_dot2c_f32_bf16 v106, v37, v165
  v_dot2c_f32_bf16 v107, v37, v10
  v_dot2c_f32_bf16 v108, v38, v165
  v_dot2c_f32_bf16 v109, v38, v10
  v_dot2c_f32_bf16 v110, v39, v165
  v_dot2c_f32_bf16 v111, v39, v10
  s_waitcnt lgkmcnt(0)
  s_lshl_b32 s75, s76, 4
  s_sub_u32 s75, s75, s78
  s_and_b32 s75, s75, s72
  s_add_u32 s78, s78, s79
  s_waitcnt vmcnt(3)
  s_cmp_gt_i32 s75, 480
  s_cbranch_scc1 L_go_23
  s_waitcnt vmcnt(2)
  s_cmp_ge_i32 s75, 0
  s_cbranch_scc1 L_go_23
  s_waitcnt vmcnt(1)
L_go_23:
  buffer_load_dwordx4 v[56:59], v1, s[12:15], s67 offen offset:128 nt
  s_memrealtime s[76:77]
  v_lshlrev_b32 v10, 16, v166
  v_dot2c_f32_bf16 v88, v40, v166
  v_dot2c_f32_bf16 v89, v40, v10
  v_dot2c_f32_bf16 v90, v41, v166
  v_dot2c_f32_bf16 v91, v41, v10
  v_dot2c_f32_bf16 v92, v42, v166
  v_dot2c_f32_bf16 v93, v42, v10
  v_dot2c_f32_bf16 v94, v43, v166
  v_dot2c_f32_bf16 v95, v43, v10
  s_waitcnt lgkmcnt(0)
  s_lshl_b32 s75, s76, 4
  s_sub_u32 s75, s75, s78
  s_and_b32 s75, s75, s72
  s_add_u32 s78, s78, s79
  s_waitcnt vmcnt(3)
  s_cmp_gt_i32 s75, 480
  s_cbranch_scc1 L_go_24
  s_waitcnt vmcnt(2)
  s_cmp_ge_i32 s75, 0
  s_cbranch_scc1 L_go_24
  s_waitcnt vmcnt(1)
L_go_24:
  buffer_load_dwordx4 v[60:63], v1, s[12:15], s67 offen offset:256 nt
  v_dot2c_f32_bf16 v96, v44, v166
  v_dot2c_f32_bf16 v97, v44, v10
  v_dot2c_f32_bf16 v98, v45, v166
  v_dot2c_f32_bf16 v99, v45, v10
  v_dot2c_f32_bf16 v100, v46, v166
  v_dot2c_f32_bf16 v101, v46, v10
  v_dot2c_f32_bf16 v102, v47, v166
  v_dot2c_f32_bf16 v103, v47, v10
  s_waitcnt vmcnt(3)
  v_dot2c_f32_bf16 v104, v48, v166
  v_dot2c_f32_bf16 v105, v48, v10
  v_dot2c_f32_bf16 v106, v49, v166
  v_dot2c_f32_bf16 v107, v49, v10
  v_dot2c_f32_bf16 v108, v50, v166
  v_dot2c_f32_bf16 v109, v50, v10
  v_dot2c_f32_bf16 v110, v51, v166
  v_dot2c_f32_bf16 v111, v51, v10
  s_waitcnt vmcnt(2)
  v_lshlrev_b32 v10, 16, v167
  v_dot2c_f32_bf16 v88, v52, v167
  v_dot2c_f32_bf16 v89, v52, v10
  v_dot2c_f32_bf16 v90, v53, v167
  v_dot2c_f32_bf16 v91, v53, v10
  v_dot2c_f32_bf16 v92, v54, v167
  v_dot2c_f32_bf16 v93, v54, v10
  v_dot2c_f32_bf16 v94, v55, v167
  v_dot2c_f32_bf16 v95, v55, v10
  v_permlane32_swap_b32 v88, v92
  v_permlane32_swap_b32 v89, v93
  v_permlane32_swap_b32 v90, v94
  v_permlane32_swap_b32 v91, v95
  v_add_f32 v88, v88, v92
  v_add_f32 v89, v89, v93
  v_add_f32 v90, v90, v94
  v_add_f32 v91, v91, v95
  s_nop 0
  v_permlane16_swap_b32 v88, v90
  v_permlane16_swap_b32 v89, v91
  v_add_f32 v88, v88, v90
  v_add_f32 v89, v89, v91
  s_nop 0
  v_add_f32_dpp v88, v88, v88 row_ror:8 row_mask:0xf bank_mask:0xf
  v_add_f32_dpp v89, v89, v89 row_ror:8 row_mask:0xf bank_mask:0xf
  v_mul_f32 v88, v5, v88
  v_mul_f32 v89, v5, v89
  ds_write_b64 v8, v[88:89] offset:1024
  s_waitcnt vmcnt(1)
  v_dot2c_f32_bf16 v96, v56, v167
  v_dot2c_f32_bf16 v97, v56, v10
  v_dot2c_f32_bf16 v98, v57, v167
  v_dot2c_f32_bf16 v99, v57, v10
  v_dot2c_f32_bf16 v100, v58, v167
  v_dot2c_f32_bf16 v101, v58, v10
  v_dot2c_f32_bf16 v102, v59, v167
  v_dot2c_f32_bf16 v103, v59, v10
  v_permlane32_swap_b32 v96, v100
  v_permlane32_swap_b32 v97, v101
  v_permlane32_swap_b32 v98, v102
  v_permlane32_swap_b32 v99, v103
  v_add_f32 v96, v96, v100
  v_add_f32 v97, v97, v101
  v_add_f32 v98, v98, v102
  v_add_f32 v99, v99, v103
  s_nop 0
  v_permlane16_swap_b32 v96, v98
  v_permlane16_swap_b32 v97, v99
  v_add_f32 v96, v96, v98
  v_add_f32 v97, v97, v99
  s_nop 0
  v_add_f32_dpp v96, v96, v96 row_ror:8 row_mask:0xf bank_mask:0xf
  v_add_f32_dpp v97, v97, v97 row_ror:8 row_mask:0xf bank_mask:0xf
  v_mul_f32 v96, v5, v96
  v_mul_f32 v97, v5, v97
  ds_write_b64 v8, v[96:97] offset:1280
  s_waitcnt vmcnt(0)
  v_dot2c_f32_bf16 v104, v60, v167
  v_dot2c_f32_bf16 v105, v60, v10
  v_dot2c_f32_bf16 v106, v61, v167
  v_dot2c_f32_bf16 v107, v61, v10
  v_dot2c_f32_bf16 v108, v62, v167
  v_dot2c_f32_bf16 v109, v62, v10
  v_dot2c_f32_bf16 v110, v63, v167
  v_dot2c_f32_bf16 v111, v63, v10
  v_permlane32_swap_b32 v104, v108
  v_permlane32_swap_b32 v105, v109
  v_permlane32_swap_b32 v106, v110
  v_permlane32_swap_b32 v107, v111
  v_add_f32 v104, v104, v108
  v_add_f32 v105, v105, v109
  v_add_f32 v106, v106, v110
  v_add_f32 v107, v107, v111
  s_nop 0
  v_permlane16_swap_b32 v104, v106
  v_permlane16_swap_b32 v105, v107
  v_add_f32 v104, v104, v106
  v_add_f32 v105, v105, v107
  s_nop 0
  v_add_f32_dpp v104, v104, v104 row_ror:8 row_mask:0xf bank_mask:0xf
  v_add_f32_dpp v105, v105, v105 row_ror:8 row_mask:0xf bank_mask:0xf
  v_mul_f32 v104, v5, v104
  v_mul_f32 v105, v5, v105
  ds_write_b64 v8, v[104:105] offset:1536
  s_mov_b64 exec, 1
  ds_add_rtn_u32 v10, v2, v11 offset:640
  s_mov_b64 exec, -1
  ds_read_b128 v[16:19], v12 offset:1024
  ds_read_b128 v[20:23], v12 offset:1792
  ds_read_b128 v[24:27], v12 offset:2560
  ds_read_b128 v[28:31], v12 offset:3328
  ds_read_b128 v[32:35], v12 offset:4096
  ds_read_b128 v[36:39], v12 offset:4864
  ds_read_b128 v[40:43], v12 offset:5632
  ds_read_b128 v[44:47], v12 offset:6400
  s_waitcnt lgkmcnt(8)
  v_readfirstlane_b32 s68, v10
  s_nop 0
  s_cmp_lg_u32 s68, 7
  s_cbranch_scc1 L_nopub
  s_waitcnt lgkmcnt(6)
  v_pk_add_f32 v[16:17], v[16:17], v[20:21]
  v_pk_add_f32 v[18:19], v[18:19], v[22:23]
  s_waitcnt lgkmcnt(4)
  v_pk_add_f32 v[24:25], v[24:25], v[28:29]
  v_pk_add_f32 v[26:27], v[26:27], v[30:31]
  v_pk_add_f32 v[16:17], v[16:17], v[24:25]
  v_pk_add_f32 v[18:19], v[18:19], v[26:27]
  s_waitcnt lgkmcnt(2)
  v_pk_add_f32 v[32:33], v[32:33], v[36:37]
  v_pk_add_f32 v[34:35], v[34:35], v[38:39]
  s_waitcnt lgkmcnt(0)
  v_pk_add_f32 v[40:41], v[40:41], v[44:45]
  v_pk_add_f32 v[42:43], v[42:43], v[46:47]
  v_pk_add_f32 v[32:33], v[32:33], v[40:41]
  v_pk_add_f32 v[34:35], v[34:35], v[42:43]
  v_pk_add_f32 v[4:5], v[16:17], v[32:33]
  v_pk_add_f32 v[6:7], v[18:19], v[34:35]
  v_cvt_pk_bf16_f32 v8, v4, v5
  v_cvt_pk_bf16_f32 v9, v6, v7
  v_cndmask_b32 v4, v8, v14, s[22:23]
  v_cndmask_b32 v5, v9, v15, s[22:23]
  v_cndmask_b32 v6, v14, v8, s[22:23]
  v_cndmask_b32 v7, v15, v9, s[22:23]
  s_mov_b32 exec_lo, 0xffffffff
  s_mov_b32 exec_hi, 0xffff
  buffer_store_dwordx4 v[4:7], v13, s[32:35], s74 offen
  s_mov_b64 exec, -1
  s_cmp_lg_u32 s46, 1
  s_cbranch_scc1 L_slow_25
L_back_26:
  ds_write_b32 v2, v11 offset:668
L_nopub:
  s_waitcnt lgkmcnt(0)
  s_cmp_lt_u32 s5, 20
  s_cbranch_scc1 L_notf1
  s_cmp_lt_u32 s5, 30
  s_cbranch_scc1 L_f1
  s_branch L_spare
L_notf1:
  s_cmp_gt_u32 s5, 11
  s_cbranch_scc1 L_stream_exit
  s_cmp_gt_u32 s3, 6
  s_cbranch_scc1 L_f2
  s_branch L_dry
L_stream_exit:
  s_endpgm
L_helper:
  s_setprio 3
  v_lshlrev_b32 v1, 2, v0
  v_lshrrev_b32 v2, 3, v0
  s_mul_i32 s68, s7, 80
  v_add_u32 v3, s68, v2
  v_lshlrev_b32 v3, 1, v3
  v_mul_u32_u24 v2, 12288, v2
  v_and_b32 v7, 7, v0
  v_lshl_add_u32 v2, v7, 4, v2
  s_mul_i32 s68, s68, 12288
  s_mul_i32 s69, s6, 384
  s_add_u32 s68, s68, s69
  s_lshl_b32 s69, s3, 7
  s_add_u32 s68, s68, s69
  s_waitcnt lgkmcnt(0)
  s_load_dword s12, s[36:37], 0
  s_load_dword s13, s[36:37], 128
  s_load_dword s14, s[36:37], 256
  s_load_dword s15, s[36:37], 384
  s_load_dword s16, s[36:37], 512
  s_load_dword s17, s[36:37], 640
  s_load_dword s18, s[36:37], 768
  s_load_dword s19, s[36:37], 896
  s_load_dword s20, s[36:37], 1024
  s_load_dword s21, s[36:37], 1152
  s_barrier
  s_mov_b32 s8, s42
  s_mov_b32 s9, s43
  s_mov_b32 s10, 7864320
  s_mov_b32 s11, 0x20000
  s_waitcnt lgkmcnt(0)
  global_load_dword v64, v1, s[36:37] offset:0
  global_load_dword v65, v1, s[36:37] offset:256
  global_load_dword v66, v1, s[36:37] offset:512
  global_load_dword v67, v1, s[36:37] offset:768
  global_load_dword v68, v1, s[36:37] offset:1024
  global_load_ushort v8, v3, s[36:37] offset:0
  global_load_ushort v9, v3, s[36:37] offset:16
  global_load_ushort v10, v3, s[36:37] offset:32
  global_load_ushort v11, v3, s[36:37] offset:48
  global_load_ushort v12, v3, s[36:37] offset:64
  global_load_ushort v13, v3, s[36:37] offset:80
  global_load_ushort v14, v3, s[36:37] offset:96
  global_load_ushort v15, v3, s[36:37] offset:112
  global_load_ushort v16, v3, s[36:37] offset:128
  global_load_ushort v17, v3, s[36:37] offset:144
  s_load_dwordx2 s[28:29], s[58:59], 917504
  s_mov_b32 s69, 0xffff0000
  s_mov_b32 s24, s58
  s_mov_b32 s25, s59
  s_mov_b32 s26, 4194304
  s_mov_b32 s27, 0x20000
  s_add_u32 s32, s58, 4194304
  s_addc_u32 s33, s59, 0
  s_mov_b32 s34, 4194304
  s_mov_b32 s35, 0x20000
  s_lshl3_add_u32 s71, s6, s7
  s_mul_i32 s5, s79, 5
  s_mul_i32 s47, s79, 3
  s_add_u32 s47, s47, 15
  s_cmp_lt_u32 s7, 5
  s_cselect_b32 s5, s5, s47
  s_add_u32 s5, s5, s7
  s_waitcnt lgkmcnt(0)
  s_mul_i32 s30, s28, 0x2c9277b5
  s_add_u32 s30, s30, 0xac564b05
  s_mul_i32 s31, s29, 0x0019660d
  s_add_u32 s31, s31, 0x3c6ef35f
  s_waitcnt vmcnt(10)
  v_lshlrev_b32 v70, 16, v64
  v_and_b32 v71, s69, v64
  v_lshlrev_b32 v72, 16, v65
  v_and_b32 v73, s69, v65
  v_lshlrev_b32 v74, 16, v66
  v_and_b32 v75, s69, v66
  v_lshlrev_b32 v76, 16, v67
  v_and_b32 v77, s69, v67
  v_lshlrev_b32 v78, 16, v68
  v_and_b32 v79, s69, v68
  v_add_f32 v4, v70, v71
  v_add_f32 v5, v72, v73
  v_add_f32 v6, v74, v75
  v_add_f32 v7, v76, v77
  v_add_f32 v4, v4, v5
  v_add_f32 v6, v6, v7
  v_add_f32 v5, v78, v79
  v_add_f32 v4, v4, v6
  v_add_f32 v4, v4, v5
  s_nop 1
  v_add_f32_dpp v4, v4, v4 quad_perm:[1,0,3,2] row_mask:0xf bank_mask:0xf
  s_nop 1
  v_add_f32_dpp v4, v4, v4 quad_perm:[2,3,0,1] row_mask:0xf bank_mask:0xf
  s_nop 1
  v_add_f32_dpp v4, v4, v4 row_half_mirror row_mask:0xf bank_mask:0xf
  s_nop 1
  v_add_f32_dpp v4, v4, v4 row_mirror row_mask:0xf bank_mask:0xf
  v_mov_b32 v5, v4
  s_nop 1
  v_permlane16_swap_b32 v4, v5
  v_add_f32 v4, v4, v5
  v_mov_b32 v5, v4
  s_nop 1
  v_permlane32_swap_b32 v4, v5
  v_add_f32 v4, v4, v5
  v_mul_f32 v4, 0x3acccccd, v4
  v_sub_f32 v70, v70, v4
  v_sub_f32 v71, v71, v4
  v_sub_f32 v72, v72, v4
  v_sub_f32 v73, v73, v4
  v_sub_f32 v74, v74, v4
  v_sub_f32 v75, v75, v4
  v_sub_f32 v76, v76, v4
  v_sub_f32 v77, v77, v4
  v_sub_f32 v78, v78, v4
  v_sub_f32 v79, v79, v4
  v_mul_f32 v5, v70, v70
  v_fmac_f32 v5, v71, v71
  v_fmac_f32 v5, v72, v72
  v_fmac_f32 v5, v73, v73
  v_fmac_f32 v5, v74, v74
  v_fmac_f32 v5, v75, v75
  v_fmac_f32 v5, v76, v76
  v_fmac_f32 v5, v77, v77
  v_fmac_f32 v5, v78, v78
  v_fmac_f32 v5, v79, v79
  s_nop 1
  v_add_f32_dpp v5, v5, v5 quad_perm:[1,0,3,2] row_mask:0xf bank_mask:0xf
  s_nop 1
  v_add_f32_dpp v5, v5, v5 quad_perm:[2,3,0,1] row_mask:0xf bank_mask:0xf
  s_nop 1
  v_add_f32_dpp v5, v5, v5 row_half_mirror row_mask:0xf bank_mask:0xf
  s_nop 1
  v_add_f32_dpp v5, v5, v5 row_mirror row_mask:0xf bank_mask:0xf
  v_mov_b32 v6, v5
  s_nop 1
  v_permlane16_swap_b32 v5, v6
  v_add_f32 v5, v5, v6
  v_mov_b32 v6, v5
  s_nop 1
  v_permlane32_swap_b32 v5, v6
  v_add_f32 v5, v5, v6
  v_mul_f32 v5, 0x3acccccd, v5
  v_cvt_pk_bf16_f32 v4, v4, v4
  v_lshlrev_b32 v4, 16, v4
  v_cvt_pk_bf16_f32 v5, v5, v5
  v_lshlrev_b32 v5, 16, v5
  v_add_f32 v5, 0x3727c5ac, v5
  v_cvt_pk_bf16_f32 v5, v5, v5
  v_lshlrev_b32 v5, 16, v5
  v_sqrt_f32 v5, v5
  s_nop 0
  v_cvt_pk_bf16_f32 v5, v5, v5
  v_lshlrev_b32 v5, 16, v5
  v_rcp_f32 v5, v5
  v_mov_b32 v6, 0
  s_waitcnt vmcnt(0)
  v_lshlrev_b32 v8, 16, v8
  v_lshlrev_b32 v9, 16, v9
  v_lshlrev_b32 v10, 16, v10
  v_lshlrev_b32 v11, 16, v11
  v_lshlrev_b32 v12, 16, v12
  v_lshlrev_b32 v13, 16, v13
  v_lshlrev_b32 v14, 16, v14
  v_lshlrev_b32 v15, 16, v15
  v_lshlrev_b32 v16, 16, v16
  v_lshlrev_b32 v17, 16, v17
  v_sub_f32 v8, v8, v4
  v_sub_f32 v9, v9, v4
  v_sub_f32 v10, v10, v4
  v_sub_f32 v11, v11, v4
  v_sub_f32 v12, v12, v4
  v_sub_f32 v13, v13, v4
  v_sub_f32 v14, v14, v4
  v_sub_f32 v15, v15, v4
  v_sub_f32 v16, v16, v4
  v_sub_f32 v17, v17, v4
  v_cvt_pk_bf16_f32 v8, v6, v8
  v_cvt_pk_bf16_f32 v9, v6, v9
  v_cvt_pk_bf16_f32 v10, v6, v10
  v_cvt_pk_bf16_f32 v11, v6, v11
  v_cvt_pk_bf16_f32 v12, v6, v12
  v_cvt_pk_bf16_f32 v13, v6, v13
  v_cvt_pk_bf16_f32 v14, v6, v14
  v_cvt_pk_bf16_f32 v15, v6, v15
  v_cvt_pk_bf16_f32 v16, v6, v16
  v_cvt_pk_bf16_f32 v17, v6, v17
  v_mul_f32 v8, v8, v5
  v_mul_f32 v9, v9, v5
  v_mul_f32 v10, v10, v5
  v_mul_f32 v11, v11, v5
  v_mul_f32 v12, v12, v5
  v_mul_f32 v13, v13, v5
  v_mul_f32 v14, v14, v5
  v_mul_f32 v15, v15, v5
  v_mul_f32 v16, v16, v5
  v_mul_f32 v17, v17, v5
  v_cvt_pk_bf16_f32 v70, v6, v8
  v_cvt_pk_bf16_f32 v8, v8, v6
  v_cvt_pk_bf16_f32 v71, v6, v9
  v_cvt_pk_bf16_f32 v9, v9, v6
  v_cvt_pk_bf16_f32 v72, v6, v10
  v_cvt_pk_bf16_f32 v10, v10, v6
  v_cvt_pk_bf16_f32 v73, v6, v11
  v_cvt_pk_bf16_f32 v11, v11, v6
  v_cvt_pk_bf16_f32 v74, v6, v12
  v_cvt_pk_bf16_f32 v12, v12, v6
  v_cvt_pk_bf16_f32 v75, v6, v13
  v_cvt_pk_bf16_f32 v13, v13, v6
  v_cvt_pk_bf16_f32 v76, v6, v14
  v_cvt_pk_bf16_f32 v14, v14, v6
  v_cvt_pk_bf16_f32 v77, v6, v15
  v_cvt_pk_bf16_f32 v15, v15, v6
  v_cvt_pk_bf16_f32 v78, v6, v16
  v_cvt_pk_bf16_f32 v16, v16, v6
  v_cvt_pk_bf16_f32 v79, v6, v17
  v_cvt_pk_bf16_f32 v17, v17, v6
  v_mov_b32 v80, 0
  v_mov_b32 v81, 0
  v_mov_b32 v82, 0
  v_mov_b32 v83, 0
  v_mov_b32 v84, 0
  v_mov_b32 v85, 0
  v_mov_b32 v86, 0
  v_mov_b32 v87, 0
  v_and_b32 v90, 7, v0
  v_lshrrev_b32 v6, 4, v0
  v_lshl_add_u32 v90, v90, 2, v6
  v_lshlrev_b32 v90, 4, v90
  s_lshl_b32 s64, s71, 11
  s_lshl_b32 s69, s3, 9
  s_add_u32 s64, s64, s69
  v_dot2c_f32_bf16 v80, v24, v8
  v_dot2c_f32_bf16 v81, v24, v70
  v_dot2c_f32_bf16 v82, v25, v8
  v_dot2c_f32_bf16 v83, v25, v70
  v_dot2c_f32_bf16 v84, v26, v8
  v_dot2c_f32_bf16 v85, v26, v70
  v_dot2c_f32_bf16 v86, v27, v8
  v_dot2c_f32_bf16 v87, v27, v70
  v_dot2c_f32_bf16 v80, v28, v9
  v_dot2c_f32_bf16 v81, v28, v71
  v_dot2c_f32_bf16 v82, v29, v9
  v_dot2c_f32_bf16 v83, v29, v71
  v_dot2c_f32_bf16 v84, v30, v9
  v_dot2c_f32_bf16 v85, v30, v71
  v_dot2c_f32_bf16 v86, v31, v9
  v_dot2c_f32_bf16 v87, v31, v71
  v_dot2c_f32_bf16 v80, v32, v10
  v_dot2c_f32_bf16 v81, v32, v72
  v_dot2c_f32_bf16 v82, v33, v10
  v_dot2c_f32_bf16 v83, v33, v72
  v_dot2c_f32_bf16 v84, v34, v10
  v_dot2c_f32_bf16 v85, v34, v72
  v_dot2c_f32_bf16 v86, v35, v10
  v_dot2c_f32_bf16 v87, v35, v72
  v_dot2c_f32_bf16 v80, v36, v11
  v_dot2c_f32_bf16 v81, v36, v73
  v_dot2c_f32_bf16 v82, v37, v11
  v_dot2c_f32_bf16 v83, v37, v73
  v_dot2c_f32_bf16 v84, v38, v11
  v_dot2c_f32_bf16 v85, v38, v73
  v_dot2c_f32_bf16 v86, v39, v11
  v_dot2c_f32_bf16 v87, v39, v73
  v_dot2c_f32_bf16 v80, v40, v12
  v_dot2c_f32_bf16 v81, v40, v74
  v_dot2c_f32_bf16 v82, v41, v12
  v_dot2c_f32_bf16 v83, v41, v74
  v_dot2c_f32_bf16 v84, v42, v12
  v_dot2c_f32_bf16 v85, v42, v74
  v_dot2c_f32_bf16 v86, v43, v12
  v_dot2c_f32_bf16 v87, v43, v74
  v_dot2c_f32_bf16 v80, v44, v13
  v_dot2c_f32_bf16 v81, v44, v75
  v_dot2c_f32_bf16 v82, v45, v13
  v_dot2c_f32_bf16 v83, v45, v75
  v_dot2c_f32_bf16 v84, v46, v13
  v_dot2c_f32_bf16 v85, v46, v75
  v_dot2c_f32_bf16 v86, v47, v13
  v_dot2c_f32_bf16 v87, v47, v75
  v_dot2c_f32_bf16 v80, v48, v14
  v_dot2c_f32_bf16 v81, v48, v76
  v_dot2c_f32_bf16 v82, v49, v14
  v_dot2c_f32_bf16 v83, v49, v76
  v_dot2c_f32_bf16 v84, v50, v14
  v_dot2c_f32_bf16 v85, v50, v76
  v_dot2c_f32_bf16 v86, v51, v14
  v_dot2c_f32_bf16 v87, v51, v76
  v_dot2c_f32_bf16 v80, v52, v15
  v_dot2c_f32_bf16 v81, v52, v77
  v_dot2c_f32_bf16 v82, v53, v15
  v_dot2c_f32_bf16 v83, v53, v77
  v_dot2c_f32_bf16 v84, v54, v15
  v_dot2c_f32_bf16 v85, v54, v77
  v_dot2c_f32_bf16 v86, v55, v15
  v_dot2c_f32_bf16 v87, v55, v77
  v_dot2c_f32_bf16 v80, v56, v16
  v_dot2c_f32_bf16 v81, v56, v78
  v_dot2c_f32_bf16 v82, v57, v16
  v_dot2c_f32_bf16 v83, v57, v78
  v_dot2c_f32_bf16 v84, v58, v16
  v_dot2c_f32_bf16 v85, v58, v78
  v_dot2c_f32_bf16 v86, v59, v16
  v_dot2c_f32_bf16 v87, v59, v78
  v_dot2c_f32_bf16 v80, v60, v17
  v_dot2c_f32_bf16 v81, v60, v79
  v_dot2c_f32_bf16 v82, v61, v17
  v_dot2c_f32_bf16 v83, v61, v79
  v_dot2c_f32_bf16 v84, v62, v17
  v_dot2c_f32_bf16 v85, v62, v79
  v_dot2c_f32_bf16 v86, v63, v17
  v_dot2c_f32_bf16 v87, v63, v79
  v_permlane32_swap_b32 v80, v84
  v_permlane32_swap_b32 v81, v85
  v_permlane32_swap_b32 v82, v86
  v_permlane32_swap_b32 v83, v87
  v_add_f32 v80, v80, v84
  v_add_f32 v81, v81, v85
  v_add_f32 v82, v82, v86
  v_add_f32 v83, v83, v87
  s_nop 0
  v_permlane16_swap_b32 v80, v82
  v_permlane16_swap_b32 v81, v83
  v_add_f32 v80, v80, v82
  v_add_f32 v81, v81, v83
  s_nop 0
  v_add_f32_dpp v80, v80, v80 row_ror:8 row_mask:0xf bank_mask:0xf
  v_add_f32_dpp v81, v81, v81 row_ror:8 row_mask:0xf bank_mask:0xf
  v_mov_b32 v82, s30
  v_mov_b32 v83, s31
  s_mov_b32 exec_lo, 0xff00ff
  s_mov_b32 exec_hi, 0xff00ff
  buffer_store_dwordx4 v[80:83], v90, s[32:35], s64 offen offset:0
  s_mov_b64 exec, -1
  v_and_b32 v3, 31, v0
  v_lshrrev_b32 v2, 5, v0
  v_lshlrev_b32 v2, 11, v2
  v_lshl_add_u32 v2, v3, 4, v2
  s_lshl_b32 s68, s6, 14
  s_add_u32 s60, s68, s69
  s_add_u32 s61, s60, 4096
  s_add_u32 s62, s60, 8192
  s_add_u32 s63, s60, 12288
  v_lshlrev_b32 v3, 2, v3
  s_lshl_b32 s69, s3, 7
  v_add_u32 v3, s69, v3
  v_mov_b32 v1, 0
  s_mov_b32 s65, 0
  s_add_u32 s68, s3, 5
  s_cmp_lg_u32 s68, s7
  s_cbranch_scc1 L_qwait
  s_mov_b32 s16, s32
  s_mov_b32 s17, s33
  s_mov_b32 s18, 4194304
  s_mov_b32 s19, 0x20000
  s_mov_b32 s70, 4000007
L_spin_27:
  buffer_load_dwordx4 v[8:11], v2, s[16:19], s60 offen offset:0 sc1 nt
  buffer_load_dwordx4 v[12:15], v2, s[16:19], s61 offen offset:0 sc1 nt
  buffer_load_dwordx4 v[16:19], v2, s[16:19], s62 offen offset:0 sc1 nt
  buffer_load_dwordx4 v[20:23], v2, s[16:19], s63 offen offset:0 sc1 nt
  s_waitcnt vmcnt(0)
  v_cmp_ne_u64 vcc, s[30:31], v[10:11]
  v_cmp_ne_u64 s[20:21], s[30:31], v[14:15]
  v_cmp_ne_u64 s[22:23], s[30:31], v[18:19]
  s_or_b64 vcc, vcc, s[20:21]
  v_cmp_ne_u64 s[20:21], s[30:31], v[22:23]
  s_or_b64 vcc, vcc, s[22:23]
  s_or_b64 vcc, vcc, s[20:21]
  s_nop 0
  s_cbranch_vccz L_sdone_28
  s_sleep 2
  ds_read_b32 v4, v1 offset:648
  s_waitcnt lgkmcnt(0)
  v_readfirstlane_b32 s46, v4
  s_nop 0
  s_sub_u32 s68, s46, s65
  s_cmp_lg_u32 s68, 2
  s_cbranch_scc1 L_qlazy_29
  s_mov_b32 exec_lo, 0xff00ff
  s_mov_b32 exec_hi, 0xff00ff
  buffer_store_dwordx4 v[80:83], v90, s[24:27], s64 offen offset:0 sc1
  s_mov_b64 exec, -1
  s_mov_b32 s65, 1
L_qlazy_29:
  s_and_b32 s99, s70, 7
  s_cselect_b32 s16, s32, s24
  s_cselect_b32 s17, s33, s25
  s_sub_u32 s70, s70, 1
  s_cbranch_scc0 L_spin_27
L_sdone_28:
  v_add_f32 v8, v8, v12
  v_add_f32 v9, v9, v13
  v_add_f32 v16, v16, v20
  v_add_f32 v17, v17, v21
  v_add_f32 v8, v8, v16
  v_add_f32 v9, v9, v17
  v_mov_b32 v10, v8
  v_mov_b32 v11, v9
  s_nop 0
  v_permlane32_swap_b32 v8, v10
  v_permlane32_swap_b32 v9, v11
  v_add_f32 v8, v8, v10
  v_add_f32 v9, v9, v11
  v_cvt_pk_bf16_f32 v8, v8, v9
  s_lshl_b32 s66, s6, 14
  s_lshl_b32 s68, s3, 11
  s_add_u32 s66, s66, s68
  v_mov_b32_dpp v9, v8 quad_perm:[1,0,3,2] row_mask:0xf bank_mask:0xf
  v_mov_b32 v10, s30
  v_mov_b32 v11, s31
  v_lshlrev_b32 v2, 3, v0
  v_mov_b32 v1, 0
  s_mov_b32 s70, 4000007
L_spin_30:
  ds_read_b32 v4, v1 offset:648
  s_waitcnt lgkmcnt(0)
  v_cmp_gt_u32 vcc, 1, v4
  s_nop 0
  s_cbranch_vccz L_sdone_31
  s_sleep 2
  s_sub_u32 s70, s70, 1
  s_cbranch_scc0 L_spin_30
L_sdone_31:
  v_readfirstlane_b32 s46, v4
  s_mov_b32 exec_lo, 0x55555555
  s_mov_b32 exec_hi, 0x0
  buffer_store_dwordx4 v[8:11], v2, s[32:35], s66 offen offset:1536
  s_mov_b64 exec, -1
  s_cmp_lg_u32 s46, 1
  s_cbranch_scc1 L_slow_32
L_back_33:
  s_branch L_qget
L_qwait:
  s_sleep 40
L_qget:
  s_lshr_b32 s66, s2, 7
  s_lshl2_add_u32 s66, s4, s66
  s_lshl_b32 s66, s66, 14
  s_lshl_b32 s68, s3, 11
  s_add_u32 s66, s66, s68
  v_and_b32 v2, 15, v0
  v_bfe_u32 v5, v0, 4, 1
  v_lshlrev_b32 v3, 3, v2
  v_add_u32 v3, s69, v3
  v_lshl_add_u32 v3, v5, 13, v3
  v_lshlrev_b32 v2, 4, v2
  v_lshl_add_u32 v2, v5, 15, v2
  s_mov_b32 s16, s32
  s_mov_b32 s17, s33
  s_mov_b32 s18, 4194304
  s_mov_b32 s19, 0x20000
  s_mov_b32 s70, 4000007
L_spin_34:
  buffer_load_dwordx4 v[12:15], v2, s[16:19], s66 offen offset:1536 sc1 nt
  s_waitcnt vmcnt(0)
  v_cmp_ne_u64 vcc, s[30:31], v[14:15]
  s_nop 0
  s_cbranch_vccz L_sdone_35
  s_sleep 8
  ds_read_b32 v4, v1 offset:648
  s_waitcnt lgkmcnt(0)
  v_readfirstlane_b32 s46, v4
  s_nop 0
  s_sub_u32 s68, s46, s65
  s_cmp_lg_u32 s68, 2
  s_cbranch_scc1 L_qlazy_36
  s_mov_b32 exec_lo, 0xff00ff
  s_mov_b32 exec_hi, 0xff00ff
  buffer_store_dwordx4 v[80:83], v90, s[24:27], s64 offen offset:0 sc1
  s_mov_b64 exec, -1
  s_mov_b32 s65, 1
L_qlazy_36:
  s_and_b32 s99, s70, 7
  s_cselect_b32 s16, s32, s24
  s_cselect_b32 s17, s33, s25
  s_sub_u32 s70, s70, 1
  s_cbranch_scc0 L_spin_34
L_sdone_35:
  ds_write_b64 v3, v[12:13] offset:0
  s_lshl_b32 s69, s3, 3
  v_mov_b32 v4, s69
  v_mov_b32 v6, 1
  s_waitcnt lgkmcnt(0)
  ds_write_b32 v4, v6 offset:384
  v_mov_b32 v1, 0
  s_mov_b32 s70, 4000007
L_spin_37:
  ds_read_b32 v4, v1 offset:648
  s_waitcnt lgkmcnt(0)
  v_cmp_gt_u32 vcc, 1, v4
  s_nop 0
  s_cbranch_vccz L_sdone_38
  s_sleep 2
  s_sub_u32 s70, s70, 1
  s_cbranch_scc0 L_spin_37
L_sdone_38:
  v_readfirstlane_b32 s46, v4
  ds_read_b32 v4, v1 offset:648
  s_waitcnt lgkmcnt(0)
  v_readfirstlane_b32 s46, v4
  s_nop 0
  s_sub_u32 s68, s46, s65
  s_cmp_lg_u32 s68, 2
  s_cbranch_scc1 L_qlazy_39
  s_mov_b32 exec_lo, 0xff00ff
  s_mov_b32 exec_hi, 0xff00ff
  buffer_store_dwordx4 v[80:83], v90, s[24:27], s64 offen offset:0 sc1
  s_mov_b64 exec, -1
  s_mov_b32 s65, 1
L_qlazy_39:
  s_branch L_stats
L_ids:
  s_setprio 3
  s_getreg_b32 s64, hwreg(HW_REG_XCC_ID)
  s_mov_b32 s24, s58
  s_mov_b32 s25, s59
  s_mov_b32 s26, 4194304
  s_mov_b32 s27, 0x20000
  s_add_u32 s32, s58, 4194304
  s_addc_u32 s33, s59, 0
  s_mov_b32 s34, 4194304
  s_mov_b32 s35, 0x20000
  s_lshl3_add_u32 s71, s6, s7
  s_mul_i32 s5, s79, 5
  s_mul_i32 s47, s79, 3
  s_add_u32 s47, s47, 15
  s_cmp_lt_u32 s7, 5
  s_cselect_b32 s5, s5, s47
  s_add_u32 s5, s5, s7
  s_waitcnt lgkmcnt(0)
  s_mul_i32 s30, s28, 0x2c9277b5
  s_add_u32 s30, s30, 0xac564b05
  s_mul_i32 s31, s29, 0x0019660d
  s_add_u32 s31, s31, 0x3c6ef35f
  s_and_b32 s64, s64, 15
  v_mov_b32 v4, s30
  v_mov_b32 v5, s31
  v_mov_b32 v6, s64
  v_mov_b32 v7, s64
  s_lshl_b32 s68, s4, 9
  s_add_u32 s68, s68, 2080768
  s_lshr_b32 s65, s2, 3
  s_lshl_b32 s69, s65, 4
  v_mov_b32 v1, s69
  s_mov_b64 exec, 1
  buffer_store_dwordx4 v[4:7], v1, s[32:35], s68 offen
  s_mov_b64 exec, -1
  s_cmp_lg_u32 s65, 31
  s_cbranch_scc1 L_noinit
  v_lshlrev_b32 v12, 8, v0
  s_lshl_b32 s69, s4, 15
  s_add_u32 s69, s69, 1703936
  s_mov_b32 exec_lo, 0x8040201
  s_mov_b32 exec_hi, 0x8040201
  buffer_store_dword v4, v12, s[24:27], s69 offen sc1
  s_mov_b64 exec, -1
L_noinit:
  v_and_b32 v1, 31, v0
  v_lshlrev_b32 v1, 4, v1
  s_mov_b32 s70, 12
  s_mov_b32 s46, 2
L_idpoll:
  s_sleep 16
  buffer_load_dwordx4 v[8:11], v1, s[32:35], s68 offen sc1 nt
  s_waitcnt vmcnt(0)
  v_cmp_ne_u64 vcc, s[30:31], v[8:9]
  s_nop 0
  s_cbranch_vccz L_iddone
  s_sub_u32 s70, s70, 1
  s_cbranch_scc0 L_idpoll
  s_branch L_idset
L_iddone:
  v_cmp_ne_u32 vcc, s64, v10
  s_nop 0
  s_cbranch_vccnz L_idset
  s_mov_b32 s46, 1
L_idset:
  v_mov_b32 v1, 0
  v_mov_b32 v4, s46
  ds_write_b32 v1, v4 offset:648
  s_cmp_lg_u32 s65, 31
  s_cbranch_scc1 L_pf
  s_lshl_b32 s69, s4, 15
  s_add_u32 s69, s69, 1703936
  s_add_u32 s22, s58, s69
  s_addc_u32 s23, s59, 0
  s_waitcnt lgkmcnt(0)
  s_mov_b32 s8, -1
  s_mov_b32 s9, -1
  s_memtime s[12:13]
  s_waitcnt lgkmcnt(0)
  s_load_dword s10, s[22:23], 0
  s_waitcnt lgkmcnt(0)
  s_memtime s[14:15]
  s_waitcnt lgkmcnt(0)
  s_sub_u32 s11, s14, s12
  s_min_u32 s8, s8, s11
  s_waitcnt lgkmcnt(0)
  s_load_dword s10, s[22:23], 8192
  s_waitcnt lgkmcnt(0)
  s_memtime s[12:13]
  s_waitcnt lgkmcnt(0)
  s_sub_u32 s11, s12, s14
  s_min_u32 s9, s9, s11
  s_waitcnt lgkmcnt(0)
  s_load_dword s10, s[22:23], 10496
  s_waitcnt lgkmcnt(0)
  s_memtime s[14:15]
  s_waitcnt lgkmcnt(0)
  s_sub_u32 s11, s14, s12
  s_min_u32 s9, s9, s11
  s_waitcnt lgkmcnt(0)
  s_load_dword s10, s[22:23], 2304
  s_waitcnt lgkmcnt(0)
  s_memtime s[12:13]
  s_waitcnt lgkmcnt(0)
  s_sub_u32 s11, s12, s14
  s_min_u32 s8, s8, s11
  s_waitcnt lgkmcnt(0)
  s_load_dword s10, s[22:23], 4608
  s_waitcnt lgkmcnt(0)
  s_memtime s[14:15]
  s_waitcnt lgkmcnt(0)
  s_sub_u32 s11, s14, s12
  s_min_u32 s8, s8, s11
  s_waitcnt lgkmcnt(0)
  s_load_dword s10, s[22:23], 12800
  s_waitcnt lgkmcnt(0)
  s_memtime s[12:13]
  s_waitcnt lgkmcnt(0)
  s_sub_u32 s11, s12, s14
  s_min_u32 s9, s9, s11
  s_waitcnt lgkmcnt(0)
  s_load_dword s10, s[22:23], 15104
  s_waitcnt lgkmcnt(0)
  s_memtime s[14:15]
  s_waitcnt lgkmcnt(0)
  s_sub_u32 s11, s14, s12
  s_min_u32 s9, s9, s11
  s_waitcnt lgkmcnt(0)
  s_load_dword s10, s[22:23], 6912
  s_waitcnt lgkmcnt(0)
  s_memtime s[12:13]
  s_waitcnt lgkmcnt(0)
  s_sub_u32 s11, s12, s14
  s_min_u32 s8, s8, s11
  s_cmp_gt_u32 s8, s9
  s_cselect_b32 s21, 1, 0
  v_mov_b32 v4, s21
  v_mov_b32 v5, s62
  v_mov_b32 v6, s30
  v_mov_b32 v7, s31
  s_lshl_b32 s69, s4, 4
  s_add_u32 s69, s69, 950272
  s_mov_b64 exec, 1
  buffer_store_dwordx4 v[4:7], v1, s[24:27], s69 offen sc1
  s_mov_b64 exec, -1
L_pf:
  s_mov_b32 s65, 0
  s_cmp_lg_u32 s7, 6
  s_cbranch_scc1 L_nosample0
  v_mov_b32 v1, 0
  s_mov_b32 s70, 4000007
L_spin_40:
  ds_read_b64 v[4:5], v1 offset:696
  s_waitcnt lgkmcnt(0)
  v_cmp_gt_u32 vcc, 8, v5
  s_nop 0
  s_cbranch_vccz L_sdone_41
  s_sleep 2
  s_sub_u32 s70, s70, 1
  s_cbranch_scc0 L_spin_40
L_sdone_41:
  v_mov_b32 v5, s31
  v_lshlrev_b32 v6, 9, v0
  s_lshl_b32 s68, s6, 3
  s_add_u32 s68, s68, 958464
  s_mov_b64 exec, 7
  buffer_store_dwordx2 v[4:5], v6, s[24:27], s68 offen sc1
  s_mov_b64 exec, -1
L_nosample0:
  v_mov_b32 v1, 0
  s_mov_b32 s70, 4000007
L_spin_42:
  ds_read_b32 v12, v1 offset:692
  s_waitcnt lgkmcnt(0)
  v_cmp_gt_u32 vcc, 8, v12
  s_nop 0
  s_cbranch_vccz L_sdone_43
  s_sleep 4
  s_sub_u32 s70, s70, 1
  s_cbranch_scc0 L_spin_42
L_sdone_43:
  s_add_u32 s60, s58, 958464
  s_addc_u32 s61, s59, 0
  s_mov_b32 s70, 2
L_calpoll0:
  s_lshl_b32 s96, s62, 8
  s_sub_u32 s96, 0, s96
  s_mov_b32 s97, 0
  s_load_dwordx16 s[8:23], s[60:61], 0
  s_load_dwordx16 s[80:95], s[60:61], 64
  s_waitcnt lgkmcnt(0)
  s_add_u32 s96, s96, s8
  s_cmp_lg_u32 s9, s31
  s_addc_u32 s97, s97, 0
  s_add_u32 s96, s96, s10
  s_cmp_lg_u32 s11, s31
  s_addc_u32 s97, s97, 0
  s_add_u32 s96, s96, s12
  s_cmp_lg_u32 s13, s31
  s_addc_u32 s97, s97, 0
  s_add_u32 s96, s96, s14
  s_cmp_lg_u32 s15, s31
  s_addc_u32 s97, s97, 0
  s_add_u32 s96, s96, s16
  s_cmp_lg_u32 s17, s31
  s_addc_u32 s97, s97, 0
  s_add_u32 s96, s96, s18
  s_cmp_lg_u32 s19, s31
  s_addc_u32 s97, s97, 0
  s_add_u32 s96, s96, s20
  s_cmp_lg_u32 s21, s31
  s_addc_u32 s97, s97, 0
  s_add_u32 s96, s96, s22
  s_cmp_lg_u32 s23, s31
  s_addc_u32 s97, s97, 0
  s_add_u32 s96, s96, s80
  s_cmp_lg_u32 s81, s31
  s_addc_u32 s97, s97, 0
  s_add_u32 s96, s96, s82
  s_cmp_lg_u32 s83, s31
  s_addc_u32 s97, s97, 0
  s_add_u32 s96, s96, s84
  s_cmp_lg_u32 s85, s31
  s_addc_u32 s97, s97, 0
  s_add_u32 s96, s96, s86
  s_cmp_lg_u32 s87, s31
  s_addc_u32 s97, s97, 0
  s_add_u32 s96, s96, s88
  s_cmp_lg_u32 s89, s31
  s_addc_u32 s97, s97, 0
  s_add_u32 s96, s96, s90
  s_cmp_lg_u32 s91, s31
  s_addc_u32 s97, s97, 0
  s_add_u32 s96, s96, s92
  s_cmp_lg_u32 s93, s31
  s_addc_u32 s97, s97, 0
  s_add_u32 s96, s96, s94
  s_cmp_lg_u32 s95, s31
  s_addc_u32 s97, s97, 0
  s_load_dwordx16 s[8:23], s[60:61], 128
  s_load_dwordx16 s[80:95], s[60:61], 192
  s_waitcnt lgkmcnt(0)
  s_add_u32 s96, s96, s8
  s_cmp_lg_u32 s9, s31
  s_addc_u32 s97, s97, 0
  s_add_u32 s96, s96, s10
  s_cmp_lg_u32 s11, s31
  s_addc_u32 s97, s97, 0
  s_add_u32 s96, s96, s12
  s_cmp_lg_u32 s13, s31
  s_addc_u32 s97, s97, 0
  s_add_u32 s96, s96, s14
  s_cmp_lg_u32 s15, s31
  s_addc_u32 s97, s97, 0
  s_add_u32 s96, s96, s16
  s_cmp_lg_u32 s17, s31
  s_addc_u32 s97, s97, 0
  s_add_u32 s96, s96, s18
  s_cmp_lg_u32 s19, s31
  s_addc_u32 s97, s97, 0
  s_add_u32 s96, s96, s20
  s_cmp_lg_u32 s21, s31
  s_addc_u32 s97, s97, 0
  s_add_u32 s96, s96, s22
  s_cmp_lg_u32 s23, s31
  s_addc_u32 s97, s97, 0
  s_add_u32 s96, s96, s80
  s_cmp_lg_u32 s81, s31
  s_addc_u32 s97, s97, 0
  s_add_u32 s96, s96, s82
  s_cmp_lg_u32 s83, s31
  s_addc_u32 s97, s97, 0
  s_add_u32 s96, s96, s84
  s_cmp_lg_u32 s85, s31
  s_addc_u32 s97, s97, 0
  s_add_u32 s96, s96, s86
  s_cmp_lg_u32 s87, s31
  s_addc_u32 s97, s97, 0
  s_add_u32 s96, s96, s88
  s_cmp_lg_u32 s89, s31
  s_addc_u32 s97, s97, 0
  s_add_u32 s96, s96, s90
  s_cmp_lg_u32 s91, s31
  s_addc_u32 s97, s97, 0
  s_add_u32 s96, s96, s92
  s_cmp_lg_u32 s93, s31
  s_addc_u32 s97, s97, 0
  s_add_u32 s96, s96, s94
  s_cmp_lg_u32 s95, s31
  s_addc_u32 s97, s97, 0
  s_cmp_eq_u32 s97, 0
  s_cbranch_scc1 L_calok0
  s_add_u32 s60, s60, 512
  s_addc_u32 s61, s61, 0
  s_sub_u32 s70, s70, 1
  s_cbranch_scc1 L_stats
  s_sleep 20
  s_branch L_calpoll0
L_calok0:
  s_ashr_i32 s96, s96, 4
  s_mov_b32 s68, 352
  s_cmp_lt_u32 s5, 30
  s_cselect_b32 s68, -80, s68
  s_cmp_lt_u32 s5, 20
  s_cselect_b32 s68, 112, s68
  s_lshl4_add_u32 s68, s62, s68
  s_add_u32 s68, s68, s96
  s_mov_b32 s66, s68
  s_mov_b32 s65, -1
  v_mov_b32 v12, s68
  v_mov_b32 v13, -1
  ds_write_b64 v1, v[12:13] offset:680
L_stats:
  v_and_b32 v1, 7, v0
  v_lshlrev_b32 v1, 4, v1
  s_mov_b32 s70, 4000007
L_spin_44:
  ds_read_b128 v[4:7], v1 offset:512
  s_waitcnt lgkmcnt(0)
  v_cmp_eq_u32 vcc, 0, v7
  s_nop 0
  s_cbranch_vccz L_sdone_45
  s_sleep 4
  s_sub_u32 s70, s70, 1
  s_cbranch_scc0 L_spin_44
L_sdone_45:
  s_cmp_lg_u32 s3, 3
  s_cbranch_scc1 L_nostat
  v_and_b32 v12, 8, v0
  v_cmp_ne_u32 vcc, 0, v12
  v_lshlrev_b32 v12, 6, v12
  s_nop 0
  v_cndmask_b32 v4, v4, v6, vcc
  v_cndmask_b32 v5, v5, v7, vcc
  s_mov_b32 s68, 0x3fb8aa3b
  v_mov_b32 v2, v4
  s_nop 1
  v_max_f32_dpp v2, v2, v2 quad_perm:[1,0,3,2] row_mask:0xf bank_mask:0xf
  s_nop 1
  v_max_f32_dpp v2, v2, v2 quad_perm:[2,3,0,1] row_mask:0xf bank_mask:0xf
  s_nop 1
  v_max_f32_dpp v2, v2, v2 row_half_mirror row_mask:0xf bank_mask:0xf
  v_sub_f32 v4, v4, v2
  v_mul_f32 v4, s68, v4
  v_exp_f32 v4, v4
  s_nop 0
  v_mul_f32 v3, v4, v5
  s_nop 1
  v_add_f32_dpp v3, v3, v3 quad_perm:[1,0,3,2] row_mask:0xf bank_mask:0xf
  s_nop 1
  v_add_f32_dpp v3, v3, v3 quad_perm:[2,3,0,1] row_mask:0xf bank_mask:0xf
  s_nop 1
  v_add_f32_dpp v3, v3, v3 row_half_mirror row_mask:0xf bank_mask:0xf
  s_lshr_b32 s68, s2, 7
  s_lshl2_add_u32 s68, s4, s68
  s_bfe_u32 s69, s2, 0x40003
  s_lshl4_add_u32 s68, s68, s69
  s_lshl_b32 s68, s68, 4
  s_add_u32 s68, s68, 2064384
  v_mov_b32 v4, s30
  v_mov_b32 v5, s31
  s_mov_b32 exec_lo, 0x101
  s_mov_b32 exec_hi, 0x0
  buffer_store_dwordx4 v[2:5], v12, s[32:35], s68 offen
  s_mov_b64 exec, -1
  s_cmp_lg_u32 s46, 1
  s_cbranch_scc1 L_slow_46
L_back_47:
  s_mov_b32 s68, 950272
  s_mov_b32 s70, 4000007
L_spin_48:
  buffer_load_dwordx4 v[8:11], v1, s[24:27], s68 offen sc1
  s_waitcnt vmcnt(0)
  v_cmp_ne_u64 vcc, s[30:31], v[10:11]
  s_nop 0
  s_cbranch_vccz L_sdone_49
  s_sleep 8
  s_sub_u32 s70, s70, 1
  s_cbranch_scc0 L_spin_48
L_sdone_49:
  v_cmp_ne_u32 vcc, 0, v8
  s_nop 0
  s_and_b32 s67, vcc_lo, 0xff
  s_bitset1_b32 s67, 8
  v_mov_b32 v4, s67
  v_mov_b32 v1, 0
  ds_write_b32 v1, v4 offset:660
L_nostat:
  s_cmp_lg_u32 s3, 2
  s_cbranch_scc1 L_noa
  v_min_u32 v12, 47, v0
  v_lshrrev_b32 v13, 3, v12
  v_lshlrev_b32 v13, 11, v13
  v_and_b32 v14, 1, v12
  v_lshl_add_u32 v13, v14, 10, v13
  v_bfe_u32 v14, v12, 1, 2
  v_lshl_add_u32 v13, v14, 8, v13
  v_lshlrev_b32 v12, 4, v12
  s_lshr_b32 s74, s2, 7
  s_lshl2_add_u32 s74, s4, s74
  s_mul_i32 s74, s74, 12288
  s_bfe_u32 s69, s2, 0x40003
  s_lshl4_add_u32 s74, s69, s74
  s_add_u32 s74, s74, 524288
  s_mov_b32 s22, 0x55555555
  s_mov_b32 s23, 0x55555555
  v_mov_b32 v14, s30
  v_mov_b32 v15, s31
  v_mov_b32 v1, 0
  s_mov_b32 s70, 4000007
L_spin_50:
  ds_read_b32 v4, v1 offset:652
  s_waitcnt lgkmcnt(0)
  v_cmp_gt_u32 vcc, 8, v4
  s_nop 0
  s_cbranch_vccz L_sdone_51
  s_sleep 4
  s_sub_u32 s70, s70, 1
  s_cbranch_scc0 L_spin_50
L_sdone_51:
  v_mov_b32 v1, 0
  s_mov_b32 s70, 4000007
L_spin_52:
  ds_read_b32 v4, v1 offset:644
  s_waitcnt lgkmcnt(0)
  v_cmp_gt_u32 vcc, 1, v4
  s_nop 0
  s_cbranch_vccz L_sdone_53
  s_sleep 2
  s_sub_u32 s70, s70, 1
  s_cbranch_scc0 L_spin_52
L_sdone_53:
  ds_read_b128 v[16:19], v12 offset:57856
  ds_read_b128 v[20:23], v12 offset:58624
  ds_read_b128 v[24:27], v12 offset:59392
  ds_read_b128 v[28:31], v12 offset:60160
  ds_read_b128 v[32:35], v12 offset:60928
  ds_read_b128 v[36:39], v12 offset:61696
  ds_read_b128 v[40:43], v12 offset:62464
  ds_read_b128 v[44:47], v12 offset:63232
  s_waitcnt lgkmcnt(6)
  v_pk_add_f32 v[16:17], v[16:17], v[20:21]
  v_pk_add_f32 v[18:19], v[18:19], v[22:23]
  s_waitcnt lgkmcnt(4)
  v_pk_add_f32 v[24:25], v[24:25], v[28:29]
  v_pk_add_f32 v[26:27], v[26:27], v[30:31]
  v_pk_add_f32 v[16:17], v[16:17], v[24:25]
  v_pk_add_f32 v[18:19], v[18:19], v[26:27]
  s_waitcnt lgkmcnt(2)
  v_pk_add_f32 v[32:33], v[32:33], v[36:37]
  v_pk_add_f32 v[34:35], v[34:35], v[38:39]
  s_waitcnt lgkmcnt(0)
  v_pk_add_f32 v[40:41], v[40:41], v[44:45]
  v_pk_add_f32 v[42:43], v[42:43], v[46:47]
  v_pk_add_f32 v[32:33], v[32:33], v[40:41]
  v_pk_add_f32 v[34:35], v[34:35], v[42:43]
  v_pk_add_f32 v[4:5], v[16:17], v[32:33]
  v_pk_add_f32 v[6:7], v[18:19], v[34:35]
  v_cvt_pk_bf16_f32 v8, v4, v5
  v_cvt_pk_bf16_f32 v9, v6, v7
  v_cndmask_b32 v4, v8, v14, s[22:23]
  v_cndmask_b32 v5, v9, v15, s[22:23]
  v_cndmask_b32 v6, v14, v8, s[22:23]
  v_cndmask_b32 v7, v15, v9, s[22:23]
  s_mov_b32 exec_lo, 0xffffffff
  s_mov_b32 exec_hi, 0xffff
  buffer_store_dwordx4 v[4:7], v13, s[32:35], s74 offen
  s_mov_b64 exec, -1
  s_cmp_lg_u32 s46, 1
  s_cbranch_scc1 L_slow_54
L_back_55:
L_noa:
  s_cmp_lg_u32 s3, 1
  s_cbranch_scc1 L_notl
  s_lshl_b32 s68, s2, 12
  v_mov_b32 v8, s68
  s_mov_b64 exec, 1
  s_cmp_lt_u32 s5, 20
  s_cbranch_scc1 L_tlwo
  s_branch L_tlj
L_tlwo:
  global_load_dword v9, v8, s[52:53] nt
L_tlj:
  s_lshl_b32 s68, s2, 7
  s_add_u32 s68, s68, 4128768
  v_mov_b32 v14, 0
  buffer_load_dword v15, v14, s[32:35], s68 offen nt
  s_mov_b64 exec, -1
  s_waitcnt vmcnt(0)
L_notl:
  s_cmp_lt_u32 s5, 20
  s_cbranch_scc0 L_helper_exit
  s_cmp_ge_u32 s5, 10
  s_cselect_b32 s76, 1, 0
  s_mul_i32 s77, s76, 10
  s_sub_u32 s77, s5, s77
  s_lshr_b32 s78, s3, 1
  v_and_b32 v2, 48, v0
  s_lshl_b32 s68, s78, 6
  v_add_u32 v22, s68, v2
  v_lshlrev_b32 v60, 4, v0
  s_lshl1_add_u32 s73, s4, s78
  s_lshl1_add_u32 s73, s73, s76
  s_lshl1_add_u32 s73, s73, s3
  s_lshl_b32 s68, s78, 1
  s_sub_u32 s73, s73, s68
  s_mul_i32 s73, s73, 6144
  s_add_u32 s73, s73, 524288
  s_add_u32 s74, s73, 4096
  v_lshlrev_b32 v62, 2, v0
  s_lshl_b32 s68, s3, 8
  v_add_u32 v61, s68, v62
  v_lshrrev_b32 v2, 5, v0
  v_lshlrev_b32 v2, 11, v2
  v_bfe_u32 v3, v0, 2, 3
  v_lshl_add_u32 v2, v3, 4, v2
  v_and_b32 v3, 1, v0
  v_lshl_add_u32 v63, v3, 13, v2
  s_lshr_b32 s75, s77, 1
  s_lshl_b32 s75, s75, 14
  s_and_b32 s68, s77, 1
  s_lshl_b32 s68, s68, 12
  s_add_u32 s75, s75, s68
  s_lshl1_add_u32 s68, s4, s76
  s_lshl_b32 s68, s68, 7
  s_add_u32 s75, s75, s68
  s_add_u32 s75, s75, 1966080
  s_mov_b32 s8, 0x33333333
  s_mov_b32 s9, 0x33333333
  v_mov_b32 v50, s30
  v_mov_b32 v51, s31
  v_lshrrev_b32 v24, 4, v0
  v_lshlrev_b32 v24, 10, v24
  v_bfe_u32 v25, v0, 2, 2
  v_lshl_add_u32 v24, v25, 7, v24
  v_and_b32 v25, 3, v0
  v_lshl_add_u32 v24, v25, 3, v24
  s_mul_i32 s69, s3, 12288
  v_add_u32 v24, s69, v24
  s_cmp_lg_u32 s3, 0
  s_cbranch_scc1 L_noc
  s_lshl2_add_u32 s72, s4, s76
  s_lshl_b32 s72, s72, 8
  s_add_u32 s72, s72, 2064384
  v_and_b32 v1, 15, v0
  v_lshlrev_b32 v1, 4, v1
  v_and_b32 v2, 16, v0
  v_lshl_add_u32 v1, v2, 5, v1
  s_mov_b32 s16, s32
  s_mov_b32 s17, s33
  s_mov_b32 s18, 4194304
  s_mov_b32 s19, 0x20000
  s_mov_b32 s70, 4000007
L_spin_56:
  s_sleep 24
  buffer_load_dwordx4 v[4:7], v1, s[16:19], s72 offen sc1 nt
  s_waitcnt vmcnt(0)
  v_cmp_ne_u64 vcc, s[30:31], v[6:7]
  s_nop 0
  s_cbranch_vccz L_sdone_57
  s_and_b32 s99, s70, 7
  s_cmp_eq_u32 s46, 1
  s_cselect_b32 s99, 1, s99
  s_cmp_lg_u32 s99, 0
  s_cselect_b32 s16, s32, s24
  s_cselect_b32 s17, s33, s25
  s_sub_u32 s70, s70, 1
  s_cbranch_scc0 L_spin_56
L_sdone_57:
  s_mov_b32 s68, 0x3fb8aa3b
  v_mov_b32 v2, v4
  s_nop 1
  v_max_f32_dpp v2, v2, v2 quad_perm:[1,0,3,2] row_mask:0xf bank_mask:0xf
  s_nop 1
  v_max_f32_dpp v2, v2, v2 quad_perm:[2,3,0,1] row_mask:0xf bank_mask:0xf
  s_nop 1
  v_max_f32_dpp v2, v2, v2 row_half_mirror row_mask:0xf bank_mask:0xf
  s_nop 1
  v_max_f32_dpp v2, v2, v2 row_mirror row_mask:0xf bank_mask:0xf
  v_sub_f32 v4, v4, v2
  v_mul_f32 v4, s68, v4
  v_exp_f32 v4, v4
  s_nop 0
  v_mul_f32 v3, v4, v5
  s_nop 1
  v_add_f32_dpp v3, v3, v3 quad_perm:[1,0,3,2] row_mask:0xf bank_mask:0xf
  s_nop 1
  v_add_f32_dpp v3, v3, v3 quad_perm:[2,3,0,1] row_mask:0xf bank_mask:0xf
  s_nop 1
  v_add_f32_dpp v3, v3, v3 row_half_mirror row_mask:0xf bank_mask:0xf
  s_nop 1
  v_add_f32_dpp v3, v3, v3 row_mirror row_mask:0xf bank_mask:0xf
  v_rcp_f32 v3, v3
  v_and_b32 v1, 0x7c, v62
  v_mul_f32 v4, v4, v3
  v_mov_b32 v2, 0
  v_mov_b32 v3, 1
  ds_write_b32 v1, v4 offset:768
  ds_write_b32 v2, v3 offset:664
L_noc:
  v_mov_b32 v1, 0
  s_mov_b32 s70, 4000007
L_spin_58:
  ds_read_b32 v4, v1 offset:664
  s_waitcnt lgkmcnt(0)
  v_cmp_gt_u32 vcc, 1, v4
  s_nop 0
  s_cbranch_vccz L_sdone_59
  s_sleep 2
  s_sub_u32 s70, s70, 1
  s_cbranch_scc0 L_spin_58
L_sdone_59:
  ds_read_b128 v[56:59], v22 offset:768
  s_mov_b32 s12, s44
  s_mov_b32 s13, s45
  s_mov_b32 s14, 7864320
  s_mov_b32 s15, 0x20000
  v_lshrrev_b32 v21, 3, v0
  v_mul_u32_u24 v21, 1280, v21
  v_and_b32 v3, 7, v0
  v_lshl_add_u32 v21, v3, 4, v21
  s_lshl1_add_u32 s60, s4, s76
  s_mul_i32 s68, s78, 16
  s_add_u32 s60, s60, s68
  s_add_u32 s60, s60, 0
  s_and_b32 s68, s3, 1
  s_lshl1_add_u32 s60, s60, s68
  s_mul_i32 s60, s60, 122880
  s_lshl_b32 s69, s77, 7
  s_add_u32 s60, s60, s69
  s_mul_i32 s61, s3, 12288
  s_add_u32 s61, s61, 8704
  v_mov_b32 v23, 1
  s_lshl_b32 s68, s3, 2
  v_mov_b32 v25, s68
  v_mov_b32 v1, 0
  s_mov_b32 s70, 4000007
L_spin_60:
  ds_read_b32 v4, v1 offset:660
  s_waitcnt lgkmcnt(0)
  v_cmp_gt_u32 vcc, 1, v4
  s_nop 0
  s_cbranch_vccz L_sdone_61
  s_sleep 4
  s_sub_u32 s70, s70, 1
  s_cbranch_scc0 L_spin_60
L_sdone_61:
  v_readfirstlane_b32 s47, v4
  v_mov_b32 v1, 0
  s_mov_b32 s70, 4000007
L_spin_62:
  ds_read_b32 v4, v1 offset:644
  s_waitcnt lgkmcnt(0)
  v_cmp_gt_u32 vcc, 8, v4
  s_nop 0
  s_cbranch_vccz L_sdone_63
  s_sleep 2
  s_sub_u32 s70, s70, 1
  s_cbranch_scc0 L_spin_62
L_sdone_63:
  s_cmp_lg_u32 s78, 0
  s_cbranch_scc1 L_nofirst
L_nofirst:
  s_mov_b32 m0, s61
  s_nop 0
  buffer_load_dwordx4 v21, s[12:15], s60 offen nt lds
  s_add_u32 s60, s60, 10240
  s_add_u32 s61, s61, 1024
  s_mov_b32 m0, s61
  s_nop 0
  buffer_load_dwordx4 v21, s[12:15], s60 offen nt lds
  s_add_u32 s60, s60, 10240
  s_add_u32 s61, s61, 1024
  s_mov_b32 m0, s61
  s_nop 0
  buffer_load_dwordx4 v21, s[12:15], s60 offen nt lds
  s_add_u32 s60, s60, 10240
  s_add_u32 s61, s61, 1024
  s_mov_b32 m0, s61
  s_nop 0
  buffer_load_dwordx4 v21, s[12:15], s60 offen nt lds
  s_add_u32 s60, s60, 10240
  s_add_u32 s61, s61, 1024
  s_mov_b32 m0, s61
  s_nop 0
  buffer_load_dwordx4 v21, s[12:15], s60 offen nt lds
  s_add_u32 s60, s60, 10240
  s_add_u32 s61, s61, 1024
  s_mov_b32 m0, s61
  s_nop 0
  buffer_load_dwordx4 v21, s[12:15], s60 offen nt lds
  s_add_u32 s60, s60, 10240
  s_add_u32 s61, s61, 1024
  s_waitcnt vmcnt(5)
  s_mov_b32 m0, s61
  s_nop 0
  buffer_load_dwordx4 v21, s[12:15], s60 offen nt lds
  s_add_u32 s60, s60, 10240
  s_add_u32 s61, s61, 1024
  s_waitcnt vmcnt(5)
  s_mov_b32 m0, s61
  s_nop 0
  buffer_load_dwordx4 v21, s[12:15], s60 offen nt lds
  s_add_u32 s60, s60, 10240
  s_add_u32 s61, s61, 1024
  s_waitcnt vmcnt(5)
  s_mov_b32 m0, s61
  s_nop 0
  buffer_load_dwordx4 v21, s[12:15], s60 offen nt lds
  s_add_u32 s60, s60, 10240
  s_add_u32 s61, s61, 1024
  s_waitcnt vmcnt(5)
  s_mov_b32 m0, s61
  s_nop 0
  buffer_load_dwordx4 v21, s[12:15], s60 offen nt lds
  s_add_u32 s60, s60, 10240
  s_add_u32 s61, s61, 1024
  s_waitcnt vmcnt(5)
  s_mov_b32 m0, s61
  s_nop 0
  buffer_load_dwordx4 v21, s[12:15], s60 offen nt lds
  s_add_u32 s60, s60, 10240
  s_add_u32 s61, s61, 1024
  s_waitcnt vmcnt(5)
  s_mov_b32 m0, s61
  s_nop 0
  buffer_load_dwordx4 v21, s[12:15], s60 offen nt lds
  s_waitcnt vmcnt(4)
  ds_read_b64_tr_b16 v[64:65], v24 offset:8704
  ds_read_b64_tr_b16 v[66:67], v24 offset:9216
  ds_read_b64_tr_b16 v[68:69], v24 offset:8736
  ds_read_b64_tr_b16 v[70:71], v24 offset:9248
  ds_read_b64_tr_b16 v[72:73], v24 offset:8768
  ds_read_b64_tr_b16 v[74:75], v24 offset:9280
  ds_read_b64_tr_b16 v[76:77], v24 offset:8800
  ds_read_b64_tr_b16 v[78:79], v24 offset:9312
  ds_read_b64_tr_b16 v[80:81], v24 offset:12800
  ds_read_b64_tr_b16 v[82:83], v24 offset:13312
  ds_read_b64_tr_b16 v[84:85], v24 offset:12832
  ds_read_b64_tr_b16 v[86:87], v24 offset:13344
  ds_read_b64_tr_b16 v[88:89], v24 offset:12864
  ds_read_b64_tr_b16 v[90:91], v24 offset:13376
  ds_read_b64_tr_b16 v[92:93], v24 offset:12896
  ds_read_b64_tr_b16 v[94:95], v24 offset:13408
  v_mov_b32 v1, 0
  s_mov_b32 s70, 4000007
L_spin_64:
  ds_read_b32 v4, v1 offset:668
  s_waitcnt lgkmcnt(0)
  v_cmp_gt_u32 vcc, 1, v4
  s_nop 0
  s_cbranch_vccz L_sdone_65
  s_sleep 1
  s_sub_u32 s70, s70, 1
  s_cbranch_scc0 L_spin_64
L_sdone_65:
  s_waitcnt vmcnt(0)
  buffer_load_dwordx4 v[144:147], v60, s[32:35], s73 offen offset:0 sc1
  buffer_load_dwordx4 v[148:151], v60, s[32:35], s73 offen offset:1024 sc1
  buffer_load_dwordx4 v[152:155], v60, s[32:35], s73 offen offset:2048 sc1
  buffer_load_dwordx4 v[156:159], v60, s[32:35], s73 offen offset:3072 sc1
  buffer_load_dwordx4 v[160:163], v60, s[32:35], s74 offen offset:0 sc1
  buffer_load_dwordx4 v[164:167], v60, s[32:35], s74 offen offset:1024 sc1
  s_waitcnt vmcnt(6)
L_both:
  ds_read_b64_tr_b16 v[96:97], v24 offset:16896
  ds_read_b64_tr_b16 v[98:99], v24 offset:17408
  ds_read_b64_tr_b16 v[100:101], v24 offset:16928
  ds_read_b64_tr_b16 v[102:103], v24 offset:17440
  ds_read_b64_tr_b16 v[104:105], v24 offset:16960
  ds_read_b64_tr_b16 v[106:107], v24 offset:17472
  ds_read_b64_tr_b16 v[108:109], v24 offset:16992
  ds_read_b64_tr_b16 v[110:111], v24 offset:17504
  s_mov_b32 s16, s32
  s_mov_b32 s17, s33
  s_mov_b32 s18, 4194304
  s_mov_b32 s19, 0x20000
  s_mov_b32 s70, 4000007
  s_branch L_opw
L_spin_66:
  buffer_load_dwordx4 v[144:147], v60, s[16:19], s73 offen offset:0 sc1
  buffer_load_dwordx4 v[148:151], v60, s[16:19], s73 offen offset:1024 sc1
  buffer_load_dwordx4 v[152:155], v60, s[16:19], s73 offen offset:2048 sc1
  buffer_load_dwordx4 v[156:159], v60, s[16:19], s73 offen offset:3072 sc1
  buffer_load_dwordx4 v[160:163], v60, s[16:19], s74 offen offset:0 sc1
  buffer_load_dwordx4 v[164:167], v60, s[16:19], s74 offen offset:1024 sc1
L_opw:
  s_waitcnt vmcnt(4)
  v_mfma_f32_16x16x32_bf16 v[32:35], v[146:149], v[64:67], 0
  v_cmp_ne_u64 vcc, s[30:31], v[144:145]
  v_cmp_ne_u64 s[22:23], s[30:31], v[150:151]
  v_mfma_f32_16x16x32_bf16 v[36:39], v[146:149], v[68:71], 0
  s_or_b64 vcc, vcc, s[22:23]
  v_mfma_f32_16x16x32_bf16 v[40:43], v[146:149], v[72:75], 0
  v_mfma_f32_16x16x32_bf16 v[44:47], v[146:149], v[76:79], 0
  s_waitcnt vmcnt(2)
  v_mfma_f32_16x16x32_bf16 v[32:35], v[154:157], v[80:83], v[32:35]
  v_cmp_ne_u64 s[20:21], s[30:31], v[152:153]
  v_cmp_ne_u64 s[22:23], s[30:31], v[158:159]
  v_mfma_f32_16x16x32_bf16 v[36:39], v[154:157], v[84:87], v[36:39]
  s_or_b64 vcc, vcc, s[20:21]
  s_or_b64 vcc, vcc, s[22:23]
  v_mfma_f32_16x16x32_bf16 v[40:43], v[154:157], v[88:91], v[40:43]
  v_mfma_f32_16x16x32_bf16 v[44:47], v[154:157], v[92:95], v[44:47]
  s_waitcnt vmcnt(0) lgkmcnt(0)
  v_mfma_f32_16x16x32_bf16 v[32:35], v[162:165], v[96:99], v[32:35]
  v_cmp_ne_u64 s[20:21], s[30:31], v[160:161]
  v_cmp_ne_u64 s[22:23], s[30:31], v[166:167]
  v_mfma_f32_16x16x32_bf16 v[36:39], v[162:165], v[100:103], v[36:39]
  s_or_b64 vcc, vcc, s[20:21]
  s_or_b64 vcc, vcc, s[22:23]
  v_mfma_f32_16x16x32_bf16 v[40:43], v[162:165], v[104:107], v[40:43]
  v_mfma_f32_16x16x32_bf16 v[44:47], v[162:165], v[108:111], v[44:47]
  s_nop 0
  s_cbranch_vccz L_sdone_67
  s_and_b32 s99, s70, 7
  s_cmp_eq_u32 s46, 1
  s_cselect_b32 s99, 1, s99
  s_cmp_lg_u32 s99, 0
  s_cselect_b32 s16, s32, s24
  s_cselect_b32 s17, s33, s25
  s_sub_u32 s70, s70, 1
  s_cbranch_scc0 L_spin_66
L_sdone_67:
  v_mul_f32 v4, v32, v56
  v_fmac_f32 v4, v33, v57
  v_fmac_f32 v4, v34, v58
  v_fmac_f32 v4, v35, v59
  v_mul_f32 v5, v36, v56
  v_fmac_f32 v5, v37, v57
  v_fmac_f32 v5, v38, v58
  v_fmac_f32 v5, v39, v59
  v_mul_f32 v6, v40, v56
  v_fmac_f32 v6, v41, v57
  v_fmac_f32 v6, v42, v58
  v_fmac_f32 v6, v43, v59
  v_mul_f32 v7, v44, v56
  v_fmac_f32 v7, v45, v57
  v_fmac_f32 v7, v46, v58
  v_fmac_f32 v7, v47, v59
  v_permlane32_swap_b32 v4, v6
  s_nop 0
  v_permlane32_swap_b32 v5, v7
  v_add_f32 v4, v4, v6
  v_add_f32 v5, v5, v7
  s_nop 1
  v_permlane16_swap_b32 v4, v5
  v_add_f32 v4, v4, v5
  ds_write_b32 v61, v4 offset:7168
  s_cmp_lg_u32 s3, 0
  s_waitcnt lgkmcnt(0)
  s_barrier
  s_cbranch_scc1 L_post_wo
  ds_read_b32 v5, v62 offset:7424
  ds_read_b32 v6, v62 offset:7680
  ds_read_b32 v7, v62 offset:7936
  s_waitcnt lgkmcnt(0)
  v_add_f32 v4, v4, v5
  v_add_f32 v6, v6, v7
  v_add_f32 v4, v4, v6
  s_nop 1
  v_mov_b32_dpp v5, v4 quad_perm:[1,0,3,2] row_mask:0xf bank_mask:0xf
  v_cvt_pk_bf16_f32 v4, v4, v5
  s_nop 1
  v_mov_b32_dpp v48, v4 quad_perm:[0,0,0,0] row_mask:0xf bank_mask:0xf
  v_mov_b32_dpp v49, v4 quad_perm:[2,2,2,2] row_mask:0xf bank_mask:0xf
  s_mov_b64 exec, s[8:9]
  buffer_store_dwordx4 v[48:51], v63, s[24:27], s75 offen sc1
  s_barrier
  s_endpgm
L_helper_exit:
  s_endpgm
L_f1:
  s_mov_b32 s12, s48
  s_mov_b32 s13, s49
  s_mov_b32 s14, 1966080
  s_mov_b32 s15, 0x20000
  s_mov_b32 s16, s50
  s_mov_b32 s17, s51
  s_mov_b32 s18, 1966080
  s_mov_b32 s19, 0x20000
  s_sub_u32 s74, s5, 20
  v_lshrrev_b32 v3, 4, v0
  v_and_b32 v2, 7, v0
  v_lshrrev_b32 v62, 3, v0
  v_mul_u32_u24 v62, 3072, v62
  v_lshl_add_u32 v62, v2, 4, v62
  s_lshl3_add_u32 s61, s74, s73
  s_mul_i32 s61, s61, 24576
  s_mul_i32 s68, s4, 384
  s_add_u32 s61, s61, s68
  s_add_u32 s62, s61, 128
  s_add_u32 s63, s61, 256
  s_lshl_b32 s79, s73, 10
  s_add_u32 s79, s79, 8704
  v_mov_b32 v57, 0
  v_mov_b32 v6, s30
  v_mov_b32 v7, s31
  v_mov_b32 v1, 0
  s_mov_b32 s70, 4000007
L_spin_68:
  ds_read_b32 v4, v1 offset:668
  s_waitcnt lgkmcnt(0)
  v_cmp_gt_u32 vcc, 1, v4
  s_nop 0
  s_cbranch_vccz L_sdone_69
  s_sleep 1
  s_sub_u32 s70, s70, 1
  s_cbranch_scc0 L_spin_68
L_sdone_69:
  s_add_u32 m0, s79, 0
  s_nop 0
  buffer_load_dwordx4 v62, s[12:15], s61 offen nt lds
  s_add_u32 m0, s79, 24576
  s_nop 0
  buffer_load_dwordx4 v62, s[16:19], s61 offen nt lds
  s_add_u32 m0, s79, 8192
  s_nop 0
  buffer_load_dwordx4 v62, s[12:15], s62 offen nt lds
  s_add_u32 m0, s79, 32768
  s_nop 0
  buffer_load_dwordx4 v62, s[16:19], s62 offen nt lds
  s_add_u32 m0, s79, 16384
  s_nop 0
  buffer_load_dwordx4 v62, s[12:15], s63 offen nt lds
  s_add_u32 m0, s79, 40960
  s_nop 0
  buffer_load_dwordx4 v62, s[16:19], s63 offen nt lds
  s_setprio 3
  s_cmp_gt_u32 s73, 1
  s_cbranch_scc1 L_f1m
  v_mov_b32 v1, 0
  s_mov_b32 s70, 4000007
L_spin_70:
  ds_read_b32 v4, v1 offset:660
  s_waitcnt lgkmcnt(0)
  v_cmp_gt_u32 vcc, 1, v4
  s_nop 0
  s_cbranch_vccz L_sdone_71
  s_sleep 1
  s_sub_u32 s70, s70, 1
  s_cbranch_scc0 L_spin_70
L_sdone_71:
  v_readfirstlane_b32 s47, v4
  s_lshl1_add_u32 s74, s74, s73
  v_lshl_add_u32 v61, v2, 2, v3
  v_lshlrev_b32 v61, 1, v61
  s_lshl_b32 s68, s74, 6
  v_add_u32 v61, s68, v61
  global_load_ushort v56, v61, s[36:37]
  v_lshlrev_b32 v54, 5, v3
  v_lshl_add_u32 v54, v2, 2, v54
  v_lshlrev_b32 v55, 4, v0
  s_lshl_b32 s72, s4, 9
  s_lshl4_add_u32 s72, s74, s72
  s_add_u32 s72, s72, 2752512
  s_mul_i32 s75, s4, 20
  s_add_u32 s75, s75, s74
  s_lshl_b32 s75, s75, 7
  s_add_u32 s75, s75, 2768896
  s_mov_b64 exec, 1
  buffer_load_dword v104, v54, s[32:35], s75 offen sc1
  buffer_load_dword v105, v55, s[32:35], s72 offen sc1
  s_mov_b64 exec, -1
  s_lshr_b32 s60, s74, 2
  s_lshl_b32 s60, s60, 14
  s_and_b32 s68, s74, 3
  s_lshl_b32 s68, s68, 11
  s_add_u32 s60, s60, s68
  s_lshr_b32 s68, s47, s4
  s_and_b32 s68, s68, 1
  s_lshl_b32 s68, s68, 13
  s_add_u32 s60, s60, s68
  s_add_u32 s60, s60, 1966080
  v_lshlrev_b32 v51, 4, v3
  v_lshl_add_u32 v51, v2, 1, v51
  v_and_b32 v4, 1, v0
  v_mul_u32_u24 v4, 126, v4
  v_add_u32 v51, v51, v4
  s_lshl_b32 s68, s73, 6
  v_add_u32 v51, s68, v51
  s_mov_b32 s77, 0x3f80
  s_mov_b32 s71, 0x3f800000
  v_mov_b32 v14, s30
  v_mov_b32 v15, s31
  v_mov_b32 v8, 0
  v_mov_b32 v9, 0
  v_mov_b32 v10, 0
  v_mov_b32 v11, 0
  v_not_b32 v98, s30
  v_not_b32 v102, s30
  s_waitcnt vmcnt(2)
  s_barrier
  v_lshlrev_b32 v56, 16, v56
  s_mov_b32 s70, 4000007
  s_mov_b64 s[20:21], -1
  s_mov_b64 s[22:23], -1
L_ypoll:
  s_mov_b64 exec, s[20:21]
  buffer_load_dwordx4 v[96:99], v55, s[24:27], s60 offen sc1
  s_mov_b64 exec, s[22:23]
  buffer_load_dwordx4 v[100:103], v55, s[24:27], s60 offen offset:1024 sc1
  s_mov_b64 exec, -1
  v_cmp_ne_u64 s[20:21], s[30:31], v[98:99]
  v_cmp_ne_u64 s[22:23], s[30:31], v[102:103]
  s_nop 0
  s_or_b64 vcc, s[20:21], s[22:23]
  s_cbranch_scc0 L_yok
  v_cmp_ne_u64 s[20:21], s[30:31], v[98:99]
  v_cmp_ne_u64 s[22:23], s[30:31], v[102:103]
  s_nop 0
  s_or_b64 vcc, s[20:21], s[22:23]
  s_cbranch_scc0 L_yok
  v_cmp_ne_u64 s[20:21], s[30:31], v[98:99]
  v_cmp_ne_u64 s[22:23], s[30:31], v[102:103]
  s_nop 0
  s_or_b64 vcc, s[20:21], s[22:23]
  s_cbranch_scc0 L_yok
  v_cmp_ne_u64 s[20:21], s[30:31], v[98:99]
  v_cmp_ne_u64 s[22:23], s[30:31], v[102:103]
  s_nop 0
  s_or_b64 vcc, s[20:21], s[22:23]
  s_cbranch_scc0 L_yok
  v_cmp_ne_u64 s[20:21], s[30:31], v[98:99]
  v_cmp_ne_u64 s[22:23], s[30:31], v[102:103]
  s_nop 0
  s_or_b64 vcc, s[20:21], s[22:23]
  s_cbranch_scc0 L_yok
  v_cmp_ne_u64 s[20:21], s[30:31], v[98:99]
  v_cmp_ne_u64 s[22:23], s[30:31], v[102:103]
  s_nop 0
  s_or_b64 vcc, s[20:21], s[22:23]
  s_cbranch_scc0 L_yok
  s_waitcnt vmcnt(16)
  s_sub_u32 s70, s70, 1
  s_cbranch_scc0 L_ypoll
L_yok:
  v_dot2c_f32_bf16 v8, s77, v96
  v_dot2c_f32_bf16 v10, s77, v97
  v_dot2c_f32_bf16 v9, s71, v96
  v_dot2c_f32_bf16 v11, s71, v97
  v_dot2c_f32_bf16 v8, s77, v100
  v_dot2c_f32_bf16 v10, s77, v101
  v_dot2c_f32_bf16 v9, s71, v100
  v_dot2c_f32_bf16 v11, s71, v101
  s_nop 0
  v_permlane32_swap_b32 v8, v10
  s_nop 0
  v_permlane32_swap_b32 v9, v11
  v_add_f32 v8, v8, v10
  v_add_f32 v9, v9, v11
  s_nop 1
  v_permlane16_swap_b32 v8, v9
  v_add_f32 v8, v8, v9
  s_nop 1
  v_add_f32_dpp v8, v8, v8 row_ror:8 row_mask:0xf bank_mask:0xf
  v_cvt_pk_bf16_f32 v8, v57, v8
  v_add_f32 v12, v8, v56
  s_nop 1
  v_mov_b32_dpp v13, v12 quad_perm:[1,0,3,2] row_mask:0xf bank_mask:0xf
  v_cvt_pk_bf16_f32 v12, v12, v13
  ds_write_b32 v51, v12 offset:7168
  v_lshlrev_b32 v4, 16, v12
  v_mul_f32 v5, v4, v4
  s_nop 0
  v_add_f32_dpp v4, v4, v4 quad_perm:[1,0,3,2] row_mask:0xf bank_mask:0xf
  v_add_f32_dpp v5, v5, v5 quad_perm:[1,0,3,2] row_mask:0xf bank_mask:0xf
  s_nop 0
  v_add_f32_dpp v4, v4, v4 quad_perm:[2,3,0,1] row_mask:0xf bank_mask:0xf
  v_add_f32_dpp v5, v5, v5 quad_perm:[2,3,0,1] row_mask:0xf bank_mask:0xf
  s_nop 0
  v_add_f32_dpp v4, v4, v4 row_half_mirror row_mask:0xf bank_mask:0xf
  v_add_f32_dpp v5, v5, v5 row_half_mirror row_mask:0xf bank_mask:0xf
  s_waitcnt lgkmcnt(0)
  s_barrier
  v_mov_b32_dpp v13, v12 quad_perm:[2,3,2,3] row_mask:0xf bank_mask:0xf
  v_mov_b32 v8, v4
  v_mov_b32 v9, v5
  s_nop 0
  v_permlane16_swap_b32 v4, v8
  v_permlane16_swap_b32 v5, v9
  v_add_f32 v4, v4, v8
  v_add_f32 v5, v5, v9
  v_mov_b32 v8, v4
  v_mov_b32 v9, v5
  s_nop 0
  v_permlane32_swap_b32 v4, v8
  v_permlane32_swap_b32 v5, v9
  v_add_f32 v4, v4, v8
  v_add_f32 v5, v5, v9
  s_mov_b32 exec_lo, 0x1
  s_mov_b32 exec_hi, 0x0
  buffer_store_dwordx4 v[4:7], v55, s[32:35], s72 offen
  s_mov_b32 exec_lo, 0x110011
  s_mov_b32 exec_hi, 0x110011
  buffer_store_dwordx4 v[12:15], v54, s[32:35], s75 offen
  s_mov_b64 exec, -1
  s_cmp_lg_u32 s46, 1
  s_cbranch_scc1 L_slow_72
L_back_73:
  s_endpgm
L_f1m:
  s_sub_u32 s68, s73, 2
  s_lshr_b32 s78, s68, 1
  s_and_b32 s69, s73, 1
  v_lshlrev_b32 v58, 7, v3
  v_bfe_u32 v4, v0, 2, 2
  v_lshl_add_u32 v58, v4, 9, v58
  v_and_b32 v4, 3, v0
  v_lshl_add_u32 v58, v4, 3, v58
  s_lshl_b32 s75, s78, 13
  s_lshl_b32 s68, s69, 6
  s_add_u32 s75, s75, s68
  v_add_u32 v58, s75, v58
  v_lshlrev_b32 v52, 4, v3
  v_and_b32 v59, 1, v3
  v_cmp_eq_u32 s[62:63], 1, v59
  v_mul_u32_u24 v59, 3072, v59
  v_bfe_u32 v4, v0, 3, 1
  v_lshl_add_u32 v59, v4, 9, v59
  v_lshl_add_u32 v59, v2, 4, v59
  s_mul_i32 s76, s4, 3
  s_add_u32 s76, s76, s78
  s_lshl1_add_u32 s76, s76, s69
  s_mul_i32 s76, s76, 6144
  s_lshr_b32 s68, s74, 2
  s_lshl_b32 s68, s68, 10
  s_add_u32 s76, s76, s68
  s_and_b32 s68, s74, 3
  s_lshl_b32 s68, s68, 7
  s_add_u32 s76, s76, s68
  s_add_u32 s77, s76, 3145728
  s_add_u32 s76, s76, 2228224
  v_mov_b32 v8, 0x3f803f80
  v_mov_b32 v9, 0x3f803f80
  v_mov_b32 v10, 0x3f803f80
  v_mov_b32 v11, 0x3f803f80
  v_mov_b32 v34, s30
  v_mov_b32 v35, s31
  s_waitcnt vmcnt(0)
  s_barrier
  ds_read_b64_tr_b16 v[64:65], v58 offset:8704
  ds_read_b64_tr_b16 v[66:67], v58 offset:10752
  ds_read_b64_tr_b16 v[68:69], v58 offset:8736
  ds_read_b64_tr_b16 v[70:71], v58 offset:10784
  ds_read_b64_tr_b16 v[72:73], v58 offset:33280
  ds_read_b64_tr_b16 v[74:75], v58 offset:35328
  ds_read_b64_tr_b16 v[76:77], v58 offset:33312
  ds_read_b64_tr_b16 v[78:79], v58 offset:35360
  ds_read_b64_tr_b16 v[80:81], v58 offset:12800
  ds_read_b64_tr_b16 v[82:83], v58 offset:14848
  ds_read_b64_tr_b16 v[84:85], v58 offset:12832
  ds_read_b64_tr_b16 v[86:87], v58 offset:14880
  ds_read_b64_tr_b16 v[88:89], v58 offset:37376
  ds_read_b64_tr_b16 v[90:91], v58 offset:39424
  ds_read_b64_tr_b16 v[92:93], v58 offset:37408
  ds_read_b64_tr_b16 v[94:95], v58 offset:39456
  s_waitcnt lgkmcnt(0)
  v_mfma_f32_16x16x32_bf16 v[16:19], v[8:11], v[64:67], 0
  v_mfma_f32_16x16x32_bf16 v[20:23], v[8:11], v[68:71], 0
  v_mfma_f32_16x16x32_bf16 v[24:27], v[8:11], v[72:75], 0
  v_mfma_f32_16x16x32_bf16 v[28:31], v[8:11], v[76:79], 0
  v_mfma_f32_16x16x32_bf16 v[16:19], v[8:11], v[80:83], v[16:19]
  v_mfma_f32_16x16x32_bf16 v[20:23], v[8:11], v[84:87], v[20:23]
  v_mfma_f32_16x16x32_bf16 v[24:27], v[8:11], v[88:91], v[24:27]
  v_mfma_f32_16x16x32_bf16 v[28:31], v[8:11], v[92:95], v[28:31]
  s_nop 5
  v_cndmask_b32 v32, v16, v20, s[62:63]
  s_nop 0
  v_cndmask_b32 v33, v24, v28, s[62:63]
  s_mov_b32 exec_lo, 0xffffffff
  s_mov_b32 exec_hi, 0x0
  buffer_store_dwordx4 v[32:35], v59, s[32:35], s77 offen
  s_mov_b64 exec, -1
  s_cmp_lg_u32 s46, 1
  s_cbranch_scc1 L_slow_74
L_back_75:
  s_barrier
  ds_read_b128 v[8:11], v52 offset:7168
  ds_read_b128 v[12:15], v52 offset:7232
  s_waitcnt lgkmcnt(1)
  v_mfma_f32_16x16x32_bf16 v[16:19], v[8:11], v[64:67], 0
  v_mfma_f32_16x16x32_bf16 v[20:23], v[8:11], v[68:71], 0
  v_mfma_f32_16x16x32_bf16 v[24:27], v[8:11], v[72:75], 0
  v_mfma_f32_16x16x32_bf16 v[28:31], v[8:11], v[76:79], 0
  s_waitcnt lgkmcnt(0)
  v_mfma_f32_16x16x32_bf16 v[16:19], v[12:15], v[80:83], v[16:19]
  v_mfma_f32_16x16x32_bf16 v[20:23], v[12:15], v[84:87], v[20:23]
  v_mfma_f32_16x16x32_bf16 v[24:27], v[12:15], v[88:91], v[24:27]
  v_mfma_f32_16x16x32_bf16 v[28:31], v[12:15], v[92:95], v[28:31]
  s_nop 5
  v_cndmask_b32 v4, v16, v20, s[62:63]
  s_nop 0
  v_cndmask_b32 v5, v24, v28, s[62:63]
  s_mov_b32 exec_lo, 0xffffffff
  s_mov_b32 exec_hi, 0x0
  buffer_store_dwordx4 v[4:7], v59, s[32:35], s76 offen
  s_mov_b64 exec, -1
  s_cmp_lg_u32 s46, 1
  s_cbranch_scc1 L_slow_76
L_back_77:
  s_endpgm
L_post_wo:
  s_cmp_gt_u32 s5, 11
  s_cbranch_scc1 L_end
  s_cmp_eq_u32 s3, 3
  s_cbranch_scc1 L_end
  v_mov_b32 v57, 0
  s_cmp_eq_u32 s3, 1
  s_cbranch_scc1 L_hid
  s_barrier
  s_and_b32 s68, s4, 1
  s_lshl_b32 s68, s68, 2
  s_sub_u32 s68, 12, s68
  s_cmp_ge_u32 s5, s68
  s_cbranch_scc1 L_end
  s_mul_i32 s72, s4, 5
  s_add_u32 s72, s72, 1
  s_lshr_b32 s72, s72, 1
  s_lshr_b32 s68, s5, 2
  s_add_u32 s72, s72, s68
  s_and_b32 s73, s5, 3
  v_lshrrev_b32 v2, 1, v0
  v_lshlrev_b32 v2, 7, v2
  v_and_b32 v3, 1, v0
  v_lshl_add_u32 v96, v3, 4, v2
  s_lshl_b32 s10, s72, 15
  s_lshr_b32 s68, s47, s4
  s_and_b32 s68, s68, 1
  s_lshl_b32 s68, s68, 13
  s_add_u32 s10, s10, s68
  s_lshl_b32 s68, s73, 5
  s_add_u32 s10, s10, s68
  s_add_u32 s10, s10, 1048576
  s_add_u32 s11, s10, 4096
  s_add_u32 s12, s10, 16384
  v_lshrrev_b32 v4, 4, v0
  v_lshl_add_u32 v97, v3, 2, v4
  v_lshlrev_b32 v97, 1, v97
  v_lshlrev_b32 v99, 5, v4
  s_and_b32 s68, s73, 1
  s_lshl_b32 s68, s68, 5
  v_lshl_add_u32 v98, v3, 4, s68
  s_mul_i32 s13, s4, 20
  s_add_u32 s13, s13, s72
  s_lshl_b32 s13, s13, 7
  s_lshr_b32 s68, s73, 1
  s_lshl4_add_u32 s13, s68, s13
  s_add_u32 s13, s13, 2768896
  s_lshl2_add_u32 s14, s72, s73
  s_lshl_b32 s14, s14, 4
  s_mov_b32 s8, 0x30003
  s_mov_b32 s9, 0x30003
  s_mov_b32 s77, 0x3f80
  s_mov_b32 s71, 0x3f800000
  v_mov_b32 v8, 0
  v_mov_b32 v9, 0
  v_mov_b32 v10, 0
  v_mov_b32 v11, 0
  s_mov_b32 s64, s54
  s_mov_b32 s65, s55
  s_mov_b32 s66, 1280
  s_mov_b32 s67, 0x20000
  s_setprio 0
  v_mov_b32 v1, 0
  s_mov_b32 s70, 4000007
L_spin_78:
  ds_read_b32 v4, v1 offset:736
  s_waitcnt lgkmcnt(0)
  v_cmp_gt_u32 vcc, 1, v4
  s_nop 0
  s_cbranch_vccz L_sdone_79
  s_sub_u32 s70, s70, 1
  s_cbranch_scc0 L_spin_78
L_sdone_79:
  s_sleep 16
  s_mov_b32 s16, s32
  s_mov_b32 s17, s33
  s_mov_b32 s18, 4194304
  s_mov_b32 s19, 0x20000
  s_mov_b32 s70, 4000007
L_spin_80:
  buffer_load_dwordx4 v[4:7], v99, s[16:19], s13 offen sc1
  buffer_load_dwordx4 v[16:19], v96, s[24:27], s10 offen sc1
  buffer_load_dwordx4 v[20:23], v96, s[24:27], s11 offen sc1
  buffer_load_dwordx4 v[24:27], v96, s[24:27], s12 offen sc1
  s_waitcnt vmcnt(0)
  v_cmp_ne_u64 vcc, s[30:31], v[6:7]
  v_cmp_ne_u64 s[20:21], s[30:31], v[18:19]
  v_cmp_ne_u64 s[22:23], s[30:31], v[22:23]
  s_or_b64 vcc, vcc, s[20:21]
  v_cmp_ne_u64 s[20:21], s[30:31], v[26:27]
  s_or_b64 vcc, vcc, s[22:23]
  s_or_b64 vcc, vcc, s[20:21]
  s_nop 0
  s_cbranch_vccz L_sdone_81
  s_and_b32 s99, s70, 7
  s_cmp_eq_u32 s46, 1
  s_cselect_b32 s99, 1, s99
  s_cmp_lg_u32 s99, 0
  s_cselect_b32 s16, s32, s24
  s_cselect_b32 s17, s33, s25
  s_sub_u32 s70, s70, 1
  s_cbranch_scc0 L_spin_80
L_sdone_81:
L_finc:
  v_dot2c_f32_bf16 v8, s77, v16
  v_dot2c_f32_bf16 v10, s77, v17
  v_dot2c_f32_bf16 v9, s71, v16
  v_dot2c_f32_bf16 v11, s71, v17
  v_dot2c_f32_bf16 v8, s77, v20
  v_dot2c_f32_bf16 v10, s77, v21
  v_dot2c_f32_bf16 v9, s71, v20
  v_dot2c_f32_bf16 v11, s71, v21
  v_dot2c_f32_bf16 v8, s77, v24
  v_dot2c_f32_bf16 v10, s77, v25
  v_dot2c_f32_bf16 v9, s71, v24
  v_dot2c_f32_bf16 v11, s71, v25
  v_lshrrev_b64 v[58:59], v98, v[4:5]
  v_permlane32_swap_b32 v8, v10
  s_nop 0
  v_permlane32_swap_b32 v9, v11
  v_add_f32 v8, v8, v10
  v_add_f32 v9, v9, v11
  v_lshlrev_b32 v58, 16, v58
  s_nop 0
  v_permlane16_swap_b32 v8, v9
  v_add_f32 v8, v8, v9
  s_nop 1
  v_add_f32_dpp v8, v8, v8 row_ror:8 row_mask:0xf bank_mask:0xf
  s_nop 1
  v_add_f32_dpp v8, v8, v8 row_ror:4 row_mask:0xf bank_mask:0xf
  s_nop 1
  v_add_f32_dpp v8, v8, v8 quad_perm:[2,3,0,1] row_mask:0xf bank_mask:0xf
  v_cvt_pk_bf16_f32 v8, v57, v8
  v_add_f32 v8, v8, v58
  v_cvt_pk_bf16_f32 v8, v8, v8
  s_mov_b64 exec, s[8:9]
  buffer_store_short v8, v97, s[64:67], s14 offen
  s_cmp_lg_u32 s14, 0
  s_cbranch_scc1 L_fin_exit
  s_mov_b64 exec, 1
  v_mov_b32 v4, s30
  v_mov_b32 v5, s31
  s_mov_b32 s68, 917504
  buffer_store_dwordx2 v[4:5], v57, s[24:27], s68 offen
L_fin_exit:
  s_endpgm
L_hid:
  s_mul_i32 s72, s4, 12
  s_add_u32 s72, s72, s5
  v_lshrrev_b32 v4, 5, v0
  v_and_b32 v2, 7, v0
  v_lshl_add_u32 v62, v4, 3, v2
  v_lshlrev_b32 v62, 1, v62
  v_lshlrev_b32 v63, 2, v2
  v_lshlrev_b32 v60, 4, v0
  v_and_b32 v3, 31, v0
  v_lshlrev_b32 v61, 4, v3
  s_lshl_b32 s65, s4, 9
  s_add_u32 s65, s65, 2752512
  s_mul_i32 s60, s72, 3072
  s_add_u32 s62, s60, 3145728
  s_add_u32 s60, s60, 2228224
  s_mov_b32 s8, 0xfffff
  s_mov_b32 s9, 0xfffff
  s_mov_b32 s10, 0xffff
  s_mov_b32 s11, 0xffff
  v_mov_b32 v59, 1
  v_mov_b32 v24, 0
  v_mov_b32 v25, 0
  v_mov_b32 v26, s30
  v_mov_b32 v27, s31
  v_mov_b32 v136, 0
  v_mov_b32 v137, 0
  v_mov_b32 v138, s30
  v_mov_b32 v139, s31
  v_mov_b32 v140, 0
  v_mov_b32 v141, 0
  v_mov_b32 v142, s30
  v_mov_b32 v143, s31
  v_not_b32 v18, s30
  v_not_b32 v22, s30
  v_not_b32 v130, s30
  v_not_b32 v134, s30
  s_mov_b64 exec, s[10:11]
  v_not_b32 v26, s30
  v_not_b32 v138, s30
  s_mov_b64 exec, s[8:9]
  v_not_b32 v142, s30
  s_mov_b64 exec, -1
  s_barrier
  v_cmp_ne_u64 vcc, s[30:31], v[18:19]
  v_cmp_ne_u64 s[20:21], s[30:31], v[22:23]
  v_cmp_ne_u64 s[22:23], s[30:31], v[26:27]
  s_or_b64 vcc, vcc, s[20:21]
  s_or_b64 vcc, vcc, s[22:23]
  s_nop 0
  s_cbranch_vccz L_pok_83
  s_cmp_lg_u32 s46, 1
  s_cbranch_scc1 L_pslow_82
  s_mov_b32 s70, 4000007
L_fp_84:
  buffer_load_dwordx4 v[16:19], v60, s[32:35], s62 offen sc1
  buffer_load_dwordx4 v[20:23], v60, s[32:35], s62 offen offset:1024 sc1
  s_mov_b64 exec, s[10:11]
  buffer_load_dwordx4 v[24:27], v60, s[32:35], s62 offen offset:2048 sc1
  s_mov_b64 exec, -1
  s_mov_b64 exec, s[8:9]
  buffer_load_dwordx4 v[140:143], v61, s[32:35], s65 offen sc1
  s_mov_b64 exec, -1
  buffer_load_dwordx4 v[128:131], v60, s[32:35], s60 offen sc1
  buffer_load_dwordx4 v[132:135], v60, s[32:35], s60 offen offset:1024 sc1
  s_mov_b64 exec, s[10:11]
  buffer_load_dwordx4 v[136:139], v60, s[32:35], s60 offen offset:2048 sc1
  s_mov_b64 exec, -1
  v_cmp_ne_u64 vcc, s[30:31], v[18:19]
  v_cmp_ne_u64 s[20:21], s[30:31], v[22:23]
  v_cmp_ne_u64 s[22:23], s[30:31], v[26:27]
  s_or_b64 vcc, vcc, s[20:21]
  s_or_b64 vcc, vcc, s[22:23]
  s_nop 0
  s_cbranch_vccz L_pok_83
  v_cmp_ne_u64 vcc, s[30:31], v[18:19]
  v_cmp_ne_u64 s[20:21], s[30:31], v[22:23]
  v_cmp_ne_u64 s[22:23], s[30:31], v[26:27]
  s_or_b64 vcc, vcc, s[20:21]
  s_or_b64 vcc, vcc, s[22:23]
  s_nop 0
  s_cbranch_vccz L_pok_83
  v_cmp_ne_u64 vcc, s[30:31], v[18:19]
  v_cmp_ne_u64 s[20:21], s[30:31], v[22:23]
  v_cmp_ne_u64 s[22:23], s[30:31], v[26:27]
  s_or_b64 vcc, vcc, s[20:21]
  s_or_b64 vcc, vcc, s[22:23]
  s_nop 0
  s_cbranch_vccz L_pok_83
  v_cmp_ne_u64 vcc, s[30:31], v[18:19]
  v_cmp_ne_u64 s[20:21], s[30:31], v[22:23]
  v_cmp_ne_u64 s[22:23], s[30:31], v[26:27]
  s_or_b64 vcc, vcc, s[20:21]
  s_or_b64 vcc, vcc, s[22:23]
  s_nop 0
  s_cbranch_vccz L_pok_83
  v_cmp_ne_u64 vcc, s[30:31], v[18:19]
  v_cmp_ne_u64 s[20:21], s[30:31], v[22:23]
  v_cmp_ne_u64 s[22:23], s[30:31], v[26:27]
  s_or_b64 vcc, vcc, s[20:21]
  s_or_b64 vcc, vcc, s[22:23]
  s_nop 0
  s_cbranch_vccz L_pok_83
  v_cmp_ne_u64 vcc, s[30:31], v[18:19]
  v_cmp_ne_u64 s[20:21], s[30:31], v[22:23]
  v_cmp_ne_u64 s[22:23], s[30:31], v[26:27]
  s_or_b64 vcc, vcc, s[20:21]
  s_or_b64 vcc, vcc, s[22:23]
  s_nop 0
  s_cbranch_vccz L_pok_83
  v_cmp_ne_u64 vcc, s[30:31], v[18:19]
  v_cmp_ne_u64 s[20:21], s[30:31], v[22:23]
  v_cmp_ne_u64 s[22:23], s[30:31], v[26:27]
  s_or_b64 vcc, vcc, s[20:21]
  s_or_b64 vcc, vcc, s[22:23]
  s_nop 0
  s_cbranch_vccz L_pok_83
  v_cmp_ne_u64 vcc, s[30:31], v[18:19]
  v_cmp_ne_u64 s[20:21], s[30:31], v[22:23]
  v_cmp_ne_u64 s[22:23], s[30:31], v[26:27]
  s_or_b64 vcc, vcc, s[20:21]
  s_or_b64 vcc, vcc, s[22:23]
  s_nop 0
  s_cbranch_vccz L_pok_83
  s_waitcnt vmcnt(14)
  s_sub_u32 s70, s70, 1
  s_cbranch_scc0 L_fp_84
L_pok_83:
  v_pk_add_f32 v[40:41], v[16:17], v[20:21]
  v_pk_add_f32 v[40:41], v[40:41], v[24:25]
  s_nop 1
  v_add_f32_dpp v40, v40, v40 row_ror:8 row_mask:0xf bank_mask:0xf
  v_add_f32_dpp v41, v41, v41 row_ror:8 row_mask:0xf bank_mask:0xf
  v_mov_b32 v42, v40
  v_mov_b32 v43, v41
  s_nop 0
  v_permlane16_swap_b32 v40, v42
  v_permlane16_swap_b32 v41, v43
  v_add_f32 v40, v40, v42
  v_add_f32 v41, v41, v43
  v_cmp_ne_u64 vcc, s[30:31], v[142:143]
  s_nop 0
  s_cbranch_vccz L_pok_88
  s_cmp_lg_u32 s46, 1
  s_cbranch_scc1 L_pslow_87
  s_mov_b32 s70, 4000007
L_fp_89:
  s_mov_b64 exec, s[8:9]
  buffer_load_dwordx4 v[140:143], v61, s[32:35], s65 offen sc1
  s_mov_b64 exec, -1
  v_cmp_ne_u64 vcc, s[30:31], v[142:143]
  s_nop 0
  s_cbranch_vccz L_pok_88
  v_cmp_ne_u64 vcc, s[30:31], v[142:143]
  s_nop 0
  s_cbranch_vccz L_pok_88
  s_waitcnt vmcnt(12)
  s_sub_u32 s70, s70, 1
  s_cbranch_scc0 L_fp_89
L_pok_88:
  s_cmp_lg_u32 s46, 1
  s_cbranch_scc1 L_nopre
  buffer_load_dwordx4 v[128:131], v60, s[32:35], s60 offen sc1
  buffer_load_dwordx4 v[132:135], v60, s[32:35], s60 offen offset:1024 sc1
  s_mov_b64 exec, s[10:11]
  buffer_load_dwordx4 v[136:139], v60, s[32:35], s60 offen offset:2048 sc1
  s_mov_b64 exec, -1
L_nopre:
  v_add_f32_dpp v36, v140, v140 quad_perm:[1,0,3,2] row_mask:0xf bank_mask:0xf
  v_add_f32_dpp v37, v141, v141 quad_perm:[1,0,3,2] row_mask:0xf bank_mask:0xf
  s_nop 0
  v_add_f32_dpp v36, v36, v36 quad_perm:[2,3,0,1] row_mask:0xf bank_mask:0xf
  v_add_f32_dpp v37, v37, v37 quad_perm:[2,3,0,1] row_mask:0xf bank_mask:0xf
  s_nop 0
  v_add_f32_dpp v36, v36, v36 row_half_mirror row_mask:0xf bank_mask:0xf
  v_add_f32_dpp v37, v37, v37 row_half_mirror row_mask:0xf bank_mask:0xf
  s_nop 0
  v_add_f32_dpp v46, v36, v36 row_mirror row_mask:0xf bank_mask:0xf
  v_add_f32_dpp v47, v37, v37 row_mirror row_mask:0xf bank_mask:0xf
  v_add_f32_dpp v36, v36, v36 row_mirror row_mask:0xf bank_mask:0xf
  v_add_f32_dpp v37, v37, v37 row_mirror row_mask:0xf bank_mask:0xf
  s_nop 0
  v_permlane16_swap_b32 v36, v46
  v_permlane16_swap_b32 v37, v47
  v_pk_add_f32 v[36:37], v[36:37], v[46:47]
  s_cbranch_scc1 L_nopre2
  buffer_load_dwordx4 v[128:131], v60, s[32:35], s60 offen sc1
  buffer_load_dwordx4 v[132:135], v60, s[32:35], s60 offen offset:1024 sc1
  s_mov_b64 exec, s[10:11]
  buffer_load_dwordx4 v[136:139], v60, s[32:35], s60 offen offset:2048 sc1
  s_mov_b64 exec, -1
L_nopre2:
  v_mul_f32 v44, 0x3acccccd, v36
  v_mul_f32 v45, 0x3acccccd, v37
  v_fma_f32 v45, -v44, v44, v45
  v_max_f32 v45, 0, v45
  v_cvt_pk_bf16_f32 v45, v57, v45
  v_cvt_pk_bf16_f32 v44, v57, v44
  v_add_f32 v45, 0x3727c5ac, v45
  v_cvt_pk_bf16_f32 v45, v57, v45
  v_sqrt_f32 v45, v45
  v_mul_f32 v40, v44, v40
  v_cvt_pk_bf16_f32 v45, v57, v45
  v_rcp_f32 v45, v45
  v_mul_f32 v41, v44, v41
  v_cmp_ne_u64 vcc, s[30:31], v[130:131]
  v_cmp_ne_u64 s[20:21], s[30:31], v[134:135]
  v_cmp_ne_u64 s[22:23], s[30:31], v[138:139]
  s_or_b64 vcc, vcc, s[20:21]
  s_or_b64 vcc, vcc, s[22:23]
  s_nop 0
  s_cbranch_vccz L_pok_93
  s_cmp_lg_u32 s46, 1
  s_cbranch_scc1 L_pslow_92
  s_mov_b32 s70, 4000007
L_fp_94:
  buffer_load_dwordx4 v[128:131], v60, s[32:35], s60 offen sc1
  buffer_load_dwordx4 v[132:135], v60, s[32:35], s60 offen offset:1024 sc1
  s_mov_b64 exec, s[10:11]
  buffer_load_dwordx4 v[136:139], v60, s[32:35], s60 offen offset:2048 sc1
  s_mov_b64 exec, -1
  v_cmp_ne_u64 vcc, s[30:31], v[130:131]
  v_cmp_ne_u64 s[20:21], s[30:31], v[134:135]
  v_cmp_ne_u64 s[22:23], s[30:31], v[138:139]
  s_or_b64 vcc, vcc, s[20:21]
  s_or_b64 vcc, vcc, s[22:23]
  s_nop 0
  s_cbranch_vccz L_pok_93
  s_waitcnt vmcnt(12)
  s_sub_u32 s70, s70, 1
  s_cbranch_scc0 L_fp_94
L_pok_93:
L_hidc:
  v_pk_add_f32 v[8:9], v[128:129], v[132:133]
  v_pk_add_f32 v[8:9], v[8:9], v[136:137]
  s_nop 1
  v_add_f32_dpp v10, v8, v8 row_ror:8 row_mask:0xf bank_mask:0xf
  v_add_f32_dpp v11, v9, v9 row_ror:8 row_mask:0xf bank_mask:0xf
  v_add_f32_dpp v8, v8, v8 row_ror:8 row_mask:0xf bank_mask:0xf
  v_add_f32_dpp v9, v9, v9 row_ror:8 row_mask:0xf bank_mask:0xf
  s_nop 0
  v_permlane16_swap_b32 v8, v10
  v_permlane16_swap_b32 v9, v11
  v_add_f32 v8, v8, v10
  v_sub_f32 v8, v8, v40
  v_mul_f32 v8, v8, v45
  v_cvt_pk_bf16_f32 v8, v57, v8
  v_mul_f32 v12, 0xbfb8aa3b, v8
  v_exp_f32 v12, v12
  v_add_f32 v9, v9, v11
  v_add_f32 v12, 1.0, v12
  v_rcp_f32 v12, v12
  v_sub_f32 v9, v9, v41
  v_mul_f32 v9, v9, v45
  v_mul_f32 v8, v8, v12
  v_cvt_pk_bf16_f32 v9, v57, v9
  v_cvt_pk_bf16_f32 v8, v57, v8
  v_mul_f32 v8, v8, v9
  v_cvt_pk_bf16_f32 v8, v8, v8
  ds_write_b16 v62, v8 offset:704
  ds_write_b32 v63, v59 offset:736
  s_endpgm
L_f2:
  s_mov_b32 s8, s52
  s_mov_b32 s9, s53
  s_mov_b32 s10, 1966080
  s_mov_b32 s11, 0x20000
  v_mov_b32 v17, 0
  s_mov_b32 s70, 4000007
L_spin_97:
  ds_read_b32 v16, v17 offset:660
  s_waitcnt lgkmcnt(0)
  v_cmp_gt_u32 vcc, 1, v16
  s_nop 0
  s_cbranch_vccz L_sdone_98
  s_sleep 1
  s_sub_u32 s70, s70, 1
  s_cbranch_scc0 L_spin_97
L_sdone_98:
  v_readfirstlane_b32 s47, v16
  s_mul_i32 s72, s4, 12
  s_add_u32 s72, s72, s5
  v_mov_b32 v57, 0
  s_sub_u32 s68, s3, 7
  s_lshl_b32 s69, s68, 8
  v_lshlrev_b32 v58, 2, v0
  v_add_u32 v58, s69, v58
  v_lshrrev_b32 v2, 4, v0
  v_lshl_add_u32 v2, s68, 2, v2
  v_mul_u32_u24 v3, 52, v2
  v_lshrrev_b32 v3, 8, v3
  v_mul_u32_u24 v4, 5, v3
  v_sub_u32 v4, v2, v4
  v_cmp_lt_u32 vcc, 2, v4
  v_lshlrev_b32 v3, 1, v3
  s_nop 0
  v_addc_co_u32 v3, vcc, 0, v3, vcc
  v_lshrrev_b32 v3, v3, s47
  v_and_b32 v3, 1, v3
  v_lshlrev_b32 v116, 15, v2
  v_lshl_add_u32 v116, v3, 13, v116
  v_bfe_u32 v3, v0, 1, 3
  v_lshl_add_u32 v116, v3, 4, v116
  s_lshr_b32 s79, s72, 6
  s_lshl_b32 s79, s79, 14
  s_and_b32 s68, s72, 63
  s_lshl_b32 s68, s68, 7
  s_add_u32 s79, s79, s68
  s_add_u32 s79, s79, 1048576
  s_mov_b32 s60, 0x05040100
  s_mov_b32 s61, 0x07060302
  s_mul_i32 s62, s72, 20480
  v_lshrrev_b32 v2, 4, v0
  v_mul_u32_u24 v2, 1280, v2
  v_and_b32 v3, 15, v0
  v_lshl_add_u32 v2, v3, 4, v2
  s_add_u32 s62, s62, s69
  s_lshl_b32 s63, s69, 4
  v_lshlrev_b32 v3, 2, v0
  v_add_u32 v3, s63, v3
  s_add_u32 s63, s63, 8704
  s_barrier
  s_add_u32 m0, s63, 0
  s_nop 0
  buffer_load_dwordx4 v2, s[8:11], s62 offen nt lds
  s_add_u32 s62, s62, 5120
  s_add_u32 m0, s63, 1024
  s_nop 0
  buffer_load_dwordx4 v2, s[8:11], s62 offen nt lds
  s_add_u32 s62, s62, 5120
  s_add_u32 m0, s63, 2048
  s_nop 0
  buffer_load_dwordx4 v2, s[8:11], s62 offen nt lds
  s_add_u32 s62, s62, 5120
  s_add_u32 m0, s63, 3072
  s_nop 0
  buffer_load_dwordx4 v2, s[8:11], s62 offen nt lds
  s_add_u32 s62, s62, 5120
  s_barrier
  s_waitcnt vmcnt(0)
  ds_read_b32 v64, v3 offset:8704
  ds_read_b32 v65, v3 offset:8960
  ds_read_b32 v66, v3 offset:9216
  ds_read_b32 v67, v3 offset:9472
  ds_read_b32 v68, v3 offset:9728
  ds_read_b32 v69, v3 offset:9984
  ds_read_b32 v70, v3 offset:10240
  ds_read_b32 v71, v3 offset:10496
  ds_read_b32 v72, v3 offset:10752
  ds_read_b32 v73, v3 offset:11008
  ds_read_b32 v74, v3 offset:11264
  ds_read_b32 v75, v3 offset:11520
  ds_read_b32 v76, v3 offset:11776
  ds_read_b32 v77, v3 offset:12032
  ds_read_b32 v78, v3 offset:12288
  ds_read_b32 v79, v3 offset:12544
  s_waitcnt lgkmcnt(0)
  v_perm_b32 v80, v65, v64, s60
  v_perm_b32 v88, v65, v64, s61
  v_perm_b32 v81, v67, v66, s60
  v_perm_b32 v89, v67, v66, s61
  v_perm_b32 v82, v69, v68, s60
  v_perm_b32 v90, v69, v68, s61
  v_perm_b32 v83, v71, v70, s60
  v_perm_b32 v91, v71, v70, s61
  v_perm_b32 v84, v73, v72, s60
  v_perm_b32 v92, v73, v72, s61
  v_perm_b32 v85, v75, v74, s60
  v_perm_b32 v93, v75, v74, s61
  v_perm_b32 v86, v77, v76, s60
  v_perm_b32 v94, v77, v76, s61
  v_perm_b32 v87, v79, v78, s60
  v_perm_b32 v95, v79, v78, s61
  v_mov_b32 v16, 0
  v_mov_b32 v17, 0
  v_mov_b32 v18, 0
  v_mov_b32 v19, 0
  s_mov_b32 s66, 0x55555555
  s_mov_b32 s67, 0x55555555
  v_mov_b32 v6, s30
  v_mov_b32 v7, s31
  v_and_b32 v9, 15, v0
  v_lshlrev_b32 v9, 2, v9
  v_mov_b32 v8, 0
  s_mov_b32 s64, 0xff00ff00
  s_mov_b32 s65, 0xff00ff00
  s_mov_b32 s70, 32000056
  s_waitcnt lgkmcnt(0)
L_f2poll:
  ds_read_b32 v8, v9 offset:704
  s_waitcnt lgkmcnt(4)
  v_cmp_eq_u32 vcc, 0, v8
  s_sub_u32 s70, s70, 1
  s_cbranch_scc1 L_f2go
  s_and_b64 vcc, vcc, s[64:65]
  s_cbranch_scc1 L_f2poll
L_f2go:
  v_dot2c_f32_bf16_dpp v16, v8, v80 row_newbcast:0 row_mask:0xf bank_mask:0xf
  v_dot2c_f32_bf16_dpp v17, v8, v88 row_newbcast:0 row_mask:0xf bank_mask:0xf
  v_dot2c_f32_bf16_dpp v18, v8, v81 row_newbcast:1 row_mask:0xf bank_mask:0xf
  v_dot2c_f32_bf16_dpp v19, v8, v89 row_newbcast:1 row_mask:0xf bank_mask:0xf
  v_dot2c_f32_bf16_dpp v16, v8, v82 row_newbcast:2 row_mask:0xf bank_mask:0xf
  v_dot2c_f32_bf16_dpp v17, v8, v90 row_newbcast:2 row_mask:0xf bank_mask:0xf
  v_dot2c_f32_bf16_dpp v18, v8, v83 row_newbcast:3 row_mask:0xf bank_mask:0xf
  v_dot2c_f32_bf16_dpp v19, v8, v91 row_newbcast:3 row_mask:0xf bank_mask:0xf
  v_dot2c_f32_bf16_dpp v16, v8, v84 row_newbcast:4 row_mask:0xf bank_mask:0xf
  v_dot2c_f32_bf16_dpp v17, v8, v92 row_newbcast:4 row_mask:0xf bank_mask:0xf
  v_dot2c_f32_bf16_dpp v18, v8, v85 row_newbcast:5 row_mask:0xf bank_mask:0xf
  v_dot2c_f32_bf16_dpp v19, v8, v93 row_newbcast:5 row_mask:0xf bank_mask:0xf
  v_dot2c_f32_bf16_dpp v16, v8, v86 row_newbcast:6 row_mask:0xf bank_mask:0xf
  v_dot2c_f32_bf16_dpp v17, v8, v94 row_newbcast:6 row_mask:0xf bank_mask:0xf
  v_dot2c_f32_bf16_dpp v18, v8, v87 row_newbcast:7 row_mask:0xf bank_mask:0xf
  v_dot2c_f32_bf16_dpp v19, v8, v95 row_newbcast:7 row_mask:0xf bank_mask:0xf
  s_nop 2
  v_pk_add_f32 v[16:17], v[16:17], v[18:19]
  v_cvt_pk_bf16_f32 v4, v16, v17
  s_nop 1
  v_mov_b32_dpp v5, v4 quad_perm:[1,0,3,2] row_mask:0xf bank_mask:0xf
  s_mov_b64 exec, s[66:67]
  buffer_store_dwordx4 v[4:7], v116, s[24:27], s79 offen sc1
L_end:
  s_endpgm
L_spare:
  v_mov_b32 v1, 0
  s_mov_b32 s70, 4000007
L_spin_99:
  ds_read_b32 v4, v1 offset:668
  s_waitcnt lgkmcnt(0)
  v_cmp_gt_u32 vcc, 1, v4
  s_nop 0
  s_cbranch_vccz L_sdone_100
  s_sleep 2
  s_sub_u32 s70, s70, 1
  s_cbranch_scc0 L_spin_99
L_sdone_100:
  v_lshlrev_b32 v1, 7, v0
  s_sub_u32 s76, s5, 30
  v_mov_b32 v17, 0
  s_mov_b32 s70, 4000007
L_spin_101:
  ds_read_b32 v16, v17 offset:660
  s_waitcnt lgkmcnt(0)
  v_cmp_gt_u32 vcc, 1, v16
  s_nop 0
  s_cbranch_vccz L_sdone_102
  s_sleep 1
  s_sub_u32 s70, s70, 1
  s_cbranch_scc0 L_spin_101
L_sdone_102:
  v_readfirstlane_b32 s47, v16
  s_lshl3_add_u32 s68, s76, s73
  s_cmp_gt_u32 s68, 4
  s_cbranch_scc1 L_noy
  s_lshl_b32 s68, s68, 14
  s_lshr_b32 s69, s47, s4
  s_and_b32 s69, s69, 1
  s_lshl_b32 s69, s69, 13
  s_add_u32 s68, s68, s69
  s_add_u32 s68, s68, 1966080
  buffer_load_dword v8, v1, s[24:27], s68 offen sc1
L_noy:
  s_lshl1_add_u32 s68, s4, s76
  s_lshl3_add_u32 s68, s68, s73
  s_mul_i32 s68, s68, 3072
  s_add_u32 s68, s68, 524288
  s_mov_b64 exec, 0xffffff
  buffer_load_dword v5, v1, s[32:35], s68 offen nt
  s_waitcnt vmcnt(0)
  buffer_load_dword v5, v1, s[32:35], s68 offen sc1
  s_mov_b64 exec, -1
  s_cmp_gt_u32 s73, 5
  s_cbranch_scc1 L_nopa
  s_mul_i32 s68, s4, 6
  s_add_u32 s68, s68, s73
  s_mul_i32 s68, s68, 6144
  s_mul_i32 s69, s76, 917504
  s_add_u32 s68, s68, s69
  s_add_u32 s68, s68, 2228224
  s_mov_b32 exec_lo, 0xff33ffff
  s_mov_b32 exec_hi, 0x33ff
  buffer_load_dword v4, v1, s[32:35], s68 offen nt
  s_waitcnt vmcnt(0)
  buffer_load_dword v4, v1, s[32:35], s68 offen sc1
  s_mov_b64 exec, -1
L_nopa:
  s_endpgm
L_dry:
  s_endpgm
L_slow_25:
  s_mov_b32 exec_lo, 0xffffffff
  s_mov_b32 exec_hi, 0xffff
  buffer_store_dwordx4 v[4:7], v13, s[24:27], s74 offen sc1
  s_mov_b64 exec, -1
  s_nop 1
  s_branch L_back_26
L_slow_32:
  s_mov_b32 exec_lo, 0x55555555
  s_mov_b32 exec_hi, 0x0
  buffer_store_dwordx4 v[8:11], v2, s[24:27], s66 offen offset:1536 sc1
  s_mov_b64 exec, -1
  s_nop 1
  s_branch L_back_33
L_slow_46:
  s_mov_b32 exec_lo, 0x101
  s_mov_b32 exec_hi, 0x0
  buffer_store_dwordx4 v[2:5], v12, s[24:27], s68 offen sc1
  s_mov_b64 exec, -1
  s_nop 1
  s_branch L_back_47
L_slow_54:
  s_mov_b32 exec_lo, 0xffffffff
  s_mov_b32 exec_hi, 0xffff
  buffer_store_dwordx4 v[4:7], v13, s[24:27], s74 offen sc1
  s_mov_b64 exec, -1
  s_nop 1
  s_branch L_back_55
L_slow_72:
  s_mov_b32 exec_lo, 0x1
  s_mov_b32 exec_hi, 0x0
  buffer_store_dwordx4 v[4:7], v55, s[24:27], s72 offen sc1
  s_mov_b32 exec_lo, 0x110011
  s_mov_b32 exec_hi, 0x110011
  buffer_store_dwordx4 v[12:15], v54, s[24:27], s75 offen sc1
  s_mov_b64 exec, -1
  s_nop 1
  s_branch L_back_73
L_slow_74:
  s_mov_b32 exec_lo, 0xffffffff
  s_mov_b32 exec_hi, 0x0
  buffer_store_dwordx4 v[32:35], v59, s[24:27], s77 offen sc1
  s_mov_b64 exec, -1
  s_nop 1
  s_branch L_back_75
L_slow_76:
  s_mov_b32 exec_lo, 0xffffffff
  s_mov_b32 exec_hi, 0x0
  buffer_store_dwordx4 v[4:7], v59, s[24:27], s76 offen sc1
  s_mov_b64 exec, -1
  s_nop 1
  s_branch L_back_77
L_pslow_82:
  s_mov_b32 s16, s32
  s_mov_b32 s17, s33
  s_mov_b32 s18, 4194304
  s_mov_b32 s19, 0x20000
  s_mov_b32 s70, 4000007
L_spin_85:
  buffer_load_dwordx4 v[16:19], v60, s[16:19], s62 offen sc1
  buffer_load_dwordx4 v[20:23], v60, s[16:19], s62 offen offset:1024 sc1
  s_mov_b64 exec, s[10:11]
  buffer_load_dwordx4 v[24:27], v60, s[16:19], s62 offen offset:2048 sc1
  s_mov_b64 exec, -1
  s_mov_b64 exec, s[8:9]
  buffer_load_dwordx4 v[140:143], v61, s[16:19], s65 offen sc1
  s_mov_b64 exec, -1
  buffer_load_dwordx4 v[128:131], v60, s[16:19], s60 offen sc1
  buffer_load_dwordx4 v[132:135], v60, s[16:19], s60 offen offset:1024 sc1
  s_mov_b64 exec, s[10:11]
  buffer_load_dwordx4 v[136:139], v60, s[16:19], s60 offen offset:2048 sc1
  s_mov_b64 exec, -1
  s_waitcnt vmcnt(0)
  v_cmp_ne_u64 vcc, s[30:31], v[18:19]
  v_cmp_ne_u64 s[20:21], s[30:31], v[22:23]
  v_cmp_ne_u64 s[22:23], s[30:31], v[26:27]
  s_or_b64 vcc, vcc, s[20:21]
  s_or_b64 vcc, vcc, s[22:23]
  s_nop 0
  s_cbranch_vccz L_sdone_86
  s_and_b32 s99, s70, 7
  s_cmp_eq_u32 s46, 1
  s_cselect_b32 s99, 1, s99
  s_cmp_lg_u32 s99, 0
  s_cselect_b32 s16, s32, s24
  s_cselect_b32 s17, s33, s25
  s_sub_u32 s70, s70, 1
  s_cbranch_scc0 L_spin_85
L_sdone_86:
  s_branch L_pok_83
L_pslow_87:
  s_mov_b32 s16, s32
  s_mov_b32 s17, s33
  s_mov_b32 s18, 4194304
  s_mov_b32 s19, 0x20000
  s_mov_b32 s70, 4000007
L_spin_90:
  s_mov_b64 exec, s[8:9]
  buffer_load_dwordx4 v[140:143], v61, s[16:19], s65 offen sc1
  s_mov_b64 exec, -1
  s_waitcnt vmcnt(0)
  v_cmp_ne_u64 vcc, s[30:31], v[142:143]
  s_nop 0
  s_cbranch_vccz L_sdone_91
  s_and_b32 s99, s70, 7
  s_cmp_eq_u32 s46, 1
  s_cselect_b32 s99, 1, s99
  s_cmp_lg_u32 s99, 0
  s_cselect_b32 s16, s32, s24
  s_cselect_b32 s17, s33, s25
  s_sub_u32 s70, s70, 1
  s_cbranch_scc0 L_spin_90
L_sdone_91:
  s_branch L_pok_88
L_pslow_92:
  s_mov_b32 s16, s32
  s_mov_b32 s17, s33
  s_mov_b32 s18, 4194304
  s_mov_b32 s19, 0x20000
  s_mov_b32 s70, 4000007
L_spin_95:
  buffer_load_dwordx4 v[128:131], v60, s[16:19], s60 offen sc1
  buffer_load_dwordx4 v[132:135], v60, s[16:19], s60 offen offset:1024 sc1
  s_mov_b64 exec, s[10:11]
  buffer_load_dwordx4 v[136:139], v60, s[16:19], s60 offen offset:2048 sc1
  s_mov_b64 exec, -1
  s_waitcnt vmcnt(0)
  v_cmp_ne_u64 vcc, s[30:31], v[130:131]
  v_cmp_ne_u64 s[20:21], s[30:31], v[134:135]
  v_cmp_ne_u64 s[22:23], s[30:31], v[138:139]
  s_or_b64 vcc, vcc, s[20:21]
  s_or_b64 vcc, vcc, s[22:23]
  s_nop 0
  s_cbranch_vccz L_sdone_96
  s_and_b32 s99, s70, 7
  s_cmp_eq_u32 s46, 1
  s_cselect_b32 s99, 1, s99
  s_cmp_lg_u32 s99, 0
  s_cselect_b32 s16, s32, s24
  s_cselect_b32 s17, s33, s25
  s_sub_u32 s70, s70, 1
  s_cbranch_scc0 L_spin_95
L_sdone_96:
  s_branch L_pok_93
L_codeend:
.section .rodata,"a"
.p2align 6
.amdhsa_kernel sequential_preLN__sliding_block_cached__glu_gated_swiglu__decode_kernel
  .amdhsa_next_free_vgpr 168
  .amdhsa_next_free_sgpr 100
  .amdhsa_accum_offset 168
  .amdhsa_group_segment_fixed_size 0
  .amdhsa_kernarg_size 96
  .amdhsa_user_sgpr_count 2
  .amdhsa_user_sgpr_kernarg_segment_ptr 1
  .amdhsa_system_sgpr_workgroup_id_x 1
.end_amdhsa_kernel
```
